```python
import torch

def _softmax(x, axis=-1):
    return torch.softmax(x, dim=axis)
def _gelu(x):
    return torch.nn.functional.gelu(x, approximate="tanh")
def _silu(x):
    return torch.nn.functional.silu(x)
def _sigmoid(x):
    return torch.sigmoid(x)
def _layernorm(x, axis=-1, eps=1e-5):
    m = x.mean(dim=axis, keepdim=True)
    v = x.var(dim=axis, keepdim=True, unbiased=False)
    return (x - m) / torch.sqrt(v + eps)
def _scatter_add(tgt, idx, src, axis=0):
    return tgt.clone().index_add_(axis, idx, src)
def _segment_sum(src, seg, n):
    out = torch.zeros((n,) + src.shape[1:], dtype=src.dtype)
    return out.index_add_(0, seg, src)
def _pad(x, pw):
    flat = tuple(v for pair in reversed(pw) for v in pair)
    return torch.nn.functional.pad(x, flat)

kernel_name = 'standalone__hybrid_graph_tf_exphormer__graph'

def setup_inputs():

    _w = (lambda a: (lambda t: t.to(torch.bfloat16) if t.is_floating_point() else t)(torch.as_tensor(a)))
    N, deg, D = 10000, 16, 256
    E = N * deg
    exp_deg = 4
    Ee = N * exp_deg
    src = (lambda lo, hi, *s: torch.randint(lo, hi, s))(0, N, E).to(torch.int64)
    dst = (lambda lo, hi, *s: torch.randint(lo, hi, s))(0, N, E).to(torch.int64)
    esrc = (lambda lo, hi, *s: torch.randint(lo, hi, s))(0, N, Ee).to(torch.int64)
    edst = torch.repeat_interleave(torch.arange(N), exp_deg).to(torch.int64)
    deg_cnt = torch.bincount(dst, minlength=N).to(float) + 1.0
    return {
        "x": _w((lambda *s: torch.randn(*s, dtype=torch.bfloat16) * 0.05)(N, D)),
        "src": _w(src),
        "dst": _w(dst),
        "esrc": _w(esrc),
        "edst": _w(edst),
        "deg_inv_sqrt": _w(1.0 / (lambda _x: torch.sqrt(torch.as_tensor(_x)))(deg_cnt)),
        "w_l": _w((lambda *s: torch.randn(*s, dtype=torch.bfloat16) * 0.05)(D, D)),
        "wq": _w((lambda *s: torch.randn(*s, dtype=torch.bfloat16) * 0.05)(D, D)),
        "wk": _w((lambda *s: torch.randn(*s, dtype=torch.bfloat16) * 0.05)(D, D)),
        "wv": _w((lambda *s: torch.randn(*s, dtype=torch.bfloat16) * 0.05)(D, D)),
    }

def reference(x, src, dst, esrc, edst, deg_inv_sqrt, w_l, wq, wk, wv):
    N, D = x.shape
    h = x @ w_l
    msg = h[src] * deg_inv_sqrt[src, None] * deg_inv_sqrt[dst, None]
    h_local = _segment_sum(msg, dst, N)
    q = x @ wq
    k = x @ wk
    v = x @ wv
    e = (q[edst] * k[esrc]).sum(-1) * (D ** -0.5)
    exp_e = torch.exp(e)
    denom = _segment_sum(exp_e[:, None], edst, N)[:, 0] + 1e-9
    alpha = exp_e / denom[edst]
    h_attn = _segment_sum(alpha[:, None] * v[esrc], edst, N)
    return h_local + h_attn
```

```asm
; @launch grid=(250,1,1) block=(512,1,1) lds=160832
.amdgcn_target "amdgcn-amd-amdhsa--gfx950"
.text
.globl standalone__hybrid_graph_tf_exphormer__graph_kernel
.p2align 8
.type standalone__hybrid_graph_tf_exphormer__graph_kernel,@function
standalone__hybrid_graph_tf_exphormer__graph_kernel:
    s_cmp_ge_u32 s2, 250
    s_cbranch_scc1 L_exit
    s_load_dwordx16 s[32:47], s[0:1], 0
    s_load_dwordx8 s[48:55], s[0:1], 64
    s_load_dwordx2 s[56:57], s[0:1], 96
    v_lshrrev_b32 v1, 6, v0
    v_mov_b32 v8, 0xffff
    v_readfirstlane_b32 s3, v1
    v_cmp_gt_u32 vcc, 256, v0
    v_lshlrev_b32 v4, 4, v0
    v_add_u32 v4, 152064, v4
    v_cndmask_b32 v8, 0, v8, vcc
    v_mov_b32 v9, v8
    v_mov_b32 v10, v8
    v_mov_b32 v11, v8
    v_cmp_gt_u32 vcc, 356, v0
    s_and_saveexec_b64 s[58:59], vcc
    ds_write_b128 v4, v[8:11]
    s_mov_b64 exec, -1
    v_and_b32 v0, 63, v0
    s_and_b32 s58, s2, 7
    s_lshr_b32 s59, s2, 3
    s_mul_i32 s6, s58, 31
    s_min_u32 s58, s58, 2
    s_add_u32 s6, s6, s58
    s_add_u32 s6, s6, s59
    s_mul_i32 s5, s6, 40
    s_and_b32 s4, s3, 3
    s_movk_i32 s7, 512
    v_and_b32 v4, 7, v0
    v_mul_u32_u24 v1, 1056, v4
    v_and_b32 v4, 8, v0
    v_lshl_add_u32 v1, v4, 6, v1
    v_and_b32 v4, 48, v0
    v_add_u32 v1, v4, v1
    v_and_b32 v2, 31, v0
    v_lshlrev_b32 v2, 4, v2
    v_mov_b32 v3, 156672
    s_mov_b32 s70, 0x05040100
    s_mov_b32 s71, 0x07060302
    s_waitcnt lgkmcnt(0)
    s_barrier
    s_mov_b32 s8, s32
    s_mov_b32 s9, s33
    s_mov_b32 s10, 5120000
    s_mov_b32 s11, 0x20000
    s_mov_b32 s16, s56
    s_mov_b32 s17, s57
    s_mov_b32 s18, 2097152
    s_mov_b32 s19, 0x20000
    s_cmp_ge_u32 s3, 4
    s_cselect_b32 s12, s44, s50
    s_cselect_b32 s13, s45, s51
    s_mov_b32 s14, 131072
    s_mov_b32 s15, 0x20000
    s_cbranch_scc1 L_preB
    s_mov_b32 s24, s38
    s_mov_b32 s25, s39
    s_mov_b32 s26, 160000
    s_mov_b32 s27, 0x20000
    v_and_b32 v4, 32, v0
    s_mul_i32 s58, s6, 640
    s_lshl_b32 s59, s3, 6
    s_add_u32 s58, s58, s59
    buffer_load_dwordx4 v[16:19], v4, s[24:27], s58 offen offset:0
    buffer_load_dwordx4 v[20:23], v4, s[24:27], s58 offen offset:16
    buffer_load_dwordx4 v[24:27], v4, s[24:27], s58 offen offset:256
    buffer_load_dwordx4 v[28:31], v4, s[24:27], s58 offen offset:272
    buffer_load_dwordx4 v[32:35], v4, s[24:27], s58 offen offset:512
    buffer_load_dwordx4 v[36:39], v4, s[24:27], s58 offen offset:528
    v_lshl_add_u32 v5, v4, 7, v2
    v_lshl_add_u32 v6, v4, 6, v2
    s_add_u32 s58, s5, s3
    s_lshl_b32 s58, s58, 9
    s_mul_i32 s59, s3, 1056
    s_add_u32 m0, s59, 84480
    s_add_u32 s60, s58, 0
    buffer_load_dwordx4 v5, s[8:11], s60 offen lds
    s_add_u32 m0, s59, 88704
    s_add_u32 s60, s58, 2048
    buffer_load_dwordx4 v5, s[8:11], s60 offen lds
    s_add_u32 m0, s59, 92928
    s_add_u32 s60, s58, 8192
    buffer_load_dwordx4 v5, s[8:11], s60 offen lds
    s_add_u32 m0, s59, 97152
    s_add_u32 s60, s58, 10240
    buffer_load_dwordx4 v5, s[8:11], s60 offen lds
    s_add_u32 m0, s59, 101376
    s_add_u32 s60, s58, 16384
    buffer_load_dwordx4 v6, s[8:11], s60 offen lds
    s_mul_i32 s59, s3, 8448
    s_waitcnt vmcnt(5)
    s_add_u32 m0, s59, 0
    v_lshl_add_u32 v4, v16, 9, v2
    buffer_load_dwordx4 v4, s[8:11], 0 offen lds
    s_add_u32 m0, s59, 1056
    v_lshl_add_u32 v5, v17, 9, v2
    buffer_load_dwordx4 v5, s[8:11], 0 offen lds
    s_add_u32 m0, s59, 2112
    v_lshl_add_u32 v4, v18, 9, v2
    buffer_load_dwordx4 v4, s[8:11], 0 offen lds
    s_add_u32 m0, s59, 3168
    v_lshl_add_u32 v5, v19, 9, v2
    buffer_load_dwordx4 v5, s[8:11], 0 offen lds
    s_add_u32 m0, s59, 4224
    v_lshl_add_u32 v4, v20, 9, v2
    buffer_load_dwordx4 v4, s[8:11], 0 offen lds
    s_add_u32 m0, s59, 5280
    v_lshl_add_u32 v5, v21, 9, v2
    buffer_load_dwordx4 v5, s[8:11], 0 offen lds
    s_add_u32 m0, s59, 6336
    v_lshl_add_u32 v4, v22, 9, v2
    buffer_load_dwordx4 v4, s[8:11], 0 offen lds
    s_add_u32 m0, s59, 7392
    v_lshl_add_u32 v5, v23, 9, v2
    buffer_load_dwordx4 v5, s[8:11], 0 offen lds
    s_add_u32 m0, s59, 33792
    v_lshl_add_u32 v4, v24, 9, v2
    buffer_load_dwordx4 v4, s[8:11], 0 offen lds
    s_add_u32 m0, s59, 34848
    v_lshl_add_u32 v5, v25, 9, v2
    buffer_load_dwordx4 v5, s[8:11], 0 offen lds
    s_add_u32 m0, s59, 35904
    v_lshl_add_u32 v4, v26, 9, v2
    buffer_load_dwordx4 v4, s[8:11], 0 offen lds
    s_add_u32 m0, s59, 36960
    v_lshl_add_u32 v5, v27, 9, v2
    buffer_load_dwordx4 v5, s[8:11], 0 offen lds
    s_add_u32 m0, s59, 38016
    v_lshl_add_u32 v4, v28, 9, v2
    buffer_load_dwordx4 v4, s[8:11], 0 offen lds
    s_add_u32 m0, s59, 39072
    v_lshl_add_u32 v5, v29, 9, v2
    buffer_load_dwordx4 v5, s[8:11], 0 offen lds
    s_add_u32 m0, s59, 40128
    v_lshl_add_u32 v4, v30, 9, v2
    buffer_load_dwordx4 v4, s[8:11], 0 offen lds
    s_add_u32 m0, s59, 41184
    v_lshl_add_u32 v5, v31, 9, v2
    buffer_load_dwordx4 v5, s[8:11], 0 offen lds
    s_cmp_ge_u32 s3, 2
    s_cbranch_scc1 L_wload
    s_add_u32 m0, s59, 67584
    v_lshl_add_u32 v4, v32, 9, v2
    buffer_load_dwordx4 v4, s[8:11], 0 offen lds
    s_add_u32 m0, s59, 68640
    v_lshl_add_u32 v5, v33, 9, v2
    buffer_load_dwordx4 v5, s[8:11], 0 offen lds
    s_add_u32 m0, s59, 69696
    v_lshl_add_u32 v4, v34, 9, v2
    buffer_load_dwordx4 v4, s[8:11], 0 offen lds
    s_add_u32 m0, s59, 70752
    v_lshl_add_u32 v5, v35, 9, v2
    buffer_load_dwordx4 v5, s[8:11], 0 offen lds
    s_add_u32 m0, s59, 71808
    v_lshl_add_u32 v4, v36, 9, v2
    buffer_load_dwordx4 v4, s[8:11], 0 offen lds
    s_add_u32 m0, s59, 72864
    v_lshl_add_u32 v5, v37, 9, v2
    buffer_load_dwordx4 v5, s[8:11], 0 offen lds
    s_add_u32 m0, s59, 73920
    v_lshl_add_u32 v4, v38, 9, v2
    buffer_load_dwordx4 v4, s[8:11], 0 offen lds
    s_add_u32 m0, s59, 74976
    v_lshl_add_u32 v5, v39, 9, v2
    buffer_load_dwordx4 v5, s[8:11], 0 offen lds
    s_branch L_wload
L_preB:
    s_cmp_eq_u32 s3, 5
    s_cbranch_scc1 L_mtask
    s_cmp_eq_u32 s3, 4
    s_cbranch_scc1 L_prod
    s_mov_b32 s24, s42
    s_mov_b32 s25, s43
    s_mov_b32 s26, 20000
    s_mov_b32 s27, 0x20000
    s_sub_u32 s58, s3, 6
    s_mul_i32 s58, s58, 10240
    v_lshlrev_b32 v4, 4, v0
    s_add_u32 m0, s58, 130944
    s_add_u32 s59, s58, 0
    buffer_load_dwordx4 v4, s[24:27], s59 offen offset:0 lds
    buffer_load_dwordx4 v4, s[24:27], s59 offen offset:1024 lds
    buffer_load_dwordx4 v4, s[24:27], s59 offen offset:2048 lds
    buffer_load_dwordx4 v4, s[24:27], s59 offen offset:3072 lds
    s_add_u32 m0, s58, 135040
    s_add_u32 s59, s58, 4096
    buffer_load_dwordx4 v4, s[24:27], s59 offen offset:0 lds
    buffer_load_dwordx4 v4, s[24:27], s59 offen offset:1024 lds
    buffer_load_dwordx4 v4, s[24:27], s59 offen offset:2048 lds
    buffer_load_dwordx4 v4, s[24:27], s59 offen offset:3072 lds
    s_add_u32 m0, s58, 139136
    s_add_u32 s59, s58, 8192
    buffer_load_dwordx4 v4, s[24:27], s59 offen offset:0 lds
    buffer_load_dwordx4 v4, s[24:27], s59 offen offset:1024 lds
    s_branch L_wload
L_mtask:
    s_cmp_ge_u32 s2, 128
    s_cbranch_scc1 L_mdone
    s_setprio 2
    s_mov_b32 s24, s46
    s_mov_b32 s25, s47
    s_mov_b32 s26, 131072
    s_mov_b32 s27, 0x20000
    s_mov_b32 s28, s48
    s_mov_b32 s29, s49
    s_mov_b32 s30, 131072
    s_mov_b32 s31, 0x20000
    v_and_b32 v4, 32, v0
    v_lshl_add_u32 v4, v4, 8, v2
    s_and_b32 s58, s2, 7
    s_lshl_b32 s58, s58, 14
    s_lshr_b32 s59, s2, 4
    s_lshl_b32 s59, s59, 14
    s_bfe_u32 s60, s2, 0x10003
    s_lshl_b32 s60, s60, 11
    s_add_u32 s59, s59, s60
    s_mov_b32 m0, 105600
    s_add_u32 s60, s58, 0
    buffer_load_dwordx4 v4, s[24:27], s60 offen lds
    s_mov_b32 m0, 106656
    s_add_u32 s60, s58, 512
    buffer_load_dwordx4 v4, s[24:27], s60 offen lds
    s_mov_b32 m0, 107712
    s_add_u32 s60, s58, 1024
    buffer_load_dwordx4 v4, s[24:27], s60 offen lds
    s_mov_b32 m0, 108768
    s_add_u32 s60, s58, 1536
    buffer_load_dwordx4 v4, s[24:27], s60 offen lds
    s_mov_b32 m0, 109824
    s_add_u32 s60, s58, 4096
    buffer_load_dwordx4 v4, s[24:27], s60 offen lds
    s_mov_b32 m0, 110880
    s_add_u32 s60, s58, 4608
    buffer_load_dwordx4 v4, s[24:27], s60 offen lds
    s_mov_b32 m0, 111936
    s_add_u32 s60, s58, 5120
    buffer_load_dwordx4 v4, s[24:27], s60 offen lds
    s_mov_b32 m0, 112992
    s_add_u32 s60, s58, 5632
    buffer_load_dwordx4 v4, s[24:27], s60 offen lds
    s_mov_b32 m0, 114048
    s_add_u32 s60, s58, 2048
    buffer_load_dwordx4 v4, s[24:27], s60 offen lds
    s_mov_b32 m0, 115104
    s_add_u32 s60, s58, 2560
    buffer_load_dwordx4 v4, s[24:27], s60 offen lds
    s_mov_b32 m0, 116160
    s_add_u32 s60, s58, 3072
    buffer_load_dwordx4 v4, s[24:27], s60 offen lds
    s_mov_b32 m0, 117216
    s_add_u32 s60, s58, 3584
    buffer_load_dwordx4 v4, s[24:27], s60 offen lds
    s_mov_b32 m0, 118272
    s_add_u32 s60, s58, 6144
    buffer_load_dwordx4 v4, s[24:27], s60 offen lds
    s_mov_b32 m0, 119328
    s_add_u32 s60, s58, 6656
    buffer_load_dwordx4 v4, s[24:27], s60 offen lds
    s_mov_b32 m0, 120384
    s_add_u32 s60, s58, 7168
    buffer_load_dwordx4 v4, s[24:27], s60 offen lds
    s_mov_b32 m0, 121440
    s_add_u32 s60, s58, 7680
    buffer_load_dwordx4 v4, s[24:27], s60 offen lds
    s_mov_b32 m0, 122496
    s_add_u32 s60, s59, 0
    buffer_load_dwordx4 v4, s[28:31], s60 offen lds
    s_mov_b32 m0, 123552
    s_add_u32 s60, s59, 512
    buffer_load_dwordx4 v4, s[28:31], s60 offen lds
    s_mov_b32 m0, 124608
    s_add_u32 s60, s59, 1024
    buffer_load_dwordx4 v4, s[28:31], s60 offen lds
    s_mov_b32 m0, 125664
    s_add_u32 s60, s59, 1536
    buffer_load_dwordx4 v4, s[28:31], s60 offen lds
    s_mov_b32 m0, 126720
    s_add_u32 s60, s59, 4096
    buffer_load_dwordx4 v4, s[28:31], s60 offen lds
    s_mov_b32 m0, 127776
    s_add_u32 s60, s59, 4608
    buffer_load_dwordx4 v4, s[28:31], s60 offen lds
    s_mov_b32 m0, 128832
    s_add_u32 s60, s59, 5120
    buffer_load_dwordx4 v4, s[28:31], s60 offen lds
    s_mov_b32 m0, 129888
    s_add_u32 s60, s59, 5632
    buffer_load_dwordx4 v4, s[28:31], s60 offen lds
    v_add_u32 v5, 105600, v1
    s_lshr_b32 s58, s2, 4
    s_lshl_b32 s58, s58, 3
    s_and_b32 s59, s2, 7
    s_add_u32 s58, s58, s59
    s_lshl_b32 s58, s58, 1
    s_bfe_u32 s59, s2, 0x10003
    s_add_u32 s58, s58, s59
    s_lshl_b32 s58, s58, 10
    s_add_u32 s58, s58, 1048576
    v_lshlrev_b32 v6, 4, v0
    s_waitcnt vmcnt(0)
    ds_read_b128 v[16:19], v5 offset:0
    ds_read_b128 v[20:23], v5 offset:8448
    ds_read_b128 v[24:27], v5 offset:16896
    ds_read_b128 v[28:31], v5 offset:64
    ds_read_b128 v[32:35], v5 offset:8512
    ds_read_b128 v[36:39], v5 offset:16960
    ds_read_b128 v[40:43], v5 offset:128
    ds_read_b128 v[44:47], v5 offset:8576
    ds_read_b128 v[48:51], v5 offset:17024
    ds_read_b128 v[52:55], v5 offset:192
    ds_read_b128 v[56:59], v5 offset:8640
    ds_read_b128 v[60:63], v5 offset:17088
    s_waitcnt lgkmcnt(9)
    v_mfma_f32_16x16x32_bf16 v[8:11], v[16:19], v[24:27], 0
    v_mfma_f32_16x16x32_bf16 v[12:15], v[20:23], v[24:27], 0
    s_waitcnt lgkmcnt(6)
    v_mfma_f32_16x16x32_bf16 v[8:11], v[28:31], v[36:39], v[8:11]
    v_mfma_f32_16x16x32_bf16 v[12:15], v[32:35], v[36:39], v[12:15]
    s_waitcnt lgkmcnt(3)
    v_mfma_f32_16x16x32_bf16 v[8:11], v[40:43], v[48:51], v[8:11]
    v_mfma_f32_16x16x32_bf16 v[12:15], v[44:47], v[48:51], v[12:15]
    s_waitcnt lgkmcnt(0)
    v_mfma_f32_16x16x32_bf16 v[8:11], v[52:55], v[60:63], v[8:11]
    v_mfma_f32_16x16x32_bf16 v[12:15], v[56:59], v[60:63], v[12:15]
    ds_read_b128 v[16:19], v5 offset:256
    ds_read_b128 v[20:23], v5 offset:8704
    ds_read_b128 v[24:27], v5 offset:17152
    ds_read_b128 v[28:31], v5 offset:320
    ds_read_b128 v[32:35], v5 offset:8768
    ds_read_b128 v[36:39], v5 offset:17216
    ds_read_b128 v[40:43], v5 offset:384
    ds_read_b128 v[44:47], v5 offset:8832
    ds_read_b128 v[48:51], v5 offset:17280
    ds_read_b128 v[52:55], v5 offset:448
    ds_read_b128 v[56:59], v5 offset:8896
    ds_read_b128 v[60:63], v5 offset:17344
    s_waitcnt lgkmcnt(9)
    v_mfma_f32_16x16x32_bf16 v[8:11], v[16:19], v[24:27], v[8:11]
    v_mfma_f32_16x16x32_bf16 v[12:15], v[20:23], v[24:27], v[12:15]
    s_waitcnt lgkmcnt(6)
    v_mfma_f32_16x16x32_bf16 v[8:11], v[28:31], v[36:39], v[8:11]
    v_mfma_f32_16x16x32_bf16 v[12:15], v[32:35], v[36:39], v[12:15]
    s_waitcnt lgkmcnt(3)
    v_mfma_f32_16x16x32_bf16 v[8:11], v[40:43], v[48:51], v[8:11]
    v_mfma_f32_16x16x32_bf16 v[12:15], v[44:47], v[48:51], v[12:15]
    s_waitcnt lgkmcnt(0)
    v_mfma_f32_16x16x32_bf16 v[8:11], v[52:55], v[60:63], v[8:11]
    v_mfma_f32_16x16x32_bf16 v[12:15], v[56:59], v[60:63], v[12:15]
    s_nop 7
    v_cvt_pk_bf16_f32 v16, v8, v9
    v_cvt_pk_bf16_f32 v17, v10, v11
    v_cvt_pk_bf16_f32 v18, v12, v13
    v_cvt_pk_bf16_f32 v19, v14, v15
    buffer_store_dwordx4 v[16:19], v6, s[16:19], s58 offen sc1
    s_waitcnt vmcnt(0)
    s_setprio 0
L_mdone:
    s_mov_b64 exec, 1
    v_mov_b32 v4, 1
    ds_add_u32 v3, v4 offset:8
    s_mov_b64 exec, -1
    s_branch L_wload
L_prod:
    s_setprio 3
    s_mov_b32 s24, s34
    s_mov_b32 s25, s35
    s_mov_b32 s26, 640000
    s_mov_b32 s27, 0x20000
    s_mov_b32 s28, s36
    s_mov_b32 s29, s37
    s_mov_b32 s30, 640000
    s_mov_b32 s31, 0x20000
    v_lshlrev_b32 v5, 4, v0
    v_lshlrev_b32 v6, 3, v0
    s_mul_i32 s58, s2, 2560
    buffer_load_dwordx4 v[26:29], v5, s[28:31], s58 offen
    buffer_load_dwordx4 v[30:33], v5, s[28:31], s58 offen offset:1024
    buffer_load_dwordx2 v[34:35], v6, s[28:31], s58 offen offset:2048
    buffer_load_dwordx4 v[16:19], v5, s[24:27], s58 offen
    buffer_load_dwordx4 v[20:23], v5, s[24:27], s58 offen offset:1024
    buffer_load_dwordx2 v[24:25], v6, s[24:27], s58 offen offset:2048
    v_mov_b32 v8, 1
    v_mov_b32 v9, 4
    v_mov_b32 v10, 156736
    v_add_u32 v11, 156736, v5
    s_lshl_b32 s59, s2, 10
    s_add_u32 s58, s58, 262144
    s_waitcnt vmcnt(3)
    v_mul_u32_u24 v36, 52429, v26
    v_lshrrev_b32 v36, 21, v36
    v_lshl_add_u32 v36, v36, 2, v10
    ds_add_u32 v36, v8
    v_mul_u32_u24 v37, 52429, v27
    v_lshrrev_b32 v37, 21, v37
    v_lshl_add_u32 v37, v37, 2, v10
    ds_add_u32 v37, v8
    v_mul_u32_u24 v38, 52429, v28
    v_lshrrev_b32 v38, 21, v38
    v_lshl_add_u32 v38, v38, 2, v10
    ds_add_u32 v38, v8
    v_mul_u32_u24 v39, 52429, v29
    v_lshrrev_b32 v39, 21, v39
    v_lshl_add_u32 v39, v39, 2, v10
    ds_add_u32 v39, v8
    v_mul_u32_u24 v40, 52429, v30
    v_lshrrev_b32 v40, 21, v40
    v_lshl_add_u32 v40, v40, 2, v10
    ds_add_u32 v40, v8
    v_mul_u32_u24 v41, 52429, v31
    v_lshrrev_b32 v41, 21, v41
    v_lshl_add_u32 v41, v41, 2, v10
    ds_add_u32 v41, v8
    v_mul_u32_u24 v42, 52429, v32
    v_lshrrev_b32 v42, 21, v42
    v_lshl_add_u32 v42, v42, 2, v10
    ds_add_u32 v42, v8
    v_mul_u32_u24 v43, 52429, v33
    v_lshrrev_b32 v43, 21, v43
    v_lshl_add_u32 v43, v43, 2, v10
    ds_add_u32 v43, v8
    v_mul_u32_u24 v44, 52429, v34
    v_lshrrev_b32 v44, 21, v44
    v_lshl_add_u32 v44, v44, 2, v10
    ds_add_u32 v44, v8
    v_mul_u32_u24 v45, 52429, v35
    v_lshrrev_b32 v45, 21, v45
    v_lshl_add_u32 v45, v45, 2, v10
    ds_add_u32 v45, v8
    ds_read_b128 v[12:15], v11
    s_waitcnt vmcnt(0)
    v_lshl_or_b32 v16, v26, 16, v16
    v_lshl_or_b32 v17, v27, 16, v17
    v_lshl_or_b32 v18, v28, 16, v18
    v_lshl_or_b32 v19, v29, 16, v19
    v_lshl_or_b32 v20, v30, 16, v20
    v_lshl_or_b32 v21, v31, 16, v21
    v_lshl_or_b32 v22, v32, 16, v22
    v_lshl_or_b32 v23, v33, 16, v23
    v_lshl_or_b32 v24, v34, 16, v24
    v_lshl_or_b32 v25, v35, 16, v25
    s_waitcnt lgkmcnt(0)
    v_add_u32 v56, v12, v13
    v_add3_u32 v57, v56, v14, v15
    v_mov_b32 v58, v57
    s_nop 1
    v_add_u32_dpp v58, v58, v58 row_shr:1 row_mask:0xf bank_mask:0xf bound_ctrl:1
    s_nop 1
    v_add_u32_dpp v58, v58, v58 row_shr:2 row_mask:0xf bank_mask:0xf bound_ctrl:1
    s_nop 1
    v_add_u32_dpp v58, v58, v58 row_shr:4 row_mask:0xf bank_mask:0xf bound_ctrl:1
    s_nop 1
    v_add_u32_dpp v58, v58, v58 row_shr:8 row_mask:0xf bank_mask:0xf bound_ctrl:1
    s_nop 1
    v_add_u32_dpp v58, v58, v58 row_bcast:15 row_mask:0xa bank_mask:0xf
    s_nop 1
    v_add_u32_dpp v58, v58, v58 row_bcast:31 row_mask:0xc bank_mask:0xf
    v_mov_b32 v59, 157760
    v_sub_u32 v60, v58, v57
    v_add_u32 v61, v60, v12
    v_add_u32 v62, v60, v56
    v_add_u32 v63, v62, v14
    v_lshl_add_u32 v64, v60, 2, v59
    v_lshl_add_u32 v65, v61, 2, v59
    v_lshl_add_u32 v66, v62, 2, v59
    v_lshl_add_u32 v67, v63, 2, v59
    ds_write_b128 v11, v[64:67]
    ds_add_rtn_u32 v46, v36, v9
    ds_add_rtn_u32 v47, v37, v9
    ds_add_rtn_u32 v48, v38, v9
    ds_add_rtn_u32 v49, v39, v9
    ds_add_rtn_u32 v50, v40, v9
    ds_add_rtn_u32 v51, v41, v9
    ds_add_rtn_u32 v52, v42, v9
    ds_add_rtn_u32 v53, v43, v9
    ds_add_rtn_u32 v54, v44, v9
    ds_add_rtn_u32 v55, v45, v9
    v_lshl_or_b32 v60, v12, 16, v60
    v_lshl_or_b32 v61, v13, 16, v61
    v_lshl_or_b32 v62, v14, 16, v62
    v_lshl_or_b32 v63, v15, 16, v63
    buffer_store_dwordx4 v[60:63], v5, s[16:19], s59 offen sc1
    v_add_u32 v11, 157760, v5
    v_add_u32 v10, 157760, v6
    s_waitcnt lgkmcnt(9)
    ds_write_b32 v46, v16
    s_waitcnt lgkmcnt(9)
    ds_write_b32 v47, v17
    s_waitcnt lgkmcnt(9)
    ds_write_b32 v48, v18
    s_waitcnt lgkmcnt(9)
    ds_write_b32 v49, v19
    s_waitcnt lgkmcnt(9)
    ds_write_b32 v50, v20
    s_waitcnt lgkmcnt(9)
    ds_write_b32 v51, v21
    s_waitcnt lgkmcnt(9)
    ds_write_b32 v52, v22
    s_waitcnt lgkmcnt(9)
    ds_write_b32 v53, v23
    s_waitcnt lgkmcnt(9)
    ds_write_b32 v54, v24
    s_waitcnt lgkmcnt(9)
    ds_write_b32 v55, v25
    ds_read_b128 v[64:67], v11
    ds_read_b128 v[68:71], v11 offset:1024
    ds_read_b64 v[72:73], v10 offset:2048
    s_waitcnt lgkmcnt(2)
    buffer_store_dwordx4 v[64:67], v5, s[16:19], s58 offen sc1
    s_waitcnt lgkmcnt(1)
    buffer_store_dwordx4 v[68:71], v5, s[16:19], s58 offen offset:1024 sc1
    s_waitcnt lgkmcnt(0)
    buffer_store_dwordx2 v[72:73], v6, s[16:19], s58 offen offset:2048 sc1
    s_mov_b32 s59, 0
Lw_1:
    ds_read_b32 v4, v3 offset:8
    s_add_u32 s59, s59, 1
    s_cmp_gt_u32 s59, 0x400000
    s_cbranch_scc1 L_end
    s_waitcnt lgkmcnt(0)
    v_readfirstlane_b32 s58, v4
    s_nop 0
    s_cmp_lt_u32 s58, 1
    s_cbranch_scc1 Lw_1
    v_mov_b32 v5, s2
    s_waitcnt vmcnt(0)
    s_mov_b64 exec, 1
    global_store_byte v5, v8, s[54:55] sc1
    s_mov_b64 exec, -1
    s_setprio 0
L_wload:
    v_and_b32 v4, 15, v0
    v_lshlrev_b32 v4, 2, v4
    v_and_b32 v5, 48, v0
    v_lshl_add_u32 v4, v5, 8, v4
    s_lshl_b32 s58, s4, 7
    buffer_load_dword v128, v4, s[12:15], s58 offen offset:0
    buffer_load_dword v129, v4, s[12:15], s58 offen offset:512
    buffer_load_dword v130, v4, s[12:15], s58 offen offset:1024
    buffer_load_dword v131, v4, s[12:15], s58 offen offset:1536
    buffer_load_dword v132, v4, s[12:15], s58 offen offset:2048
    buffer_load_dword v133, v4, s[12:15], s58 offen offset:2560
    buffer_load_dword v134, v4, s[12:15], s58 offen offset:3072
    buffer_load_dword v135, v4, s[12:15], s58 offen offset:3584
    buffer_load_dword v136, v4, s[12:15], s58 offen offset:64
    buffer_load_dword v137, v4, s[12:15], s58 offen offset:576
    buffer_load_dword v138, v4, s[12:15], s58 offen offset:1088
    buffer_load_dword v139, v4, s[12:15], s58 offen offset:1600
    buffer_load_dword v140, v4, s[12:15], s58 offen offset:2112
    buffer_load_dword v141, v4, s[12:15], s58 offen offset:2624
    buffer_load_dword v142, v4, s[12:15], s58 offen offset:3136
    buffer_load_dword v143, v4, s[12:15], s58 offen offset:3648
    s_waitcnt vmcnt(46)
    s_add_u32 s58, s58, 16384
    buffer_load_dword v144, v4, s[12:15], s58 offen offset:0
    buffer_load_dword v145, v4, s[12:15], s58 offen offset:512
    buffer_load_dword v146, v4, s[12:15], s58 offen offset:1024
    buffer_load_dword v147, v4, s[12:15], s58 offen offset:1536
    buffer_load_dword v148, v4, s[12:15], s58 offen offset:2048
    buffer_load_dword v149, v4, s[12:15], s58 offen offset:2560
    buffer_load_dword v150, v4, s[12:15], s58 offen offset:3072
    buffer_load_dword v151, v4, s[12:15], s58 offen offset:3584
    buffer_load_dword v152, v4, s[12:15], s58 offen offset:64
    buffer_load_dword v153, v4, s[12:15], s58 offen offset:576
    buffer_load_dword v154, v4, s[12:15], s58 offen offset:1088
    buffer_load_dword v155, v4, s[12:15], s58 offen offset:1600
    buffer_load_dword v156, v4, s[12:15], s58 offen offset:2112
    buffer_load_dword v157, v4, s[12:15], s58 offen offset:2624
    buffer_load_dword v158, v4, s[12:15], s58 offen offset:3136
    buffer_load_dword v159, v4, s[12:15], s58 offen offset:3648
    s_waitcnt vmcnt(46)
    s_add_u32 s58, s58, 16384
    buffer_load_dword v160, v4, s[12:15], s58 offen offset:0
    buffer_load_dword v161, v4, s[12:15], s58 offen offset:512
    buffer_load_dword v162, v4, s[12:15], s58 offen offset:1024
    buffer_load_dword v163, v4, s[12:15], s58 offen offset:1536
    buffer_load_dword v164, v4, s[12:15], s58 offen offset:2048
    buffer_load_dword v165, v4, s[12:15], s58 offen offset:2560
    buffer_load_dword v166, v4, s[12:15], s58 offen offset:3072
    buffer_load_dword v167, v4, s[12:15], s58 offen offset:3584
    buffer_load_dword v168, v4, s[12:15], s58 offen offset:64
    buffer_load_dword v169, v4, s[12:15], s58 offen offset:576
    buffer_load_dword v170, v4, s[12:15], s58 offen offset:1088
    buffer_load_dword v171, v4, s[12:15], s58 offen offset:1600
    buffer_load_dword v172, v4, s[12:15], s58 offen offset:2112
    buffer_load_dword v173, v4, s[12:15], s58 offen offset:2624
    buffer_load_dword v174, v4, s[12:15], s58 offen offset:3136
    buffer_load_dword v175, v4, s[12:15], s58 offen offset:3648
    s_waitcnt vmcnt(40)
    v_perm_b32 v120, v129, v128, s70
    v_perm_b32 v124, v129, v128, s71
    v_perm_b32 v121, v131, v130, s70
    v_perm_b32 v125, v131, v130, s71
    v_perm_b32 v122, v133, v132, s70
    v_perm_b32 v126, v133, v132, s71
    v_perm_b32 v123, v135, v134, s70
    v_perm_b32 v127, v135, v134, s71
    s_add_u32 s58, s58, 16384
    buffer_load_dword v176, v4, s[12:15], s58 offen offset:0
    buffer_load_dword v177, v4, s[12:15], s58 offen offset:512
    buffer_load_dword v178, v4, s[12:15], s58 offen offset:1024
    buffer_load_dword v179, v4, s[12:15], s58 offen offset:1536
    buffer_load_dword v180, v4, s[12:15], s58 offen offset:2048
    buffer_load_dword v181, v4, s[12:15], s58 offen offset:2560
    buffer_load_dword v182, v4, s[12:15], s58 offen offset:3072
    buffer_load_dword v183, v4, s[12:15], s58 offen offset:3584
    s_waitcnt vmcnt(40)
    v_perm_b32 v128, v137, v136, s70
    v_perm_b32 v132, v137, v136, s71
    v_perm_b32 v129, v139, v138, s70
    v_perm_b32 v133, v139, v138, s71
    v_perm_b32 v130, v141, v140, s70
    v_perm_b32 v134, v141, v140, s71
    v_perm_b32 v131, v143, v142, s70
    v_perm_b32 v135, v143, v142, s71
    buffer_load_dword v184, v4, s[12:15], s58 offen offset:64
    buffer_load_dword v185, v4, s[12:15], s58 offen offset:576
    buffer_load_dword v186, v4, s[12:15], s58 offen offset:1088
    buffer_load_dword v187, v4, s[12:15], s58 offen offset:1600
    buffer_load_dword v188, v4, s[12:15], s58 offen offset:2112
    buffer_load_dword v189, v4, s[12:15], s58 offen offset:2624
    buffer_load_dword v190, v4, s[12:15], s58 offen offset:3136
    buffer_load_dword v191, v4, s[12:15], s58 offen offset:3648
    s_waitcnt vmcnt(40)
    v_perm_b32 v136, v145, v144, s70
    v_perm_b32 v140, v145, v144, s71
    v_perm_b32 v137, v147, v146, s70
    v_perm_b32 v141, v147, v146, s71
    v_perm_b32 v138, v149, v148, s70
    v_perm_b32 v142, v149, v148, s71
    v_perm_b32 v139, v151, v150, s70
    v_perm_b32 v143, v151, v150, s71
    s_add_u32 s58, s58, 16384
    buffer_load_dword v192, v4, s[12:15], s58 offen offset:0
    buffer_load_dword v193, v4, s[12:15], s58 offen offset:512
    buffer_load_dword v194, v4, s[12:15], s58 offen offset:1024
    buffer_load_dword v195, v4, s[12:15], s58 offen offset:1536
    buffer_load_dword v196, v4, s[12:15], s58 offen offset:2048
    buffer_load_dword v197, v4, s[12:15], s58 offen offset:2560
    buffer_load_dword v198, v4, s[12:15], s58 offen offset:3072
    buffer_load_dword v199, v4, s[12:15], s58 offen offset:3584
    s_waitcnt vmcnt(40)
    v_perm_b32 v144, v153, v152, s70
    v_perm_b32 v148, v153, v152, s71
    v_perm_b32 v145, v155, v154, s70
    v_perm_b32 v149, v155, v154, s71
    v_perm_b32 v146, v157, v156, s70
    v_perm_b32 v150, v157, v156, s71
    v_perm_b32 v147, v159, v158, s70
    v_perm_b32 v151, v159, v158, s71
    buffer_load_dword v200, v4, s[12:15], s58 offen offset:64
    buffer_load_dword v201, v4, s[12:15], s58 offen offset:576
    buffer_load_dword v202, v4, s[12:15], s58 offen offset:1088
    buffer_load_dword v203, v4, s[12:15], s58 offen offset:1600
    buffer_load_dword v204, v4, s[12:15], s58 offen offset:2112
    buffer_load_dword v205, v4, s[12:15], s58 offen offset:2624
    buffer_load_dword v206, v4, s[12:15], s58 offen offset:3136
    buffer_load_dword v207, v4, s[12:15], s58 offen offset:3648
    s_waitcnt vmcnt(40)
    v_perm_b32 v152, v161, v160, s70
    v_perm_b32 v156, v161, v160, s71
    v_perm_b32 v153, v163, v162, s70
    v_perm_b32 v157, v163, v162, s71
    v_perm_b32 v154, v165, v164, s70
    v_perm_b32 v158, v165, v164, s71
    v_perm_b32 v155, v167, v166, s70
    v_perm_b32 v159, v167, v166, s71
    s_add_u32 s58, s58, 16384
    buffer_load_dword v208, v4, s[12:15], s58 offen offset:0
    buffer_load_dword v209, v4, s[12:15], s58 offen offset:512
    buffer_load_dword v210, v4, s[12:15], s58 offen offset:1024
    buffer_load_dword v211, v4, s[12:15], s58 offen offset:1536
    buffer_load_dword v212, v4, s[12:15], s58 offen offset:2048
    buffer_load_dword v213, v4, s[12:15], s58 offen offset:2560
    buffer_load_dword v214, v4, s[12:15], s58 offen offset:3072
    buffer_load_dword v215, v4, s[12:15], s58 offen offset:3584
    s_waitcnt vmcnt(40)
    v_perm_b32 v160, v169, v168, s70
    v_perm_b32 v164, v169, v168, s71
    v_perm_b32 v161, v171, v170, s70
    v_perm_b32 v165, v171, v170, s71
    v_perm_b32 v162, v173, v172, s70
    v_perm_b32 v166, v173, v172, s71
    v_perm_b32 v163, v175, v174, s70
    v_perm_b32 v167, v175, v174, s71
    buffer_load_dword v216, v4, s[12:15], s58 offen offset:64
    buffer_load_dword v217, v4, s[12:15], s58 offen offset:576
    buffer_load_dword v218, v4, s[12:15], s58 offen offset:1088
    buffer_load_dword v219, v4, s[12:15], s58 offen offset:1600
    buffer_load_dword v220, v4, s[12:15], s58 offen offset:2112
    buffer_load_dword v221, v4, s[12:15], s58 offen offset:2624
    buffer_load_dword v222, v4, s[12:15], s58 offen offset:3136
    buffer_load_dword v223, v4, s[12:15], s58 offen offset:3648
    s_waitcnt vmcnt(40)
    v_perm_b32 v168, v177, v176, s70
    v_perm_b32 v172, v177, v176, s71
    v_perm_b32 v169, v179, v178, s70
    v_perm_b32 v173, v179, v178, s71
    v_perm_b32 v170, v181, v180, s70
    v_perm_b32 v174, v181, v180, s71
    v_perm_b32 v171, v183, v182, s70
    v_perm_b32 v175, v183, v182, s71
    s_add_u32 s58, s58, 16384
    buffer_load_dword v224, v4, s[12:15], s58 offen offset:0
    buffer_load_dword v225, v4, s[12:15], s58 offen offset:512
    buffer_load_dword v226, v4, s[12:15], s58 offen offset:1024
    buffer_load_dword v227, v4, s[12:15], s58 offen offset:1536
    buffer_load_dword v228, v4, s[12:15], s58 offen offset:2048
    buffer_load_dword v229, v4, s[12:15], s58 offen offset:2560
    buffer_load_dword v230, v4, s[12:15], s58 offen offset:3072
    buffer_load_dword v231, v4, s[12:15], s58 offen offset:3584
    s_waitcnt vmcnt(40)
    v_perm_b32 v176, v185, v184, s70
    v_perm_b32 v180, v185, v184, s71
    v_perm_b32 v177, v187, v186, s70
    v_perm_b32 v181, v187, v186, s71
    v_perm_b32 v178, v189, v188, s70
    v_perm_b32 v182, v189, v188, s71
    v_perm_b32 v179, v191, v190, s70
    v_perm_b32 v183, v191, v190, s71
    buffer_load_dword v232, v4, s[12:15], s58 offen offset:64
    buffer_load_dword v233, v4, s[12:15], s58 offen offset:576
    buffer_load_dword v234, v4, s[12:15], s58 offen offset:1088
    buffer_load_dword v235, v4, s[12:15], s58 offen offset:1600
    buffer_load_dword v236, v4, s[12:15], s58 offen offset:2112
    buffer_load_dword v237, v4, s[12:15], s58 offen offset:2624
    buffer_load_dword v238, v4, s[12:15], s58 offen offset:3136
    buffer_load_dword v239, v4, s[12:15], s58 offen offset:3648
    s_waitcnt vmcnt(40)
    v_perm_b32 v184, v193, v192, s70
    v_perm_b32 v188, v193, v192, s71
    v_perm_b32 v185, v195, v194, s70
    v_perm_b32 v189, v195, v194, s71
    v_perm_b32 v186, v197, v196, s70
    v_perm_b32 v190, v197, v196, s71
    v_perm_b32 v187, v199, v198, s70
    v_perm_b32 v191, v199, v198, s71
    s_add_u32 s58, s58, 16384
    buffer_load_dword v240, v4, s[12:15], s58 offen offset:0
    buffer_load_dword v241, v4, s[12:15], s58 offen offset:512
    buffer_load_dword v242, v4, s[12:15], s58 offen offset:1024
    buffer_load_dword v243, v4, s[12:15], s58 offen offset:1536
    buffer_load_dword v244, v4, s[12:15], s58 offen offset:2048
    buffer_load_dword v245, v4, s[12:15], s58 offen offset:2560
    buffer_load_dword v246, v4, s[12:15], s58 offen offset:3072
    buffer_load_dword v247, v4, s[12:15], s58 offen offset:3584
    s_waitcnt vmcnt(40)
    v_perm_b32 v192, v201, v200, s70
    v_perm_b32 v196, v201, v200, s71
    v_perm_b32 v193, v203, v202, s70
    v_perm_b32 v197, v203, v202, s71
    v_perm_b32 v194, v205, v204, s70
    v_perm_b32 v198, v205, v204, s71
    v_perm_b32 v195, v207, v206, s70
    v_perm_b32 v199, v207, v206, s71
    buffer_load_dword v248, v4, s[12:15], s58 offen offset:64
    buffer_load_dword v249, v4, s[12:15], s58 offen offset:576
    buffer_load_dword v250, v4, s[12:15], s58 offen offset:1088
    buffer_load_dword v251, v4, s[12:15], s58 offen offset:1600
    buffer_load_dword v252, v4, s[12:15], s58 offen offset:2112
    buffer_load_dword v253, v4, s[12:15], s58 offen offset:2624
    buffer_load_dword v254, v4, s[12:15], s58 offen offset:3136
    buffer_load_dword v255, v4, s[12:15], s58 offen offset:3648
    s_waitcnt vmcnt(40)
    v_perm_b32 v200, v209, v208, s70
    v_perm_b32 v204, v209, v208, s71
    v_perm_b32 v201, v211, v210, s70
    v_perm_b32 v205, v211, v210, s71
    v_perm_b32 v202, v213, v212, s70
    v_perm_b32 v206, v213, v212, s71
    v_perm_b32 v203, v215, v214, s70
    v_perm_b32 v207, v215, v214, s71
    s_waitcnt vmcnt(32)
    v_perm_b32 v208, v217, v216, s70
    v_perm_b32 v212, v217, v216, s71
    v_perm_b32 v209, v219, v218, s70
    v_perm_b32 v213, v219, v218, s71
    v_perm_b32 v210, v221, v220, s70
    v_perm_b32 v214, v221, v220, s71
    v_perm_b32 v211, v223, v222, s70
    v_perm_b32 v215, v223, v222, s71
    s_waitcnt vmcnt(24)
    v_perm_b32 v216, v225, v224, s70
    v_perm_b32 v220, v225, v224, s71
    v_perm_b32 v217, v227, v226, s70
    v_perm_b32 v221, v227, v226, s71
    v_perm_b32 v218, v229, v228, s70
    v_perm_b32 v222, v229, v228, s71
    v_perm_b32 v219, v231, v230, s70
    v_perm_b32 v223, v231, v230, s71
    s_waitcnt vmcnt(16)
    v_perm_b32 v224, v233, v232, s70
    v_perm_b32 v228, v233, v232, s71
    v_perm_b32 v225, v235, v234, s70
    v_perm_b32 v229, v235, v234, s71
    v_perm_b32 v226, v237, v236, s70
    v_perm_b32 v230, v237, v236, s71
    v_perm_b32 v227, v239, v238, s70
    v_perm_b32 v231, v239, v238, s71
    s_waitcnt vmcnt(8)
    v_perm_b32 v232, v241, v240, s70
    v_perm_b32 v236, v241, v240, s71
    v_perm_b32 v233, v243, v242, s70
    v_perm_b32 v237, v243, v242, s71
    v_perm_b32 v234, v245, v244, s70
    v_perm_b32 v238, v245, v244, s71
    v_perm_b32 v235, v247, v246, s70
    v_perm_b32 v239, v247, v246, s71
    s_waitcnt vmcnt(0)
    v_perm_b32 v240, v249, v248, s70
    v_perm_b32 v244, v249, v248, s71
    v_perm_b32 v241, v251, v250, s70
    v_perm_b32 v245, v251, v250, s71
    v_perm_b32 v242, v253, v252, s70
    v_perm_b32 v246, v253, v252, s71
    v_perm_b32 v243, v255, v254, s70
    v_perm_b32 v247, v255, v254, s71
    s_lshr_b32 s58, s3, 2
    s_lshl_b32 s58, s58, 2
    s_mov_b64 exec, 1
    v_add_u32 v5, s58, v3
    v_mov_b32 v4, 1
    ds_add_u32 v5, v4
    s_mov_b64 exec, -1
    v_lshlrev_b32 v5, 2, v0
    v_mov_b32 v6, 0x01010101
    v_mov_b32 v7, 0x0101
    v_cmp_eq_u32 vcc, 62, v0
    s_mov_b32 s59, 0
    s_nop 0
    v_cndmask_b32 v6, v6, v7, vcc
    v_cmp_gt_u32 vcc, 63, v0
    s_nop 1
    v_cndmask_b32 v6, 0, v6, vcc
L_poll:
    global_load_dword v4, v5, s[54:55] sc1
    s_add_u32 s59, s59, 1
    s_cmp_gt_u32 s59, 0x40000
    s_cbranch_scc1 L_end
    s_waitcnt vmcnt(0)
    v_cmp_ne_u32 vcc, v4, v6
    s_cbranch_vccz L_polled
    s_sleep 2
    s_branch L_poll
L_polled:
    s_cmp_ge_u32 s3, 4
    s_cbranch_scc1 L_postB
    v_lshlrev_b32 v10, 4, v0
    s_lshl_b32 s60, s3, 15
    s_add_u32 s60, s60, 1048576
    buffer_load_dwordx4 v[16:19], v10, s[16:19], s60 offen offset:0 sc1
    buffer_load_dwordx4 v[20:23], v10, s[16:19], s60 offen offset:1024 sc1
    buffer_load_dwordx4 v[24:27], v10, s[16:19], s60 offen offset:2048 sc1
    buffer_load_dwordx4 v[28:31], v10, s[16:19], s60 offen offset:3072 sc1
    s_add_u32 s60, s60, 4096
    buffer_load_dwordx4 v[32:35], v10, s[16:19], s60 offen offset:0 sc1
    buffer_load_dwordx4 v[36:39], v10, s[16:19], s60 offen offset:1024 sc1
    buffer_load_dwordx4 v[40:43], v10, s[16:19], s60 offen offset:2048 sc1
    buffer_load_dwordx4 v[44:47], v10, s[16:19], s60 offen offset:3072 sc1
    s_add_u32 s60, s60, 4096
    buffer_load_dwordx4 v[48:51], v10, s[16:19], s60 offen offset:0 sc1
    buffer_load_dwordx4 v[52:55], v10, s[16:19], s60 offen offset:1024 sc1
    buffer_load_dwordx4 v[56:59], v10, s[16:19], s60 offen offset:2048 sc1
    buffer_load_dwordx4 v[60:63], v10, s[16:19], s60 offen offset:3072 sc1
    s_add_u32 s60, s60, 4096
    buffer_load_dwordx4 v[64:67], v10, s[16:19], s60 offen offset:0 sc1
    buffer_load_dwordx4 v[68:71], v10, s[16:19], s60 offen offset:1024 sc1
    buffer_load_dwordx4 v[72:75], v10, s[16:19], s60 offen offset:2048 sc1
    buffer_load_dwordx4 v[76:79], v10, s[16:19], s60 offen offset:3072 sc1
    v_add_u32 v8, 84480, v1
    s_lshl_b32 s61, s3, 7
    s_add_u32 s61, s61, 105600
    v_add_u32 v9, s61, v1
    s_mov_b32 s59, 0
Lw_2:
    ds_read_b32 v4, v3 offset:0
    s_add_u32 s59, s59, 1
    s_cmp_gt_u32 s59, 0x400000
    s_cbranch_scc1 L_end
    s_waitcnt lgkmcnt(0)
    v_readfirstlane_b32 s58, v4
    s_nop 0
    s_cmp_lt_u32 s58, 4
    s_cbranch_scc1 Lw_2
    ds_read_b128 v[80:83], v8 offset:0
    ds_read_b128 v[84:87], v8 offset:8448
    ds_read_b128 v[88:91], v8 offset:16896
    ds_read_b128 v[92:95], v8 offset:64
    ds_read_b128 v[96:99], v8 offset:8512
    ds_read_b128 v[100:103], v8 offset:16960
    s_waitcnt vmcnt(14) lgkmcnt(3)
    v_mfma_f32_16x16x32_bf16 v[104:107], v[16:19], v[80:83], 0
    v_mfma_f32_16x16x32_bf16 v[108:111], v[20:23], v[80:83], 0
    v_mfma_f32_16x16x32_bf16 v[112:115], v[16:19], v[84:87], 0
    v_mfma_f32_16x16x32_bf16 v[116:119], v[20:23], v[84:87], 0
    v_mfma_f32_16x16x32_bf16 v[248:251], v[16:19], v[88:91], 0
    v_mfma_f32_16x16x32_bf16 v[252:255], v[20:23], v[88:91], 0
    s_add_u32 s60, s60, 4096
    buffer_load_dwordx4 v[16:19], v10, s[16:19], s60 offen offset:0 sc1
    buffer_load_dwordx4 v[20:23], v10, s[16:19], s60 offen offset:1024 sc1
    ds_read_b128 v[80:83], v8 offset:128
    ds_read_b128 v[84:87], v8 offset:8576
    ds_read_b128 v[88:91], v8 offset:17024
    s_waitcnt vmcnt(14) lgkmcnt(3)
    v_mfma_f32_16x16x32_bf16 v[104:107], v[24:27], v[92:95], v[104:107]
    v_mfma_f32_16x16x32_bf16 v[108:111], v[28:31], v[92:95], v[108:111]
    v_mfma_f32_16x16x32_bf16 v[112:115], v[24:27], v[96:99], v[112:115]
    v_mfma_f32_16x16x32_bf16 v[116:119], v[28:31], v[96:99], v[116:119]
    v_mfma_f32_16x16x32_bf16 v[248:251], v[24:27], v[100:103], v[248:251]
    v_mfma_f32_16x16x32_bf16 v[252:255], v[28:31], v[100:103], v[252:255]
    buffer_load_dwordx4 v[24:27], v10, s[16:19], s60 offen offset:2048 sc1
    buffer_load_dwordx4 v[28:31], v10, s[16:19], s60 offen offset:3072 sc1
    ds_read_b128 v[92:95], v8 offset:192
    ds_read_b128 v[96:99], v8 offset:8640
    ds_read_b128 v[100:103], v8 offset:17088
    s_waitcnt vmcnt(14) lgkmcnt(3)
    v_mfma_f32_16x16x32_bf16 v[104:107], v[32:35], v[80:83], v[104:107]
    v_mfma_f32_16x16x32_bf16 v[108:111], v[36:39], v[80:83], v[108:111]
    v_mfma_f32_16x16x32_bf16 v[112:115], v[32:35], v[84:87], v[112:115]
    v_mfma_f32_16x16x32_bf16 v[116:119], v[36:39], v[84:87], v[116:119]
    v_mfma_f32_16x16x32_bf16 v[248:251], v[32:35], v[88:91], v[248:251]
    v_mfma_f32_16x16x32_bf16 v[252:255], v[36:39], v[88:91], v[252:255]
    s_add_u32 s60, s60, 4096
    buffer_load_dwordx4 v[32:35], v10, s[16:19], s60 offen offset:0 sc1
    buffer_load_dwordx4 v[36:39], v10, s[16:19], s60 offen offset:1024 sc1
    ds_read_b128 v[80:83], v8 offset:256
    ds_read_b128 v[84:87], v8 offset:8704
    ds_read_b128 v[88:91], v8 offset:17152
    s_waitcnt vmcnt(14) lgkmcnt(3)
    v_mfma_f32_16x16x32_bf16 v[104:107], v[40:43], v[92:95], v[104:107]
    v_mfma_f32_16x16x32_bf16 v[108:111], v[44:47], v[92:95], v[108:111]
    v_mfma_f32_16x16x32_bf16 v[112:115], v[40:43], v[96:99], v[112:115]
    v_mfma_f32_16x16x32_bf16 v[116:119], v[44:47], v[96:99], v[116:119]
    v_mfma_f32_16x16x32_bf16 v[248:251], v[40:43], v[100:103], v[248:251]
    v_mfma_f32_16x16x32_bf16 v[252:255], v[44:47], v[100:103], v[252:255]
    buffer_load_dwordx4 v[40:43], v10, s[16:19], s60 offen offset:2048 sc1
    buffer_load_dwordx4 v[44:47], v10, s[16:19], s60 offen offset:3072 sc1
    ds_read_b128 v[92:95], v8 offset:320
    ds_read_b128 v[96:99], v8 offset:8768
    ds_read_b128 v[100:103], v8 offset:17216
    s_waitcnt vmcnt(14) lgkmcnt(3)
    v_mfma_f32_16x16x32_bf16 v[104:107], v[48:51], v[80:83], v[104:107]
    v_mfma_f32_16x16x32_bf16 v[108:111], v[52:55], v[80:83], v[108:111]
    v_mfma_f32_16x16x32_bf16 v[112:115], v[48:51], v[84:87], v[112:115]
    v_mfma_f32_16x16x32_bf16 v[116:119], v[52:55], v[84:87], v[116:119]
    v_mfma_f32_16x16x32_bf16 v[248:251], v[48:51], v[88:91], v[248:251]
    v_mfma_f32_16x16x32_bf16 v[252:255], v[52:55], v[88:91], v[252:255]
    s_add_u32 s60, s60, 4096
    buffer_load_dwordx4 v[48:51], v10, s[16:19], s60 offen offset:0 sc1
    buffer_load_dwordx4 v[52:55], v10, s[16:19], s60 offen offset:1024 sc1
    ds_read_b128 v[80:83], v8 offset:384
    ds_read_b128 v[84:87], v8 offset:8832
    ds_read_b128 v[88:91], v8 offset:17280
    s_waitcnt vmcnt(14) lgkmcnt(3)
    v_mfma_f32_16x16x32_bf16 v[104:107], v[56:59], v[92:95], v[104:107]
    v_mfma_f32_16x16x32_bf16 v[108:111], v[60:63], v[92:95], v[108:111]
    v_mfma_f32_16x16x32_bf16 v[112:115], v[56:59], v[96:99], v[112:115]
    v_mfma_f32_16x16x32_bf16 v[116:119], v[60:63], v[96:99], v[116:119]
    v_mfma_f32_16x16x32_bf16 v[248:251], v[56:59], v[100:103], v[248:251]
    v_mfma_f32_16x16x32_bf16 v[252:255], v[60:63], v[100:103], v[252:255]
    buffer_load_dwordx4 v[56:59], v10, s[16:19], s60 offen offset:2048 sc1
    buffer_load_dwordx4 v[60:63], v10, s[16:19], s60 offen offset:3072 sc1
    ds_read_b128 v[92:95], v8 offset:448
    ds_read_b128 v[96:99], v8 offset:8896
    ds_read_b128 v[100:103], v8 offset:17344
    s_waitcnt vmcnt(14) lgkmcnt(3)
    v_mfma_f32_16x16x32_bf16 v[104:107], v[64:67], v[80:83], v[104:107]
    v_mfma_f32_16x16x32_bf16 v[108:111], v[68:71], v[80:83], v[108:111]
    v_mfma_f32_16x16x32_bf16 v[112:115], v[64:67], v[84:87], v[112:115]
    v_mfma_f32_16x16x32_bf16 v[116:119], v[68:71], v[84:87], v[116:119]
    v_mfma_f32_16x16x32_bf16 v[248:251], v[64:67], v[88:91], v[248:251]
    v_mfma_f32_16x16x32_bf16 v[252:255], v[68:71], v[88:91], v[252:255]
    s_add_u32 s60, s60, 4096
    buffer_load_dwordx4 v[64:67], v10, s[16:19], s60 offen offset:0 sc1
    buffer_load_dwordx4 v[68:71], v10, s[16:19], s60 offen offset:1024 sc1
    ds_read_b128 v[80:83], v8 offset:0
    ds_read_b128 v[84:87], v8 offset:8448
    ds_read_b128 v[88:91], v8 offset:16896
    s_waitcnt vmcnt(14) lgkmcnt(3)
    v_mfma_f32_16x16x32_bf16 v[104:107], v[72:75], v[92:95], v[104:107]
    v_mfma_f32_16x16x32_bf16 v[108:111], v[76:79], v[92:95], v[108:111]
    v_mfma_f32_16x16x32_bf16 v[112:115], v[72:75], v[96:99], v[112:115]
    v_mfma_f32_16x16x32_bf16 v[116:119], v[76:79], v[96:99], v[116:119]
    v_mfma_f32_16x16x32_bf16 v[248:251], v[72:75], v[100:103], v[248:251]
    v_mfma_f32_16x16x32_bf16 v[252:255], v[76:79], v[100:103], v[252:255]
    buffer_load_dwordx4 v[72:75], v10, s[16:19], s60 offen offset:2048 sc1
    buffer_load_dwordx4 v[76:79], v10, s[16:19], s60 offen offset:3072 sc1
    s_nop 3
    v_cvt_pk_bf16_f32 v12, v104, v105
    v_cvt_pk_bf16_f32 v13, v106, v107
    v_cvt_pk_bf16_f32 v14, v108, v109
    v_cvt_pk_bf16_f32 v15, v110, v111
    ds_write_b128 v9, v[12:15] offset:0
    v_cvt_pk_bf16_f32 v12, v112, v113
    v_cvt_pk_bf16_f32 v13, v114, v115
    v_cvt_pk_bf16_f32 v14, v116, v117
    v_cvt_pk_bf16_f32 v15, v118, v119
    ds_write_b128 v9, v[12:15] offset:8448
    v_cvt_pk_bf16_f32 v12, v248, v249
    v_cvt_pk_bf16_f32 v13, v250, v251
    v_cvt_pk_bf16_f32 v14, v252, v253
    v_cvt_pk_bf16_f32 v15, v254, v255
    ds_write_b128 v9, v[12:15] offset:16896
    ds_read_b128 v[92:95], v8 offset:64
    ds_read_b128 v[96:99], v8 offset:8512
    ds_read_b128 v[100:103], v8 offset:16960
    s_waitcnt vmcnt(14) lgkmcnt(3)
    v_mfma_f32_16x16x32_bf16 v[104:107], v[16:19], v[80:83], 0
    v_mfma_f32_16x16x32_bf16 v[108:111], v[20:23], v[80:83], 0
    v_mfma_f32_16x16x32_bf16 v[112:115], v[16:19], v[84:87], 0
    v_mfma_f32_16x16x32_bf16 v[116:119], v[20:23], v[84:87], 0
    v_mfma_f32_16x16x32_bf16 v[248:251], v[16:19], v[88:91], 0
    v_mfma_f32_16x16x32_bf16 v[252:255], v[20:23], v[88:91], 0
    ds_read_b128 v[80:83], v8 offset:128
    ds_read_b128 v[84:87], v8 offset:8576
    ds_read_b128 v[88:91], v8 offset:17024
    s_waitcnt vmcnt(12) lgkmcnt(3)
    v_mfma_f32_16x16x32_bf16 v[104:107], v[24:27], v[92:95], v[104:107]
    v_mfma_f32_16x16x32_bf16 v[108:111], v[28:31], v[92:95], v[108:111]
    v_mfma_f32_16x16x32_bf16 v[112:115], v[24:27], v[96:99], v[112:115]
    v_mfma_f32_16x16x32_bf16 v[116:119], v[28:31], v[96:99], v[116:119]
    v_mfma_f32_16x16x32_bf16 v[248:251], v[24:27], v[100:103], v[248:251]
    v_mfma_f32_16x16x32_bf16 v[252:255], v[28:31], v[100:103], v[252:255]
    ds_read_b128 v[92:95], v8 offset:192
    ds_read_b128 v[96:99], v8 offset:8640
    ds_read_b128 v[100:103], v8 offset:17088
    s_waitcnt vmcnt(10) lgkmcnt(3)
    v_mfma_f32_16x16x32_bf16 v[104:107], v[32:35], v[80:83], v[104:107]
    v_mfma_f32_16x16x32_bf16 v[108:111], v[36:39], v[80:83], v[108:111]
    v_mfma_f32_16x16x32_bf16 v[112:115], v[32:35], v[84:87], v[112:115]
    v_mfma_f32_16x16x32_bf16 v[116:119], v[36:39], v[84:87], v[116:119]
    v_mfma_f32_16x16x32_bf16 v[248:251], v[32:35], v[88:91], v[248:251]
    v_mfma_f32_16x16x32_bf16 v[252:255], v[36:39], v[88:91], v[252:255]
    ds_read_b128 v[80:83], v8 offset:256
    ds_read_b128 v[84:87], v8 offset:8704
    ds_read_b128 v[88:91], v8 offset:17152
    s_waitcnt vmcnt(8) lgkmcnt(3)
    v_mfma_f32_16x16x32_bf16 v[104:107], v[40:43], v[92:95], v[104:107]
    v_mfma_f32_16x16x32_bf16 v[108:111], v[44:47], v[92:95], v[108:111]
    v_mfma_f32_16x16x32_bf16 v[112:115], v[40:43], v[96:99], v[112:115]
    v_mfma_f32_16x16x32_bf16 v[116:119], v[44:47], v[96:99], v[116:119]
    v_mfma_f32_16x16x32_bf16 v[248:251], v[40:43], v[100:103], v[248:251]
    v_mfma_f32_16x16x32_bf16 v[252:255], v[44:47], v[100:103], v[252:255]
    ds_read_b128 v[92:95], v8 offset:320
    ds_read_b128 v[96:99], v8 offset:8768
    ds_read_b128 v[100:103], v8 offset:17216
    s_waitcnt vmcnt(6) lgkmcnt(3)
    v_mfma_f32_16x16x32_bf16 v[104:107], v[48:51], v[80:83], v[104:107]
    v_mfma_f32_16x16x32_bf16 v[108:111], v[52:55], v[80:83], v[108:111]
    v_mfma_f32_16x16x32_bf16 v[112:115], v[48:51], v[84:87], v[112:115]
    v_mfma_f32_16x16x32_bf16 v[116:119], v[52:55], v[84:87], v[116:119]
    v_mfma_f32_16x16x32_bf16 v[248:251], v[48:51], v[88:91], v[248:251]
    v_mfma_f32_16x16x32_bf16 v[252:255], v[52:55], v[88:91], v[252:255]
    ds_read_b128 v[80:83], v8 offset:384
    ds_read_b128 v[84:87], v8 offset:8832
    ds_read_b128 v[88:91], v8 offset:17280
    s_waitcnt vmcnt(4) lgkmcnt(3)
    v_mfma_f32_16x16x32_bf16 v[104:107], v[56:59], v[92:95], v[104:107]
    v_mfma_f32_16x16x32_bf16 v[108:111], v[60:63], v[92:95], v[108:111]
    v_mfma_f32_16x16x32_bf16 v[112:115], v[56:59], v[96:99], v[112:115]
    v_mfma_f32_16x16x32_bf16 v[116:119], v[60:63], v[96:99], v[116:119]
    v_mfma_f32_16x16x32_bf16 v[248:251], v[56:59], v[100:103], v[248:251]
    v_mfma_f32_16x16x32_bf16 v[252:255], v[60:63], v[100:103], v[252:255]
    ds_read_b128 v[92:95], v8 offset:448
    ds_read_b128 v[96:99], v8 offset:8896
    ds_read_b128 v[100:103], v8 offset:17344
    s_waitcnt vmcnt(2) lgkmcnt(3)
    v_mfma_f32_16x16x32_bf16 v[104:107], v[64:67], v[80:83], v[104:107]
    v_mfma_f32_16x16x32_bf16 v[108:111], v[68:71], v[80:83], v[108:111]
    v_mfma_f32_16x16x32_bf16 v[112:115], v[64:67], v[84:87], v[112:115]
    v_mfma_f32_16x16x32_bf16 v[116:119], v[68:71], v[84:87], v[116:119]
    v_mfma_f32_16x16x32_bf16 v[248:251], v[64:67], v[88:91], v[248:251]
    v_mfma_f32_16x16x32_bf16 v[252:255], v[68:71], v[88:91], v[252:255]
    s_waitcnt vmcnt(0) lgkmcnt(0)
    v_mfma_f32_16x16x32_bf16 v[104:107], v[72:75], v[92:95], v[104:107]
    v_mfma_f32_16x16x32_bf16 v[108:111], v[76:79], v[92:95], v[108:111]
    v_mfma_f32_16x16x32_bf16 v[112:115], v[72:75], v[96:99], v[112:115]
    v_mfma_f32_16x16x32_bf16 v[116:119], v[76:79], v[96:99], v[116:119]
    v_mfma_f32_16x16x32_bf16 v[248:251], v[72:75], v[100:103], v[248:251]
    v_mfma_f32_16x16x32_bf16 v[252:255], v[76:79], v[100:103], v[252:255]
    s_nop 3
    v_cvt_pk_bf16_f32 v12, v104, v105
    v_cvt_pk_bf16_f32 v13, v106, v107
    v_cvt_pk_bf16_f32 v14, v108, v109
    v_cvt_pk_bf16_f32 v15, v110, v111
    ds_write_b128 v9, v[12:15] offset:64
    v_cvt_pk_bf16_f32 v12, v112, v113
    v_cvt_pk_bf16_f32 v13, v114, v115
    v_cvt_pk_bf16_f32 v14, v116, v117
    v_cvt_pk_bf16_f32 v15, v118, v119
    ds_write_b128 v9, v[12:15] offset:8512
    v_cvt_pk_bf16_f32 v12, v248, v249
    v_cvt_pk_bf16_f32 v13, v250, v251
    v_cvt_pk_bf16_f32 v14, v252, v253
    v_cvt_pk_bf16_f32 v15, v254, v255
    ds_write_b128 v9, v[12:15] offset:16960
    s_mov_b64 exec, 1
    v_mov_b32 v4, 1
    ds_add_u32 v3, v4 offset:20
    s_mov_b64 exec, -1
    v_and_b32 v4, 3, v0
    v_mov_b32 v5, 0x0c0c0c0c
    v_mov_b32 v6, 0x0c0c0302
    v_mov_b32 v7, 0x03020c0c
    v_cmp_eq_u32 s[58:59], 0, v4
    v_cmp_eq_u32 s[60:61], 2, v4
    v_cmp_eq_u32 vcc, 1, v4
    v_cndmask_b32 v10, v5, v6, s[58:59]
    v_cndmask_b32 v11, v5, v6, s[60:61]
    v_cndmask_b32 v10, v10, v7, vcc
    v_cmp_eq_u32 vcc, 3, v4
    s_nop 1
    v_cndmask_b32 v11, v11, v7, vcc
    v_and_b32 v8, 0xfdfdfdfd, v10
    v_and_b32 v9, 0xfdfdfdfd, v11
    s_mov_b32 s63, s3
    s_mov_b32 s59, 0
Lw_3:
    ds_read_b32 v4, v3 offset:20
    s_add_u32 s59, s59, 1
    s_cmp_gt_u32 s59, 0x400000
    s_cbranch_scc1 L_end
    s_waitcnt lgkmcnt(0)
    v_readfirstlane_b32 s58, v4
    s_nop 0
    s_cmp_lt_u32 s58, 4
    s_cbranch_scc1 Lw_3
L_grp:
    s_mul_i32 s58, s63, 8448
    s_lshr_b32 s59, s63, 2
    s_mul_i32 s59, s59, 8448
    s_and_b32 s60, s63, 1
    s_bfe_u32 s61, s63, 0x10001
    s_cmp_ge_u32 s63, 8
    s_cselect_b32 s61, s60, s61
    s_cselect_b32 s60, 0, s60
    s_mul_i32 s60, s60, 4224
    s_lshl_b32 s61, s61, 9
    s_add_u32 s59, s59, s60
    s_add_u32 s59, s59, s61
    s_add_u32 s59, s59, 105600
    v_add_u32 v12, s58, v1
    v_bfe_u32 v4, v0, 2, 2
    v_mul_u32_u24 v4, 1056, v4
    v_and_b32 v5, 48, v0
    v_add3_u32 v13, v4, v5, s59
    v_lshl_add_u32 v14, v0, 3, s58
    v_lshl_add_u32 v15, v0, 3, s59
    ds_read_b128 v[16:19], v12 offset:0
    ds_read_b128 v[48:51], v13 offset:0
    ds_read_b128 v[20:23], v12 offset:64
    ds_read_b128 v[52:55], v13 offset:64
    ds_read_b128 v[24:27], v12 offset:128
    ds_read_b128 v[56:59], v13 offset:128
    ds_read_b128 v[28:31], v12 offset:192
    ds_read_b128 v[60:63], v13 offset:192
    s_waitcnt lgkmcnt(7)
    ds_read_b128 v[32:35], v12 offset:256
    ds_read_b128 v[64:67], v13 offset:256
    ds_read_b128 v[36:39], v12 offset:320
    ds_read_b128 v[68:71], v13 offset:320
    ds_read_b128 v[40:43], v12 offset:384
    ds_read_b128 v[72:75], v13 offset:384
    ds_read_b128 v[44:47], v12 offset:448
    ds_read_b128 v[76:79], v13 offset:448
    s_waitcnt lgkmcnt(14)
    v_mfma_f32_16x16x32_bf16 v[104:107], v[16:19], v[48:51], 0
    s_waitcnt lgkmcnt(12)
    v_mfma_f32_16x16x32_bf16 v[104:107], v[20:23], v[52:55], v[104:107]
    s_waitcnt lgkmcnt(10)
    v_mfma_f32_16x16x32_bf16 v[104:107], v[24:27], v[56:59], v[104:107]
    s_waitcnt lgkmcnt(8)
    v_mfma_f32_16x16x32_bf16 v[104:107], v[28:31], v[60:63], v[104:107]
    s_waitcnt lgkmcnt(6)
    v_mfma_f32_16x16x32_bf16 v[104:107], v[32:35], v[64:67], v[104:107]
    s_waitcnt lgkmcnt(4)
    v_mfma_f32_16x16x32_bf16 v[104:107], v[36:39], v[68:71], v[104:107]
    s_waitcnt lgkmcnt(2)
    v_mfma_f32_16x16x32_bf16 v[104:107], v[40:43], v[72:75], v[104:107]
    s_waitcnt lgkmcnt(0)
    v_mfma_f32_16x16x32_bf16 v[104:107], v[44:47], v[76:79], v[104:107]
    ds_read_b64 v[16:17], v14 offset:0
    ds_read_b64 v[18:19], v14 offset:4224
    ds_read_b64 v[20:21], v14 offset:512
    ds_read_b64 v[22:23], v14 offset:4736
    ds_read_b64 v[24:25], v14 offset:1056
    ds_read_b64 v[26:27], v14 offset:5280
    ds_read_b64 v[28:29], v14 offset:1568
    ds_read_b64 v[30:31], v14 offset:5792
    ds_read_b64 v[32:33], v14 offset:2112
    ds_read_b64 v[34:35], v14 offset:6336
    ds_read_b64 v[36:37], v14 offset:2624
    ds_read_b64 v[38:39], v14 offset:6848
    ds_read_b64 v[40:41], v14 offset:3168
    ds_read_b64 v[42:43], v14 offset:7392
    ds_read_b64 v[44:45], v14 offset:3680
    s_waitcnt lgkmcnt(14)
    ds_read_b64 v[46:47], v14 offset:7904
    v_mul_f32 v104, 0x3db8aa3b, v104
    v_mul_f32 v105, 0x3db8aa3b, v105
    v_mul_f32 v106, 0x3db8aa3b, v106
    v_mul_f32 v107, 0x3db8aa3b, v107
    v_exp_f32 v104, v104
    v_exp_f32 v105, v105
    v_exp_f32 v106, v106
    v_exp_f32 v107, v107
    v_add_f32 v108, v104, v105
    v_add_f32 v109, v106, v107
    v_add_f32 v108, v108, v109
    v_add_f32 v108, 0x3089705f, v108
    v_rcp_f32 v108, v108
    s_nop 0
    v_mul_f32 v104, v104, v108
    v_mul_f32 v105, v105, v108
    v_mul_f32 v106, v106, v108
    v_mul_f32 v107, v107, v108
    v_cvt_pk_bf16_f32 v104, v104, v105
    v_cvt_pk_bf16_f32 v106, v106, v107
    v_perm_b32 v80, v104, v104, v8
    v_perm_b32 v81, v104, v104, v9
    v_perm_b32 v82, v104, v104, v10
    v_perm_b32 v83, v104, v104, v11
    v_perm_b32 v84, v106, v106, v8
    v_perm_b32 v85, v106, v106, v9
    v_perm_b32 v86, v106, v106, v10
    v_perm_b32 v87, v106, v106, v11
    s_waitcnt lgkmcnt(0)
    v_mfma_f32_4x4x4_16b_bf16 v[88:91], v[80:81], v[16:17], 0 cbsz:4 abid:0
    v_mfma_f32_4x4x4_16b_bf16 v[92:95], v[80:81], v[18:19], 0 cbsz:4 abid:5
    v_mfma_f32_4x4x4_16b_bf16 v[96:99], v[80:81], v[20:21], 0 cbsz:4 abid:10
    v_mfma_f32_4x4x4_16b_bf16 v[100:103], v[80:81], v[22:23], 0 cbsz:4 abid:15
    v_mfma_f32_4x4x4_16b_bf16 v[88:91], v[82:83], v[24:25], v[88:91] cbsz:4 abid:0
    v_mfma_f32_4x4x4_16b_bf16 v[92:95], v[82:83], v[26:27], v[92:95] cbsz:4 abid:5
    v_mfma_f32_4x4x4_16b_bf16 v[96:99], v[82:83], v[28:29], v[96:99] cbsz:4 abid:10
    v_mfma_f32_4x4x4_16b_bf16 v[100:103], v[82:83], v[30:31], v[100:103] cbsz:4 abid:15
    v_mfma_f32_4x4x4_16b_bf16 v[88:91], v[84:85], v[32:33], v[88:91] cbsz:4 abid:0
    v_mfma_f32_4x4x4_16b_bf16 v[92:95], v[84:85], v[34:35], v[92:95] cbsz:4 abid:5
    v_mfma_f32_4x4x4_16b_bf16 v[96:99], v[84:85], v[36:37], v[96:99] cbsz:4 abid:10
    v_mfma_f32_4x4x4_16b_bf16 v[100:103], v[84:85], v[38:39], v[100:103] cbsz:4 abid:15
    v_mfma_f32_4x4x4_16b_bf16 v[88:91], v[86:87], v[40:41], v[88:91] cbsz:4 abid:0
    v_mfma_f32_4x4x4_16b_bf16 v[92:95], v[86:87], v[42:43], v[92:95] cbsz:4 abid:5
    v_mfma_f32_4x4x4_16b_bf16 v[96:99], v[86:87], v[44:45], v[96:99] cbsz:4 abid:10
    v_mfma_f32_4x4x4_16b_bf16 v[100:103], v[86:87], v[46:47], v[100:103] cbsz:4 abid:15
    s_add_u32 s63, s63, 4
    s_nop 1
    v_cvt_pk_bf16_f32 v80, v88, v89
    v_cvt_pk_bf16_f32 v81, v90, v91
    ds_write_b64 v15, v[80:81] offset:0
    v_cvt_pk_bf16_f32 v82, v92, v93
    v_cvt_pk_bf16_f32 v83, v94, v95
    ds_write_b64 v15, v[82:83] offset:1056
    v_cvt_pk_bf16_f32 v84, v96, v97
    v_cvt_pk_bf16_f32 v85, v98, v99
    ds_write_b64 v15, v[84:85] offset:2112
    v_cvt_pk_bf16_f32 v86, v100, v101
    v_cvt_pk_bf16_f32 v87, v102, v103
    ds_write_b64 v15, v[86:87] offset:3168
    s_cmp_lt_u32 s63, 10
    s_cbranch_scc1 L_grp
    s_mov_b64 exec, 1
    v_mov_b32 v4, 1
    ds_add_u32 v3, v4 offset:24
    s_mov_b64 exec, -1
    v_add_u32 v8, 105600, v1
    s_mul_i32 s60, s4, 12288
    v_lshl_add_u32 v9, v0, 4, s60
    s_mov_b32 s63, 0
    s_mov_b32 s59, 0
Lw_4:
    ds_read_b32 v4, v3 offset:24
    s_add_u32 s59, s59, 1
    s_cmp_gt_u32 s59, 0x400000
    s_cbranch_scc1 L_end
    s_waitcnt lgkmcnt(0)
    v_readfirstlane_b32 s58, v4
    s_nop 0
    s_cmp_lt_u32 s58, 4
    s_cbranch_scc1 Lw_4
L_wvt:
    ds_read_b128 v[16:19], v8 offset:0
    ds_read_b128 v[20:23], v8 offset:64
    ds_read_b128 v[24:27], v8 offset:128
    ds_read_b128 v[28:31], v8 offset:192
    ds_read_b128 v[32:35], v8 offset:256
    ds_read_b128 v[36:39], v8 offset:320
    ds_read_b128 v[40:43], v8 offset:384
    ds_read_b128 v[44:47], v8 offset:448
    s_waitcnt lgkmcnt(7)
    v_mfma_f32_16x16x32_bf16 v[48:51], v[16:19], v[120:123], 0
    v_mfma_f32_16x16x32_bf16 v[52:55], v[16:19], v[124:127], 0
    v_mfma_f32_16x16x32_bf16 v[56:59], v[16:19], v[128:131], 0
    v_mfma_f32_16x16x32_bf16 v[60:63], v[16:19], v[132:135], 0
    s_waitcnt lgkmcnt(6)
    v_mfma_f32_16x16x32_bf16 v[48:51], v[20:23], v[136:139], v[48:51]
    v_mfma_f32_16x16x32_bf16 v[52:55], v[20:23], v[140:143], v[52:55]
    v_mfma_f32_16x16x32_bf16 v[56:59], v[20:23], v[144:147], v[56:59]
    v_mfma_f32_16x16x32_bf16 v[60:63], v[20:23], v[148:151], v[60:63]
    s_waitcnt lgkmcnt(5)
    v_mfma_f32_16x16x32_bf16 v[48:51], v[24:27], v[152:155], v[48:51]
    v_mfma_f32_16x16x32_bf16 v[52:55], v[24:27], v[156:159], v[52:55]
    v_mfma_f32_16x16x32_bf16 v[56:59], v[24:27], v[160:163], v[56:59]
    v_mfma_f32_16x16x32_bf16 v[60:63], v[24:27], v[164:167], v[60:63]
    s_waitcnt lgkmcnt(4)
    v_mfma_f32_16x16x32_bf16 v[48:51], v[28:31], v[168:171], v[48:51]
    v_mfma_f32_16x16x32_bf16 v[52:55], v[28:31], v[172:175], v[52:55]
    v_mfma_f32_16x16x32_bf16 v[56:59], v[28:31], v[176:179], v[56:59]
    v_mfma_f32_16x16x32_bf16 v[60:63], v[28:31], v[180:183], v[60:63]
    s_waitcnt lgkmcnt(3)
    v_mfma_f32_16x16x32_bf16 v[48:51], v[32:35], v[184:187], v[48:51]
    v_mfma_f32_16x16x32_bf16 v[52:55], v[32:35], v[188:191], v[52:55]
    v_mfma_f32_16x16x32_bf16 v[56:59], v[32:35], v[192:195], v[56:59]
    v_mfma_f32_16x16x32_bf16 v[60:63], v[32:35], v[196:199], v[60:63]
    s_waitcnt lgkmcnt(2)
    v_mfma_f32_16x16x32_bf16 v[48:51], v[36:39], v[200:203], v[48:51]
    v_mfma_f32_16x16x32_bf16 v[52:55], v[36:39], v[204:207], v[52:55]
    v_mfma_f32_16x16x32_bf16 v[56:59], v[36:39], v[208:211], v[56:59]
    v_mfma_f32_16x16x32_bf16 v[60:63], v[36:39], v[212:215], v[60:63]
    s_waitcnt lgkmcnt(1)
    v_mfma_f32_16x16x32_bf16 v[48:51], v[40:43], v[216:219], v[48:51]
    v_mfma_f32_16x16x32_bf16 v[52:55], v[40:43], v[220:223], v[52:55]
    v_mfma_f32_16x16x32_bf16 v[56:59], v[40:43], v[224:227], v[56:59]
    v_mfma_f32_16x16x32_bf16 v[60:63], v[40:43], v[228:231], v[60:63]
    s_waitcnt lgkmcnt(0)
    v_mfma_f32_16x16x32_bf16 v[48:51], v[44:47], v[232:235], v[48:51]
    v_mfma_f32_16x16x32_bf16 v[52:55], v[44:47], v[236:239], v[52:55]
    v_mfma_f32_16x16x32_bf16 v[56:59], v[44:47], v[240:243], v[56:59]
    v_mfma_f32_16x16x32_bf16 v[60:63], v[44:47], v[244:247], v[60:63]
    v_add_u32 v8, 8448, v8
    s_add_u32 s63, s63, 1
    s_nop 2
    ds_write_b128 v9, v[48:51] offset:0
    ds_write_b128 v9, v[52:55] offset:1024
    ds_write_b128 v9, v[56:59] offset:2048
    ds_write_b128 v9, v[60:63] offset:3072
    v_add_u32 v9, 4096, v9
    s_cmp_lt_u32 s63, 3
    s_cbranch_scc1 L_wvt
    s_waitcnt lgkmcnt(0)
    s_barrier
    s_branch L_end
L_postB:
    s_setprio 1
    s_mov_b32 s24, s56
    s_mov_b32 s25, s57
    s_mov_b32 s26, 256000
    s_mov_b32 s27, 0x20000
    s_lshl_b32 s58, s4, 6
    v_add_u32 v5, s58, v0
    v_lshlrev_b32 v6, 10, v5
    s_lshl_b32 s58, s6, 2
    buffer_load_dword v64, v6, s[24:27], s58 offen sc1
    v_mul_u32_u24 v65, 2560, v5
    s_mov_b32 s20, s52
    s_mov_b32 s21, s53
    s_mov_b32 s22, 5120000
    s_mov_b32 s23, 0x20000
    v_and_b32 v4, 3, v0
    v_mov_b32 v5, 0x0c0c0c0c
    v_mov_b32 v6, 0x0c0c0302
    v_mov_b32 v7, 0x03020c0c
    v_cmp_eq_u32 s[58:59], 0, v4
    v_cmp_eq_u32 s[60:61], 2, v4
    v_cmp_eq_u32 vcc, 1, v4
    v_cndmask_b32 v10, v5, v6, s[58:59]
    v_cndmask_b32 v11, v5, v6, s[60:61]
    v_cndmask_b32 v10, v10, v7, vcc
    v_cmp_eq_u32 vcc, 3, v4
    s_nop 1
    v_cndmask_b32 v11, v11, v7, vcc
    v_lshrrev_b32 v5, 4, v0
    v_and_b32 v6, 15, v0
    v_mad_u32_u24 v66, v5, 10, v6
    v_lshrrev_b32 v5, 4, v66
    v_mul_u32_u24 v9, 8448, v5
    v_cmp_le_u32 vcc, 32, v66
    v_and_b32 v5, 7, v66
    v_and_b32 v6, 3, v66
    v_cndmask_b32 v5, v5, v6, vcc
    v_mul_u32_u24 v5, 1056, v5
    v_bfe_u32 v6, v66, 3, 1
    v_bfe_u32 v7, v66, 2, 1
    v_cndmask_b32 v6, v6, v7, vcc
    v_lshl_add_u32 v5, v6, 9, v5
    v_mov_b32 v69, 130944
    v_add3_u32 v9, v9, v5, v69
    v_lshrrev_b32 v5, 5, v0
    v_lshl_add_u32 v15, v5, 3, v2
    v_mov_b32 v68, 4
    s_lshl_b32 s58, s5, 2
    s_sub_u32 s58, 156160, s58
    v_mov_b32 v70, s58
    s_mov_b32 s59, 0
Lw_5:
    ds_read_b32 v4, v3 offset:4
    s_add_u32 s59, s59, 1
    s_cmp_gt_u32 s59, 0x400000
    s_cbranch_scc1 L_end
    s_waitcnt lgkmcnt(0)
    v_readfirstlane_b32 s58, v4
    s_nop 0
    s_cmp_lt_u32 s58, 4
    s_cbranch_scc1 Lw_5
    v_add_u32 v5, s5, v66
    v_lshl_add_u32 v5, v5, 1, v69
    ds_read_u16 v8, v5
    s_mov_b32 s58, 262144
    s_waitcnt vmcnt(0)
    v_mad_u32_u16 v65, v64, 4, v65
    v_lshrrev_b32 v64, 16, v64
    v_cmpx_lt_u32 vcc, 0, v64
    s_cbranch_execz L_entld
    buffer_load_dwordx4 v[16:19], v65, s[16:19], s58 offen offset:0 sc1
    v_cmpx_lt_u32 vcc, 4, v64
    s_cbranch_execz L_entld
    buffer_load_dwordx4 v[20:23], v65, s[16:19], s58 offen offset:16 sc1
    v_cmpx_lt_u32 vcc, 8, v64
    s_cbranch_execz L_entld
    buffer_load_dwordx4 v[24:27], v65, s[16:19], s58 offen offset:32 sc1
    v_cmpx_lt_u32 vcc, 12, v64
    s_cbranch_execz L_entld
    buffer_load_dwordx4 v[28:31], v65, s[16:19], s58 offen offset:48 sc1
    v_cmpx_lt_u32 vcc, 16, v64
    s_cbranch_execz L_entld
    ds_write_b32 v3, v68 offset:28
L_entld:
    s_mov_b64 exec, -1
    s_waitcnt vmcnt(0)
    v_cmpx_lt_u32 vcc, 0, v64
    s_cbranch_execz L_l1
    v_mad_u32_u16 v32, v16, 4, v70 op_sel:[1,0,0,0]
    v_mad_u32_u16 v5, v16, 2, v69
    ds_add_rtn_u32 v48, v32, v68
    ds_read_u16 v72, v5
    v_cmpx_lt_u32 vcc, 1, v64
    s_cbranch_execz L_l1
    v_mad_u32_u16 v33, v17, 4, v70 op_sel:[1,0,0,0]
    v_mad_u32_u16 v5, v17, 2, v69
    ds_add_rtn_u32 v49, v33, v68
    ds_read_u16 v73, v5
    v_cmpx_lt_u32 vcc, 2, v64
    s_cbranch_execz L_l1
    v_mad_u32_u16 v34, v18, 4, v70 op_sel:[1,0,0,0]
    v_mad_u32_u16 v5, v18, 2, v69
    ds_add_rtn_u32 v50, v34, v68
    ds_read_u16 v74, v5
    v_cmpx_lt_u32 vcc, 3, v64
    s_cbranch_execz L_l1
    v_mad_u32_u16 v35, v19, 4, v70 op_sel:[1,0,0,0]
    v_mad_u32_u16 v5, v19, 2, v69
    ds_add_rtn_u32 v51, v35, v68
    ds_read_u16 v75, v5
    s_waitcnt lgkmcnt(4)
    v_cmpx_lt_u32 vcc, 4, v64
    s_cbranch_execz L_l1
    v_mad_u32_u16 v36, v20, 4, v70 op_sel:[1,0,0,0]
    v_mad_u32_u16 v5, v20, 2, v69
    ds_add_rtn_u32 v52, v36, v68
    ds_read_u16 v76, v5
    v_cmpx_lt_u32 vcc, 5, v64
    s_cbranch_execz L_l1
    v_mad_u32_u16 v37, v21, 4, v70 op_sel:[1,0,0,0]
    v_mad_u32_u16 v5, v21, 2, v69
    ds_add_rtn_u32 v53, v37, v68
    ds_read_u16 v77, v5
    v_cmpx_lt_u32 vcc, 6, v64
    s_cbranch_execz L_l1
    v_mad_u32_u16 v38, v22, 4, v70 op_sel:[1,0,0,0]
    v_mad_u32_u16 v5, v22, 2, v69
    ds_add_rtn_u32 v54, v38, v68
    ds_read_u16 v78, v5
    v_cmpx_lt_u32 vcc, 7, v64
    s_cbranch_execz L_l1
    v_mad_u32_u16 v39, v23, 4, v70 op_sel:[1,0,0,0]
    v_mad_u32_u16 v5, v23, 2, v69
    ds_add_rtn_u32 v55, v39, v68
    ds_read_u16 v79, v5
    s_waitcnt lgkmcnt(4)
    v_cmpx_lt_u32 vcc, 8, v64
    s_cbranch_execz L_l1
    v_mad_u32_u16 v40, v24, 4, v70 op_sel:[1,0,0,0]
    v_mad_u32_u16 v5, v24, 2, v69
    ds_add_rtn_u32 v56, v40, v68
    ds_read_u16 v80, v5
    v_cmpx_lt_u32 vcc, 9, v64
    s_cbranch_execz L_l1
    v_mad_u32_u16 v41, v25, 4, v70 op_sel:[1,0,0,0]
    v_mad_u32_u16 v5, v25, 2, v69
    ds_add_rtn_u32 v57, v41, v68
    ds_read_u16 v81, v5
    v_cmpx_lt_u32 vcc, 10, v64
    s_cbranch_execz L_l1
    v_mad_u32_u16 v42, v26, 4, v70 op_sel:[1,0,0,0]
    v_mad_u32_u16 v5, v26, 2, v69
    ds_add_rtn_u32 v58, v42, v68
    ds_read_u16 v82, v5
    v_cmpx_lt_u32 vcc, 11, v64
    s_cbranch_execz L_l1
    v_mad_u32_u16 v43, v27, 4, v70 op_sel:[1,0,0,0]
    v_mad_u32_u16 v5, v27, 2, v69
    ds_add_rtn_u32 v59, v43, v68
    ds_read_u16 v83, v5
    s_waitcnt lgkmcnt(4)
    v_cmpx_lt_u32 vcc, 12, v64
    s_cbranch_execz L_l1
    v_mad_u32_u16 v44, v28, 4, v70 op_sel:[1,0,0,0]
    v_mad_u32_u16 v5, v28, 2, v69
    ds_add_rtn_u32 v60, v44, v68
    ds_read_u16 v84, v5
    v_cmpx_lt_u32 vcc, 13, v64
    s_cbranch_execz L_l1
    v_mad_u32_u16 v45, v29, 4, v70 op_sel:[1,0,0,0]
    v_mad_u32_u16 v5, v29, 2, v69
    ds_add_rtn_u32 v61, v45, v68
    ds_read_u16 v85, v5
    v_cmpx_lt_u32 vcc, 14, v64
    s_cbranch_execz L_l1
    v_mad_u32_u16 v46, v30, 4, v70 op_sel:[1,0,0,0]
    v_mad_u32_u16 v5, v30, 2, v69
    ds_add_rtn_u32 v62, v46, v68
    ds_read_u16 v86, v5
    v_cmpx_lt_u32 vcc, 15, v64
    s_cbranch_execz L_l1
    v_mad_u32_u16 v47, v31, 4, v70 op_sel:[1,0,0,0]
    v_mad_u32_u16 v5, v31, 2, v69
    ds_add_rtn_u32 v63, v47, v68
    ds_read_u16 v87, v5
L_l1:
    s_mov_b64 exec, -1
    s_mov_b64 exec, 1
    v_mov_b32 v4, 1
    ds_add_u32 v3, v4 offset:12
    s_mov_b64 exec, -1
    v_lshlrev_b32 v66, 2, v66
    v_add_u32 v66, 156160, v66
    v_lshrrev_b32 v6, 4, v0
    v_mul_u32_u24 v6, 1024, v6
    v_add_u32 v6, 153088, v6
    v_and_b32 v7, 15, v0
    s_mov_b32 s59, 0
Lw_6:
    ds_read_b32 v4, v3 offset:12
    s_add_u32 s59, s59, 1
    s_cmp_gt_u32 s59, 0x400000
    s_cbranch_scc1 L_end
    s_waitcnt lgkmcnt(0)
    v_readfirstlane_b32 s58, v4
    s_nop 0
    s_cmp_lt_u32 s58, 4
    s_cbranch_scc1 Lw_6
    ds_read_b32 v12, v66
    ds_read_b32 v5, v3 offset:28
    v_cmp_gt_u32 s[60:61], 10, v7
    v_lshlrev_b32 v8, 16, v8
    s_waitcnt lgkmcnt(1)
    v_add_u32 v12, 4, v12
    v_lshrrev_b32 v12, 3, v12
    v_max_u32 v12, 1, v12
    v_cndmask_b32 v12, 0, v12, s[60:61]
    v_mov_b32 v67, v12
    s_nop 1
    v_add_u32_dpp v67, v67, v67 row_shl:1 row_mask:0xf bank_mask:0xf bound_ctrl:1
    s_nop 1
    v_add_u32_dpp v67, v67, v67 row_shl:2 row_mask:0xf bank_mask:0xf bound_ctrl:1
    s_nop 1
    v_add_u32_dpp v67, v67, v67 row_shl:4 row_mask:0xf bank_mask:0xf bound_ctrl:1
    s_nop 1
    v_add_u32_dpp v67, v67, v67 row_shl:8 row_mask:0xf bank_mask:0xf bound_ctrl:1
    s_waitcnt lgkmcnt(0)
    v_lshl_add_u32 v5, v5, 10, v67
    v_lshlrev_b32 v7, 3, v67
    v_cmp_le_u32 vcc, 128, v5
    v_sub_u32 v6, v6, v7
    v_subrev_u32 v12, 1, v12
    s_lshl_b32 s63, s4, 4
    s_cbranch_vccnz L_slow
    s_mov_b64 exec, s[60:61]
    ds_write_b32 v66, v6 offset:256
    s_mov_b64 exec, -1
    v_cmpx_lt_u32 vcc, 0, v64
    s_cbranch_execz L_l2
    ds_read_b32 v32, v32 offset:256
    v_cmpx_lt_u32 vcc, 1, v64
    s_cbranch_execz L_l2
    ds_read_b32 v33, v33 offset:256
    v_cmpx_lt_u32 vcc, 2, v64
    s_cbranch_execz L_l2
    ds_read_b32 v34, v34 offset:256
    v_cmpx_lt_u32 vcc, 3, v64
    s_cbranch_execz L_l2
    ds_read_b32 v35, v35 offset:256
    v_cmpx_lt_u32 vcc, 4, v64
    s_cbranch_execz L_l2
    ds_read_b32 v36, v36 offset:256
    v_cmpx_lt_u32 vcc, 5, v64
    s_cbranch_execz L_l2
    ds_read_b32 v37, v37 offset:256
    v_cmpx_lt_u32 vcc, 6, v64
    s_cbranch_execz L_l2
    ds_read_b32 v38, v38 offset:256
    v_cmpx_lt_u32 vcc, 7, v64
    s_cbranch_execz L_l2
    ds_read_b32 v39, v39 offset:256
    v_cmpx_lt_u32 vcc, 8, v64
    s_cbranch_execz L_l2
    ds_read_b32 v40, v40 offset:256
    v_cmpx_lt_u32 vcc, 9, v64
    s_cbranch_execz L_l2
    ds_read_b32 v41, v41 offset:256
    v_cmpx_lt_u32 vcc, 10, v64
    s_cbranch_execz L_l2
    ds_read_b32 v42, v42 offset:256
    v_cmpx_lt_u32 vcc, 11, v64
    s_cbranch_execz L_l2
    ds_read_b32 v43, v43 offset:256
    v_cmpx_lt_u32 vcc, 12, v64
    s_cbranch_execz L_l2
    ds_read_b32 v44, v44 offset:256
    s_waitcnt lgkmcnt(8)
    v_cmpx_lt_u32 vcc, 13, v64
    s_cbranch_execz L_l2
    ds_read_b32 v45, v45 offset:256
    v_cmpx_lt_u32 vcc, 14, v64
    s_cbranch_execz L_l2
    ds_read_b32 v46, v46 offset:256
    v_cmpx_lt_u32 vcc, 15, v64
    s_cbranch_execz L_l2
    ds_read_b32 v47, v47 offset:256
L_l2:
    s_mov_b64 exec, -1
    s_nop 3
    v_readlane_b32 s67, v67, s63
    s_waitcnt lgkmcnt(0)
    v_cmpx_lt_u32 vcc, 0, v64
    s_cbranch_execz L_l3
    v_add_u32 v32, v32, v48
    v_perm_b32 v16, v72, v16, s70
    ds_write_b32 v32, v16
    v_cmpx_lt_u32 vcc, 1, v64
    s_cbranch_execz L_l3
    v_add_u32 v33, v33, v49
    v_perm_b32 v17, v73, v17, s70
    ds_write_b32 v33, v17
    v_cmpx_lt_u32 vcc, 2, v64
    s_cbranch_execz L_l3
    v_add_u32 v34, v34, v50
    v_perm_b32 v18, v74, v18, s70
    ds_write_b32 v34, v18
    v_cmpx_lt_u32 vcc, 3, v64
    s_cbranch_execz L_l3
    v_add_u32 v35, v35, v51
    v_perm_b32 v19, v75, v19, s70
    ds_write_b32 v35, v19
    v_cmpx_lt_u32 vcc, 4, v64
    s_cbranch_execz L_l3
    v_add_u32 v36, v36, v52
    v_perm_b32 v20, v76, v20, s70
    ds_write_b32 v36, v20
    v_cmpx_lt_u32 vcc, 5, v64
    s_cbranch_execz L_l3
    v_add_u32 v37, v37, v53
    v_perm_b32 v21, v77, v21, s70
    ds_write_b32 v37, v21
    v_cmpx_lt_u32 vcc, 6, v64
    s_cbranch_execz L_l3
    v_add_u32 v38, v38, v54
    v_perm_b32 v22, v78, v22, s70
    ds_write_b32 v38, v22
    v_cmpx_lt_u32 vcc, 7, v64
    s_cbranch_execz L_l3
    v_add_u32 v39, v39, v55
    v_perm_b32 v23, v79, v23, s70
    ds_write_b32 v39, v23
    v_cmpx_lt_u32 vcc, 8, v64
    s_cbranch_execz L_l3
    v_add_u32 v40, v40, v56
    v_perm_b32 v24, v80, v24, s70
    ds_write_b32 v40, v24
    v_cmpx_lt_u32 vcc, 9, v64
    s_cbranch_execz L_l3
    v_add_u32 v41, v41, v57
    v_perm_b32 v25, v81, v25, s70
    ds_write_b32 v41, v25
    v_cmpx_lt_u32 vcc, 10, v64
    s_cbranch_execz L_l3
    v_add_u32 v42, v42, v58
    v_perm_b32 v26, v82, v26, s70
    ds_write_b32 v42, v26
    v_cmpx_lt_u32 vcc, 11, v64
    s_cbranch_execz L_l3
    v_add_u32 v43, v43, v59
    v_perm_b32 v27, v83, v27, s70
    ds_write_b32 v43, v27
    v_cmpx_lt_u32 vcc, 12, v64
    s_cbranch_execz L_l3
    v_add_u32 v44, v44, v60
    v_perm_b32 v28, v84, v28, s70
    ds_write_b32 v44, v28
    s_waitcnt lgkmcnt(8)
    v_cmpx_lt_u32 vcc, 13, v64
    s_cbranch_execz L_l3
    v_add_u32 v45, v45, v61
    v_perm_b32 v29, v85, v29, s70
    ds_write_b32 v45, v29
    v_cmpx_lt_u32 vcc, 14, v64
    s_cbranch_execz L_l3
    v_add_u32 v46, v46, v62
    v_perm_b32 v30, v86, v30, s70
    ds_write_b32 v46, v30
    v_cmpx_lt_u32 vcc, 15, v64
    s_cbranch_execz L_l3
    v_add_u32 v47, v47, v63
    v_perm_b32 v31, v87, v31, s70
    ds_write_b32 v47, v31
L_l3:
    s_mov_b64 exec, -1
    s_mov_b64 exec, 1
    v_mov_b32 v4, 1
    ds_add_u32 v3, v4 offset:16
    s_mov_b64 exec, -1
    s_lshr_b32 s66, s67, 4
    s_add_u32 s60, s66, 1
    s_mul_i32 s60, s60, 16
    s_sub_u32 s67, s60, s67
    s_sub_u32 s62, s67, 1
    s_add_u32 s61, s4, 1
    s_mul_i32 s61, s61, 128
    s_sub_u32 s60, s61, s60
    s_lshl_b32 s60, s60, 3
    s_add_u32 s60, s60, 152064
    v_lshrrev_b32 v5, 5, v0
    v_lshl_add_u32 v13, v5, 2, s60
    v_bfe_u32 v5, v0, 2, 3
    v_lshl_add_u32 v14, v5, 3, v13
    s_mov_b32 s64, 160320
    s_mov_b32 s65, 0
    s_sub_u32 s63, s63, 1
    s_mov_b32 s59, 0
Lw_7:
    ds_read_b32 v4, v3 offset:16
    s_add_u32 s59, s59, 1
    s_cmp_gt_u32 s59, 0x400000
    s_cbranch_scc1 L_end
    s_waitcnt lgkmcnt(0)
    v_readfirstlane_b32 s58, v4
    s_nop 0
    s_cmp_lt_u32 s58, 4
    s_cbranch_scc1 Lw_7
    s_cmp_ge_u32 s67, 8
    s_cbranch_scc1 Lpg_8
    ds_read2_b32 v[80:81], v13 offset0:0 offset1:2
    ds_read2_b32 v[82:83], v13 offset0:4 offset1:6
    ds_read2_b32 v[84:85], v13 offset0:8 offset1:10
    ds_read2_b32 v[86:87], v13 offset0:12 offset1:14
    s_waitcnt lgkmcnt(0)
    s_cmp_gt_u32 s67, 0
    s_cbranch_scc1 Lps_9
    v_mad_u32_u16 v4, v80, s7, v2
    buffer_load_dwordx4 v[16:19], v4, s[8:11], 0 offen
Lps_9:
    s_cmp_gt_u32 s67, 1
    s_cbranch_scc1 Lps_10
    v_mad_u32_u16 v4, v81, s7, v2
    buffer_load_dwordx4 v[20:23], v4, s[8:11], 0 offen
Lps_10:
    s_cmp_gt_u32 s67, 2
    s_cbranch_scc1 Lps_11
    v_mad_u32_u16 v4, v82, s7, v2
    buffer_load_dwordx4 v[24:27], v4, s[8:11], 0 offen
Lps_11:
    s_cmp_gt_u32 s67, 3
    s_cbranch_scc1 Lps_12
    v_mad_u32_u16 v4, v83, s7, v2
    buffer_load_dwordx4 v[28:31], v4, s[8:11], 0 offen
Lps_12:
    s_cmp_gt_u32 s67, 4
    s_cbranch_scc1 Lps_13
    v_mad_u32_u16 v4, v84, s7, v2
    buffer_load_dwordx4 v[32:35], v4, s[8:11], 0 offen
Lps_13:
    s_cmp_gt_u32 s67, 5
    s_cbranch_scc1 Lps_14
    v_mad_u32_u16 v4, v85, s7, v2
    buffer_load_dwordx4 v[36:39], v4, s[8:11], 0 offen
Lps_14:
    s_cmp_gt_u32 s67, 6
    s_cbranch_scc1 Lps_15
    v_mad_u32_u16 v4, v86, s7, v2
    buffer_load_dwordx4 v[40:43], v4, s[8:11], 0 offen
Lps_15:
    v_mad_u32_u16 v4, v87, s7, v2
    buffer_load_dwordx4 v[44:47], v4, s[8:11], 0 offen
Lpg_8:
    s_cmp_ge_u32 s67, 16
    s_cbranch_scc1 Lpg_16
    ds_read2_b32 v[80:81], v13 offset0:16 offset1:18
    ds_read2_b32 v[82:83], v13 offset0:20 offset1:22
    ds_read2_b32 v[84:85], v13 offset0:24 offset1:26
    ds_read2_b32 v[86:87], v13 offset0:28 offset1:30
    s_waitcnt lgkmcnt(0)
    s_cmp_gt_u32 s67, 8
    s_cbranch_scc1 Lps_17
    v_mad_u32_u16 v4, v80, s7, v2
    buffer_load_dwordx4 v[48:51], v4, s[8:11], 0 offen
Lps_17:
    s_cmp_gt_u32 s67, 9
    s_cbranch_scc1 Lps_18
    v_mad_u32_u16 v4, v81, s7, v2
    buffer_load_dwordx4 v[52:55], v4, s[8:11], 0 offen
Lps_18:
    s_cmp_gt_u32 s67, 10
    s_cbranch_scc1 Lps_19
    v_mad_u32_u16 v4, v82, s7, v2
    buffer_load_dwordx4 v[56:59], v4, s[8:11], 0 offen
Lps_19:
    s_cmp_gt_u32 s67, 11
    s_cbranch_scc1 Lps_20
    v_mad_u32_u16 v4, v83, s7, v2
    buffer_load_dwordx4 v[60:63], v4, s[8:11], 0 offen
Lps_20:
    s_cmp_gt_u32 s67, 12
    s_cbranch_scc1 Lps_21
    v_mad_u32_u16 v4, v84, s7, v2
    buffer_load_dwordx4 v[64:67], v4, s[8:11], 0 offen
Lps_21:
    s_cmp_gt_u32 s67, 13
    s_cbranch_scc1 Lps_22
    v_mad_u32_u16 v4, v85, s7, v2
    buffer_load_dwordx4 v[68:71], v4, s[8:11], 0 offen
Lps_22:
    s_cmp_gt_u32 s67, 14
    s_cbranch_scc1 Lps_23
    v_mad_u32_u16 v4, v86, s7, v2
    buffer_load_dwordx4 v[72:75], v4, s[8:11], 0 offen
Lps_23:
    v_mad_u32_u16 v4, v87, s7, v2
    buffer_load_dwordx4 v[76:79], v4, s[8:11], 0 offen
Lpg_16:
    ds_read_b32 v5, v14
    ds_read2_b32 v[80:81], v13 offset0:32 offset1:34
    ds_read2_b32 v[82:83], v13 offset0:36 offset1:38
    ds_read2_b32 v[84:85], v13 offset0:40 offset1:42
    ds_read2_b32 v[86:87], v13 offset0:44 offset1:46
    s_cmp_eq_u32 s66, 0
    s_cbranch_scc1 L_drain
L_gl:
    s_waitcnt lgkmcnt(3)
    v_perm_b32 v6, v5, v5, v10
    v_perm_b32 v7, v5, v5, v11
    ds_read_b32 v5, v14 offset:64
    s_waitcnt vmcnt(15)
    v_mfma_f32_4x4x4_16b_bf16 v[248:251], v[6:7], v[16:17], v[248:251] cbsz:3 abid:0
    v_mfma_f32_4x4x4_16b_bf16 v[252:255], v[6:7], v[18:19], v[252:255] cbsz:3 abid:0
    s_sub_u32 s62, s62, 1
    s_cbranch_scc1 Lfs_0
Lbs_0:
    v_mad_u32_u16 v4, v80, s7, v2
    buffer_load_dwordx4 v[16:19], v4, s[8:11], 0 offen
    s_waitcnt vmcnt(15)
    v_mfma_f32_4x4x4_16b_bf16 v[248:251], v[6:7], v[20:21], v[248:251] cbsz:3 abid:1
    v_mfma_f32_4x4x4_16b_bf16 v[252:255], v[6:7], v[22:23], v[252:255] cbsz:3 abid:1
    s_sub_u32 s62, s62, 1
    s_cbranch_scc1 Lfs_1
Lbs_1:
    v_mad_u32_u16 v4, v81, s7, v2
    buffer_load_dwordx4 v[20:23], v4, s[8:11], 0 offen
    ds_read2_b32 v[80:81], v13 offset0:48 offset1:50
    s_waitcnt vmcnt(15) lgkmcnt(3)
    v_mfma_f32_4x4x4_16b_bf16 v[248:251], v[6:7], v[24:25], v[248:251] cbsz:3 abid:2
    v_mfma_f32_4x4x4_16b_bf16 v[252:255], v[6:7], v[26:27], v[252:255] cbsz:3 abid:2
    s_sub_u32 s62, s62, 1
    s_cbranch_scc1 Lfs_2
Lbs_2:
    v_mad_u32_u16 v4, v82, s7, v2
    buffer_load_dwordx4 v[24:27], v4, s[8:11], 0 offen
    s_waitcnt vmcnt(15)
    v_mfma_f32_4x4x4_16b_bf16 v[248:251], v[6:7], v[28:29], v[248:251] cbsz:3 abid:3
    v_mfma_f32_4x4x4_16b_bf16 v[252:255], v[6:7], v[30:31], v[252:255] cbsz:3 abid:3
    s_sub_u32 s62, s62, 1
    s_cbranch_scc1 Lfs_3
Lbs_3:
    v_mad_u32_u16 v4, v83, s7, v2
    buffer_load_dwordx4 v[28:31], v4, s[8:11], 0 offen
    ds_read2_b32 v[82:83], v13 offset0:52 offset1:54
    s_waitcnt vmcnt(15) lgkmcnt(3)
    v_mfma_f32_4x4x4_16b_bf16 v[248:251], v[6:7], v[32:33], v[248:251] cbsz:3 abid:4
    v_mfma_f32_4x4x4_16b_bf16 v[252:255], v[6:7], v[34:35], v[252:255] cbsz:3 abid:4
    s_sub_u32 s62, s62, 1
    s_cbranch_scc1 Lfs_4
Lbs_4:
    v_mad_u32_u16 v4, v84, s7, v2
    buffer_load_dwordx4 v[32:35], v4, s[8:11], 0 offen
    s_waitcnt vmcnt(15)
    v_mfma_f32_4x4x4_16b_bf16 v[248:251], v[6:7], v[36:37], v[248:251] cbsz:3 abid:5
    v_mfma_f32_4x4x4_16b_bf16 v[252:255], v[6:7], v[38:39], v[252:255] cbsz:3 abid:5
    s_sub_u32 s62, s62, 1
    s_cbranch_scc1 Lfs_5
Lbs_5:
    v_mad_u32_u16 v4, v85, s7, v2
    buffer_load_dwordx4 v[36:39], v4, s[8:11], 0 offen
    ds_read2_b32 v[84:85], v13 offset0:56 offset1:58
    s_waitcnt vmcnt(15) lgkmcnt(3)
    v_mfma_f32_4x4x4_16b_bf16 v[248:251], v[6:7], v[40:41], v[248:251] cbsz:3 abid:6
    v_mfma_f32_4x4x4_16b_bf16 v[252:255], v[6:7], v[42:43], v[252:255] cbsz:3 abid:6
    s_sub_u32 s62, s62, 1
    s_cbranch_scc1 Lfs_6
Lbs_6:
    v_mad_u32_u16 v4, v86, s7, v2
    buffer_load_dwordx4 v[40:43], v4, s[8:11], 0 offen
    s_waitcnt vmcnt(15)
    v_mfma_f32_4x4x4_16b_bf16 v[248:251], v[6:7], v[44:45], v[248:251] cbsz:3 abid:7
    v_mfma_f32_4x4x4_16b_bf16 v[252:255], v[6:7], v[46:47], v[252:255] cbsz:3 abid:7
    s_sub_u32 s62, s62, 1
    s_cbranch_scc1 Lfs_7
Lbs_7:
    v_mad_u32_u16 v4, v87, s7, v2
    buffer_load_dwordx4 v[44:47], v4, s[8:11], 0 offen
    ds_read2_b32 v[86:87], v13 offset0:60 offset1:62
    s_waitcnt lgkmcnt(3)
    v_perm_b32 v6, v5, v5, v10
    v_perm_b32 v7, v5, v5, v11
    ds_read_b32 v5, v14 offset:128
    s_waitcnt vmcnt(15)
    v_mfma_f32_4x4x4_16b_bf16 v[248:251], v[6:7], v[48:49], v[248:251] cbsz:3 abid:0
    v_mfma_f32_4x4x4_16b_bf16 v[252:255], v[6:7], v[50:51], v[252:255] cbsz:3 abid:0
    s_sub_u32 s62, s62, 1
    s_cbranch_scc1 Lfs_8
Lbs_8:
    v_mad_u32_u16 v4, v80, s7, v2
    buffer_load_dwordx4 v[48:51], v4, s[8:11], 0 offen
    s_waitcnt vmcnt(15)
    v_mfma_f32_4x4x4_16b_bf16 v[248:251], v[6:7], v[52:53], v[248:251] cbsz:3 abid:1
    v_mfma_f32_4x4x4_16b_bf16 v[252:255], v[6:7], v[54:55], v[252:255] cbsz:3 abid:1
    s_sub_u32 s62, s62, 1
    s_cbranch_scc1 Lfs_9
Lbs_9:
    v_mad_u32_u16 v4, v81, s7, v2
    buffer_load_dwordx4 v[52:55], v4, s[8:11], 0 offen
    ds_read2_b32 v[80:81], v13 offset0:64 offset1:66
    s_waitcnt vmcnt(15) lgkmcnt(3)
    v_mfma_f32_4x4x4_16b_bf16 v[248:251], v[6:7], v[56:57], v[248:251] cbsz:3 abid:2
    v_mfma_f32_4x4x4_16b_bf16 v[252:255], v[6:7], v[58:59], v[252:255] cbsz:3 abid:2
    s_sub_u32 s62, s62, 1
    s_cbranch_scc1 Lfs_10
Lbs_10:
    v_mad_u32_u16 v4, v82, s7, v2
    buffer_load_dwordx4 v[56:59], v4, s[8:11], 0 offen
    s_waitcnt vmcnt(15)
    v_mfma_f32_4x4x4_16b_bf16 v[248:251], v[6:7], v[60:61], v[248:251] cbsz:3 abid:3
    v_mfma_f32_4x4x4_16b_bf16 v[252:255], v[6:7], v[62:63], v[252:255] cbsz:3 abid:3
    s_sub_u32 s62, s62, 1
    s_cbranch_scc1 Lfs_11
Lbs_11:
    v_mad_u32_u16 v4, v83, s7, v2
    buffer_load_dwordx4 v[60:63], v4, s[8:11], 0 offen
    ds_read2_b32 v[82:83], v13 offset0:68 offset1:70
    s_waitcnt vmcnt(15) lgkmcnt(3)
    v_mfma_f32_4x4x4_16b_bf16 v[248:251], v[6:7], v[64:65], v[248:251] cbsz:3 abid:4
    v_mfma_f32_4x4x4_16b_bf16 v[252:255], v[6:7], v[66:67], v[252:255] cbsz:3 abid:4
    s_sub_u32 s62, s62, 1
    s_cbranch_scc1 Lfs_12
Lbs_12:
    v_mad_u32_u16 v4, v84, s7, v2
    buffer_load_dwordx4 v[64:67], v4, s[8:11], 0 offen
    s_waitcnt vmcnt(15)
    v_mfma_f32_4x4x4_16b_bf16 v[248:251], v[6:7], v[68:69], v[248:251] cbsz:3 abid:5
    v_mfma_f32_4x4x4_16b_bf16 v[252:255], v[6:7], v[70:71], v[252:255] cbsz:3 abid:5
    s_sub_u32 s62, s62, 1
    s_cbranch_scc1 Lfs_13
Lbs_13:
    v_mad_u32_u16 v4, v85, s7, v2
    buffer_load_dwordx4 v[68:71], v4, s[8:11], 0 offen
    ds_read2_b32 v[84:85], v13 offset0:72 offset1:74
    s_waitcnt vmcnt(15) lgkmcnt(3)
    v_mfma_f32_4x4x4_16b_bf16 v[248:251], v[6:7], v[72:73], v[248:251] cbsz:3 abid:6
    v_mfma_f32_4x4x4_16b_bf16 v[252:255], v[6:7], v[74:75], v[252:255] cbsz:3 abid:6
    s_sub_u32 s62, s62, 1
    s_cbranch_scc1 Lfs_14
Lbs_14:
    v_mad_u32_u16 v4, v86, s7, v2
    buffer_load_dwordx4 v[72:75], v4, s[8:11], 0 offen
    s_waitcnt vmcnt(15)
    v_mfma_f32_4x4x4_16b_bf16 v[248:251], v[6:7], v[76:77], v[248:251] cbsz:3 abid:7
    v_mfma_f32_4x4x4_16b_bf16 v[252:255], v[6:7], v[78:79], v[252:255] cbsz:3 abid:7
    s_sub_u32 s62, s62, 1
    s_cbranch_scc1 Lfs_15
Lbs_15:
    v_mad_u32_u16 v4, v87, s7, v2
    buffer_load_dwordx4 v[76:79], v4, s[8:11], 0 offen
    ds_read2_b32 v[86:87], v13 offset0:76 offset1:78
    v_add_u32 v13, 128, v13
    v_add_u32 v14, 128, v14
    s_sub_u32 s66, s66, 1
    s_cmp_lg_u32 s66, 0
    s_cbranch_scc1 L_gl
L_drain:
    s_waitcnt lgkmcnt(0)
    v_perm_b32 v6, v5, v5, v10
    v_perm_b32 v7, v5, v5, v11
    ds_read_b32 v5, v14 offset:64
    s_waitcnt vmcnt(15)
    v_mfma_f32_4x4x4_16b_bf16 v[248:251], v[6:7], v[16:17], v[248:251] cbsz:3 abid:0
    v_mfma_f32_4x4x4_16b_bf16 v[252:255], v[6:7], v[18:19], v[252:255] cbsz:3 abid:0
    s_sub_u32 s62, s62, 1
    s_cbranch_scc1 Lfd_0
Lbd_0:
    s_waitcnt vmcnt(14)
    v_mfma_f32_4x4x4_16b_bf16 v[248:251], v[6:7], v[20:21], v[248:251] cbsz:3 abid:1
    v_mfma_f32_4x4x4_16b_bf16 v[252:255], v[6:7], v[22:23], v[252:255] cbsz:3 abid:1
    s_sub_u32 s62, s62, 1
    s_cbranch_scc1 Lfd_1
Lbd_1:
    s_waitcnt vmcnt(13)
    v_mfma_f32_4x4x4_16b_bf16 v[248:251], v[6:7], v[24:25], v[248:251] cbsz:3 abid:2
    v_mfma_f32_4x4x4_16b_bf16 v[252:255], v[6:7], v[26:27], v[252:255] cbsz:3 abid:2
    s_sub_u32 s62, s62, 1
    s_cbranch_scc1 Lfd_2
Lbd_2:
    s_waitcnt vmcnt(12)
    v_mfma_f32_4x4x4_16b_bf16 v[248:251], v[6:7], v[28:29], v[248:251] cbsz:3 abid:3
    v_mfma_f32_4x4x4_16b_bf16 v[252:255], v[6:7], v[30:31], v[252:255] cbsz:3 abid:3
    s_sub_u32 s62, s62, 1
    s_cbranch_scc1 Lfd_3
Lbd_3:
    s_waitcnt vmcnt(11)
    v_mfma_f32_4x4x4_16b_bf16 v[248:251], v[6:7], v[32:33], v[248:251] cbsz:3 abid:4
    v_mfma_f32_4x4x4_16b_bf16 v[252:255], v[6:7], v[34:35], v[252:255] cbsz:3 abid:4
    s_sub_u32 s62, s62, 1
    s_cbranch_scc1 Lfd_4
Lbd_4:
    s_waitcnt vmcnt(10)
    v_mfma_f32_4x4x4_16b_bf16 v[248:251], v[6:7], v[36:37], v[248:251] cbsz:3 abid:5
    v_mfma_f32_4x4x4_16b_bf16 v[252:255], v[6:7], v[38:39], v[252:255] cbsz:3 abid:5
    s_sub_u32 s62, s62, 1
    s_cbranch_scc1 Lfd_5
Lbd_5:
    s_waitcnt vmcnt(9)
    v_mfma_f32_4x4x4_16b_bf16 v[248:251], v[6:7], v[40:41], v[248:251] cbsz:3 abid:6
    v_mfma_f32_4x4x4_16b_bf16 v[252:255], v[6:7], v[42:43], v[252:255] cbsz:3 abid:6
    s_sub_u32 s62, s62, 1
    s_cbranch_scc1 Lfd_6
Lbd_6:
    s_waitcnt vmcnt(8)
    v_mfma_f32_4x4x4_16b_bf16 v[248:251], v[6:7], v[44:45], v[248:251] cbsz:3 abid:7
    v_mfma_f32_4x4x4_16b_bf16 v[252:255], v[6:7], v[46:47], v[252:255] cbsz:3 abid:7
    s_sub_u32 s62, s62, 1
    s_cbranch_scc1 Lfd_7
Lbd_7:
    s_waitcnt lgkmcnt(0)
    v_perm_b32 v6, v5, v5, v10
    v_perm_b32 v7, v5, v5, v11
    ds_read_b32 v5, v14 offset:128
    s_waitcnt vmcnt(7)
    v_mfma_f32_4x4x4_16b_bf16 v[248:251], v[6:7], v[48:49], v[248:251] cbsz:3 abid:0
    v_mfma_f32_4x4x4_16b_bf16 v[252:255], v[6:7], v[50:51], v[252:255] cbsz:3 abid:0
    s_sub_u32 s62, s62, 1
    s_cbranch_scc1 Lfd_8
Lbd_8:
    s_waitcnt vmcnt(6)
    v_mfma_f32_4x4x4_16b_bf16 v[248:251], v[6:7], v[52:53], v[248:251] cbsz:3 abid:1
    v_mfma_f32_4x4x4_16b_bf16 v[252:255], v[6:7], v[54:55], v[252:255] cbsz:3 abid:1
    s_sub_u32 s62, s62, 1
    s_cbranch_scc1 Lfd_9
Lbd_9:
    s_waitcnt vmcnt(5)
    v_mfma_f32_4x4x4_16b_bf16 v[248:251], v[6:7], v[56:57], v[248:251] cbsz:3 abid:2
    v_mfma_f32_4x4x4_16b_bf16 v[252:255], v[6:7], v[58:59], v[252:255] cbsz:3 abid:2
    s_sub_u32 s62, s62, 1
    s_cbranch_scc1 Lfd_10
Lbd_10:
    s_waitcnt vmcnt(4)
    v_mfma_f32_4x4x4_16b_bf16 v[248:251], v[6:7], v[60:61], v[248:251] cbsz:3 abid:3
    v_mfma_f32_4x4x4_16b_bf16 v[252:255], v[6:7], v[62:63], v[252:255] cbsz:3 abid:3
    s_sub_u32 s62, s62, 1
    s_cbranch_scc1 Lfd_11
Lbd_11:
    s_waitcnt vmcnt(3)
    v_mfma_f32_4x4x4_16b_bf16 v[248:251], v[6:7], v[64:65], v[248:251] cbsz:3 abid:4
    v_mfma_f32_4x4x4_16b_bf16 v[252:255], v[6:7], v[66:67], v[252:255] cbsz:3 abid:4
    s_sub_u32 s62, s62, 1
    s_cbranch_scc1 Lfd_12
Lbd_12:
    s_waitcnt vmcnt(2)
    v_mfma_f32_4x4x4_16b_bf16 v[248:251], v[6:7], v[68:69], v[248:251] cbsz:3 abid:5
    v_mfma_f32_4x4x4_16b_bf16 v[252:255], v[6:7], v[70:71], v[252:255] cbsz:3 abid:5
    s_sub_u32 s62, s62, 1
    s_cbranch_scc1 Lfd_13
Lbd_13:
    s_waitcnt vmcnt(1)
    v_mfma_f32_4x4x4_16b_bf16 v[248:251], v[6:7], v[72:73], v[248:251] cbsz:3 abid:6
    v_mfma_f32_4x4x4_16b_bf16 v[252:255], v[6:7], v[74:75], v[252:255] cbsz:3 abid:6
    s_sub_u32 s62, s62, 1
    s_cbranch_scc1 Lfd_14
Lbd_14:
    s_waitcnt vmcnt(0)
    v_mfma_f32_4x4x4_16b_bf16 v[248:251], v[6:7], v[76:77], v[248:251] cbsz:3 abid:7
    v_mfma_f32_4x4x4_16b_bf16 v[252:255], v[6:7], v[78:79], v[252:255] cbsz:3 abid:7
    s_sub_u32 s62, s62, 1
    s_cbranch_scc1 Lfd_15
Lbd_15:
L_gdone:
    v_add_u32 v8, 130944, v1
    s_mul_i32 s60, s4, 12288
    v_lshl_add_u32 v9, v0, 4, s60
    v_and_b32 v4, 15, v0
    v_lshlrev_b32 v4, 2, v4
    v_and_b32 v5, 48, v0
    v_lshl_add_u32 v10, v5, 7, v4
    v_and_b32 v5, 32, v0
    v_lshl_add_u32 v11, v5, 6, v4
    v_and_b32 v5, 16, v0
    v_lshl_add_u32 v11, v5, 22, v11
    s_lshl_b32 s60, s5, 9
    s_lshl_b32 s61, s4, 7
    s_add_u32 s60, s60, s61
    s_mov_b32 s63, 0
    s_waitcnt lgkmcnt(0)
    s_barrier
L_wlt:
    ds_read_b128 v[48:51], v9 offset:0
    ds_read_b128 v[52:55], v9 offset:1024
    ds_read_b128 v[56:59], v9 offset:2048
    ds_read_b128 v[60:63], v9 offset:3072
    ds_read_b128 v[16:19], v8 offset:0
    ds_read_b128 v[20:23], v8 offset:64
    ds_read_b128 v[24:27], v8 offset:128
    ds_read_b128 v[28:31], v8 offset:192
    ds_read_b128 v[32:35], v8 offset:256
    ds_read_b128 v[36:39], v8 offset:320
    ds_read_b128 v[40:43], v8 offset:384
    ds_read_b128 v[44:47], v8 offset:448
    s_waitcnt lgkmcnt(7)
    v_mfma_f32_16x16x32_bf16 v[48:51], v[16:19], v[120:123], v[48:51]
    v_mfma_f32_16x16x32_bf16 v[52:55], v[16:19], v[124:127], v[52:55]
    v_mfma_f32_16x16x32_bf16 v[56:59], v[16:19], v[128:131], v[56:59]
    v_mfma_f32_16x16x32_bf16 v[60:63], v[16:19], v[132:135], v[60:63]
    s_waitcnt lgkmcnt(6)
    v_mfma_f32_16x16x32_bf16 v[48:51], v[20:23], v[136:139], v[48:51]
    v_mfma_f32_16x16x32_bf16 v[52:55], v[20:23], v[140:143], v[52:55]
    v_mfma_f32_16x16x32_bf16 v[56:59], v[20:23], v[144:147], v[56:59]
    v_mfma_f32_16x16x32_bf16 v[60:63], v[20:23], v[148:151], v[60:63]
    s_waitcnt lgkmcnt(5)
    v_mfma_f32_16x16x32_bf16 v[48:51], v[24:27], v[152:155], v[48:51]
    v_mfma_f32_16x16x32_bf16 v[52:55], v[24:27], v[156:159], v[52:55]
    v_mfma_f32_16x16x32_bf16 v[56:59], v[24:27], v[160:163], v[56:59]
    v_mfma_f32_16x16x32_bf16 v[60:63], v[24:27], v[164:167], v[60:63]
    s_waitcnt lgkmcnt(4)
    v_mfma_f32_16x16x32_bf16 v[48:51], v[28:31], v[168:171], v[48:51]
    v_mfma_f32_16x16x32_bf16 v[52:55], v[28:31], v[172:175], v[52:55]
    v_mfma_f32_16x16x32_bf16 v[56:59], v[28:31], v[176:179], v[56:59]
    v_mfma_f32_16x16x32_bf16 v[60:63], v[28:31], v[180:183], v[60:63]
    s_waitcnt lgkmcnt(3)
    v_mfma_f32_16x16x32_bf16 v[48:51], v[32:35], v[184:187], v[48:51]
    v_mfma_f32_16x16x32_bf16 v[52:55], v[32:35], v[188:191], v[52:55]
    v_mfma_f32_16x16x32_bf16 v[56:59], v[32:35], v[192:195], v[56:59]
    v_mfma_f32_16x16x32_bf16 v[60:63], v[32:35], v[196:199], v[60:63]
    s_waitcnt lgkmcnt(2)
    v_mfma_f32_16x16x32_bf16 v[48:51], v[36:39], v[200:203], v[48:51]
    v_mfma_f32_16x16x32_bf16 v[52:55], v[36:39], v[204:207], v[52:55]
    v_mfma_f32_16x16x32_bf16 v[56:59], v[36:39], v[208:211], v[56:59]
    v_mfma_f32_16x16x32_bf16 v[60:63], v[36:39], v[212:215], v[60:63]
    s_waitcnt lgkmcnt(1)
    v_mfma_f32_16x16x32_bf16 v[48:51], v[40:43], v[216:219], v[48:51]
    v_mfma_f32_16x16x32_bf16 v[52:55], v[40:43], v[220:223], v[52:55]
    v_mfma_f32_16x16x32_bf16 v[56:59], v[40:43], v[224:227], v[56:59]
    v_mfma_f32_16x16x32_bf16 v[60:63], v[40:43], v[228:231], v[60:63]
    s_waitcnt lgkmcnt(0)
    v_mfma_f32_16x16x32_bf16 v[48:51], v[44:47], v[232:235], v[48:51]
    v_mfma_f32_16x16x32_bf16 v[52:55], v[44:47], v[236:239], v[52:55]
    v_mfma_f32_16x16x32_bf16 v[56:59], v[44:47], v[240:243], v[56:59]
    v_mfma_f32_16x16x32_bf16 v[60:63], v[44:47], v[244:247], v[60:63]
    v_add_u32 v8, 8448, v8
    v_add_u32 v9, 4096, v9
    s_add_u32 s63, s63, 1
    s_nop 3
    v_cvt_pk_bf16_f32 v64, v48, v52
    buffer_store_dword v64, v10, s[20:23], s60 offen offset:0
    v_cvt_pk_bf16_f32 v65, v56, v60
    buffer_store_dword v65, v10, s[20:23], s60 offen offset:64
    v_cvt_pk_bf16_f32 v66, v49, v53
    buffer_store_dword v66, v10, s[20:23], s60 offen offset:512
    v_cvt_pk_bf16_f32 v67, v57, v61
    buffer_store_dword v67, v10, s[20:23], s60 offen offset:576
    v_cvt_pk_bf16_f32 v68, v50, v54
    buffer_store_dword v68, v10, s[20:23], s60 offen offset:1024
    v_cvt_pk_bf16_f32 v69, v58, v62
    buffer_store_dword v69, v10, s[20:23], s60 offen offset:1088
    v_cvt_pk_bf16_f32 v70, v51, v55
    buffer_store_dword v70, v10, s[20:23], s60 offen offset:1536
    v_cvt_pk_bf16_f32 v71, v59, v63
    buffer_store_dword v71, v10, s[20:23], s60 offen offset:1600
    s_add_u32 s60, s60, 8192
    s_cmp_lt_u32 s63, 2
    s_cbranch_scc1 L_wlt
    v_mov_b32 v10, v11
    s_cmp_lt_u32 s63, 3
    s_cbranch_scc1 L_wlt
L_end:
L_exit:
    s_endpgm
Lfs_0:
    s_call_b64 s[68:69], L_flush
    s_branch Lbs_0
Lfs_1:
    s_call_b64 s[68:69], L_flush
    s_branch Lbs_1
Lfs_2:
    s_call_b64 s[68:69], L_flush
    s_branch Lbs_2
Lfs_3:
    s_call_b64 s[68:69], L_flush
    s_branch Lbs_3
Lfs_4:
    s_call_b64 s[68:69], L_flush
    s_branch Lbs_4
Lfs_5:
    s_call_b64 s[68:69], L_flush
    s_branch Lbs_5
Lfs_6:
    s_call_b64 s[68:69], L_flush
    s_branch Lbs_6
Lfs_7:
    s_call_b64 s[68:69], L_flush
    s_branch Lbs_7
Lfs_8:
    s_call_b64 s[68:69], L_flush
    s_branch Lbs_8
Lfs_9:
    s_call_b64 s[68:69], L_flush
    s_branch Lbs_9
Lfs_10:
    s_call_b64 s[68:69], L_flush
    s_branch Lbs_10
Lfs_11:
    s_call_b64 s[68:69], L_flush
    s_branch Lbs_11
Lfs_12:
    s_call_b64 s[68:69], L_flush
    s_branch Lbs_12
Lfs_13:
    s_call_b64 s[68:69], L_flush
    s_branch Lbs_13
Lfs_14:
    s_call_b64 s[68:69], L_flush
    s_branch Lbs_14
Lfs_15:
    s_call_b64 s[68:69], L_flush
    s_branch Lbs_15
Lfd_0:
    s_call_b64 s[68:69], L_flush
    s_branch Lbd_0
Lfd_1:
    s_call_b64 s[68:69], L_flush
    s_branch Lbd_1
Lfd_2:
    s_call_b64 s[68:69], L_flush
    s_branch Lbd_2
Lfd_3:
    s_call_b64 s[68:69], L_flush
    s_branch Lbd_3
Lfd_4:
    s_call_b64 s[68:69], L_flush
    s_branch Lbd_4
Lfd_5:
    s_call_b64 s[68:69], L_flush
    s_branch Lbd_5
Lfd_6:
    s_call_b64 s[68:69], L_flush
    s_branch Lbd_6
Lfd_7:
    s_call_b64 s[68:69], L_flush
    s_branch Lbd_7
Lfd_8:
    s_call_b64 s[68:69], L_flush
    s_branch Lbd_8
Lfd_9:
    s_call_b64 s[68:69], L_flush
    s_branch Lbd_9
Lfd_10:
    s_call_b64 s[68:69], L_flush
    s_branch Lbd_10
Lfd_11:
    s_call_b64 s[68:69], L_flush
    s_branch Lbd_11
Lfd_12:
    s_call_b64 s[68:69], L_flush
    s_branch Lbd_12
Lfd_13:
    s_call_b64 s[68:69], L_flush
    s_branch Lbd_13
Lfd_14:
    s_call_b64 s[68:69], L_flush
    s_branch Lbd_14
Lfd_15:
    s_call_b64 s[68:69], L_flush
    s_branch Lbd_15
L_flush:
    s_add_u32 s63, s63, 1
    v_add_u32 v4, s64, v15
    s_nop 0
    v_permlane32_swap_b32 v248, v252
    v_permlane32_swap_b32 v249, v253
    v_permlane32_swap_b32 v250, v254
    v_permlane32_swap_b32 v251, v255
    v_readlane_b32 s64, v9, s63
    v_readlane_b32 s62, v12, s63
    v_add_f32 v248, v248, v252
    v_add_f32 v249, v249, v253
    v_add_f32 v250, v250, v254
    v_add_f32 v251, v251, v255
    v_mul_f32 v248, s65, v248
    v_mul_f32 v249, s65, v249
    v_mul_f32 v250, s65, v250
    v_mul_f32 v251, s65, v251
    v_readlane_b32 s65, v8, s63
    v_cvt_pk_bf16_f32 v252, v248, v249
    v_cvt_pk_bf16_f32 v253, v250, v251
    ds_write_b64 v4, v[252:253]
    v_mov_b64 v[248:249], 0
    v_mov_b64 v[250:251], 0
    v_mov_b64 v[254:255], 0
    v_mov_b64 v[252:253], 0
    s_setpc_b64 s[68:69]
L_slow:
    s_mov_b32 s24, s34
    s_mov_b32 s25, s35
    s_mov_b32 s26, 640000
    s_mov_b32 s27, 0x20000
    s_mov_b32 s28, s36
    s_mov_b32 s29, s37
    s_mov_b32 s30, 640000
    s_mov_b32 s31, 0x20000
    s_mov_b32 s12, s42
    s_mov_b32 s13, s43
    s_mov_b32 s14, 20000
    s_mov_b32 s15, 0x20000
    s_sub_u32 s63, s63, 1
    s_mov_b32 s64, 160320
    s_mov_b32 s65, 0
    s_call_b64 s[68:69], L_flush
    s_mul_i32 s66, s4, 10
    s_add_u32 s66, s66, s5
    s_add_u32 s67, s66, 10
    v_lshlrev_b32 v16, 2, v0
    v_and_b32 v17, 32, v0
    v_lshl_add_u32 v17, v17, 22, v2
    v_mov_b32 v24, 0
L_sn:
    s_mov_b32 s60, 0
L_sc:
    buffer_load_dword v18, v16, s[28:31], s60 offen
    buffer_load_dword v19, v16, s[24:27], s60 offen
    s_waitcnt vmcnt(0)
    v_cmp_eq_u32 vcc, s66, v18
    s_cbranch_vccz L_sx
L_se:
    s_ff1_i32_b64 s58, vcc
    s_bitset0_b64 vcc, s58
    v_readlane_b32 s59, v19, s58
    s_nop 0
    s_lshl_b32 s61, s59, 9
    s_lshl_b32 s59, s59, 1
    buffer_load_dwordx4 v[20:23], v17, s[8:11], s61 offen
    buffer_load_short_d16_hi v5, v24, s[12:15], s59 offen
    s_waitcnt vmcnt(0)
    v_perm_b32 v6, v5, v5, v10
    v_perm_b32 v7, v5, v5, v11
    s_nop 1
    v_mfma_f32_4x4x4_16b_bf16 v[248:251], v[6:7], v[20:21], v[248:251]
    v_mfma_f32_4x4x4_16b_bf16 v[252:255], v[6:7], v[22:23], v[252:255]
    s_cmp_lg_u64 vcc, 0
    s_cbranch_scc1 L_se
L_sx:
    s_add_u32 s60, s60, 256
    s_cmp_lt_u32 s60, 640000
    s_cbranch_scc1 L_sc
    s_call_b64 s[68:69], L_flush
    s_add_u32 s66, s66, 1
    s_cmp_lt_u32 s66, s67
    s_cbranch_scc1 L_sn
    s_branch L_gdone
.section .rodata,"a"
.p2align 6
.amdhsa_kernel standalone__hybrid_graph_tf_exphormer__graph_kernel
  .amdhsa_next_free_vgpr 256
  .amdhsa_next_free_sgpr 102
  .amdhsa_accum_offset 256
  .amdhsa_group_segment_fixed_size 0
  .amdhsa_kernarg_size 104
  .amdhsa_user_sgpr_count 2
  .amdhsa_user_sgpr_kernarg_segment_ptr 1
  .amdhsa_system_sgpr_workgroup_id_x 1
.end_amdhsa_kernel
```

```asm
; @launch grid=(250,1,1) block=(512,1,1) lds=160832
.amdgcn_target "amdgcn-amd-amdhsa--gfx950"
.text
.globl standalone__hybrid_graph_tf_exphormer__graph_kernel
.p2align 8
.type standalone__hybrid_graph_tf_exphormer__graph_kernel,@function
standalone__hybrid_graph_tf_exphormer__graph_kernel:
    s_cmp_ge_u32 s2, 250
    s_cbranch_scc1 L_exit
    s_load_dwordx16 s[32:47], s[0:1], 0
    s_load_dwordx8 s[48:55], s[0:1], 64
    s_load_dwordx2 s[56:57], s[0:1], 96
    s_getpc_b64 s[60:61]
    v_cmp_gt_u32 vcc, 116, v0
    v_lshlrev_b32 v1, 7, v0
    s_and_saveexec_b64 s[58:59], vcc
    s_cbranch_execz L_nopf
    global_load_dword v255, v1, s[60:61]
L_nopf:
    s_mov_b64 exec, -1
    v_lshrrev_b32 v1, 6, v0
    v_mov_b32 v8, 0xffff
    v_readfirstlane_b32 s3, v1
    v_cmp_gt_u32 vcc, 256, v0
    v_lshlrev_b32 v4, 4, v0
    v_add_u32 v4, 152064, v4
    v_cndmask_b32 v8, 0, v8, vcc
    v_mov_b32 v9, v8
    v_mov_b32 v10, v8
    v_mov_b32 v11, v8
    v_cmp_gt_u32 vcc, 356, v0
    s_and_saveexec_b64 s[58:59], vcc
    ds_write_b128 v4, v[8:11]
    s_mov_b64 exec, -1
    v_and_b32 v0, 63, v0
    s_and_b32 s58, s2, 7
    s_lshr_b32 s59, s2, 3
    s_mul_i32 s6, s58, 31
    s_min_u32 s58, s58, 2
    s_add_u32 s6, s6, s58
    s_add_u32 s6, s6, s59
    s_mul_i32 s5, s6, 40
    s_and_b32 s4, s3, 3
    s_movk_i32 s7, 512
    v_and_b32 v4, 7, v0
    v_mul_u32_u24 v1, 1056, v4
    v_and_b32 v4, 8, v0
    v_lshl_add_u32 v1, v4, 6, v1
    v_and_b32 v4, 48, v0
    v_add_u32 v1, v4, v1
    v_and_b32 v2, 31, v0
    v_lshlrev_b32 v2, 4, v2
    v_mov_b32 v3, 156672
    s_mov_b32 s70, 0x05040100
    s_mov_b32 s71, 0x07060302
    v_and_b32 v119, 15, v0
    v_lshlrev_b32 v119, 2, v119
    v_and_b32 v5, 48, v0
    v_lshl_add_u32 v119, v5, 8, v119
    s_lshl_b32 s100, s4, 7
    s_waitcnt lgkmcnt(0)
    s_mov_b32 s8, s32
    s_mov_b32 s9, s33
    s_mov_b32 s10, 5120000
    s_mov_b32 s11, 0x20000
    s_mov_b32 s16, s56
    s_mov_b32 s17, s57
    s_mov_b32 s18, 2097152
    s_mov_b32 s19, 0x20000
    s_cmp_ge_u32 s3, 4
    s_cselect_b32 s12, s44, s50
    s_cselect_b32 s13, s45, s51
    s_mov_b32 s14, 131072
    s_mov_b32 s15, 0x20000
    s_cbranch_scc1 L_preB
    s_mov_b32 s24, s38
    s_mov_b32 s25, s39
    s_mov_b32 s26, 160000
    s_mov_b32 s27, 0x20000
    v_and_b32 v4, 32, v0
    s_mul_i32 s58, s6, 640
    s_lshl_b32 s59, s3, 6
    s_add_u32 s58, s58, s59
    buffer_load_dwordx4 v[16:19], v4, s[24:27], s58 offen offset:0
    buffer_load_dwordx4 v[20:23], v4, s[24:27], s58 offen offset:16
    buffer_load_dwordx4 v[24:27], v4, s[24:27], s58 offen offset:256
    buffer_load_dwordx4 v[28:31], v4, s[24:27], s58 offen offset:272
    buffer_load_dwordx4 v[32:35], v4, s[24:27], s58 offen offset:512
    buffer_load_dwordx4 v[36:39], v4, s[24:27], s58 offen offset:528
    s_barrier
    v_lshl_add_u32 v5, v4, 7, v2
    v_lshl_add_u32 v6, v4, 6, v2
    s_add_u32 s58, s5, s3
    s_lshl_b32 s58, s58, 9
    s_mul_i32 s59, s3, 1056
    s_add_u32 m0, s59, 84480
    s_add_u32 s60, s58, 0
    buffer_load_dwordx4 v5, s[8:11], s60 offen lds
    s_add_u32 m0, s59, 88704
    s_add_u32 s60, s58, 2048
    buffer_load_dwordx4 v5, s[8:11], s60 offen lds
    s_add_u32 m0, s59, 92928
    s_add_u32 s60, s58, 8192
    buffer_load_dwordx4 v5, s[8:11], s60 offen lds
    s_add_u32 m0, s59, 97152
    s_add_u32 s60, s58, 10240
    buffer_load_dwordx4 v5, s[8:11], s60 offen lds
    s_add_u32 m0, s59, 101376
    s_add_u32 s60, s58, 16384
    buffer_load_dwordx4 v6, s[8:11], s60 offen lds
    s_call_b64 s[68:69], L_w1
    s_mul_i32 s59, s3, 8448
    s_waitcnt vmcnt(53)
    s_add_u32 m0, s59, 0
    v_lshl_add_u32 v4, v16, 9, v2
    buffer_load_dwordx4 v4, s[8:11], 0 offen lds
    s_add_u32 m0, s59, 1056
    v_lshl_add_u32 v5, v17, 9, v2
    buffer_load_dwordx4 v5, s[8:11], 0 offen lds
    s_add_u32 m0, s59, 2112
    v_lshl_add_u32 v4, v18, 9, v2
    buffer_load_dwordx4 v4, s[8:11], 0 offen lds
    s_add_u32 m0, s59, 3168
    v_lshl_add_u32 v5, v19, 9, v2
    buffer_load_dwordx4 v5, s[8:11], 0 offen lds
    s_add_u32 m0, s59, 4224
    v_lshl_add_u32 v4, v20, 9, v2
    buffer_load_dwordx4 v4, s[8:11], 0 offen lds
    s_add_u32 m0, s59, 5280
    v_lshl_add_u32 v5, v21, 9, v2
    buffer_load_dwordx4 v5, s[8:11], 0 offen lds
    s_add_u32 m0, s59, 6336
    v_lshl_add_u32 v4, v22, 9, v2
    buffer_load_dwordx4 v4, s[8:11], 0 offen lds
    s_add_u32 m0, s59, 7392
    v_lshl_add_u32 v5, v23, 9, v2
    buffer_load_dwordx4 v5, s[8:11], 0 offen lds
    s_waitcnt vmcnt(55)
    s_add_u32 m0, s59, 33792
    v_lshl_add_u32 v4, v24, 9, v2
    buffer_load_dwordx4 v4, s[8:11], 0 offen lds
    s_add_u32 m0, s59, 34848
    v_lshl_add_u32 v5, v25, 9, v2
    buffer_load_dwordx4 v5, s[8:11], 0 offen lds
    s_add_u32 m0, s59, 35904
    v_lshl_add_u32 v4, v26, 9, v2
    buffer_load_dwordx4 v4, s[8:11], 0 offen lds
    s_add_u32 m0, s59, 36960
    v_lshl_add_u32 v5, v27, 9, v2
    buffer_load_dwordx4 v5, s[8:11], 0 offen lds
    s_add_u32 m0, s59, 38016
    v_lshl_add_u32 v4, v28, 9, v2
    buffer_load_dwordx4 v4, s[8:11], 0 offen lds
    s_add_u32 m0, s59, 39072
    v_lshl_add_u32 v5, v29, 9, v2
    buffer_load_dwordx4 v5, s[8:11], 0 offen lds
    s_add_u32 m0, s59, 40128
    v_lshl_add_u32 v4, v30, 9, v2
    buffer_load_dwordx4 v4, s[8:11], 0 offen lds
    s_add_u32 m0, s59, 41184
    v_lshl_add_u32 v5, v31, 9, v2
    buffer_load_dwordx4 v5, s[8:11], 0 offen lds
    s_cmp_ge_u32 s3, 2
    s_cbranch_scc1 L_w2
    s_waitcnt vmcnt(55)
    s_add_u32 m0, s59, 67584
    v_lshl_add_u32 v4, v32, 9, v2
    buffer_load_dwordx4 v4, s[8:11], 0 offen lds
    s_add_u32 m0, s59, 68640
    v_lshl_add_u32 v5, v33, 9, v2
    buffer_load_dwordx4 v5, s[8:11], 0 offen lds
    s_add_u32 m0, s59, 69696
    v_lshl_add_u32 v4, v34, 9, v2
    buffer_load_dwordx4 v4, s[8:11], 0 offen lds
    s_add_u32 m0, s59, 70752
    v_lshl_add_u32 v5, v35, 9, v2
    buffer_load_dwordx4 v5, s[8:11], 0 offen lds
    s_add_u32 m0, s59, 71808
    v_lshl_add_u32 v4, v36, 9, v2
    buffer_load_dwordx4 v4, s[8:11], 0 offen lds
    s_add_u32 m0, s59, 72864
    v_lshl_add_u32 v5, v37, 9, v2
    buffer_load_dwordx4 v5, s[8:11], 0 offen lds
    s_add_u32 m0, s59, 73920
    v_lshl_add_u32 v4, v38, 9, v2
    buffer_load_dwordx4 v4, s[8:11], 0 offen lds
    s_add_u32 m0, s59, 74976
    v_lshl_add_u32 v5, v39, 9, v2
    buffer_load_dwordx4 v5, s[8:11], 0 offen lds
    s_branch L_w2
L_preB:
    s_cmp_eq_u32 s3, 5
    s_cbranch_scc1 L_mtask
    s_cmp_eq_u32 s3, 4
    s_cbranch_scc1 L_prod
    s_mov_b32 s24, s42
    s_mov_b32 s25, s43
    s_mov_b32 s26, 20000
    s_mov_b32 s27, 0x20000
    s_cmp_eq_u32 s3, 6
    s_cselect_b32 s60, s44, s50
    s_cselect_b32 s61, s45, s51
    s_lshr_b32 s58, s2, 3
    s_lshl_b32 s58, s58, 12
    v_lshl_add_u32 v4, v0, 7, s58
    s_mov_b32 exec_hi, 0
    global_load_dword v254, v4, s[60:61]
    s_mov_b64 exec, -1
    s_lshl_b32 s58, s2, 3
    s_add_u32 s58, s58, s3
    s_cmp_eq_u32 s58, 6
    s_cbranch_scc0 L_noz
    v_lshlrev_b32 v4, 8, v0
    v_mov_b32 v5, 0
    v_mov_b32 v6, 1
    s_mov_b32 s58, 1572864
    s_mov_b32 s59, 1589248
    buffer_store_dword v5, v4, s[16:19], s58 offen sc1
    buffer_store_dword v5, v4, s[16:19], s59 offen sc1
    s_barrier
    s_waitcnt vmcnt(0)
    s_mov_b64 exec, 1
    global_store_dword v5, v6, s[54:55] sc1
    s_mov_b64 exec, -1
    s_branch L_zd
L_noz:
    s_barrier
L_zd:
    s_sub_u32 s58, s3, 6
    s_mul_i32 s58, s58, 10240
    v_lshlrev_b32 v4, 4, v0
    s_add_u32 m0, s58, 130944
    s_add_u32 s59, s58, 0
    buffer_load_dwordx4 v4, s[24:27], s59 offen offset:0 lds
    buffer_load_dwordx4 v4, s[24:27], s59 offen offset:1024 lds
    buffer_load_dwordx4 v4, s[24:27], s59 offen offset:2048 lds
    buffer_load_dwordx4 v4, s[24:27], s59 offen offset:3072 lds
    s_add_u32 m0, s58, 135040
    s_add_u32 s59, s58, 4096
    buffer_load_dwordx4 v4, s[24:27], s59 offen offset:0 lds
    buffer_load_dwordx4 v4, s[24:27], s59 offen offset:1024 lds
    buffer_load_dwordx4 v4, s[24:27], s59 offen offset:2048 lds
    buffer_load_dwordx4 v4, s[24:27], s59 offen offset:3072 lds
    s_add_u32 m0, s58, 139136
    s_add_u32 s59, s58, 8192
    buffer_load_dwordx4 v4, s[24:27], s59 offen offset:0 lds
    buffer_load_dwordx4 v4, s[24:27], s59 offen offset:1024 lds
    s_branch L_w12
L_mtask:
    s_cmp_ge_u32 s2, 128
    s_cbranch_scc0 L_mgo
    s_barrier
    s_mov_b64 exec, 1
    v_mov_b32 v4, 1
    ds_add_u32 v3, v4 offset:8
    s_mov_b64 exec, -1
    s_branch L_w12
L_mgo:
    s_setprio 2
    s_mov_b32 s24, s46
    s_mov_b32 s25, s47
    s_mov_b32 s26, 131072
    s_mov_b32 s27, 0x20000
    s_mov_b32 s28, s48
    s_mov_b32 s29, s49
    s_mov_b32 s30, 131072
    s_mov_b32 s31, 0x20000
    v_and_b32 v4, 32, v0
    v_lshl_add_u32 v4, v4, 8, v2
    s_and_b32 s58, s2, 7
    s_lshl_b32 s58, s58, 14
    s_lshr_b32 s59, s2, 4
    s_lshl_b32 s59, s59, 14
    s_bfe_u32 s60, s2, 0x10003
    s_lshl_b32 s60, s60, 11
    s_add_u32 s59, s59, s60
    s_mov_b32 m0, 105600
    s_add_u32 s60, s58, 0
    buffer_load_dwordx4 v4, s[24:27], s60 offen lds
    s_mov_b32 m0, 106656
    s_add_u32 s60, s58, 512
    buffer_load_dwordx4 v4, s[24:27], s60 offen lds
    s_mov_b32 m0, 107712
    s_add_u32 s60, s58, 1024
    buffer_load_dwordx4 v4, s[24:27], s60 offen lds
    s_mov_b32 m0, 108768
    s_add_u32 s60, s58, 1536
    buffer_load_dwordx4 v4, s[24:27], s60 offen lds
    s_mov_b32 m0, 109824
    s_add_u32 s60, s58, 4096
    buffer_load_dwordx4 v4, s[24:27], s60 offen lds
    s_mov_b32 m0, 110880
    s_add_u32 s60, s58, 4608
    buffer_load_dwordx4 v4, s[24:27], s60 offen lds
    s_mov_b32 m0, 111936
    s_add_u32 s60, s58, 5120
    buffer_load_dwordx4 v4, s[24:27], s60 offen lds
    s_mov_b32 m0, 112992
    s_add_u32 s60, s58, 5632
    buffer_load_dwordx4 v4, s[24:27], s60 offen lds
    s_mov_b32 m0, 114048
    s_add_u32 s60, s58, 2048
    buffer_load_dwordx4 v4, s[24:27], s60 offen lds
    s_mov_b32 m0, 115104
    s_add_u32 s60, s58, 2560
    buffer_load_dwordx4 v4, s[24:27], s60 offen lds
    s_mov_b32 m0, 116160
    s_add_u32 s60, s58, 3072
    buffer_load_dwordx4 v4, s[24:27], s60 offen lds
    s_mov_b32 m0, 117216
    s_add_u32 s60, s58, 3584
    buffer_load_dwordx4 v4, s[24:27], s60 offen lds
    s_mov_b32 m0, 118272
    s_add_u32 s60, s58, 6144
    buffer_load_dwordx4 v4, s[24:27], s60 offen lds
    s_mov_b32 m0, 119328
    s_add_u32 s60, s58, 6656
    buffer_load_dwordx4 v4, s[24:27], s60 offen lds
    s_mov_b32 m0, 120384
    s_add_u32 s60, s58, 7168
    buffer_load_dwordx4 v4, s[24:27], s60 offen lds
    s_mov_b32 m0, 121440
    s_add_u32 s60, s58, 7680
    buffer_load_dwordx4 v4, s[24:27], s60 offen lds
    s_mov_b32 m0, 122496
    s_add_u32 s60, s59, 0
    buffer_load_dwordx4 v4, s[28:31], s60 offen lds
    s_mov_b32 m0, 123552
    s_add_u32 s60, s59, 512
    buffer_load_dwordx4 v4, s[28:31], s60 offen lds
    s_mov_b32 m0, 124608
    s_add_u32 s60, s59, 1024
    buffer_load_dwordx4 v4, s[28:31], s60 offen lds
    s_mov_b32 m0, 125664
    s_add_u32 s60, s59, 1536
    buffer_load_dwordx4 v4, s[28:31], s60 offen lds
    s_mov_b32 m0, 126720
    s_add_u32 s60, s59, 4096
    buffer_load_dwordx4 v4, s[28:31], s60 offen lds
    s_mov_b32 m0, 127776
    s_add_u32 s60, s59, 4608
    buffer_load_dwordx4 v4, s[28:31], s60 offen lds
    s_mov_b32 m0, 128832
    s_add_u32 s60, s59, 5120
    buffer_load_dwordx4 v4, s[28:31], s60 offen lds
    s_mov_b32 m0, 129888
    s_add_u32 s60, s59, 5632
    buffer_load_dwordx4 v4, s[28:31], s60 offen lds
    v_add_u32 v5, 105600, v1
    s_lshr_b32 s58, s2, 4
    s_lshl_b32 s58, s58, 3
    s_and_b32 s59, s2, 7
    s_add_u32 s58, s58, s59
    s_lshl_b32 s58, s58, 1
    s_bfe_u32 s59, s2, 0x10003
    s_add_u32 s58, s58, s59
    s_lshl_b32 s58, s58, 10
    s_add_u32 s58, s58, 1048576
    v_lshlrev_b32 v6, 4, v0
    s_barrier
    s_waitcnt vmcnt(0)
    ds_read_b128 v[16:19], v5 offset:0
    ds_read_b128 v[20:23], v5 offset:8448
    ds_read_b128 v[24:27], v5 offset:16896
    ds_read_b128 v[28:31], v5 offset:64
    ds_read_b128 v[32:35], v5 offset:8512
    ds_read_b128 v[36:39], v5 offset:16960
    ds_read_b128 v[40:43], v5 offset:128
    ds_read_b128 v[44:47], v5 offset:8576
    ds_read_b128 v[48:51], v5 offset:17024
    ds_read_b128 v[52:55], v5 offset:192
    ds_read_b128 v[56:59], v5 offset:8640
    ds_read_b128 v[60:63], v5 offset:17088
    s_waitcnt lgkmcnt(9)
    v_mfma_f32_16x16x32_bf16 v[8:11], v[16:19], v[24:27], 0
    v_mfma_f32_16x16x32_bf16 v[12:15], v[20:23], v[24:27], 0
    s_waitcnt lgkmcnt(6)
    v_mfma_f32_16x16x32_bf16 v[8:11], v[28:31], v[36:39], v[8:11]
    v_mfma_f32_16x16x32_bf16 v[12:15], v[32:35], v[36:39], v[12:15]
    s_waitcnt lgkmcnt(3)
    v_mfma_f32_16x16x32_bf16 v[8:11], v[40:43], v[48:51], v[8:11]
    v_mfma_f32_16x16x32_bf16 v[12:15], v[44:47], v[48:51], v[12:15]
    s_waitcnt lgkmcnt(0)
    v_mfma_f32_16x16x32_bf16 v[8:11], v[52:55], v[60:63], v[8:11]
    v_mfma_f32_16x16x32_bf16 v[12:15], v[56:59], v[60:63], v[12:15]
    ds_read_b128 v[16:19], v5 offset:256
    ds_read_b128 v[20:23], v5 offset:8704
    ds_read_b128 v[24:27], v5 offset:17152
    ds_read_b128 v[28:31], v5 offset:320
    ds_read_b128 v[32:35], v5 offset:8768
    ds_read_b128 v[36:39], v5 offset:17216
    ds_read_b128 v[40:43], v5 offset:384
    ds_read_b128 v[44:47], v5 offset:8832
    ds_read_b128 v[48:51], v5 offset:17280
    ds_read_b128 v[52:55], v5 offset:448
    ds_read_b128 v[56:59], v5 offset:8896
    ds_read_b128 v[60:63], v5 offset:17344
    s_waitcnt lgkmcnt(9)
    v_mfma_f32_16x16x32_bf16 v[8:11], v[16:19], v[24:27], v[8:11]
    v_mfma_f32_16x16x32_bf16 v[12:15], v[20:23], v[24:27], v[12:15]
    s_waitcnt lgkmcnt(6)
    v_mfma_f32_16x16x32_bf16 v[8:11], v[28:31], v[36:39], v[8:11]
    v_mfma_f32_16x16x32_bf16 v[12:15], v[32:35], v[36:39], v[12:15]
    s_waitcnt lgkmcnt(3)
    v_mfma_f32_16x16x32_bf16 v[8:11], v[40:43], v[48:51], v[8:11]
    v_mfma_f32_16x16x32_bf16 v[12:15], v[44:47], v[48:51], v[12:15]
    s_waitcnt lgkmcnt(0)
    v_mfma_f32_16x16x32_bf16 v[8:11], v[52:55], v[60:63], v[8:11]
    v_mfma_f32_16x16x32_bf16 v[12:15], v[56:59], v[60:63], v[12:15]
    s_nop 7
    v_cvt_pk_bf16_f32 v16, v8, v9
    v_cvt_pk_bf16_f32 v17, v10, v11
    v_cvt_pk_bf16_f32 v18, v12, v13
    v_cvt_pk_bf16_f32 v19, v14, v15
    buffer_store_dwordx4 v[16:19], v6, s[16:19], s58 offen sc1
    s_waitcnt vmcnt(0)
    s_mov_b64 exec, 1
    v_mov_b32 v4, 1
    ds_add_u32 v3, v4 offset:8
    s_mov_b64 exec, -1
    s_setprio 0
    s_branch L_w12
L_prod:
    s_setprio 3
    s_mov_b32 s24, s34
    s_mov_b32 s25, s35
    s_mov_b32 s26, 640000
    s_mov_b32 s27, 0x20000
    s_mov_b32 s28, s36
    s_mov_b32 s29, s37
    s_mov_b32 s30, 640000
    s_mov_b32 s31, 0x20000
    v_lshlrev_b32 v5, 4, v0
    v_lshlrev_b32 v6, 3, v0
    s_mul_i32 s58, s2, 2560
    buffer_load_dwordx4 v[26:29], v5, s[28:31], s58 offen
    buffer_load_dwordx4 v[30:33], v5, s[28:31], s58 offen offset:1024
    buffer_load_dwordx2 v[34:35], v6, s[28:31], s58 offen offset:2048
    buffer_load_dwordx4 v[16:19], v5, s[24:27], s58 offen
    buffer_load_dwordx4 v[20:23], v5, s[24:27], s58 offen offset:1024
    buffer_load_dwordx2 v[24:25], v6, s[24:27], s58 offen offset:2048
    v_mov_b32 v8, 1
    v_mov_b32 v9, 4
    v_mov_b32 v10, 156736
    v_add_u32 v11, 156736, v5
    s_lshl_b32 s59, s2, 10
    s_add_u32 s58, s58, 262144
    s_barrier
    s_call_b64 s[68:69], L_w1
    s_waitcnt vmcnt(51)
    v_mul_u32_u24 v36, 52429, v26
    v_lshrrev_b32 v36, 21, v36
    v_lshl_add_u32 v36, v36, 2, v10
    ds_add_u32 v36, v8
    v_mul_u32_u24 v37, 52429, v27
    v_lshrrev_b32 v37, 21, v37
    v_lshl_add_u32 v37, v37, 2, v10
    ds_add_u32 v37, v8
    v_mul_u32_u24 v38, 52429, v28
    v_lshrrev_b32 v38, 21, v38
    v_lshl_add_u32 v38, v38, 2, v10
    ds_add_u32 v38, v8
    v_mul_u32_u24 v39, 52429, v29
    v_lshrrev_b32 v39, 21, v39
    v_lshl_add_u32 v39, v39, 2, v10
    ds_add_u32 v39, v8
    v_mul_u32_u24 v40, 52429, v30
    v_lshrrev_b32 v40, 21, v40
    v_lshl_add_u32 v40, v40, 2, v10
    ds_add_u32 v40, v8
    v_mul_u32_u24 v41, 52429, v31
    v_lshrrev_b32 v41, 21, v41
    v_lshl_add_u32 v41, v41, 2, v10
    ds_add_u32 v41, v8
    v_mul_u32_u24 v42, 52429, v32
    v_lshrrev_b32 v42, 21, v42
    v_lshl_add_u32 v42, v42, 2, v10
    ds_add_u32 v42, v8
    v_mul_u32_u24 v43, 52429, v33
    v_lshrrev_b32 v43, 21, v43
    v_lshl_add_u32 v43, v43, 2, v10
    ds_add_u32 v43, v8
    v_mul_u32_u24 v44, 52429, v34
    v_lshrrev_b32 v44, 21, v44
    v_lshl_add_u32 v44, v44, 2, v10
    ds_add_u32 v44, v8
    v_mul_u32_u24 v45, 52429, v35
    v_lshrrev_b32 v45, 21, v45
    v_lshl_add_u32 v45, v45, 2, v10
    ds_add_u32 v45, v8
    ds_read_b128 v[12:15], v11
    s_waitcnt vmcnt(48)
    v_lshl_or_b32 v16, v26, 16, v16
    v_lshl_or_b32 v17, v27, 16, v17
    v_lshl_or_b32 v18, v28, 16, v18
    v_lshl_or_b32 v19, v29, 16, v19
    v_lshl_or_b32 v20, v30, 16, v20
    v_lshl_or_b32 v21, v31, 16, v21
    v_lshl_or_b32 v22, v32, 16, v22
    v_lshl_or_b32 v23, v33, 16, v23
    v_lshl_or_b32 v24, v34, 16, v24
    v_lshl_or_b32 v25, v35, 16, v25
    s_waitcnt lgkmcnt(0)
    v_add_u32 v56, v12, v13
    v_add3_u32 v57, v56, v14, v15
    v_mov_b32 v58, v57
    s_nop 1
    v_add_u32_dpp v58, v58, v58 row_shr:1 row_mask:0xf bank_mask:0xf bound_ctrl:1
    s_nop 1
    v_add_u32_dpp v58, v58, v58 row_shr:2 row_mask:0xf bank_mask:0xf bound_ctrl:1
    s_nop 1
    v_add_u32_dpp v58, v58, v58 row_shr:4 row_mask:0xf bank_mask:0xf bound_ctrl:1
    s_nop 1
    v_add_u32_dpp v58, v58, v58 row_shr:8 row_mask:0xf bank_mask:0xf bound_ctrl:1
    s_nop 1
    v_add_u32_dpp v58, v58, v58 row_bcast:15 row_mask:0xa bank_mask:0xf
    s_nop 1
    v_add_u32_dpp v58, v58, v58 row_bcast:31 row_mask:0xc bank_mask:0xf
    v_mov_b32 v59, 157760
    v_sub_u32 v60, v58, v57
    v_add_u32 v61, v60, v12
    v_add_u32 v62, v60, v56
    v_add_u32 v63, v62, v14
    v_lshl_add_u32 v64, v60, 2, v59
    v_lshl_add_u32 v65, v61, 2, v59
    v_lshl_add_u32 v66, v62, 2, v59
    v_lshl_add_u32 v67, v63, 2, v59
    ds_write_b128 v11, v[64:67]
    ds_add_rtn_u32 v46, v36, v9
    ds_add_rtn_u32 v47, v37, v9
    ds_add_rtn_u32 v48, v38, v9
    ds_add_rtn_u32 v49, v39, v9
    ds_add_rtn_u32 v50, v40, v9
    ds_add_rtn_u32 v51, v41, v9
    ds_add_rtn_u32 v52, v42, v9
    ds_add_rtn_u32 v53, v43, v9
    ds_add_rtn_u32 v54, v44, v9
    ds_add_rtn_u32 v55, v45, v9
    v_lshl_or_b32 v60, v12, 16, v60
    v_lshl_or_b32 v61, v13, 16, v61
    v_lshl_or_b32 v62, v14, 16, v62
    v_lshl_or_b32 v63, v15, 16, v63
    buffer_store_dwordx4 v[60:63], v5, s[16:19], s59 offen sc1
    v_add_u32 v11, 157760, v5
    v_add_u32 v10, 157760, v6
    s_waitcnt lgkmcnt(9)
    ds_write_b32 v46, v16
    s_waitcnt lgkmcnt(9)
    ds_write_b32 v47, v17
    s_waitcnt lgkmcnt(9)
    ds_write_b32 v48, v18
    s_waitcnt lgkmcnt(9)
    ds_write_b32 v49, v19
    s_waitcnt lgkmcnt(9)
    ds_write_b32 v50, v20
    s_waitcnt lgkmcnt(9)
    ds_write_b32 v51, v21
    s_waitcnt lgkmcnt(9)
    ds_write_b32 v52, v22
    s_waitcnt lgkmcnt(9)
    ds_write_b32 v53, v23
    s_waitcnt lgkmcnt(9)
    ds_write_b32 v54, v24
    s_waitcnt lgkmcnt(9)
    ds_write_b32 v55, v25
    ds_read_b128 v[64:67], v11
    ds_read_b128 v[68:71], v11 offset:1024
    ds_read_b64 v[72:73], v10 offset:2048
    s_waitcnt lgkmcnt(2)
    buffer_store_dwordx4 v[64:67], v5, s[16:19], s58 offen sc1
    s_waitcnt lgkmcnt(1)
    buffer_store_dwordx4 v[68:71], v5, s[16:19], s58 offen offset:1024 sc1
    s_waitcnt lgkmcnt(0)
    buffer_store_dwordx2 v[72:73], v6, s[16:19], s58 offen offset:2048 sc1
    v_mov_b32 v9, 0
    s_mov_b32 s60, 0
    s_and_b32 s58, s2, 15
    v_lshl_add_u32 v10, v0, 4, s58
    v_lshlrev_b32 v10, 8, v10
L_zp:
    global_load_dword v11, v9, s[54:55] sc1
    s_add_u32 s60, s60, 1
    s_cmp_gt_u32 s60, 0x40000
    s_cbranch_scc1 L_end
    s_mov_b32 s59, 0
Lw_1:
    ds_read_b32 v4, v3 offset:8
    s_add_u32 s59, s59, 1
    s_cmp_gt_u32 s59, 0x400000
    s_cbranch_scc1 L_end
    s_waitcnt lgkmcnt(0)
    v_readfirstlane_b32 s58, v4
    s_nop 0
    s_cmp_lt_u32 s58, 1
    s_cbranch_scc1 Lw_1
    s_waitcnt vmcnt(0)
    v_cmp_ne_u32 vcc, 1, v11
    s_cbranch_vccnz L_zp
    s_mov_b32 s58, 1572864
    s_mov_b64 exec, 255
    buffer_atomic_add v8, v10, s[16:19], s58 offen sc1
    s_mov_b64 exec, -1
    s_branch L_w2
L_w1:
    buffer_load_dword v128, v119, s[12:15], s100 offen offset:0
    buffer_load_dword v136, v119, s[12:15], s100 offen offset:64
    buffer_load_dword v129, v119, s[12:15], s100 offen offset:512
    buffer_load_dword v137, v119, s[12:15], s100 offen offset:576
    buffer_load_dword v130, v119, s[12:15], s100 offen offset:1024
    buffer_load_dword v138, v119, s[12:15], s100 offen offset:1088
    buffer_load_dword v131, v119, s[12:15], s100 offen offset:1536
    buffer_load_dword v139, v119, s[12:15], s100 offen offset:1600
    buffer_load_dword v132, v119, s[12:15], s100 offen offset:2048
    buffer_load_dword v140, v119, s[12:15], s100 offen offset:2112
    buffer_load_dword v133, v119, s[12:15], s100 offen offset:2560
    buffer_load_dword v141, v119, s[12:15], s100 offen offset:2624
    buffer_load_dword v134, v119, s[12:15], s100 offen offset:3072
    buffer_load_dword v142, v119, s[12:15], s100 offen offset:3136
    buffer_load_dword v135, v119, s[12:15], s100 offen offset:3584
    buffer_load_dword v143, v119, s[12:15], s100 offen offset:3648
    s_waitcnt vmcnt(47)
    s_add_u32 s100, s100, 16384
    buffer_load_dword v144, v119, s[12:15], s100 offen offset:0
    buffer_load_dword v152, v119, s[12:15], s100 offen offset:64
    buffer_load_dword v145, v119, s[12:15], s100 offen offset:512
    buffer_load_dword v153, v119, s[12:15], s100 offen offset:576
    buffer_load_dword v146, v119, s[12:15], s100 offen offset:1024
    buffer_load_dword v154, v119, s[12:15], s100 offen offset:1088
    buffer_load_dword v147, v119, s[12:15], s100 offen offset:1536
    buffer_load_dword v155, v119, s[12:15], s100 offen offset:1600
    buffer_load_dword v148, v119, s[12:15], s100 offen offset:2048
    buffer_load_dword v156, v119, s[12:15], s100 offen offset:2112
    buffer_load_dword v149, v119, s[12:15], s100 offen offset:2560
    buffer_load_dword v157, v119, s[12:15], s100 offen offset:2624
    buffer_load_dword v150, v119, s[12:15], s100 offen offset:3072
    buffer_load_dword v158, v119, s[12:15], s100 offen offset:3136
    buffer_load_dword v151, v119, s[12:15], s100 offen offset:3584
    buffer_load_dword v159, v119, s[12:15], s100 offen offset:3648
    s_waitcnt vmcnt(47)
    s_add_u32 s100, s100, 16384
    buffer_load_dword v160, v119, s[12:15], s100 offen offset:0
    buffer_load_dword v168, v119, s[12:15], s100 offen offset:64
    buffer_load_dword v161, v119, s[12:15], s100 offen offset:512
    buffer_load_dword v169, v119, s[12:15], s100 offen offset:576
    buffer_load_dword v162, v119, s[12:15], s100 offen offset:1024
    buffer_load_dword v170, v119, s[12:15], s100 offen offset:1088
    buffer_load_dword v163, v119, s[12:15], s100 offen offset:1536
    buffer_load_dword v171, v119, s[12:15], s100 offen offset:1600
    buffer_load_dword v164, v119, s[12:15], s100 offen offset:2048
    buffer_load_dword v172, v119, s[12:15], s100 offen offset:2112
    buffer_load_dword v165, v119, s[12:15], s100 offen offset:2560
    buffer_load_dword v173, v119, s[12:15], s100 offen offset:2624
    buffer_load_dword v166, v119, s[12:15], s100 offen offset:3072
    buffer_load_dword v174, v119, s[12:15], s100 offen offset:3136
    buffer_load_dword v167, v119, s[12:15], s100 offen offset:3584
    buffer_load_dword v175, v119, s[12:15], s100 offen offset:3648
    s_setpc_b64 s[68:69]
L_w12:
    s_call_b64 s[68:69], L_w1
L_w2:
    s_waitcnt vmcnt(32)
    s_add_u32 s100, s100, 16384
    buffer_load_dword v176, v119, s[12:15], s100 offen offset:0
    buffer_load_dword v184, v119, s[12:15], s100 offen offset:64
    buffer_load_dword v177, v119, s[12:15], s100 offen offset:512
    buffer_load_dword v185, v119, s[12:15], s100 offen offset:576
    buffer_load_dword v178, v119, s[12:15], s100 offen offset:1024
    buffer_load_dword v186, v119, s[12:15], s100 offen offset:1088
    buffer_load_dword v179, v119, s[12:15], s100 offen offset:1536
    buffer_load_dword v187, v119, s[12:15], s100 offen offset:1600
    buffer_load_dword v180, v119, s[12:15], s100 offen offset:2048
    buffer_load_dword v188, v119, s[12:15], s100 offen offset:2112
    buffer_load_dword v181, v119, s[12:15], s100 offen offset:2560
    buffer_load_dword v189, v119, s[12:15], s100 offen offset:2624
    buffer_load_dword v182, v119, s[12:15], s100 offen offset:3072
    buffer_load_dword v190, v119, s[12:15], s100 offen offset:3136
    buffer_load_dword v183, v119, s[12:15], s100 offen offset:3584
    buffer_load_dword v191, v119, s[12:15], s100 offen offset:3648
    v_perm_b32 v120, v129, v128, s70
    v_perm_b32 v124, v129, v128, s71
    v_perm_b32 v121, v131, v130, s70
    v_perm_b32 v125, v131, v130, s71
    v_perm_b32 v122, v133, v132, s70
    v_perm_b32 v126, v133, v132, s71
    v_perm_b32 v123, v135, v134, s70
    v_perm_b32 v127, v135, v134, s71
    v_perm_b32 v128, v137, v136, s70
    v_perm_b32 v132, v137, v136, s71
    v_perm_b32 v129, v139, v138, s70
    v_perm_b32 v133, v139, v138, s71
    v_perm_b32 v130, v141, v140, s70
    v_perm_b32 v134, v141, v140, s71
    v_perm_b32 v131, v143, v142, s70
    v_perm_b32 v135, v143, v142, s71
    s_waitcnt vmcnt(32)
    s_add_u32 s100, s100, 16384
    buffer_load_dword v192, v119, s[12:15], s100 offen offset:0
    buffer_load_dword v200, v119, s[12:15], s100 offen offset:64
    buffer_load_dword v193, v119, s[12:15], s100 offen offset:512
    buffer_load_dword v201, v119, s[12:15], s100 offen offset:576
    buffer_load_dword v194, v119, s[12:15], s100 offen offset:1024
    buffer_load_dword v202, v119, s[12:15], s100 offen offset:1088
    buffer_load_dword v195, v119, s[12:15], s100 offen offset:1536
    buffer_load_dword v203, v119, s[12:15], s100 offen offset:1600
    buffer_load_dword v196, v119, s[12:15], s100 offen offset:2048
    buffer_load_dword v204, v119, s[12:15], s100 offen offset:2112
    buffer_load_dword v197, v119, s[12:15], s100 offen offset:2560
    buffer_load_dword v205, v119, s[12:15], s100 offen offset:2624
    buffer_load_dword v198, v119, s[12:15], s100 offen offset:3072
    buffer_load_dword v206, v119, s[12:15], s100 offen offset:3136
    buffer_load_dword v199, v119, s[12:15], s100 offen offset:3584
    buffer_load_dword v207, v119, s[12:15], s100 offen offset:3648
    v_perm_b32 v136, v145, v144, s70
    v_perm_b32 v140, v145, v144, s71
    v_perm_b32 v137, v147, v146, s70
    v_perm_b32 v141, v147, v146, s71
    v_perm_b32 v138, v149, v148, s70
    v_perm_b32 v142, v149, v148, s71
    v_perm_b32 v139, v151, v150, s70
    v_perm_b32 v143, v151, v150, s71
    v_perm_b32 v144, v153, v152, s70
    v_perm_b32 v148, v153, v152, s71
    v_perm_b32 v145, v155, v154, s70
    v_perm_b32 v149, v155, v154, s71
    v_perm_b32 v146, v157, v156, s70
    v_perm_b32 v150, v157, v156, s71
    v_perm_b32 v147, v159, v158, s70
    v_perm_b32 v151, v159, v158, s71
    s_waitcnt vmcnt(32)
    s_add_u32 s100, s100, 16384
    buffer_load_dword v208, v119, s[12:15], s100 offen offset:0
    buffer_load_dword v216, v119, s[12:15], s100 offen offset:64
    buffer_load_dword v209, v119, s[12:15], s100 offen offset:512
    buffer_load_dword v217, v119, s[12:15], s100 offen offset:576
    buffer_load_dword v210, v119, s[12:15], s100 offen offset:1024
    buffer_load_dword v218, v119, s[12:15], s100 offen offset:1088
    buffer_load_dword v211, v119, s[12:15], s100 offen offset:1536
    buffer_load_dword v219, v119, s[12:15], s100 offen offset:1600
    buffer_load_dword v212, v119, s[12:15], s100 offen offset:2048
    buffer_load_dword v220, v119, s[12:15], s100 offen offset:2112
    buffer_load_dword v213, v119, s[12:15], s100 offen offset:2560
    buffer_load_dword v221, v119, s[12:15], s100 offen offset:2624
    buffer_load_dword v214, v119, s[12:15], s100 offen offset:3072
    buffer_load_dword v222, v119, s[12:15], s100 offen offset:3136
    buffer_load_dword v215, v119, s[12:15], s100 offen offset:3584
    buffer_load_dword v223, v119, s[12:15], s100 offen offset:3648
    v_perm_b32 v152, v161, v160, s70
    v_perm_b32 v156, v161, v160, s71
    v_perm_b32 v153, v163, v162, s70
    v_perm_b32 v157, v163, v162, s71
    v_perm_b32 v154, v165, v164, s70
    v_perm_b32 v158, v165, v164, s71
    v_perm_b32 v155, v167, v166, s70
    v_perm_b32 v159, v167, v166, s71
    v_perm_b32 v160, v169, v168, s70
    v_perm_b32 v164, v169, v168, s71
    v_perm_b32 v161, v171, v170, s70
    v_perm_b32 v165, v171, v170, s71
    v_perm_b32 v162, v173, v172, s70
    v_perm_b32 v166, v173, v172, s71
    v_perm_b32 v163, v175, v174, s70
    v_perm_b32 v167, v175, v174, s71
    s_waitcnt vmcnt(32)
    s_add_u32 s100, s100, 16384
    buffer_load_dword v224, v119, s[12:15], s100 offen offset:0
    buffer_load_dword v232, v119, s[12:15], s100 offen offset:64
    buffer_load_dword v225, v119, s[12:15], s100 offen offset:512
    buffer_load_dword v233, v119, s[12:15], s100 offen offset:576
    buffer_load_dword v226, v119, s[12:15], s100 offen offset:1024
    buffer_load_dword v234, v119, s[12:15], s100 offen offset:1088
    buffer_load_dword v227, v119, s[12:15], s100 offen offset:1536
    buffer_load_dword v235, v119, s[12:15], s100 offen offset:1600
    buffer_load_dword v228, v119, s[12:15], s100 offen offset:2048
    buffer_load_dword v236, v119, s[12:15], s100 offen offset:2112
    buffer_load_dword v229, v119, s[12:15], s100 offen offset:2560
    buffer_load_dword v237, v119, s[12:15], s100 offen offset:2624
    buffer_load_dword v230, v119, s[12:15], s100 offen offset:3072
    buffer_load_dword v238, v119, s[12:15], s100 offen offset:3136
    buffer_load_dword v231, v119, s[12:15], s100 offen offset:3584
    buffer_load_dword v239, v119, s[12:15], s100 offen offset:3648
    v_perm_b32 v168, v177, v176, s70
    v_perm_b32 v172, v177, v176, s71
    v_perm_b32 v169, v179, v178, s70
    v_perm_b32 v173, v179, v178, s71
    v_perm_b32 v170, v181, v180, s70
    v_perm_b32 v174, v181, v180, s71
    v_perm_b32 v171, v183, v182, s70
    v_perm_b32 v175, v183, v182, s71
    v_perm_b32 v176, v185, v184, s70
    v_perm_b32 v180, v185, v184, s71
    v_perm_b32 v177, v187, v186, s70
    v_perm_b32 v181, v187, v186, s71
    v_perm_b32 v178, v189, v188, s70
    v_perm_b32 v182, v189, v188, s71
    v_perm_b32 v179, v191, v190, s70
    v_perm_b32 v183, v191, v190, s71
    s_waitcnt vmcnt(32)
    s_add_u32 s100, s100, 16384
    buffer_load_dword v240, v119, s[12:15], s100 offen offset:0
    buffer_load_dword v248, v119, s[12:15], s100 offen offset:64
    buffer_load_dword v241, v119, s[12:15], s100 offen offset:512
    buffer_load_dword v249, v119, s[12:15], s100 offen offset:576
    buffer_load_dword v242, v119, s[12:15], s100 offen offset:1024
    buffer_load_dword v250, v119, s[12:15], s100 offen offset:1088
    buffer_load_dword v243, v119, s[12:15], s100 offen offset:1536
    buffer_load_dword v251, v119, s[12:15], s100 offen offset:1600
    buffer_load_dword v244, v119, s[12:15], s100 offen offset:2048
    buffer_load_dword v252, v119, s[12:15], s100 offen offset:2112
    buffer_load_dword v245, v119, s[12:15], s100 offen offset:2560
    buffer_load_dword v253, v119, s[12:15], s100 offen offset:2624
    buffer_load_dword v246, v119, s[12:15], s100 offen offset:3072
    buffer_load_dword v254, v119, s[12:15], s100 offen offset:3136
    buffer_load_dword v247, v119, s[12:15], s100 offen offset:3584
    buffer_load_dword v255, v119, s[12:15], s100 offen offset:3648
    v_perm_b32 v184, v193, v192, s70
    v_perm_b32 v188, v193, v192, s71
    v_perm_b32 v185, v195, v194, s70
    v_perm_b32 v189, v195, v194, s71
    v_perm_b32 v186, v197, v196, s70
    v_perm_b32 v190, v197, v196, s71
    v_perm_b32 v187, v199, v198, s70
    v_perm_b32 v191, v199, v198, s71
    v_perm_b32 v192, v201, v200, s70
    v_perm_b32 v196, v201, v200, s71
    v_perm_b32 v193, v203, v202, s70
    v_perm_b32 v197, v203, v202, s71
    v_perm_b32 v194, v205, v204, s70
    v_perm_b32 v198, v205, v204, s71
    v_perm_b32 v195, v207, v206, s70
    v_perm_b32 v199, v207, v206, s71
    s_waitcnt vmcnt(32)
    v_perm_b32 v200, v209, v208, s70
    v_perm_b32 v204, v209, v208, s71
    v_perm_b32 v201, v211, v210, s70
    v_perm_b32 v205, v211, v210, s71
    v_perm_b32 v202, v213, v212, s70
    v_perm_b32 v206, v213, v212, s71
    v_perm_b32 v203, v215, v214, s70
    v_perm_b32 v207, v215, v214, s71
    v_perm_b32 v208, v217, v216, s70
    v_perm_b32 v212, v217, v216, s71
    v_perm_b32 v209, v219, v218, s70
    v_perm_b32 v213, v219, v218, s71
    v_perm_b32 v210, v221, v220, s70
    v_perm_b32 v214, v221, v220, s71
    v_perm_b32 v211, v223, v222, s70
    v_perm_b32 v215, v223, v222, s71
    s_waitcnt vmcnt(16)
    v_perm_b32 v216, v225, v224, s70
    v_perm_b32 v220, v225, v224, s71
    v_perm_b32 v217, v227, v226, s70
    v_perm_b32 v221, v227, v226, s71
    v_perm_b32 v218, v229, v228, s70
    v_perm_b32 v222, v229, v228, s71
    v_perm_b32 v219, v231, v230, s70
    v_perm_b32 v223, v231, v230, s71
    v_perm_b32 v224, v233, v232, s70
    v_perm_b32 v228, v233, v232, s71
    v_perm_b32 v225, v235, v234, s70
    v_perm_b32 v229, v235, v234, s71
    v_perm_b32 v226, v237, v236, s70
    v_perm_b32 v230, v237, v236, s71
    v_perm_b32 v227, v239, v238, s70
    v_perm_b32 v231, v239, v238, s71
    s_waitcnt vmcnt(0)
    v_perm_b32 v232, v241, v240, s70
    v_perm_b32 v236, v241, v240, s71
    v_perm_b32 v233, v243, v242, s70
    v_perm_b32 v237, v243, v242, s71
    v_perm_b32 v234, v245, v244, s70
    v_perm_b32 v238, v245, v244, s71
    v_perm_b32 v235, v247, v246, s70
    v_perm_b32 v239, v247, v246, s71
    v_perm_b32 v240, v249, v248, s70
    v_perm_b32 v244, v249, v248, s71
    v_perm_b32 v241, v251, v250, s70
    v_perm_b32 v245, v251, v250, s71
    v_perm_b32 v242, v253, v252, s70
    v_perm_b32 v246, v253, v252, s71
    v_perm_b32 v243, v255, v254, s70
    v_perm_b32 v247, v255, v254, s71
    s_lshr_b32 s58, s3, 2
    s_lshl_b32 s58, s58, 2
    s_mov_b64 exec, 1
    v_add_u32 v5, s58, v3
    v_mov_b32 v4, 1
    ds_add_u32 v5, v4
    s_mov_b64 exec, -1
    s_cmp_eq_u32 s3, 4
    s_cbranch_scc0 L_gow
    s_and_b32 s58, s2, 7
    s_mul_i32 s58, s58, 4096
    s_add_u32 s58, s58, 1572864
    v_lshlrev_b32 v5, 8, v0
    v_cmp_gt_u32 vcc, 10, v0
    v_mov_b32 v6, 15
    s_mov_b32 s59, 0
    v_addc_co_u32 v6, vcc, 0, v6, vcc
    s_mov_b64 exec, 65535
L_poll:
    buffer_load_dword v7, v5, s[16:19], s58 offen sc1
    s_add_u32 s59, s59, 1
    s_cmp_gt_u32 s59, 0x40000
    s_cbranch_scc1 L_end
    s_waitcnt vmcnt(0)
    v_cmp_ne_u32 vcc, v7, v6
    s_cbranch_vccz L_polled
    s_sleep 2
    s_branch L_poll
L_polled:
    s_mov_b64 exec, 1
    v_mov_b32 v4, 1
    ds_add_u32 v3, v4 offset:32
    s_mov_b64 exec, -1
    s_branch L_go
L_gow:
    s_mov_b32 s59, 0
Lw_2:
    s_sleep 1
    ds_read_b32 v4, v3 offset:32
    s_add_u32 s59, s59, 1
    s_cmp_gt_u32 s59, 0x400000
    s_cbranch_scc1 L_end
    s_waitcnt lgkmcnt(0)
    v_readfirstlane_b32 s58, v4
    s_nop 0
    s_cmp_lt_u32 s58, 1
    s_cbranch_scc1 Lw_2
L_go:
    s_cmp_ge_u32 s3, 4
    s_cbranch_scc1 L_postB
    v_lshlrev_b32 v10, 4, v0
    s_lshl_b32 s60, s3, 15
    s_add_u32 s60, s60, 1048576
    buffer_load_dwordx4 v[16:19], v10, s[16:19], s60 offen offset:0 sc1
    buffer_load_dwordx4 v[20:23], v10, s[16:19], s60 offen offset:1024 sc1
    buffer_load_dwordx4 v[24:27], v10, s[16:19], s60 offen offset:2048 sc1
    buffer_load_dwordx4 v[28:31], v10, s[16:19], s60 offen offset:3072 sc1
    s_add_u32 s60, s60, 4096
    buffer_load_dwordx4 v[32:35], v10, s[16:19], s60 offen offset:0 sc1
    buffer_load_dwordx4 v[36:39], v10, s[16:19], s60 offen offset:1024 sc1
    buffer_load_dwordx4 v[40:43], v10, s[16:19], s60 offen offset:2048 sc1
    buffer_load_dwordx4 v[44:47], v10, s[16:19], s60 offen offset:3072 sc1
    s_add_u32 s60, s60, 4096
    buffer_load_dwordx4 v[48:51], v10, s[16:19], s60 offen offset:0 sc1
    buffer_load_dwordx4 v[52:55], v10, s[16:19], s60 offen offset:1024 sc1
    buffer_load_dwordx4 v[56:59], v10, s[16:19], s60 offen offset:2048 sc1
    buffer_load_dwordx4 v[60:63], v10, s[16:19], s60 offen offset:3072 sc1
    s_add_u32 s60, s60, 4096
    buffer_load_dwordx4 v[64:67], v10, s[16:19], s60 offen offset:0 sc1
    buffer_load_dwordx4 v[68:71], v10, s[16:19], s60 offen offset:1024 sc1
    buffer_load_dwordx4 v[72:75], v10, s[16:19], s60 offen offset:2048 sc1
    buffer_load_dwordx4 v[76:79], v10, s[16:19], s60 offen offset:3072 sc1
    v_add_u32 v8, 84480, v1
    s_lshl_b32 s61, s3, 7
    s_add_u32 s61, s61, 105600
    v_add_u32 v9, s61, v1
    s_mov_b32 s59, 0
Lw_3:
    ds_read_b32 v4, v3 offset:0
    s_add_u32 s59, s59, 1
    s_cmp_gt_u32 s59, 0x400000
    s_cbranch_scc1 L_end
    s_waitcnt lgkmcnt(0)
    v_readfirstlane_b32 s58, v4
    s_nop 0
    s_cmp_lt_u32 s58, 4
    s_cbranch_scc1 Lw_3
    ds_read_b128 v[80:83], v8 offset:0
    ds_read_b128 v[84:87], v8 offset:8448
    ds_read_b128 v[88:91], v8 offset:16896
    ds_read_b128 v[92:95], v8 offset:64
    ds_read_b128 v[96:99], v8 offset:8512
    ds_read_b128 v[100:103], v8 offset:16960
    s_waitcnt vmcnt(14) lgkmcnt(3)
    v_mfma_f32_16x16x32_bf16 v[104:107], v[16:19], v[80:83], 0
    v_mfma_f32_16x16x32_bf16 v[108:111], v[20:23], v[80:83], 0
    v_mfma_f32_16x16x32_bf16 v[112:115], v[16:19], v[84:87], 0
    v_mfma_f32_16x16x32_bf16 v[116:119], v[20:23], v[84:87], 0
    v_mfma_f32_16x16x32_bf16 v[248:251], v[16:19], v[88:91], 0
    v_mfma_f32_16x16x32_bf16 v[252:255], v[20:23], v[88:91], 0
    s_add_u32 s60, s60, 4096
    buffer_load_dwordx4 v[16:19], v10, s[16:19], s60 offen offset:0 sc1
    buffer_load_dwordx4 v[20:23], v10, s[16:19], s60 offen offset:1024 sc1
    ds_read_b128 v[80:83], v8 offset:128
    ds_read_b128 v[84:87], v8 offset:8576
    ds_read_b128 v[88:91], v8 offset:17024
    s_waitcnt vmcnt(14) lgkmcnt(3)
    v_mfma_f32_16x16x32_bf16 v[104:107], v[24:27], v[92:95], v[104:107]
    v_mfma_f32_16x16x32_bf16 v[108:111], v[28:31], v[92:95], v[108:111]
    v_mfma_f32_16x16x32_bf16 v[112:115], v[24:27], v[96:99], v[112:115]
    v_mfma_f32_16x16x32_bf16 v[116:119], v[28:31], v[96:99], v[116:119]
    v_mfma_f32_16x16x32_bf16 v[248:251], v[24:27], v[100:103], v[248:251]
    v_mfma_f32_16x16x32_bf16 v[252:255], v[28:31], v[100:103], v[252:255]
    buffer_load_dwordx4 v[24:27], v10, s[16:19], s60 offen offset:2048 sc1
    buffer_load_dwordx4 v[28:31], v10, s[16:19], s60 offen offset:3072 sc1
    ds_read_b128 v[92:95], v8 offset:192
    ds_read_b128 v[96:99], v8 offset:8640
    ds_read_b128 v[100:103], v8 offset:17088
    s_waitcnt vmcnt(14) lgkmcnt(3)
    v_mfma_f32_16x16x32_bf16 v[104:107], v[32:35], v[80:83], v[104:107]
    v_mfma_f32_16x16x32_bf16 v[108:111], v[36:39], v[80:83], v[108:111]
    v_mfma_f32_16x16x32_bf16 v[112:115], v[32:35], v[84:87], v[112:115]
    v_mfma_f32_16x16x32_bf16 v[116:119], v[36:39], v[84:87], v[116:119]
    v_mfma_f32_16x16x32_bf16 v[248:251], v[32:35], v[88:91], v[248:251]
    v_mfma_f32_16x16x32_bf16 v[252:255], v[36:39], v[88:91], v[252:255]
    s_add_u32 s60, s60, 4096
    buffer_load_dwordx4 v[32:35], v10, s[16:19], s60 offen offset:0 sc1
    buffer_load_dwordx4 v[36:39], v10, s[16:19], s60 offen offset:1024 sc1
    ds_read_b128 v[80:83], v8 offset:256
    ds_read_b128 v[84:87], v8 offset:8704
    ds_read_b128 v[88:91], v8 offset:17152
    s_waitcnt vmcnt(14) lgkmcnt(3)
    v_mfma_f32_16x16x32_bf16 v[104:107], v[40:43], v[92:95], v[104:107]
    v_mfma_f32_16x16x32_bf16 v[108:111], v[44:47], v[92:95], v[108:111]
    v_mfma_f32_16x16x32_bf16 v[112:115], v[40:43], v[96:99], v[112:115]
    v_mfma_f32_16x16x32_bf16 v[116:119], v[44:47], v[96:99], v[116:119]
    v_mfma_f32_16x16x32_bf16 v[248:251], v[40:43], v[100:103], v[248:251]
    v_mfma_f32_16x16x32_bf16 v[252:255], v[44:47], v[100:103], v[252:255]
    buffer_load_dwordx4 v[40:43], v10, s[16:19], s60 offen offset:2048 sc1
    buffer_load_dwordx4 v[44:47], v10, s[16:19], s60 offen offset:3072 sc1
    ds_read_b128 v[92:95], v8 offset:320
    ds_read_b128 v[96:99], v8 offset:8768
    ds_read_b128 v[100:103], v8 offset:17216
    s_waitcnt vmcnt(14) lgkmcnt(3)
    v_mfma_f32_16x16x32_bf16 v[104:107], v[48:51], v[80:83], v[104:107]
    v_mfma_f32_16x16x32_bf16 v[108:111], v[52:55], v[80:83], v[108:111]
    v_mfma_f32_16x16x32_bf16 v[112:115], v[48:51], v[84:87], v[112:115]
    v_mfma_f32_16x16x32_bf16 v[116:119], v[52:55], v[84:87], v[116:119]
    v_mfma_f32_16x16x32_bf16 v[248:251], v[48:51], v[88:91], v[248:251]
    v_mfma_f32_16x16x32_bf16 v[252:255], v[52:55], v[88:91], v[252:255]
    s_add_u32 s60, s60, 4096
    buffer_load_dwordx4 v[48:51], v10, s[16:19], s60 offen offset:0 sc1
    buffer_load_dwordx4 v[52:55], v10, s[16:19], s60 offen offset:1024 sc1
    ds_read_b128 v[80:83], v8 offset:384
    ds_read_b128 v[84:87], v8 offset:8832
    ds_read_b128 v[88:91], v8 offset:17280
    s_waitcnt vmcnt(14) lgkmcnt(3)
    v_mfma_f32_16x16x32_bf16 v[104:107], v[56:59], v[92:95], v[104:107]
    v_mfma_f32_16x16x32_bf16 v[108:111], v[60:63], v[92:95], v[108:111]
    v_mfma_f32_16x16x32_bf16 v[112:115], v[56:59], v[96:99], v[112:115]
    v_mfma_f32_16x16x32_bf16 v[116:119], v[60:63], v[96:99], v[116:119]
    v_mfma_f32_16x16x32_bf16 v[248:251], v[56:59], v[100:103], v[248:251]
    v_mfma_f32_16x16x32_bf16 v[252:255], v[60:63], v[100:103], v[252:255]
    buffer_load_dwordx4 v[56:59], v10, s[16:19], s60 offen offset:2048 sc1
    buffer_load_dwordx4 v[60:63], v10, s[16:19], s60 offen offset:3072 sc1
    ds_read_b128 v[92:95], v8 offset:448
    ds_read_b128 v[96:99], v8 offset:8896
    ds_read_b128 v[100:103], v8 offset:17344
    s_waitcnt vmcnt(14) lgkmcnt(3)
    v_mfma_f32_16x16x32_bf16 v[104:107], v[64:67], v[80:83], v[104:107]
    v_mfma_f32_16x16x32_bf16 v[108:111], v[68:71], v[80:83], v[108:111]
    v_mfma_f32_16x16x32_bf16 v[112:115], v[64:67], v[84:87], v[112:115]
    v_mfma_f32_16x16x32_bf16 v[116:119], v[68:71], v[84:87], v[116:119]
    v_mfma_f32_16x16x32_bf16 v[248:251], v[64:67], v[88:91], v[248:251]
    v_mfma_f32_16x16x32_bf16 v[252:255], v[68:71], v[88:91], v[252:255]
    s_add_u32 s60, s60, 4096
    buffer_load_dwordx4 v[64:67], v10, s[16:19], s60 offen offset:0 sc1
    buffer_load_dwordx4 v[68:71], v10, s[16:19], s60 offen offset:1024 sc1
    ds_read_b128 v[80:83], v8 offset:0
    ds_read_b128 v[84:87], v8 offset:8448
    ds_read_b128 v[88:91], v8 offset:16896
    s_waitcnt vmcnt(14) lgkmcnt(3)
    v_mfma_f32_16x16x32_bf16 v[104:107], v[72:75], v[92:95], v[104:107]
    v_mfma_f32_16x16x32_bf16 v[108:111], v[76:79], v[92:95], v[108:111]
    v_mfma_f32_16x16x32_bf16 v[112:115], v[72:75], v[96:99], v[112:115]
    v_mfma_f32_16x16x32_bf16 v[116:119], v[76:79], v[96:99], v[116:119]
    v_mfma_f32_16x16x32_bf16 v[248:251], v[72:75], v[100:103], v[248:251]
    v_mfma_f32_16x16x32_bf16 v[252:255], v[76:79], v[100:103], v[252:255]
    buffer_load_dwordx4 v[72:75], v10, s[16:19], s60 offen offset:2048 sc1
    buffer_load_dwordx4 v[76:79], v10, s[16:19], s60 offen offset:3072 sc1
    s_nop 3
    v_cvt_pk_bf16_f32 v12, v104, v105
    v_cvt_pk_bf16_f32 v13, v106, v107
    v_cvt_pk_bf16_f32 v14, v108, v109
    v_cvt_pk_bf16_f32 v15, v110, v111
    ds_write_b128 v9, v[12:15] offset:0
    v_cvt_pk_bf16_f32 v12, v112, v113
    v_cvt_pk_bf16_f32 v13, v114, v115
    v_cvt_pk_bf16_f32 v14, v116, v117
    v_cvt_pk_bf16_f32 v15, v118, v119
    ds_write_b128 v9, v[12:15] offset:8448
    v_cvt_pk_bf16_f32 v12, v248, v249
    v_cvt_pk_bf16_f32 v13, v250, v251
    v_cvt_pk_bf16_f32 v14, v252, v253
    v_cvt_pk_bf16_f32 v15, v254, v255
    ds_write_b128 v9, v[12:15] offset:16896
    ds_read_b128 v[92:95], v8 offset:64
    ds_read_b128 v[96:99], v8 offset:8512
    ds_read_b128 v[100:103], v8 offset:16960
    s_waitcnt vmcnt(14) lgkmcnt(3)
    v_mfma_f32_16x16x32_bf16 v[104:107], v[16:19], v[80:83], 0
    v_mfma_f32_16x16x32_bf16 v[108:111], v[20:23], v[80:83], 0
    v_mfma_f32_16x16x32_bf16 v[112:115], v[16:19], v[84:87], 0
    v_mfma_f32_16x16x32_bf16 v[116:119], v[20:23], v[84:87], 0
    v_mfma_f32_16x16x32_bf16 v[248:251], v[16:19], v[88:91], 0
    v_mfma_f32_16x16x32_bf16 v[252:255], v[20:23], v[88:91], 0
    ds_read_b128 v[80:83], v8 offset:128
    ds_read_b128 v[84:87], v8 offset:8576
    ds_read_b128 v[88:91], v8 offset:17024
    s_waitcnt vmcnt(12) lgkmcnt(3)
    v_mfma_f32_16x16x32_bf16 v[104:107], v[24:27], v[92:95], v[104:107]
    v_mfma_f32_16x16x32_bf16 v[108:111], v[28:31], v[92:95], v[108:111]
    v_mfma_f32_16x16x32_bf16 v[112:115], v[24:27], v[96:99], v[112:115]
    v_mfma_f32_16x16x32_bf16 v[116:119], v[28:31], v[96:99], v[116:119]
    v_mfma_f32_16x16x32_bf16 v[248:251], v[24:27], v[100:103], v[248:251]
    v_mfma_f32_16x16x32_bf16 v[252:255], v[28:31], v[100:103], v[252:255]
    ds_read_b128 v[92:95], v8 offset:192
    ds_read_b128 v[96:99], v8 offset:8640
    ds_read_b128 v[100:103], v8 offset:17088
    s_waitcnt vmcnt(10) lgkmcnt(3)
    v_mfma_f32_16x16x32_bf16 v[104:107], v[32:35], v[80:83], v[104:107]
    v_mfma_f32_16x16x32_bf16 v[108:111], v[36:39], v[80:83], v[108:111]
    v_mfma_f32_16x16x32_bf16 v[112:115], v[32:35], v[84:87], v[112:115]
    v_mfma_f32_16x16x32_bf16 v[116:119], v[36:39], v[84:87], v[116:119]
    v_mfma_f32_16x16x32_bf16 v[248:251], v[32:35], v[88:91], v[248:251]
    v_mfma_f32_16x16x32_bf16 v[252:255], v[36:39], v[88:91], v[252:255]
    ds_read_b128 v[80:83], v8 offset:256
    ds_read_b128 v[84:87], v8 offset:8704
    ds_read_b128 v[88:91], v8 offset:17152
    s_waitcnt vmcnt(8) lgkmcnt(3)
    v_mfma_f32_16x16x32_bf16 v[104:107], v[40:43], v[92:95], v[104:107]
    v_mfma_f32_16x16x32_bf16 v[108:111], v[44:47], v[92:95], v[108:111]
    v_mfma_f32_16x16x32_bf16 v[112:115], v[40:43], v[96:99], v[112:115]
    v_mfma_f32_16x16x32_bf16 v[116:119], v[44:47], v[96:99], v[116:119]
    v_mfma_f32_16x16x32_bf16 v[248:251], v[40:43], v[100:103], v[248:251]
    v_mfma_f32_16x16x32_bf16 v[252:255], v[44:47], v[100:103], v[252:255]
    ds_read_b128 v[92:95], v8 offset:320
    ds_read_b128 v[96:99], v8 offset:8768
    ds_read_b128 v[100:103], v8 offset:17216
    s_waitcnt vmcnt(6) lgkmcnt(3)
    v_mfma_f32_16x16x32_bf16 v[104:107], v[48:51], v[80:83], v[104:107]
    v_mfma_f32_16x16x32_bf16 v[108:111], v[52:55], v[80:83], v[108:111]
    v_mfma_f32_16x16x32_bf16 v[112:115], v[48:51], v[84:87], v[112:115]
    v_mfma_f32_16x16x32_bf16 v[116:119], v[52:55], v[84:87], v[116:119]
    v_mfma_f32_16x16x32_bf16 v[248:251], v[48:51], v[88:91], v[248:251]
    v_mfma_f32_16x16x32_bf16 v[252:255], v[52:55], v[88:91], v[252:255]
    ds_read_b128 v[80:83], v8 offset:384
    ds_read_b128 v[84:87], v8 offset:8832
    ds_read_b128 v[88:91], v8 offset:17280
    s_waitcnt vmcnt(4) lgkmcnt(3)
    v_mfma_f32_16x16x32_bf16 v[104:107], v[56:59], v[92:95], v[104:107]
    v_mfma_f32_16x16x32_bf16 v[108:111], v[60:63], v[92:95], v[108:111]
    v_mfma_f32_16x16x32_bf16 v[112:115], v[56:59], v[96:99], v[112:115]
    v_mfma_f32_16x16x32_bf16 v[116:119], v[60:63], v[96:99], v[116:119]
    v_mfma_f32_16x16x32_bf16 v[248:251], v[56:59], v[100:103], v[248:251]
    v_mfma_f32_16x16x32_bf16 v[252:255], v[60:63], v[100:103], v[252:255]
    ds_read_b128 v[92:95], v8 offset:448
    ds_read_b128 v[96:99], v8 offset:8896
    ds_read_b128 v[100:103], v8 offset:17344
    s_waitcnt vmcnt(2) lgkmcnt(3)
    v_mfma_f32_16x16x32_bf16 v[104:107], v[64:67], v[80:83], v[104:107]
    v_mfma_f32_16x16x32_bf16 v[108:111], v[68:71], v[80:83], v[108:111]
    v_mfma_f32_16x16x32_bf16 v[112:115], v[64:67], v[84:87], v[112:115]
    v_mfma_f32_16x16x32_bf16 v[116:119], v[68:71], v[84:87], v[116:119]
    v_mfma_f32_16x16x32_bf16 v[248:251], v[64:67], v[88:91], v[248:251]
    v_mfma_f32_16x16x32_bf16 v[252:255], v[68:71], v[88:91], v[252:255]
    s_waitcnt vmcnt(0) lgkmcnt(0)
    v_mfma_f32_16x16x32_bf16 v[104:107], v[72:75], v[92:95], v[104:107]
    v_mfma_f32_16x16x32_bf16 v[108:111], v[76:79], v[92:95], v[108:111]
    v_mfma_f32_16x16x32_bf16 v[112:115], v[72:75], v[96:99], v[112:115]
    v_mfma_f32_16x16x32_bf16 v[116:119], v[76:79], v[96:99], v[116:119]
    v_mfma_f32_16x16x32_bf16 v[248:251], v[72:75], v[100:103], v[248:251]
    v_mfma_f32_16x16x32_bf16 v[252:255], v[76:79], v[100:103], v[252:255]
    s_nop 3
    v_cvt_pk_bf16_f32 v12, v104, v105
    v_cvt_pk_bf16_f32 v13, v106, v107
    v_cvt_pk_bf16_f32 v14, v108, v109
    v_cvt_pk_bf16_f32 v15, v110, v111
    ds_write_b128 v9, v[12:15] offset:64
    v_cvt_pk_bf16_f32 v12, v112, v113
    v_cvt_pk_bf16_f32 v13, v114, v115
    v_cvt_pk_bf16_f32 v14, v116, v117
    v_cvt_pk_bf16_f32 v15, v118, v119
    ds_write_b128 v9, v[12:15] offset:8512
    v_cvt_pk_bf16_f32 v12, v248, v249
    v_cvt_pk_bf16_f32 v13, v250, v251
    v_cvt_pk_bf16_f32 v14, v252, v253
    v_cvt_pk_bf16_f32 v15, v254, v255
    ds_write_b128 v9, v[12:15] offset:16960
    s_mov_b64 exec, 1
    v_mov_b32 v4, 1
    ds_add_u32 v3, v4 offset:20
    s_mov_b64 exec, -1
    v_and_b32 v4, 3, v0
    v_mov_b32 v5, 0x0c0c0c0c
    v_mov_b32 v6, 0x0c0c0302
    v_mov_b32 v7, 0x03020c0c
    v_cmp_eq_u32 s[58:59], 0, v4
    v_cmp_eq_u32 s[60:61], 2, v4
    v_cmp_eq_u32 vcc, 1, v4
    v_cndmask_b32 v10, v5, v6, s[58:59]
    v_cndmask_b32 v11, v5, v6, s[60:61]
    v_cndmask_b32 v10, v10, v7, vcc
    v_cmp_eq_u32 vcc, 3, v4
    s_nop 1
    v_cndmask_b32 v11, v11, v7, vcc
    v_and_b32 v8, 0xfdfdfdfd, v10
    v_and_b32 v9, 0xfdfdfdfd, v11
    s_mov_b32 s63, s3
    s_mov_b32 s59, 0
Lw_4:
    ds_read_b32 v4, v3 offset:20
    s_add_u32 s59, s59, 1
    s_cmp_gt_u32 s59, 0x400000
    s_cbranch_scc1 L_end
    s_waitcnt lgkmcnt(0)
    v_readfirstlane_b32 s58, v4
    s_nop 0
    s_cmp_lt_u32 s58, 4
    s_cbranch_scc1 Lw_4
L_grp:
    s_mul_i32 s58, s63, 8448
    s_lshr_b32 s59, s63, 2
    s_mul_i32 s59, s59, 8448
    s_and_b32 s60, s63, 1
    s_bfe_u32 s61, s63, 0x10001
    s_cmp_ge_u32 s63, 8
    s_cselect_b32 s61, s60, s61
    s_cselect_b32 s60, 0, s60
    s_mul_i32 s60, s60, 4224
    s_lshl_b32 s61, s61, 9
    s_add_u32 s59, s59, s60
    s_add_u32 s59, s59, s61
    s_add_u32 s59, s59, 105600
    v_add_u32 v12, s58, v1
    v_bfe_u32 v4, v0, 2, 2
    v_mul_u32_u24 v4, 1056, v4
    v_and_b32 v5, 48, v0
    v_add3_u32 v13, v4, v5, s59
    v_lshl_add_u32 v14, v0, 3, s58
    v_lshl_add_u32 v15, v0, 3, s59
    ds_read_b128 v[16:19], v12 offset:0
    ds_read_b128 v[48:51], v13 offset:0
    ds_read_b128 v[20:23], v12 offset:64
    ds_read_b128 v[52:55], v13 offset:64
    ds_read_b128 v[24:27], v12 offset:128
    ds_read_b128 v[56:59], v13 offset:128
    ds_read_b128 v[28:31], v12 offset:192
    ds_read_b128 v[60:63], v13 offset:192
    s_waitcnt lgkmcnt(7)
    ds_read_b128 v[32:35], v12 offset:256
    ds_read_b128 v[64:67], v13 offset:256
    ds_read_b128 v[36:39], v12 offset:320
    ds_read_b128 v[68:71], v13 offset:320
    ds_read_b128 v[40:43], v12 offset:384
    ds_read_b128 v[72:75], v13 offset:384
    ds_read_b128 v[44:47], v12 offset:448
    ds_read_b128 v[76:79], v13 offset:448
    s_waitcnt lgkmcnt(14)
    v_mfma_f32_16x16x32_bf16 v[104:107], v[16:19], v[48:51], 0
    s_waitcnt lgkmcnt(12)
    v_mfma_f32_16x16x32_bf16 v[104:107], v[20:23], v[52:55], v[104:107]
    s_waitcnt lgkmcnt(10)
    v_mfma_f32_16x16x32_bf16 v[104:107], v[24:27], v[56:59], v[104:107]
    s_waitcnt lgkmcnt(8)
    v_mfma_f32_16x16x32_bf16 v[104:107], v[28:31], v[60:63], v[104:107]
    s_waitcnt lgkmcnt(6)
    v_mfma_f32_16x16x32_bf16 v[104:107], v[32:35], v[64:67], v[104:107]
    s_waitcnt lgkmcnt(4)
    v_mfma_f32_16x16x32_bf16 v[104:107], v[36:39], v[68:71], v[104:107]
    s_waitcnt lgkmcnt(2)
    v_mfma_f32_16x16x32_bf16 v[104:107], v[40:43], v[72:75], v[104:107]
    s_waitcnt lgkmcnt(0)
    v_mfma_f32_16x16x32_bf16 v[104:107], v[44:47], v[76:79], v[104:107]
    ds_read_b64 v[16:17], v14 offset:0
    ds_read_b64 v[18:19], v14 offset:4224
    ds_read_b64 v[20:21], v14 offset:512
    ds_read_b64 v[22:23], v14 offset:4736
    ds_read_b64 v[24:25], v14 offset:1056
    ds_read_b64 v[26:27], v14 offset:5280
    ds_read_b64 v[28:29], v14 offset:1568
    ds_read_b64 v[30:31], v14 offset:5792
    ds_read_b64 v[32:33], v14 offset:2112
    ds_read_b64 v[34:35], v14 offset:6336
    ds_read_b64 v[36:37], v14 offset:2624
    ds_read_b64 v[38:39], v14 offset:6848
    ds_read_b64 v[40:41], v14 offset:3168
    ds_read_b64 v[42:43], v14 offset:7392
    ds_read_b64 v[44:45], v14 offset:3680
    s_waitcnt lgkmcnt(14)
    ds_read_b64 v[46:47], v14 offset:7904
    v_mul_f32 v104, 0x3db8aa3b, v104
    v_mul_f32 v105, 0x3db8aa3b, v105
    v_mul_f32 v106, 0x3db8aa3b, v106
    v_mul_f32 v107, 0x3db8aa3b, v107
    v_exp_f32 v104, v104
    v_exp_f32 v105, v105
    v_exp_f32 v106, v106
    v_exp_f32 v107, v107
    v_add_f32 v108, v104, v105
    v_add_f32 v109, v106, v107
    v_add_f32 v108, v108, v109
    v_add_f32 v108, 0x3089705f, v108
    v_rcp_f32 v108, v108
    s_nop 0
    v_mul_f32 v104, v104, v108
    v_mul_f32 v105, v105, v108
    v_mul_f32 v106, v106, v108
    v_mul_f32 v107, v107, v108
    v_cvt_pk_bf16_f32 v104, v104, v105
    v_cvt_pk_bf16_f32 v106, v106, v107
    v_perm_b32 v80, v104, v104, v8
    v_perm_b32 v81, v104, v104, v9
    v_perm_b32 v82, v104, v104, v10
    v_perm_b32 v83, v104, v104, v11
    v_perm_b32 v84, v106, v106, v8
    v_perm_b32 v85, v106, v106, v9
    v_perm_b32 v86, v106, v106, v10
    v_perm_b32 v87, v106, v106, v11
    s_waitcnt lgkmcnt(0)
    v_mfma_f32_4x4x4_16b_bf16 v[88:91], v[80:81], v[16:17], 0 cbsz:4 abid:0
    v_mfma_f32_4x4x4_16b_bf16 v[92:95], v[80:81], v[18:19], 0 cbsz:4 abid:5
    v_mfma_f32_4x4x4_16b_bf16 v[96:99], v[80:81], v[20:21], 0 cbsz:4 abid:10
    v_mfma_f32_4x4x4_16b_bf16 v[100:103], v[80:81], v[22:23], 0 cbsz:4 abid:15
    v_mfma_f32_4x4x4_16b_bf16 v[88:91], v[82:83], v[24:25], v[88:91] cbsz:4 abid:0
    v_mfma_f32_4x4x4_16b_bf16 v[92:95], v[82:83], v[26:27], v[92:95] cbsz:4 abid:5
    v_mfma_f32_4x4x4_16b_bf16 v[96:99], v[82:83], v[28:29], v[96:99] cbsz:4 abid:10
    v_mfma_f32_4x4x4_16b_bf16 v[100:103], v[82:83], v[30:31], v[100:103] cbsz:4 abid:15
    v_mfma_f32_4x4x4_16b_bf16 v[88:91], v[84:85], v[32:33], v[88:91] cbsz:4 abid:0
    v_mfma_f32_4x4x4_16b_bf16 v[92:95], v[84:85], v[34:35], v[92:95] cbsz:4 abid:5
    v_mfma_f32_4x4x4_16b_bf16 v[96:99], v[84:85], v[36:37], v[96:99] cbsz:4 abid:10
    v_mfma_f32_4x4x4_16b_bf16 v[100:103], v[84:85], v[38:39], v[100:103] cbsz:4 abid:15
    v_mfma_f32_4x4x4_16b_bf16 v[88:91], v[86:87], v[40:41], v[88:91] cbsz:4 abid:0
    v_mfma_f32_4x4x4_16b_bf16 v[92:95], v[86:87], v[42:43], v[92:95] cbsz:4 abid:5
    v_mfma_f32_4x4x4_16b_bf16 v[96:99], v[86:87], v[44:45], v[96:99] cbsz:4 abid:10
    v_mfma_f32_4x4x4_16b_bf16 v[100:103], v[86:87], v[46:47], v[100:103] cbsz:4 abid:15
    s_add_u32 s63, s63, 4
    s_nop 1
    v_cvt_pk_bf16_f32 v80, v88, v89
    v_cvt_pk_bf16_f32 v81, v90, v91
    ds_write_b64 v15, v[80:81] offset:0
    v_cvt_pk_bf16_f32 v82, v92, v93
    v_cvt_pk_bf16_f32 v83, v94, v95
    ds_write_b64 v15, v[82:83] offset:1056
    v_cvt_pk_bf16_f32 v84, v96, v97
    v_cvt_pk_bf16_f32 v85, v98, v99
    ds_write_b64 v15, v[84:85] offset:2112
    v_cvt_pk_bf16_f32 v86, v100, v101
    v_cvt_pk_bf16_f32 v87, v102, v103
    ds_write_b64 v15, v[86:87] offset:3168
    s_cmp_lt_u32 s63, 10
    s_cbranch_scc1 L_grp
    s_mov_b64 exec, 1
    v_mov_b32 v4, 1
    ds_add_u32 v3, v4 offset:24
    s_mov_b64 exec, -1
    v_add_u32 v8, 105600, v1
    s_mul_i32 s60, s4, 12288
    v_lshl_add_u32 v9, v0, 4, s60
    s_mov_b32 s63, 0
    s_mov_b32 s59, 0
Lw_5:
    ds_read_b32 v4, v3 offset:24
    s_add_u32 s59, s59, 1
    s_cmp_gt_u32 s59, 0x400000
    s_cbranch_scc1 L_end
    s_waitcnt lgkmcnt(0)
    v_readfirstlane_b32 s58, v4
    s_nop 0
    s_cmp_lt_u32 s58, 4
    s_cbranch_scc1 Lw_5
L_wvt:
    ds_read_b128 v[16:19], v8 offset:0
    ds_read_b128 v[20:23], v8 offset:64
    ds_read_b128 v[24:27], v8 offset:128
    ds_read_b128 v[28:31], v8 offset:192
    ds_read_b128 v[32:35], v8 offset:256
    ds_read_b128 v[36:39], v8 offset:320
    ds_read_b128 v[40:43], v8 offset:384
    ds_read_b128 v[44:47], v8 offset:448
    s_waitcnt lgkmcnt(7)
    v_mfma_f32_16x16x32_bf16 v[48:51], v[16:19], v[120:123], 0
    v_mfma_f32_16x16x32_bf16 v[52:55], v[16:19], v[124:127], 0
    v_mfma_f32_16x16x32_bf16 v[56:59], v[16:19], v[128:131], 0
    v_mfma_f32_16x16x32_bf16 v[60:63], v[16:19], v[132:135], 0
    s_waitcnt lgkmcnt(6)
    v_mfma_f32_16x16x32_bf16 v[48:51], v[20:23], v[136:139], v[48:51]
    v_mfma_f32_16x16x32_bf16 v[52:55], v[20:23], v[140:143], v[52:55]
    v_mfma_f32_16x16x32_bf16 v[56:59], v[20:23], v[144:147], v[56:59]
    v_mfma_f32_16x16x32_bf16 v[60:63], v[20:23], v[148:151], v[60:63]
    s_waitcnt lgkmcnt(5)
    v_mfma_f32_16x16x32_bf16 v[48:51], v[24:27], v[152:155], v[48:51]
    v_mfma_f32_16x16x32_bf16 v[52:55], v[24:27], v[156:159], v[52:55]
    v_mfma_f32_16x16x32_bf16 v[56:59], v[24:27], v[160:163], v[56:59]
    v_mfma_f32_16x16x32_bf16 v[60:63], v[24:27], v[164:167], v[60:63]
    s_waitcnt lgkmcnt(4)
    v_mfma_f32_16x16x32_bf16 v[48:51], v[28:31], v[168:171], v[48:51]
    v_mfma_f32_16x16x32_bf16 v[52:55], v[28:31], v[172:175], v[52:55]
    v_mfma_f32_16x16x32_bf16 v[56:59], v[28:31], v[176:179], v[56:59]
    v_mfma_f32_16x16x32_bf16 v[60:63], v[28:31], v[180:183], v[60:63]
    s_waitcnt lgkmcnt(3)
    v_mfma_f32_16x16x32_bf16 v[48:51], v[32:35], v[184:187], v[48:51]
    v_mfma_f32_16x16x32_bf16 v[52:55], v[32:35], v[188:191], v[52:55]
    v_mfma_f32_16x16x32_bf16 v[56:59], v[32:35], v[192:195], v[56:59]
    v_mfma_f32_16x16x32_bf16 v[60:63], v[32:35], v[196:199], v[60:63]
    s_waitcnt lgkmcnt(2)
    v_mfma_f32_16x16x32_bf16 v[48:51], v[36:39], v[200:203], v[48:51]
    v_mfma_f32_16x16x32_bf16 v[52:55], v[36:39], v[204:207], v[52:55]
    v_mfma_f32_16x16x32_bf16 v[56:59], v[36:39], v[208:211], v[56:59]
    v_mfma_f32_16x16x32_bf16 v[60:63], v[36:39], v[212:215], v[60:63]
    s_waitcnt lgkmcnt(1)
    v_mfma_f32_16x16x32_bf16 v[48:51], v[40:43], v[216:219], v[48:51]
    v_mfma_f32_16x16x32_bf16 v[52:55], v[40:43], v[220:223], v[52:55]
    v_mfma_f32_16x16x32_bf16 v[56:59], v[40:43], v[224:227], v[56:59]
    v_mfma_f32_16x16x32_bf16 v[60:63], v[40:43], v[228:231], v[60:63]
    s_waitcnt lgkmcnt(0)
    v_mfma_f32_16x16x32_bf16 v[48:51], v[44:47], v[232:235], v[48:51]
    v_mfma_f32_16x16x32_bf16 v[52:55], v[44:47], v[236:239], v[52:55]
    v_mfma_f32_16x16x32_bf16 v[56:59], v[44:47], v[240:243], v[56:59]
    v_mfma_f32_16x16x32_bf16 v[60:63], v[44:47], v[244:247], v[60:63]
    v_add_u32 v8, 8448, v8
    s_add_u32 s63, s63, 1
    s_nop 2
    ds_write_b128 v9, v[48:51] offset:0
    ds_write_b128 v9, v[52:55] offset:1024
    ds_write_b128 v9, v[56:59] offset:2048
    ds_write_b128 v9, v[60:63] offset:3072
    v_add_u32 v9, 4096, v9
    s_cmp_lt_u32 s63, 3
    s_cbranch_scc1 L_wvt
    s_waitcnt lgkmcnt(0)
    s_barrier
    s_branch L_end
L_postB:
    s_setprio 1
    s_mov_b32 s24, s56
    s_mov_b32 s25, s57
    s_mov_b32 s26, 256000
    s_mov_b32 s27, 0x20000
    s_lshl_b32 s58, s4, 6
    v_add_u32 v5, s58, v0
    v_lshlrev_b32 v6, 10, v5
    s_lshl_b32 s58, s6, 2
    buffer_load_dword v64, v6, s[24:27], s58 offen sc1
    v_mul_u32_u24 v65, 2560, v5
    s_mov_b32 s20, s52
    s_mov_b32 s21, s53
    s_mov_b32 s22, 5120000
    s_mov_b32 s23, 0x20000
    v_and_b32 v4, 3, v0
    v_mov_b32 v5, 0x0c0c0c0c
    v_mov_b32 v6, 0x0c0c0302
    v_mov_b32 v7, 0x03020c0c
    v_cmp_eq_u32 s[58:59], 0, v4
    v_cmp_eq_u32 s[60:61], 2, v4
    v_cmp_eq_u32 vcc, 1, v4
    v_cndmask_b32 v10, v5, v6, s[58:59]
    v_cndmask_b32 v11, v5, v6, s[60:61]
    v_cndmask_b32 v10, v10, v7, vcc
    v_cmp_eq_u32 vcc, 3, v4
    s_nop 1
    v_cndmask_b32 v11, v11, v7, vcc
    v_lshrrev_b32 v5, 4, v0
    v_and_b32 v6, 15, v0
    v_mad_u32_u24 v66, v5, 10, v6
    v_lshrrev_b32 v5, 4, v66
    v_mul_u32_u24 v9, 8448, v5
    v_cmp_le_u32 vcc, 32, v66
    v_and_b32 v5, 7, v66
    v_and_b32 v6, 3, v66
    v_cndmask_b32 v5, v5, v6, vcc
    v_mul_u32_u24 v5, 1056, v5
    v_bfe_u32 v6, v66, 3, 1
    v_bfe_u32 v7, v66, 2, 1
    v_cndmask_b32 v6, v6, v7, vcc
    v_lshl_add_u32 v5, v6, 9, v5
    v_mov_b32 v69, 130944
    v_add3_u32 v9, v9, v5, v69
    v_lshrrev_b32 v5, 5, v0
    v_lshl_add_u32 v15, v5, 3, v2
    v_mov_b32 v68, 4
    s_lshl_b32 s58, s5, 2
    s_sub_u32 s58, 156160, s58
    v_mov_b32 v70, s58
    s_mov_b32 s59, 0
Lw_6:
    ds_read_b32 v4, v3 offset:4
    s_add_u32 s59, s59, 1
    s_cmp_gt_u32 s59, 0x400000
    s_cbranch_scc1 L_end
    s_waitcnt lgkmcnt(0)
    v_readfirstlane_b32 s58, v4
    s_nop 0
    s_cmp_lt_u32 s58, 4
    s_cbranch_scc1 Lw_6
    v_add_u32 v5, s5, v66
    v_lshl_add_u32 v5, v5, 1, v69
    ds_read_u16 v8, v5
    s_mov_b32 s58, 262144
    s_waitcnt vmcnt(0)
    v_mad_u32_u16 v65, v64, 4, v65
    v_lshrrev_b32 v64, 16, v64
    v_cmpx_lt_u32 vcc, 0, v64
    s_cbranch_execz L_entld
    buffer_load_dwordx4 v[16:19], v65, s[16:19], s58 offen offset:0 sc1
    v_cmpx_lt_u32 vcc, 4, v64
    s_cbranch_execz L_entld
    buffer_load_dwordx4 v[20:23], v65, s[16:19], s58 offen offset:16 sc1
    v_cmpx_lt_u32 vcc, 8, v64
    s_cbranch_execz L_entld
    buffer_load_dwordx4 v[24:27], v65, s[16:19], s58 offen offset:32 sc1
    v_cmpx_lt_u32 vcc, 12, v64
    s_cbranch_execz L_entld
    buffer_load_dwordx4 v[28:31], v65, s[16:19], s58 offen offset:48 sc1
    v_cmpx_lt_u32 vcc, 16, v64
    s_cbranch_execz L_entld
    ds_write_b32 v3, v68 offset:28
L_entld:
    s_mov_b64 exec, -1
    s_waitcnt vmcnt(0)
    v_cmpx_lt_u32 vcc, 0, v64
    s_cbranch_execz L_l1
    v_mad_u32_u16 v32, v16, 4, v70 op_sel:[1,0,0,0]
    v_mad_u32_u16 v5, v16, 2, v69
    ds_add_rtn_u32 v48, v32, v68
    ds_read_u16 v72, v5
    v_cmpx_lt_u32 vcc, 1, v64
    s_cbranch_execz L_l1
    v_mad_u32_u16 v33, v17, 4, v70 op_sel:[1,0,0,0]
    v_mad_u32_u16 v5, v17, 2, v69
    ds_add_rtn_u32 v49, v33, v68
    ds_read_u16 v73, v5
    v_cmpx_lt_u32 vcc, 2, v64
    s_cbranch_execz L_l1
    v_mad_u32_u16 v34, v18, 4, v70 op_sel:[1,0,0,0]
    v_mad_u32_u16 v5, v18, 2, v69
    ds_add_rtn_u32 v50, v34, v68
    ds_read_u16 v74, v5
    v_cmpx_lt_u32 vcc, 3, v64
    s_cbranch_execz L_l1
    v_mad_u32_u16 v35, v19, 4, v70 op_sel:[1,0,0,0]
    v_mad_u32_u16 v5, v19, 2, v69
    ds_add_rtn_u32 v51, v35, v68
    ds_read_u16 v75, v5
    s_waitcnt lgkmcnt(4)
    v_cmpx_lt_u32 vcc, 4, v64
    s_cbranch_execz L_l1
    v_mad_u32_u16 v36, v20, 4, v70 op_sel:[1,0,0,0]
    v_mad_u32_u16 v5, v20, 2, v69
    ds_add_rtn_u32 v52, v36, v68
    ds_read_u16 v76, v5
    v_cmpx_lt_u32 vcc, 5, v64
    s_cbranch_execz L_l1
    v_mad_u32_u16 v37, v21, 4, v70 op_sel:[1,0,0,0]
    v_mad_u32_u16 v5, v21, 2, v69
    ds_add_rtn_u32 v53, v37, v68
    ds_read_u16 v77, v5
    v_cmpx_lt_u32 vcc, 6, v64
    s_cbranch_execz L_l1
    v_mad_u32_u16 v38, v22, 4, v70 op_sel:[1,0,0,0]
    v_mad_u32_u16 v5, v22, 2, v69
    ds_add_rtn_u32 v54, v38, v68
    ds_read_u16 v78, v5
    v_cmpx_lt_u32 vcc, 7, v64
    s_cbranch_execz L_l1
    v_mad_u32_u16 v39, v23, 4, v70 op_sel:[1,0,0,0]
    v_mad_u32_u16 v5, v23, 2, v69
    ds_add_rtn_u32 v55, v39, v68
    ds_read_u16 v79, v5
    s_waitcnt lgkmcnt(4)
    v_cmpx_lt_u32 vcc, 8, v64
    s_cbranch_execz L_l1
    v_mad_u32_u16 v40, v24, 4, v70 op_sel:[1,0,0,0]
    v_mad_u32_u16 v5, v24, 2, v69
    ds_add_rtn_u32 v56, v40, v68
    ds_read_u16 v80, v5
    v_cmpx_lt_u32 vcc, 9, v64
    s_cbranch_execz L_l1
    v_mad_u32_u16 v41, v25, 4, v70 op_sel:[1,0,0,0]
    v_mad_u32_u16 v5, v25, 2, v69
    ds_add_rtn_u32 v57, v41, v68
    ds_read_u16 v81, v5
    v_cmpx_lt_u32 vcc, 10, v64
    s_cbranch_execz L_l1
    v_mad_u32_u16 v42, v26, 4, v70 op_sel:[1,0,0,0]
    v_mad_u32_u16 v5, v26, 2, v69
    ds_add_rtn_u32 v58, v42, v68
    ds_read_u16 v82, v5
    v_cmpx_lt_u32 vcc, 11, v64
    s_cbranch_execz L_l1
    v_mad_u32_u16 v43, v27, 4, v70 op_sel:[1,0,0,0]
    v_mad_u32_u16 v5, v27, 2, v69
    ds_add_rtn_u32 v59, v43, v68
    ds_read_u16 v83, v5
    s_waitcnt lgkmcnt(4)
    v_cmpx_lt_u32 vcc, 12, v64
    s_cbranch_execz L_l1
    v_mad_u32_u16 v44, v28, 4, v70 op_sel:[1,0,0,0]
    v_mad_u32_u16 v5, v28, 2, v69
    ds_add_rtn_u32 v60, v44, v68
    ds_read_u16 v84, v5
    v_cmpx_lt_u32 vcc, 13, v64
    s_cbranch_execz L_l1
    v_mad_u32_u16 v45, v29, 4, v70 op_sel:[1,0,0,0]
    v_mad_u32_u16 v5, v29, 2, v69
    ds_add_rtn_u32 v61, v45, v68
    ds_read_u16 v85, v5
    v_cmpx_lt_u32 vcc, 14, v64
    s_cbranch_execz L_l1
    v_mad_u32_u16 v46, v30, 4, v70 op_sel:[1,0,0,0]
    v_mad_u32_u16 v5, v30, 2, v69
    ds_add_rtn_u32 v62, v46, v68
    ds_read_u16 v86, v5
    v_cmpx_lt_u32 vcc, 15, v64
    s_cbranch_execz L_l1
    v_mad_u32_u16 v47, v31, 4, v70 op_sel:[1,0,0,0]
    v_mad_u32_u16 v5, v31, 2, v69
    ds_add_rtn_u32 v63, v47, v68
    ds_read_u16 v87, v5
L_l1:
    s_mov_b64 exec, -1
    s_mov_b64 exec, 1
    v_mov_b32 v4, 1
    ds_add_u32 v3, v4 offset:12
    s_mov_b64 exec, -1
    v_lshlrev_b32 v66, 2, v66
    v_add_u32 v66, 156160, v66
    v_lshrrev_b32 v6, 4, v0
    v_mul_u32_u24 v6, 1024, v6
    v_add_u32 v6, 153088, v6
    v_and_b32 v7, 15, v0
    s_mov_b32 s59, 0
Lw_7:
    ds_read_b32 v4, v3 offset:12
    s_add_u32 s59, s59, 1
    s_cmp_gt_u32 s59, 0x400000
    s_cbranch_scc1 L_end
    s_waitcnt lgkmcnt(0)
    v_readfirstlane_b32 s58, v4
    s_nop 0
    s_cmp_lt_u32 s58, 4
    s_cbranch_scc1 Lw_7
    ds_read_b32 v12, v66
    ds_read_b32 v5, v3 offset:28
    v_cmp_gt_u32 s[60:61], 10, v7
    v_lshlrev_b32 v8, 16, v8
    s_waitcnt lgkmcnt(1)
    v_add_u32 v12, 4, v12
    v_lshrrev_b32 v12, 3, v12
    v_max_u32 v12, 1, v12
    v_cndmask_b32 v12, 0, v12, s[60:61]
    v_mov_b32 v67, v12
    s_nop 1
    v_add_u32_dpp v67, v67, v67 row_shl:1 row_mask:0xf bank_mask:0xf bound_ctrl:1
    s_nop 1
    v_add_u32_dpp v67, v67, v67 row_shl:2 row_mask:0xf bank_mask:0xf bound_ctrl:1
    s_nop 1
    v_add_u32_dpp v67, v67, v67 row_shl:4 row_mask:0xf bank_mask:0xf bound_ctrl:1
    s_nop 1
    v_add_u32_dpp v67, v67, v67 row_shl:8 row_mask:0xf bank_mask:0xf bound_ctrl:1
    s_waitcnt lgkmcnt(0)
    v_lshl_add_u32 v5, v5, 10, v67
    v_lshlrev_b32 v7, 3, v67
    v_cmp_le_u32 vcc, 128, v5
    v_sub_u32 v6, v6, v7
    v_subrev_u32 v12, 1, v12
    s_lshl_b32 s63, s4, 4
    s_cbranch_vccnz L_slow
    s_mov_b64 exec, s[60:61]
    ds_write_b32 v66, v6 offset:256
    s_mov_b64 exec, -1
    v_cmpx_lt_u32 vcc, 0, v64
    s_cbranch_execz L_l2
    ds_read_b32 v32, v32 offset:256
    v_cmpx_lt_u32 vcc, 1, v64
    s_cbranch_execz L_l2
    ds_read_b32 v33, v33 offset:256
    v_cmpx_lt_u32 vcc, 2, v64
    s_cbranch_execz L_l2
    ds_read_b32 v34, v34 offset:256
    v_cmpx_lt_u32 vcc, 3, v64
    s_cbranch_execz L_l2
    ds_read_b32 v35, v35 offset:256
    v_cmpx_lt_u32 vcc, 4, v64
    s_cbranch_execz L_l2
    ds_read_b32 v36, v36 offset:256
    v_cmpx_lt_u32 vcc, 5, v64
    s_cbranch_execz L_l2
    ds_read_b32 v37, v37 offset:256
    v_cmpx_lt_u32 vcc, 6, v64
    s_cbranch_execz L_l2
    ds_read_b32 v38, v38 offset:256
    v_cmpx_lt_u32 vcc, 7, v64
    s_cbranch_execz L_l2
    ds_read_b32 v39, v39 offset:256
    v_cmpx_lt_u32 vcc, 8, v64
    s_cbranch_execz L_l2
    ds_read_b32 v40, v40 offset:256
    v_cmpx_lt_u32 vcc, 9, v64
    s_cbranch_execz L_l2
    ds_read_b32 v41, v41 offset:256
    v_cmpx_lt_u32 vcc, 10, v64
    s_cbranch_execz L_l2
    ds_read_b32 v42, v42 offset:256
    v_cmpx_lt_u32 vcc, 11, v64
    s_cbranch_execz L_l2
    ds_read_b32 v43, v43 offset:256
    v_cmpx_lt_u32 vcc, 12, v64
    s_cbranch_execz L_l2
    ds_read_b32 v44, v44 offset:256
    s_waitcnt lgkmcnt(8)
    v_cmpx_lt_u32 vcc, 13, v64
    s_cbranch_execz L_l2
    ds_read_b32 v45, v45 offset:256
    v_cmpx_lt_u32 vcc, 14, v64
    s_cbranch_execz L_l2
    ds_read_b32 v46, v46 offset:256
    v_cmpx_lt_u32 vcc, 15, v64
    s_cbranch_execz L_l2
    ds_read_b32 v47, v47 offset:256
L_l2:
    s_mov_b64 exec, -1
    s_nop 3
    v_readlane_b32 s67, v67, s63
    s_waitcnt lgkmcnt(0)
    v_cmpx_lt_u32 vcc, 0, v64
    s_cbranch_execz L_l3
    v_add_u32 v32, v32, v48
    v_perm_b32 v16, v72, v16, s70
    ds_write_b32 v32, v16
    v_cmpx_lt_u32 vcc, 1, v64
    s_cbranch_execz L_l3
    v_add_u32 v33, v33, v49
    v_perm_b32 v17, v73, v17, s70
    ds_write_b32 v33, v17
    v_cmpx_lt_u32 vcc, 2, v64
    s_cbranch_execz L_l3
    v_add_u32 v34, v34, v50
    v_perm_b32 v18, v74, v18, s70
    ds_write_b32 v34, v18
    v_cmpx_lt_u32 vcc, 3, v64
    s_cbranch_execz L_l3
    v_add_u32 v35, v35, v51
    v_perm_b32 v19, v75, v19, s70
    ds_write_b32 v35, v19
    v_cmpx_lt_u32 vcc, 4, v64
    s_cbranch_execz L_l3
    v_add_u32 v36, v36, v52
    v_perm_b32 v20, v76, v20, s70
    ds_write_b32 v36, v20
    v_cmpx_lt_u32 vcc, 5, v64
    s_cbranch_execz L_l3
    v_add_u32 v37, v37, v53
    v_perm_b32 v21, v77, v21, s70
    ds_write_b32 v37, v21
    v_cmpx_lt_u32 vcc, 6, v64
    s_cbranch_execz L_l3
    v_add_u32 v38, v38, v54
    v_perm_b32 v22, v78, v22, s70
    ds_write_b32 v38, v22
    v_cmpx_lt_u32 vcc, 7, v64
    s_cbranch_execz L_l3
    v_add_u32 v39, v39, v55
    v_perm_b32 v23, v79, v23, s70
    ds_write_b32 v39, v23
    v_cmpx_lt_u32 vcc, 8, v64
    s_cbranch_execz L_l3
    v_add_u32 v40, v40, v56
    v_perm_b32 v24, v80, v24, s70
    ds_write_b32 v40, v24
    v_cmpx_lt_u32 vcc, 9, v64
    s_cbranch_execz L_l3
    v_add_u32 v41, v41, v57
    v_perm_b32 v25, v81, v25, s70
    ds_write_b32 v41, v25
    v_cmpx_lt_u32 vcc, 10, v64
    s_cbranch_execz L_l3
    v_add_u32 v42, v42, v58
    v_perm_b32 v26, v82, v26, s70
    ds_write_b32 v42, v26
    v_cmpx_lt_u32 vcc, 11, v64
    s_cbranch_execz L_l3
    v_add_u32 v43, v43, v59
    v_perm_b32 v27, v83, v27, s70
    ds_write_b32 v43, v27
    v_cmpx_lt_u32 vcc, 12, v64
    s_cbranch_execz L_l3
    v_add_u32 v44, v44, v60
    v_perm_b32 v28, v84, v28, s70
    ds_write_b32 v44, v28
    s_waitcnt lgkmcnt(8)
    v_cmpx_lt_u32 vcc, 13, v64
    s_cbranch_execz L_l3
    v_add_u32 v45, v45, v61
    v_perm_b32 v29, v85, v29, s70
    ds_write_b32 v45, v29
    v_cmpx_lt_u32 vcc, 14, v64
    s_cbranch_execz L_l3
    v_add_u32 v46, v46, v62
    v_perm_b32 v30, v86, v30, s70
    ds_write_b32 v46, v30
    v_cmpx_lt_u32 vcc, 15, v64
    s_cbranch_execz L_l3
    v_add_u32 v47, v47, v63
    v_perm_b32 v31, v87, v31, s70
    ds_write_b32 v47, v31
L_l3:
    s_mov_b64 exec, -1
    s_mov_b64 exec, 1
    v_mov_b32 v4, 1
    ds_add_u32 v3, v4 offset:16
    s_mov_b64 exec, -1
    s_lshr_b32 s66, s67, 4
    s_add_u32 s60, s66, 1
    s_mul_i32 s60, s60, 16
    s_sub_u32 s67, s60, s67
    s_sub_u32 s62, s67, 1
    s_add_u32 s61, s4, 1
    s_mul_i32 s61, s61, 128
    s_sub_u32 s60, s61, s60
    s_lshl_b32 s60, s60, 3
    s_add_u32 s60, s60, 152064
    v_lshrrev_b32 v5, 5, v0
    v_lshl_add_u32 v13, v5, 2, s60
    v_bfe_u32 v5, v0, 2, 3
    v_lshl_add_u32 v14, v5, 3, v13
    s_mov_b32 s64, 160320
    s_mov_b32 s65, 0
    s_sub_u32 s63, s63, 1
    s_mov_b32 s59, 0
Lw_8:
    ds_read_b32 v4, v3 offset:16
    s_add_u32 s59, s59, 1
    s_cmp_gt_u32 s59, 0x400000
    s_cbranch_scc1 L_end
    s_waitcnt lgkmcnt(0)
    v_readfirstlane_b32 s58, v4
    s_nop 0
    s_cmp_lt_u32 s58, 4
    s_cbranch_scc1 Lw_8
    s_cmp_ge_u32 s67, 8
    s_cbranch_scc1 Lpg_9
    ds_read2_b32 v[80:81], v13 offset0:0 offset1:2
    ds_read2_b32 v[82:83], v13 offset0:4 offset1:6
    ds_read2_b32 v[84:85], v13 offset0:8 offset1:10
    ds_read2_b32 v[86:87], v13 offset0:12 offset1:14
    s_waitcnt lgkmcnt(0)
    s_cmp_gt_u32 s67, 0
    s_cbranch_scc1 Lps_10
    v_mad_u32_u16 v4, v80, s7, v2
    buffer_load_dwordx4 v[16:19], v4, s[8:11], 0 offen
Lps_10:
    s_cmp_gt_u32 s67, 1
    s_cbranch_scc1 Lps_11
    v_mad_u32_u16 v4, v81, s7, v2
    buffer_load_dwordx4 v[20:23], v4, s[8:11], 0 offen
Lps_11:
    s_cmp_gt_u32 s67, 2
    s_cbranch_scc1 Lps_12
    v_mad_u32_u16 v4, v82, s7, v2
    buffer_load_dwordx4 v[24:27], v4, s[8:11], 0 offen
Lps_12:
    s_cmp_gt_u32 s67, 3
    s_cbranch_scc1 Lps_13
    v_mad_u32_u16 v4, v83, s7, v2
    buffer_load_dwordx4 v[28:31], v4, s[8:11], 0 offen
Lps_13:
    s_cmp_gt_u32 s67, 4
    s_cbranch_scc1 Lps_14
    v_mad_u32_u16 v4, v84, s7, v2
    buffer_load_dwordx4 v[32:35], v4, s[8:11], 0 offen
Lps_14:
    s_cmp_gt_u32 s67, 5
    s_cbranch_scc1 Lps_15
    v_mad_u32_u16 v4, v85, s7, v2
    buffer_load_dwordx4 v[36:39], v4, s[8:11], 0 offen
Lps_15:
    s_cmp_gt_u32 s67, 6
    s_cbranch_scc1 Lps_16
    v_mad_u32_u16 v4, v86, s7, v2
    buffer_load_dwordx4 v[40:43], v4, s[8:11], 0 offen
Lps_16:
    v_mad_u32_u16 v4, v87, s7, v2
    buffer_load_dwordx4 v[44:47], v4, s[8:11], 0 offen
Lpg_9:
    s_cmp_ge_u32 s67, 16
    s_cbranch_scc1 Lpg_17
    ds_read2_b32 v[80:81], v13 offset0:16 offset1:18
    ds_read2_b32 v[82:83], v13 offset0:20 offset1:22
    ds_read2_b32 v[84:85], v13 offset0:24 offset1:26
    ds_read2_b32 v[86:87], v13 offset0:28 offset1:30
    s_waitcnt lgkmcnt(0)
    s_cmp_gt_u32 s67, 8
    s_cbranch_scc1 Lps_18
    v_mad_u32_u16 v4, v80, s7, v2
    buffer_load_dwordx4 v[48:51], v4, s[8:11], 0 offen
Lps_18:
    s_cmp_gt_u32 s67, 9
    s_cbranch_scc1 Lps_19
    v_mad_u32_u16 v4, v81, s7, v2
    buffer_load_dwordx4 v[52:55], v4, s[8:11], 0 offen
Lps_19:
    s_cmp_gt_u32 s67, 10
    s_cbranch_scc1 Lps_20
    v_mad_u32_u16 v4, v82, s7, v2
    buffer_load_dwordx4 v[56:59], v4, s[8:11], 0 offen
Lps_20:
    s_cmp_gt_u32 s67, 11
    s_cbranch_scc1 Lps_21
    v_mad_u32_u16 v4, v83, s7, v2
    buffer_load_dwordx4 v[60:63], v4, s[8:11], 0 offen
Lps_21:
    s_cmp_gt_u32 s67, 12
    s_cbranch_scc1 Lps_22
    v_mad_u32_u16 v4, v84, s7, v2
    buffer_load_dwordx4 v[64:67], v4, s[8:11], 0 offen
Lps_22:
    s_cmp_gt_u32 s67, 13
    s_cbranch_scc1 Lps_23
    v_mad_u32_u16 v4, v85, s7, v2
    buffer_load_dwordx4 v[68:71], v4, s[8:11], 0 offen
Lps_23:
    s_cmp_gt_u32 s67, 14
    s_cbranch_scc1 Lps_24
    v_mad_u32_u16 v4, v86, s7, v2
    buffer_load_dwordx4 v[72:75], v4, s[8:11], 0 offen
Lps_24:
    v_mad_u32_u16 v4, v87, s7, v2
    buffer_load_dwordx4 v[76:79], v4, s[8:11], 0 offen
Lpg_17:
    ds_read_b32 v5, v14
    ds_read2_b32 v[80:81], v13 offset0:32 offset1:34
    ds_read2_b32 v[82:83], v13 offset0:36 offset1:38
    ds_read2_b32 v[84:85], v13 offset0:40 offset1:42
    ds_read2_b32 v[86:87], v13 offset0:44 offset1:46
    s_cmp_eq_u32 s66, 0
    s_cbranch_scc1 L_drain
L_gl:
    s_waitcnt lgkmcnt(3)
    v_perm_b32 v6, v5, v5, v10
    v_perm_b32 v7, v5, v5, v11
    ds_read_b32 v5, v14 offset:64
    s_waitcnt vmcnt(15)
    v_mfma_f32_4x4x4_16b_bf16 v[248:251], v[6:7], v[16:17], v[248:251] cbsz:3 abid:0
    v_mfma_f32_4x4x4_16b_bf16 v[252:255], v[6:7], v[18:19], v[252:255] cbsz:3 abid:0
    s_sub_u32 s62, s62, 1
    s_cbranch_scc1 Lfs_0
Lbs_0:
    v_mad_u32_u16 v4, v80, s7, v2
    buffer_load_dwordx4 v[16:19], v4, s[8:11], 0 offen
    s_waitcnt vmcnt(15)
    v_mfma_f32_4x4x4_16b_bf16 v[248:251], v[6:7], v[20:21], v[248:251] cbsz:3 abid:1
    v_mfma_f32_4x4x4_16b_bf16 v[252:255], v[6:7], v[22:23], v[252:255] cbsz:3 abid:1
    s_sub_u32 s62, s62, 1
    s_cbranch_scc1 Lfs_1
Lbs_1:
    v_mad_u32_u16 v4, v81, s7, v2
    buffer_load_dwordx4 v[20:23], v4, s[8:11], 0 offen
    ds_read2_b32 v[80:81], v13 offset0:48 offset1:50
    s_waitcnt vmcnt(15) lgkmcnt(3)
    v_mfma_f32_4x4x4_16b_bf16 v[248:251], v[6:7], v[24:25], v[248:251] cbsz:3 abid:2
    v_mfma_f32_4x4x4_16b_bf16 v[252:255], v[6:7], v[26:27], v[252:255] cbsz:3 abid:2
    s_sub_u32 s62, s62, 1
    s_cbranch_scc1 Lfs_2
Lbs_2:
    v_mad_u32_u16 v4, v82, s7, v2
    buffer_load_dwordx4 v[24:27], v4, s[8:11], 0 offen
    s_waitcnt vmcnt(15)
    v_mfma_f32_4x4x4_16b_bf16 v[248:251], v[6:7], v[28:29], v[248:251] cbsz:3 abid:3
    v_mfma_f32_4x4x4_16b_bf16 v[252:255], v[6:7], v[30:31], v[252:255] cbsz:3 abid:3
    s_sub_u32 s62, s62, 1
    s_cbranch_scc1 Lfs_3
Lbs_3:
    v_mad_u32_u16 v4, v83, s7, v2
    buffer_load_dwordx4 v[28:31], v4, s[8:11], 0 offen
    ds_read2_b32 v[82:83], v13 offset0:52 offset1:54
    s_waitcnt vmcnt(15) lgkmcnt(3)
    v_mfma_f32_4x4x4_16b_bf16 v[248:251], v[6:7], v[32:33], v[248:251] cbsz:3 abid:4
    v_mfma_f32_4x4x4_16b_bf16 v[252:255], v[6:7], v[34:35], v[252:255] cbsz:3 abid:4
    s_sub_u32 s62, s62, 1
    s_cbranch_scc1 Lfs_4
Lbs_4:
    v_mad_u32_u16 v4, v84, s7, v2
    buffer_load_dwordx4 v[32:35], v4, s[8:11], 0 offen
    s_waitcnt vmcnt(15)
    v_mfma_f32_4x4x4_16b_bf16 v[248:251], v[6:7], v[36:37], v[248:251] cbsz:3 abid:5
    v_mfma_f32_4x4x4_16b_bf16 v[252:255], v[6:7], v[38:39], v[252:255] cbsz:3 abid:5
    s_sub_u32 s62, s62, 1
    s_cbranch_scc1 Lfs_5
Lbs_5:
    v_mad_u32_u16 v4, v85, s7, v2
    buffer_load_dwordx4 v[36:39], v4, s[8:11], 0 offen
    ds_read2_b32 v[84:85], v13 offset0:56 offset1:58
    s_waitcnt vmcnt(15) lgkmcnt(3)
    v_mfma_f32_4x4x4_16b_bf16 v[248:251], v[6:7], v[40:41], v[248:251] cbsz:3 abid:6
    v_mfma_f32_4x4x4_16b_bf16 v[252:255], v[6:7], v[42:43], v[252:255] cbsz:3 abid:6
    s_sub_u32 s62, s62, 1
    s_cbranch_scc1 Lfs_6
Lbs_6:
    v_mad_u32_u16 v4, v86, s7, v2
    buffer_load_dwordx4 v[40:43], v4, s[8:11], 0 offen
    s_waitcnt vmcnt(15)
    v_mfma_f32_4x4x4_16b_bf16 v[248:251], v[6:7], v[44:45], v[248:251] cbsz:3 abid:7
    v_mfma_f32_4x4x4_16b_bf16 v[252:255], v[6:7], v[46:47], v[252:255] cbsz:3 abid:7
    s_sub_u32 s62, s62, 1
    s_cbranch_scc1 Lfs_7
Lbs_7:
    v_mad_u32_u16 v4, v87, s7, v2
    buffer_load_dwordx4 v[44:47], v4, s[8:11], 0 offen
    ds_read2_b32 v[86:87], v13 offset0:60 offset1:62
    s_waitcnt lgkmcnt(3)
    v_perm_b32 v6, v5, v5, v10
    v_perm_b32 v7, v5, v5, v11
    ds_read_b32 v5, v14 offset:128
    s_waitcnt vmcnt(15)
    v_mfma_f32_4x4x4_16b_bf16 v[248:251], v[6:7], v[48:49], v[248:251] cbsz:3 abid:0
    v_mfma_f32_4x4x4_16b_bf16 v[252:255], v[6:7], v[50:51], v[252:255] cbsz:3 abid:0
    s_sub_u32 s62, s62, 1
    s_cbranch_scc1 Lfs_8
Lbs_8:
    v_mad_u32_u16 v4, v80, s7, v2
    buffer_load_dwordx4 v[48:51], v4, s[8:11], 0 offen
    s_waitcnt vmcnt(15)
    v_mfma_f32_4x4x4_16b_bf16 v[248:251], v[6:7], v[52:53], v[248:251] cbsz:3 abid:1
    v_mfma_f32_4x4x4_16b_bf16 v[252:255], v[6:7], v[54:55], v[252:255] cbsz:3 abid:1
    s_sub_u32 s62, s62, 1
    s_cbranch_scc1 Lfs_9
Lbs_9:
    v_mad_u32_u16 v4, v81, s7, v2
    buffer_load_dwordx4 v[52:55], v4, s[8:11], 0 offen
    ds_read2_b32 v[80:81], v13 offset0:64 offset1:66
    s_waitcnt vmcnt(15) lgkmcnt(3)
    v_mfma_f32_4x4x4_16b_bf16 v[248:251], v[6:7], v[56:57], v[248:251] cbsz:3 abid:2
    v_mfma_f32_4x4x4_16b_bf16 v[252:255], v[6:7], v[58:59], v[252:255] cbsz:3 abid:2
    s_sub_u32 s62, s62, 1
    s_cbranch_scc1 Lfs_10
Lbs_10:
    v_mad_u32_u16 v4, v82, s7, v2
    buffer_load_dwordx4 v[56:59], v4, s[8:11], 0 offen
    s_waitcnt vmcnt(15)
    v_mfma_f32_4x4x4_16b_bf16 v[248:251], v[6:7], v[60:61], v[248:251] cbsz:3 abid:3
    v_mfma_f32_4x4x4_16b_bf16 v[252:255], v[6:7], v[62:63], v[252:255] cbsz:3 abid:3
    s_sub_u32 s62, s62, 1
    s_cbranch_scc1 Lfs_11
Lbs_11:
    v_mad_u32_u16 v4, v83, s7, v2
    buffer_load_dwordx4 v[60:63], v4, s[8:11], 0 offen
    ds_read2_b32 v[82:83], v13 offset0:68 offset1:70
    s_waitcnt vmcnt(15) lgkmcnt(3)
    v_mfma_f32_4x4x4_16b_bf16 v[248:251], v[6:7], v[64:65], v[248:251] cbsz:3 abid:4
    v_mfma_f32_4x4x4_16b_bf16 v[252:255], v[6:7], v[66:67], v[252:255] cbsz:3 abid:4
    s_sub_u32 s62, s62, 1
    s_cbranch_scc1 Lfs_12
Lbs_12:
    v_mad_u32_u16 v4, v84, s7, v2
    buffer_load_dwordx4 v[64:67], v4, s[8:11], 0 offen
    s_waitcnt vmcnt(15)
    v_mfma_f32_4x4x4_16b_bf16 v[248:251], v[6:7], v[68:69], v[248:251] cbsz:3 abid:5
    v_mfma_f32_4x4x4_16b_bf16 v[252:255], v[6:7], v[70:71], v[252:255] cbsz:3 abid:5
    s_sub_u32 s62, s62, 1
    s_cbranch_scc1 Lfs_13
Lbs_13:
    v_mad_u32_u16 v4, v85, s7, v2
    buffer_load_dwordx4 v[68:71], v4, s[8:11], 0 offen
    ds_read2_b32 v[84:85], v13 offset0:72 offset1:74
    s_waitcnt vmcnt(15) lgkmcnt(3)
    v_mfma_f32_4x4x4_16b_bf16 v[248:251], v[6:7], v[72:73], v[248:251] cbsz:3 abid:6
    v_mfma_f32_4x4x4_16b_bf16 v[252:255], v[6:7], v[74:75], v[252:255] cbsz:3 abid:6
    s_sub_u32 s62, s62, 1
    s_cbranch_scc1 Lfs_14
Lbs_14:
    v_mad_u32_u16 v4, v86, s7, v2
    buffer_load_dwordx4 v[72:75], v4, s[8:11], 0 offen
    s_waitcnt vmcnt(15)
    v_mfma_f32_4x4x4_16b_bf16 v[248:251], v[6:7], v[76:77], v[248:251] cbsz:3 abid:7
    v_mfma_f32_4x4x4_16b_bf16 v[252:255], v[6:7], v[78:79], v[252:255] cbsz:3 abid:7
    s_sub_u32 s62, s62, 1
    s_cbranch_scc1 Lfs_15
Lbs_15:
    v_mad_u32_u16 v4, v87, s7, v2
    buffer_load_dwordx4 v[76:79], v4, s[8:11], 0 offen
    ds_read2_b32 v[86:87], v13 offset0:76 offset1:78
    v_add_u32 v13, 128, v13
    v_add_u32 v14, 128, v14
    s_sub_u32 s66, s66, 1
    s_cmp_lg_u32 s66, 0
    s_cbranch_scc1 L_gl
L_drain:
    s_waitcnt lgkmcnt(0)
    v_perm_b32 v6, v5, v5, v10
    v_perm_b32 v7, v5, v5, v11
    ds_read_b32 v5, v14 offset:64
    s_waitcnt vmcnt(15)
    v_mfma_f32_4x4x4_16b_bf16 v[248:251], v[6:7], v[16:17], v[248:251] cbsz:3 abid:0
    v_mfma_f32_4x4x4_16b_bf16 v[252:255], v[6:7], v[18:19], v[252:255] cbsz:3 abid:0
    s_sub_u32 s62, s62, 1
    s_cbranch_scc1 Lfd_0
Lbd_0:
    s_waitcnt vmcnt(14)
    v_mfma_f32_4x4x4_16b_bf16 v[248:251], v[6:7], v[20:21], v[248:251] cbsz:3 abid:1
    v_mfma_f32_4x4x4_16b_bf16 v[252:255], v[6:7], v[22:23], v[252:255] cbsz:3 abid:1
    s_sub_u32 s62, s62, 1
    s_cbranch_scc1 Lfd_1
Lbd_1:
    s_waitcnt vmcnt(13)
    v_mfma_f32_4x4x4_16b_bf16 v[248:251], v[6:7], v[24:25], v[248:251] cbsz:3 abid:2
    v_mfma_f32_4x4x4_16b_bf16 v[252:255], v[6:7], v[26:27], v[252:255] cbsz:3 abid:2
    s_sub_u32 s62, s62, 1
    s_cbranch_scc1 Lfd_2
Lbd_2:
    s_waitcnt vmcnt(12)
    v_mfma_f32_4x4x4_16b_bf16 v[248:251], v[6:7], v[28:29], v[248:251] cbsz:3 abid:3
    v_mfma_f32_4x4x4_16b_bf16 v[252:255], v[6:7], v[30:31], v[252:255] cbsz:3 abid:3
    s_sub_u32 s62, s62, 1
    s_cbranch_scc1 Lfd_3
Lbd_3:
    s_waitcnt vmcnt(11)
    v_mfma_f32_4x4x4_16b_bf16 v[248:251], v[6:7], v[32:33], v[248:251] cbsz:3 abid:4
    v_mfma_f32_4x4x4_16b_bf16 v[252:255], v[6:7], v[34:35], v[252:255] cbsz:3 abid:4
    s_sub_u32 s62, s62, 1
    s_cbranch_scc1 Lfd_4
Lbd_4:
    s_waitcnt vmcnt(10)
    v_mfma_f32_4x4x4_16b_bf16 v[248:251], v[6:7], v[36:37], v[248:251] cbsz:3 abid:5
    v_mfma_f32_4x4x4_16b_bf16 v[252:255], v[6:7], v[38:39], v[252:255] cbsz:3 abid:5
    s_sub_u32 s62, s62, 1
    s_cbranch_scc1 Lfd_5
Lbd_5:
    s_waitcnt vmcnt(9)
    v_mfma_f32_4x4x4_16b_bf16 v[248:251], v[6:7], v[40:41], v[248:251] cbsz:3 abid:6
    v_mfma_f32_4x4x4_16b_bf16 v[252:255], v[6:7], v[42:43], v[252:255] cbsz:3 abid:6
    s_sub_u32 s62, s62, 1
    s_cbranch_scc1 Lfd_6
Lbd_6:
    s_waitcnt vmcnt(8)
    v_mfma_f32_4x4x4_16b_bf16 v[248:251], v[6:7], v[44:45], v[248:251] cbsz:3 abid:7
    v_mfma_f32_4x4x4_16b_bf16 v[252:255], v[6:7], v[46:47], v[252:255] cbsz:3 abid:7
    s_sub_u32 s62, s62, 1
    s_cbranch_scc1 Lfd_7
Lbd_7:
    s_waitcnt lgkmcnt(0)
    v_perm_b32 v6, v5, v5, v10
    v_perm_b32 v7, v5, v5, v11
    ds_read_b32 v5, v14 offset:128
    s_waitcnt vmcnt(7)
    v_mfma_f32_4x4x4_16b_bf16 v[248:251], v[6:7], v[48:49], v[248:251] cbsz:3 abid:0
    v_mfma_f32_4x4x4_16b_bf16 v[252:255], v[6:7], v[50:51], v[252:255] cbsz:3 abid:0
    s_sub_u32 s62, s62, 1
    s_cbranch_scc1 Lfd_8
Lbd_8:
    s_waitcnt vmcnt(6)
    v_mfma_f32_4x4x4_16b_bf16 v[248:251], v[6:7], v[52:53], v[248:251] cbsz:3 abid:1
    v_mfma_f32_4x4x4_16b_bf16 v[252:255], v[6:7], v[54:55], v[252:255] cbsz:3 abid:1
    s_sub_u32 s62, s62, 1
    s_cbranch_scc1 Lfd_9
Lbd_9:
    s_waitcnt vmcnt(5)
    v_mfma_f32_4x4x4_16b_bf16 v[248:251], v[6:7], v[56:57], v[248:251] cbsz:3 abid:2
    v_mfma_f32_4x4x4_16b_bf16 v[252:255], v[6:7], v[58:59], v[252:255] cbsz:3 abid:2
    s_sub_u32 s62, s62, 1
    s_cbranch_scc1 Lfd_10
Lbd_10:
    s_waitcnt vmcnt(4)
    v_mfma_f32_4x4x4_16b_bf16 v[248:251], v[6:7], v[60:61], v[248:251] cbsz:3 abid:3
    v_mfma_f32_4x4x4_16b_bf16 v[252:255], v[6:7], v[62:63], v[252:255] cbsz:3 abid:3
    s_sub_u32 s62, s62, 1
    s_cbranch_scc1 Lfd_11
Lbd_11:
    s_waitcnt vmcnt(3)
    v_mfma_f32_4x4x4_16b_bf16 v[248:251], v[6:7], v[64:65], v[248:251] cbsz:3 abid:4
    v_mfma_f32_4x4x4_16b_bf16 v[252:255], v[6:7], v[66:67], v[252:255] cbsz:3 abid:4
    s_sub_u32 s62, s62, 1
    s_cbranch_scc1 Lfd_12
Lbd_12:
    s_waitcnt vmcnt(2)
    v_mfma_f32_4x4x4_16b_bf16 v[248:251], v[6:7], v[68:69], v[248:251] cbsz:3 abid:5
    v_mfma_f32_4x4x4_16b_bf16 v[252:255], v[6:7], v[70:71], v[252:255] cbsz:3 abid:5
    s_sub_u32 s62, s62, 1
    s_cbranch_scc1 Lfd_13
Lbd_13:
    s_waitcnt vmcnt(1)
    v_mfma_f32_4x4x4_16b_bf16 v[248:251], v[6:7], v[72:73], v[248:251] cbsz:3 abid:6
    v_mfma_f32_4x4x4_16b_bf16 v[252:255], v[6:7], v[74:75], v[252:255] cbsz:3 abid:6
    s_sub_u32 s62, s62, 1
    s_cbranch_scc1 Lfd_14
Lbd_14:
    s_waitcnt vmcnt(0)
    v_mfma_f32_4x4x4_16b_bf16 v[248:251], v[6:7], v[76:77], v[248:251] cbsz:3 abid:7
    v_mfma_f32_4x4x4_16b_bf16 v[252:255], v[6:7], v[78:79], v[252:255] cbsz:3 abid:7
    s_sub_u32 s62, s62, 1
    s_cbranch_scc1 Lfd_15
Lbd_15:
L_gdone:
    v_add_u32 v8, 130944, v1
    s_mul_i32 s60, s4, 12288
    v_lshl_add_u32 v9, v0, 4, s60
    v_and_b32 v4, 15, v0
    v_lshlrev_b32 v4, 2, v4
    v_and_b32 v5, 48, v0
    v_lshl_add_u32 v10, v5, 7, v4
    v_and_b32 v5, 32, v0
    v_lshl_add_u32 v11, v5, 6, v4
    v_and_b32 v5, 16, v0
    v_lshl_add_u32 v11, v5, 22, v11
    s_lshl_b32 s60, s5, 9
    s_lshl_b32 s61, s4, 7
    s_add_u32 s60, s60, s61
    s_mov_b32 s63, 0
    s_waitcnt lgkmcnt(0)
    s_barrier
L_wlt:
    ds_read_b128 v[48:51], v9 offset:0
    ds_read_b128 v[52:55], v9 offset:1024
    ds_read_b128 v[56:59], v9 offset:2048
    ds_read_b128 v[60:63], v9 offset:3072
    ds_read_b128 v[16:19], v8 offset:0
    ds_read_b128 v[20:23], v8 offset:64
    ds_read_b128 v[24:27], v8 offset:128
    ds_read_b128 v[28:31], v8 offset:192
    ds_read_b128 v[32:35], v8 offset:256
    ds_read_b128 v[36:39], v8 offset:320
    ds_read_b128 v[40:43], v8 offset:384
    ds_read_b128 v[44:47], v8 offset:448
    s_waitcnt lgkmcnt(7)
    v_mfma_f32_16x16x32_bf16 v[48:51], v[16:19], v[120:123], v[48:51]
    v_mfma_f32_16x16x32_bf16 v[52:55], v[16:19], v[124:127], v[52:55]
    v_mfma_f32_16x16x32_bf16 v[56:59], v[16:19], v[128:131], v[56:59]
    v_mfma_f32_16x16x32_bf16 v[60:63], v[16:19], v[132:135], v[60:63]
    s_waitcnt lgkmcnt(6)
    v_mfma_f32_16x16x32_bf16 v[48:51], v[20:23], v[136:139], v[48:51]
    v_mfma_f32_16x16x32_bf16 v[52:55], v[20:23], v[140:143], v[52:55]
    v_mfma_f32_16x16x32_bf16 v[56:59], v[20:23], v[144:147], v[56:59]
    v_mfma_f32_16x16x32_bf16 v[60:63], v[20:23], v[148:151], v[60:63]
    s_waitcnt lgkmcnt(5)
    v_mfma_f32_16x16x32_bf16 v[48:51], v[24:27], v[152:155], v[48:51]
    v_mfma_f32_16x16x32_bf16 v[52:55], v[24:27], v[156:159], v[52:55]
    v_mfma_f32_16x16x32_bf16 v[56:59], v[24:27], v[160:163], v[56:59]
    v_mfma_f32_16x16x32_bf16 v[60:63], v[24:27], v[164:167], v[60:63]
    s_waitcnt lgkmcnt(4)
    v_mfma_f32_16x16x32_bf16 v[48:51], v[28:31], v[168:171], v[48:51]
    v_mfma_f32_16x16x32_bf16 v[52:55], v[28:31], v[172:175], v[52:55]
    v_mfma_f32_16x16x32_bf16 v[56:59], v[28:31], v[176:179], v[56:59]
    v_mfma_f32_16x16x32_bf16 v[60:63], v[28:31], v[180:183], v[60:63]
    s_waitcnt lgkmcnt(3)
    v_mfma_f32_16x16x32_bf16 v[48:51], v[32:35], v[184:187], v[48:51]
    v_mfma_f32_16x16x32_bf16 v[52:55], v[32:35], v[188:191], v[52:55]
    v_mfma_f32_16x16x32_bf16 v[56:59], v[32:35], v[192:195], v[56:59]
    v_mfma_f32_16x16x32_bf16 v[60:63], v[32:35], v[196:199], v[60:63]
    s_waitcnt lgkmcnt(2)
    v_mfma_f32_16x16x32_bf16 v[48:51], v[36:39], v[200:203], v[48:51]
    v_mfma_f32_16x16x32_bf16 v[52:55], v[36:39], v[204:207], v[52:55]
    v_mfma_f32_16x16x32_bf16 v[56:59], v[36:39], v[208:211], v[56:59]
    v_mfma_f32_16x16x32_bf16 v[60:63], v[36:39], v[212:215], v[60:63]
    s_waitcnt lgkmcnt(1)
    v_mfma_f32_16x16x32_bf16 v[48:51], v[40:43], v[216:219], v[48:51]
    v_mfma_f32_16x16x32_bf16 v[52:55], v[40:43], v[220:223], v[52:55]
    v_mfma_f32_16x16x32_bf16 v[56:59], v[40:43], v[224:227], v[56:59]
    v_mfma_f32_16x16x32_bf16 v[60:63], v[40:43], v[228:231], v[60:63]
    s_waitcnt lgkmcnt(0)
    v_mfma_f32_16x16x32_bf16 v[48:51], v[44:47], v[232:235], v[48:51]
    v_mfma_f32_16x16x32_bf16 v[52:55], v[44:47], v[236:239], v[52:55]
    v_mfma_f32_16x16x32_bf16 v[56:59], v[44:47], v[240:243], v[56:59]
    v_mfma_f32_16x16x32_bf16 v[60:63], v[44:47], v[244:247], v[60:63]
    v_add_u32 v8, 8448, v8
    v_add_u32 v9, 4096, v9
    s_add_u32 s63, s63, 1
    s_nop 3
    v_cvt_pk_bf16_f32 v64, v48, v52
    buffer_store_dword v64, v10, s[20:23], s60 offen offset:0
    v_cvt_pk_bf16_f32 v65, v56, v60
    buffer_store_dword v65, v10, s[20:23], s60 offen offset:64
    v_cvt_pk_bf16_f32 v66, v49, v53
    buffer_store_dword v66, v10, s[20:23], s60 offen offset:512
    v_cvt_pk_bf16_f32 v67, v57, v61
    buffer_store_dword v67, v10, s[20:23], s60 offen offset:576
    v_cvt_pk_bf16_f32 v68, v50, v54
    buffer_store_dword v68, v10, s[20:23], s60 offen offset:1024
    v_cvt_pk_bf16_f32 v69, v58, v62
    buffer_store_dword v69, v10, s[20:23], s60 offen offset:1088
    v_cvt_pk_bf16_f32 v70, v51, v55
    buffer_store_dword v70, v10, s[20:23], s60 offen offset:1536
    v_cvt_pk_bf16_f32 v71, v59, v63
    buffer_store_dword v71, v10, s[20:23], s60 offen offset:1600
    s_add_u32 s60, s60, 8192
    s_cmp_lt_u32 s63, 2
    s_cbranch_scc1 L_wlt
    v_mov_b32 v10, v11
    s_cmp_lt_u32 s63, 3
    s_cbranch_scc1 L_wlt
L_end:
L_exit:
    s_endpgm
Lfs_0:
    s_call_b64 s[68:69], L_flush
    s_branch Lbs_0
Lfs_1:
    s_call_b64 s[68:69], L_flush
    s_branch Lbs_1
Lfs_2:
    s_call_b64 s[68:69], L_flush
    s_branch Lbs_2
Lfs_3:
    s_call_b64 s[68:69], L_flush
    s_branch Lbs_3
Lfs_4:
    s_call_b64 s[68:69], L_flush
    s_branch Lbs_4
Lfs_5:
    s_call_b64 s[68:69], L_flush
    s_branch Lbs_5
Lfs_6:
    s_call_b64 s[68:69], L_flush
    s_branch Lbs_6
Lfs_7:
    s_call_b64 s[68:69], L_flush
    s_branch Lbs_7
Lfs_8:
    s_call_b64 s[68:69], L_flush
    s_branch Lbs_8
Lfs_9:
    s_call_b64 s[68:69], L_flush
    s_branch Lbs_9
Lfs_10:
    s_call_b64 s[68:69], L_flush
    s_branch Lbs_10
Lfs_11:
    s_call_b64 s[68:69], L_flush
    s_branch Lbs_11
Lfs_12:
    s_call_b64 s[68:69], L_flush
    s_branch Lbs_12
Lfs_13:
    s_call_b64 s[68:69], L_flush
    s_branch Lbs_13
Lfs_14:
    s_call_b64 s[68:69], L_flush
    s_branch Lbs_14
Lfs_15:
    s_call_b64 s[68:69], L_flush
    s_branch Lbs_15
Lfd_0:
    s_call_b64 s[68:69], L_flush
    s_branch Lbd_0
Lfd_1:
    s_call_b64 s[68:69], L_flush
    s_branch Lbd_1
Lfd_2:
    s_call_b64 s[68:69], L_flush
    s_branch Lbd_2
Lfd_3:
    s_call_b64 s[68:69], L_flush
    s_branch Lbd_3
Lfd_4:
    s_call_b64 s[68:69], L_flush
    s_branch Lbd_4
Lfd_5:
    s_call_b64 s[68:69], L_flush
    s_branch Lbd_5
Lfd_6:
    s_call_b64 s[68:69], L_flush
    s_branch Lbd_6
Lfd_7:
    s_call_b64 s[68:69], L_flush
    s_branch Lbd_7
Lfd_8:
    s_call_b64 s[68:69], L_flush
    s_branch Lbd_8
Lfd_9:
    s_call_b64 s[68:69], L_flush
    s_branch Lbd_9
Lfd_10:
    s_call_b64 s[68:69], L_flush
    s_branch Lbd_10
Lfd_11:
    s_call_b64 s[68:69], L_flush
    s_branch Lbd_11
Lfd_12:
    s_call_b64 s[68:69], L_flush
    s_branch Lbd_12
Lfd_13:
    s_call_b64 s[68:69], L_flush
    s_branch Lbd_13
Lfd_14:
    s_call_b64 s[68:69], L_flush
    s_branch Lbd_14
Lfd_15:
    s_call_b64 s[68:69], L_flush
    s_branch Lbd_15
L_flush:
    s_add_u32 s63, s63, 1
    v_add_u32 v4, s64, v15
    s_nop 0
    v_permlane32_swap_b32 v248, v252
    v_permlane32_swap_b32 v249, v253
    v_permlane32_swap_b32 v250, v254
    v_permlane32_swap_b32 v251, v255
    v_readlane_b32 s64, v9, s63
    v_readlane_b32 s62, v12, s63
    v_add_f32 v248, v248, v252
    v_add_f32 v249, v249, v253
    v_add_f32 v250, v250, v254
    v_add_f32 v251, v251, v255
    v_mul_f32 v248, s65, v248
    v_mul_f32 v249, s65, v249
    v_mul_f32 v250, s65, v250
    v_mul_f32 v251, s65, v251
    v_readlane_b32 s65, v8, s63
    v_cvt_pk_bf16_f32 v252, v248, v249
    v_cvt_pk_bf16_f32 v253, v250, v251
    ds_write_b64 v4, v[252:253]
    v_mov_b64 v[248:249], 0
    v_mov_b64 v[250:251], 0
    v_mov_b64 v[254:255], 0
    v_mov_b64 v[252:253], 0
    s_setpc_b64 s[68:69]
L_slow:
    s_mov_b32 s24, s34
    s_mov_b32 s25, s35
    s_mov_b32 s26, 640000
    s_mov_b32 s27, 0x20000
    s_mov_b32 s28, s36
    s_mov_b32 s29, s37
    s_mov_b32 s30, 640000
    s_mov_b32 s31, 0x20000
    s_mov_b32 s12, s42
    s_mov_b32 s13, s43
    s_mov_b32 s14, 20000
    s_mov_b32 s15, 0x20000
    s_sub_u32 s63, s63, 1
    s_mov_b32 s64, 160320
    s_mov_b32 s65, 0
    s_call_b64 s[68:69], L_flush
    s_mul_i32 s66, s4, 10
    s_add_u32 s66, s66, s5
    s_add_u32 s67, s66, 10
    v_lshlrev_b32 v16, 2, v0
    v_and_b32 v17, 32, v0
    v_lshl_add_u32 v17, v17, 22, v2
    v_mov_b32 v24, 0
L_sn:
    s_mov_b32 s60, 0
L_sc:
    buffer_load_dword v18, v16, s[28:31], s60 offen
    buffer_load_dword v19, v16, s[24:27], s60 offen
    s_waitcnt vmcnt(0)
    v_cmp_eq_u32 vcc, s66, v18
    s_cbranch_vccz L_sx
L_se:
    s_ff1_i32_b64 s58, vcc
    s_bitset0_b64 vcc, s58
    v_readlane_b32 s59, v19, s58
    s_nop 0
    s_lshl_b32 s61, s59, 9
    s_lshl_b32 s59, s59, 1
    buffer_load_dwordx4 v[20:23], v17, s[8:11], s61 offen
    buffer_load_short_d16_hi v5, v24, s[12:15], s59 offen
    s_waitcnt vmcnt(0)
    v_perm_b32 v6, v5, v5, v10
    v_perm_b32 v7, v5, v5, v11
    s_nop 1
    v_mfma_f32_4x4x4_16b_bf16 v[248:251], v[6:7], v[20:21], v[248:251]
    v_mfma_f32_4x4x4_16b_bf16 v[252:255], v[6:7], v[22:23], v[252:255]
    s_cmp_lg_u64 vcc, 0
    s_cbranch_scc1 L_se
L_sx:
    s_add_u32 s60, s60, 256
    s_cmp_lt_u32 s60, 640000
    s_cbranch_scc1 L_sc
    s_call_b64 s[68:69], L_flush
    s_add_u32 s66, s66, 1
    s_cmp_lt_u32 s66, s67
    s_cbranch_scc1 L_sn
    s_branch L_gdone
.section .rodata,"a"
.p2align 6
.amdhsa_kernel standalone__hybrid_graph_tf_exphormer__graph_kernel
  .amdhsa_next_free_vgpr 256
  .amdhsa_next_free_sgpr 102
  .amdhsa_accum_offset 256
  .amdhsa_group_segment_fixed_size 0
  .amdhsa_kernarg_size 104
  .amdhsa_user_sgpr_count 2
  .amdhsa_user_sgpr_kernarg_segment_ptr 1
  .amdhsa_system_sgpr_workgroup_id_x 1
.end_amdhsa_kernel
```

```asm
; @launch grid=(250,1,1) block=(1024,1,1) lds=161856
.amdgcn_target "amdgcn-amd-amdhsa--gfx950"
.text
.globl standalone__hybrid_graph_tf_exphormer__graph_kernel
.p2align 8
.type standalone__hybrid_graph_tf_exphormer__graph_kernel,@function
standalone__hybrid_graph_tf_exphormer__graph_kernel:
    s_cmp_ge_u32 s2, 250
    s_cbranch_scc1 L_exit
    s_load_dwordx16 s[32:47], s[0:1], 0
    s_load_dwordx8 s[48:55], s[0:1], 64
    s_load_dwordx2 s[56:57], s[0:1], 96
    s_getpc_b64 s[60:61]
    v_cmp_gt_u32 vcc, 91, v0
    v_lshlrev_b32 v1, 7, v0
    s_and_saveexec_b64 s[58:59], vcc
    s_cbranch_execz L_nopf
    global_load_dword v127, v1, s[60:61]
L_nopf:
    s_mov_b64 exec, -1
    v_lshrrev_b32 v1, 6, v0
    v_mov_b32 v8, 0xffff
    v_readfirstlane_b32 s3, v1
    v_cmp_gt_u32 vcc, 320, v0
    v_lshlrev_b32 v4, 4, v0
    v_add_u32 v4, 152064, v4
    v_cndmask_b32 v8, 0, v8, vcc
    v_mov_b32 v9, v8
    v_mov_b32 v10, v8
    v_mov_b32 v11, v8
    v_cmp_gt_u32 vcc, 420, v0
    s_and_saveexec_b64 s[58:59], vcc
    ds_write_b128 v4, v[8:11]
    s_mov_b64 exec, -1
    v_and_b32 v0, 63, v0
    s_and_b32 s58, s2, 7
    s_lshr_b32 s59, s2, 3
    s_mul_i32 s6, s58, 31
    s_min_u32 s58, s58, 2
    s_add_u32 s6, s6, s58
    s_add_u32 s6, s6, s59
    s_mul_i32 s5, s6, 40
    s_and_b32 s4, s3, 7
    s_movk_i32 s7, 512
    v_and_b32 v4, 7, v0
    v_mul_u32_u24 v1, 1056, v4
    v_and_b32 v4, 8, v0
    v_lshl_add_u32 v1, v4, 6, v1
    v_and_b32 v4, 48, v0
    v_add_u32 v1, v4, v1
    v_and_b32 v2, 31, v0
    v_lshlrev_b32 v2, 4, v2
    v_mov_b32 v3, 157696
    s_mov_b32 s70, 0x05040100
    s_mov_b32 s71, 0x07060302
    s_mov_b32 s10, 5120000
    s_mov_b32 s11, 0x20000
    s_mov_b32 s18, 0x200000
    s_mov_b32 s19, 0x20000
    s_waitcnt lgkmcnt(0)
    s_mov_b64 s[8:9], s[32:33]
    s_mov_b64 s[16:17], s[56:57]
    s_cmp_eq_u32 s3, 8
    s_cbranch_scc0 L_notprod
    s_setprio 3
    s_mov_b32 s24, s34
    s_mov_b32 s25, s35
    s_mov_b32 s26, 640000
    s_mov_b32 s27, 0x20000
    s_mov_b32 s28, s36
    s_mov_b32 s29, s37
    s_mov_b32 s30, 640000
    s_mov_b32 s31, 0x20000
    v_lshlrev_b32 v5, 4, v0
    v_lshlrev_b32 v6, 3, v0
    s_mul_i32 s58, s2, 2560
    buffer_load_dwordx4 v[26:29], v5, s[28:31], s58 offen
    buffer_load_dwordx4 v[30:33], v5, s[28:31], s58 offen offset:1024
    buffer_load_dwordx2 v[34:35], v6, s[28:31], s58 offen offset:2048
    buffer_load_dwordx4 v[16:19], v5, s[24:27], s58 offen
    buffer_load_dwordx4 v[20:23], v5, s[24:27], s58 offen offset:1024
    buffer_load_dwordx2 v[24:25], v6, s[24:27], s58 offen offset:2048
    s_barrier
    v_mov_b32 v8, 1
    v_mov_b32 v9, 4
    v_mov_b32 v10, 157760
    v_add_u32 v11, 157760, v5
    v_mov_b32 v59, 158784
    v_add_u32 v74, 158784, v5
    v_add_u32 v75, 158784, v6
    v_mov_b32 v76, 0
    s_and_b32 s60, s2, 15
    v_lshl_add_u32 v77, v0, 4, s60
    v_lshlrev_b32 v77, 8, v77
    v_lshlrev_b32 v78, 8, v0
    v_cmp_gt_u32 vcc, 10, v0
    v_mov_b32 v79, 15
    s_lshl_b32 s61, s2, 10
    v_addc_co_u32 v79, vcc, 0, v79, vcc
    s_add_u32 s58, s58, 262144
    s_waitcnt vmcnt(5)
    v_mul_u32_u24 v36, 52429, v26
    v_lshrrev_b32 v36, 21, v36
    v_lshl_add_u32 v36, v36, 2, v10
    ds_add_u32 v36, v8
    v_mul_u32_u24 v37, 52429, v27
    v_lshrrev_b32 v37, 21, v37
    v_lshl_add_u32 v37, v37, 2, v10
    ds_add_u32 v37, v8
    v_mul_u32_u24 v38, 52429, v28
    v_lshrrev_b32 v38, 21, v38
    v_lshl_add_u32 v38, v38, 2, v10
    ds_add_u32 v38, v8
    v_mul_u32_u24 v39, 52429, v29
    v_lshrrev_b32 v39, 21, v39
    v_lshl_add_u32 v39, v39, 2, v10
    ds_add_u32 v39, v8
    s_waitcnt vmcnt(4)
    v_mul_u32_u24 v40, 52429, v30
    v_lshrrev_b32 v40, 21, v40
    v_lshl_add_u32 v40, v40, 2, v10
    ds_add_u32 v40, v8
    v_mul_u32_u24 v41, 52429, v31
    v_lshrrev_b32 v41, 21, v41
    v_lshl_add_u32 v41, v41, 2, v10
    ds_add_u32 v41, v8
    v_mul_u32_u24 v42, 52429, v32
    v_lshrrev_b32 v42, 21, v42
    v_lshl_add_u32 v42, v42, 2, v10
    ds_add_u32 v42, v8
    v_mul_u32_u24 v43, 52429, v33
    v_lshrrev_b32 v43, 21, v43
    v_lshl_add_u32 v43, v43, 2, v10
    ds_add_u32 v43, v8
    s_waitcnt vmcnt(3)
    v_mul_u32_u24 v44, 52429, v34
    v_lshrrev_b32 v44, 21, v44
    v_lshl_add_u32 v44, v44, 2, v10
    ds_add_u32 v44, v8
    v_mul_u32_u24 v45, 52429, v35
    v_lshrrev_b32 v45, 21, v45
    v_lshl_add_u32 v45, v45, 2, v10
    ds_add_u32 v45, v8
    ds_read_b128 v[12:15], v11
    s_waitcnt vmcnt(0)
    v_lshl_or_b32 v16, v26, 16, v16
    v_lshl_or_b32 v17, v27, 16, v17
    v_lshl_or_b32 v18, v28, 16, v18
    v_lshl_or_b32 v19, v29, 16, v19
    v_lshl_or_b32 v20, v30, 16, v20
    v_lshl_or_b32 v21, v31, 16, v21
    v_lshl_or_b32 v22, v32, 16, v22
    v_lshl_or_b32 v23, v33, 16, v23
    v_lshl_or_b32 v24, v34, 16, v24
    v_lshl_or_b32 v25, v35, 16, v25
    s_waitcnt lgkmcnt(0)
    v_add_u32 v56, v12, v13
    v_add3_u32 v57, v56, v14, v15
    s_nop 1
    v_add_u32_dpp v58, v57, v57 row_shr:1 row_mask:0xf bank_mask:0xf bound_ctrl:1
    s_nop 1
    v_add_u32_dpp v58, v58, v58 row_shr:2 row_mask:0xf bank_mask:0xf bound_ctrl:1
    s_nop 1
    v_add_u32_dpp v58, v58, v58 row_shr:4 row_mask:0xf bank_mask:0xf bound_ctrl:1
    s_nop 1
    v_add_u32_dpp v58, v58, v58 row_shr:8 row_mask:0xf bank_mask:0xf bound_ctrl:1
    s_nop 1
    v_add_u32_dpp v58, v58, v58 row_bcast:15 row_mask:0xa bank_mask:0xf
    s_nop 1
    v_add_u32_dpp v58, v58, v58 row_bcast:31 row_mask:0xc bank_mask:0xf
    v_sub_u32 v60, v58, v57
    v_add_u32 v61, v60, v12
    v_add_u32 v62, v60, v56
    v_add_u32 v63, v62, v14
    v_lshl_add_u32 v64, v60, 2, v59
    v_lshl_add_u32 v65, v61, 2, v59
    v_lshl_add_u32 v66, v62, 2, v59
    v_lshl_add_u32 v67, v63, 2, v59
    ds_write_b128 v11, v[64:67]
    ds_add_rtn_u32 v46, v36, v9
    ds_add_rtn_u32 v47, v37, v9
    ds_add_rtn_u32 v48, v38, v9
    ds_add_rtn_u32 v49, v39, v9
    ds_add_rtn_u32 v50, v40, v9
    ds_add_rtn_u32 v51, v41, v9
    ds_add_rtn_u32 v52, v42, v9
    ds_add_rtn_u32 v53, v43, v9
    ds_add_rtn_u32 v54, v44, v9
    ds_add_rtn_u32 v55, v45, v9
    v_lshl_or_b32 v60, v12, 16, v60
    v_lshl_or_b32 v61, v13, 16, v61
    v_lshl_or_b32 v62, v14, 16, v62
    v_lshl_or_b32 v63, v15, 16, v63
    buffer_store_dwordx4 v[60:63], v5, s[16:19], s61 offen sc1
    global_load_dword v11, v76, s[54:55] sc1
    s_waitcnt lgkmcnt(8)
    ds_write_b32 v46, v16
    ds_write_b32 v47, v17
    s_waitcnt lgkmcnt(8)
    ds_write_b32 v48, v18
    ds_write_b32 v49, v19
    s_waitcnt lgkmcnt(8)
    ds_write_b32 v50, v20
    ds_write_b32 v51, v21
    s_waitcnt lgkmcnt(8)
    ds_write_b32 v52, v22
    ds_write_b32 v53, v23
    s_waitcnt lgkmcnt(8)
    ds_write_b32 v54, v24
    ds_write_b32 v55, v25
    ds_read_b128 v[64:67], v74
    ds_read_b128 v[68:71], v74 offset:1024
    ds_read_b64 v[72:73], v75 offset:2048
    s_waitcnt lgkmcnt(2)
    buffer_store_dwordx4 v[64:67], v5, s[16:19], s58 offen sc1
    s_waitcnt lgkmcnt(1)
    buffer_store_dwordx4 v[68:71], v5, s[16:19], s58 offen offset:1024 sc1
    s_waitcnt lgkmcnt(0)
    buffer_store_dwordx2 v[72:73], v6, s[16:19], s58 offen offset:2048 sc1
    s_mov_b32 s59, 0
Lw_1:
    ds_read_b32 v4, v3 offset:8
    s_waitcnt lgkmcnt(0)
    v_cmp_gt_u32 vcc, 2, v4
    s_cbranch_vccz Lk_2
    s_add_u32 s59, s59, 1
    s_cmp_lt_u32 s59, 4194304
    s_cbranch_scc1 Lw_1
    s_branch L_end
Lk_2:
    s_mov_b32 s59, 0
    s_mov_b32 s58, 1572864
L_zp:
    s_waitcnt vmcnt(0)
    v_cmp_ne_u32 vcc, 1, v11
    s_cbranch_vccz L_zok
    global_load_dword v11, v76, s[54:55] sc1
    s_add_u32 s59, s59, 1
    s_cmp_lt_u32 s59, 0x40000
    s_cbranch_scc1 L_zp
    s_branch L_end
L_zok:
    s_mov_b64 exec, 255
    buffer_atomic_add v8, v77, s[16:19], s58 offen sc1
    s_mov_b64 exec, -1
    s_branch L_preB
L_notprod:
    s_cmp_lt_u32 s3, 8
    s_cbranch_scc1 L_egrp
    s_cmp_ge_u32 s3, 14
    s_cbranch_scc1 L_egrp
    s_cmp_eq_u32 s3, 9
    s_cbranch_scc1 L_mtask
    s_cmp_eq_u32 s3, 10
    s_cbranch_scc1 L_wtask
    s_mov_b32 s24, s42
    s_mov_b32 s25, s43
    s_mov_b32 s26, 20000
    s_mov_b32 s27, 0x20000
    s_lshl_b32 s58, s2, 4
    s_add_u32 s58, s58, s3
    s_cmp_eq_u32 s58, 13
    s_cbranch_scc0 L_noz
    v_lshlrev_b32 v4, 8, v0
    v_mov_b32 v5, 0
    v_mov_b32 v6, 1
    s_mov_b32 s58, 1572864
    s_mov_b32 s59, 1589248
    buffer_store_dword v5, v4, s[16:19], s58 offen sc1
    buffer_store_dword v5, v4, s[16:19], s59 offen sc1
    s_barrier
    s_waitcnt vmcnt(0)
    s_mov_b64 exec, 1
    global_store_dword v5, v6, s[54:55] sc1
    s_mov_b64 exec, -1
    s_branch L_zd
L_noz:
    s_barrier
L_zd:
    s_sub_u32 s58, s3, 11
    s_mul_i32 s58, s58, 7168
    v_lshlrev_b32 v4, 4, v0
    s_add_u32 m0, s58, 130944
    s_add_u32 s59, s58, 0
    buffer_load_dwordx4 v4, s[24:27], s59 offen offset:0 lds
    buffer_load_dwordx4 v4, s[24:27], s59 offen offset:1024 lds
    buffer_load_dwordx4 v4, s[24:27], s59 offen offset:2048 lds
    buffer_load_dwordx4 v4, s[24:27], s59 offen offset:3072 lds
    s_add_u32 m0, s58, 135040
    s_add_u32 s59, s58, 4096
    buffer_load_dwordx4 v4, s[24:27], s59 offen offset:0 lds
    buffer_load_dwordx4 v4, s[24:27], s59 offen offset:1024 lds
    s_cmp_eq_u32 s3, 13
    s_cbranch_scc1 L_disd
    buffer_load_dwordx4 v4, s[24:27], s59 offen offset:2048 lds
L_disd:
    s_waitcnt vmcnt(0)
    s_mov_b64 exec, 1
    v_mov_b32 v4, 1
    ds_add_u32 v3, v4 offset:4
    s_mov_b64 exec, -1
    s_branch L_preB
L_mtask:
    s_cmp_ge_u32 s2, 128
    s_cbranch_scc1 L_notask
    s_setprio 2
    s_mov_b32 s24, s46
    s_mov_b32 s25, s47
    s_mov_b32 s26, 131072
    s_mov_b32 s27, 0x20000
    s_mov_b32 s28, s48
    s_mov_b32 s29, s49
    s_mov_b32 s30, 131072
    s_mov_b32 s31, 0x20000
    v_and_b32 v4, 32, v0
    v_lshl_add_u32 v4, v4, 8, v2
    s_and_b32 s58, s2, 7
    s_lshl_b32 s58, s58, 14
    s_lshr_b32 s59, s2, 4
    s_lshl_b32 s59, s59, 14
    s_bfe_u32 s60, s2, 0x10003
    s_lshl_b32 s60, s60, 11
    s_add_u32 s59, s59, s60
    s_add_u32 s60, s58, 0
    s_mov_b32 m0, 105600
    s_nop 0
    buffer_load_dwordx4 v4, s[24:27], s60 offen offset:0 lds
    s_mov_b32 m0, 106144
    s_nop 0
    buffer_load_dwordx4 v4, s[24:27], s60 offen offset:512 lds
    s_mov_b32 m0, 106688
    s_nop 0
    buffer_load_dwordx4 v4, s[24:27], s60 offen offset:1024 lds
    s_mov_b32 m0, 107232
    s_nop 0
    buffer_load_dwordx4 v4, s[24:27], s60 offen offset:1536 lds
    s_add_u32 s60, s58, 4096
    s_mov_b32 m0, 109824
    s_nop 0
    buffer_load_dwordx4 v4, s[24:27], s60 offen offset:0 lds
    s_mov_b32 m0, 110368
    s_nop 0
    buffer_load_dwordx4 v4, s[24:27], s60 offen offset:512 lds
    s_mov_b32 m0, 110912
    s_nop 0
    buffer_load_dwordx4 v4, s[24:27], s60 offen offset:1024 lds
    s_mov_b32 m0, 111456
    s_nop 0
    buffer_load_dwordx4 v4, s[24:27], s60 offen offset:1536 lds
    s_add_u32 s60, s58, 2048
    s_mov_b32 m0, 114048
    s_nop 0
    buffer_load_dwordx4 v4, s[24:27], s60 offen offset:0 lds
    s_mov_b32 m0, 114592
    s_nop 0
    buffer_load_dwordx4 v4, s[24:27], s60 offen offset:512 lds
    s_mov_b32 m0, 115136
    s_nop 0
    buffer_load_dwordx4 v4, s[24:27], s60 offen offset:1024 lds
    s_mov_b32 m0, 115680
    s_nop 0
    buffer_load_dwordx4 v4, s[24:27], s60 offen offset:1536 lds
    s_add_u32 s60, s58, 6144
    s_mov_b32 m0, 118272
    s_nop 0
    buffer_load_dwordx4 v4, s[24:27], s60 offen offset:0 lds
    s_mov_b32 m0, 118816
    s_nop 0
    buffer_load_dwordx4 v4, s[24:27], s60 offen offset:512 lds
    s_mov_b32 m0, 119360
    s_nop 0
    buffer_load_dwordx4 v4, s[24:27], s60 offen offset:1024 lds
    s_mov_b32 m0, 119904
    s_nop 0
    buffer_load_dwordx4 v4, s[24:27], s60 offen offset:1536 lds
    s_add_u32 s60, s59, 0
    s_mov_b32 m0, 122496
    s_nop 0
    buffer_load_dwordx4 v4, s[28:31], s60 offen offset:0 lds
    s_mov_b32 m0, 123040
    s_nop 0
    buffer_load_dwordx4 v4, s[28:31], s60 offen offset:512 lds
    s_mov_b32 m0, 123584
    s_nop 0
    buffer_load_dwordx4 v4, s[28:31], s60 offen offset:1024 lds
    s_mov_b32 m0, 124128
    s_nop 0
    buffer_load_dwordx4 v4, s[28:31], s60 offen offset:1536 lds
    s_add_u32 s60, s59, 4096
    s_mov_b32 m0, 126720
    s_nop 0
    buffer_load_dwordx4 v4, s[28:31], s60 offen offset:0 lds
    s_mov_b32 m0, 127264
    s_nop 0
    buffer_load_dwordx4 v4, s[28:31], s60 offen offset:512 lds
    s_mov_b32 m0, 127808
    s_nop 0
    buffer_load_dwordx4 v4, s[28:31], s60 offen offset:1024 lds
    s_mov_b32 m0, 128352
    s_nop 0
    buffer_load_dwordx4 v4, s[28:31], s60 offen offset:1536 lds
    s_barrier
    v_add_u32 v5, 105600, v1
    s_lshr_b32 s58, s2, 4
    s_lshl_b32 s58, s58, 3
    s_and_b32 s59, s2, 7
    s_add_u32 s58, s58, s59
    s_lshl_b32 s58, s58, 1
    s_bfe_u32 s59, s2, 0x10003
    s_add_u32 s58, s58, s59
    s_lshl_b32 s58, s58, 10
    s_add_u32 s58, s58, 1048576
    v_lshlrev_b32 v6, 4, v0
    s_waitcnt vmcnt(0)
    ds_read_b128 v[16:19], v5 offset:0
    ds_read_b128 v[20:23], v5 offset:8448
    ds_read_b128 v[24:27], v5 offset:16896
    ds_read_b128 v[28:31], v5 offset:64
    ds_read_b128 v[32:35], v5 offset:8512
    ds_read_b128 v[36:39], v5 offset:16960
    ds_read_b128 v[40:43], v5 offset:128
    ds_read_b128 v[44:47], v5 offset:8576
    ds_read_b128 v[48:51], v5 offset:17024
    ds_read_b128 v[52:55], v5 offset:192
    ds_read_b128 v[56:59], v5 offset:8640
    ds_read_b128 v[60:63], v5 offset:17088
    s_waitcnt lgkmcnt(9)
    ds_read_b128 v[64:67], v5 offset:256
    ds_read_b128 v[68:71], v5 offset:8704
    ds_read_b128 v[72:75], v5 offset:17152
    v_mfma_f32_16x16x32_bf16 v[8:11], v[16:19], v[24:27], 0
    v_mfma_f32_16x16x32_bf16 v[12:15], v[20:23], v[24:27], 0
    s_waitcnt lgkmcnt(9)
    ds_read_b128 v[76:79], v5 offset:320
    ds_read_b128 v[80:83], v5 offset:8768
    ds_read_b128 v[84:87], v5 offset:17216
    v_mfma_f32_16x16x32_bf16 v[8:11], v[28:31], v[36:39], v[8:11]
    v_mfma_f32_16x16x32_bf16 v[12:15], v[32:35], v[36:39], v[12:15]
    s_waitcnt lgkmcnt(9)
    ds_read_b128 v[88:91], v5 offset:384
    ds_read_b128 v[92:95], v5 offset:8832
    ds_read_b128 v[96:99], v5 offset:17280
    v_mfma_f32_16x16x32_bf16 v[8:11], v[40:43], v[48:51], v[8:11]
    v_mfma_f32_16x16x32_bf16 v[12:15], v[44:47], v[48:51], v[12:15]
    s_waitcnt lgkmcnt(9)
    ds_read_b128 v[100:103], v5 offset:448
    ds_read_b128 v[104:107], v5 offset:8896
    ds_read_b128 v[108:111], v5 offset:17344
    v_mfma_f32_16x16x32_bf16 v[8:11], v[52:55], v[60:63], v[8:11]
    v_mfma_f32_16x16x32_bf16 v[12:15], v[56:59], v[60:63], v[12:15]
    s_waitcnt lgkmcnt(9)
    v_mfma_f32_16x16x32_bf16 v[8:11], v[64:67], v[72:75], v[8:11]
    v_mfma_f32_16x16x32_bf16 v[12:15], v[68:71], v[72:75], v[12:15]
    s_waitcnt lgkmcnt(6)
    v_mfma_f32_16x16x32_bf16 v[8:11], v[76:79], v[84:87], v[8:11]
    v_mfma_f32_16x16x32_bf16 v[12:15], v[80:83], v[84:87], v[12:15]
    s_waitcnt lgkmcnt(3)
    v_mfma_f32_16x16x32_bf16 v[8:11], v[88:91], v[96:99], v[8:11]
    v_mfma_f32_16x16x32_bf16 v[12:15], v[92:95], v[96:99], v[12:15]
    s_waitcnt lgkmcnt(0)
    v_mfma_f32_16x16x32_bf16 v[8:11], v[100:103], v[108:111], v[8:11]
    v_mfma_f32_16x16x32_bf16 v[12:15], v[104:107], v[108:111], v[12:15]
    s_nop 6
    v_cvt_pk_bf16_f32 v16, v8, v9
    v_cvt_pk_bf16_f32 v17, v10, v11
    v_cvt_pk_bf16_f32 v18, v12, v13
    v_cvt_pk_bf16_f32 v19, v14, v15
    buffer_store_dwordx4 v[16:19], v6, s[16:19], s58 offen sc1
    s_branch L_taskd
L_wtask:
    s_cmp_lt_u32 s2, 122
    s_cbranch_scc1 L_notask
    s_setprio 2
    s_sub_u32 s58, s2, 122
    s_cmp_lt_u32 s58, 64
    s_cselect_b32 s24, s50, s44
    s_cselect_b32 s25, s51, s45
    s_mov_b32 s26, 131072
    s_mov_b32 s27, 0x20000
    s_and_b32 s59, s58, 7
    s_lshl_b32 s59, s59, 14
    s_bfe_u32 s60, s58, 0x30003
    s_lshl_b32 s60, s60, 6
    s_add_u32 s59, s59, s60
    v_and_b32 v4, 15, v0
    v_lshlrev_b32 v4, 2, v4
    v_and_b32 v5, 48, v0
    v_lshl_add_u32 v4, v5, 8, v4
    buffer_load_dword v16, v4, s[24:27], s59 offen offset:0
    buffer_load_dword v17, v4, s[24:27], s59 offen offset:512
    buffer_load_dword v18, v4, s[24:27], s59 offen offset:1024
    buffer_load_dword v19, v4, s[24:27], s59 offen offset:1536
    buffer_load_dword v20, v4, s[24:27], s59 offen offset:2048
    buffer_load_dword v21, v4, s[24:27], s59 offen offset:2560
    buffer_load_dword v22, v4, s[24:27], s59 offen offset:3072
    buffer_load_dword v23, v4, s[24:27], s59 offen offset:3584
    s_barrier
    s_lshl_b32 s58, s58, 11
    s_add_u32 s58, s58, 1179648
    v_lshlrev_b32 v6, 4, v0
    s_waitcnt vmcnt(0)
    v_perm_b32 v24, v17, v16, s70
    v_perm_b32 v28, v17, v16, s71
    v_perm_b32 v25, v19, v18, s70
    v_perm_b32 v29, v19, v18, s71
    v_perm_b32 v26, v21, v20, s70
    v_perm_b32 v30, v21, v20, s71
    v_perm_b32 v27, v23, v22, s70
    v_perm_b32 v31, v23, v22, s71
    buffer_store_dwordx4 v[24:27], v6, s[16:19], s58 offen sc1
    buffer_store_dwordx4 v[28:31], v6, s[16:19], s58 offen offset:1024 sc1
    s_branch L_taskd
L_notask:
    s_barrier
L_taskd:
    s_waitcnt vmcnt(0)
    s_mov_b64 exec, 1
    v_mov_b32 v4, 1
    ds_add_u32 v3, v4 offset:8
    s_mov_b64 exec, -1
    s_branch L_preB
L_egrp:
    s_mov_b32 s24, s38
    s_mov_b32 s25, s39
    s_mov_b32 s26, 160000
    s_mov_b32 s27, 0x20000
    s_sub_u32 s59, s3, 6
    s_cmp_lt_u32 s3, 8
    s_cselect_b32 s61, s3, s59
    v_and_b32 v4, 32, v0
    s_mul_i32 s58, s6, 640
    s_lshl_b32 s59, s61, 6
    s_add_u32 s58, s58, s59
    buffer_load_dwordx4 v[16:19], v4, s[24:27], s58 offen
    buffer_load_dwordx4 v[20:23], v4, s[24:27], s58 offen offset:16
    s_barrier
    s_cmp_lt_u32 s3, 8
    s_cselect_b32 s58, 7, 6
    v_lshlrev_b32 v5, s58, v4
    v_add_u32 v5, v5, v2
    s_lshl_b32 s58, s3, 1
    s_add_u32 s58, s58, 4
    s_sub_u32 s59, s58, 16
    s_cmp_lt_u32 s3, 8
    s_cselect_b32 s58, s3, s58
    s_cselect_b32 s59, s3, s59
    s_cselect_b32 s62, 16, 1
    s_cselect_b32 s63, 8, 1
    s_lshl_b32 s62, s62, 9
    s_mul_i32 s63, s63, 1056
    s_add_u32 s58, s58, s5
    s_lshl_b32 s58, s58, 9
    s_mul_i32 s59, s59, 1056
    s_add_u32 m0, s59, 84480
    s_mul_i32 s61, s61, 8448
    buffer_load_dwordx4 v5, s[8:11], s58 offen lds
    s_add_u32 m0, m0, s63
    s_add_u32 s58, s58, s62
    buffer_load_dwordx4 v5, s[8:11], s58 offen lds
    s_waitcnt vmcnt(2)
    s_add_u32 m0, s61, 0
    v_lshl_add_u32 v4, v16, 9, v2
    s_waitcnt vmcnt(1)
    buffer_load_dwordx4 v4, s[8:11], 0 offen lds
    s_add_u32 m0, s61, 1056
    v_lshl_add_u32 v5, v17, 9, v2
    s_waitcnt vmcnt(1)
    buffer_load_dwordx4 v5, s[8:11], 0 offen lds
    s_add_u32 m0, s61, 2112
    v_lshl_add_u32 v4, v18, 9, v2
    s_waitcnt vmcnt(1)
    buffer_load_dwordx4 v4, s[8:11], 0 offen lds
    s_add_u32 m0, s61, 3168
    v_lshl_add_u32 v5, v19, 9, v2
    s_waitcnt vmcnt(1)
    buffer_load_dwordx4 v5, s[8:11], 0 offen lds
    s_add_u32 m0, s61, 4224
    v_lshl_add_u32 v4, v20, 9, v2
    s_waitcnt vmcnt(1)
    buffer_load_dwordx4 v4, s[8:11], 0 offen lds
    s_add_u32 m0, s61, 5280
    v_lshl_add_u32 v5, v21, 9, v2
    s_waitcnt vmcnt(1)
    buffer_load_dwordx4 v5, s[8:11], 0 offen lds
    s_add_u32 m0, s61, 6336
    v_lshl_add_u32 v4, v22, 9, v2
    s_waitcnt vmcnt(1)
    buffer_load_dwordx4 v4, s[8:11], 0 offen lds
    s_add_u32 m0, s61, 7392
    v_lshl_add_u32 v5, v23, 9, v2
    s_waitcnt vmcnt(1)
    buffer_load_dwordx4 v5, s[8:11], 0 offen lds
    s_waitcnt vmcnt(0)
    s_mov_b64 exec, 1
    v_mov_b32 v4, 1
    ds_add_u32 v3, v4 offset:0
    s_mov_b64 exec, -1
    s_cmp_ge_u32 s3, 8
    s_cbranch_scc1 L_preB
    v_and_b32 v4, 3, v0
    v_mov_b32 v5, 0x0c0c0c0c
    v_mov_b32 v6, 0x0c0c0302
    v_mov_b32 v7, 0x03020c0c
    v_cmp_eq_u32 s[58:59], 0, v4
    v_cmp_eq_u32 s[60:61], 2, v4
    v_cmp_eq_u32 vcc, 1, v4
    v_cndmask_b32 v10, v5, v6, s[58:59]
    v_cndmask_b32 v11, v5, v6, s[60:61]
    v_cndmask_b32 v10, v10, v7, vcc
    v_cmp_eq_u32 vcc, 3, v4
    s_nop 1
    v_cndmask_b32 v11, v11, v7, vcc
    v_and_b32 v8, 0xfdfdfdfd, v10
    v_and_b32 v9, 0xfdfdfdfd, v11
    s_mov_b32 s20, s52
    s_mov_b32 s21, s53
    s_mov_b32 s22, 5120000
    s_mov_b32 s23, 0x20000
    v_lshlrev_b32 v14, 4, v0
    s_lshl_b32 s100, s3, 14
    s_add_u32 s100, s100, 1048576
    v_add_u32 v12, 84480, v1
    s_lshl_b32 s61, s3, 6
    s_add_u32 s61, s61, 105600
    v_add_u32 v13, s61, v1
    s_mov_b32 s59, 0
Lw_3:
    ds_read_b32 v4, v3 offset:0
    s_waitcnt lgkmcnt(0)
    v_cmp_gt_u32 vcc, 10, v4
    s_cbranch_vccz Lk_4
    s_sleep 1
    s_add_u32 s59, s59, 1
    s_cmp_lt_u32 s59, 4194304
    s_cbranch_scc1 Lw_3
    s_branch L_end
Lk_4:
    ds_read_b128 v[80:83], v12 offset:0
    ds_read_b128 v[84:87], v12 offset:8448
    ds_read_b128 v[88:91], v12 offset:16896
    s_mov_b32 s59, 0
Lw_5:
    ds_read_b32 v4, v3 offset:32
    s_waitcnt lgkmcnt(0)
    v_cmp_gt_u32 vcc, 1, v4
    s_cbranch_vccz Lk_6
    s_sleep 1
    s_add_u32 s59, s59, 1
    s_cmp_lt_u32 s59, 4194304
    s_cbranch_scc1 Lw_5
    s_branch L_end
Lk_6:
    s_setprio 0
    buffer_load_dwordx4 v[16:19], v14, s[16:19], s100 offen offset:0 sc1
    buffer_load_dwordx4 v[20:23], v14, s[16:19], s100 offen offset:1024 sc1
    buffer_load_dwordx4 v[24:27], v14, s[16:19], s100 offen offset:2048 sc1
    buffer_load_dwordx4 v[28:31], v14, s[16:19], s100 offen offset:3072 sc1
    s_add_u32 s100, s100, 4096
    buffer_load_dwordx4 v[32:35], v14, s[16:19], s100 offen offset:0 sc1
    buffer_load_dwordx4 v[36:39], v14, s[16:19], s100 offen offset:1024 sc1
    buffer_load_dwordx4 v[40:43], v14, s[16:19], s100 offen offset:2048 sc1
    buffer_load_dwordx4 v[44:47], v14, s[16:19], s100 offen offset:3072 sc1
    s_add_u32 s100, s100, 4096
    buffer_load_dwordx4 v[48:51], v14, s[16:19], s100 offen offset:0 sc1
    buffer_load_dwordx4 v[52:55], v14, s[16:19], s100 offen offset:1024 sc1
    buffer_load_dwordx4 v[56:59], v14, s[16:19], s100 offen offset:2048 sc1
    buffer_load_dwordx4 v[60:63], v14, s[16:19], s100 offen offset:3072 sc1
    s_add_u32 s100, s100, 4096
    buffer_load_dwordx4 v[64:67], v14, s[16:19], s100 offen offset:0 sc1
    buffer_load_dwordx4 v[68:71], v14, s[16:19], s100 offen offset:1024 sc1
    buffer_load_dwordx4 v[72:75], v14, s[16:19], s100 offen offset:2048 sc1
    buffer_load_dwordx4 v[76:79], v14, s[16:19], s100 offen offset:3072 sc1
    ds_read_b128 v[92:95], v12 offset:64
    ds_read_b128 v[96:99], v12 offset:8512
    ds_read_b128 v[100:103], v12 offset:16960
    s_waitcnt vmcnt(14) lgkmcnt(3)
    v_mfma_f32_16x16x32_bf16 v[104:107], v[16:19], v[80:83], 0
    v_mfma_f32_16x16x32_bf16 v[108:111], v[20:23], v[80:83], 0
    v_mfma_f32_16x16x32_bf16 v[112:115], v[16:19], v[84:87], 0
    v_mfma_f32_16x16x32_bf16 v[116:119], v[20:23], v[84:87], 0
    v_mfma_f32_16x16x32_bf16 v[120:123], v[16:19], v[88:91], 0
    v_mfma_f32_16x16x32_bf16 v[124:127], v[20:23], v[88:91], 0
    s_add_u32 s100, s100, 118784
    buffer_load_dwordx4 v[16:19], v14, s[16:19], s100 offen offset:0 sc1
    buffer_load_dwordx4 v[20:23], v14, s[16:19], s100 offen offset:1024 sc1
    ds_read_b128 v[80:83], v12 offset:128
    ds_read_b128 v[84:87], v12 offset:8576
    ds_read_b128 v[88:91], v12 offset:17024
    s_waitcnt vmcnt(14) lgkmcnt(3)
    v_mfma_f32_16x16x32_bf16 v[104:107], v[24:27], v[92:95], v[104:107]
    v_mfma_f32_16x16x32_bf16 v[108:111], v[28:31], v[92:95], v[108:111]
    v_mfma_f32_16x16x32_bf16 v[112:115], v[24:27], v[96:99], v[112:115]
    v_mfma_f32_16x16x32_bf16 v[116:119], v[28:31], v[96:99], v[116:119]
    v_mfma_f32_16x16x32_bf16 v[120:123], v[24:27], v[100:103], v[120:123]
    v_mfma_f32_16x16x32_bf16 v[124:127], v[28:31], v[100:103], v[124:127]
    buffer_load_dwordx4 v[24:27], v14, s[16:19], s100 offen offset:2048 sc1
    buffer_load_dwordx4 v[28:31], v14, s[16:19], s100 offen offset:3072 sc1
    ds_read_b128 v[92:95], v12 offset:192
    ds_read_b128 v[96:99], v12 offset:8640
    ds_read_b128 v[100:103], v12 offset:17088
    s_waitcnt vmcnt(14) lgkmcnt(3)
    v_mfma_f32_16x16x32_bf16 v[104:107], v[32:35], v[80:83], v[104:107]
    v_mfma_f32_16x16x32_bf16 v[108:111], v[36:39], v[80:83], v[108:111]
    v_mfma_f32_16x16x32_bf16 v[112:115], v[32:35], v[84:87], v[112:115]
    v_mfma_f32_16x16x32_bf16 v[116:119], v[36:39], v[84:87], v[116:119]
    v_mfma_f32_16x16x32_bf16 v[120:123], v[32:35], v[88:91], v[120:123]
    v_mfma_f32_16x16x32_bf16 v[124:127], v[36:39], v[88:91], v[124:127]
    s_add_u32 s100, s100, 4096
    buffer_load_dwordx4 v[32:35], v14, s[16:19], s100 offen offset:0 sc1
    buffer_load_dwordx4 v[36:39], v14, s[16:19], s100 offen offset:1024 sc1
    ds_read_b128 v[80:83], v12 offset:256
    ds_read_b128 v[84:87], v12 offset:8704
    ds_read_b128 v[88:91], v12 offset:17152
    s_waitcnt vmcnt(14) lgkmcnt(3)
    v_mfma_f32_16x16x32_bf16 v[104:107], v[40:43], v[92:95], v[104:107]
    v_mfma_f32_16x16x32_bf16 v[108:111], v[44:47], v[92:95], v[108:111]
    v_mfma_f32_16x16x32_bf16 v[112:115], v[40:43], v[96:99], v[112:115]
    v_mfma_f32_16x16x32_bf16 v[116:119], v[44:47], v[96:99], v[116:119]
    v_mfma_f32_16x16x32_bf16 v[120:123], v[40:43], v[100:103], v[120:123]
    v_mfma_f32_16x16x32_bf16 v[124:127], v[44:47], v[100:103], v[124:127]
    buffer_load_dwordx4 v[40:43], v14, s[16:19], s100 offen offset:2048 sc1
    buffer_load_dwordx4 v[44:47], v14, s[16:19], s100 offen offset:3072 sc1
    ds_read_b128 v[92:95], v12 offset:320
    ds_read_b128 v[96:99], v12 offset:8768
    ds_read_b128 v[100:103], v12 offset:17216
    s_waitcnt vmcnt(14) lgkmcnt(3)
    v_mfma_f32_16x16x32_bf16 v[104:107], v[48:51], v[80:83], v[104:107]
    v_mfma_f32_16x16x32_bf16 v[108:111], v[52:55], v[80:83], v[108:111]
    v_mfma_f32_16x16x32_bf16 v[112:115], v[48:51], v[84:87], v[112:115]
    v_mfma_f32_16x16x32_bf16 v[116:119], v[52:55], v[84:87], v[116:119]
    v_mfma_f32_16x16x32_bf16 v[120:123], v[48:51], v[88:91], v[120:123]
    v_mfma_f32_16x16x32_bf16 v[124:127], v[52:55], v[88:91], v[124:127]
    s_add_u32 s100, s100, 4096
    buffer_load_dwordx4 v[48:51], v14, s[16:19], s100 offen offset:0 sc1
    buffer_load_dwordx4 v[52:55], v14, s[16:19], s100 offen offset:1024 sc1
    ds_read_b128 v[80:83], v12 offset:384
    ds_read_b128 v[84:87], v12 offset:8832
    ds_read_b128 v[88:91], v12 offset:17280
    s_waitcnt vmcnt(14) lgkmcnt(3)
    v_mfma_f32_16x16x32_bf16 v[104:107], v[56:59], v[92:95], v[104:107]
    v_mfma_f32_16x16x32_bf16 v[108:111], v[60:63], v[92:95], v[108:111]
    v_mfma_f32_16x16x32_bf16 v[112:115], v[56:59], v[96:99], v[112:115]
    v_mfma_f32_16x16x32_bf16 v[116:119], v[60:63], v[96:99], v[116:119]
    v_mfma_f32_16x16x32_bf16 v[120:123], v[56:59], v[100:103], v[120:123]
    v_mfma_f32_16x16x32_bf16 v[124:127], v[60:63], v[100:103], v[124:127]
    buffer_load_dwordx4 v[56:59], v14, s[16:19], s100 offen offset:2048 sc1
    buffer_load_dwordx4 v[60:63], v14, s[16:19], s100 offen offset:3072 sc1
    ds_read_b128 v[92:95], v12 offset:448
    ds_read_b128 v[96:99], v12 offset:8896
    ds_read_b128 v[100:103], v12 offset:17344
    s_waitcnt vmcnt(14) lgkmcnt(3)
    v_mfma_f32_16x16x32_bf16 v[104:107], v[64:67], v[80:83], v[104:107]
    v_mfma_f32_16x16x32_bf16 v[108:111], v[68:71], v[80:83], v[108:111]
    v_mfma_f32_16x16x32_bf16 v[112:115], v[64:67], v[84:87], v[112:115]
    v_mfma_f32_16x16x32_bf16 v[116:119], v[68:71], v[84:87], v[116:119]
    v_mfma_f32_16x16x32_bf16 v[120:123], v[64:67], v[88:91], v[120:123]
    v_mfma_f32_16x16x32_bf16 v[124:127], v[68:71], v[88:91], v[124:127]
    s_add_u32 s100, s100, 4096
    buffer_load_dwordx4 v[64:67], v14, s[16:19], s100 offen offset:0 sc1
    buffer_load_dwordx4 v[68:71], v14, s[16:19], s100 offen offset:1024 sc1
    s_waitcnt vmcnt(14) lgkmcnt(0)
    v_mfma_f32_16x16x32_bf16 v[104:107], v[72:75], v[92:95], v[104:107]
    v_mfma_f32_16x16x32_bf16 v[108:111], v[76:79], v[92:95], v[108:111]
    v_mfma_f32_16x16x32_bf16 v[112:115], v[72:75], v[96:99], v[112:115]
    v_mfma_f32_16x16x32_bf16 v[116:119], v[76:79], v[96:99], v[116:119]
    v_mfma_f32_16x16x32_bf16 v[120:123], v[72:75], v[100:103], v[120:123]
    v_mfma_f32_16x16x32_bf16 v[124:127], v[76:79], v[100:103], v[124:127]
    buffer_load_dwordx4 v[72:75], v14, s[16:19], s100 offen offset:2048 sc1
    buffer_load_dwordx4 v[76:79], v14, s[16:19], s100 offen offset:3072 sc1
    s_nop 1
    v_cvt_pk_bf16_f32 v80, v104, v105
    v_cvt_pk_bf16_f32 v81, v106, v107
    v_cvt_pk_bf16_f32 v82, v108, v109
    v_cvt_pk_bf16_f32 v83, v110, v111
    ds_write_b128 v13, v[80:83] offset:0
    v_cvt_pk_bf16_f32 v84, v112, v113
    v_cvt_pk_bf16_f32 v85, v114, v115
    v_cvt_pk_bf16_f32 v86, v116, v117
    v_cvt_pk_bf16_f32 v87, v118, v119
    ds_write_b128 v13, v[84:87] offset:8448
    v_cvt_pk_bf16_f32 v88, v120, v121
    v_cvt_pk_bf16_f32 v89, v122, v123
    v_cvt_pk_bf16_f32 v90, v124, v125
    v_cvt_pk_bf16_f32 v91, v126, v127
    ds_write_b128 v13, v[88:91] offset:16896
    s_mov_b64 exec, 1
    v_mov_b32 v4, 1
    ds_add_u32 v3, v4 offset:20
    s_mov_b64 exec, -1
    s_mov_b32 s63, s3
L_grp:
    s_mul_i32 s58, s63, 8448
    s_lshr_b32 s59, s63, 2
    s_mul_i32 s59, s59, 8448
    s_and_b32 s60, s63, 1
    s_bfe_u32 s61, s63, 0x10001
    s_cmp_ge_u32 s63, 8
    s_cselect_b32 s61, s60, s61
    s_cselect_b32 s60, 0, s60
    s_mul_i32 s60, s60, 4224
    s_lshl_b32 s61, s61, 9
    s_add_u32 s59, s59, s60
    s_add_u32 s59, s59, s61
    s_add_u32 s59, s59, 105600
    v_add_u32 v12, s58, v1
    v_bfe_u32 v4, v0, 2, 2
    v_mul_u32_u24 v4, 1056, v4
    v_and_b32 v5, 48, v0
    v_add3_u32 v13, v4, v5, s59
    v_lshl_add_u32 v14, v0, 3, s58
    v_lshl_add_u32 v2, v0, 3, s59
    s_cmp_ge_u32 s63, 8
    s_cbranch_scc1 L_grp2
    s_mov_b32 s59, 0
Lw_7:
    ds_read_b32 v4, v3 offset:20
    s_waitcnt lgkmcnt(0)
    v_cmp_gt_u32 vcc, 8, v4
    s_cbranch_vccz Lk_8
    s_add_u32 s59, s59, 1
    s_cmp_lt_u32 s59, 4194304
    s_cbranch_scc1 Lw_7
    s_branch L_end
Lk_8:
L_grp2:
    s_waitcnt lgkmcnt(0)
    ds_read_b128 v[80:83], v12 offset:0
    ds_read_b128 v[84:87], v13 offset:0
    ds_read_b128 v[88:91], v12 offset:64
    ds_read_b128 v[92:95], v13 offset:64
    ds_read_b128 v[96:99], v12 offset:128
    ds_read_b128 v[100:103], v13 offset:128
    ds_read_b128 v[104:107], v12 offset:192
    ds_read_b128 v[108:111], v13 offset:192
    ds_read_b128 v[112:115], v12 offset:256
    ds_read_b128 v[116:119], v13 offset:256
    ds_read_b128 v[120:123], v12 offset:320
    ds_read_b128 v[124:127], v13 offset:320
    s_waitcnt lgkmcnt(10)
    v_mfma_f32_16x16x32_bf16 v[4:7], v[80:83], v[84:87], 0
    ds_read_b128 v[80:83], v12 offset:384
    ds_read_b128 v[84:87], v13 offset:384
    s_waitcnt lgkmcnt(10)
    v_mfma_f32_16x16x32_bf16 v[4:7], v[88:91], v[92:95], v[4:7]
    ds_read_b128 v[88:91], v12 offset:448
    ds_read_b128 v[92:95], v13 offset:448
    s_waitcnt lgkmcnt(10)
    v_mfma_f32_16x16x32_bf16 v[4:7], v[96:99], v[100:103], v[4:7]
    s_waitcnt lgkmcnt(8)
    v_mfma_f32_16x16x32_bf16 v[4:7], v[104:107], v[108:111], v[4:7]
    s_waitcnt lgkmcnt(6)
    v_mfma_f32_16x16x32_bf16 v[4:7], v[112:115], v[116:119], v[4:7]
    s_waitcnt lgkmcnt(4)
    v_mfma_f32_16x16x32_bf16 v[4:7], v[120:123], v[124:127], v[4:7]
    s_waitcnt lgkmcnt(2)
    v_mfma_f32_16x16x32_bf16 v[4:7], v[80:83], v[84:87], v[4:7]
    s_waitcnt lgkmcnt(0)
    v_mfma_f32_16x16x32_bf16 v[4:7], v[88:91], v[92:95], v[4:7]
    ds_read_b64 v[96:97], v14 offset:2112
    ds_read_b64 v[98:99], v14 offset:6336
    ds_read_b64 v[100:101], v14 offset:2624
    ds_read_b64 v[102:103], v14 offset:6848
    ds_read_b64 v[104:105], v14 offset:3168
    ds_read_b64 v[106:107], v14 offset:7392
    ds_read_b64 v[108:109], v14 offset:3680
    ds_read_b64 v[110:111], v14 offset:7904
    ds_read_b64 v[80:81], v14 offset:0
    ds_read_b64 v[82:83], v14 offset:4224
    ds_read_b64 v[84:85], v14 offset:512
    ds_read_b64 v[86:87], v14 offset:4736
    ds_read_b64 v[88:89], v14 offset:1056
    ds_read_b64 v[90:91], v14 offset:5280
    ds_read_b64 v[92:93], v14 offset:1568
    s_waitcnt lgkmcnt(14)
    ds_read_b64 v[94:95], v14 offset:5792
    v_mul_f32 v4, 0x3db8aa3b, v4
    v_mul_f32 v5, 0x3db8aa3b, v5
    v_mul_f32 v6, 0x3db8aa3b, v6
    v_mul_f32 v7, 0x3db8aa3b, v7
    v_exp_f32 v4, v4
    v_exp_f32 v5, v5
    v_exp_f32 v6, v6
    v_exp_f32 v7, v7
    v_add_f32 v12, v4, v5
    v_add_f32 v13, v6, v7
    v_add_f32 v12, v12, v13
    v_add_f32 v12, 0x3089705f, v12
    v_rcp_f32 v12, v12
    s_add_u32 s63, s63, 8
    v_mul_f32 v4, v4, v12
    v_mul_f32 v5, v5, v12
    v_mul_f32 v6, v6, v12
    v_mul_f32 v7, v7, v12
    v_cvt_pk_bf16_f32 v4, v4, v5
    v_cvt_pk_bf16_f32 v6, v6, v7
    v_perm_b32 v112, v4, v4, v8
    v_perm_b32 v113, v4, v4, v9
    v_perm_b32 v114, v4, v4, v10
    v_perm_b32 v115, v4, v4, v11
    v_perm_b32 v116, v6, v6, v8
    v_perm_b32 v117, v6, v6, v9
    v_perm_b32 v118, v6, v6, v10
    v_perm_b32 v119, v6, v6, v11
    s_waitcnt lgkmcnt(0)
    v_mfma_f32_4x4x4_16b_bf16 v[120:123], v[112:113], v[80:81], 0 cbsz:4 abid:0
    v_mfma_f32_4x4x4_16b_bf16 v[124:127], v[112:113], v[82:83], 0 cbsz:4 abid:5
    v_mfma_f32_4x4x4_16b_bf16 v[4:7], v[112:113], v[84:85], 0 cbsz:4 abid:10
    v_mfma_f32_4x4x4_16b_bf16 v[12:15], v[112:113], v[86:87], 0 cbsz:4 abid:15
    v_mfma_f32_4x4x4_16b_bf16 v[120:123], v[114:115], v[88:89], v[120:123] cbsz:4 abid:0
    v_mfma_f32_4x4x4_16b_bf16 v[124:127], v[114:115], v[90:91], v[124:127] cbsz:4 abid:5
    v_mfma_f32_4x4x4_16b_bf16 v[4:7], v[114:115], v[92:93], v[4:7] cbsz:4 abid:10
    v_mfma_f32_4x4x4_16b_bf16 v[12:15], v[114:115], v[94:95], v[12:15] cbsz:4 abid:15
    v_mfma_f32_4x4x4_16b_bf16 v[120:123], v[116:117], v[96:97], v[120:123] cbsz:4 abid:0
    v_mfma_f32_4x4x4_16b_bf16 v[124:127], v[116:117], v[98:99], v[124:127] cbsz:4 abid:5
    v_mfma_f32_4x4x4_16b_bf16 v[4:7], v[116:117], v[100:101], v[4:7] cbsz:4 abid:10
    v_mfma_f32_4x4x4_16b_bf16 v[12:15], v[116:117], v[102:103], v[12:15] cbsz:4 abid:15
    v_mfma_f32_4x4x4_16b_bf16 v[120:123], v[118:119], v[104:105], v[120:123] cbsz:4 abid:0
    v_mfma_f32_4x4x4_16b_bf16 v[124:127], v[118:119], v[106:107], v[124:127] cbsz:4 abid:5
    v_mfma_f32_4x4x4_16b_bf16 v[4:7], v[118:119], v[108:109], v[4:7] cbsz:4 abid:10
    v_mfma_f32_4x4x4_16b_bf16 v[12:15], v[118:119], v[110:111], v[12:15] cbsz:4 abid:15
    s_nop 1
    v_cvt_pk_bf16_f32 v112, v120, v121
    v_cvt_pk_bf16_f32 v113, v122, v123
    ds_write_b64 v2, v[112:113] offset:0
    v_cvt_pk_bf16_f32 v114, v124, v125
    v_cvt_pk_bf16_f32 v115, v126, v127
    ds_write_b64 v2, v[114:115] offset:1056
    v_cvt_pk_bf16_f32 v116, v4, v5
    v_cvt_pk_bf16_f32 v117, v6, v7
    ds_write_b64 v2, v[116:117] offset:2112
    v_cvt_pk_bf16_f32 v118, v12, v13
    v_cvt_pk_bf16_f32 v119, v14, v15
    ds_write_b64 v2, v[118:119] offset:3168
    s_cmp_lt_u32 s63, 10
    s_cbranch_scc1 L_grp
    s_mov_b64 exec, 1
    v_mov_b32 v4, 1
    ds_add_u32 v3, v4 offset:24
    s_mov_b64 exec, -1
    v_add_u32 v12, 105600, v1
    v_lshlrev_b32 v14, 4, v0
    v_and_b32 v6, 15, v0
    v_lshlrev_b32 v6, 2, v6
    v_and_b32 v5, 48, v0
    v_lshl_add_u32 v8, v5, 7, v6
    v_and_b32 v5, 32, v0
    v_lshl_add_u32 v9, v5, 6, v6
    v_and_b32 v5, 16, v0
    v_lshl_add_u32 v9, v5, 22, v9
    s_lshl_b32 s60, s5, 9
    s_lshl_b32 s61, s3, 6
    s_add_u32 s60, s60, s61
    s_mov_b32 s59, 0
Lw_9:
    ds_read_b32 v4, v3 offset:24
    s_waitcnt lgkmcnt(0)
    v_cmp_gt_u32 vcc, 8, v4
    s_cbranch_vccz Lk_10
    s_add_u32 s59, s59, 1
    s_cmp_lt_u32 s59, 4194304
    s_cbranch_scc1 Lw_9
    s_branch L_end
Lk_10:
    ds_read_b128 v[80:83], v12 offset:0
    ds_read_b128 v[84:87], v12 offset:8448
    ds_read_b128 v[88:91], v12 offset:16896
    ds_read_b128 v[92:95], v12 offset:64
    ds_read_b128 v[96:99], v12 offset:8512
    ds_read_b128 v[100:103], v12 offset:16960
    s_waitcnt vmcnt(14) lgkmcnt(3)
    v_mfma_f32_16x16x32_bf16 v[104:107], v[80:83], v[16:19], 0
    v_mfma_f32_16x16x32_bf16 v[108:111], v[80:83], v[20:23], 0
    v_mfma_f32_16x16x32_bf16 v[112:115], v[84:87], v[16:19], 0
    v_mfma_f32_16x16x32_bf16 v[116:119], v[84:87], v[20:23], 0
    v_mfma_f32_16x16x32_bf16 v[120:123], v[88:91], v[16:19], 0
    v_mfma_f32_16x16x32_bf16 v[124:127], v[88:91], v[20:23], 0
    s_add_u32 s100, s100, 118784
    buffer_load_dwordx4 v[16:19], v14, s[16:19], s100 offen offset:0 sc1
    buffer_load_dwordx4 v[20:23], v14, s[16:19], s100 offen offset:1024 sc1
    ds_read_b128 v[80:83], v12 offset:128
    ds_read_b128 v[84:87], v12 offset:8576
    ds_read_b128 v[88:91], v12 offset:17024
    s_waitcnt vmcnt(14) lgkmcnt(3)
    v_mfma_f32_16x16x32_bf16 v[104:107], v[92:95], v[24:27], v[104:107]
    v_mfma_f32_16x16x32_bf16 v[108:111], v[92:95], v[28:31], v[108:111]
    v_mfma_f32_16x16x32_bf16 v[112:115], v[96:99], v[24:27], v[112:115]
    v_mfma_f32_16x16x32_bf16 v[116:119], v[96:99], v[28:31], v[116:119]
    v_mfma_f32_16x16x32_bf16 v[120:123], v[100:103], v[24:27], v[120:123]
    v_mfma_f32_16x16x32_bf16 v[124:127], v[100:103], v[28:31], v[124:127]
    buffer_load_dwordx4 v[24:27], v14, s[16:19], s100 offen offset:2048 sc1
    buffer_load_dwordx4 v[28:31], v14, s[16:19], s100 offen offset:3072 sc1
    ds_read_b128 v[92:95], v12 offset:192
    ds_read_b128 v[96:99], v12 offset:8640
    ds_read_b128 v[100:103], v12 offset:17088
    s_waitcnt vmcnt(14) lgkmcnt(3)
    v_mfma_f32_16x16x32_bf16 v[104:107], v[80:83], v[32:35], v[104:107]
    v_mfma_f32_16x16x32_bf16 v[108:111], v[80:83], v[36:39], v[108:111]
    v_mfma_f32_16x16x32_bf16 v[112:115], v[84:87], v[32:35], v[112:115]
    v_mfma_f32_16x16x32_bf16 v[116:119], v[84:87], v[36:39], v[116:119]
    v_mfma_f32_16x16x32_bf16 v[120:123], v[88:91], v[32:35], v[120:123]
    v_mfma_f32_16x16x32_bf16 v[124:127], v[88:91], v[36:39], v[124:127]
    s_add_u32 s100, s100, 4096
    buffer_load_dwordx4 v[32:35], v14, s[16:19], s100 offen offset:0 sc1
    buffer_load_dwordx4 v[36:39], v14, s[16:19], s100 offen offset:1024 sc1
    ds_read_b128 v[80:83], v12 offset:256
    ds_read_b128 v[84:87], v12 offset:8704
    ds_read_b128 v[88:91], v12 offset:17152
    s_waitcnt vmcnt(14) lgkmcnt(3)
    v_mfma_f32_16x16x32_bf16 v[104:107], v[92:95], v[40:43], v[104:107]
    v_mfma_f32_16x16x32_bf16 v[108:111], v[92:95], v[44:47], v[108:111]
    v_mfma_f32_16x16x32_bf16 v[112:115], v[96:99], v[40:43], v[112:115]
    v_mfma_f32_16x16x32_bf16 v[116:119], v[96:99], v[44:47], v[116:119]
    v_mfma_f32_16x16x32_bf16 v[120:123], v[100:103], v[40:43], v[120:123]
    v_mfma_f32_16x16x32_bf16 v[124:127], v[100:103], v[44:47], v[124:127]
    buffer_load_dwordx4 v[40:43], v14, s[16:19], s100 offen offset:2048 sc1
    buffer_load_dwordx4 v[44:47], v14, s[16:19], s100 offen offset:3072 sc1
    ds_read_b128 v[92:95], v12 offset:320
    ds_read_b128 v[96:99], v12 offset:8768
    ds_read_b128 v[100:103], v12 offset:17216
    s_waitcnt vmcnt(14) lgkmcnt(3)
    v_mfma_f32_16x16x32_bf16 v[104:107], v[80:83], v[48:51], v[104:107]
    v_mfma_f32_16x16x32_bf16 v[108:111], v[80:83], v[52:55], v[108:111]
    v_mfma_f32_16x16x32_bf16 v[112:115], v[84:87], v[48:51], v[112:115]
    v_mfma_f32_16x16x32_bf16 v[116:119], v[84:87], v[52:55], v[116:119]
    v_mfma_f32_16x16x32_bf16 v[120:123], v[88:91], v[48:51], v[120:123]
    v_mfma_f32_16x16x32_bf16 v[124:127], v[88:91], v[52:55], v[124:127]
    s_add_u32 s100, s100, 4096
    buffer_load_dwordx4 v[48:51], v14, s[16:19], s100 offen offset:0 sc1
    buffer_load_dwordx4 v[52:55], v14, s[16:19], s100 offen offset:1024 sc1
    ds_read_b128 v[80:83], v12 offset:384
    ds_read_b128 v[84:87], v12 offset:8832
    ds_read_b128 v[88:91], v12 offset:17280
    s_waitcnt vmcnt(14) lgkmcnt(3)
    v_mfma_f32_16x16x32_bf16 v[104:107], v[92:95], v[56:59], v[104:107]
    v_mfma_f32_16x16x32_bf16 v[108:111], v[92:95], v[60:63], v[108:111]
    v_mfma_f32_16x16x32_bf16 v[112:115], v[96:99], v[56:59], v[112:115]
    v_mfma_f32_16x16x32_bf16 v[116:119], v[96:99], v[60:63], v[116:119]
    v_mfma_f32_16x16x32_bf16 v[120:123], v[100:103], v[56:59], v[120:123]
    v_mfma_f32_16x16x32_bf16 v[124:127], v[100:103], v[60:63], v[124:127]
    buffer_load_dwordx4 v[56:59], v14, s[16:19], s100 offen offset:2048 sc1
    buffer_load_dwordx4 v[60:63], v14, s[16:19], s100 offen offset:3072 sc1
    ds_read_b128 v[92:95], v12 offset:448
    ds_read_b128 v[96:99], v12 offset:8896
    ds_read_b128 v[100:103], v12 offset:17344
    s_waitcnt vmcnt(14) lgkmcnt(3)
    v_mfma_f32_16x16x32_bf16 v[104:107], v[80:83], v[64:67], v[104:107]
    v_mfma_f32_16x16x32_bf16 v[108:111], v[80:83], v[68:71], v[108:111]
    v_mfma_f32_16x16x32_bf16 v[112:115], v[84:87], v[64:67], v[112:115]
    v_mfma_f32_16x16x32_bf16 v[116:119], v[84:87], v[68:71], v[116:119]
    v_mfma_f32_16x16x32_bf16 v[120:123], v[88:91], v[64:67], v[120:123]
    v_mfma_f32_16x16x32_bf16 v[124:127], v[88:91], v[68:71], v[124:127]
    s_add_u32 s100, s100, 4096
    buffer_load_dwordx4 v[64:67], v14, s[16:19], s100 offen offset:0 sc1
    buffer_load_dwordx4 v[68:71], v14, s[16:19], s100 offen offset:1024 sc1
    s_waitcnt vmcnt(14) lgkmcnt(0)
    v_mfma_f32_16x16x32_bf16 v[104:107], v[92:95], v[72:75], v[104:107]
    v_mfma_f32_16x16x32_bf16 v[108:111], v[92:95], v[76:79], v[108:111]
    v_mfma_f32_16x16x32_bf16 v[112:115], v[96:99], v[72:75], v[112:115]
    v_mfma_f32_16x16x32_bf16 v[116:119], v[96:99], v[76:79], v[116:119]
    v_mfma_f32_16x16x32_bf16 v[120:123], v[100:103], v[72:75], v[120:123]
    v_mfma_f32_16x16x32_bf16 v[124:127], v[100:103], v[76:79], v[124:127]
    buffer_load_dwordx4 v[72:75], v14, s[16:19], s100 offen offset:2048 sc1
    buffer_load_dwordx4 v[76:79], v14, s[16:19], s100 offen offset:3072 sc1
    v_add_u32 v12, 130944, v1
    s_mov_b32 s59, 0
Lw_11:
    ds_read_b32 v4, v3 offset:36
    s_waitcnt lgkmcnt(0)
    v_cmp_gt_u32 vcc, 16, v4
    s_cbranch_vccz Lk_12
    s_sleep 1
    s_add_u32 s59, s59, 1
    s_cmp_lt_u32 s59, 16777216
    s_cbranch_scc1 Lw_11
    s_branch L_end
Lk_12:
    ds_read_b128 v[80:83], v12 offset:0
    ds_read_b128 v[84:87], v12 offset:64
    ds_read_b128 v[88:91], v12 offset:128
    ds_read_b128 v[92:95], v12 offset:192
    ds_read_b128 v[96:99], v12 offset:256
    ds_read_b128 v[100:103], v12 offset:320
    s_waitcnt vmcnt(14) lgkmcnt(5)
    v_mfma_f32_16x16x32_bf16 v[104:107], v[80:83], v[16:19], v[104:107]
    v_mfma_f32_16x16x32_bf16 v[108:111], v[80:83], v[20:23], v[108:111]
    ds_read_b128 v[80:83], v12 offset:384
    s_waitcnt vmcnt(12) lgkmcnt(5)
    v_mfma_f32_16x16x32_bf16 v[104:107], v[84:87], v[24:27], v[104:107]
    v_mfma_f32_16x16x32_bf16 v[108:111], v[84:87], v[28:31], v[108:111]
    ds_read_b128 v[84:87], v12 offset:448
    s_waitcnt vmcnt(10) lgkmcnt(5)
    v_mfma_f32_16x16x32_bf16 v[104:107], v[88:91], v[32:35], v[104:107]
    v_mfma_f32_16x16x32_bf16 v[108:111], v[88:91], v[36:39], v[108:111]
    s_waitcnt vmcnt(8) lgkmcnt(4)
    v_mfma_f32_16x16x32_bf16 v[104:107], v[92:95], v[40:43], v[104:107]
    v_mfma_f32_16x16x32_bf16 v[108:111], v[92:95], v[44:47], v[108:111]
    s_waitcnt vmcnt(6) lgkmcnt(3)
    v_mfma_f32_16x16x32_bf16 v[104:107], v[96:99], v[48:51], v[104:107]
    v_mfma_f32_16x16x32_bf16 v[108:111], v[96:99], v[52:55], v[108:111]
    s_waitcnt vmcnt(4) lgkmcnt(2)
    v_mfma_f32_16x16x32_bf16 v[104:107], v[100:103], v[56:59], v[104:107]
    v_mfma_f32_16x16x32_bf16 v[108:111], v[100:103], v[60:63], v[108:111]
    s_waitcnt vmcnt(2) lgkmcnt(1)
    v_mfma_f32_16x16x32_bf16 v[104:107], v[80:83], v[64:67], v[104:107]
    v_mfma_f32_16x16x32_bf16 v[108:111], v[80:83], v[68:71], v[108:111]
    s_waitcnt vmcnt(0) lgkmcnt(0)
    v_mfma_f32_16x16x32_bf16 v[104:107], v[84:87], v[72:75], v[104:107]
    v_mfma_f32_16x16x32_bf16 v[108:111], v[84:87], v[76:79], v[108:111]
    s_nop 7
    v_cvt_pk_bf16_f32 v104, v104, v108
    buffer_store_dword v104, v8, s[20:23], s60 offen offset:0
    v_cvt_pk_bf16_f32 v105, v105, v109
    buffer_store_dword v105, v8, s[20:23], s60 offen offset:512
    v_cvt_pk_bf16_f32 v106, v106, v110
    buffer_store_dword v106, v8, s[20:23], s60 offen offset:1024
    v_cvt_pk_bf16_f32 v107, v107, v111
    buffer_store_dword v107, v8, s[20:23], s60 offen offset:1536
    s_add_u32 s60, s60, 8192
    s_mov_b32 s59, 0
Lw_13:
    ds_read_b32 v4, v3 offset:40
    s_waitcnt lgkmcnt(0)
    v_cmp_gt_u32 vcc, 16, v4
    s_cbranch_vccz Lk_14
    s_sleep 1
    s_add_u32 s59, s59, 1
    s_cmp_lt_u32 s59, 16777216
    s_cbranch_scc1 Lw_13
    s_branch L_end
Lk_14:
    ds_read_b128 v[80:83], v12 offset:8448
    ds_read_b128 v[84:87], v12 offset:8512
    ds_read_b128 v[88:91], v12 offset:8576
    ds_read_b128 v[92:95], v12 offset:8640
    ds_read_b128 v[96:99], v12 offset:8704
    ds_read_b128 v[100:103], v12 offset:8768
    s_waitcnt lgkmcnt(5)
    v_mfma_f32_16x16x32_bf16 v[112:115], v[80:83], v[16:19], v[112:115]
    v_mfma_f32_16x16x32_bf16 v[116:119], v[80:83], v[20:23], v[116:119]
    ds_read_b128 v[80:83], v12 offset:8832
    s_waitcnt lgkmcnt(5)
    v_mfma_f32_16x16x32_bf16 v[112:115], v[84:87], v[24:27], v[112:115]
    v_mfma_f32_16x16x32_bf16 v[116:119], v[84:87], v[28:31], v[116:119]
    ds_read_b128 v[84:87], v12 offset:8896
    s_waitcnt lgkmcnt(5)
    v_mfma_f32_16x16x32_bf16 v[112:115], v[88:91], v[32:35], v[112:115]
    v_mfma_f32_16x16x32_bf16 v[116:119], v[88:91], v[36:39], v[116:119]
    s_waitcnt lgkmcnt(4)
    v_mfma_f32_16x16x32_bf16 v[112:115], v[92:95], v[40:43], v[112:115]
    v_mfma_f32_16x16x32_bf16 v[116:119], v[92:95], v[44:47], v[116:119]
    s_waitcnt lgkmcnt(3)
    v_mfma_f32_16x16x32_bf16 v[112:115], v[96:99], v[48:51], v[112:115]
    v_mfma_f32_16x16x32_bf16 v[116:119], v[96:99], v[52:55], v[116:119]
    s_waitcnt lgkmcnt(2)
    v_mfma_f32_16x16x32_bf16 v[112:115], v[100:103], v[56:59], v[112:115]
    v_mfma_f32_16x16x32_bf16 v[116:119], v[100:103], v[60:63], v[116:119]
    s_waitcnt lgkmcnt(1)
    v_mfma_f32_16x16x32_bf16 v[112:115], v[80:83], v[64:67], v[112:115]
    v_mfma_f32_16x16x32_bf16 v[116:119], v[80:83], v[68:71], v[116:119]
    s_waitcnt lgkmcnt(0)
    v_mfma_f32_16x16x32_bf16 v[112:115], v[84:87], v[72:75], v[112:115]
    v_mfma_f32_16x16x32_bf16 v[116:119], v[84:87], v[76:79], v[116:119]
    s_nop 7
    v_cvt_pk_bf16_f32 v112, v112, v116
    buffer_store_dword v112, v8, s[20:23], s60 offen offset:0
    v_cvt_pk_bf16_f32 v113, v113, v117
    buffer_store_dword v113, v8, s[20:23], s60 offen offset:512
    v_cvt_pk_bf16_f32 v114, v114, v118
    buffer_store_dword v114, v8, s[20:23], s60 offen offset:1024
    v_cvt_pk_bf16_f32 v115, v115, v119
    buffer_store_dword v115, v8, s[20:23], s60 offen offset:1536
    s_add_u32 s60, s60, 8192
    s_mov_b32 s59, 0
Lw_15:
    ds_read_b32 v4, v3 offset:44
    s_waitcnt lgkmcnt(0)
    v_cmp_gt_u32 vcc, 8, v4
    s_cbranch_vccz Lk_16
    s_add_u32 s59, s59, 1
    s_cmp_lt_u32 s59, 16777216
    s_cbranch_scc1 Lw_15
    s_branch L_end
Lk_16:
    ds_read_b128 v[80:83], v12 offset:16896
    ds_read_b128 v[84:87], v12 offset:16960
    ds_read_b128 v[88:91], v12 offset:17024
    ds_read_b128 v[92:95], v12 offset:17088
    ds_read_b128 v[96:99], v12 offset:17152
    ds_read_b128 v[100:103], v12 offset:17216
    s_waitcnt lgkmcnt(5)
    v_mfma_f32_16x16x32_bf16 v[120:123], v[80:83], v[16:19], v[120:123]
    v_mfma_f32_16x16x32_bf16 v[124:127], v[80:83], v[20:23], v[124:127]
    ds_read_b128 v[80:83], v12 offset:17280
    s_waitcnt lgkmcnt(5)
    v_mfma_f32_16x16x32_bf16 v[120:123], v[84:87], v[24:27], v[120:123]
    v_mfma_f32_16x16x32_bf16 v[124:127], v[84:87], v[28:31], v[124:127]
    ds_read_b128 v[84:87], v12 offset:17344
    s_waitcnt lgkmcnt(5)
    v_mfma_f32_16x16x32_bf16 v[120:123], v[88:91], v[32:35], v[120:123]
    v_mfma_f32_16x16x32_bf16 v[124:127], v[88:91], v[36:39], v[124:127]
    s_waitcnt lgkmcnt(4)
    v_mfma_f32_16x16x32_bf16 v[120:123], v[92:95], v[40:43], v[120:123]
    v_mfma_f32_16x16x32_bf16 v[124:127], v[92:95], v[44:47], v[124:127]
    s_waitcnt lgkmcnt(3)
    v_mfma_f32_16x16x32_bf16 v[120:123], v[96:99], v[48:51], v[120:123]
    v_mfma_f32_16x16x32_bf16 v[124:127], v[96:99], v[52:55], v[124:127]
    s_waitcnt lgkmcnt(2)
    v_mfma_f32_16x16x32_bf16 v[120:123], v[100:103], v[56:59], v[120:123]
    v_mfma_f32_16x16x32_bf16 v[124:127], v[100:103], v[60:63], v[124:127]
    s_waitcnt lgkmcnt(1)
    v_mfma_f32_16x16x32_bf16 v[120:123], v[80:83], v[64:67], v[120:123]
    v_mfma_f32_16x16x32_bf16 v[124:127], v[80:83], v[68:71], v[124:127]
    s_waitcnt lgkmcnt(0)
    v_mfma_f32_16x16x32_bf16 v[120:123], v[84:87], v[72:75], v[120:123]
    v_mfma_f32_16x16x32_bf16 v[124:127], v[84:87], v[76:79], v[124:127]
    s_nop 7
    v_cvt_pk_bf16_f32 v120, v120, v124
    buffer_store_dword v120, v9, s[20:23], s60 offen offset:0
    v_cvt_pk_bf16_f32 v121, v121, v125
    buffer_store_dword v121, v9, s[20:23], s60 offen offset:512
    v_cvt_pk_bf16_f32 v122, v122, v126
    buffer_store_dword v122, v9, s[20:23], s60 offen offset:1024
    v_cvt_pk_bf16_f32 v123, v123, v127
    buffer_store_dword v123, v9, s[20:23], s60 offen offset:1536
    s_branch L_end
L_preB:
    s_mov_b32 s24, s56
    s_mov_b32 s25, s57
    s_mov_b32 s26, 256000
    s_mov_b32 s27, 0x20000
    v_and_b32 v4, 3, v0
    v_mov_b32 v5, 0x0c0c0c0c
    v_mov_b32 v6, 0x0c0c0302
    v_mov_b32 v7, 0x03020c0c
    v_cmp_eq_u32 s[58:59], 0, v4
    v_cmp_eq_u32 s[60:61], 2, v4
    v_cmp_eq_u32 vcc, 1, v4
    v_cndmask_b32 v10, v5, v6, s[58:59]
    v_cndmask_b32 v11, v5, v6, s[60:61]
    v_cndmask_b32 v10, v10, v7, vcc
    v_cmp_eq_u32 vcc, 3, v4
    s_nop 1
    v_cndmask_b32 v11, v11, v7, vcc
    s_lshl_b32 s58, s4, 5
    v_lshrrev_b32 v5, 1, v0
    v_add_u32 v5, s58, v5
    v_lshlrev_b32 v55, 10, v5
    v_mul_u32_u24 v49, 2560, v5
    v_and_b32 v57, 1, v0
    v_lshl_add_u32 v49, v57, 4, v49
    v_lshlrev_b32 v57, 2, v57
    v_lshrrev_b32 v5, 3, v0
    v_and_b32 v6, 7, v0
    v_cmp_gt_u32 s[62:63], 5, v6
    v_lshl_add_u32 v50, v6, 3, v5
    v_mul_u32_u24 v56, 640, v5
    v_add_u32 v56, 152704, v56
    v_lshrrev_b32 v5, 4, v50
    v_mul_u32_u24 v9, 8448, v5
    v_lshl_add_u32 v9, v5, 26, v9
    v_cmp_le_u32 vcc, 32, v50
    v_and_b32 v5, 7, v50
    v_and_b32 v6, 3, v50
    v_cndmask_b32 v5, v5, v6, vcc
    v_mul_u32_u24 v5, 1056, v5
    v_bfe_u32 v6, v50, 3, 1
    v_bfe_u32 v7, v50, 2, 1
    v_cndmask_b32 v6, v6, v7, vcc
    v_lshl_add_u32 v5, v6, 9, v5
    v_mov_b32 v53, 130944
    v_add3_u32 v9, v9, v5, v53
    v_lshrrev_b32 v5, 5, v0
    v_lshl_add_u32 v15, v5, 3, v2
    v_mov_b32 v52, 4
    s_lshl_b32 s58, s5, 2
    s_sub_u32 s58, 157184, s58
    v_mov_b32 v54, s58
    v_add_u32 v5, s5, v50
    v_lshl_add_u32 v8, v5, 1, v53
    v_lshlrev_b32 v50, 2, v50
    v_add_u32 v50, 157184, v50
    s_lshl_b32 s60, s6, 2
    s_mov_b32 s61, 262144
    s_cmp_eq_u32 s3, 8
    s_cbranch_scc0 L_gow
    s_and_b32 s58, s2, 7
    s_mul_i32 s58, s58, 4096
    s_add_u32 s58, s58, 1572864
    s_mov_b32 s59, 0
    s_mov_b64 exec, 65535
L_poll:
    buffer_load_dword v76, v78, s[16:19], s58 offen sc1
    s_add_u32 s59, s59, 1
    s_cmp_gt_u32 s59, 0x40000
    s_cbranch_scc1 L_end
    s_waitcnt vmcnt(0)
    v_cmp_ne_u32 vcc, v76, v79
    s_cbranch_vccz L_polled
    s_sleep 2
    s_branch L_poll
L_polled:
    s_mov_b64 exec, 1
    v_mov_b32 v4, 1
    ds_add_u32 v3, v4 offset:32
    s_mov_b64 exec, -1
    s_branch L_go
L_gow:
    s_mov_b32 s59, 0
Lw_17:
    ds_read_b32 v4, v3 offset:32
    s_waitcnt lgkmcnt(0)
    v_cmp_gt_u32 vcc, 1, v4
    s_cbranch_vccz Lk_18
    s_sleep 1
    s_add_u32 s59, s59, 1
    s_cmp_lt_u32 s59, 4194304
    s_cbranch_scc1 Lw_17
    s_branch L_end
Lk_18:
L_go:
    s_setprio 3
    buffer_load_dword v48, v55, s[24:27], s60 offen sc1
    s_mov_b32 s59, 0
Lw_19:
    ds_read_b32 v4, v3 offset:4
    s_waitcnt lgkmcnt(0)
    v_cmp_gt_u32 vcc, 3, v4
    s_cbranch_vccz Lk_20
    s_add_u32 s59, s59, 1
    s_cmp_lt_u32 s59, 4194304
    s_cbranch_scc1 Lw_19
    s_branch L_end
Lk_20:
    ds_read_u16 v8, v8
    s_waitcnt vmcnt(0)
    v_mad_u32_u16 v49, v48, 4, v49
    v_lshrrev_b32 v48, 16, v48
    v_sub_u32 v48, v48, v57
    v_cmpx_lt_i32 vcc, 0, v48
    s_cbranch_execz L_entld
    buffer_load_dwordx4 v[16:19], v49, s[16:19], s61 offen offset:0 sc1
    v_cmpx_lt_i32 vcc, 8, v48
    s_cbranch_execz L_entld
    buffer_load_dwordx4 v[20:23], v49, s[16:19], s61 offen offset:32 sc1
    v_cmpx_lt_i32 vcc, 16, v48
    s_cbranch_execz L_entld
    ds_write_b32 v3, v52 offset:28
L_entld:
    s_mov_b64 exec, -1
    s_waitcnt vmcnt(0)
    v_cmpx_lt_i32 vcc, 0, v48
    v_mad_u32_u16 v24, v16, 4, v54 op_sel:[1,0,0,0]
    v_mad_u32_u16 v40, v16, 2, v53
    ds_add_rtn_u32 v32, v24, v52
    ds_read_u16 v40, v40
    v_cmpx_lt_i32 vcc, 1, v48
    v_mad_u32_u16 v25, v17, 4, v54 op_sel:[1,0,0,0]
    v_mad_u32_u16 v41, v17, 2, v53
    ds_add_rtn_u32 v33, v25, v52
    ds_read_u16 v41, v41
    v_cmpx_lt_i32 vcc, 2, v48
    v_mad_u32_u16 v26, v18, 4, v54 op_sel:[1,0,0,0]
    v_mad_u32_u16 v42, v18, 2, v53
    ds_add_rtn_u32 v34, v26, v52
    ds_read_u16 v42, v42
    v_cmpx_lt_i32 vcc, 3, v48
    v_mad_u32_u16 v27, v19, 4, v54 op_sel:[1,0,0,0]
    v_mad_u32_u16 v43, v19, 2, v53
    ds_add_rtn_u32 v35, v27, v52
    ds_read_u16 v43, v43
    v_cmpx_lt_i32 vcc, 8, v48
    s_cbranch_execz L_l1
    s_waitcnt lgkmcnt(2)
    v_mad_u32_u16 v28, v20, 4, v54 op_sel:[1,0,0,0]
    v_mad_u32_u16 v44, v20, 2, v53
    ds_add_rtn_u32 v36, v28, v52
    ds_read_u16 v44, v44
    v_cmpx_lt_i32 vcc, 9, v48
    s_cbranch_execz L_l1
    v_mad_u32_u16 v29, v21, 4, v54 op_sel:[1,0,0,0]
    v_mad_u32_u16 v45, v21, 2, v53
    ds_add_rtn_u32 v37, v29, v52
    ds_read_u16 v45, v45
    v_cmpx_lt_i32 vcc, 10, v48
    s_cbranch_execz L_l1
    v_mad_u32_u16 v30, v22, 4, v54 op_sel:[1,0,0,0]
    v_mad_u32_u16 v46, v22, 2, v53
    ds_add_rtn_u32 v38, v30, v52
    ds_read_u16 v46, v46
    v_cmpx_lt_i32 vcc, 11, v48
    s_cbranch_execz L_l1
    v_mad_u32_u16 v31, v23, 4, v54 op_sel:[1,0,0,0]
    v_mad_u32_u16 v47, v23, 2, v53
    ds_add_rtn_u32 v39, v31, v52
    ds_read_u16 v47, v47
L_l1:
    s_mov_b64 exec, -1
    s_mov_b64 exec, 1
    v_mov_b32 v4, 1
    ds_add_u32 v3, v4 offset:12
    s_mov_b64 exec, -1
    s_mov_b32 s59, 0
Lw_21:
    ds_read_b32 v4, v3 offset:12
    s_waitcnt lgkmcnt(0)
    v_cmp_gt_u32 vcc, 8, v4
    s_cbranch_vccz Lk_22
    s_add_u32 s59, s59, 1
    s_cmp_lt_u32 s59, 4194304
    s_cbranch_scc1 Lw_21
    s_branch L_end
Lk_22:
    ds_read_b32 v12, v50
    ds_read_b32 v5, v3 offset:28
    v_lshlrev_b32 v8, 16, v8
    v_perm_b32 v16, v40, v16, s70
    v_perm_b32 v17, v41, v17, s70
    v_perm_b32 v18, v42, v18, s70
    v_perm_b32 v19, v43, v19, s70
    s_waitcnt lgkmcnt(1)
    v_add_u32 v12, 4, v12
    v_lshrrev_b32 v12, 3, v12
    v_max_u32 v12, 1, v12
    v_cndmask_b32 v12, 0, v12, s[62:63]
    s_lshl_b32 s67, s4, 3
    s_nop 0
    v_add_u32_dpp v51, v12, v12 row_shl:1 row_mask:0xf bank_mask:0xf bound_ctrl:1
    s_nop 1
    v_add_u32_dpp v51, v51, v51 row_shl:2 row_mask:0xf bank_mask:0xf bound_ctrl:1
    s_nop 1
    v_add_u32_dpp v51, v12, v51 row_shl:4 row_mask:0xf bank_mask:0x5 bound_ctrl:1
    s_waitcnt lgkmcnt(0)
    v_lshl_add_u32 v5, v5, 10, v51
    v_lshlrev_b32 v7, 3, v51
    v_cmp_le_u32 vcc, 80, v5
    v_sub_u32 v6, v56, v7
    v_subrev_u32 v12, 1, v12
    s_cbranch_vccnz L_slow
    s_mov_b64 exec, s[62:63]
    ds_write_b32 v50, v6 offset:256
    s_mov_b64 exec, -1
    s_sub_u32 s63, s67, 1
    v_readlane_b32 s67, v51, s67
    v_cmpx_lt_i32 vcc, 0, v48
    ds_read_b32 v24, v24 offset:256
    v_cmpx_lt_i32 vcc, 1, v48
    ds_read_b32 v25, v25 offset:256
    v_cmpx_lt_i32 vcc, 2, v48
    ds_read_b32 v26, v26 offset:256
    v_cmpx_lt_i32 vcc, 3, v48
    ds_read_b32 v27, v27 offset:256
    v_cmpx_lt_i32 vcc, 8, v48
    s_cbranch_execz L_l2
    s_waitcnt lgkmcnt(2)
    ds_read_b32 v28, v28 offset:256
    v_cmpx_lt_i32 vcc, 9, v48
    s_cbranch_execz L_l2
    ds_read_b32 v29, v29 offset:256
    v_cmpx_lt_i32 vcc, 10, v48
    s_cbranch_execz L_l2
    ds_read_b32 v30, v30 offset:256
    v_cmpx_lt_i32 vcc, 11, v48
    s_cbranch_execz L_l2
    ds_read_b32 v31, v31 offset:256
L_l2:
    s_mov_b64 exec, -1
    s_lshr_b32 s66, s67, 4
    s_add_u32 s60, s66, 1
    s_mul_i32 s60, s60, 16
    s_sub_u32 s67, s60, s67
    s_sub_u32 s62, s67, 1
    s_add_u32 s61, s4, 1
    s_mul_i32 s61, s61, 80
    s_sub_u32 s60, s61, s60
    s_lshl_b32 s60, s60, 3
    s_add_u32 s60, s60, 152064
    s_waitcnt lgkmcnt(0)
    v_cmpx_lt_i32 vcc, 0, v48
    v_add_u32 v24, v24, v32
    ds_write_b32 v24, v16
    v_cmpx_lt_i32 vcc, 1, v48
    v_add_u32 v25, v25, v33
    ds_write_b32 v25, v17
    v_cmpx_lt_i32 vcc, 2, v48
    v_add_u32 v26, v26, v34
    ds_write_b32 v26, v18
    v_cmpx_lt_i32 vcc, 3, v48
    v_add_u32 v27, v27, v35
    ds_write_b32 v27, v19
    v_cmpx_lt_i32 vcc, 8, v48
    s_cbranch_execz L_l3
    s_waitcnt lgkmcnt(2)
    v_perm_b32 v20, v44, v20, s70
    v_add_u32 v28, v28, v36
    ds_write_b32 v28, v20
    v_cmpx_lt_i32 vcc, 9, v48
    s_cbranch_execz L_l3
    v_perm_b32 v21, v45, v21, s70
    v_add_u32 v29, v29, v37
    ds_write_b32 v29, v21
    v_cmpx_lt_i32 vcc, 10, v48
    s_cbranch_execz L_l3
    v_perm_b32 v22, v46, v22, s70
    v_add_u32 v30, v30, v38
    ds_write_b32 v30, v22
    v_cmpx_lt_i32 vcc, 11, v48
    s_cbranch_execz L_l3
    v_perm_b32 v23, v47, v23, s70
    v_add_u32 v31, v31, v39
    ds_write_b32 v31, v23
L_l3:
    s_mov_b64 exec, -1
    s_mov_b64 exec, 1
    v_mov_b32 v4, 1
    ds_add_u32 v3, v4 offset:16
    s_mov_b64 exec, -1
    v_lshrrev_b32 v5, 5, v0
    v_lshl_add_u32 v13, v5, 2, s60
    v_bfe_u32 v5, v0, 2, 3
    v_lshl_add_u32 v14, v5, 3, v13
    s_mov_b32 s64, 201487936
    s_mov_b32 s65, 0
    s_mov_b32 s59, 0
Lw_23:
    ds_read_b32 v4, v3 offset:16
    s_waitcnt lgkmcnt(0)
    v_cmp_gt_u32 vcc, 8, v4
    s_cbranch_vccz Lk_24
    s_add_u32 s59, s59, 1
    s_cmp_lt_u32 s59, 4194304
    s_cbranch_scc1 Lw_23
    s_branch L_end
Lk_24:
    s_setprio 0
    s_cmp_ge_u32 s67, 8
    s_cbranch_scc1 Lpg_25
    ds_read2_b32 v[112:113], v13 offset0:0 offset1:2
    ds_read2_b32 v[114:115], v13 offset0:4 offset1:6
    ds_read2_b32 v[116:117], v13 offset0:8 offset1:10
    ds_read2_b32 v[118:119], v13 offset0:12 offset1:14
    s_waitcnt lgkmcnt(0)
    s_cmp_gt_u32 s67, 0
    s_cbranch_scc1 Lps_26
    v_mad_u32_u16 v4, v112, s7, v2
    buffer_load_dwordx4 v[16:19], v4, s[8:11], 0 offen
Lps_26:
    s_cmp_gt_u32 s67, 1
    s_cbranch_scc1 Lps_27
    v_mad_u32_u16 v4, v113, s7, v2
    buffer_load_dwordx4 v[20:23], v4, s[8:11], 0 offen
Lps_27:
    s_cmp_gt_u32 s67, 2
    s_cbranch_scc1 Lps_28
    v_mad_u32_u16 v4, v114, s7, v2
    buffer_load_dwordx4 v[24:27], v4, s[8:11], 0 offen
Lps_28:
    s_cmp_gt_u32 s67, 3
    s_cbranch_scc1 Lps_29
    v_mad_u32_u16 v4, v115, s7, v2
    buffer_load_dwordx4 v[28:31], v4, s[8:11], 0 offen
Lps_29:
    s_cmp_gt_u32 s67, 4
    s_cbranch_scc1 Lps_30
    v_mad_u32_u16 v4, v116, s7, v2
    buffer_load_dwordx4 v[32:35], v4, s[8:11], 0 offen
Lps_30:
    s_cmp_gt_u32 s67, 5
    s_cbranch_scc1 Lps_31
    v_mad_u32_u16 v4, v117, s7, v2
    buffer_load_dwordx4 v[36:39], v4, s[8:11], 0 offen
Lps_31:
    s_cmp_gt_u32 s67, 6
    s_cbranch_scc1 Lps_32
    v_mad_u32_u16 v4, v118, s7, v2
    buffer_load_dwordx4 v[40:43], v4, s[8:11], 0 offen
Lps_32:
    v_mad_u32_u16 v4, v119, s7, v2
    buffer_load_dwordx4 v[44:47], v4, s[8:11], 0 offen
Lpg_25:
    s_cmp_ge_u32 s67, 16
    s_cbranch_scc1 Lpg_33
    ds_read2_b32 v[112:113], v13 offset0:16 offset1:18
    ds_read2_b32 v[114:115], v13 offset0:20 offset1:22
    ds_read2_b32 v[116:117], v13 offset0:24 offset1:26
    ds_read2_b32 v[118:119], v13 offset0:28 offset1:30
    s_waitcnt lgkmcnt(0)
    s_cmp_gt_u32 s67, 8
    s_cbranch_scc1 Lps_34
    v_mad_u32_u16 v4, v112, s7, v2
    buffer_load_dwordx4 v[48:51], v4, s[8:11], 0 offen
Lps_34:
    s_cmp_gt_u32 s67, 9
    s_cbranch_scc1 Lps_35
    v_mad_u32_u16 v4, v113, s7, v2
    buffer_load_dwordx4 v[52:55], v4, s[8:11], 0 offen
Lps_35:
    s_cmp_gt_u32 s67, 10
    s_cbranch_scc1 Lps_36
    v_mad_u32_u16 v4, v114, s7, v2
    buffer_load_dwordx4 v[56:59], v4, s[8:11], 0 offen
Lps_36:
    s_cmp_gt_u32 s67, 11
    s_cbranch_scc1 Lps_37
    v_mad_u32_u16 v4, v115, s7, v2
    buffer_load_dwordx4 v[60:63], v4, s[8:11], 0 offen
Lps_37:
    s_cmp_gt_u32 s67, 12
    s_cbranch_scc1 Lps_38
    v_mad_u32_u16 v4, v116, s7, v2
    buffer_load_dwordx4 v[64:67], v4, s[8:11], 0 offen
Lps_38:
    s_cmp_gt_u32 s67, 13
    s_cbranch_scc1 Lps_39
    v_mad_u32_u16 v4, v117, s7, v2
    buffer_load_dwordx4 v[68:71], v4, s[8:11], 0 offen
Lps_39:
    s_cmp_gt_u32 s67, 14
    s_cbranch_scc1 Lps_40
    v_mad_u32_u16 v4, v118, s7, v2
    buffer_load_dwordx4 v[72:75], v4, s[8:11], 0 offen
Lps_40:
    v_mad_u32_u16 v4, v119, s7, v2
    buffer_load_dwordx4 v[76:79], v4, s[8:11], 0 offen
Lpg_33:
    ds_read_b32 v5, v14
    ds_read2_b32 v[112:113], v13 offset0:32 offset1:34
    ds_read2_b32 v[114:115], v13 offset0:36 offset1:38
    ds_read2_b32 v[116:117], v13 offset0:40 offset1:42
    ds_read2_b32 v[118:119], v13 offset0:44 offset1:46
    s_cmp_eq_u32 s66, 0
    s_cbranch_scc1 L_drain
L_gl:
    s_waitcnt lgkmcnt(3)
    v_perm_b32 v6, v5, v5, v10
    v_perm_b32 v7, v5, v5, v11
    ds_read_b32 v5, v14 offset:64
    s_waitcnt vmcnt(15)
    v_mfma_f32_4x4x4_16b_bf16 v[120:123], v[6:7], v[16:17], v[120:123] cbsz:3 abid:0
    v_mfma_f32_4x4x4_16b_bf16 v[124:127], v[6:7], v[18:19], v[124:127] cbsz:3 abid:0
    s_sub_u32 s62, s62, 1
    s_cbranch_scc1 Lfs_0
Lbs_0:
    v_mad_u32_u16 v4, v112, s7, v2
    buffer_load_dwordx4 v[16:19], v4, s[8:11], 0 offen
    s_waitcnt vmcnt(15)
    v_mfma_f32_4x4x4_16b_bf16 v[120:123], v[6:7], v[20:21], v[120:123] cbsz:3 abid:1
    v_mfma_f32_4x4x4_16b_bf16 v[124:127], v[6:7], v[22:23], v[124:127] cbsz:3 abid:1
    s_sub_u32 s62, s62, 1
    s_cbranch_scc1 Lfs_1
Lbs_1:
    v_mad_u32_u16 v4, v113, s7, v2
    buffer_load_dwordx4 v[20:23], v4, s[8:11], 0 offen
    ds_read2_b32 v[112:113], v13 offset0:48 offset1:50
    s_waitcnt vmcnt(15) lgkmcnt(3)
    v_mfma_f32_4x4x4_16b_bf16 v[120:123], v[6:7], v[24:25], v[120:123] cbsz:3 abid:2
    v_mfma_f32_4x4x4_16b_bf16 v[124:127], v[6:7], v[26:27], v[124:127] cbsz:3 abid:2
    s_sub_u32 s62, s62, 1
    s_cbranch_scc1 Lfs_2
Lbs_2:
    v_mad_u32_u16 v4, v114, s7, v2
    buffer_load_dwordx4 v[24:27], v4, s[8:11], 0 offen
    s_waitcnt vmcnt(15)
    v_mfma_f32_4x4x4_16b_bf16 v[120:123], v[6:7], v[28:29], v[120:123] cbsz:3 abid:3
    v_mfma_f32_4x4x4_16b_bf16 v[124:127], v[6:7], v[30:31], v[124:127] cbsz:3 abid:3
    s_sub_u32 s62, s62, 1
    s_cbranch_scc1 Lfs_3
Lbs_3:
    v_mad_u32_u16 v4, v115, s7, v2
    buffer_load_dwordx4 v[28:31], v4, s[8:11], 0 offen
    ds_read2_b32 v[114:115], v13 offset0:52 offset1:54
    s_waitcnt vmcnt(15) lgkmcnt(3)
    v_mfma_f32_4x4x4_16b_bf16 v[120:123], v[6:7], v[32:33], v[120:123] cbsz:3 abid:4
    v_mfma_f32_4x4x4_16b_bf16 v[124:127], v[6:7], v[34:35], v[124:127] cbsz:3 abid:4
    s_sub_u32 s62, s62, 1
    s_cbranch_scc1 Lfs_4
Lbs_4:
    v_mad_u32_u16 v4, v116, s7, v2
    buffer_load_dwordx4 v[32:35], v4, s[8:11], 0 offen
    s_waitcnt vmcnt(15)
    v_mfma_f32_4x4x4_16b_bf16 v[120:123], v[6:7], v[36:37], v[120:123] cbsz:3 abid:5
    v_mfma_f32_4x4x4_16b_bf16 v[124:127], v[6:7], v[38:39], v[124:127] cbsz:3 abid:5
    s_sub_u32 s62, s62, 1
    s_cbranch_scc1 Lfs_5
Lbs_5:
    v_mad_u32_u16 v4, v117, s7, v2
    buffer_load_dwordx4 v[36:39], v4, s[8:11], 0 offen
    ds_read2_b32 v[116:117], v13 offset0:56 offset1:58
    s_waitcnt vmcnt(15) lgkmcnt(3)
    v_mfma_f32_4x4x4_16b_bf16 v[120:123], v[6:7], v[40:41], v[120:123] cbsz:3 abid:6
    v_mfma_f32_4x4x4_16b_bf16 v[124:127], v[6:7], v[42:43], v[124:127] cbsz:3 abid:6
    s_sub_u32 s62, s62, 1
    s_cbranch_scc1 Lfs_6
Lbs_6:
    v_mad_u32_u16 v4, v118, s7, v2
    buffer_load_dwordx4 v[40:43], v4, s[8:11], 0 offen
    s_waitcnt vmcnt(15)
    v_mfma_f32_4x4x4_16b_bf16 v[120:123], v[6:7], v[44:45], v[120:123] cbsz:3 abid:7
    v_mfma_f32_4x4x4_16b_bf16 v[124:127], v[6:7], v[46:47], v[124:127] cbsz:3 abid:7
    s_sub_u32 s62, s62, 1
    s_cbranch_scc1 Lfs_7
Lbs_7:
    v_mad_u32_u16 v4, v119, s7, v2
    buffer_load_dwordx4 v[44:47], v4, s[8:11], 0 offen
    ds_read2_b32 v[118:119], v13 offset0:60 offset1:62
    s_waitcnt lgkmcnt(3)
    v_perm_b32 v6, v5, v5, v10
    v_perm_b32 v7, v5, v5, v11
    ds_read_b32 v5, v14 offset:128
    s_waitcnt vmcnt(15)
    v_mfma_f32_4x4x4_16b_bf16 v[120:123], v[6:7], v[48:49], v[120:123] cbsz:3 abid:0
    v_mfma_f32_4x4x4_16b_bf16 v[124:127], v[6:7], v[50:51], v[124:127] cbsz:3 abid:0
    s_sub_u32 s62, s62, 1
    s_cbranch_scc1 Lfs_8
Lbs_8:
    v_mad_u32_u16 v4, v112, s7, v2
    buffer_load_dwordx4 v[48:51], v4, s[8:11], 0 offen
    s_waitcnt vmcnt(15)
    v_mfma_f32_4x4x4_16b_bf16 v[120:123], v[6:7], v[52:53], v[120:123] cbsz:3 abid:1
    v_mfma_f32_4x4x4_16b_bf16 v[124:127], v[6:7], v[54:55], v[124:127] cbsz:3 abid:1
    s_sub_u32 s62, s62, 1
    s_cbranch_scc1 Lfs_9
Lbs_9:
    v_mad_u32_u16 v4, v113, s7, v2
    buffer_load_dwordx4 v[52:55], v4, s[8:11], 0 offen
    ds_read2_b32 v[112:113], v13 offset0:64 offset1:66
    s_waitcnt vmcnt(15) lgkmcnt(3)
    v_mfma_f32_4x4x4_16b_bf16 v[120:123], v[6:7], v[56:57], v[120:123] cbsz:3 abid:2
    v_mfma_f32_4x4x4_16b_bf16 v[124:127], v[6:7], v[58:59], v[124:127] cbsz:3 abid:2
    s_sub_u32 s62, s62, 1
    s_cbranch_scc1 Lfs_10
Lbs_10:
    v_mad_u32_u16 v4, v114, s7, v2
    buffer_load_dwordx4 v[56:59], v4, s[8:11], 0 offen
    s_waitcnt vmcnt(15)
    v_mfma_f32_4x4x4_16b_bf16 v[120:123], v[6:7], v[60:61], v[120:123] cbsz:3 abid:3
    v_mfma_f32_4x4x4_16b_bf16 v[124:127], v[6:7], v[62:63], v[124:127] cbsz:3 abid:3
    s_sub_u32 s62, s62, 1
    s_cbranch_scc1 Lfs_11
Lbs_11:
    v_mad_u32_u16 v4, v115, s7, v2
    buffer_load_dwordx4 v[60:63], v4, s[8:11], 0 offen
    ds_read2_b32 v[114:115], v13 offset0:68 offset1:70
    s_waitcnt vmcnt(15) lgkmcnt(3)
    v_mfma_f32_4x4x4_16b_bf16 v[120:123], v[6:7], v[64:65], v[120:123] cbsz:3 abid:4
    v_mfma_f32_4x4x4_16b_bf16 v[124:127], v[6:7], v[66:67], v[124:127] cbsz:3 abid:4
    s_sub_u32 s62, s62, 1
    s_cbranch_scc1 Lfs_12
Lbs_12:
    v_mad_u32_u16 v4, v116, s7, v2
    buffer_load_dwordx4 v[64:67], v4, s[8:11], 0 offen
    s_waitcnt vmcnt(15)
    v_mfma_f32_4x4x4_16b_bf16 v[120:123], v[6:7], v[68:69], v[120:123] cbsz:3 abid:5
    v_mfma_f32_4x4x4_16b_bf16 v[124:127], v[6:7], v[70:71], v[124:127] cbsz:3 abid:5
    s_sub_u32 s62, s62, 1
    s_cbranch_scc1 Lfs_13
Lbs_13:
    v_mad_u32_u16 v4, v117, s7, v2
    buffer_load_dwordx4 v[68:71], v4, s[8:11], 0 offen
    ds_read2_b32 v[116:117], v13 offset0:72 offset1:74
    s_waitcnt vmcnt(15) lgkmcnt(3)
    v_mfma_f32_4x4x4_16b_bf16 v[120:123], v[6:7], v[72:73], v[120:123] cbsz:3 abid:6
    v_mfma_f32_4x4x4_16b_bf16 v[124:127], v[6:7], v[74:75], v[124:127] cbsz:3 abid:6
    s_sub_u32 s62, s62, 1
    s_cbranch_scc1 Lfs_14
Lbs_14:
    v_mad_u32_u16 v4, v118, s7, v2
    buffer_load_dwordx4 v[72:75], v4, s[8:11], 0 offen
    s_waitcnt vmcnt(15)
    v_mfma_f32_4x4x4_16b_bf16 v[120:123], v[6:7], v[76:77], v[120:123] cbsz:3 abid:7
    v_mfma_f32_4x4x4_16b_bf16 v[124:127], v[6:7], v[78:79], v[124:127] cbsz:3 abid:7
    s_sub_u32 s62, s62, 1
    s_cbranch_scc1 Lfs_15
Lbs_15:
    v_mad_u32_u16 v4, v119, s7, v2
    buffer_load_dwordx4 v[76:79], v4, s[8:11], 0 offen
    ds_read2_b32 v[118:119], v13 offset0:76 offset1:78
    v_add_u32 v13, 128, v13
    v_add_u32 v14, 128, v14
    s_sub_u32 s66, s66, 1
    s_cmp_lg_u32 s66, 0
    s_cbranch_scc1 L_gl
L_drain:
    s_waitcnt lgkmcnt(0)
    v_perm_b32 v6, v5, v5, v10
    v_perm_b32 v7, v5, v5, v11
    ds_read_b32 v5, v14 offset:64
    s_waitcnt vmcnt(15)
    v_mfma_f32_4x4x4_16b_bf16 v[120:123], v[6:7], v[16:17], v[120:123] cbsz:3 abid:0
    v_mfma_f32_4x4x4_16b_bf16 v[124:127], v[6:7], v[18:19], v[124:127] cbsz:3 abid:0
    s_sub_u32 s62, s62, 1
    s_cbranch_scc1 Lfd_0
Lbd_0:
    s_waitcnt vmcnt(14)
    v_mfma_f32_4x4x4_16b_bf16 v[120:123], v[6:7], v[20:21], v[120:123] cbsz:3 abid:1
    v_mfma_f32_4x4x4_16b_bf16 v[124:127], v[6:7], v[22:23], v[124:127] cbsz:3 abid:1
    s_sub_u32 s62, s62, 1
    s_cbranch_scc1 Lfd_1
Lbd_1:
    s_waitcnt vmcnt(13)
    v_mfma_f32_4x4x4_16b_bf16 v[120:123], v[6:7], v[24:25], v[120:123] cbsz:3 abid:2
    v_mfma_f32_4x4x4_16b_bf16 v[124:127], v[6:7], v[26:27], v[124:127] cbsz:3 abid:2
    s_sub_u32 s62, s62, 1
    s_cbranch_scc1 Lfd_2
Lbd_2:
    s_waitcnt vmcnt(12)
    v_mfma_f32_4x4x4_16b_bf16 v[120:123], v[6:7], v[28:29], v[120:123] cbsz:3 abid:3
    v_mfma_f32_4x4x4_16b_bf16 v[124:127], v[6:7], v[30:31], v[124:127] cbsz:3 abid:3
    s_sub_u32 s62, s62, 1
    s_cbranch_scc1 Lfd_3
Lbd_3:
    s_waitcnt vmcnt(11)
    v_mfma_f32_4x4x4_16b_bf16 v[120:123], v[6:7], v[32:33], v[120:123] cbsz:3 abid:4
    v_mfma_f32_4x4x4_16b_bf16 v[124:127], v[6:7], v[34:35], v[124:127] cbsz:3 abid:4
    s_sub_u32 s62, s62, 1
    s_cbranch_scc1 Lfd_4
Lbd_4:
    s_waitcnt vmcnt(10)
    v_mfma_f32_4x4x4_16b_bf16 v[120:123], v[6:7], v[36:37], v[120:123] cbsz:3 abid:5
    v_mfma_f32_4x4x4_16b_bf16 v[124:127], v[6:7], v[38:39], v[124:127] cbsz:3 abid:5
    s_sub_u32 s62, s62, 1
    s_cbranch_scc1 Lfd_5
Lbd_5:
    s_waitcnt vmcnt(9)
    v_mfma_f32_4x4x4_16b_bf16 v[120:123], v[6:7], v[40:41], v[120:123] cbsz:3 abid:6
    v_mfma_f32_4x4x4_16b_bf16 v[124:127], v[6:7], v[42:43], v[124:127] cbsz:3 abid:6
    s_sub_u32 s62, s62, 1
    s_cbranch_scc1 Lfd_6
Lbd_6:
    s_waitcnt vmcnt(8)
    v_mfma_f32_4x4x4_16b_bf16 v[120:123], v[6:7], v[44:45], v[120:123] cbsz:3 abid:7
    v_mfma_f32_4x4x4_16b_bf16 v[124:127], v[6:7], v[46:47], v[124:127] cbsz:3 abid:7
    s_sub_u32 s62, s62, 1
    s_cbranch_scc1 Lfd_7
Lbd_7:
    s_waitcnt lgkmcnt(0)
    v_perm_b32 v6, v5, v5, v10
    v_perm_b32 v7, v5, v5, v11
    ds_read_b32 v5, v14 offset:128
    s_waitcnt vmcnt(7)
    v_mfma_f32_4x4x4_16b_bf16 v[120:123], v[6:7], v[48:49], v[120:123] cbsz:3 abid:0
    v_mfma_f32_4x4x4_16b_bf16 v[124:127], v[6:7], v[50:51], v[124:127] cbsz:3 abid:0
    s_sub_u32 s62, s62, 1
    s_cbranch_scc1 Lfd_8
Lbd_8:
    s_waitcnt vmcnt(6)
    v_mfma_f32_4x4x4_16b_bf16 v[120:123], v[6:7], v[52:53], v[120:123] cbsz:3 abid:1
    v_mfma_f32_4x4x4_16b_bf16 v[124:127], v[6:7], v[54:55], v[124:127] cbsz:3 abid:1
    s_sub_u32 s62, s62, 1
    s_cbranch_scc1 Lfd_9
Lbd_9:
    s_waitcnt vmcnt(5)
    v_mfma_f32_4x4x4_16b_bf16 v[120:123], v[6:7], v[56:57], v[120:123] cbsz:3 abid:2
    v_mfma_f32_4x4x4_16b_bf16 v[124:127], v[6:7], v[58:59], v[124:127] cbsz:3 abid:2
    s_sub_u32 s62, s62, 1
    s_cbranch_scc1 Lfd_10
Lbd_10:
    s_waitcnt vmcnt(4)
    v_mfma_f32_4x4x4_16b_bf16 v[120:123], v[6:7], v[60:61], v[120:123] cbsz:3 abid:3
    v_mfma_f32_4x4x4_16b_bf16 v[124:127], v[6:7], v[62:63], v[124:127] cbsz:3 abid:3
    s_sub_u32 s62, s62, 1
    s_cbranch_scc1 Lfd_11
Lbd_11:
    s_waitcnt vmcnt(3)
    v_mfma_f32_4x4x4_16b_bf16 v[120:123], v[6:7], v[64:65], v[120:123] cbsz:3 abid:4
    v_mfma_f32_4x4x4_16b_bf16 v[124:127], v[6:7], v[66:67], v[124:127] cbsz:3 abid:4
    s_sub_u32 s62, s62, 1
    s_cbranch_scc1 Lfd_12
Lbd_12:
    s_waitcnt vmcnt(2)
    v_mfma_f32_4x4x4_16b_bf16 v[120:123], v[6:7], v[68:69], v[120:123] cbsz:3 abid:5
    v_mfma_f32_4x4x4_16b_bf16 v[124:127], v[6:7], v[70:71], v[124:127] cbsz:3 abid:5
    s_sub_u32 s62, s62, 1
    s_cbranch_scc1 Lfd_13
Lbd_13:
    s_waitcnt vmcnt(1)
    v_mfma_f32_4x4x4_16b_bf16 v[120:123], v[6:7], v[72:73], v[120:123] cbsz:3 abid:6
    v_mfma_f32_4x4x4_16b_bf16 v[124:127], v[6:7], v[74:75], v[124:127] cbsz:3 abid:6
    s_sub_u32 s62, s62, 1
    s_cbranch_scc1 Lfd_14
Lbd_14:
    s_waitcnt vmcnt(0)
    v_mfma_f32_4x4x4_16b_bf16 v[120:123], v[6:7], v[76:77], v[120:123] cbsz:3 abid:7
    v_mfma_f32_4x4x4_16b_bf16 v[124:127], v[6:7], v[78:79], v[124:127] cbsz:3 abid:7
    s_sub_u32 s62, s62, 1
    s_cbranch_scc1 Lfd_15
Lbd_15:
L_gdone:
L_end:
L_exit:
    s_endpgm
Lfs_0:
    s_call_b64 s[68:69], L_flush
    s_branch Lbs_0
Lfs_1:
    s_call_b64 s[68:69], L_flush
    s_branch Lbs_1
Lfs_2:
    s_call_b64 s[68:69], L_flush
    s_branch Lbs_2
Lfs_3:
    s_call_b64 s[68:69], L_flush
    s_branch Lbs_3
Lfs_4:
    s_call_b64 s[68:69], L_flush
    s_branch Lbs_4
Lfs_5:
    s_call_b64 s[68:69], L_flush
    s_branch Lbs_5
Lfs_6:
    s_call_b64 s[68:69], L_flush
    s_branch Lbs_6
Lfs_7:
    s_call_b64 s[68:69], L_flush
    s_branch Lbs_7
Lfs_8:
    s_call_b64 s[68:69], L_flush
    s_branch Lbs_8
Lfs_9:
    s_call_b64 s[68:69], L_flush
    s_branch Lbs_9
Lfs_10:
    s_call_b64 s[68:69], L_flush
    s_branch Lbs_10
Lfs_11:
    s_call_b64 s[68:69], L_flush
    s_branch Lbs_11
Lfs_12:
    s_call_b64 s[68:69], L_flush
    s_branch Lbs_12
Lfs_13:
    s_call_b64 s[68:69], L_flush
    s_branch Lbs_13
Lfs_14:
    s_call_b64 s[68:69], L_flush
    s_branch Lbs_14
Lfs_15:
    s_call_b64 s[68:69], L_flush
    s_branch Lbs_15
Lfd_0:
    s_call_b64 s[68:69], L_flush
    s_branch Lbd_0
Lfd_1:
    s_call_b64 s[68:69], L_flush
    s_branch Lbd_1
Lfd_2:
    s_call_b64 s[68:69], L_flush
    s_branch Lbd_2
Lfd_3:
    s_call_b64 s[68:69], L_flush
    s_branch Lbd_3
Lfd_4:
    s_call_b64 s[68:69], L_flush
    s_branch Lbd_4
Lfd_5:
    s_call_b64 s[68:69], L_flush
    s_branch Lbd_5
Lfd_6:
    s_call_b64 s[68:69], L_flush
    s_branch Lbd_6
Lfd_7:
    s_call_b64 s[68:69], L_flush
    s_branch Lbd_7
Lfd_8:
    s_call_b64 s[68:69], L_flush
    s_branch Lbd_8
Lfd_9:
    s_call_b64 s[68:69], L_flush
    s_branch Lbd_9
Lfd_10:
    s_call_b64 s[68:69], L_flush
    s_branch Lbd_10
Lfd_11:
    s_call_b64 s[68:69], L_flush
    s_branch Lbd_11
Lfd_12:
    s_call_b64 s[68:69], L_flush
    s_branch Lbd_12
Lfd_13:
    s_call_b64 s[68:69], L_flush
    s_branch Lbd_13
Lfd_14:
    s_call_b64 s[68:69], L_flush
    s_branch Lbd_14
Lfd_15:
    s_call_b64 s[68:69], L_flush
    s_branch Lbd_15
L_flush:
    s_add_u32 s63, s63, 1
    s_lshr_b32 s101, s64, 24
    s_and_b32 s64, s64, 0xffffff
    v_permlane32_swap_b32 v120, v124
    v_permlane32_swap_b32 v121, v125
    v_permlane32_swap_b32 v122, v126
    v_permlane32_swap_b32 v123, v127
    v_add_u32 v4, s64, v15
    v_pk_add_f32 v[120:121], v[120:121], v[124:125]
    v_pk_add_f32 v[122:123], v[122:123], v[126:127]
    v_readlane_b32 s64, v9, s63
    v_mul_f32 v120, s65, v120
    v_mul_f32 v121, s65, v121
    v_mul_f32 v122, s65, v122
    v_mul_f32 v123, s65, v123
    v_add_u32 v126, s101, v3
    v_mov_b32 v127, 1
    v_cvt_pk_bf16_f32 v124, v120, v121
    v_cvt_pk_bf16_f32 v125, v122, v123
    ds_write_b64 v4, v[124:125]
    s_mov_b64 exec, 1
    ds_add_u32 v126, v127 offset:36
    s_mov_b64 exec, -1
    v_readlane_b32 s62, v12, s63
    v_readlane_b32 s65, v8, s63
    v_mov_b64 v[120:121], 0
    v_mov_b64 v[122:123], 0
    v_mov_b64 v[124:125], 0
    v_mov_b64 v[126:127], 0
    s_setpc_b64 s[68:69]
L_slow:
    s_setprio 0
    s_mov_b32 s24, s34
    s_mov_b32 s25, s35
    s_mov_b32 s26, 640000
    s_mov_b32 s27, 0x20000
    s_mov_b32 s28, s36
    s_mov_b32 s29, s37
    s_mov_b32 s30, 640000
    s_mov_b32 s31, 0x20000
    s_mov_b32 s12, s42
    s_mov_b32 s13, s43
    s_mov_b32 s14, 20000
    s_mov_b32 s15, 0x20000
    s_sub_u32 s63, s67, 1
    s_mov_b32 s64, 201487936
    s_mov_b32 s65, 0
    s_call_b64 s[68:69], L_flush
    s_add_u32 s66, s4, s5
    s_add_u32 s67, s66, 40
    v_lshlrev_b32 v16, 2, v0
    v_and_b32 v17, 32, v0
    v_lshl_add_u32 v17, v17, 22, v2
    v_mov_b32 v24, 0
L_sn:
    s_mov_b32 s60, 0
L_sc:
    buffer_load_dword v18, v16, s[28:31], s60 offen
    buffer_load_dword v19, v16, s[24:27], s60 offen
    s_waitcnt vmcnt(0)
    v_cmp_eq_u32 vcc, s66, v18
    s_cbranch_vccz L_sx
L_se:
    s_ff1_i32_b64 s58, vcc
    s_bitset0_b64 vcc, s58
    v_readlane_b32 s59, v19, s58
    s_nop 0
    s_lshl_b32 s61, s59, 9
    s_lshl_b32 s59, s59, 1
    buffer_load_dwordx4 v[20:23], v17, s[8:11], s61 offen
    buffer_load_short_d16_hi v5, v24, s[12:15], s59 offen
    s_waitcnt vmcnt(0)
    v_perm_b32 v6, v5, v5, v10
    v_perm_b32 v7, v5, v5, v11
    s_nop 1
    v_mfma_f32_4x4x4_16b_bf16 v[120:123], v[6:7], v[20:21], v[120:123]
    v_mfma_f32_4x4x4_16b_bf16 v[124:127], v[6:7], v[22:23], v[124:127]
    s_cmp_lg_u64 vcc, 0
    s_cbranch_scc1 L_se
L_sx:
    s_add_u32 s60, s60, 256
    s_cmp_lt_u32 s60, 640000
    s_cbranch_scc1 L_sc
    s_call_b64 s[68:69], L_flush
    s_add_u32 s66, s66, 8
    s_cmp_lt_u32 s66, s67
    s_cbranch_scc1 L_sn
    s_branch L_gdone
.section .rodata,"a"
.p2align 6
.amdhsa_kernel standalone__hybrid_graph_tf_exphormer__graph_kernel
  .amdhsa_next_free_vgpr 128
  .amdhsa_next_free_sgpr 102
  .amdhsa_accum_offset 128
  .amdhsa_group_segment_fixed_size 0
  .amdhsa_kernarg_size 104
  .amdhsa_user_sgpr_count 2
  .amdhsa_user_sgpr_kernarg_segment_ptr 1
  .amdhsa_system_sgpr_workgroup_id_x 1
.end_amdhsa_kernel
```

```asm
; @launch grid=(250,1,1) block=(1024,1,1) lds=161856
.amdgcn_target "amdgcn-amd-amdhsa--gfx950"
.text
.globl standalone__hybrid_graph_tf_exphormer__graph_kernel
.p2align 8
.type standalone__hybrid_graph_tf_exphormer__graph_kernel,@function
standalone__hybrid_graph_tf_exphormer__graph_kernel:
    s_cmp_ge_u32 s2, 250
    s_cbranch_scc1 L_exit
    s_load_dwordx16 s[32:47], s[0:1], 0
    s_load_dwordx8 s[48:55], s[0:1], 64
    s_load_dwordx2 s[56:57], s[0:1], 96
    s_getpc_b64 s[60:61]
    s_lshr_b32 s58, s2, 3
    v_lshl_add_u32 v1, v0, 5, s58
    v_cmp_gt_u32 vcc, 83, v1
    v_lshlrev_b32 v1, 7, v1
    s_and_saveexec_b64 s[58:59], vcc
    s_cbranch_execz L_nopf
    global_load_dword v127, v1, s[60:61]
L_nopf:
    s_mov_b64 exec, -1
    v_lshrrev_b32 v1, 6, v0
    v_mov_b32 v8, 0xffff
    v_readfirstlane_b32 s3, v1
    v_cmp_gt_u32 vcc, 320, v0
    v_lshlrev_b32 v30, 4, v0
    v_add_u32 v4, 152064, v30
    v_cndmask_b32 v8, 0, v8, vcc
    v_mov_b32 v9, v8
    v_mov_b32 v10, v8
    v_mov_b32 v11, v8
    v_cmp_gt_u32 vcc, 420, v0
    s_and_saveexec_b64 s[58:59], vcc
    ds_write_b128 v4, v[8:11]
    s_mov_b64 exec, -1
    v_and_b32 v0, 63, v0
    s_and_b32 s58, s2, 7
    s_lshr_b32 s59, s2, 3
    s_mul_i32 s6, s58, 31
    s_min_u32 s58, s58, 2
    s_add_u32 s6, s6, s58
    s_add_u32 s6, s6, s59
    s_mul_i32 s5, s6, 40
    s_and_b32 s4, s3, 7
    s_xor_b32 s3, s3, 8
    s_movk_i32 s7, 512
    v_and_b32 v2, 31, v0
    v_lshlrev_b32 v2, 4, v2
    v_mov_b32 v3, 157696
    s_mov_b32 s70, 0x05040100
    s_mov_b32 s71, 0x07060302
    s_mov_b32 s10, 5120000
    s_mov_b32 s11, 0x20000
    s_mov_b32 s18, 2097152
    s_mov_b32 s19, 0x20000
    s_mov_b32 s27, 0x20000
    s_mov_b32 s31, 0x20000
    s_mov_b32 s15, 0x20000
    s_cmp_eq_u32 s3, 8
    s_waitcnt lgkmcnt(0)
    s_mov_b64 s[8:9], s[32:33]
    s_mov_b64 s[16:17], s[56:57]
    s_cbranch_scc0 L_notprod
    s_setprio 3
    s_mov_b64 s[24:25], s[34:35]
    s_mov_b32 s26, 640000
    s_mov_b64 s[28:29], s[36:37]
    s_mov_b32 s30, 640000
    v_lshlrev_b32 v5, 4, v0
    v_lshlrev_b32 v6, 3, v0
    s_mul_i32 s58, s2, 2560
    buffer_load_dwordx4 v[26:29], v5, s[28:31], s58 offen
    buffer_load_dwordx4 v[30:33], v5, s[28:31], s58 offen offset:1024
    buffer_load_dwordx2 v[34:35], v6, s[28:31], s58 offen offset:2048
    buffer_load_dwordx4 v[16:19], v5, s[24:27], s58 offen
    buffer_load_dwordx4 v[20:23], v5, s[24:27], s58 offen offset:1024
    buffer_load_dwordx2 v[24:25], v6, s[24:27], s58 offen offset:2048
    s_mov_b32 s59, 1572864
    s_load_dword s40, s[56:57], s59
    s_barrier
    v_mov_b32 v8, 1
    v_mov_b32 v9, 4
    v_mov_b32 v10, 157760
    v_add_u32 v11, 157760, v5
    v_mov_b32 v59, 158784
    v_add_u32 v74, 158784, v5
    v_add_u32 v75, 158784, v6
    s_lshl_b32 s61, s2, 10
    s_add_u32 s58, s58, 262144
    s_waitcnt vmcnt(5)
    v_mul_u32_u24 v36, 52429, v26
    v_lshrrev_b32 v36, 21, v36
    v_lshl_add_u32 v36, v36, 2, v10
    ds_add_u32 v36, v8
    v_mul_u32_u24 v37, 52429, v27
    v_lshrrev_b32 v37, 21, v37
    v_lshl_add_u32 v37, v37, 2, v10
    ds_add_u32 v37, v8
    v_mul_u32_u24 v38, 52429, v28
    v_lshrrev_b32 v38, 21, v38
    v_lshl_add_u32 v38, v38, 2, v10
    ds_add_u32 v38, v8
    v_mul_u32_u24 v39, 52429, v29
    v_lshrrev_b32 v39, 21, v39
    v_lshl_add_u32 v39, v39, 2, v10
    ds_add_u32 v39, v8
    s_waitcnt vmcnt(4)
    v_mul_u32_u24 v40, 52429, v30
    v_lshrrev_b32 v40, 21, v40
    v_lshl_add_u32 v40, v40, 2, v10
    ds_add_u32 v40, v8
    v_mul_u32_u24 v41, 52429, v31
    v_lshrrev_b32 v41, 21, v41
    v_lshl_add_u32 v41, v41, 2, v10
    ds_add_u32 v41, v8
    v_mul_u32_u24 v42, 52429, v32
    v_lshrrev_b32 v42, 21, v42
    v_lshl_add_u32 v42, v42, 2, v10
    ds_add_u32 v42, v8
    v_mul_u32_u24 v43, 52429, v33
    v_lshrrev_b32 v43, 21, v43
    v_lshl_add_u32 v43, v43, 2, v10
    ds_add_u32 v43, v8
    s_waitcnt vmcnt(3)
    v_mul_u32_u24 v44, 52429, v34
    v_lshrrev_b32 v44, 21, v44
    v_lshl_add_u32 v44, v44, 2, v10
    ds_add_u32 v44, v8
    v_mul_u32_u24 v45, 52429, v35
    v_lshrrev_b32 v45, 21, v45
    v_lshl_add_u32 v45, v45, 2, v10
    ds_add_u32 v45, v8
    ds_read_b128 v[12:15], v11
    s_waitcnt vmcnt(0)
    v_lshl_or_b32 v16, v26, 16, v16
    v_lshl_or_b32 v17, v27, 16, v17
    v_lshl_or_b32 v18, v28, 16, v18
    v_lshl_or_b32 v19, v29, 16, v19
    v_lshl_or_b32 v20, v30, 16, v20
    v_lshl_or_b32 v21, v31, 16, v21
    v_lshl_or_b32 v22, v32, 16, v22
    v_lshl_or_b32 v23, v33, 16, v23
    v_lshl_or_b32 v24, v34, 16, v24
    v_lshl_or_b32 v25, v35, 16, v25
    s_waitcnt lgkmcnt(0)
    v_add_u32 v56, v12, v13
    v_add3_u32 v57, v56, v14, v15
    s_nop 1
    v_add_u32_dpp v58, v57, v57 row_shr:1 row_mask:0xf bank_mask:0xf bound_ctrl:1
    s_nop 1
    v_add_u32_dpp v58, v58, v58 row_shr:2 row_mask:0xf bank_mask:0xf bound_ctrl:1
    s_nop 1
    v_add_u32_dpp v58, v58, v58 row_shr:4 row_mask:0xf bank_mask:0xf bound_ctrl:1
    s_nop 1
    v_add_u32_dpp v58, v58, v58 row_shr:8 row_mask:0xf bank_mask:0xf bound_ctrl:1
    s_nop 1
    v_add_u32_dpp v58, v58, v58 row_bcast:15 row_mask:0xa bank_mask:0xf
    s_nop 1
    v_add_u32_dpp v58, v58, v58 row_bcast:31 row_mask:0xc bank_mask:0xf
    v_sub_u32 v60, v58, v57
    v_add_u32 v61, v60, v12
    v_add_u32 v62, v60, v56
    v_add_u32 v63, v62, v14
    v_lshl_add_u32 v64, v60, 2, v59
    v_lshl_add_u32 v65, v61, 2, v59
    v_lshl_add_u32 v66, v62, 2, v59
    v_lshl_add_u32 v67, v63, 2, v59
    ds_write_b128 v11, v[64:67]
    ds_add_rtn_u32 v46, v36, v9
    ds_add_rtn_u32 v47, v37, v9
    ds_add_rtn_u32 v48, v38, v9
    ds_add_rtn_u32 v49, v39, v9
    ds_add_rtn_u32 v50, v40, v9
    ds_add_rtn_u32 v51, v41, v9
    ds_add_rtn_u32 v52, v42, v9
    ds_add_rtn_u32 v53, v43, v9
    ds_add_rtn_u32 v54, v44, v9
    ds_add_rtn_u32 v55, v45, v9
    s_add_u32 s40, s40, 0x400
    s_and_b32 s40, s40, 4294966272
    v_or_b32 v60, s40, v60
    v_or_b32 v61, s40, v61
    v_or_b32 v62, s40, v62
    v_or_b32 v63, s40, v63
    s_or_b32 s60, s40, 1
    v_mov_b32 v12, s60
    s_waitcnt lgkmcnt(8)
    ds_write_b32 v46, v16
    ds_write_b32 v47, v17
    s_waitcnt lgkmcnt(8)
    ds_write_b32 v48, v18
    ds_write_b32 v49, v19
    s_waitcnt lgkmcnt(8)
    ds_write_b32 v50, v20
    ds_write_b32 v51, v21
    s_waitcnt lgkmcnt(8)
    ds_write_b32 v52, v22
    ds_write_b32 v53, v23
    s_waitcnt lgkmcnt(8)
    ds_write_b32 v54, v24
    ds_write_b32 v55, v25
    ds_read_b128 v[64:67], v74
    ds_read_b128 v[68:71], v74 offset:1024
    ds_read_b64 v[72:73], v75 offset:2048
    s_waitcnt lgkmcnt(2)
    buffer_store_dwordx4 v[64:67], v5, s[16:19], s58 offen sc1
    s_waitcnt lgkmcnt(1)
    buffer_store_dwordx4 v[68:71], v5, s[16:19], s58 offen offset:1024 sc1
    s_waitcnt lgkmcnt(0)
    buffer_store_dwordx2 v[72:73], v6, s[16:19], s58 offen offset:2048 sc1
    s_mov_b32 s59, 0
Lw_1:
    ds_read_b32 v4, v3 offset:56
    s_waitcnt lgkmcnt(0)
    v_cmp_gt_u32 vcc, 2, v4
    s_cbranch_vccz Lk_2
    s_add_u32 s59, s59, 1
    s_cmp_lt_u32 s59, 4194304
    s_cbranch_scc1 Lw_1
    s_branch L_end
Lk_2:
    s_waitcnt vmcnt(0)
    buffer_store_dwordx4 v[60:63], v5, s[16:19], s61 offen sc1
    ds_write_b32 v3, v12 offset:32
    s_branch L_preB
L_notprod:
    s_cmp_lt_u32 s3, 8
    s_cbranch_scc1 L_preA
    s_setprio 3
    s_cmp_eq_u32 s3, 9
    s_cbranch_scc1 L_touch
    s_cmp_ge_u32 s3, 13
    s_cbranch_scc1 L_notm
    s_cmp_ge_u32 s2, 128
    s_cbranch_scc1 L_b1
    s_and_b32 s58, s2, 7
    s_lshr_b32 s59, s2, 4
    s_sub_u32 s60, s3, 10
    s_bfe_u32 s61, s2, 0x10003
    s_cmp_eq_u32 s3, 12
    s_cselect_b32 s58, s59, s58
    s_cselect_b32 s61, s61, s60
    s_cselect_b64 s[24:25], s[48:49], s[46:47]
    s_mov_b32 s26, 131072
    s_lshl_b32 s58, s58, 14
    s_lshl_b32 s61, s61, 11
    s_add_u32 s58, s58, s61
    s_mul_i32 s60, s60, 8448
    v_and_b32 v4, 32, v0
    v_lshl_add_u32 v4, v4, 8, v2
    s_add_u32 m0, s60, 105600
    s_nop 0
    buffer_load_dwordx4 v4, s[24:27], s58 offen offset:0 lds
    s_add_u32 m0, s60, 106144
    s_nop 0
    buffer_load_dwordx4 v4, s[24:27], s58 offen offset:512 lds
    s_add_u32 m0, s60, 106688
    s_nop 0
    buffer_load_dwordx4 v4, s[24:27], s58 offen offset:1024 lds
    s_add_u32 m0, s60, 107232
    s_nop 0
    buffer_load_dwordx4 v4, s[24:27], s58 offen offset:1536 lds
    s_add_u32 m0, s60, 109824
    s_add_u32 s58, s58, 4096
    buffer_load_dwordx4 v4, s[24:27], s58 offen offset:0 lds
    s_add_u32 m0, s60, 110368
    s_nop 0
    buffer_load_dwordx4 v4, s[24:27], s58 offen offset:512 lds
    s_add_u32 m0, s60, 110912
    s_nop 0
    buffer_load_dwordx4 v4, s[24:27], s58 offen offset:1024 lds
    s_add_u32 m0, s60, 111456
    s_nop 0
    buffer_load_dwordx4 v4, s[24:27], s58 offen offset:1536 lds
    s_branch L_b1
L_notm:
    s_cmp_eq_u32 s3, 13
    s_cbranch_scc0 L_b1
    s_cmp_lt_u32 s2, 122
    s_cbranch_scc1 L_b1
    s_sub_u32 s58, s2, 122
    s_cmp_lt_u32 s58, 64
    s_cselect_b64 s[24:25], s[50:51], s[44:45]
    s_mov_b32 s26, 131072
    s_and_b32 s59, s58, 7
    s_lshl_b32 s59, s59, 14
    s_bfe_u32 s60, s58, 0x30003
    s_lshl_b32 s60, s60, 6
    s_add_u32 s59, s59, s60
    v_and_b32 v4, 15, v0
    v_lshlrev_b32 v4, 2, v4
    v_and_b32 v5, 48, v0
    v_lshl_add_u32 v4, v5, 8, v4
    buffer_load_dword v16, v4, s[24:27], s59 offen offset:0
    buffer_load_dword v17, v4, s[24:27], s59 offen offset:512
    buffer_load_dword v18, v4, s[24:27], s59 offen offset:1024
    buffer_load_dword v19, v4, s[24:27], s59 offen offset:1536
    buffer_load_dword v20, v4, s[24:27], s59 offen offset:2048
    buffer_load_dword v21, v4, s[24:27], s59 offen offset:2560
    buffer_load_dword v22, v4, s[24:27], s59 offen offset:3072
    buffer_load_dword v23, v4, s[24:27], s59 offen offset:3584
    s_branch L_b1
L_touch:
    s_mov_b64 s[24:25], s[50:51]
    s_mov_b32 s26, 131072
    s_mov_b64 s[28:29], s[42:43]
    s_mov_b32 s30, 20000
    s_lshr_b32 s58, s2, 3
    s_mul_i32 s59, s58, 640
    s_mul_i32 s58, s58, 4352
    v_lshlrev_b32 v4, 7, v0
    s_mov_b64 exec, 63
    buffer_load_dword v16, v4, s[28:31], s59 offen
    s_lshl_b32 s59, s2, 10
    s_mov_b64 exec, 255
    buffer_load_dword v18, v4, s[16:19], s59 offen
    s_mov_b64 exec, -1
    s_barrier
    s_waitcnt vmcnt(0)
    s_mov_b64 exec, 1
    v_mov_b32 v4, 1
    ds_add_u32 v3, v4 offset:4
    s_mov_b64 exec, -1
    s_branch L_preB
L_b1:
    s_barrier
    s_mov_b64 s[28:29], s[42:43]
    s_mov_b32 s30, 20000
    s_cmp_eq_u32 s3, 9
    s_cbranch_scc1 L_preB
    s_cmp_eq_u32 s3, 10
    s_cbranch_scc1 L_disd
    s_cmp_eq_u32 s3, 13
    s_cbranch_scc1 L_wtask
    s_cmp_lt_u32 s3, 13
    s_cbranch_scc1 L_min
    s_mov_b32 s59, 0
Lw_3:
    ds_read_b32 v4, v3 offset:4
    s_waitcnt lgkmcnt(0)
    v_cmp_gt_u32 vcc, 1, v4
    s_cbranch_vccz Lk_4
    s_sleep 1
    s_add_u32 s59, s59, 1
    s_cmp_lt_u32 s59, 4194304
    s_cbranch_scc1 Lw_3
    s_branch L_end
Lk_4:
    s_sub_u32 s58, s3, 14
    s_mul_i32 s58, s58, 10240
    v_lshlrev_b32 v4, 4, v0
    s_add_u32 m0, s58, 130944
    s_add_u32 s59, s58, 0
    buffer_load_dwordx4 v4, s[28:31], s59 offen offset:0 lds
    buffer_load_dwordx4 v4, s[28:31], s59 offen offset:1024 lds
    buffer_load_dwordx4 v4, s[28:31], s59 offen offset:2048 lds
    buffer_load_dwordx4 v4, s[28:31], s59 offen offset:3072 lds
    s_add_u32 m0, s58, 135040
    s_add_u32 s59, s58, 4096
    buffer_load_dwordx4 v4, s[28:31], s59 offen offset:0 lds
    buffer_load_dwordx4 v4, s[28:31], s59 offen offset:1024 lds
    buffer_load_dwordx4 v4, s[28:31], s59 offen offset:2048 lds
    buffer_load_dwordx4 v4, s[28:31], s59 offen offset:3072 lds
    s_add_u32 m0, s58, 139136
    s_add_u32 s59, s58, 8192
    buffer_load_dwordx4 v4, s[28:31], s59 offen offset:0 lds
    buffer_load_dwordx4 v4, s[28:31], s59 offen offset:1024 lds
    s_branch L_preB
L_min:
    s_waitcnt vmcnt(0)
    s_mov_b64 exec, 1
    v_mov_b32 v4, 1
    ds_add_u32 v3, v4 offset:8
    s_mov_b64 exec, -1
    s_branch L_preB
L_disd:
    s_cmp_ge_u32 s2, 128
    s_cbranch_scc1 L_taskd
    s_setprio 3
    v_and_b32 v4, 7, v0
    v_mul_u32_u24 v1, 1056, v4
    v_and_b32 v4, 8, v0
    v_lshl_add_u32 v1, v4, 6, v1
    v_and_b32 v4, 48, v0
    v_add_u32 v1, v4, v1
    v_add_u32 v5, 105600, v1
    s_lshr_b32 s58, s2, 4
    s_lshl_b32 s58, s58, 3
    s_and_b32 s59, s2, 7
    s_add_u32 s58, s58, s59
    s_lshl_b32 s58, s58, 1
    s_bfe_u32 s59, s2, 0x10003
    s_add_u32 s58, s58, s59
    s_lshl_b32 s58, s58, 10
    s_add_u32 s58, s58, 1048576
    v_lshlrev_b32 v6, 4, v0
    s_waitcnt vmcnt(0)
    s_mov_b32 s59, 0
Lw_5:
    ds_read_b32 v4, v3 offset:8
    s_waitcnt lgkmcnt(0)
    v_cmp_gt_u32 vcc, 2, v4
    s_cbranch_vccz Lk_6
    s_add_u32 s59, s59, 1
    s_cmp_lt_u32 s59, 4194304
    s_cbranch_scc1 Lw_5
    s_branch L_end
Lk_6:
    ds_read_b128 v[32:35], v5 offset:0
    ds_read_b128 v[36:39], v5 offset:8448
    ds_read_b128 v[40:43], v5 offset:16896
    ds_read_b128 v[44:47], v5 offset:64
    ds_read_b128 v[48:51], v5 offset:8512
    ds_read_b128 v[52:55], v5 offset:16960
    ds_read_b128 v[56:59], v5 offset:128
    ds_read_b128 v[60:63], v5 offset:8576
    ds_read_b128 v[64:67], v5 offset:17024
    ds_read_b128 v[68:71], v5 offset:192
    ds_read_b128 v[72:75], v5 offset:8640
    ds_read_b128 v[76:79], v5 offset:17088
    s_waitcnt lgkmcnt(9)
    ds_read_b128 v[80:83], v5 offset:256
    ds_read_b128 v[84:87], v5 offset:8704
    ds_read_b128 v[88:91], v5 offset:17152
    v_mfma_f32_16x16x32_bf16 v[8:11], v[32:35], v[40:43], 0
    v_mfma_f32_16x16x32_bf16 v[12:15], v[36:39], v[40:43], 0
    s_waitcnt lgkmcnt(9)
    ds_read_b128 v[92:95], v5 offset:320
    ds_read_b128 v[96:99], v5 offset:8768
    ds_read_b128 v[100:103], v5 offset:17216
    v_mfma_f32_16x16x32_bf16 v[8:11], v[44:47], v[52:55], v[8:11]
    v_mfma_f32_16x16x32_bf16 v[12:15], v[48:51], v[52:55], v[12:15]
    s_waitcnt lgkmcnt(9)
    ds_read_b128 v[104:107], v5 offset:384
    ds_read_b128 v[108:111], v5 offset:8832
    ds_read_b128 v[112:115], v5 offset:17280
    v_mfma_f32_16x16x32_bf16 v[8:11], v[56:59], v[64:67], v[8:11]
    v_mfma_f32_16x16x32_bf16 v[12:15], v[60:63], v[64:67], v[12:15]
    s_waitcnt lgkmcnt(9)
    ds_read_b128 v[116:119], v5 offset:448
    ds_read_b128 v[120:123], v5 offset:8896
    ds_read_b128 v[124:127], v5 offset:17344
    v_mfma_f32_16x16x32_bf16 v[8:11], v[68:71], v[76:79], v[8:11]
    v_mfma_f32_16x16x32_bf16 v[12:15], v[72:75], v[76:79], v[12:15]
    s_waitcnt lgkmcnt(9)
    v_mfma_f32_16x16x32_bf16 v[8:11], v[80:83], v[88:91], v[8:11]
    v_mfma_f32_16x16x32_bf16 v[12:15], v[84:87], v[88:91], v[12:15]
    s_waitcnt lgkmcnt(6)
    v_mfma_f32_16x16x32_bf16 v[8:11], v[92:95], v[100:103], v[8:11]
    v_mfma_f32_16x16x32_bf16 v[12:15], v[96:99], v[100:103], v[12:15]
    s_waitcnt lgkmcnt(3)
    v_mfma_f32_16x16x32_bf16 v[8:11], v[104:107], v[112:115], v[8:11]
    v_mfma_f32_16x16x32_bf16 v[12:15], v[108:111], v[112:115], v[12:15]
    s_waitcnt lgkmcnt(0)
    v_mfma_f32_16x16x32_bf16 v[8:11], v[116:119], v[124:127], v[8:11]
    v_mfma_f32_16x16x32_bf16 v[12:15], v[120:123], v[124:127], v[12:15]
    s_nop 6
    v_cvt_pk_bf16_f32 v16, v8, v9
    v_cvt_pk_bf16_f32 v17, v10, v11
    v_cvt_pk_bf16_f32 v18, v12, v13
    v_cvt_pk_bf16_f32 v19, v14, v15
    buffer_store_dwordx4 v[16:19], v6, s[16:19], s58 offen sc1
    s_branch L_taskw
L_wtask:
    s_cmp_lt_u32 s2, 122
    s_cbranch_scc1 L_taskd
    s_sub_u32 s58, s2, 122
    s_lshl_b32 s58, s58, 11
    s_add_u32 s58, s58, 1179648
    v_lshlrev_b32 v6, 4, v0
    s_waitcnt vmcnt(0)
    v_perm_b32 v60, v17, v16, s70
    v_perm_b32 v64, v17, v16, s71
    v_perm_b32 v61, v19, v18, s70
    v_perm_b32 v65, v19, v18, s71
    v_perm_b32 v62, v21, v20, s70
    v_perm_b32 v66, v21, v20, s71
    v_perm_b32 v63, v23, v22, s70
    v_perm_b32 v67, v23, v22, s71
    buffer_store_dwordx4 v[60:63], v6, s[16:19], s58 offen sc1
    buffer_store_dwordx4 v[64:67], v6, s[16:19], s58 offen offset:1024 sc1
L_taskw:
    s_waitcnt vmcnt(0)
L_taskd:
    s_mov_b64 exec, 1
    v_mov_b32 v4, 1
    ds_add_u32 v3, v4 offset:56
    s_mov_b64 exec, -1
    s_branch L_preB
L_preA:
    s_barrier
    s_setprio 2
    s_mov_b64 s[12:13], s[38:39]
    s_mov_b32 s14, 160000
    s_mov_b32 s59, 0
Lw_7:
    ds_read_b32 v4, v3 offset:32
    s_waitcnt lgkmcnt(0)
    v_cmp_gt_u32 vcc, 1, v4
    s_cbranch_vccz Lk_8
    s_sleep 1
    s_add_u32 s59, s59, 1
    s_cmp_lt_u32 s59, 4194304
    s_cbranch_scc1 Lw_7
    s_branch L_end
Lk_8:
    v_and_b32 v6, 32, v0
    s_mul_i32 s58, s6, 640
    s_lshl_b32 s59, s3, 6
    s_add_u32 s59, s58, s59
    s_lshr_b32 s60, s3, 2
    s_lshl_b32 s60, s60, 6
    s_and_b32 s61, s3, 3
    s_lshl_b32 s61, s61, 3
    s_add_u32 s58, s58, s60
    s_add_u32 s58, s58, s61
    buffer_load_dwordx4 v[104:107], v6, s[12:15], s59 offen
    buffer_load_dwordx4 v[108:111], v6, s[12:15], s59 offen offset:16
    buffer_load_dwordx2 v[112:113], v6, s[12:15], s58 offen offset:512
    v_lshl_add_u32 v5, v6, 7, v2
    v_lshl_add_u32 v6, v6, 6, v2
    s_add_u32 s58, s3, s5
    s_mul_i32 s59, s3, 1056
    s_add_u32 m0, s59, 84480
    s_lshl_b32 s58, s58, 9
    buffer_load_dwordx4 v5, s[8:11], s58 offen lds
    s_add_u32 m0, s59, 92928
    s_add_u32 s58, s58, 8192
    buffer_load_dwordx4 v5, s[8:11], s58 offen lds
    s_cmp_ge_u32 s3, 4
    s_cbranch_scc1 L_xa2
    s_add_u32 m0, s59, 101376
    s_add_u32 s58, s58, 8192
    buffer_load_dwordx4 v6, s[8:11], s58 offen lds
L_xa2:
    v_and_b32 v4, 7, v0
    v_mul_u32_u24 v1, 1056, v4
    v_and_b32 v4, 8, v0
    v_lshl_add_u32 v1, v4, 6, v1
    v_and_b32 v4, 48, v0
    v_add_u32 v1, v4, v1
    s_mov_b32 s20, s52
    s_mov_b32 s21, s53
    s_mov_b32 s22, 5120000
    s_mov_b32 s23, 0x20000
    v_lshlrev_b32 v14, 4, v0
    s_lshl_b32 s100, s3, 14
    s_add_u32 s100, s100, 1048576
    v_add_u32 v12, 84480, v1
    s_lshl_b32 s61, s3, 6
    s_add_u32 s61, s61, 105600
    v_add_u32 v13, s61, v1
    s_mul_i32 s60, s3, 2112
    s_mul_i32 s61, s3, 8448
    s_waitcnt vmcnt(0)
    s_mov_b64 exec, 1
    v_mov_b32 v4, 1
    ds_add_u32 v3, v4 offset:0
    s_mov_b64 exec, -1
    v_lshl_add_u32 v104, v104, 9, v2
    v_lshl_add_u32 v105, v105, 9, v2
    v_lshl_add_u32 v106, v106, 9, v2
    v_lshl_add_u32 v107, v107, 9, v2
    v_lshl_add_u32 v108, v108, 9, v2
    v_lshl_add_u32 v109, v109, 9, v2
    v_lshl_add_u32 v110, v110, 9, v2
    v_lshl_add_u32 v111, v111, 9, v2
    v_lshl_add_u32 v112, v112, 9, v2
    v_lshl_add_u32 v113, v113, 9, v2
    s_mov_b32 s59, 0
Lw_9:
    ds_read_b32 v4, v3 offset:52
    s_waitcnt lgkmcnt(0)
    v_cmp_gt_u32 vcc, 8, v4
    s_cbranch_vccz Lk_10
    s_sleep 1
    s_add_u32 s59, s59, 1
    s_cmp_lt_u32 s59, 4194304
    s_cbranch_scc1 Lw_9
    s_branch L_end
Lk_10:
    s_setprio 2
    s_add_u32 m0, s61, 0
    s_waitcnt vmcnt(63)
    buffer_load_dwordx4 v104, s[8:11], 0 offen lds
    buffer_load_dwordx4 v[16:19], v14, s[16:19], s100 offen offset:0 sc1
    buffer_load_dwordx4 v[20:23], v14, s[16:19], s100 offen offset:1024 sc1
    s_add_u32 m0, s61, 1056
    s_waitcnt vmcnt(63)
    buffer_load_dwordx4 v105, s[8:11], 0 offen lds
    buffer_load_dwordx4 v[24:27], v14, s[16:19], s100 offen offset:2048 sc1
    buffer_load_dwordx4 v[28:31], v14, s[16:19], s100 offen offset:3072 sc1
    s_add_u32 m0, s61, 2112
    s_waitcnt vmcnt(63)
    buffer_load_dwordx4 v106, s[8:11], 0 offen lds
    s_add_u32 s100, s100, 4096
    buffer_load_dwordx4 v[32:35], v14, s[16:19], s100 offen offset:0 sc1
    buffer_load_dwordx4 v[36:39], v14, s[16:19], s100 offen offset:1024 sc1
    s_add_u32 m0, s61, 3168
    s_waitcnt vmcnt(63)
    buffer_load_dwordx4 v107, s[8:11], 0 offen lds
    s_add_u32 m0, s61, 4224
    s_waitcnt vmcnt(63)
    buffer_load_dwordx4 v108, s[8:11], 0 offen lds
    buffer_load_dwordx4 v[40:43], v14, s[16:19], s100 offen offset:2048 sc1
    buffer_load_dwordx4 v[44:47], v14, s[16:19], s100 offen offset:3072 sc1
    s_add_u32 m0, s61, 5280
    s_waitcnt vmcnt(63)
    buffer_load_dwordx4 v109, s[8:11], 0 offen lds
    s_add_u32 s100, s100, 4096
    buffer_load_dwordx4 v[48:51], v14, s[16:19], s100 offen offset:0 sc1
    buffer_load_dwordx4 v[52:55], v14, s[16:19], s100 offen offset:1024 sc1
    s_add_u32 m0, s61, 6336
    s_waitcnt vmcnt(63)
    buffer_load_dwordx4 v110, s[8:11], 0 offen lds
    buffer_load_dwordx4 v[56:59], v14, s[16:19], s100 offen offset:2048 sc1
    buffer_load_dwordx4 v[60:63], v14, s[16:19], s100 offen offset:3072 sc1
    s_add_u32 m0, s61, 7392
    s_waitcnt vmcnt(63)
    buffer_load_dwordx4 v111, s[8:11], 0 offen lds
    s_add_u32 s100, s100, 4096
    buffer_load_dwordx4 v[64:67], v14, s[16:19], s100 offen offset:0 sc1
    buffer_load_dwordx4 v[68:71], v14, s[16:19], s100 offen offset:1024 sc1
    s_add_u32 m0, s60, 67584
    s_waitcnt vmcnt(63)
    buffer_load_dwordx4 v112, s[8:11], 0 offen lds
    s_add_u32 m0, s60, 68640
    s_waitcnt vmcnt(63)
    buffer_load_dwordx4 v113, s[8:11], 0 offen lds
    buffer_load_dwordx4 v[72:75], v14, s[16:19], s100 offen offset:2048 sc1
    buffer_load_dwordx4 v[76:79], v14, s[16:19], s100 offen offset:3072 sc1
    s_setprio 0
    s_mov_b32 s59, 0
Lw_11:
    ds_read_b32 v4, v3 offset:0
    s_waitcnt lgkmcnt(0)
    v_cmp_gt_u32 vcc, 8, v4
    s_cbranch_vccz Lk_12
    s_add_u32 s59, s59, 1
    s_cmp_lt_u32 s59, 4194304
    s_cbranch_scc1 Lw_11
    s_branch L_end
Lk_12:
    ds_read_b128 v[80:83], v12 offset:0
    ds_read_b128 v[84:87], v12 offset:8448
    ds_read_b128 v[88:91], v12 offset:16896
    ds_read_b128 v[92:95], v12 offset:64
    ds_read_b128 v[96:99], v12 offset:8512
    ds_read_b128 v[100:103], v12 offset:16960
    s_waitcnt vmcnt(23) lgkmcnt(3)
    v_mfma_f32_16x16x32_bf16 v[104:107], v[16:19], v[80:83], 0
    v_mfma_f32_16x16x32_bf16 v[108:111], v[20:23], v[80:83], 0
    v_mfma_f32_16x16x32_bf16 v[112:115], v[16:19], v[84:87], 0
    v_mfma_f32_16x16x32_bf16 v[116:119], v[20:23], v[84:87], 0
    v_mfma_f32_16x16x32_bf16 v[120:123], v[16:19], v[88:91], 0
    v_mfma_f32_16x16x32_bf16 v[124:127], v[20:23], v[88:91], 0
    ds_read_b128 v[80:83], v12 offset:128
    ds_read_b128 v[84:87], v12 offset:8576
    ds_read_b128 v[88:91], v12 offset:17024
    s_waitcnt vmcnt(20) lgkmcnt(3)
    v_mfma_f32_16x16x32_bf16 v[104:107], v[24:27], v[92:95], v[104:107]
    v_mfma_f32_16x16x32_bf16 v[108:111], v[28:31], v[92:95], v[108:111]
    v_mfma_f32_16x16x32_bf16 v[112:115], v[24:27], v[96:99], v[112:115]
    v_mfma_f32_16x16x32_bf16 v[116:119], v[28:31], v[96:99], v[116:119]
    v_mfma_f32_16x16x32_bf16 v[120:123], v[24:27], v[100:103], v[120:123]
    v_mfma_f32_16x16x32_bf16 v[124:127], v[28:31], v[100:103], v[124:127]
    ds_read_b128 v[92:95], v12 offset:192
    ds_read_b128 v[96:99], v12 offset:8640
    ds_read_b128 v[100:103], v12 offset:17088
    s_waitcnt vmcnt(17) lgkmcnt(3)
    v_mfma_f32_16x16x32_bf16 v[104:107], v[32:35], v[80:83], v[104:107]
    v_mfma_f32_16x16x32_bf16 v[108:111], v[36:39], v[80:83], v[108:111]
    v_mfma_f32_16x16x32_bf16 v[112:115], v[32:35], v[84:87], v[112:115]
    v_mfma_f32_16x16x32_bf16 v[116:119], v[36:39], v[84:87], v[116:119]
    v_mfma_f32_16x16x32_bf16 v[120:123], v[32:35], v[88:91], v[120:123]
    v_mfma_f32_16x16x32_bf16 v[124:127], v[36:39], v[88:91], v[124:127]
    ds_read_b128 v[80:83], v12 offset:256
    ds_read_b128 v[84:87], v12 offset:8704
    ds_read_b128 v[88:91], v12 offset:17152
    s_waitcnt vmcnt(13) lgkmcnt(3)
    v_mfma_f32_16x16x32_bf16 v[104:107], v[40:43], v[92:95], v[104:107]
    v_mfma_f32_16x16x32_bf16 v[108:111], v[44:47], v[92:95], v[108:111]
    v_mfma_f32_16x16x32_bf16 v[112:115], v[40:43], v[96:99], v[112:115]
    v_mfma_f32_16x16x32_bf16 v[116:119], v[44:47], v[96:99], v[116:119]
    v_mfma_f32_16x16x32_bf16 v[120:123], v[40:43], v[100:103], v[120:123]
    v_mfma_f32_16x16x32_bf16 v[124:127], v[44:47], v[100:103], v[124:127]
    ds_read_b128 v[92:95], v12 offset:320
    ds_read_b128 v[96:99], v12 offset:8768
    ds_read_b128 v[100:103], v12 offset:17216
    s_waitcnt vmcnt(10) lgkmcnt(3)
    v_mfma_f32_16x16x32_bf16 v[104:107], v[48:51], v[80:83], v[104:107]
    v_mfma_f32_16x16x32_bf16 v[108:111], v[52:55], v[80:83], v[108:111]
    v_mfma_f32_16x16x32_bf16 v[112:115], v[48:51], v[84:87], v[112:115]
    v_mfma_f32_16x16x32_bf16 v[116:119], v[52:55], v[84:87], v[116:119]
    v_mfma_f32_16x16x32_bf16 v[120:123], v[48:51], v[88:91], v[120:123]
    v_mfma_f32_16x16x32_bf16 v[124:127], v[52:55], v[88:91], v[124:127]
    ds_read_b128 v[80:83], v12 offset:384
    ds_read_b128 v[84:87], v12 offset:8832
    ds_read_b128 v[88:91], v12 offset:17280
    s_waitcnt vmcnt(7) lgkmcnt(3)
    v_mfma_f32_16x16x32_bf16 v[104:107], v[56:59], v[92:95], v[104:107]
    v_mfma_f32_16x16x32_bf16 v[108:111], v[60:63], v[92:95], v[108:111]
    v_mfma_f32_16x16x32_bf16 v[112:115], v[56:59], v[96:99], v[112:115]
    v_mfma_f32_16x16x32_bf16 v[116:119], v[60:63], v[96:99], v[116:119]
    v_mfma_f32_16x16x32_bf16 v[120:123], v[56:59], v[100:103], v[120:123]
    v_mfma_f32_16x16x32_bf16 v[124:127], v[60:63], v[100:103], v[124:127]
    ds_read_b128 v[92:95], v12 offset:448
    ds_read_b128 v[96:99], v12 offset:8896
    ds_read_b128 v[100:103], v12 offset:17344
    s_waitcnt vmcnt(4) lgkmcnt(3)
    v_mfma_f32_16x16x32_bf16 v[104:107], v[64:67], v[80:83], v[104:107]
    v_mfma_f32_16x16x32_bf16 v[108:111], v[68:71], v[80:83], v[108:111]
    v_mfma_f32_16x16x32_bf16 v[112:115], v[64:67], v[84:87], v[112:115]
    v_mfma_f32_16x16x32_bf16 v[116:119], v[68:71], v[84:87], v[116:119]
    v_mfma_f32_16x16x32_bf16 v[120:123], v[64:67], v[88:91], v[120:123]
    v_mfma_f32_16x16x32_bf16 v[124:127], v[68:71], v[88:91], v[124:127]
    s_waitcnt vmcnt(0) lgkmcnt(0)
    v_mfma_f32_16x16x32_bf16 v[104:107], v[72:75], v[92:95], v[104:107]
    v_mfma_f32_16x16x32_bf16 v[108:111], v[76:79], v[92:95], v[108:111]
    v_mfma_f32_16x16x32_bf16 v[112:115], v[72:75], v[96:99], v[112:115]
    v_mfma_f32_16x16x32_bf16 v[116:119], v[76:79], v[96:99], v[116:119]
    v_mfma_f32_16x16x32_bf16 v[120:123], v[72:75], v[100:103], v[120:123]
    v_mfma_f32_16x16x32_bf16 v[124:127], v[76:79], v[100:103], v[124:127]
    s_nop 3
    v_cvt_pk_bf16_f32 v80, v104, v105
    v_cvt_pk_bf16_f32 v81, v106, v107
    v_cvt_pk_bf16_f32 v82, v108, v109
    v_cvt_pk_bf16_f32 v83, v110, v111
    ds_write_b128 v13, v[80:83] offset:0
    v_cvt_pk_bf16_f32 v84, v112, v113
    v_cvt_pk_bf16_f32 v85, v114, v115
    v_cvt_pk_bf16_f32 v86, v116, v117
    v_cvt_pk_bf16_f32 v87, v118, v119
    ds_write_b128 v13, v[84:87] offset:8448
    v_cvt_pk_bf16_f32 v88, v120, v121
    v_cvt_pk_bf16_f32 v89, v122, v123
    v_cvt_pk_bf16_f32 v90, v124, v125
    v_cvt_pk_bf16_f32 v91, v126, v127
    ds_write_b128 v13, v[88:91] offset:16896
    s_mov_b64 exec, 1
    v_mov_b32 v4, 1
    ds_add_u32 v3, v4 offset:20
    s_mov_b64 exec, -1
    s_setprio 2
    s_add_u32 s100, s100, 118784
    buffer_load_dwordx4 v[16:19], v14, s[16:19], s100 offen offset:0 sc1
    buffer_load_dwordx4 v[20:23], v14, s[16:19], s100 offen offset:1024 sc1
    buffer_load_dwordx4 v[24:27], v14, s[16:19], s100 offen offset:2048 sc1
    buffer_load_dwordx4 v[28:31], v14, s[16:19], s100 offen offset:3072 sc1
    s_add_u32 s100, s100, 4096
    buffer_load_dwordx4 v[32:35], v14, s[16:19], s100 offen offset:0 sc1
    buffer_load_dwordx4 v[36:39], v14, s[16:19], s100 offen offset:1024 sc1
    buffer_load_dwordx4 v[40:43], v14, s[16:19], s100 offen offset:2048 sc1
    buffer_load_dwordx4 v[44:47], v14, s[16:19], s100 offen offset:3072 sc1
    s_add_u32 s100, s100, 4096
    buffer_load_dwordx4 v[48:51], v14, s[16:19], s100 offen offset:0 sc1
    buffer_load_dwordx4 v[52:55], v14, s[16:19], s100 offen offset:1024 sc1
    buffer_load_dwordx4 v[56:59], v14, s[16:19], s100 offen offset:2048 sc1
    buffer_load_dwordx4 v[60:63], v14, s[16:19], s100 offen offset:3072 sc1
    s_add_u32 s100, s100, 4096
    buffer_load_dwordx4 v[64:67], v14, s[16:19], s100 offen offset:0 sc1
    buffer_load_dwordx4 v[68:71], v14, s[16:19], s100 offen offset:1024 sc1
    buffer_load_dwordx4 v[72:75], v14, s[16:19], s100 offen offset:2048 sc1
    buffer_load_dwordx4 v[76:79], v14, s[16:19], s100 offen offset:3072 sc1
    s_setprio 0
    v_and_b32 v4, 3, v0
    v_mov_b32 v5, 0x0c0c0c0c
    v_mov_b32 v6, 0x0c0c0302
    v_mov_b32 v7, 0x03020c0c
    v_cmp_eq_u32 s[58:59], 0, v4
    v_cmp_eq_u32 s[60:61], 2, v4
    v_cmp_eq_u32 vcc, 1, v4
    v_cndmask_b32 v10, v5, v6, s[58:59]
    v_cndmask_b32 v11, v5, v6, s[60:61]
    v_cndmask_b32 v10, v10, v7, vcc
    v_cmp_eq_u32 vcc, 3, v4
    s_nop 1
    v_cndmask_b32 v11, v11, v7, vcc
    v_and_b32 v8, 0xfdfdfdfd, v10
    v_and_b32 v9, 0xfdfdfdfd, v11
    s_mov_b32 s63, s3
L_grp:
    s_mul_i32 s58, s63, 8448
    s_lshr_b32 s59, s63, 2
    s_mul_i32 s59, s59, 8448
    s_and_b32 s60, s63, 1
    s_bfe_u32 s61, s63, 0x10001
    s_cmp_ge_u32 s63, 8
    s_cselect_b32 s61, s60, s61
    s_cselect_b32 s60, 0, s60
    s_mul_i32 s60, s60, 4224
    s_lshl_b32 s61, s61, 9
    s_add_u32 s59, s59, s60
    s_add_u32 s59, s59, s61
    s_add_u32 s59, s59, 105600
    v_add_u32 v12, s58, v1
    v_bfe_u32 v4, v0, 2, 2
    v_mul_u32_u24 v4, 1056, v4
    v_and_b32 v5, 48, v0
    v_add3_u32 v13, v4, v5, s59
    v_lshl_add_u32 v14, v0, 3, s58
    v_lshl_add_u32 v2, v0, 3, s59
    s_cmp_ge_u32 s63, 8
    s_cbranch_scc1 L_grp2
    s_mov_b32 s59, 0
Lw_13:
    ds_read_b32 v4, v3 offset:20
    s_waitcnt lgkmcnt(0)
    v_cmp_gt_u32 vcc, 8, v4
    s_cbranch_vccz Lk_14
    s_add_u32 s59, s59, 1
    s_cmp_lt_u32 s59, 4194304
    s_cbranch_scc1 Lw_13
    s_branch L_end
Lk_14:
L_grp2:
    s_waitcnt lgkmcnt(0)
    ds_read_b128 v[80:83], v12 offset:0
    ds_read_b128 v[84:87], v13 offset:0
    ds_read_b128 v[88:91], v12 offset:64
    ds_read_b128 v[92:95], v13 offset:64
    ds_read_b128 v[96:99], v12 offset:128
    ds_read_b128 v[100:103], v13 offset:128
    ds_read_b128 v[104:107], v12 offset:192
    ds_read_b128 v[108:111], v13 offset:192
    ds_read_b128 v[112:115], v12 offset:256
    ds_read_b128 v[116:119], v13 offset:256
    ds_read_b128 v[120:123], v12 offset:320
    ds_read_b128 v[124:127], v13 offset:320
    s_waitcnt lgkmcnt(10)
    v_mfma_f32_16x16x32_bf16 v[4:7], v[80:83], v[84:87], 0
    ds_read_b128 v[80:83], v12 offset:384
    ds_read_b128 v[84:87], v13 offset:384
    s_waitcnt lgkmcnt(10)
    v_mfma_f32_16x16x32_bf16 v[4:7], v[88:91], v[92:95], v[4:7]
    ds_read_b128 v[88:91], v12 offset:448
    ds_read_b128 v[92:95], v13 offset:448
    s_waitcnt lgkmcnt(10)
    v_mfma_f32_16x16x32_bf16 v[4:7], v[96:99], v[100:103], v[4:7]
    s_waitcnt lgkmcnt(8)
    v_mfma_f32_16x16x32_bf16 v[4:7], v[104:107], v[108:111], v[4:7]
    s_waitcnt lgkmcnt(6)
    v_mfma_f32_16x16x32_bf16 v[4:7], v[112:115], v[116:119], v[4:7]
    s_waitcnt lgkmcnt(4)
    v_mfma_f32_16x16x32_bf16 v[4:7], v[120:123], v[124:127], v[4:7]
    s_waitcnt lgkmcnt(2)
    v_mfma_f32_16x16x32_bf16 v[4:7], v[80:83], v[84:87], v[4:7]
    s_waitcnt lgkmcnt(0)
    v_mfma_f32_16x16x32_bf16 v[4:7], v[88:91], v[92:95], v[4:7]
    ds_read_b64 v[96:97], v14 offset:2112
    ds_read_b64 v[98:99], v14 offset:6336
    ds_read_b64 v[100:101], v14 offset:2624
    ds_read_b64 v[102:103], v14 offset:6848
    ds_read_b64 v[104:105], v14 offset:3168
    ds_read_b64 v[106:107], v14 offset:7392
    ds_read_b64 v[108:109], v14 offset:3680
    ds_read_b64 v[110:111], v14 offset:7904
    ds_read_b64 v[80:81], v14 offset:0
    ds_read_b64 v[82:83], v14 offset:4224
    ds_read_b64 v[84:85], v14 offset:512
    ds_read_b64 v[86:87], v14 offset:4736
    ds_read_b64 v[88:89], v14 offset:1056
    ds_read_b64 v[90:91], v14 offset:5280
    ds_read_b64 v[92:93], v14 offset:1568
    s_waitcnt lgkmcnt(14)
    ds_read_b64 v[94:95], v14 offset:5792
    v_mul_f32 v4, 0x3db8aa3b, v4
    v_mul_f32 v5, 0x3db8aa3b, v5
    v_mul_f32 v6, 0x3db8aa3b, v6
    v_mul_f32 v7, 0x3db8aa3b, v7
    v_exp_f32 v4, v4
    v_exp_f32 v5, v5
    v_exp_f32 v6, v6
    v_exp_f32 v7, v7
    v_add_f32 v12, v4, v5
    v_add_f32 v13, v6, v7
    v_add_f32 v12, v12, v13
    v_add_f32 v12, 0x3089705f, v12
    v_rcp_f32 v12, v12
    s_add_u32 s63, s63, 8
    v_mul_f32 v4, v4, v12
    v_mul_f32 v5, v5, v12
    v_mul_f32 v6, v6, v12
    v_mul_f32 v7, v7, v12
    v_cvt_pk_bf16_f32 v4, v4, v5
    v_cvt_pk_bf16_f32 v6, v6, v7
    v_perm_b32 v112, v4, v4, v8
    v_perm_b32 v113, v4, v4, v9
    v_perm_b32 v114, v4, v4, v10
    v_perm_b32 v115, v4, v4, v11
    v_perm_b32 v116, v6, v6, v8
    v_perm_b32 v117, v6, v6, v9
    v_perm_b32 v118, v6, v6, v10
    v_perm_b32 v119, v6, v6, v11
    s_waitcnt lgkmcnt(0)
    v_mfma_f32_4x4x4_16b_bf16 v[120:123], v[112:113], v[80:81], 0 cbsz:4 abid:0
    v_mfma_f32_4x4x4_16b_bf16 v[124:127], v[112:113], v[82:83], 0 cbsz:4 abid:5
    v_mfma_f32_4x4x4_16b_bf16 v[4:7], v[112:113], v[84:85], 0 cbsz:4 abid:10
    v_mfma_f32_4x4x4_16b_bf16 v[12:15], v[112:113], v[86:87], 0 cbsz:4 abid:15
    v_mfma_f32_4x4x4_16b_bf16 v[120:123], v[114:115], v[88:89], v[120:123] cbsz:4 abid:0
    v_mfma_f32_4x4x4_16b_bf16 v[124:127], v[114:115], v[90:91], v[124:127] cbsz:4 abid:5
    v_mfma_f32_4x4x4_16b_bf16 v[4:7], v[114:115], v[92:93], v[4:7] cbsz:4 abid:10
    v_mfma_f32_4x4x4_16b_bf16 v[12:15], v[114:115], v[94:95], v[12:15] cbsz:4 abid:15
    v_mfma_f32_4x4x4_16b_bf16 v[120:123], v[116:117], v[96:97], v[120:123] cbsz:4 abid:0
    v_mfma_f32_4x4x4_16b_bf16 v[124:127], v[116:117], v[98:99], v[124:127] cbsz:4 abid:5
    v_mfma_f32_4x4x4_16b_bf16 v[4:7], v[116:117], v[100:101], v[4:7] cbsz:4 abid:10
    v_mfma_f32_4x4x4_16b_bf16 v[12:15], v[116:117], v[102:103], v[12:15] cbsz:4 abid:15
    v_mfma_f32_4x4x4_16b_bf16 v[120:123], v[118:119], v[104:105], v[120:123] cbsz:4 abid:0
    v_mfma_f32_4x4x4_16b_bf16 v[124:127], v[118:119], v[106:107], v[124:127] cbsz:4 abid:5
    v_mfma_f32_4x4x4_16b_bf16 v[4:7], v[118:119], v[108:109], v[4:7] cbsz:4 abid:10
    v_mfma_f32_4x4x4_16b_bf16 v[12:15], v[118:119], v[110:111], v[12:15] cbsz:4 abid:15
    s_nop 1
    v_cvt_pk_bf16_f32 v112, v120, v121
    v_cvt_pk_bf16_f32 v113, v122, v123
    ds_write_b64 v2, v[112:113] offset:0
    v_cvt_pk_bf16_f32 v114, v124, v125
    v_cvt_pk_bf16_f32 v115, v126, v127
    ds_write_b64 v2, v[114:115] offset:1056
    v_cvt_pk_bf16_f32 v116, v4, v5
    v_cvt_pk_bf16_f32 v117, v6, v7
    ds_write_b64 v2, v[116:117] offset:2112
    v_cvt_pk_bf16_f32 v118, v12, v13
    v_cvt_pk_bf16_f32 v119, v14, v15
    ds_write_b64 v2, v[118:119] offset:3168
    s_cmp_lt_u32 s63, 10
    s_cbranch_scc1 L_grp
    s_mov_b64 exec, 1
    v_mov_b32 v4, 1
    ds_add_u32 v3, v4 offset:24
    s_mov_b64 exec, -1
    v_add_u32 v12, 105600, v1
    v_lshlrev_b32 v14, 4, v0
    v_and_b32 v6, 15, v0
    v_lshlrev_b32 v6, 2, v6
    v_and_b32 v5, 48, v0
    v_lshl_add_u32 v8, v5, 7, v6
    v_and_b32 v5, 32, v0
    v_lshl_add_u32 v9, v5, 6, v6
    v_and_b32 v5, 16, v0
    v_lshl_add_u32 v9, v5, 22, v9
    s_lshl_b32 s60, s5, 9
    s_lshl_b32 s61, s3, 6
    s_add_u32 s60, s60, s61
    s_mov_b32 s59, 0
Lw_15:
    ds_read_b32 v4, v3 offset:24
    s_waitcnt lgkmcnt(0)
    v_cmp_gt_u32 vcc, 8, v4
    s_cbranch_vccz Lk_16
    s_add_u32 s59, s59, 1
    s_cmp_lt_u32 s59, 4194304
    s_cbranch_scc1 Lw_15
    s_branch L_end
Lk_16:
    ds_read_b128 v[80:83], v12 offset:0
    ds_read_b128 v[84:87], v12 offset:8448
    ds_read_b128 v[88:91], v12 offset:16896
    ds_read_b128 v[92:95], v12 offset:64
    ds_read_b128 v[96:99], v12 offset:8512
    ds_read_b128 v[100:103], v12 offset:16960
    s_waitcnt vmcnt(14) lgkmcnt(3)
    v_mfma_f32_16x16x32_bf16 v[104:107], v[80:83], v[16:19], 0
    v_mfma_f32_16x16x32_bf16 v[108:111], v[80:83], v[20:23], 0
    v_mfma_f32_16x16x32_bf16 v[112:115], v[84:87], v[16:19], 0
    v_mfma_f32_16x16x32_bf16 v[116:119], v[84:87], v[20:23], 0
    v_mfma_f32_16x16x32_bf16 v[120:123], v[88:91], v[16:19], 0
    v_mfma_f32_16x16x32_bf16 v[124:127], v[88:91], v[20:23], 0
    ds_read_b128 v[80:83], v12 offset:128
    ds_read_b128 v[84:87], v12 offset:8576
    ds_read_b128 v[88:91], v12 offset:17024
    s_waitcnt vmcnt(12) lgkmcnt(3)
    v_mfma_f32_16x16x32_bf16 v[104:107], v[92:95], v[24:27], v[104:107]
    v_mfma_f32_16x16x32_bf16 v[108:111], v[92:95], v[28:31], v[108:111]
    v_mfma_f32_16x16x32_bf16 v[112:115], v[96:99], v[24:27], v[112:115]
    v_mfma_f32_16x16x32_bf16 v[116:119], v[96:99], v[28:31], v[116:119]
    v_mfma_f32_16x16x32_bf16 v[120:123], v[100:103], v[24:27], v[120:123]
    v_mfma_f32_16x16x32_bf16 v[124:127], v[100:103], v[28:31], v[124:127]
    ds_read_b128 v[92:95], v12 offset:192
    ds_read_b128 v[96:99], v12 offset:8640
    ds_read_b128 v[100:103], v12 offset:17088
    s_waitcnt vmcnt(10) lgkmcnt(3)
    v_mfma_f32_16x16x32_bf16 v[104:107], v[80:83], v[32:35], v[104:107]
    v_mfma_f32_16x16x32_bf16 v[108:111], v[80:83], v[36:39], v[108:111]
    v_mfma_f32_16x16x32_bf16 v[112:115], v[84:87], v[32:35], v[112:115]
    v_mfma_f32_16x16x32_bf16 v[116:119], v[84:87], v[36:39], v[116:119]
    v_mfma_f32_16x16x32_bf16 v[120:123], v[88:91], v[32:35], v[120:123]
    v_mfma_f32_16x16x32_bf16 v[124:127], v[88:91], v[36:39], v[124:127]
    ds_read_b128 v[80:83], v12 offset:256
    ds_read_b128 v[84:87], v12 offset:8704
    ds_read_b128 v[88:91], v12 offset:17152
    s_waitcnt vmcnt(8) lgkmcnt(3)
    v_mfma_f32_16x16x32_bf16 v[104:107], v[92:95], v[40:43], v[104:107]
    v_mfma_f32_16x16x32_bf16 v[108:111], v[92:95], v[44:47], v[108:111]
    v_mfma_f32_16x16x32_bf16 v[112:115], v[96:99], v[40:43], v[112:115]
    v_mfma_f32_16x16x32_bf16 v[116:119], v[96:99], v[44:47], v[116:119]
    v_mfma_f32_16x16x32_bf16 v[120:123], v[100:103], v[40:43], v[120:123]
    v_mfma_f32_16x16x32_bf16 v[124:127], v[100:103], v[44:47], v[124:127]
    ds_read_b128 v[92:95], v12 offset:320
    ds_read_b128 v[96:99], v12 offset:8768
    ds_read_b128 v[100:103], v12 offset:17216
    s_waitcnt vmcnt(6) lgkmcnt(3)
    v_mfma_f32_16x16x32_bf16 v[104:107], v[80:83], v[48:51], v[104:107]
    v_mfma_f32_16x16x32_bf16 v[108:111], v[80:83], v[52:55], v[108:111]
    v_mfma_f32_16x16x32_bf16 v[112:115], v[84:87], v[48:51], v[112:115]
    v_mfma_f32_16x16x32_bf16 v[116:119], v[84:87], v[52:55], v[116:119]
    v_mfma_f32_16x16x32_bf16 v[120:123], v[88:91], v[48:51], v[120:123]
    v_mfma_f32_16x16x32_bf16 v[124:127], v[88:91], v[52:55], v[124:127]
    ds_read_b128 v[80:83], v12 offset:384
    ds_read_b128 v[84:87], v12 offset:8832
    ds_read_b128 v[88:91], v12 offset:17280
    s_waitcnt vmcnt(4) lgkmcnt(3)
    v_mfma_f32_16x16x32_bf16 v[104:107], v[92:95], v[56:59], v[104:107]
    v_mfma_f32_16x16x32_bf16 v[108:111], v[92:95], v[60:63], v[108:111]
    v_mfma_f32_16x16x32_bf16 v[112:115], v[96:99], v[56:59], v[112:115]
    v_mfma_f32_16x16x32_bf16 v[116:119], v[96:99], v[60:63], v[116:119]
    v_mfma_f32_16x16x32_bf16 v[120:123], v[100:103], v[56:59], v[120:123]
    v_mfma_f32_16x16x32_bf16 v[124:127], v[100:103], v[60:63], v[124:127]
    ds_read_b128 v[92:95], v12 offset:448
    ds_read_b128 v[96:99], v12 offset:8896
    ds_read_b128 v[100:103], v12 offset:17344
    s_waitcnt vmcnt(2) lgkmcnt(3)
    v_mfma_f32_16x16x32_bf16 v[104:107], v[80:83], v[64:67], v[104:107]
    v_mfma_f32_16x16x32_bf16 v[108:111], v[80:83], v[68:71], v[108:111]
    v_mfma_f32_16x16x32_bf16 v[112:115], v[84:87], v[64:67], v[112:115]
    v_mfma_f32_16x16x32_bf16 v[116:119], v[84:87], v[68:71], v[116:119]
    v_mfma_f32_16x16x32_bf16 v[120:123], v[88:91], v[64:67], v[120:123]
    v_mfma_f32_16x16x32_bf16 v[124:127], v[88:91], v[68:71], v[124:127]
    s_waitcnt vmcnt(0) lgkmcnt(0)
    v_mfma_f32_16x16x32_bf16 v[104:107], v[92:95], v[72:75], v[104:107]
    v_mfma_f32_16x16x32_bf16 v[108:111], v[92:95], v[76:79], v[108:111]
    v_mfma_f32_16x16x32_bf16 v[112:115], v[96:99], v[72:75], v[112:115]
    v_mfma_f32_16x16x32_bf16 v[116:119], v[96:99], v[76:79], v[116:119]
    v_mfma_f32_16x16x32_bf16 v[120:123], v[100:103], v[72:75], v[120:123]
    v_mfma_f32_16x16x32_bf16 v[124:127], v[100:103], v[76:79], v[124:127]
    s_setprio 2
    s_add_u32 s100, s100, 118784
    buffer_load_dwordx4 v[16:19], v14, s[16:19], s100 offen offset:0 sc1
    buffer_load_dwordx4 v[20:23], v14, s[16:19], s100 offen offset:1024 sc1
    buffer_load_dwordx4 v[24:27], v14, s[16:19], s100 offen offset:2048 sc1
    buffer_load_dwordx4 v[28:31], v14, s[16:19], s100 offen offset:3072 sc1
    s_add_u32 s100, s100, 4096
    buffer_load_dwordx4 v[32:35], v14, s[16:19], s100 offen offset:0 sc1
    buffer_load_dwordx4 v[36:39], v14, s[16:19], s100 offen offset:1024 sc1
    buffer_load_dwordx4 v[40:43], v14, s[16:19], s100 offen offset:2048 sc1
    buffer_load_dwordx4 v[44:47], v14, s[16:19], s100 offen offset:3072 sc1
    s_add_u32 s100, s100, 4096
    buffer_load_dwordx4 v[48:51], v14, s[16:19], s100 offen offset:0 sc1
    buffer_load_dwordx4 v[52:55], v14, s[16:19], s100 offen offset:1024 sc1
    buffer_load_dwordx4 v[56:59], v14, s[16:19], s100 offen offset:2048 sc1
    buffer_load_dwordx4 v[60:63], v14, s[16:19], s100 offen offset:3072 sc1
    s_add_u32 s100, s100, 4096
    buffer_load_dwordx4 v[64:67], v14, s[16:19], s100 offen offset:0 sc1
    buffer_load_dwordx4 v[68:71], v14, s[16:19], s100 offen offset:1024 sc1
    buffer_load_dwordx4 v[72:75], v14, s[16:19], s100 offen offset:2048 sc1
    buffer_load_dwordx4 v[76:79], v14, s[16:19], s100 offen offset:3072 sc1
    s_setprio 0
    v_add_u32 v12, 130944, v1
    s_mov_b32 s59, 0
Lw_17:
    ds_read_b32 v4, v3 offset:36
    s_waitcnt lgkmcnt(0)
    v_cmp_gt_u32 vcc, 16, v4
    s_cbranch_vccz Lk_18
    s_sleep 1
    s_add_u32 s59, s59, 1
    s_cmp_lt_u32 s59, 16777216
    s_cbranch_scc1 Lw_17
    s_branch L_end
Lk_18:
    ds_read_b128 v[80:83], v12 offset:0
    ds_read_b128 v[84:87], v12 offset:64
    ds_read_b128 v[88:91], v12 offset:128
    ds_read_b128 v[92:95], v12 offset:192
    ds_read_b128 v[96:99], v12 offset:256
    ds_read_b128 v[100:103], v12 offset:320
    s_waitcnt vmcnt(14) lgkmcnt(5)
    v_mfma_f32_16x16x32_bf16 v[104:107], v[80:83], v[16:19], v[104:107]
    v_mfma_f32_16x16x32_bf16 v[108:111], v[80:83], v[20:23], v[108:111]
    ds_read_b128 v[80:83], v12 offset:384
    s_waitcnt vmcnt(12) lgkmcnt(5)
    v_mfma_f32_16x16x32_bf16 v[104:107], v[84:87], v[24:27], v[104:107]
    v_mfma_f32_16x16x32_bf16 v[108:111], v[84:87], v[28:31], v[108:111]
    ds_read_b128 v[84:87], v12 offset:448
    s_waitcnt vmcnt(10) lgkmcnt(5)
    v_mfma_f32_16x16x32_bf16 v[104:107], v[88:91], v[32:35], v[104:107]
    v_mfma_f32_16x16x32_bf16 v[108:111], v[88:91], v[36:39], v[108:111]
    s_waitcnt vmcnt(8) lgkmcnt(4)
    v_mfma_f32_16x16x32_bf16 v[104:107], v[92:95], v[40:43], v[104:107]
    v_mfma_f32_16x16x32_bf16 v[108:111], v[92:95], v[44:47], v[108:111]
    s_waitcnt vmcnt(6) lgkmcnt(3)
    v_mfma_f32_16x16x32_bf16 v[104:107], v[96:99], v[48:51], v[104:107]
    v_mfma_f32_16x16x32_bf16 v[108:111], v[96:99], v[52:55], v[108:111]
    s_waitcnt vmcnt(4) lgkmcnt(2)
    v_mfma_f32_16x16x32_bf16 v[104:107], v[100:103], v[56:59], v[104:107]
    v_mfma_f32_16x16x32_bf16 v[108:111], v[100:103], v[60:63], v[108:111]
    s_waitcnt vmcnt(2) lgkmcnt(1)
    v_mfma_f32_16x16x32_bf16 v[104:107], v[80:83], v[64:67], v[104:107]
    v_mfma_f32_16x16x32_bf16 v[108:111], v[80:83], v[68:71], v[108:111]
    s_waitcnt vmcnt(0) lgkmcnt(0)
    v_mfma_f32_16x16x32_bf16 v[104:107], v[84:87], v[72:75], v[104:107]
    v_mfma_f32_16x16x32_bf16 v[108:111], v[84:87], v[76:79], v[108:111]
    s_nop 7
    v_cvt_pk_bf16_f32 v104, v104, v108
    buffer_store_dword v104, v8, s[20:23], s60 offen offset:0
    v_cvt_pk_bf16_f32 v105, v105, v109
    buffer_store_dword v105, v8, s[20:23], s60 offen offset:512
    v_cvt_pk_bf16_f32 v106, v106, v110
    buffer_store_dword v106, v8, s[20:23], s60 offen offset:1024
    v_cvt_pk_bf16_f32 v107, v107, v111
    buffer_store_dword v107, v8, s[20:23], s60 offen offset:1536
    s_add_u32 s60, s60, 8192
    s_mov_b32 s59, 0
Lw_19:
    ds_read_b32 v4, v3 offset:40
    s_waitcnt lgkmcnt(0)
    v_cmp_gt_u32 vcc, 16, v4
    s_cbranch_vccz Lk_20
    s_sleep 1
    s_add_u32 s59, s59, 1
    s_cmp_lt_u32 s59, 16777216
    s_cbranch_scc1 Lw_19
    s_branch L_end
Lk_20:
    ds_read_b128 v[80:83], v12 offset:8448
    ds_read_b128 v[84:87], v12 offset:8512
    ds_read_b128 v[88:91], v12 offset:8576
    ds_read_b128 v[92:95], v12 offset:8640
    ds_read_b128 v[96:99], v12 offset:8704
    ds_read_b128 v[100:103], v12 offset:8768
    s_waitcnt lgkmcnt(5)
    v_mfma_f32_16x16x32_bf16 v[112:115], v[80:83], v[16:19], v[112:115]
    v_mfma_f32_16x16x32_bf16 v[116:119], v[80:83], v[20:23], v[116:119]
    ds_read_b128 v[80:83], v12 offset:8832
    s_waitcnt lgkmcnt(5)
    v_mfma_f32_16x16x32_bf16 v[112:115], v[84:87], v[24:27], v[112:115]
    v_mfma_f32_16x16x32_bf16 v[116:119], v[84:87], v[28:31], v[116:119]
    ds_read_b128 v[84:87], v12 offset:8896
    s_waitcnt lgkmcnt(5)
    v_mfma_f32_16x16x32_bf16 v[112:115], v[88:91], v[32:35], v[112:115]
    v_mfma_f32_16x16x32_bf16 v[116:119], v[88:91], v[36:39], v[116:119]
    s_waitcnt lgkmcnt(4)
    v_mfma_f32_16x16x32_bf16 v[112:115], v[92:95], v[40:43], v[112:115]
    v_mfma_f32_16x16x32_bf16 v[116:119], v[92:95], v[44:47], v[116:119]
    s_waitcnt lgkmcnt(3)
    v_mfma_f32_16x16x32_bf16 v[112:115], v[96:99], v[48:51], v[112:115]
    v_mfma_f32_16x16x32_bf16 v[116:119], v[96:99], v[52:55], v[116:119]
    s_waitcnt lgkmcnt(2)
    v_mfma_f32_16x16x32_bf16 v[112:115], v[100:103], v[56:59], v[112:115]
    v_mfma_f32_16x16x32_bf16 v[116:119], v[100:103], v[60:63], v[116:119]
    s_waitcnt lgkmcnt(1)
    v_mfma_f32_16x16x32_bf16 v[112:115], v[80:83], v[64:67], v[112:115]
    v_mfma_f32_16x16x32_bf16 v[116:119], v[80:83], v[68:71], v[116:119]
    s_waitcnt lgkmcnt(0)
    v_mfma_f32_16x16x32_bf16 v[112:115], v[84:87], v[72:75], v[112:115]
    v_mfma_f32_16x16x32_bf16 v[116:119], v[84:87], v[76:79], v[116:119]
    s_nop 7
    v_cvt_pk_bf16_f32 v112, v112, v116
    buffer_store_dword v112, v8, s[20:23], s60 offen offset:0
    v_cvt_pk_bf16_f32 v113, v113, v117
    buffer_store_dword v113, v8, s[20:23], s60 offen offset:512
    v_cvt_pk_bf16_f32 v114, v114, v118
    buffer_store_dword v114, v8, s[20:23], s60 offen offset:1024
    v_cvt_pk_bf16_f32 v115, v115, v119
    buffer_store_dword v115, v8, s[20:23], s60 offen offset:1536
    s_add_u32 s60, s60, 8192
    s_mov_b32 s59, 0
Lw_21:
    ds_read_b32 v4, v3 offset:44
    s_waitcnt lgkmcnt(0)
    v_cmp_gt_u32 vcc, 8, v4
    s_cbranch_vccz Lk_22
    s_add_u32 s59, s59, 1
    s_cmp_lt_u32 s59, 16777216
    s_cbranch_scc1 Lw_21
    s_branch L_end
Lk_22:
    ds_read_b128 v[80:83], v12 offset:16896
    ds_read_b128 v[84:87], v12 offset:16960
    ds_read_b128 v[88:91], v12 offset:17024
    ds_read_b128 v[92:95], v12 offset:17088
    ds_read_b128 v[96:99], v12 offset:17152
    ds_read_b128 v[100:103], v12 offset:17216
    s_waitcnt lgkmcnt(5)
    v_mfma_f32_16x16x32_bf16 v[120:123], v[80:83], v[16:19], v[120:123]
    v_mfma_f32_16x16x32_bf16 v[124:127], v[80:83], v[20:23], v[124:127]
    ds_read_b128 v[80:83], v12 offset:17280
    s_waitcnt lgkmcnt(5)
    v_mfma_f32_16x16x32_bf16 v[120:123], v[84:87], v[24:27], v[120:123]
    v_mfma_f32_16x16x32_bf16 v[124:127], v[84:87], v[28:31], v[124:127]
    ds_read_b128 v[84:87], v12 offset:17344
    s_waitcnt lgkmcnt(5)
    v_mfma_f32_16x16x32_bf16 v[120:123], v[88:91], v[32:35], v[120:123]
    v_mfma_f32_16x16x32_bf16 v[124:127], v[88:91], v[36:39], v[124:127]
    s_waitcnt lgkmcnt(4)
    v_mfma_f32_16x16x32_bf16 v[120:123], v[92:95], v[40:43], v[120:123]
    v_mfma_f32_16x16x32_bf16 v[124:127], v[92:95], v[44:47], v[124:127]
    s_waitcnt lgkmcnt(3)
    v_mfma_f32_16x16x32_bf16 v[120:123], v[96:99], v[48:51], v[120:123]
    v_mfma_f32_16x16x32_bf16 v[124:127], v[96:99], v[52:55], v[124:127]
    s_waitcnt lgkmcnt(2)
    v_mfma_f32_16x16x32_bf16 v[120:123], v[100:103], v[56:59], v[120:123]
    v_mfma_f32_16x16x32_bf16 v[124:127], v[100:103], v[60:63], v[124:127]
    s_waitcnt lgkmcnt(1)
    v_mfma_f32_16x16x32_bf16 v[120:123], v[80:83], v[64:67], v[120:123]
    v_mfma_f32_16x16x32_bf16 v[124:127], v[80:83], v[68:71], v[124:127]
    s_waitcnt lgkmcnt(0)
    v_mfma_f32_16x16x32_bf16 v[120:123], v[84:87], v[72:75], v[120:123]
    v_mfma_f32_16x16x32_bf16 v[124:127], v[84:87], v[76:79], v[124:127]
    s_nop 7
    v_cvt_pk_bf16_f32 v120, v120, v124
    buffer_store_dword v120, v9, s[20:23], s60 offen offset:0
    v_cvt_pk_bf16_f32 v121, v121, v125
    buffer_store_dword v121, v9, s[20:23], s60 offen offset:512
    v_cvt_pk_bf16_f32 v122, v122, v126
    buffer_store_dword v122, v9, s[20:23], s60 offen offset:1024
    v_cvt_pk_bf16_f32 v123, v123, v127
    buffer_store_dword v123, v9, s[20:23], s60 offen offset:1536
    s_branch L_end
L_preB:
    s_setprio 3
    v_and_b32 v4, 3, v0
    v_mov_b32 v5, 0x0c0c0c0c
    v_mov_b32 v6, 0x0c0c0302
    v_mov_b32 v7, 0x03020c0c
    v_cmp_eq_u32 s[58:59], 0, v4
    v_cmp_eq_u32 s[60:61], 2, v4
    v_cmp_eq_u32 vcc, 1, v4
    v_cndmask_b32 v10, v5, v6, s[58:59]
    v_cndmask_b32 v11, v5, v6, s[60:61]
    v_cndmask_b32 v10, v10, v7, vcc
    v_cmp_eq_u32 vcc, 3, v4
    s_nop 1
    v_cndmask_b32 v11, v11, v7, vcc
    s_lshl_b32 s58, s4, 5
    v_lshrrev_b32 v5, 1, v0
    v_add_u32 v5, s58, v5
    v_cmp_gt_u32 vcc, 250, v5
    v_and_b32 v57, 1, v0
    s_mov_b64 s[64:65], vcc
    v_lshlrev_b32 v55, 10, v5
    v_mul_u32_u24 v49, 2560, v5
    v_lshl_add_u32 v49, v57, 4, v49
    v_lshlrev_b32 v57, 2, v57
    v_lshrrev_b32 v5, 3, v0
    v_and_b32 v6, 7, v0
    v_cmp_gt_u32 s[62:63], 5, v6
    v_lshl_add_u32 v50, v6, 3, v5
    v_mul_u32_u24 v56, 640, v5
    v_add_u32 v56, 152704, v56
    v_lshrrev_b32 v5, 4, v50
    v_mul_u32_u24 v9, 8448, v5
    v_lshl_add_u32 v9, v5, 26, v9
    v_cmp_le_u32 vcc, 32, v50
    v_and_b32 v5, 7, v50
    v_and_b32 v6, 3, v50
    v_cndmask_b32 v5, v5, v6, vcc
    v_mul_u32_u24 v5, 1056, v5
    v_bfe_u32 v6, v50, 3, 1
    v_bfe_u32 v7, v50, 2, 1
    v_cndmask_b32 v6, v6, v7, vcc
    v_lshl_add_u32 v5, v6, 9, v5
    v_mov_b32 v53, 130944
    v_add3_u32 v9, v9, v5, v53
    v_lshrrev_b32 v5, 5, v0
    v_lshl_add_u32 v15, v5, 3, v2
    v_mov_b32 v52, 4
    s_lshl_b32 s58, s5, 2
    s_sub_u32 s58, 157184, s58
    v_mov_b32 v54, s58
    v_add_u32 v5, s5, v50
    v_lshl_add_u32 v8, v5, 1, v53
    v_lshlrev_b32 v50, 2, v50
    v_add_u32 v50, 157184, v50
    s_lshl_b32 s60, s6, 2
    s_mov_b32 s61, 262144
    v_mov_b64 v[58:59], 0
    v_mov_b64 v[16:17], 0
    v_mov_b64 v[18:19], 0
    v_mov_b64 v[20:21], 0
    v_mov_b64 v[22:23], 0
    s_mov_b32 s59, 0
Lw_23:
    ds_read_b32 v4, v3 offset:32
    s_waitcnt lgkmcnt(0)
    v_cmp_gt_u32 vcc, 1, v4
    s_cbranch_vccz Lk_24
    s_sleep 1
    s_add_u32 s59, s59, 1
    s_cmp_lt_u32 s59, 4194304
    s_cbranch_scc1 Lw_23
    s_branch L_end
Lk_24:
    v_readfirstlane_b32 s40, v4
    s_sleep 30
    s_mov_b32 s59, 0
    s_mov_b64 exec, s[64:65]
    s_bitset0_b32 s40, 0
L_spoll:
    buffer_load_dwordx2 v[58:59], v55, s[16:19], s60 offen sc1
    s_add_u32 s59, s59, 1
    s_cmp_gt_u32 s59, 0x40000
    s_cbranch_scc1 L_end
    s_waitcnt vmcnt(0)
    v_xor_b32 v58, s40, v58
    v_xor_b32 v59, s40, v59
    v_or_b32 v5, v58, v59
    v_cmpx_lt_u32 vcc, 0x3ff, v5
    s_cbranch_execz L_sok
    s_sleep 10
    s_branch L_spoll
L_sok:
    s_mov_b64 exec, -1
    v_lshl_add_u32 v49, v58, 2, v49
    v_sub_u32 v48, v59, v58
    v_sub_u32 v48, v48, v57
    v_cmpx_lt_i32 vcc, 0, v48
    s_cbranch_execz L_entld
    buffer_load_dwordx4 v[16:19], v49, s[16:19], s61 offen offset:0 sc1
    v_cmpx_lt_i32 vcc, 8, v48
    s_cbranch_execz L_entld
    buffer_load_dwordx4 v[20:23], v49, s[16:19], s61 offen offset:32 sc1
    v_cmpx_lt_i32 vcc, 16, v48
    s_cbranch_execz L_entld
    ds_write_b32 v3, v52 offset:28
L_entld:
    s_mov_b64 exec, 1
    v_mov_b32 v4, 1
    ds_add_u32 v3, v4 offset:52
    s_mov_b64 exec, -1
    s_waitcnt vmcnt(0)
    v_cmpx_lt_i32 vcc, 0, v48
    v_mad_u32_u16 v24, v16, 4, v54 op_sel:[1,0,0,0]
    ds_add_rtn_u32 v32, v24, v52
    v_cmpx_lt_i32 vcc, 1, v48
    v_mad_u32_u16 v25, v17, 4, v54 op_sel:[1,0,0,0]
    ds_add_rtn_u32 v33, v25, v52
    v_cmpx_lt_i32 vcc, 2, v48
    v_mad_u32_u16 v26, v18, 4, v54 op_sel:[1,0,0,0]
    ds_add_rtn_u32 v34, v26, v52
    v_cmpx_lt_i32 vcc, 3, v48
    v_mad_u32_u16 v27, v19, 4, v54 op_sel:[1,0,0,0]
    ds_add_rtn_u32 v35, v27, v52
    v_cmpx_lt_i32 vcc, 8, v48
    s_cbranch_execz L_l1
    s_waitcnt lgkmcnt(2)
    v_mad_u32_u16 v28, v20, 4, v54 op_sel:[1,0,0,0]
    ds_add_rtn_u32 v36, v28, v52
    v_cmpx_lt_i32 vcc, 9, v48
    s_cbranch_execz L_l1
    v_mad_u32_u16 v29, v21, 4, v54 op_sel:[1,0,0,0]
    ds_add_rtn_u32 v37, v29, v52
    v_cmpx_lt_i32 vcc, 10, v48
    s_cbranch_execz L_l1
    v_mad_u32_u16 v30, v22, 4, v54 op_sel:[1,0,0,0]
    ds_add_rtn_u32 v38, v30, v52
    v_cmpx_lt_i32 vcc, 11, v48
    s_cbranch_execz L_l1
    v_mad_u32_u16 v31, v23, 4, v54 op_sel:[1,0,0,0]
    ds_add_rtn_u32 v39, v31, v52
L_l1:
    s_mov_b64 exec, -1
    s_mov_b64 exec, 1
    v_mov_b32 v4, 1
    ds_add_u32 v3, v4 offset:12
    s_mov_b64 exec, -1
    v_mad_u32_u16 v40, v16, 2, v53
    v_mad_u32_u16 v41, v17, 2, v53
    v_mad_u32_u16 v42, v18, 2, v53
    v_mad_u32_u16 v43, v19, 2, v53
    v_mad_u32_u16 v44, v20, 2, v53
    v_mad_u32_u16 v45, v21, 2, v53
    v_mad_u32_u16 v46, v22, 2, v53
    v_mad_u32_u16 v47, v23, 2, v53
    s_mov_b32 s59, 0
Lw_25:
    ds_read_b32 v4, v3 offset:12
    s_waitcnt lgkmcnt(0)
    v_cmp_gt_u32 vcc, 8, v4
    s_cbranch_vccz Lk_26
    s_add_u32 s59, s59, 1
    s_cmp_lt_u32 s59, 4194304
    s_cbranch_scc1 Lw_25
    s_branch L_end
Lk_26:
    ds_read_b32 v12, v50
    ds_read_b32 v5, v3 offset:28
    ds_read_u16 v8, v8
    ds_read_u16 v40, v40
    ds_read_u16 v41, v41
    ds_read_u16 v42, v42
    ds_read_u16 v43, v43
    ds_read_u16 v44, v44
    ds_read_u16 v45, v45
    ds_read_u16 v46, v46
    ds_read_u16 v47, v47
    s_lshl_b32 s58, s2, 4
    s_add_u32 s58, s58, s3
    s_cmp_eq_u32 s58, 15
    s_cbranch_scc0 L_noep
    v_mov_b32 v6, s40
    v_mov_b32 v7, 1572864
    s_mov_b64 exec, 1
    buffer_store_dword v6, v7, s[16:19], 0 offen sc1
    s_mov_b64 exec, -1
L_noep:
    s_waitcnt lgkmcnt(10)
    v_add_u32 v12, 4, v12
    v_lshrrev_b32 v12, 3, v12
    v_max_u32 v12, 1, v12
    v_cndmask_b32 v12, 0, v12, s[62:63]
    s_lshl_b32 s67, s4, 3
    s_nop 0
    v_add_u32_dpp v51, v12, v12 row_shl:1 row_mask:0xf bank_mask:0xf bound_ctrl:1
    s_nop 1
    v_add_u32_dpp v51, v51, v51 row_shl:2 row_mask:0xf bank_mask:0xf bound_ctrl:1
    s_nop 1
    v_add_u32_dpp v51, v12, v51 row_shl:4 row_mask:0xf bank_mask:0x5 bound_ctrl:1
    s_waitcnt lgkmcnt(0)
    v_lshlrev_b32 v8, 16, v8
    v_lshl_add_u32 v5, v5, 10, v51
    v_lshlrev_b32 v7, 3, v51
    v_cmp_le_u32 vcc, 80, v5
    v_sub_u32 v6, v56, v7
    v_subrev_u32 v12, 1, v12
    s_cbranch_vccnz L_slow
    s_mov_b64 exec, s[62:63]
    ds_write_b32 v50, v6 offset:256
    s_mov_b64 exec, -1
    s_sub_u32 s63, s67, 1
    v_readlane_b32 s67, v51, s67
    v_cmpx_lt_i32 vcc, 0, v48
    ds_read_b32 v24, v24 offset:256
    v_cmpx_lt_i32 vcc, 1, v48
    ds_read_b32 v25, v25 offset:256
    v_cmpx_lt_i32 vcc, 2, v48
    ds_read_b32 v26, v26 offset:256
    v_cmpx_lt_i32 vcc, 3, v48
    ds_read_b32 v27, v27 offset:256
    v_cmpx_lt_i32 vcc, 8, v48
    s_cbranch_execz L_l2
    s_waitcnt lgkmcnt(2)
    ds_read_b32 v28, v28 offset:256
    v_cmpx_lt_i32 vcc, 9, v48
    s_cbranch_execz L_l2
    ds_read_b32 v29, v29 offset:256
    v_cmpx_lt_i32 vcc, 10, v48
    s_cbranch_execz L_l2
    ds_read_b32 v30, v30 offset:256
    v_cmpx_lt_i32 vcc, 11, v48
    s_cbranch_execz L_l2
    ds_read_b32 v31, v31 offset:256
L_l2:
    s_mov_b64 exec, -1
    s_lshr_b32 s66, s67, 3
    s_add_u32 s60, s66, 1
    s_mul_i32 s60, s60, 8
    s_sub_u32 s67, s60, s67
    s_sub_u32 s62, s67, 1
    s_add_u32 s61, s4, 1
    s_mul_i32 s61, s61, 80
    s_sub_u32 s60, s61, s60
    s_lshl_b32 s60, s60, 3
    s_add_u32 s60, s60, 152064
    s_waitcnt lgkmcnt(0)
    v_cmpx_lt_i32 vcc, 0, v48
    v_perm_b32 v40, v40, v16, s70
    v_add_u32 v24, v24, v32
    ds_write_b32 v24, v40
    v_cmpx_lt_i32 vcc, 1, v48
    v_perm_b32 v41, v41, v17, s70
    v_add_u32 v25, v25, v33
    ds_write_b32 v25, v41
    v_cmpx_lt_i32 vcc, 2, v48
    v_perm_b32 v42, v42, v18, s70
    v_add_u32 v26, v26, v34
    ds_write_b32 v26, v42
    v_cmpx_lt_i32 vcc, 3, v48
    v_perm_b32 v43, v43, v19, s70
    v_add_u32 v27, v27, v35
    ds_write_b32 v27, v43
    v_cmpx_lt_i32 vcc, 8, v48
    s_cbranch_execz L_l3
    s_waitcnt lgkmcnt(2)
    v_perm_b32 v44, v44, v20, s70
    v_add_u32 v28, v28, v36
    ds_write_b32 v28, v44
    v_cmpx_lt_i32 vcc, 9, v48
    s_cbranch_execz L_l3
    v_perm_b32 v45, v45, v21, s70
    v_add_u32 v29, v29, v37
    ds_write_b32 v29, v45
    v_cmpx_lt_i32 vcc, 10, v48
    s_cbranch_execz L_l3
    v_perm_b32 v46, v46, v22, s70
    v_add_u32 v30, v30, v38
    ds_write_b32 v30, v46
    v_cmpx_lt_i32 vcc, 11, v48
    s_cbranch_execz L_l3
    v_perm_b32 v47, v47, v23, s70
    v_add_u32 v31, v31, v39
    ds_write_b32 v31, v47
L_l3:
    s_mov_b64 exec, -1
    s_mov_b64 exec, 1
    v_mov_b32 v4, 1
    ds_add_u32 v3, v4 offset:16
    s_mov_b64 exec, -1
    v_lshrrev_b32 v5, 5, v0
    v_lshl_add_u32 v13, v5, 2, s60
    v_bfe_u32 v5, v0, 2, 3
    v_lshl_add_u32 v14, v5, 3, v13
    s_mov_b32 s64, 201487936
    s_mov_b32 s65, 0
    s_mov_b32 s59, 0
Lw_27:
    ds_read_b32 v4, v3 offset:16
    s_waitcnt lgkmcnt(0)
    v_cmp_gt_u32 vcc, 8, v4
    s_cbranch_vccz Lk_28
    s_add_u32 s59, s59, 1
    s_cmp_lt_u32 s59, 4194304
    s_cbranch_scc1 Lw_27
    s_branch L_end
Lk_28:
    s_setprio 1
    s_cmp_ge_u32 s67, 8
    s_cbranch_scc1 Lpg_29
    ds_read2_b32 v[112:113], v13 offset0:0 offset1:2
    ds_read2_b32 v[114:115], v13 offset0:4 offset1:6
    ds_read2_b32 v[116:117], v13 offset0:8 offset1:10
    ds_read2_b32 v[118:119], v13 offset0:12 offset1:14
    s_waitcnt lgkmcnt(0)
    s_cmp_gt_u32 s67, 0
    s_cbranch_scc1 Lps_30
    v_mad_u32_u16 v4, v112, s7, v2
    buffer_load_dwordx4 v[16:19], v4, s[8:11], 0 offen
Lps_30:
    s_cmp_gt_u32 s67, 1
    s_cbranch_scc1 Lps_31
    v_mad_u32_u16 v4, v113, s7, v2
    buffer_load_dwordx4 v[20:23], v4, s[8:11], 0 offen
Lps_31:
    s_cmp_gt_u32 s67, 2
    s_cbranch_scc1 Lps_32
    v_mad_u32_u16 v4, v114, s7, v2
    buffer_load_dwordx4 v[24:27], v4, s[8:11], 0 offen
Lps_32:
    s_cmp_gt_u32 s67, 3
    s_cbranch_scc1 Lps_33
    v_mad_u32_u16 v4, v115, s7, v2
    buffer_load_dwordx4 v[28:31], v4, s[8:11], 0 offen
Lps_33:
    s_cmp_gt_u32 s67, 4
    s_cbranch_scc1 Lps_34
    v_mad_u32_u16 v4, v116, s7, v2
    buffer_load_dwordx4 v[32:35], v4, s[8:11], 0 offen
Lps_34:
    s_cmp_gt_u32 s67, 5
    s_cbranch_scc1 Lps_35
    v_mad_u32_u16 v4, v117, s7, v2
    buffer_load_dwordx4 v[36:39], v4, s[8:11], 0 offen
Lps_35:
    s_cmp_gt_u32 s67, 6
    s_cbranch_scc1 Lps_36
    v_mad_u32_u16 v4, v118, s7, v2
    buffer_load_dwordx4 v[40:43], v4, s[8:11], 0 offen
Lps_36:
    v_mad_u32_u16 v4, v119, s7, v2
    buffer_load_dwordx4 v[44:47], v4, s[8:11], 0 offen
Lpg_29:
    ds_read_b32 v5, v14
    ds_read2_b32 v[112:113], v13 offset0:16 offset1:18
    ds_read2_b32 v[114:115], v13 offset0:20 offset1:22
    ds_read2_b32 v[116:117], v13 offset0:24 offset1:26
    ds_read2_b32 v[118:119], v13 offset0:28 offset1:30
    s_cmp_eq_u32 s66, 0
    s_cbranch_scc1 L_drain
L_gl:
    s_waitcnt lgkmcnt(3)
    v_perm_b32 v6, v5, v5, v10
    v_perm_b32 v7, v5, v5, v11
    ds_read_b32 v5, v14 offset:64
    s_waitcnt vmcnt(7)
    v_mfma_f32_4x4x4_16b_bf16 v[120:123], v[6:7], v[16:17], v[120:123] cbsz:3 abid:0
    v_mfma_f32_4x4x4_16b_bf16 v[124:127], v[6:7], v[18:19], v[124:127] cbsz:3 abid:0
    s_sub_u32 s62, s62, 1
    s_cbranch_scc1 Lfs_0
Lbs_0:
    v_mad_u32_u16 v4, v112, s7, v2
    buffer_load_dwordx4 v[16:19], v4, s[8:11], 0 offen
    s_waitcnt vmcnt(7)
    v_mfma_f32_4x4x4_16b_bf16 v[120:123], v[6:7], v[20:21], v[120:123] cbsz:3 abid:1
    v_mfma_f32_4x4x4_16b_bf16 v[124:127], v[6:7], v[22:23], v[124:127] cbsz:3 abid:1
    s_sub_u32 s62, s62, 1
    s_cbranch_scc1 Lfs_1
Lbs_1:
    v_mad_u32_u16 v4, v113, s7, v2
    buffer_load_dwordx4 v[20:23], v4, s[8:11], 0 offen
    ds_read2_b32 v[112:113], v13 offset0:32 offset1:34
    s_waitcnt vmcnt(7) lgkmcnt(3)
    v_mfma_f32_4x4x4_16b_bf16 v[120:123], v[6:7], v[24:25], v[120:123] cbsz:3 abid:2
    v_mfma_f32_4x4x4_16b_bf16 v[124:127], v[6:7], v[26:27], v[124:127] cbsz:3 abid:2
    s_sub_u32 s62, s62, 1
    s_cbranch_scc1 Lfs_2
Lbs_2:
    v_mad_u32_u16 v4, v114, s7, v2
    buffer_load_dwordx4 v[24:27], v4, s[8:11], 0 offen
    s_waitcnt vmcnt(7)
    v_mfma_f32_4x4x4_16b_bf16 v[120:123], v[6:7], v[28:29], v[120:123] cbsz:3 abid:3
    v_mfma_f32_4x4x4_16b_bf16 v[124:127], v[6:7], v[30:31], v[124:127] cbsz:3 abid:3
    s_sub_u32 s62, s62, 1
    s_cbranch_scc1 Lfs_3
Lbs_3:
    v_mad_u32_u16 v4, v115, s7, v2
    buffer_load_dwordx4 v[28:31], v4, s[8:11], 0 offen
    ds_read2_b32 v[114:115], v13 offset0:36 offset1:38
    s_waitcnt vmcnt(7) lgkmcnt(3)
    v_mfma_f32_4x4x4_16b_bf16 v[120:123], v[6:7], v[32:33], v[120:123] cbsz:3 abid:4
    v_mfma_f32_4x4x4_16b_bf16 v[124:127], v[6:7], v[34:35], v[124:127] cbsz:3 abid:4
    s_sub_u32 s62, s62, 1
    s_cbranch_scc1 Lfs_4
Lbs_4:
    v_mad_u32_u16 v4, v116, s7, v2
    buffer_load_dwordx4 v[32:35], v4, s[8:11], 0 offen
    s_waitcnt vmcnt(7)
    v_mfma_f32_4x4x4_16b_bf16 v[120:123], v[6:7], v[36:37], v[120:123] cbsz:3 abid:5
    v_mfma_f32_4x4x4_16b_bf16 v[124:127], v[6:7], v[38:39], v[124:127] cbsz:3 abid:5
    s_sub_u32 s62, s62, 1
    s_cbranch_scc1 Lfs_5
Lbs_5:
    v_mad_u32_u16 v4, v117, s7, v2
    buffer_load_dwordx4 v[36:39], v4, s[8:11], 0 offen
    ds_read2_b32 v[116:117], v13 offset0:40 offset1:42
    s_waitcnt vmcnt(7) lgkmcnt(3)
    v_mfma_f32_4x4x4_16b_bf16 v[120:123], v[6:7], v[40:41], v[120:123] cbsz:3 abid:6
    v_mfma_f32_4x4x4_16b_bf16 v[124:127], v[6:7], v[42:43], v[124:127] cbsz:3 abid:6
    s_sub_u32 s62, s62, 1
    s_cbranch_scc1 Lfs_6
Lbs_6:
    v_mad_u32_u16 v4, v118, s7, v2
    buffer_load_dwordx4 v[40:43], v4, s[8:11], 0 offen
    s_waitcnt vmcnt(7)
    v_mfma_f32_4x4x4_16b_bf16 v[120:123], v[6:7], v[44:45], v[120:123] cbsz:3 abid:7
    v_mfma_f32_4x4x4_16b_bf16 v[124:127], v[6:7], v[46:47], v[124:127] cbsz:3 abid:7
    s_sub_u32 s62, s62, 1
    s_cbranch_scc1 Lfs_7
Lbs_7:
    v_mad_u32_u16 v4, v119, s7, v2
    buffer_load_dwordx4 v[44:47], v4, s[8:11], 0 offen
    ds_read2_b32 v[118:119], v13 offset0:44 offset1:46
    v_add_u32 v13, 64, v13
    v_add_u32 v14, 64, v14
    s_sub_u32 s66, s66, 1
    s_cmp_lg_u32 s66, 0
    s_cbranch_scc1 L_gl
L_drain:
    s_waitcnt lgkmcnt(0)
    v_perm_b32 v6, v5, v5, v10
    v_perm_b32 v7, v5, v5, v11
    ds_read_b32 v5, v14 offset:64
    s_waitcnt vmcnt(7)
    v_mfma_f32_4x4x4_16b_bf16 v[120:123], v[6:7], v[16:17], v[120:123] cbsz:3 abid:0
    v_mfma_f32_4x4x4_16b_bf16 v[124:127], v[6:7], v[18:19], v[124:127] cbsz:3 abid:0
    s_sub_u32 s62, s62, 1
    s_cbranch_scc1 Lfd_0
Lbd_0:
    s_waitcnt vmcnt(6)
    v_mfma_f32_4x4x4_16b_bf16 v[120:123], v[6:7], v[20:21], v[120:123] cbsz:3 abid:1
    v_mfma_f32_4x4x4_16b_bf16 v[124:127], v[6:7], v[22:23], v[124:127] cbsz:3 abid:1
    s_sub_u32 s62, s62, 1
    s_cbranch_scc1 Lfd_1
Lbd_1:
    s_waitcnt vmcnt(5)
    v_mfma_f32_4x4x4_16b_bf16 v[120:123], v[6:7], v[24:25], v[120:123] cbsz:3 abid:2
    v_mfma_f32_4x4x4_16b_bf16 v[124:127], v[6:7], v[26:27], v[124:127] cbsz:3 abid:2
    s_sub_u32 s62, s62, 1
    s_cbranch_scc1 Lfd_2
Lbd_2:
    s_waitcnt vmcnt(4)
    v_mfma_f32_4x4x4_16b_bf16 v[120:123], v[6:7], v[28:29], v[120:123] cbsz:3 abid:3
    v_mfma_f32_4x4x4_16b_bf16 v[124:127], v[6:7], v[30:31], v[124:127] cbsz:3 abid:3
    s_sub_u32 s62, s62, 1
    s_cbranch_scc1 Lfd_3
Lbd_3:
    s_waitcnt vmcnt(3)
    v_mfma_f32_4x4x4_16b_bf16 v[120:123], v[6:7], v[32:33], v[120:123] cbsz:3 abid:4
    v_mfma_f32_4x4x4_16b_bf16 v[124:127], v[6:7], v[34:35], v[124:127] cbsz:3 abid:4
    s_sub_u32 s62, s62, 1
    s_cbranch_scc1 Lfd_4
Lbd_4:
    s_waitcnt vmcnt(2)
    v_mfma_f32_4x4x4_16b_bf16 v[120:123], v[6:7], v[36:37], v[120:123] cbsz:3 abid:5
    v_mfma_f32_4x4x4_16b_bf16 v[124:127], v[6:7], v[38:39], v[124:127] cbsz:3 abid:5
    s_sub_u32 s62, s62, 1
    s_cbranch_scc1 Lfd_5
Lbd_5:
    s_waitcnt vmcnt(1)
    v_mfma_f32_4x4x4_16b_bf16 v[120:123], v[6:7], v[40:41], v[120:123] cbsz:3 abid:6
    v_mfma_f32_4x4x4_16b_bf16 v[124:127], v[6:7], v[42:43], v[124:127] cbsz:3 abid:6
    s_sub_u32 s62, s62, 1
    s_cbranch_scc1 Lfd_6
Lbd_6:
    s_waitcnt vmcnt(0)
    v_mfma_f32_4x4x4_16b_bf16 v[120:123], v[6:7], v[44:45], v[120:123] cbsz:3 abid:7
    v_mfma_f32_4x4x4_16b_bf16 v[124:127], v[6:7], v[46:47], v[124:127] cbsz:3 abid:7
    s_sub_u32 s62, s62, 1
    s_cbranch_scc1 Lfd_7
Lbd_7:
L_gdone:
L_end:
L_exit:
    s_endpgm
Lfs_0:
    s_call_b64 s[68:69], L_flush
    s_branch Lbs_0
Lfs_1:
    s_call_b64 s[68:69], L_flush
    s_branch Lbs_1
Lfs_2:
    s_call_b64 s[68:69], L_flush
    s_branch Lbs_2
Lfs_3:
    s_call_b64 s[68:69], L_flush
    s_branch Lbs_3
Lfs_4:
    s_call_b64 s[68:69], L_flush
    s_branch Lbs_4
Lfs_5:
    s_call_b64 s[68:69], L_flush
    s_branch Lbs_5
Lfs_6:
    s_call_b64 s[68:69], L_flush
    s_branch Lbs_6
Lfs_7:
    s_call_b64 s[68:69], L_flush
    s_branch Lbs_7
Lfd_0:
    s_call_b64 s[68:69], L_flush
    s_branch Lbd_0
Lfd_1:
    s_call_b64 s[68:69], L_flush
    s_branch Lbd_1
Lfd_2:
    s_call_b64 s[68:69], L_flush
    s_branch Lbd_2
Lfd_3:
    s_call_b64 s[68:69], L_flush
    s_branch Lbd_3
Lfd_4:
    s_call_b64 s[68:69], L_flush
    s_branch Lbd_4
Lfd_5:
    s_call_b64 s[68:69], L_flush
    s_branch Lbd_5
Lfd_6:
    s_call_b64 s[68:69], L_flush
    s_branch Lbd_6
Lfd_7:
    s_call_b64 s[68:69], L_flush
    s_branch Lbd_7
L_flush:
    s_add_u32 s63, s63, 1
    s_lshr_b32 s101, s64, 24
    s_and_b32 s64, s64, 0xffffff
    v_permlane32_swap_b32 v120, v124
    v_permlane32_swap_b32 v121, v125
    v_permlane32_swap_b32 v122, v126
    v_permlane32_swap_b32 v123, v127
    v_add_u32 v4, s64, v15
    v_pk_add_f32 v[120:121], v[120:121], v[124:125]
    v_pk_add_f32 v[122:123], v[122:123], v[126:127]
    v_readlane_b32 s64, v9, s63
    v_mul_f32 v120, s65, v120
    v_mul_f32 v121, s65, v121
    v_mul_f32 v122, s65, v122
    v_mul_f32 v123, s65, v123
    v_add_u32 v126, s101, v3
    v_mov_b32 v127, 1
    v_cvt_pk_bf16_f32 v124, v120, v121
    v_cvt_pk_bf16_f32 v125, v122, v123
    ds_write_b64 v4, v[124:125]
    s_mov_b64 exec, 1
    ds_add_u32 v126, v127 offset:36
    s_mov_b64 exec, -1
    v_readlane_b32 s62, v12, s63
    v_readlane_b32 s65, v8, s63
    v_mov_b64 v[120:121], 0
    v_mov_b64 v[122:123], 0
    v_mov_b64 v[124:125], 0
    v_mov_b64 v[126:127], 0
    s_setpc_b64 s[68:69]
L_slow:
    s_setprio 0
    s_mov_b64 exec, 1
    v_mov_b32 v4, 1
    ds_add_u32 v3, v4 offset:16
    s_mov_b64 exec, -1
    s_mov_b32 s59, 0
Lw_37:
    ds_read_b32 v4, v3 offset:16
    s_waitcnt lgkmcnt(0)
    v_cmp_gt_u32 vcc, 8, v4
    s_cbranch_vccz Lk_38
    s_add_u32 s59, s59, 1
    s_cmp_lt_u32 s59, 4194304
    s_cbranch_scc1 Lw_37
    s_branch L_end
Lk_38:
    s_mov_b32 s24, s34
    s_mov_b32 s25, s35
    s_mov_b32 s26, 640000
    s_mov_b32 s27, 0x20000
    s_mov_b32 s28, s36
    s_mov_b32 s29, s37
    s_mov_b32 s30, 640000
    s_mov_b32 s31, 0x20000
    s_mov_b32 s12, s42
    s_mov_b32 s13, s43
    s_mov_b32 s14, 20000
    s_mov_b32 s15, 0x20000
    s_sub_u32 s63, s67, 1
    s_mov_b32 s64, 201487936
    s_mov_b32 s65, 0
    s_call_b64 s[68:69], L_flush
    s_add_u32 s66, s4, s5
    s_add_u32 s67, s66, 40
    v_lshlrev_b32 v16, 2, v0
    v_and_b32 v17, 32, v0
    v_lshl_add_u32 v17, v17, 22, v2
    v_mov_b32 v24, 0
L_sn:
    s_mov_b32 s60, 0
L_sc:
    buffer_load_dword v18, v16, s[28:31], s60 offen
    buffer_load_dword v19, v16, s[24:27], s60 offen
    s_waitcnt vmcnt(0)
    v_cmp_eq_u32 vcc, s66, v18
    s_cbranch_vccz L_sx
L_se:
    s_ff1_i32_b64 s58, vcc
    s_bitset0_b64 vcc, s58
    v_readlane_b32 s59, v19, s58
    s_nop 0
    s_lshl_b32 s61, s59, 9
    s_lshl_b32 s59, s59, 1
    buffer_load_dwordx4 v[20:23], v17, s[8:11], s61 offen
    buffer_load_short_d16_hi v5, v24, s[12:15], s59 offen
    s_waitcnt vmcnt(0)
    v_perm_b32 v6, v5, v5, v10
    v_perm_b32 v7, v5, v5, v11
    s_nop 1
    v_mfma_f32_4x4x4_16b_bf16 v[120:123], v[6:7], v[20:21], v[120:123]
    v_mfma_f32_4x4x4_16b_bf16 v[124:127], v[6:7], v[22:23], v[124:127]
    s_cmp_lg_u64 vcc, 0
    s_cbranch_scc1 L_se
L_sx:
    s_add_u32 s60, s60, 256
    s_cmp_lt_u32 s60, 640000
    s_cbranch_scc1 L_sc
    s_call_b64 s[68:69], L_flush
    s_add_u32 s66, s66, 8
    s_cmp_lt_u32 s66, s67
    s_cbranch_scc1 L_sn
    s_branch L_gdone
.section .rodata,"a"
.p2align 6
.amdhsa_kernel standalone__hybrid_graph_tf_exphormer__graph_kernel
  .amdhsa_next_free_vgpr 128
  .amdhsa_next_free_sgpr 102
  .amdhsa_accum_offset 128
  .amdhsa_group_segment_fixed_size 0
  .amdhsa_kernarg_size 104
  .amdhsa_user_sgpr_count 2
  .amdhsa_user_sgpr_kernarg_segment_ptr 1
  .amdhsa_system_sgpr_workgroup_id_x 1
.end_amdhsa_kernel
```

```asm
; @launch grid=(250,1,1) block=(1024,1,1) lds=163712
.amdgcn_target "amdgcn-amd-amdhsa--gfx950"
.text
.globl standalone__hybrid_graph_tf_exphormer__graph_kernel
.p2align 8
.type standalone__hybrid_graph_tf_exphormer__graph_kernel,@function
standalone__hybrid_graph_tf_exphormer__graph_kernel:
    s_cmp_ge_u32 s2, 250
    s_cbranch_scc1 L_exit
    s_load_dwordx16 s[32:47], s[0:1], 0
    s_load_dwordx8 s[48:55], s[0:1], 64
    s_load_dwordx2 s[56:57], s[0:1], 96
    s_getpc_b64 s[60:61]
    s_lshr_b32 s6, s2, 3
    v_lshl_add_u32 v1, v0, 5, s6
    v_cmp_gt_u32 vcc, 87, v1
    v_lshlrev_b32 v1, 7, v1
    s_and_saveexec_b64 s[58:59], vcc
    s_cbranch_execz L_nopf
    global_load_dword v123, v1, s[60:61]
L_nopf:
    s_mov_b64 exec, -1
    v_lshrrev_b32 v1, 6, v0
    v_mov_b32 v8, 33554432
    v_readfirstlane_b32 s3, v1
    v_cmp_gt_u32 vcc, 320, v0
    v_lshlrev_b32 v4, 4, v0
    v_add_u32 v4, 152064, v4
    v_cndmask_b32 v8, 0, v8, vcc
    v_mov_b32 v9, v8
    v_mov_b64 v[10:11], v[8:9]
    v_cmp_gt_u32 vcc, 568, v0
    s_and_saveexec_b64 s[58:59], vcc
    ds_write_b128 v4, v[8:11]
    s_mov_b64 exec, -1
    v_and_b32 v0, 63, v0
    v_and_b32 v2, 31, v0
    v_lshlrev_b32 v2, 4, v2
    s_and_b32 s59, s2, 7
    s_mul_i32 s60, s59, 31
    s_min_u32 s59, s59, 2
    s_add_u32 s6, s6, s60
    s_add_u32 s6, s6, s59
    s_mov_b32 s27, 0x20000
    s_mov_b32 s31, 0x20000
    s_xor_b32 s3, s3, 8
    s_cmp_eq_u32 s3, 8
    s_cbranch_scc0 L_e1
    s_setprio 3
    v_lshlrev_b32 v5, 4, v0
    v_lshlrev_b32 v6, 3, v0
    s_mul_i32 s58, s2, 2560
    s_mov_b32 s26, 640000
    s_mov_b32 s30, 640000
    s_mov_b32 s59, 1048576
    s_waitcnt lgkmcnt(0)
    s_mov_b64 s[28:29], s[36:37]
    s_mov_b64 s[24:25], s[34:35]
    buffer_load_dwordx4 v[26:29], v5, s[28:31], s58 offen
    buffer_load_dwordx4 v[30:33], v5, s[28:31], s58 offen offset:1024
    buffer_load_dwordx2 v[34:35], v6, s[28:31], s58 offen offset:2048
    buffer_load_dwordx4 v[16:19], v5, s[24:27], s58 offen
    buffer_load_dwordx4 v[20:23], v5, s[24:27], s58 offen offset:1024
    buffer_load_dwordx2 v[24:25], v6, s[24:27], s58 offen offset:2048
    s_load_dword s40, s[56:57], s59
    s_branch L_bar
L_e1:
    s_mov_b32 s26, 131072
    s_sub_u32 s60, s3, 9
    s_cmp_lt_u32 s60, 3
    s_cbranch_scc0 L_e2
    s_cmp_ge_u32 s2, 128
    s_cbranch_scc1 L_barw
    s_setprio 3
    s_and_b32 s58, s2, 7
    s_lshr_b32 s59, s2, 4
    s_bfe_u32 s61, s2, 0x10003
    s_cmp_eq_u32 s60, 2
    s_cselect_b32 s58, s59, s58
    s_cselect_b32 s61, s61, s60
    s_lshl_b32 s58, s58, 14
    s_lshl_b32 s61, s61, 11
    s_add_u32 s58, s58, s61
    s_add_u32 s59, s58, 4096
    v_and_b32 v4, 32, v0
    v_lshl_add_u32 v4, v4, 8, v2
    s_mul_i32 s61, s60, 8448
    s_add_u32 m0, s61, 105600
    s_cmp_eq_u32 s60, 2
    s_waitcnt lgkmcnt(0)
    s_cselect_b64 s[24:25], s[48:49], s[46:47]
    buffer_load_dwordx4 v4, s[24:27], s58 offen offset:0 lds
    s_add_u32 m0, m0, 544
    s_nop 0
    buffer_load_dwordx4 v4, s[24:27], s58 offen offset:512 lds
    s_add_u32 m0, m0, 544
    s_nop 0
    buffer_load_dwordx4 v4, s[24:27], s58 offen offset:1024 lds
    s_add_u32 m0, m0, 544
    s_nop 0
    buffer_load_dwordx4 v4, s[24:27], s58 offen offset:1536 lds
    s_add_u32 m0, m0, 2592
    s_nop 0
    buffer_load_dwordx4 v4, s[24:27], s59 offen offset:0 lds
    s_add_u32 m0, m0, 544
    s_nop 0
    buffer_load_dwordx4 v4, s[24:27], s59 offen offset:512 lds
    s_add_u32 m0, m0, 544
    s_nop 0
    buffer_load_dwordx4 v4, s[24:27], s59 offen offset:1024 lds
    s_add_u32 m0, m0, 544
    s_nop 0
    buffer_load_dwordx4 v4, s[24:27], s59 offen offset:1536 lds
    s_branch L_bar
L_e2:
    s_cmp_eq_u32 s3, 12
    s_cbranch_scc0 L_e3
    s_cmp_lt_u32 s2, 122
    s_cbranch_scc1 L_barw
    s_setprio 3
    s_sub_u32 s58, s2, 122
    s_and_b32 s59, s58, 7
    s_lshl_b32 s59, s59, 14
    s_bfe_u32 s60, s58, 0x30003
    s_lshl_b32 s60, s60, 6
    s_add_u32 s59, s59, s60
    v_and_b32 v4, 15, v0
    v_lshlrev_b32 v4, 2, v4
    v_and_b32 v5, 48, v0
    v_lshl_add_u32 v4, v5, 8, v4
    s_cmp_lt_u32 s58, 64
    s_waitcnt lgkmcnt(0)
    s_cselect_b64 s[24:25], s[50:51], s[44:45]
    buffer_load_dword v16, v4, s[24:27], s59 offen offset:0
    buffer_load_dword v17, v4, s[24:27], s59 offen offset:512
    buffer_load_dword v18, v4, s[24:27], s59 offen offset:1024
    buffer_load_dword v19, v4, s[24:27], s59 offen offset:1536
    buffer_load_dword v20, v4, s[24:27], s59 offen offset:2048
    buffer_load_dword v21, v4, s[24:27], s59 offen offset:2560
    buffer_load_dword v22, v4, s[24:27], s59 offen offset:3072
    buffer_load_dword v23, v4, s[24:27], s59 offen offset:3584
    s_branch L_bar
L_e3:
    s_cmp_lt_u32 s3, 8
    s_cbranch_scc0 L_barw
    s_mul_i32 s58, s6, 640
    s_lshl_b32 s59, s3, 6
    s_add_u32 s59, s59, s58
    s_lshr_b32 s60, s3, 2
    s_lshl_b32 s60, s60, 6
    s_and_b32 s61, s3, 3
    s_lshl_b32 s61, s61, 3
    s_add_u32 s60, s60, s61
    s_add_u32 s60, s60, s58
    s_add_u32 s60, s60, 512
    s_add_u32 s61, s60, 32
    s_waitcnt lgkmcnt(0)
    s_mov_b64 s[62:63], s[38:39]
    s_mov_b64 s[8:9], s[32:33]
    s_load_dwordx16 s[32:47], s[62:63], s59
    s_load_dwordx2 s[64:65], s[62:63], s60
    s_load_dwordx2 s[66:67], s[62:63], s61
    s_barrier
    s_branch L_preA
L_barw:
    s_waitcnt lgkmcnt(0)
L_bar:
    s_barrier
    s_mov_b64 s[8:9], s[32:33]
    s_and_b32 s4, s3, 7
    s_mul_i32 s5, s6, 40
    v_mov_b32 v3, 160064
    s_mov_b32 s10, 5120000
    s_mov_b32 s11, 0x20000
    s_add_u32 s16, s56, 0
    s_addc_u32 s17, s57, 0
    s_mov_b32 s18, 4194304
    s_mov_b32 s19, 0x20000
    s_cmp_eq_u32 s3, 9
    s_cbranch_scc1 L_mtask
    s_cmp_gt_u32 s3, 9
    s_cbranch_scc1 L_other
    v_lshlrev_b32 v5, 4, v0
    v_lshlrev_b32 v6, 3, v0
    v_mov_b32 v8, 1
    v_mov_b32 v9, 4
    v_mov_b32 v10, 160128
    v_add_u32 v11, 160128, v5
    v_mov_b32 v59, 161152
    v_add_u32 v74, 161152, v5
    v_add_u32 v75, 161152, v6
    s_lshl_b32 s61, s2, 10
    s_add_u32 s61, s61, 2097152
    s_waitcnt vmcnt(5)
    v_mul_u32_u24 v36, 52429, v26
    v_lshrrev_b32 v36, 21, v36
    v_lshl_add_u32 v36, v36, 2, v10
    ds_add_u32 v36, v8
    v_mul_u32_u24 v37, 52429, v27
    v_lshrrev_b32 v37, 21, v37
    v_lshl_add_u32 v37, v37, 2, v10
    ds_add_u32 v37, v8
    v_mul_u32_u24 v38, 52429, v28
    v_lshrrev_b32 v38, 21, v38
    v_lshl_add_u32 v38, v38, 2, v10
    ds_add_u32 v38, v8
    v_mul_u32_u24 v39, 52429, v29
    v_lshrrev_b32 v39, 21, v39
    v_lshl_add_u32 v39, v39, 2, v10
    ds_add_u32 v39, v8
    s_waitcnt vmcnt(4)
    v_mul_u32_u24 v40, 52429, v30
    v_lshrrev_b32 v40, 21, v40
    v_lshl_add_u32 v40, v40, 2, v10
    ds_add_u32 v40, v8
    v_mul_u32_u24 v41, 52429, v31
    v_lshrrev_b32 v41, 21, v41
    v_lshl_add_u32 v41, v41, 2, v10
    ds_add_u32 v41, v8
    v_mul_u32_u24 v42, 52429, v32
    v_lshrrev_b32 v42, 21, v42
    v_lshl_add_u32 v42, v42, 2, v10
    ds_add_u32 v42, v8
    v_mul_u32_u24 v43, 52429, v33
    v_lshrrev_b32 v43, 21, v43
    v_lshl_add_u32 v43, v43, 2, v10
    ds_add_u32 v43, v8
    s_waitcnt vmcnt(3)
    v_mul_u32_u24 v44, 52429, v34
    v_lshrrev_b32 v44, 21, v44
    v_lshl_add_u32 v44, v44, 2, v10
    ds_add_u32 v44, v8
    v_mul_u32_u24 v45, 52429, v35
    v_lshrrev_b32 v45, 21, v45
    v_lshl_add_u32 v45, v45, 2, v10
    ds_add_u32 v45, v8
    ds_read_b128 v[12:15], v11
    s_waitcnt vmcnt(0)
    v_lshl_or_b32 v16, v26, 16, v16
    v_lshl_or_b32 v17, v27, 16, v17
    v_lshl_or_b32 v18, v28, 16, v18
    v_lshl_or_b32 v19, v29, 16, v19
    v_lshl_or_b32 v20, v30, 16, v20
    v_lshl_or_b32 v21, v31, 16, v21
    v_lshl_or_b32 v22, v32, 16, v22
    v_lshl_or_b32 v23, v33, 16, v23
    v_lshl_or_b32 v24, v34, 16, v24
    v_lshl_or_b32 v25, v35, 16, v25
    s_waitcnt lgkmcnt(0)
    v_add_u32 v56, v12, v13
    v_add3_u32 v57, v56, v14, v15
    s_add_u32 s40, s40, 0x400
    s_and_b32 s40, s40, 4294966272
    v_add_u32_dpp v58, v57, v57 row_shr:1 row_mask:0xf bank_mask:0xf bound_ctrl:1
    s_nop 1
    v_add_u32_dpp v58, v58, v58 row_shr:2 row_mask:0xf bank_mask:0xf bound_ctrl:1
    s_nop 1
    v_add_u32_dpp v58, v58, v58 row_shr:4 row_mask:0xf bank_mask:0xf bound_ctrl:1
    s_nop 1
    v_add_u32_dpp v58, v58, v58 row_shr:8 row_mask:0xf bank_mask:0xf bound_ctrl:1
    s_nop 1
    v_add_u32_dpp v58, v58, v58 row_bcast:15 row_mask:0xa bank_mask:0xf
    s_nop 1
    v_add_u32_dpp v58, v58, v58 row_bcast:31 row_mask:0xc bank_mask:0xf
    v_sub_u32 v60, v58, v57
    v_add_u32 v61, v60, v12
    v_add_u32 v62, v60, v56
    v_add_u32 v63, v62, v14
    v_lshl_add_u32 v64, v60, 2, v59
    v_lshl_add_u32 v65, v61, 2, v59
    v_lshl_add_u32 v66, v62, 2, v59
    v_lshl_add_u32 v67, v63, 2, v59
    ds_write_b128 v11, v[64:67]
    ds_add_rtn_u32 v46, v36, v9
    ds_add_rtn_u32 v47, v37, v9
    ds_add_rtn_u32 v48, v38, v9
    ds_add_rtn_u32 v49, v39, v9
    ds_add_rtn_u32 v50, v40, v9
    ds_add_rtn_u32 v51, v41, v9
    ds_add_rtn_u32 v52, v42, v9
    ds_add_rtn_u32 v53, v43, v9
    ds_add_rtn_u32 v54, v44, v9
    ds_add_rtn_u32 v55, v45, v9
    v_or_b32 v60, s40, v60
    v_or_b32 v61, s40, v61
    v_or_b32 v62, s40, v62
    v_or_b32 v63, s40, v63
    s_or_b32 s60, s40, 1
    v_mov_b32 v12, s60
    s_waitcnt lgkmcnt(8)
    ds_write_b32 v46, v16
    ds_write_b32 v47, v17
    s_waitcnt lgkmcnt(8)
    ds_write_b32 v48, v18
    ds_write_b32 v49, v19
    s_waitcnt lgkmcnt(8)
    ds_write_b32 v50, v20
    ds_write_b32 v51, v21
    s_waitcnt lgkmcnt(8)
    ds_write_b32 v52, v22
    ds_write_b32 v53, v23
    s_waitcnt lgkmcnt(8)
    ds_write_b32 v54, v24
    ds_write_b32 v55, v25
    ds_read_b128 v[64:67], v74
    ds_read_b128 v[68:71], v74 offset:1024
    ds_read_b64 v[72:73], v75 offset:2048
    s_waitcnt lgkmcnt(2)
    buffer_store_dwordx4 v[64:67], v5, s[16:19], s58 offen sc1
    s_waitcnt lgkmcnt(1)
    buffer_store_dwordx4 v[68:71], v5, s[16:19], s58 offen offset:1024 sc1
    s_waitcnt lgkmcnt(0)
    buffer_store_dwordx2 v[72:73], v6, s[16:19], s58 offen offset:2048 sc1
    s_mov_b32 s59, 0
Lw_1:
    ds_read_b32 v4, v3 offset:56
    s_waitcnt lgkmcnt(0)
    v_cmp_gt_u32 vcc, 2, v4
    s_cbranch_vccz Lk_2
    s_add_u32 s59, s59, 1
    s_cmp_lt_u32 s59, 4194304
    s_cbranch_scc1 Lw_1
    s_branch L_end
Lk_2:
    s_waitcnt vmcnt(0)
    buffer_store_dwordx4 v[60:63], v5, s[16:19], s61 offen sc1
    ds_write_b32 v3, v12 offset:32
    s_branch L_preB
L_mtask:
    s_cmp_ge_u32 s2, 128
    s_cbranch_scc1 L_taskd
    v_and_b32 v4, 7, v0
    v_mul_u32_u24 v1, 1056, v4
    v_and_b32 v4, 8, v0
    v_lshl_add_u32 v1, v4, 6, v1
    v_and_b32 v4, 48, v0
    v_add_u32 v1, v4, v1
    v_add_u32 v5, 105600, v1
    s_lshr_b32 s58, s2, 4
    s_lshl_b32 s58, s58, 3
    s_and_b32 s59, s2, 7
    s_add_u32 s58, s58, s59
    s_lshl_b32 s58, s58, 1
    s_bfe_u32 s59, s2, 0x10003
    s_add_u32 s58, s58, s59
    s_lshl_b32 s58, s58, 10
    s_add_u32 s58, s58, 655360
    v_lshlrev_b32 v6, 4, v0
    s_waitcnt vmcnt(0)
    s_mov_b32 s59, 0
Lw_3:
    ds_read_b32 v4, v3 offset:8
    s_waitcnt lgkmcnt(0)
    v_cmp_gt_u32 vcc, 2, v4
    s_cbranch_vccz Lk_4
    s_add_u32 s59, s59, 1
    s_cmp_lt_u32 s59, 4194304
    s_cbranch_scc1 Lw_3
    s_branch L_end
Lk_4:
    ds_read_b128 v[32:35], v5 offset:0
    ds_read_b128 v[36:39], v5 offset:8448
    ds_read_b128 v[40:43], v5 offset:16896
    ds_read_b128 v[44:47], v5 offset:64
    ds_read_b128 v[48:51], v5 offset:8512
    ds_read_b128 v[52:55], v5 offset:16960
    ds_read_b128 v[56:59], v5 offset:128
    ds_read_b128 v[60:63], v5 offset:8576
    ds_read_b128 v[64:67], v5 offset:17024
    ds_read_b128 v[68:71], v5 offset:192
    ds_read_b128 v[72:75], v5 offset:8640
    ds_read_b128 v[76:79], v5 offset:17088
    s_waitcnt lgkmcnt(9)
    ds_read_b128 v[80:83], v5 offset:256
    ds_read_b128 v[84:87], v5 offset:8704
    ds_read_b128 v[88:91], v5 offset:17152
    v_mfma_f32_16x16x32_bf16 v[8:11], v[32:35], v[40:43], 0
    v_mfma_f32_16x16x32_bf16 v[12:15], v[36:39], v[40:43], 0
    s_waitcnt lgkmcnt(9)
    ds_read_b128 v[92:95], v5 offset:320
    ds_read_b128 v[96:99], v5 offset:8768
    ds_read_b128 v[100:103], v5 offset:17216
    v_mfma_f32_16x16x32_bf16 v[8:11], v[44:47], v[52:55], v[8:11]
    v_mfma_f32_16x16x32_bf16 v[12:15], v[48:51], v[52:55], v[12:15]
    s_waitcnt lgkmcnt(9)
    ds_read_b128 v[104:107], v5 offset:384
    ds_read_b128 v[108:111], v5 offset:8832
    ds_read_b128 v[112:115], v5 offset:17280
    v_mfma_f32_16x16x32_bf16 v[8:11], v[56:59], v[64:67], v[8:11]
    v_mfma_f32_16x16x32_bf16 v[12:15], v[60:63], v[64:67], v[12:15]
    s_waitcnt lgkmcnt(9)
    ds_read_b128 v[116:119], v5 offset:448
    ds_read_b128 v[120:123], v5 offset:8896
    ds_read_b128 v[124:127], v5 offset:17344
    v_mfma_f32_16x16x32_bf16 v[8:11], v[68:71], v[76:79], v[8:11]
    v_mfma_f32_16x16x32_bf16 v[12:15], v[72:75], v[76:79], v[12:15]
    s_waitcnt lgkmcnt(9)
    v_mfma_f32_16x16x32_bf16 v[8:11], v[80:83], v[88:91], v[8:11]
    v_mfma_f32_16x16x32_bf16 v[12:15], v[84:87], v[88:91], v[12:15]
    s_waitcnt lgkmcnt(6)
    v_mfma_f32_16x16x32_bf16 v[8:11], v[92:95], v[100:103], v[8:11]
    v_mfma_f32_16x16x32_bf16 v[12:15], v[96:99], v[100:103], v[12:15]
    s_waitcnt lgkmcnt(3)
    v_mfma_f32_16x16x32_bf16 v[8:11], v[104:107], v[112:115], v[8:11]
    v_mfma_f32_16x16x32_bf16 v[12:15], v[108:111], v[112:115], v[12:15]
    s_waitcnt lgkmcnt(0)
    v_mfma_f32_16x16x32_bf16 v[8:11], v[116:119], v[124:127], v[8:11]
    v_mfma_f32_16x16x32_bf16 v[12:15], v[120:123], v[124:127], v[12:15]
    s_nop 6
    v_cvt_pk_bf16_f32 v16, v8, v9
    v_cvt_pk_bf16_f32 v17, v10, v11
    v_cvt_pk_bf16_f32 v18, v12, v13
    v_cvt_pk_bf16_f32 v19, v14, v15
    buffer_store_dwordx4 v[16:19], v6, s[16:19], s58 offen sc1
    s_branch L_taskw
L_other:
    s_cmp_gt_u32 s3, 12
    s_cbranch_scc1 L_dis
    s_cmp_eq_u32 s3, 12
    s_cbranch_scc1 L_wtask
    s_waitcnt vmcnt(0)
    s_mov_b64 exec, 1
    v_mov_b32 v4, 1
    ds_add_u32 v3, v4 offset:8
    s_mov_b64 exec, -1
    s_branch L_preB
L_wtask:
    s_cmp_lt_u32 s2, 122
    s_cbranch_scc1 L_taskd
    s_sub_u32 s58, s2, 122
    s_lshl_b32 s58, s58, 11
    s_add_u32 s58, s58, 786432
    v_lshlrev_b32 v6, 4, v0
    s_mov_b32 s70, 0x05040100
    s_mov_b32 s71, 0x07060302
    s_waitcnt vmcnt(0)
    v_perm_b32 v60, v17, v16, s70
    v_perm_b32 v64, v17, v16, s71
    v_perm_b32 v61, v19, v18, s70
    v_perm_b32 v65, v19, v18, s71
    v_perm_b32 v62, v21, v20, s70
    v_perm_b32 v66, v21, v20, s71
    v_perm_b32 v63, v23, v22, s70
    v_perm_b32 v67, v23, v22, s71
    buffer_store_dwordx4 v[60:63], v6, s[16:19], s58 offen sc1
    buffer_store_dwordx4 v[64:67], v6, s[16:19], s58 offen offset:1024 sc1
L_taskw:
    s_waitcnt vmcnt(0)
L_taskd:
    s_mov_b64 exec, 1
    v_mov_b32 v4, 1
    ds_add_u32 v3, v4 offset:56
    s_mov_b64 exec, -1
    s_branch L_preB
L_dis:
    s_mov_b64 s[28:29], s[42:43]
    s_mov_b32 s30, 20000
    s_sub_u32 s58, s3, 13
    s_mul_i32 s58, s58, 7168
    v_lshlrev_b32 v4, 4, v0
    s_add_u32 m0, s58, 130944
    s_add_u32 s59, s58, 0
    s_waitcnt vmcnt(1)
    buffer_load_dwordx4 v4, s[28:31], s59 offen offset:0 lds
    s_waitcnt vmcnt(1)
    buffer_load_dwordx4 v4, s[28:31], s59 offen offset:1024 lds
    s_waitcnt vmcnt(1)
    buffer_load_dwordx4 v4, s[28:31], s59 offen offset:2048 lds
    s_waitcnt vmcnt(1)
    buffer_load_dwordx4 v4, s[28:31], s59 offen offset:3072 lds
    s_add_u32 m0, s58, 135040
    s_add_u32 s59, s58, 4096
    s_waitcnt vmcnt(1)
    buffer_load_dwordx4 v4, s[28:31], s59 offen offset:0 lds
    s_waitcnt vmcnt(1)
    buffer_load_dwordx4 v4, s[28:31], s59 offen offset:1024 lds
    s_cmp_eq_u32 s3, 15
    s_cbranch_scc1 L_preB
    s_waitcnt vmcnt(1)
    buffer_load_dwordx4 v4, s[28:31], s59 offen offset:2048 lds
L_preB:
    s_setprio 3
    v_and_b32 v4, 3, v0
    v_mov_b32 v5, 0x0c0c0c0c
    v_mov_b32 v6, 0x0c0c0302
    v_mov_b32 v7, 0x03020c0c
    v_cmp_eq_u32 s[58:59], 0, v4
    v_cmp_eq_u32 s[60:61], 2, v4
    v_cmp_eq_u32 vcc, 1, v4
    v_cndmask_b32 v10, v5, v6, s[58:59]
    v_cndmask_b32 v11, v5, v6, s[60:61]
    v_cndmask_b32 v10, v10, v7, vcc
    v_cmp_eq_u32 vcc, 3, v4
    s_nop 1
    v_cndmask_b32 v11, v11, v7, vcc
    v_and_b32 v10, 0xfdfdfdfd, v10
    v_and_b32 v11, 0xfdfdfdfd, v11
    s_movk_i32 s7, 512
    s_lshl_b32 s58, s4, 5
    v_lshrrev_b32 v5, 1, v0
    v_add_u32 v5, s58, v5
    v_cmp_gt_u32 vcc, 250, v5
    v_and_b32 v56, 1, v0
    s_mov_b64 s[64:65], vcc
    v_lshlrev_b32 v54, 10, v5
    v_mul_u32_u24 v49, 2560, v5
    v_lshl_add_u32 v49, v56, 4, v49
    v_lshlrev_b32 v56, 2, v56
    v_lshrrev_b32 v5, 3, v0
    v_and_b32 v6, 7, v0
    v_cmp_gt_u32 s[62:63], 5, v6
    v_lshl_add_u32 v50, v6, 3, v5
    v_mul_u32_u24 v55, 80, v5
    v_add_u32 v55, 80, v55
    v_lshrrev_b32 v5, 4, v50
    v_mul_u32_u24 v9, 8448, v5
    v_lshl_add_u32 v9, v5, 26, v9
    v_cmp_le_u32 vcc, 32, v50
    v_and_b32 v5, 7, v50
    v_and_b32 v6, 3, v50
    v_cndmask_b32 v5, v5, v6, vcc
    v_mul_u32_u24 v5, 1056, v5
    v_bfe_u32 v6, v50, 3, 1
    v_bfe_u32 v7, v50, 2, 1
    v_cndmask_b32 v6, v6, v7, vcc
    v_lshl_add_u32 v5, v6, 9, v5
    v_mov_b32 v52, 130944
    v_add3_u32 v9, v9, v5, v52
    v_lshrrev_b32 v5, 5, v0
    v_lshl_add_u32 v15, v5, 3, v2
    v_mov_b32 v127, 1
    s_lshl_b32 s58, s5, 2
    s_sub_u32 s58, 159744, s58
    v_mov_b32 v53, s58
    v_add_u32 v5, s5, v50
    v_lshl_add_u32 v8, v5, 1, v52
    v_lshlrev_b32 v50, 2, v50
    v_add_u32 v50, 159744, v50
    v_mov_b32 v124, v2
    v_mov_b32 v125, v2
    v_min_u32 v5, 1, v0
    v_lshl_add_u32 v126, v0, 2, v3
    v_lshl_add_u32 v126, v5, 16, v126
    v_mov_b32 v57, 157184
    v_mov_b32 v76, 152064
    s_lshl_b32 s60, s6, 2
    s_add_u32 s60, s60, 2097152
    s_add_u32 s61, s60, 0
    v_mov_b64 v[58:59], 0
    v_mov_b64 v[16:17], 0
    v_mov_b64 v[18:19], 0
    v_mov_b64 v[20:21], 0
    v_mov_b64 v[22:23], 0
    s_mov_b32 s59, 0
Lw_5:
    ds_read_b32 v4, v3 offset:60
    s_waitcnt lgkmcnt(0)
    v_cmp_gt_u32 vcc, 8, v4
    s_cbranch_vccz Lk_6
    s_sleep 2
    s_add_u32 s59, s59, 1
    s_cmp_lt_u32 s59, 4194304
    s_cbranch_scc1 Lw_5
    s_branch L_end
Lk_6:
    s_mov_b32 s59, 0
Lw_7:
    ds_read_b32 v4, v3 offset:32
    s_waitcnt lgkmcnt(0)
    v_cmp_gt_u32 vcc, 1, v4
    s_cbranch_vccz Lk_8
    s_sleep 1
    s_add_u32 s59, s59, 1
    s_cmp_lt_u32 s59, 4194304
    s_cbranch_scc1 Lw_7
    s_branch L_end
Lk_8:
    v_readfirstlane_b32 s40, v4
    s_mov_b32 s59, 0
    s_mov_b64 exec, s[64:65]
    s_bitset0_b32 s40, 0
L_spoll:
    buffer_load_dwordx2 v[58:59], v54, s[16:19], s60 offen sc1
    s_add_u32 s59, s59, 1
    s_cmp_gt_u32 s59, 0x40000
    s_cbranch_scc1 L_end
    s_add_u32 s60, s60, 262144
    s_min_u32 s60, s60, s61
    s_waitcnt vmcnt(0)
    v_xor_b32 v58, s40, v58
    v_xor_b32 v59, s40, v59
    v_or_b32 v5, v58, v59
    v_cmpx_lt_u32 vcc, 0x3ff, v5
    s_cbranch_execz L_sok
    s_sleep 8
    s_branch L_spoll
L_sok:
    s_mov_b64 exec, -1
    ds_add_u32 v126, v127 offset:52
    v_lshl_add_u32 v49, v58, 2, v49
    v_sub_u32 v48, v59, v58
    v_sub_u32 v48, v48, v56
    v_cmpx_lt_i32 vcc, 0, v48
    s_cbranch_execz L_entld
    buffer_load_dwordx4 v[16:19], v49, s[16:19], 0 offen offset:0 sc1
    v_cmpx_lt_i32 vcc, 8, v48
    s_cbranch_execz L_entld
    buffer_load_dwordx4 v[20:23], v49, s[16:19], 0 offen offset:32 sc1
    v_cmpx_lt_i32 vcc, 16, v48
    s_cbranch_execz L_entld
    ds_write_b32 v3, v127 offset:28
L_entld:
    s_mov_b64 exec, -1
    s_waitcnt vmcnt(0)
    v_cmpx_lt_i32 vcc, 0, v48
    v_mad_u32_u16 v24, v16, 4, v53 op_sel:[1,0,0,0]
    ds_add_rtn_u32 v32, v24, v127
    v_cmpx_lt_i32 vcc, 1, v48
    v_mad_u32_u16 v25, v17, 4, v53 op_sel:[1,0,0,0]
    ds_add_rtn_u32 v33, v25, v127
    v_cmpx_lt_i32 vcc, 2, v48
    v_mad_u32_u16 v26, v18, 4, v53 op_sel:[1,0,0,0]
    ds_add_rtn_u32 v34, v26, v127
    v_cmpx_lt_i32 vcc, 3, v48
    v_mad_u32_u16 v27, v19, 4, v53 op_sel:[1,0,0,0]
    ds_add_rtn_u32 v35, v27, v127
    v_cmpx_lt_i32 vcc, 8, v48
    s_cbranch_execz L_l1
    s_waitcnt lgkmcnt(2)
    v_mad_u32_u16 v28, v20, 4, v53 op_sel:[1,0,0,0]
    ds_add_rtn_u32 v36, v28, v127
    v_cmpx_lt_i32 vcc, 9, v48
    s_cbranch_execz L_l1
    v_mad_u32_u16 v29, v21, 4, v53 op_sel:[1,0,0,0]
    ds_add_rtn_u32 v37, v29, v127
    v_cmpx_lt_i32 vcc, 10, v48
    s_cbranch_execz L_l1
    v_mad_u32_u16 v30, v22, 4, v53 op_sel:[1,0,0,0]
    ds_add_rtn_u32 v38, v30, v127
    v_cmpx_lt_i32 vcc, 11, v48
    s_cbranch_execz L_l1
    v_mad_u32_u16 v31, v23, 4, v53 op_sel:[1,0,0,0]
    ds_add_rtn_u32 v39, v31, v127
L_l1:
    s_mov_b64 exec, -1
    ds_add_u32 v126, v127 offset:12
    v_mad_u32_u16 v40, v16, 2, v52
    v_mad_u32_u16 v16, v16, s7, 0
    v_mad_u32_u16 v41, v17, 2, v52
    v_mad_u32_u16 v17, v17, s7, 0
    v_mad_u32_u16 v42, v18, 2, v52
    v_mad_u32_u16 v18, v18, s7, 0
    v_mad_u32_u16 v43, v19, 2, v52
    v_mad_u32_u16 v19, v19, s7, 0
    v_mad_u32_u16 v44, v20, 2, v52
    v_mad_u32_u16 v20, v20, s7, 0
    v_mad_u32_u16 v45, v21, 2, v52
    v_mad_u32_u16 v21, v21, s7, 0
    v_mad_u32_u16 v46, v22, 2, v52
    v_mad_u32_u16 v22, v22, s7, 0
    v_mad_u32_u16 v47, v23, 2, v52
    v_mad_u32_u16 v23, v23, s7, 0
    s_mov_b32 s59, 0
Lw_9:
    ds_read_b32 v4, v3 offset:12
    s_waitcnt lgkmcnt(0)
    v_cmp_gt_u32 vcc, 8, v4
    s_cbranch_vccz Lk_10
    s_add_u32 s59, s59, 1
    s_cmp_lt_u32 s59, 4194304
    s_cbranch_scc1 Lw_9
    s_branch L_end
Lk_10:
    ds_read_b32 v12, v50
    ds_read_b32 v5, v3 offset:28
    ds_read_u16 v8, v8
    ds_read_u16 v40, v40
    ds_read_u16 v41, v41
    ds_read_u16 v42, v42
    ds_read_u16 v43, v43
    ds_read_u16 v44, v44
    ds_read_u16 v45, v45
    ds_read_u16 v46, v46
    ds_read_u16 v47, v47
    s_lshl_b32 s58, s2, 4
    s_add_u32 s58, s58, s3
    s_cmp_eq_u32 s58, 15
    s_cbranch_scc0 L_noep
    v_mov_b32 v6, s40
    v_mov_b32 v7, 1048576
    s_mov_b64 exec, 1
    buffer_store_dword v6, v7, s[16:19], 0 offen sc1
    s_mov_b64 exec, -1
L_noep:
    s_waitcnt lgkmcnt(10)
    v_add_u32 v12, 1, v12
    v_lshrrev_b32 v12, 1, v12
    v_max_u32 v12, 1, v12
    v_cndmask_b32 v12, 0, v12, s[62:63]
    s_lshl_b32 s67, s4, 3
    s_movk_i32 s58, 2560
    v_add_u32_dpp v51, v12, v12 row_shl:1 row_mask:0xf bank_mask:0xf bound_ctrl:1
    s_nop 1
    v_add_u32_dpp v51, v51, v51 row_shl:2 row_mask:0xf bank_mask:0xf bound_ctrl:1
    s_nop 1
    v_add_u32_dpp v51, v12, v51 row_shl:4 row_mask:0xf bank_mask:0x5 bound_ctrl:1
    s_waitcnt lgkmcnt(0)
    v_lshlrev_b32 v8, 16, v8
    v_lshl_add_u32 v5, v5, 10, v51
    v_sub_u32 v6, v55, v51
    v_cmp_le_u32 vcc, 80, v5
    v_lshlrev_b32 v6, 1, v6
    v_subrev_u32 v12, 1, v12
    s_cbranch_vccnz L_slow
    s_mov_b64 exec, s[62:63]
    ds_write_b32 v50, v6 offset:160
    s_mov_b64 exec, -1
    s_sub_u32 s63, s67, 1
    v_readlane_b32 s67, v51, s67
    v_cmpx_lt_i32 vcc, 0, v48
    ds_read_b32 v24, v24 offset:160
    v_cmpx_lt_i32 vcc, 1, v48
    ds_read_b32 v25, v25 offset:160
    v_cmpx_lt_i32 vcc, 2, v48
    ds_read_b32 v26, v26 offset:160
    v_cmpx_lt_i32 vcc, 3, v48
    ds_read_b32 v27, v27 offset:160
    v_cmpx_lt_i32 vcc, 8, v48
    s_cbranch_execz L_l2
    s_waitcnt lgkmcnt(2)
    ds_read_b32 v28, v28 offset:160
    v_cmpx_lt_i32 vcc, 9, v48
    s_cbranch_execz L_l2
    ds_read_b32 v29, v29 offset:160
    v_cmpx_lt_i32 vcc, 10, v48
    s_cbranch_execz L_l2
    ds_read_b32 v30, v30 offset:160
    v_cmpx_lt_i32 vcc, 11, v48
    s_cbranch_execz L_l2
    ds_read_b32 v31, v31 offset:160
L_l2:
    s_mov_b64 exec, -1
    s_lshr_b32 s66, s67, 3
    s_add_u32 s60, s66, 1
    s_lshl_b32 s60, s60, 3
    s_sub_u32 s67, s60, s67
    s_sub_u32 s62, s67, 1
    s_add_u32 s61, s4, 1
    s_mul_i32 s61, s61, 80
    s_sub_u32 s60, s61, s60
    s_lshl_b32 s60, s60, 2
    s_waitcnt lgkmcnt(0)
    v_cmpx_lt_i32 vcc, 0, v48
    v_add_u32 v24, v24, v32
    v_lshl_add_u32 v5, v24, 1, v57
    ds_write_b16 v5, v40
    v_lshrrev_b32 v6, 1, v24
    v_lshl_add_u32 v6, v6, 2, v76
    v_and_b32 v7, 1, v24
    v_mad_u32_u24 v6, v7, s58, v6
    ds_write_b32 v6, v16
    v_cmpx_lt_i32 vcc, 1, v48
    v_add_u32 v25, v25, v33
    v_lshl_add_u32 v5, v25, 1, v57
    ds_write_b16 v5, v41
    v_lshrrev_b32 v6, 1, v25
    v_lshl_add_u32 v6, v6, 2, v76
    v_and_b32 v7, 1, v25
    v_mad_u32_u24 v6, v7, s58, v6
    ds_write_b32 v6, v17
    v_cmpx_lt_i32 vcc, 2, v48
    v_add_u32 v26, v26, v34
    v_lshl_add_u32 v5, v26, 1, v57
    ds_write_b16 v5, v42
    v_lshrrev_b32 v6, 1, v26
    v_lshl_add_u32 v6, v6, 2, v76
    v_and_b32 v7, 1, v26
    v_mad_u32_u24 v6, v7, s58, v6
    ds_write_b32 v6, v18
    v_cmpx_lt_i32 vcc, 3, v48
    v_add_u32 v27, v27, v35
    v_lshl_add_u32 v5, v27, 1, v57
    ds_write_b16 v5, v43
    v_lshrrev_b32 v6, 1, v27
    v_lshl_add_u32 v6, v6, 2, v76
    v_and_b32 v7, 1, v27
    v_mad_u32_u24 v6, v7, s58, v6
    ds_write_b32 v6, v19
    v_cmpx_lt_i32 vcc, 8, v48
    s_cbranch_execz L_l3
    s_waitcnt lgkmcnt(2)
    v_add_u32 v28, v28, v36
    v_lshl_add_u32 v5, v28, 1, v57
    ds_write_b16 v5, v44
    v_lshrrev_b32 v6, 1, v28
    v_lshl_add_u32 v6, v6, 2, v76
    v_and_b32 v7, 1, v28
    v_mad_u32_u24 v6, v7, s58, v6
    ds_write_b32 v6, v20
    v_cmpx_lt_i32 vcc, 9, v48
    s_cbranch_execz L_l3
    v_add_u32 v29, v29, v37
    v_lshl_add_u32 v5, v29, 1, v57
    ds_write_b16 v5, v45
    v_lshrrev_b32 v6, 1, v29
    v_lshl_add_u32 v6, v6, 2, v76
    v_and_b32 v7, 1, v29
    v_mad_u32_u24 v6, v7, s58, v6
    ds_write_b32 v6, v21
    v_cmpx_lt_i32 vcc, 10, v48
    s_cbranch_execz L_l3
    v_add_u32 v30, v30, v38
    v_lshl_add_u32 v5, v30, 1, v57
    ds_write_b16 v5, v46
    v_lshrrev_b32 v6, 1, v30
    v_lshl_add_u32 v6, v6, 2, v76
    v_and_b32 v7, 1, v30
    v_mad_u32_u24 v6, v7, s58, v6
    ds_write_b32 v6, v22
    v_cmpx_lt_i32 vcc, 11, v48
    s_cbranch_execz L_l3
    v_add_u32 v31, v31, v39
    v_lshl_add_u32 v5, v31, 1, v57
    ds_write_b16 v5, v47
    v_lshrrev_b32 v6, 1, v31
    v_lshl_add_u32 v6, v6, 2, v76
    v_and_b32 v7, 1, v31
    v_mad_u32_u24 v6, v7, s58, v6
    ds_write_b32 v6, v23
L_l3:
    s_mov_b64 exec, -1
    ds_add_u32 v126, v127 offset:16
    v_lshrrev_b32 v5, 5, v0
    v_mad_u32_u24 v13, v5, s58, v76
    v_add_u32 v13, s60, v13
    v_lshl_add_u32 v14, v5, 1, v57
    v_and_b32 v5, 28, v0
    v_add3_u32 v14, v14, v5, s60
    s_mov_b32 s65, 201487744
    s_mov_b32 s64, 0
    s_mov_b32 s59, 0
Lw_11:
    ds_read_b32 v4, v3 offset:16
    s_waitcnt lgkmcnt(0)
    v_cmp_gt_u32 vcc, 8, v4
    s_cbranch_vccz Lk_12
    s_add_u32 s59, s59, 1
    s_cmp_lt_u32 s59, 4194304
    s_cbranch_scc1 Lw_11
    s_branch L_end
Lk_12:
    s_setprio 1
    s_cmp_lt_u32 s4, 4
    s_cbranch_scc1 L_old
    s_setprio 2
L_old:
    ds_read_b128 v[96:99], v13 offset:0
    ds_read_b128 v[100:103], v13 offset:16
    ds_read_u16 v1, v14
    ds_read_b128 v[80:83], v13 offset:32
    ds_read_b128 v[84:87], v13 offset:48
    s_waitcnt lgkmcnt(3)
L_p0:
    s_cmp_ge_u32 s67, 4
    s_cbranch_scc1 L_p4
    s_cmp_gt_u32 s67, 1
    s_cbranch_scc1 Lps_13
    v_add_u32 v97, v97, v2
    buffer_load_dwordx4 v[20:23], v97, s[8:11], 0 offen
Lps_13:
    s_cmp_gt_u32 s67, 2
    s_cbranch_scc1 Lps_14
    v_add_u32 v98, v98, v2
    buffer_load_dwordx4 v[24:27], v98, s[8:11], 0 offen
Lps_14:
    s_cmp_gt_u32 s67, 3
    s_cbranch_scc1 Lps_15
    v_add_u32 v99, v99, v2
    buffer_load_dwordx4 v[28:31], v99, s[8:11], 0 offen
Lps_15:
L_p4:
    s_cmp_gt_u32 s67, 4
    s_cbranch_scc1 Lps_16
    v_add_u32 v100, v100, v2
    buffer_load_dwordx4 v[32:35], v100, s[8:11], 0 offen
Lps_16:
    s_cmp_gt_u32 s67, 5
    s_cbranch_scc1 Lps_17
    v_add_u32 v101, v101, v2
    buffer_load_dwordx4 v[36:39], v101, s[8:11], 0 offen
Lps_17:
    s_cmp_gt_u32 s67, 6
    s_cbranch_scc1 Lps_18
    v_add_u32 v102, v102, v2
    buffer_load_dwordx4 v[40:43], v102, s[8:11], 0 offen
Lps_18:
    s_cmp_gt_u32 s67, 7
    s_cbranch_scc1 Lps_19
    v_add_u32 v103, v103, v2
    buffer_load_dwordx4 v[44:47], v103, s[8:11], 0 offen
Lps_19:
    s_cmp_eq_u32 s66, 0
    s_cbranch_scc1 L_drain
L_gl:
    s_waitcnt lgkmcnt(1)
    v_perm_b32 v6, v1, v1, v10
    v_perm_b32 v7, v1, v1, v11
    ds_read_u16 v1, v14 offset:32
    s_waitcnt vmcnt(6)
    v_lshl_add_u64 v[4:5], v[80:81], 0, v[124:125]
    s_sub_u32 s62, s62, 2
    s_cbranch_scc1 Lfs_0
    v_mfma_f32_4x4x4_16b_bf16 v[88:91], v[6:7], v[16:17], v[88:91] cbsz:3 abid:0
    v_mfma_f32_4x4x4_16b_bf16 v[92:95], v[6:7], v[18:19], v[92:95] cbsz:3 abid:0
    buffer_load_dwordx4 v[16:19], v4, s[8:11], 0 offen
    v_mfma_f32_4x4x4_16b_bf16 v[88:91], v[6:7], v[20:21], v[88:91] cbsz:3 abid:1
    v_mfma_f32_4x4x4_16b_bf16 v[92:95], v[6:7], v[22:23], v[92:95] cbsz:3 abid:1
    buffer_load_dwordx4 v[20:23], v5, s[8:11], 0 offen
Lbs_0:
    s_waitcnt vmcnt(6)
    v_lshl_add_u64 v[4:5], v[82:83], 0, v[124:125]
    s_sub_u32 s62, s62, 2
    s_cbranch_scc1 Lfs_2
    v_mfma_f32_4x4x4_16b_bf16 v[88:91], v[6:7], v[24:25], v[88:91] cbsz:3 abid:2
    v_mfma_f32_4x4x4_16b_bf16 v[92:95], v[6:7], v[26:27], v[92:95] cbsz:3 abid:2
    buffer_load_dwordx4 v[24:27], v4, s[8:11], 0 offen
    v_mfma_f32_4x4x4_16b_bf16 v[88:91], v[6:7], v[28:29], v[88:91] cbsz:3 abid:3
    v_mfma_f32_4x4x4_16b_bf16 v[92:95], v[6:7], v[30:31], v[92:95] cbsz:3 abid:3
    buffer_load_dwordx4 v[28:31], v5, s[8:11], 0 offen
Lbs_2:
    ds_read_b128 v[80:83], v13 offset:64
    s_waitcnt vmcnt(6) lgkmcnt(2)
    v_lshl_add_u64 v[4:5], v[84:85], 0, v[124:125]
    s_sub_u32 s62, s62, 2
    s_cbranch_scc1 Lfs_4
    v_mfma_f32_4x4x4_16b_bf16 v[88:91], v[6:7], v[32:33], v[88:91] cbsz:3 abid:4
    v_mfma_f32_4x4x4_16b_bf16 v[92:95], v[6:7], v[34:35], v[92:95] cbsz:3 abid:4
    buffer_load_dwordx4 v[32:35], v4, s[8:11], 0 offen
    v_mfma_f32_4x4x4_16b_bf16 v[88:91], v[6:7], v[36:37], v[88:91] cbsz:3 abid:5
    v_mfma_f32_4x4x4_16b_bf16 v[92:95], v[6:7], v[38:39], v[92:95] cbsz:3 abid:5
    buffer_load_dwordx4 v[36:39], v5, s[8:11], 0 offen
Lbs_4:
    s_waitcnt vmcnt(6)
    v_lshl_add_u64 v[4:5], v[86:87], 0, v[124:125]
    s_sub_u32 s62, s62, 2
    s_cbranch_scc1 Lfs_6
    v_mfma_f32_4x4x4_16b_bf16 v[88:91], v[6:7], v[40:41], v[88:91] cbsz:3 abid:6
    v_mfma_f32_4x4x4_16b_bf16 v[92:95], v[6:7], v[42:43], v[92:95] cbsz:3 abid:6
    buffer_load_dwordx4 v[40:43], v4, s[8:11], 0 offen
    v_mfma_f32_4x4x4_16b_bf16 v[88:91], v[6:7], v[44:45], v[88:91] cbsz:3 abid:7
    v_mfma_f32_4x4x4_16b_bf16 v[92:95], v[6:7], v[46:47], v[92:95] cbsz:3 abid:7
    buffer_load_dwordx4 v[44:47], v5, s[8:11], 0 offen
Lbs_6:
    ds_read_b128 v[84:87], v13 offset:80
    v_add_u32 v13, 32, v13
    v_add_u32 v14, 32, v14
    s_sub_u32 s66, s66, 1
    s_cmp_eq_u32 s66, 3
    s_cbranch_scc0 L_nf
    s_setprio 1
L_nf:
    s_cmp_lg_u32 s66, 0
    s_cbranch_scc1 L_gl
L_drain:
    s_waitcnt lgkmcnt(0)
    v_perm_b32 v6, v1, v1, v10
    v_perm_b32 v7, v1, v1, v11
    ds_read_u16 v1, v14 offset:32
    s_waitcnt vmcnt(7)
    v_mfma_f32_4x4x4_16b_bf16 v[88:91], v[6:7], v[16:17], v[88:91] cbsz:3 abid:0
    v_mfma_f32_4x4x4_16b_bf16 v[92:95], v[6:7], v[18:19], v[92:95] cbsz:3 abid:0
    s_sub_u32 s62, s62, 1
    s_cbranch_scc1 Lfd_0
Lbd_0:
    s_waitcnt vmcnt(6)
    v_mfma_f32_4x4x4_16b_bf16 v[88:91], v[6:7], v[20:21], v[88:91] cbsz:3 abid:1
    v_mfma_f32_4x4x4_16b_bf16 v[92:95], v[6:7], v[22:23], v[92:95] cbsz:3 abid:1
    s_sub_u32 s62, s62, 1
    s_cbranch_scc1 Lfd_1
Lbd_1:
    s_waitcnt vmcnt(5)
    v_mfma_f32_4x4x4_16b_bf16 v[88:91], v[6:7], v[24:25], v[88:91] cbsz:3 abid:2
    v_mfma_f32_4x4x4_16b_bf16 v[92:95], v[6:7], v[26:27], v[92:95] cbsz:3 abid:2
    s_sub_u32 s62, s62, 1
    s_cbranch_scc1 Lfd_2
Lbd_2:
    s_waitcnt vmcnt(4)
    v_mfma_f32_4x4x4_16b_bf16 v[88:91], v[6:7], v[28:29], v[88:91] cbsz:3 abid:3
    v_mfma_f32_4x4x4_16b_bf16 v[92:95], v[6:7], v[30:31], v[92:95] cbsz:3 abid:3
    s_sub_u32 s62, s62, 1
    s_cbranch_scc1 Lfd_3
Lbd_3:
    s_waitcnt vmcnt(3)
    v_mfma_f32_4x4x4_16b_bf16 v[88:91], v[6:7], v[32:33], v[88:91] cbsz:3 abid:4
    v_mfma_f32_4x4x4_16b_bf16 v[92:95], v[6:7], v[34:35], v[92:95] cbsz:3 abid:4
    s_sub_u32 s62, s62, 1
    s_cbranch_scc1 Lfd_4
Lbd_4:
    s_waitcnt vmcnt(2)
    v_mfma_f32_4x4x4_16b_bf16 v[88:91], v[6:7], v[36:37], v[88:91] cbsz:3 abid:5
    v_mfma_f32_4x4x4_16b_bf16 v[92:95], v[6:7], v[38:39], v[92:95] cbsz:3 abid:5
    s_sub_u32 s62, s62, 1
    s_cbranch_scc1 Lfd_5
Lbd_5:
    s_waitcnt vmcnt(1)
    v_mfma_f32_4x4x4_16b_bf16 v[88:91], v[6:7], v[40:41], v[88:91] cbsz:3 abid:6
    v_mfma_f32_4x4x4_16b_bf16 v[92:95], v[6:7], v[42:43], v[92:95] cbsz:3 abid:6
    s_sub_u32 s62, s62, 1
    s_cbranch_scc1 Lfd_6
Lbd_6:
    s_waitcnt vmcnt(0)
    v_mfma_f32_4x4x4_16b_bf16 v[88:91], v[6:7], v[44:45], v[88:91] cbsz:3 abid:7
    v_mfma_f32_4x4x4_16b_bf16 v[92:95], v[6:7], v[46:47], v[92:95] cbsz:3 abid:7
    s_nop 1
    s_call_b64 s[68:69], L_flush
L_gdone:
    s_endpgm
Lfs_0:
    s_add_u32 s62, s62, 2
    v_mfma_f32_4x4x4_16b_bf16 v[88:91], v[6:7], v[16:17], v[88:91] cbsz:3 abid:0
    v_mfma_f32_4x4x4_16b_bf16 v[92:95], v[6:7], v[18:19], v[92:95] cbsz:3 abid:0
    buffer_load_dwordx4 v[16:19], v4, s[8:11], 0 offen
    s_sub_u32 s62, s62, 1
    s_cbranch_scc0 Lsk_20
    s_call_b64 s[68:69], L_flush
Lsk_20:
    v_mfma_f32_4x4x4_16b_bf16 v[88:91], v[6:7], v[20:21], v[88:91] cbsz:3 abid:1
    v_mfma_f32_4x4x4_16b_bf16 v[92:95], v[6:7], v[22:23], v[92:95] cbsz:3 abid:1
    buffer_load_dwordx4 v[20:23], v5, s[8:11], 0 offen
    s_sub_u32 s62, s62, 1
    s_cbranch_scc0 Lbs_0
    s_call_b64 s[68:69], L_flush
    s_branch Lbs_0
Lfs_2:
    s_add_u32 s62, s62, 2
    v_mfma_f32_4x4x4_16b_bf16 v[88:91], v[6:7], v[24:25], v[88:91] cbsz:3 abid:2
    v_mfma_f32_4x4x4_16b_bf16 v[92:95], v[6:7], v[26:27], v[92:95] cbsz:3 abid:2
    buffer_load_dwordx4 v[24:27], v4, s[8:11], 0 offen
    s_sub_u32 s62, s62, 1
    s_cbranch_scc0 Lsk_22
    s_call_b64 s[68:69], L_flush
Lsk_22:
    v_mfma_f32_4x4x4_16b_bf16 v[88:91], v[6:7], v[28:29], v[88:91] cbsz:3 abid:3
    v_mfma_f32_4x4x4_16b_bf16 v[92:95], v[6:7], v[30:31], v[92:95] cbsz:3 abid:3
    buffer_load_dwordx4 v[28:31], v5, s[8:11], 0 offen
    s_sub_u32 s62, s62, 1
    s_cbranch_scc0 Lbs_2
    s_call_b64 s[68:69], L_flush
    s_branch Lbs_2
Lfs_4:
    s_add_u32 s62, s62, 2
    v_mfma_f32_4x4x4_16b_bf16 v[88:91], v[6:7], v[32:33], v[88:91] cbsz:3 abid:4
    v_mfma_f32_4x4x4_16b_bf16 v[92:95], v[6:7], v[34:35], v[92:95] cbsz:3 abid:4
    buffer_load_dwordx4 v[32:35], v4, s[8:11], 0 offen
    s_sub_u32 s62, s62, 1
    s_cbranch_scc0 Lsk_24
    s_call_b64 s[68:69], L_flush
Lsk_24:
    v_mfma_f32_4x4x4_16b_bf16 v[88:91], v[6:7], v[36:37], v[88:91] cbsz:3 abid:5
    v_mfma_f32_4x4x4_16b_bf16 v[92:95], v[6:7], v[38:39], v[92:95] cbsz:3 abid:5
    buffer_load_dwordx4 v[36:39], v5, s[8:11], 0 offen
    s_sub_u32 s62, s62, 1
    s_cbranch_scc0 Lbs_4
    s_call_b64 s[68:69], L_flush
    s_branch Lbs_4
Lfs_6:
    s_add_u32 s62, s62, 2
    v_mfma_f32_4x4x4_16b_bf16 v[88:91], v[6:7], v[40:41], v[88:91] cbsz:3 abid:6
    v_mfma_f32_4x4x4_16b_bf16 v[92:95], v[6:7], v[42:43], v[92:95] cbsz:3 abid:6
    buffer_load_dwordx4 v[40:43], v4, s[8:11], 0 offen
    s_sub_u32 s62, s62, 1
    s_cbranch_scc0 Lsk_26
    s_call_b64 s[68:69], L_flush
Lsk_26:
    v_mfma_f32_4x4x4_16b_bf16 v[88:91], v[6:7], v[44:45], v[88:91] cbsz:3 abid:7
    v_mfma_f32_4x4x4_16b_bf16 v[92:95], v[6:7], v[46:47], v[92:95] cbsz:3 abid:7
    buffer_load_dwordx4 v[44:47], v5, s[8:11], 0 offen
    s_sub_u32 s62, s62, 1
    s_cbranch_scc0 Lbs_6
    s_call_b64 s[68:69], L_flush
    s_branch Lbs_6
Lfd_0:
    s_call_b64 s[68:69], L_flush
    s_branch Lbd_0
Lfd_1:
    s_call_b64 s[68:69], L_flush
    s_branch Lbd_1
Lfd_2:
    s_call_b64 s[68:69], L_flush
    s_branch Lbd_2
Lfd_3:
    s_call_b64 s[68:69], L_flush
    s_branch Lbd_3
Lfd_4:
    s_call_b64 s[68:69], L_flush
    s_branch Lbd_4
Lfd_5:
    s_call_b64 s[68:69], L_flush
    s_branch Lbd_5
Lfd_6:
    s_call_b64 s[68:69], L_flush
    s_branch Lbd_6
L_flush:
    s_and_b32 s101, s65, 0xffffff
    v_add_u32 v96, s101, v15
    v_permlane32_swap_b32 v88, v92
    v_permlane32_swap_b32 v89, v93
    v_permlane32_swap_b32 v90, v94
    v_permlane32_swap_b32 v91, v95
    s_lshr_b32 s101, s65, 24
    v_pk_add_f32 v[98:99], v[88:89], v[92:93]
    v_pk_add_f32 v[100:101], v[90:91], v[94:95]
    s_add_u32 s63, s63, 1
    v_pk_mul_f32 v[98:99], v[98:99], s[64:65] op_sel_hi:[1,0]
    v_pk_mul_f32 v[100:101], v[100:101], s[64:65] op_sel_hi:[1,0]
    v_add_u32 v97, s101, v126
    v_cvt_pk_bf16_f32 v98, v98, v99
    v_cvt_pk_bf16_f32 v99, v100, v101
    ds_write_b64 v96, v[98:99]
    ds_add_u32 v97, v127 offset:36
    v_mov_b64 v[88:89], 0
    v_mov_b64 v[90:91], 0
    v_mov_b64 v[92:93], 0
    v_mov_b64 v[94:95], 0
    v_readlane_b32 s62, v12, s63
    v_readlane_b32 s65, v9, s63
    v_readlane_b32 s64, v8, s63
    s_setpc_b64 s[68:69]
L_preA:
    s_setprio 2
    s_mul_i32 s5, s6, 40
    v_mov_b32 v3, 160064
    s_mov_b32 s10, 5120000
    s_mov_b32 s11, 0x20000
    s_add_u32 s16, s56, 0
    s_addc_u32 s17, s57, 0
    s_mov_b32 s18, 4194304
    s_mov_b32 s19, 0x20000
    v_and_b32 v6, 32, v0
    v_lshl_add_u32 v5, v6, 7, v2
    v_lshl_add_u32 v6, v6, 6, v2
    s_add_u32 s58, s3, s5
    s_mul_i32 s59, s3, 1056
    s_add_u32 m0, s59, 84480
    s_lshl_b32 s58, s58, 9
    buffer_load_dwordx4 v5, s[8:11], s58 offen lds
    s_add_u32 m0, s59, 92928
    s_add_u32 s58, s58, 8192
    buffer_load_dwordx4 v5, s[8:11], s58 offen lds
    s_cmp_ge_u32 s3, 4
    s_cbranch_scc1 L_xa2
    s_add_u32 m0, s59, 101376
    s_add_u32 s58, s58, 8192
    buffer_load_dwordx4 v6, s[8:11], s58 offen lds
L_xa2:
    v_and_b32 v4, 7, v0
    v_mul_u32_u24 v1, 1056, v4
    v_and_b32 v4, 8, v0
    v_lshl_add_u32 v1, v4, 6, v1
    v_and_b32 v4, 48, v0
    v_add_u32 v1, v4, v1
    v_add_u32 v12, 84480, v1
    s_mov_b64 s[20:21], s[52:53]
    s_mov_b32 s22, 5120000
    s_mov_b32 s23, 0x20000
    v_lshlrev_b32 v14, 4, v0
    s_lshl_b32 s61, s3, 6
    s_add_u32 s61, s61, 105600
    v_add_u32 v13, s61, v1
    s_lshl_b32 s100, s3, 14
    s_add_u32 s100, s100, 655360
    s_waitcnt lgkmcnt(0)
    v_lshl_add_u32 v104, s32, 9, v2
    v_lshl_add_u32 v105, s33, 9, v2
    v_lshl_add_u32 v106, s34, 9, v2
    v_lshl_add_u32 v107, s35, 9, v2
    v_lshl_add_u32 v108, s36, 9, v2
    v_lshl_add_u32 v109, s37, 9, v2
    v_lshl_add_u32 v110, s38, 9, v2
    v_lshl_add_u32 v111, s39, 9, v2
    v_lshl_add_u32 v112, s64, 9, v2
    v_lshl_add_u32 v113, s65, 9, v2
    s_mov_b32 exec_lo, 0
    v_lshl_add_u32 v104, s40, 9, v2
    v_lshl_add_u32 v105, s41, 9, v2
    v_lshl_add_u32 v106, s42, 9, v2
    v_lshl_add_u32 v107, s43, 9, v2
    v_lshl_add_u32 v108, s44, 9, v2
    v_lshl_add_u32 v109, s45, 9, v2
    v_lshl_add_u32 v110, s46, 9, v2
    v_lshl_add_u32 v111, s47, 9, v2
    v_lshl_add_u32 v112, s66, 9, v2
    v_lshl_add_u32 v113, s67, 9, v2
    s_mov_b64 exec, -1
    s_mul_i32 s67, s3, 2112
    s_mul_i32 s66, s3, 8448
    s_add_u32 m0, s66, 0
    s_waitcnt vmcnt(1)
    buffer_load_dwordx4 v104, s[8:11], 0 offen lds
    s_add_u32 m0, s66, 1056
    s_waitcnt vmcnt(1)
    buffer_load_dwordx4 v105, s[8:11], 0 offen lds
    v_and_b32 v4, 3, v0
    v_mov_b32 v5, 0x0c0c0c0c
    v_mov_b32 v6, 0x0c0c0302
    v_mov_b32 v7, 0x03020c0c
    v_cmp_eq_u32 s[58:59], 0, v4
    v_cmp_eq_u32 s[60:61], 2, v4
    v_cmp_eq_u32 vcc, 1, v4
    v_cndmask_b32 v8, v5, v6, s[58:59]
    v_cndmask_b32 v9, v5, v6, s[60:61]
    v_cndmask_b32 v8, v8, v7, vcc
    v_cmp_eq_u32 vcc, 3, v4
    s_nop 1
    v_cndmask_b32 v9, v9, v7, vcc
    v_mov_b32 v10, v8
    v_mov_b32 v11, v9
    v_and_b32 v8, 0xfdfdfdfd, v8
    v_and_b32 v9, 0xfdfdfdfd, v9
    s_add_u32 m0, s66, 2112
    s_waitcnt vmcnt(1)
    buffer_load_dwordx4 v106, s[8:11], 0 offen lds
    s_mov_b64 exec, 1
    v_mov_b32 v4, 1
    ds_add_u32 v3, v4 offset:0
    s_mov_b64 exec, -1
    s_add_u32 m0, s66, 3168
    s_waitcnt vmcnt(1)
    buffer_load_dwordx4 v107, s[8:11], 0 offen lds
    s_add_u32 m0, s66, 4224
    s_waitcnt vmcnt(1)
    buffer_load_dwordx4 v108, s[8:11], 0 offen lds
    s_add_u32 m0, s66, 5280
    s_waitcnt vmcnt(1)
    buffer_load_dwordx4 v109, s[8:11], 0 offen lds
    s_add_u32 m0, s66, 6336
    s_waitcnt vmcnt(1)
    buffer_load_dwordx4 v110, s[8:11], 0 offen lds
    s_mov_b64 exec, 1
    v_mov_b32 v4, 1
    ds_add_u32 v3, v4 offset:60
    s_mov_b64 exec, -1
    s_add_u32 m0, s66, 7392
    s_waitcnt vmcnt(1)
    buffer_load_dwordx4 v111, s[8:11], 0 offen lds
    s_waitcnt vmcnt(1)
    ds_read_b32 v4, v3 offset:52
    s_add_u32 m0, s67, 67584
    s_waitcnt vmcnt(1)
    buffer_load_dwordx4 v112, s[8:11], 0 offen lds
    s_waitcnt lgkmcnt(0)
    v_cmp_gt_u32 vcc, 8, v4
    s_cbranch_vccz L_eu9
    s_waitcnt vmcnt(1)
    ds_read_b32 v4, v3 offset:52
    s_add_u32 m0, s67, 68640
    s_waitcnt vmcnt(1)
    buffer_load_dwordx4 v113, s[8:11], 0 offen lds
    s_mov_b32 s59, 0
Lw_28:
    ds_read_b32 v4, v3 offset:52
    s_waitcnt lgkmcnt(0)
    v_cmp_gt_u32 vcc, 8, v4
    s_cbranch_vccz Lk_29
    s_sleep 1
    s_add_u32 s59, s59, 1
    s_cmp_lt_u32 s59, 4194304
    s_cbranch_scc1 Lw_28
    s_branch L_end
Lk_29:
    s_branch L_eu10
L_eu9:
    s_add_u32 m0, s67, 68640
    s_waitcnt vmcnt(63)
    buffer_load_dwordx4 v113, s[8:11], 0 offen lds
L_eu10:
    s_setprio 3
    buffer_load_dwordx4 v[16:19], v14, s[16:19], s100 offen offset:0 sc1
    buffer_load_dwordx4 v[20:23], v14, s[16:19], s100 offen offset:1024 sc1
    buffer_load_dwordx4 v[24:27], v14, s[16:19], s100 offen offset:2048 sc1
    buffer_load_dwordx4 v[28:31], v14, s[16:19], s100 offen offset:3072 sc1
    s_add_u32 s100, s100, 4096
    buffer_load_dwordx4 v[32:35], v14, s[16:19], s100 offen offset:0 sc1
    buffer_load_dwordx4 v[36:39], v14, s[16:19], s100 offen offset:1024 sc1
    buffer_load_dwordx4 v[40:43], v14, s[16:19], s100 offen offset:2048 sc1
    buffer_load_dwordx4 v[44:47], v14, s[16:19], s100 offen offset:3072 sc1
    s_add_u32 s100, s100, 4096
    buffer_load_dwordx4 v[48:51], v14, s[16:19], s100 offen offset:0 sc1
    buffer_load_dwordx4 v[52:55], v14, s[16:19], s100 offen offset:1024 sc1
    buffer_load_dwordx4 v[56:59], v14, s[16:19], s100 offen offset:2048 sc1
    buffer_load_dwordx4 v[60:63], v14, s[16:19], s100 offen offset:3072 sc1
    s_add_u32 s100, s100, 4096
    buffer_load_dwordx4 v[64:67], v14, s[16:19], s100 offen offset:0 sc1
    buffer_load_dwordx4 v[68:71], v14, s[16:19], s100 offen offset:1024 sc1
    buffer_load_dwordx4 v[72:75], v14, s[16:19], s100 offen offset:2048 sc1
    buffer_load_dwordx4 v[76:79], v14, s[16:19], s100 offen offset:3072 sc1
    s_setprio 0
    s_mov_b32 s59, 0
Lw_30:
    ds_read_b32 v4, v3 offset:0
    s_waitcnt lgkmcnt(0)
    v_cmp_gt_u32 vcc, 8, v4
    s_cbranch_vccz Lk_31
    s_add_u32 s59, s59, 1
    s_cmp_lt_u32 s59, 4194304
    s_cbranch_scc1 Lw_30
    s_branch L_end
Lk_31:
    ds_read_b128 v[80:83], v12 offset:0
    ds_read_b128 v[84:87], v12 offset:8448
    ds_read_b128 v[88:91], v12 offset:16896
    ds_read_b128 v[92:95], v12 offset:64
    ds_read_b128 v[96:99], v12 offset:8512
    ds_read_b128 v[100:103], v12 offset:16960
    s_waitcnt vmcnt(14) lgkmcnt(3)
    v_mfma_f32_16x16x32_bf16 v[104:107], v[16:19], v[80:83], 0
    v_mfma_f32_16x16x32_bf16 v[108:111], v[20:23], v[80:83], 0
    v_mfma_f32_16x16x32_bf16 v[112:115], v[16:19], v[84:87], 0
    v_mfma_f32_16x16x32_bf16 v[116:119], v[20:23], v[84:87], 0
    v_mfma_f32_16x16x32_bf16 v[120:123], v[16:19], v[88:91], 0
    v_mfma_f32_16x16x32_bf16 v[124:127], v[20:23], v[88:91], 0
    ds_read_b128 v[80:83], v12 offset:128
    ds_read_b128 v[84:87], v12 offset:8576
    ds_read_b128 v[88:91], v12 offset:17024
    s_waitcnt vmcnt(12) lgkmcnt(3)
    v_mfma_f32_16x16x32_bf16 v[104:107], v[24:27], v[92:95], v[104:107]
    v_mfma_f32_16x16x32_bf16 v[108:111], v[28:31], v[92:95], v[108:111]
    v_mfma_f32_16x16x32_bf16 v[112:115], v[24:27], v[96:99], v[112:115]
    v_mfma_f32_16x16x32_bf16 v[116:119], v[28:31], v[96:99], v[116:119]
    v_mfma_f32_16x16x32_bf16 v[120:123], v[24:27], v[100:103], v[120:123]
    v_mfma_f32_16x16x32_bf16 v[124:127], v[28:31], v[100:103], v[124:127]
    ds_read_b128 v[92:95], v12 offset:192
    ds_read_b128 v[96:99], v12 offset:8640
    ds_read_b128 v[100:103], v12 offset:17088
    s_waitcnt vmcnt(10) lgkmcnt(3)
    v_mfma_f32_16x16x32_bf16 v[104:107], v[32:35], v[80:83], v[104:107]
    v_mfma_f32_16x16x32_bf16 v[108:111], v[36:39], v[80:83], v[108:111]
    v_mfma_f32_16x16x32_bf16 v[112:115], v[32:35], v[84:87], v[112:115]
    v_mfma_f32_16x16x32_bf16 v[116:119], v[36:39], v[84:87], v[116:119]
    v_mfma_f32_16x16x32_bf16 v[120:123], v[32:35], v[88:91], v[120:123]
    v_mfma_f32_16x16x32_bf16 v[124:127], v[36:39], v[88:91], v[124:127]
    ds_read_b128 v[80:83], v12 offset:256
    ds_read_b128 v[84:87], v12 offset:8704
    ds_read_b128 v[88:91], v12 offset:17152
    s_waitcnt vmcnt(8) lgkmcnt(3)
    v_mfma_f32_16x16x32_bf16 v[104:107], v[40:43], v[92:95], v[104:107]
    v_mfma_f32_16x16x32_bf16 v[108:111], v[44:47], v[92:95], v[108:111]
    v_mfma_f32_16x16x32_bf16 v[112:115], v[40:43], v[96:99], v[112:115]
    v_mfma_f32_16x16x32_bf16 v[116:119], v[44:47], v[96:99], v[116:119]
    v_mfma_f32_16x16x32_bf16 v[120:123], v[40:43], v[100:103], v[120:123]
    v_mfma_f32_16x16x32_bf16 v[124:127], v[44:47], v[100:103], v[124:127]
    ds_read_b128 v[92:95], v12 offset:320
    ds_read_b128 v[96:99], v12 offset:8768
    ds_read_b128 v[100:103], v12 offset:17216
    s_waitcnt vmcnt(6) lgkmcnt(3)
    v_mfma_f32_16x16x32_bf16 v[104:107], v[48:51], v[80:83], v[104:107]
    v_mfma_f32_16x16x32_bf16 v[108:111], v[52:55], v[80:83], v[108:111]
    v_mfma_f32_16x16x32_bf16 v[112:115], v[48:51], v[84:87], v[112:115]
    v_mfma_f32_16x16x32_bf16 v[116:119], v[52:55], v[84:87], v[116:119]
    v_mfma_f32_16x16x32_bf16 v[120:123], v[48:51], v[88:91], v[120:123]
    v_mfma_f32_16x16x32_bf16 v[124:127], v[52:55], v[88:91], v[124:127]
    ds_read_b128 v[80:83], v12 offset:384
    ds_read_b128 v[84:87], v12 offset:8832
    ds_read_b128 v[88:91], v12 offset:17280
    s_waitcnt vmcnt(4) lgkmcnt(3)
    v_mfma_f32_16x16x32_bf16 v[104:107], v[56:59], v[92:95], v[104:107]
    v_mfma_f32_16x16x32_bf16 v[108:111], v[60:63], v[92:95], v[108:111]
    v_mfma_f32_16x16x32_bf16 v[112:115], v[56:59], v[96:99], v[112:115]
    v_mfma_f32_16x16x32_bf16 v[116:119], v[60:63], v[96:99], v[116:119]
    v_mfma_f32_16x16x32_bf16 v[120:123], v[56:59], v[100:103], v[120:123]
    v_mfma_f32_16x16x32_bf16 v[124:127], v[60:63], v[100:103], v[124:127]
    ds_read_b128 v[92:95], v12 offset:448
    ds_read_b128 v[96:99], v12 offset:8896
    ds_read_b128 v[100:103], v12 offset:17344
    s_waitcnt vmcnt(2) lgkmcnt(3)
    v_mfma_f32_16x16x32_bf16 v[104:107], v[64:67], v[80:83], v[104:107]
    v_mfma_f32_16x16x32_bf16 v[108:111], v[68:71], v[80:83], v[108:111]
    v_mfma_f32_16x16x32_bf16 v[112:115], v[64:67], v[84:87], v[112:115]
    v_mfma_f32_16x16x32_bf16 v[116:119], v[68:71], v[84:87], v[116:119]
    v_mfma_f32_16x16x32_bf16 v[120:123], v[64:67], v[88:91], v[120:123]
    v_mfma_f32_16x16x32_bf16 v[124:127], v[68:71], v[88:91], v[124:127]
    s_waitcnt vmcnt(0) lgkmcnt(0)
    v_mfma_f32_16x16x32_bf16 v[104:107], v[72:75], v[92:95], v[104:107]
    v_mfma_f32_16x16x32_bf16 v[108:111], v[76:79], v[92:95], v[108:111]
    v_mfma_f32_16x16x32_bf16 v[112:115], v[72:75], v[96:99], v[112:115]
    v_mfma_f32_16x16x32_bf16 v[116:119], v[76:79], v[96:99], v[116:119]
    v_mfma_f32_16x16x32_bf16 v[120:123], v[72:75], v[100:103], v[120:123]
    v_mfma_f32_16x16x32_bf16 v[124:127], v[76:79], v[100:103], v[124:127]
    s_nop 3
    v_cvt_pk_bf16_f32 v80, v104, v105
    v_cvt_pk_bf16_f32 v81, v106, v107
    v_cvt_pk_bf16_f32 v82, v108, v109
    v_cvt_pk_bf16_f32 v83, v110, v111
    ds_write_b128 v13, v[80:83] offset:0
    v_cvt_pk_bf16_f32 v84, v112, v113
    v_cvt_pk_bf16_f32 v85, v114, v115
    v_cvt_pk_bf16_f32 v86, v116, v117
    v_cvt_pk_bf16_f32 v87, v118, v119
    ds_write_b128 v13, v[84:87] offset:8448
    v_cvt_pk_bf16_f32 v88, v120, v121
    v_cvt_pk_bf16_f32 v89, v122, v123
    v_cvt_pk_bf16_f32 v90, v124, v125
    v_cvt_pk_bf16_f32 v91, v126, v127
    ds_write_b128 v13, v[88:91] offset:16896
    s_mov_b64 exec, 1
    v_mov_b32 v4, 1
    ds_add_u32 v3, v4 offset:20
    s_mov_b64 exec, -1
    s_setprio 3
    s_add_u32 s100, s100, 118784
    buffer_load_dwordx4 v[16:19], v14, s[16:19], s100 offen offset:0 sc1
    buffer_load_dwordx4 v[20:23], v14, s[16:19], s100 offen offset:1024 sc1
    buffer_load_dwordx4 v[24:27], v14, s[16:19], s100 offen offset:2048 sc1
    buffer_load_dwordx4 v[28:31], v14, s[16:19], s100 offen offset:3072 sc1
    s_add_u32 s100, s100, 4096
    buffer_load_dwordx4 v[32:35], v14, s[16:19], s100 offen offset:0 sc1
    buffer_load_dwordx4 v[36:39], v14, s[16:19], s100 offen offset:1024 sc1
    buffer_load_dwordx4 v[40:43], v14, s[16:19], s100 offen offset:2048 sc1
    buffer_load_dwordx4 v[44:47], v14, s[16:19], s100 offen offset:3072 sc1
    s_add_u32 s100, s100, 4096
    buffer_load_dwordx4 v[48:51], v14, s[16:19], s100 offen offset:0 sc1
    buffer_load_dwordx4 v[52:55], v14, s[16:19], s100 offen offset:1024 sc1
    buffer_load_dwordx4 v[56:59], v14, s[16:19], s100 offen offset:2048 sc1
    buffer_load_dwordx4 v[60:63], v14, s[16:19], s100 offen offset:3072 sc1
    s_add_u32 s100, s100, 4096
    buffer_load_dwordx4 v[64:67], v14, s[16:19], s100 offen offset:0 sc1
    buffer_load_dwordx4 v[68:71], v14, s[16:19], s100 offen offset:1024 sc1
    buffer_load_dwordx4 v[72:75], v14, s[16:19], s100 offen offset:2048 sc1
    buffer_load_dwordx4 v[76:79], v14, s[16:19], s100 offen offset:3072 sc1
    s_setprio 0
    s_mov_b32 s63, s3
L_grp:
    s_mul_i32 s58, s63, 8448
    s_lshr_b32 s59, s63, 2
    s_mul_i32 s59, s59, 8448
    s_and_b32 s60, s63, 1
    s_bfe_u32 s61, s63, 0x10001
    s_cmp_ge_u32 s63, 8
    s_cselect_b32 s61, s60, s61
    s_cselect_b32 s60, 0, s60
    s_mul_i32 s60, s60, 4224
    s_lshl_b32 s61, s61, 9
    s_add_u32 s59, s59, s60
    s_add_u32 s59, s59, s61
    s_add_u32 s59, s59, 105600
    v_add_u32 v12, s58, v1
    v_bfe_u32 v4, v0, 2, 2
    v_mul_u32_u24 v4, 1056, v4
    v_and_b32 v5, 48, v0
    v_add3_u32 v13, v4, v5, s59
    v_lshl_add_u32 v14, v0, 3, s58
    v_lshl_add_u32 v2, v0, 3, s59
    s_cmp_ge_u32 s63, 8
    s_cbranch_scc1 L_grp2
    s_mov_b32 s59, 0
Lw_32:
    ds_read_b32 v4, v3 offset:20
    s_waitcnt lgkmcnt(0)
    v_cmp_gt_u32 vcc, 8, v4
    s_cbranch_vccz Lk_33
    s_sleep 1
    s_add_u32 s59, s59, 1
    s_cmp_lt_u32 s59, 4194304
    s_cbranch_scc1 Lw_32
    s_branch L_end
Lk_33:
L_grp2:
    s_waitcnt lgkmcnt(0)
    ds_read_b128 v[80:83], v12 offset:0
    ds_read_b128 v[84:87], v13 offset:0
    ds_read_b128 v[88:91], v12 offset:64
    ds_read_b128 v[92:95], v13 offset:64
    ds_read_b128 v[96:99], v12 offset:128
    ds_read_b128 v[100:103], v13 offset:128
    ds_read_b128 v[104:107], v12 offset:192
    ds_read_b128 v[108:111], v13 offset:192
    ds_read_b128 v[112:115], v12 offset:256
    ds_read_b128 v[116:119], v13 offset:256
    ds_read_b128 v[120:123], v12 offset:320
    ds_read_b128 v[124:127], v13 offset:320
    s_waitcnt lgkmcnt(10)
    v_mfma_f32_16x16x32_bf16 v[4:7], v[80:83], v[84:87], 0
    ds_read_b128 v[80:83], v12 offset:384
    ds_read_b128 v[84:87], v13 offset:384
    s_waitcnt lgkmcnt(10)
    v_mfma_f32_16x16x32_bf16 v[4:7], v[88:91], v[92:95], v[4:7]
    ds_read_b128 v[88:91], v12 offset:448
    ds_read_b128 v[92:95], v13 offset:448
    s_waitcnt lgkmcnt(10)
    v_mfma_f32_16x16x32_bf16 v[4:7], v[96:99], v[100:103], v[4:7]
    s_waitcnt lgkmcnt(8)
    v_mfma_f32_16x16x32_bf16 v[4:7], v[104:107], v[108:111], v[4:7]
    s_waitcnt lgkmcnt(6)
    v_mfma_f32_16x16x32_bf16 v[4:7], v[112:115], v[116:119], v[4:7]
    s_waitcnt lgkmcnt(4)
    v_mfma_f32_16x16x32_bf16 v[4:7], v[120:123], v[124:127], v[4:7]
    s_waitcnt lgkmcnt(2)
    v_mfma_f32_16x16x32_bf16 v[4:7], v[80:83], v[84:87], v[4:7]
    s_waitcnt lgkmcnt(0)
    v_mfma_f32_16x16x32_bf16 v[4:7], v[88:91], v[92:95], v[4:7]
    ds_read_b64 v[96:97], v14 offset:2112
    ds_read_b64 v[98:99], v14 offset:6336
    ds_read_b64 v[100:101], v14 offset:2624
    ds_read_b64 v[102:103], v14 offset:6848
    ds_read_b64 v[104:105], v14 offset:3168
    ds_read_b64 v[106:107], v14 offset:7392
    ds_read_b64 v[108:109], v14 offset:3680
    ds_read_b64 v[110:111], v14 offset:7904
    ds_read_b64 v[80:81], v14 offset:0
    ds_read_b64 v[82:83], v14 offset:4224
    ds_read_b64 v[84:85], v14 offset:512
    ds_read_b64 v[86:87], v14 offset:4736
    ds_read_b64 v[88:89], v14 offset:1056
    ds_read_b64 v[90:91], v14 offset:5280
    ds_read_b64 v[92:93], v14 offset:1568
    s_waitcnt lgkmcnt(14)
    ds_read_b64 v[94:95], v14 offset:5792
    v_mul_f32 v4, 0x3db8aa3b, v4
    v_mul_f32 v5, 0x3db8aa3b, v5
    v_mul_f32 v6, 0x3db8aa3b, v6
    v_mul_f32 v7, 0x3db8aa3b, v7
    v_exp_f32 v4, v4
    v_exp_f32 v5, v5
    v_exp_f32 v6, v6
    v_exp_f32 v7, v7
    v_add_f32 v12, v4, v5
    v_add_f32 v13, v6, v7
    v_add_f32 v12, v12, v13
    v_add_f32 v12, 0x3089705f, v12
    v_rcp_f32 v12, v12
    s_add_u32 s63, s63, 8
    v_mul_f32 v4, v4, v12
    v_mul_f32 v5, v5, v12
    v_mul_f32 v6, v6, v12
    v_mul_f32 v7, v7, v12
    v_cvt_pk_bf16_f32 v4, v4, v5
    v_cvt_pk_bf16_f32 v6, v6, v7
    v_perm_b32 v112, v4, v4, v8
    v_perm_b32 v113, v4, v4, v9
    v_perm_b32 v114, v4, v4, v10
    v_perm_b32 v115, v4, v4, v11
    v_perm_b32 v116, v6, v6, v8
    v_perm_b32 v117, v6, v6, v9
    v_perm_b32 v118, v6, v6, v10
    v_perm_b32 v119, v6, v6, v11
    s_waitcnt lgkmcnt(0)
    v_mfma_f32_4x4x4_16b_bf16 v[120:123], v[112:113], v[80:81], 0 cbsz:4 abid:0
    v_mfma_f32_4x4x4_16b_bf16 v[124:127], v[112:113], v[82:83], 0 cbsz:4 abid:5
    v_mfma_f32_4x4x4_16b_bf16 v[4:7], v[112:113], v[84:85], 0 cbsz:4 abid:10
    v_mfma_f32_4x4x4_16b_bf16 v[12:15], v[112:113], v[86:87], 0 cbsz:4 abid:15
    v_mfma_f32_4x4x4_16b_bf16 v[120:123], v[114:115], v[88:89], v[120:123] cbsz:4 abid:0
    v_mfma_f32_4x4x4_16b_bf16 v[124:127], v[114:115], v[90:91], v[124:127] cbsz:4 abid:5
    v_mfma_f32_4x4x4_16b_bf16 v[4:7], v[114:115], v[92:93], v[4:7] cbsz:4 abid:10
    v_mfma_f32_4x4x4_16b_bf16 v[12:15], v[114:115], v[94:95], v[12:15] cbsz:4 abid:15
    v_mfma_f32_4x4x4_16b_bf16 v[120:123], v[116:117], v[96:97], v[120:123] cbsz:4 abid:0
    v_mfma_f32_4x4x4_16b_bf16 v[124:127], v[116:117], v[98:99], v[124:127] cbsz:4 abid:5
    v_mfma_f32_4x4x4_16b_bf16 v[4:7], v[116:117], v[100:101], v[4:7] cbsz:4 abid:10
    v_mfma_f32_4x4x4_16b_bf16 v[12:15], v[116:117], v[102:103], v[12:15] cbsz:4 abid:15
    v_mfma_f32_4x4x4_16b_bf16 v[120:123], v[118:119], v[104:105], v[120:123] cbsz:4 abid:0
    v_mfma_f32_4x4x4_16b_bf16 v[124:127], v[118:119], v[106:107], v[124:127] cbsz:4 abid:5
    v_mfma_f32_4x4x4_16b_bf16 v[4:7], v[118:119], v[108:109], v[4:7] cbsz:4 abid:10
    v_mfma_f32_4x4x4_16b_bf16 v[12:15], v[118:119], v[110:111], v[12:15] cbsz:4 abid:15
    s_nop 1
    v_cvt_pk_bf16_f32 v112, v120, v121
    v_cvt_pk_bf16_f32 v113, v122, v123
    ds_write_b64 v2, v[112:113] offset:0
    v_cvt_pk_bf16_f32 v114, v124, v125
    v_cvt_pk_bf16_f32 v115, v126, v127
    ds_write_b64 v2, v[114:115] offset:1056
    v_cvt_pk_bf16_f32 v116, v4, v5
    v_cvt_pk_bf16_f32 v117, v6, v7
    ds_write_b64 v2, v[116:117] offset:2112
    v_cvt_pk_bf16_f32 v118, v12, v13
    v_cvt_pk_bf16_f32 v119, v14, v15
    ds_write_b64 v2, v[118:119] offset:3168
    s_cmp_lt_u32 s63, 10
    s_cbranch_scc1 L_grp
    s_mov_b64 exec, 1
    v_mov_b32 v4, 1
    ds_add_u32 v3, v4 offset:24
    s_mov_b64 exec, -1
    v_add_u32 v12, 105600, v1
    v_lshlrev_b32 v14, 4, v0
    v_and_b32 v6, 15, v0
    v_lshlrev_b32 v6, 2, v6
    v_and_b32 v5, 48, v0
    v_lshl_add_u32 v8, v5, 7, v6
    v_and_b32 v5, 32, v0
    v_lshl_add_u32 v9, v5, 6, v6
    v_and_b32 v5, 16, v0
    v_lshl_add_u32 v9, v5, 22, v9
    s_lshl_b32 s60, s5, 9
    s_lshl_b32 s61, s3, 6
    s_add_u32 s60, s60, s61
    s_mov_b32 s59, 0
Lw_34:
    ds_read_b32 v4, v3 offset:24
    s_waitcnt lgkmcnt(0)
    v_cmp_gt_u32 vcc, 8, v4
    s_cbranch_vccz Lk_35
    s_sleep 1
    s_add_u32 s59, s59, 1
    s_cmp_lt_u32 s59, 4194304
    s_cbranch_scc1 Lw_34
    s_branch L_end
Lk_35:
    ds_read_b128 v[80:83], v12 offset:0
    ds_read_b128 v[84:87], v12 offset:8448
    ds_read_b128 v[88:91], v12 offset:16896
    ds_read_b128 v[92:95], v12 offset:64
    ds_read_b128 v[96:99], v12 offset:8512
    ds_read_b128 v[100:103], v12 offset:16960
    s_waitcnt vmcnt(14) lgkmcnt(3)
    v_mfma_f32_16x16x32_bf16 v[104:107], v[80:83], v[16:19], 0
    v_mfma_f32_16x16x32_bf16 v[108:111], v[80:83], v[20:23], 0
    v_mfma_f32_16x16x32_bf16 v[112:115], v[84:87], v[16:19], 0
    v_mfma_f32_16x16x32_bf16 v[116:119], v[84:87], v[20:23], 0
    v_mfma_f32_16x16x32_bf16 v[120:123], v[88:91], v[16:19], 0
    v_mfma_f32_16x16x32_bf16 v[124:127], v[88:91], v[20:23], 0
    ds_read_b128 v[80:83], v12 offset:128
    ds_read_b128 v[84:87], v12 offset:8576
    ds_read_b128 v[88:91], v12 offset:17024
    s_waitcnt vmcnt(12) lgkmcnt(3)
    v_mfma_f32_16x16x32_bf16 v[104:107], v[92:95], v[24:27], v[104:107]
    v_mfma_f32_16x16x32_bf16 v[108:111], v[92:95], v[28:31], v[108:111]
    v_mfma_f32_16x16x32_bf16 v[112:115], v[96:99], v[24:27], v[112:115]
    v_mfma_f32_16x16x32_bf16 v[116:119], v[96:99], v[28:31], v[116:119]
    v_mfma_f32_16x16x32_bf16 v[120:123], v[100:103], v[24:27], v[120:123]
    v_mfma_f32_16x16x32_bf16 v[124:127], v[100:103], v[28:31], v[124:127]
    ds_read_b128 v[92:95], v12 offset:192
    ds_read_b128 v[96:99], v12 offset:8640
    ds_read_b128 v[100:103], v12 offset:17088
    s_waitcnt vmcnt(10) lgkmcnt(3)
    v_mfma_f32_16x16x32_bf16 v[104:107], v[80:83], v[32:35], v[104:107]
    v_mfma_f32_16x16x32_bf16 v[108:111], v[80:83], v[36:39], v[108:111]
    v_mfma_f32_16x16x32_bf16 v[112:115], v[84:87], v[32:35], v[112:115]
    v_mfma_f32_16x16x32_bf16 v[116:119], v[84:87], v[36:39], v[116:119]
    v_mfma_f32_16x16x32_bf16 v[120:123], v[88:91], v[32:35], v[120:123]
    v_mfma_f32_16x16x32_bf16 v[124:127], v[88:91], v[36:39], v[124:127]
    ds_read_b128 v[80:83], v12 offset:256
    ds_read_b128 v[84:87], v12 offset:8704
    ds_read_b128 v[88:91], v12 offset:17152
    s_waitcnt vmcnt(8) lgkmcnt(3)
    v_mfma_f32_16x16x32_bf16 v[104:107], v[92:95], v[40:43], v[104:107]
    v_mfma_f32_16x16x32_bf16 v[108:111], v[92:95], v[44:47], v[108:111]
    v_mfma_f32_16x16x32_bf16 v[112:115], v[96:99], v[40:43], v[112:115]
    v_mfma_f32_16x16x32_bf16 v[116:119], v[96:99], v[44:47], v[116:119]
    v_mfma_f32_16x16x32_bf16 v[120:123], v[100:103], v[40:43], v[120:123]
    v_mfma_f32_16x16x32_bf16 v[124:127], v[100:103], v[44:47], v[124:127]
    ds_read_b128 v[92:95], v12 offset:320
    ds_read_b128 v[96:99], v12 offset:8768
    ds_read_b128 v[100:103], v12 offset:17216
    s_waitcnt vmcnt(6) lgkmcnt(3)
    v_mfma_f32_16x16x32_bf16 v[104:107], v[80:83], v[48:51], v[104:107]
    v_mfma_f32_16x16x32_bf16 v[108:111], v[80:83], v[52:55], v[108:111]
    v_mfma_f32_16x16x32_bf16 v[112:115], v[84:87], v[48:51], v[112:115]
    v_mfma_f32_16x16x32_bf16 v[116:119], v[84:87], v[52:55], v[116:119]
    v_mfma_f32_16x16x32_bf16 v[120:123], v[88:91], v[48:51], v[120:123]
    v_mfma_f32_16x16x32_bf16 v[124:127], v[88:91], v[52:55], v[124:127]
    ds_read_b128 v[80:83], v12 offset:384
    ds_read_b128 v[84:87], v12 offset:8832
    ds_read_b128 v[88:91], v12 offset:17280
    s_waitcnt vmcnt(4) lgkmcnt(3)
    v_mfma_f32_16x16x32_bf16 v[104:107], v[92:95], v[56:59], v[104:107]
    v_mfma_f32_16x16x32_bf16 v[108:111], v[92:95], v[60:63], v[108:111]
    v_mfma_f32_16x16x32_bf16 v[112:115], v[96:99], v[56:59], v[112:115]
    v_mfma_f32_16x16x32_bf16 v[116:119], v[96:99], v[60:63], v[116:119]
    v_mfma_f32_16x16x32_bf16 v[120:123], v[100:103], v[56:59], v[120:123]
    v_mfma_f32_16x16x32_bf16 v[124:127], v[100:103], v[60:63], v[124:127]
    ds_read_b128 v[92:95], v12 offset:448
    ds_read_b128 v[96:99], v12 offset:8896
    ds_read_b128 v[100:103], v12 offset:17344
    s_waitcnt vmcnt(2) lgkmcnt(3)
    v_mfma_f32_16x16x32_bf16 v[104:107], v[80:83], v[64:67], v[104:107]
    v_mfma_f32_16x16x32_bf16 v[108:111], v[80:83], v[68:71], v[108:111]
    v_mfma_f32_16x16x32_bf16 v[112:115], v[84:87], v[64:67], v[112:115]
    v_mfma_f32_16x16x32_bf16 v[116:119], v[84:87], v[68:71], v[116:119]
    v_mfma_f32_16x16x32_bf16 v[120:123], v[88:91], v[64:67], v[120:123]
    v_mfma_f32_16x16x32_bf16 v[124:127], v[88:91], v[68:71], v[124:127]
    s_waitcnt vmcnt(0) lgkmcnt(0)
    v_mfma_f32_16x16x32_bf16 v[104:107], v[92:95], v[72:75], v[104:107]
    v_mfma_f32_16x16x32_bf16 v[108:111], v[92:95], v[76:79], v[108:111]
    v_mfma_f32_16x16x32_bf16 v[112:115], v[96:99], v[72:75], v[112:115]
    v_mfma_f32_16x16x32_bf16 v[116:119], v[96:99], v[76:79], v[116:119]
    v_mfma_f32_16x16x32_bf16 v[120:123], v[100:103], v[72:75], v[120:123]
    v_mfma_f32_16x16x32_bf16 v[124:127], v[100:103], v[76:79], v[124:127]
    s_setprio 3
    s_add_u32 s100, s100, 118784
    buffer_load_dwordx4 v[16:19], v14, s[16:19], s100 offen offset:0 sc1
    buffer_load_dwordx4 v[20:23], v14, s[16:19], s100 offen offset:1024 sc1
    buffer_load_dwordx4 v[24:27], v14, s[16:19], s100 offen offset:2048 sc1
    buffer_load_dwordx4 v[28:31], v14, s[16:19], s100 offen offset:3072 sc1
    s_add_u32 s100, s100, 4096
    buffer_load_dwordx4 v[32:35], v14, s[16:19], s100 offen offset:0 sc1
    buffer_load_dwordx4 v[36:39], v14, s[16:19], s100 offen offset:1024 sc1
    buffer_load_dwordx4 v[40:43], v14, s[16:19], s100 offen offset:2048 sc1
    buffer_load_dwordx4 v[44:47], v14, s[16:19], s100 offen offset:3072 sc1
    s_add_u32 s100, s100, 4096
    buffer_load_dwordx4 v[48:51], v14, s[16:19], s100 offen offset:0 sc1
    buffer_load_dwordx4 v[52:55], v14, s[16:19], s100 offen offset:1024 sc1
    buffer_load_dwordx4 v[56:59], v14, s[16:19], s100 offen offset:2048 sc1
    buffer_load_dwordx4 v[60:63], v14, s[16:19], s100 offen offset:3072 sc1
    s_add_u32 s100, s100, 4096
    buffer_load_dwordx4 v[64:67], v14, s[16:19], s100 offen offset:0 sc1
    buffer_load_dwordx4 v[68:71], v14, s[16:19], s100 offen offset:1024 sc1
    buffer_load_dwordx4 v[72:75], v14, s[16:19], s100 offen offset:2048 sc1
    buffer_load_dwordx4 v[76:79], v14, s[16:19], s100 offen offset:3072 sc1
    s_setprio 0
    v_add_u32 v12, 130944, v1
    s_mov_b32 s59, 0
Lw_36:
    ds_read_b32 v4, v3 offset:36
    s_waitcnt lgkmcnt(0)
    v_cmp_gt_u32 vcc, 16, v4
    s_cbranch_vccz Lk_37
    s_sleep 2
    s_add_u32 s59, s59, 1
    s_cmp_lt_u32 s59, 16777216
    s_cbranch_scc1 Lw_36
    s_branch L_end
Lk_37:
    ds_read_b128 v[80:83], v12 offset:0
    ds_read_b128 v[84:87], v12 offset:64
    ds_read_b128 v[88:91], v12 offset:128
    ds_read_b128 v[92:95], v12 offset:192
    ds_read_b128 v[96:99], v12 offset:256
    ds_read_b128 v[100:103], v12 offset:320
    s_waitcnt vmcnt(14) lgkmcnt(5)
    v_mfma_f32_16x16x32_bf16 v[104:107], v[80:83], v[16:19], v[104:107]
    v_mfma_f32_16x16x32_bf16 v[108:111], v[80:83], v[20:23], v[108:111]
    ds_read_b128 v[80:83], v12 offset:384
    s_waitcnt vmcnt(12) lgkmcnt(5)
    v_mfma_f32_16x16x32_bf16 v[104:107], v[84:87], v[24:27], v[104:107]
    v_mfma_f32_16x16x32_bf16 v[108:111], v[84:87], v[28:31], v[108:111]
    ds_read_b128 v[84:87], v12 offset:448
    s_waitcnt vmcnt(10) lgkmcnt(5)
    v_mfma_f32_16x16x32_bf16 v[104:107], v[88:91], v[32:35], v[104:107]
    v_mfma_f32_16x16x32_bf16 v[108:111], v[88:91], v[36:39], v[108:111]
    s_waitcnt vmcnt(8) lgkmcnt(4)
    v_mfma_f32_16x16x32_bf16 v[104:107], v[92:95], v[40:43], v[104:107]
    v_mfma_f32_16x16x32_bf16 v[108:111], v[92:95], v[44:47], v[108:111]
    s_waitcnt vmcnt(6) lgkmcnt(3)
    v_mfma_f32_16x16x32_bf16 v[104:107], v[96:99], v[48:51], v[104:107]
    v_mfma_f32_16x16x32_bf16 v[108:111], v[96:99], v[52:55], v[108:111]
    s_waitcnt vmcnt(4) lgkmcnt(2)
    v_mfma_f32_16x16x32_bf16 v[104:107], v[100:103], v[56:59], v[104:107]
    v_mfma_f32_16x16x32_bf16 v[108:111], v[100:103], v[60:63], v[108:111]
    s_waitcnt vmcnt(2) lgkmcnt(1)
    v_mfma_f32_16x16x32_bf16 v[104:107], v[80:83], v[64:67], v[104:107]
    v_mfma_f32_16x16x32_bf16 v[108:111], v[80:83], v[68:71], v[108:111]
    s_waitcnt vmcnt(0) lgkmcnt(0)
    v_mfma_f32_16x16x32_bf16 v[104:107], v[84:87], v[72:75], v[104:107]
    v_mfma_f32_16x16x32_bf16 v[108:111], v[84:87], v[76:79], v[108:111]
    s_nop 7
    v_cvt_pk_bf16_f32 v104, v104, v108
    buffer_store_dword v104, v8, s[20:23], s60 offen offset:0 sc1
    v_cvt_pk_bf16_f32 v105, v105, v109
    buffer_store_dword v105, v8, s[20:23], s60 offen offset:512 sc1
    v_cvt_pk_bf16_f32 v106, v106, v110
    buffer_store_dword v106, v8, s[20:23], s60 offen offset:1024 sc1
    v_cvt_pk_bf16_f32 v107, v107, v111
    buffer_store_dword v107, v8, s[20:23], s60 offen offset:1536 sc1
    s_add_u32 s60, s60, 8192
    s_mov_b32 s59, 0
Lw_38:
    ds_read_b32 v4, v3 offset:40
    s_waitcnt lgkmcnt(0)
    v_cmp_gt_u32 vcc, 16, v4
    s_cbranch_vccz Lk_39
    s_sleep 2
    s_add_u32 s59, s59, 1
    s_cmp_lt_u32 s59, 16777216
    s_cbranch_scc1 Lw_38
    s_branch L_end
Lk_39:
    ds_read_b128 v[80:83], v12 offset:8448
    ds_read_b128 v[84:87], v12 offset:8512
    ds_read_b128 v[88:91], v12 offset:8576
    ds_read_b128 v[92:95], v12 offset:8640
    ds_read_b128 v[96:99], v12 offset:8704
    ds_read_b128 v[100:103], v12 offset:8768
    s_waitcnt lgkmcnt(5)
    v_mfma_f32_16x16x32_bf16 v[112:115], v[80:83], v[16:19], v[112:115]
    v_mfma_f32_16x16x32_bf16 v[116:119], v[80:83], v[20:23], v[116:119]
    ds_read_b128 v[80:83], v12 offset:8832
    s_waitcnt lgkmcnt(5)
    v_mfma_f32_16x16x32_bf16 v[112:115], v[84:87], v[24:27], v[112:115]
    v_mfma_f32_16x16x32_bf16 v[116:119], v[84:87], v[28:31], v[116:119]
    ds_read_b128 v[84:87], v12 offset:8896
    s_waitcnt lgkmcnt(5)
    v_mfma_f32_16x16x32_bf16 v[112:115], v[88:91], v[32:35], v[112:115]
    v_mfma_f32_16x16x32_bf16 v[116:119], v[88:91], v[36:39], v[116:119]
    s_waitcnt lgkmcnt(4)
    v_mfma_f32_16x16x32_bf16 v[112:115], v[92:95], v[40:43], v[112:115]
    v_mfma_f32_16x16x32_bf16 v[116:119], v[92:95], v[44:47], v[116:119]
    s_waitcnt lgkmcnt(3)
    v_mfma_f32_16x16x32_bf16 v[112:115], v[96:99], v[48:51], v[112:115]
    v_mfma_f32_16x16x32_bf16 v[116:119], v[96:99], v[52:55], v[116:119]
    s_waitcnt lgkmcnt(2)
    v_mfma_f32_16x16x32_bf16 v[112:115], v[100:103], v[56:59], v[112:115]
    v_mfma_f32_16x16x32_bf16 v[116:119], v[100:103], v[60:63], v[116:119]
    s_waitcnt lgkmcnt(1)
    v_mfma_f32_16x16x32_bf16 v[112:115], v[80:83], v[64:67], v[112:115]
    v_mfma_f32_16x16x32_bf16 v[116:119], v[80:83], v[68:71], v[116:119]
    s_waitcnt lgkmcnt(0)
    v_mfma_f32_16x16x32_bf16 v[112:115], v[84:87], v[72:75], v[112:115]
    v_mfma_f32_16x16x32_bf16 v[116:119], v[84:87], v[76:79], v[116:119]
    s_nop 7
    v_cvt_pk_bf16_f32 v112, v112, v116
    buffer_store_dword v112, v8, s[20:23], s60 offen offset:0 sc1
    v_cvt_pk_bf16_f32 v113, v113, v117
    buffer_store_dword v113, v8, s[20:23], s60 offen offset:512 sc1
    v_cvt_pk_bf16_f32 v114, v114, v118
    buffer_store_dword v114, v8, s[20:23], s60 offen offset:1024 sc1
    v_cvt_pk_bf16_f32 v115, v115, v119
    buffer_store_dword v115, v8, s[20:23], s60 offen offset:1536 sc1
    s_add_u32 s60, s60, 8192
    s_mov_b32 s59, 0
Lw_40:
    ds_read_b32 v4, v3 offset:44
    s_waitcnt lgkmcnt(0)
    v_cmp_gt_u32 vcc, 8, v4
    s_cbranch_vccz Lk_41
    s_add_u32 s59, s59, 1
    s_cmp_lt_u32 s59, 16777216
    s_cbranch_scc1 Lw_40
    s_branch L_end
Lk_41:
    ds_read_b128 v[80:83], v12 offset:16896
    ds_read_b128 v[84:87], v12 offset:16960
    ds_read_b128 v[88:91], v12 offset:17024
    ds_read_b128 v[92:95], v12 offset:17088
    ds_read_b128 v[96:99], v12 offset:17152
    ds_read_b128 v[100:103], v12 offset:17216
    s_waitcnt lgkmcnt(5)
    v_mfma_f32_16x16x32_bf16 v[120:123], v[80:83], v[16:19], v[120:123]
    v_mfma_f32_16x16x32_bf16 v[124:127], v[80:83], v[20:23], v[124:127]
    ds_read_b128 v[80:83], v12 offset:17280
    s_waitcnt lgkmcnt(5)
    v_mfma_f32_16x16x32_bf16 v[120:123], v[84:87], v[24:27], v[120:123]
    v_mfma_f32_16x16x32_bf16 v[124:127], v[84:87], v[28:31], v[124:127]
    ds_read_b128 v[84:87], v12 offset:17344
    s_waitcnt lgkmcnt(5)
    v_mfma_f32_16x16x32_bf16 v[120:123], v[88:91], v[32:35], v[120:123]
    v_mfma_f32_16x16x32_bf16 v[124:127], v[88:91], v[36:39], v[124:127]
    s_waitcnt lgkmcnt(4)
    v_mfma_f32_16x16x32_bf16 v[120:123], v[92:95], v[40:43], v[120:123]
    v_mfma_f32_16x16x32_bf16 v[124:127], v[92:95], v[44:47], v[124:127]
    s_waitcnt lgkmcnt(3)
    v_mfma_f32_16x16x32_bf16 v[120:123], v[96:99], v[48:51], v[120:123]
    v_mfma_f32_16x16x32_bf16 v[124:127], v[96:99], v[52:55], v[124:127]
    s_waitcnt lgkmcnt(2)
    v_mfma_f32_16x16x32_bf16 v[120:123], v[100:103], v[56:59], v[120:123]
    v_mfma_f32_16x16x32_bf16 v[124:127], v[100:103], v[60:63], v[124:127]
    s_waitcnt lgkmcnt(1)
    v_mfma_f32_16x16x32_bf16 v[120:123], v[80:83], v[64:67], v[120:123]
    v_mfma_f32_16x16x32_bf16 v[124:127], v[80:83], v[68:71], v[124:127]
    s_waitcnt lgkmcnt(0)
    v_mfma_f32_16x16x32_bf16 v[120:123], v[84:87], v[72:75], v[120:123]
    v_mfma_f32_16x16x32_bf16 v[124:127], v[84:87], v[76:79], v[124:127]
    s_nop 7
    v_cvt_pk_bf16_f32 v120, v120, v124
    buffer_store_dword v120, v9, s[20:23], s60 offen offset:0 sc1
    v_cvt_pk_bf16_f32 v121, v121, v125
    buffer_store_dword v121, v9, s[20:23], s60 offen offset:512 sc1
    v_cvt_pk_bf16_f32 v122, v122, v126
    buffer_store_dword v122, v9, s[20:23], s60 offen offset:1024 sc1
    v_cvt_pk_bf16_f32 v123, v123, v127
    buffer_store_dword v123, v9, s[20:23], s60 offen offset:1536 sc1
L_end:
L_exit:
    s_endpgm
L_slow:
    s_setprio 0
    ds_add_u32 v126, v127 offset:16
    s_mov_b32 s59, 0
Lw_42:
    ds_read_b32 v4, v3 offset:16
    s_waitcnt lgkmcnt(0)
    v_cmp_gt_u32 vcc, 8, v4
    s_cbranch_vccz Lk_43
    s_add_u32 s59, s59, 1
    s_cmp_lt_u32 s59, 4194304
    s_cbranch_scc1 Lw_42
    s_branch L_end
Lk_43:
    s_mov_b64 s[24:25], s[34:35]
    s_mov_b32 s26, 640000
    s_mov_b64 s[28:29], s[36:37]
    s_mov_b32 s30, 640000
    s_mov_b64 s[12:13], s[42:43]
    s_mov_b32 s14, 20000
    s_mov_b32 s15, 0x20000
    s_sub_u32 s63, s67, 1
    s_mov_b32 s65, 201487744
    s_mov_b32 s64, 0
    s_call_b64 s[68:69], L_flush
    s_add_u32 s66, s4, s5
    s_add_u32 s67, s66, 40
    v_lshlrev_b32 v16, 2, v0
    v_and_b32 v17, 32, v0
    v_lshl_add_u32 v17, v17, 22, v2
    v_mov_b32 v24, 0
L_sn:
    s_mov_b32 s60, 0
L_sc:
    buffer_load_dword v18, v16, s[28:31], s60 offen
    buffer_load_dword v19, v16, s[24:27], s60 offen
    s_waitcnt vmcnt(0)
    v_cmp_eq_u32 vcc, s66, v18
    s_cbranch_vccz L_sx
L_se:
    s_ff1_i32_b64 s58, vcc
    s_bitset0_b64 vcc, s58
    v_readlane_b32 s59, v19, s58
    s_nop 0
    s_lshl_b32 s61, s59, 9
    s_lshl_b32 s59, s59, 1
    buffer_load_dwordx4 v[20:23], v17, s[8:11], s61 offen
    buffer_load_ushort v1, v24, s[12:15], s59 offen
    s_waitcnt vmcnt(0)
    v_perm_b32 v6, v1, v1, v10
    v_perm_b32 v7, v1, v1, v11
    s_nop 1
    v_mfma_f32_4x4x4_16b_bf16 v[88:91], v[6:7], v[20:21], v[88:91]
    v_mfma_f32_4x4x4_16b_bf16 v[92:95], v[6:7], v[22:23], v[92:95]
    s_cmp_lg_u64 vcc, 0
    s_cbranch_scc1 L_se
L_sx:
    s_add_u32 s60, s60, 256
    s_cmp_lt_u32 s60, 640000
    s_cbranch_scc1 L_sc
    s_call_b64 s[68:69], L_flush
    s_add_u32 s66, s66, 8
    s_cmp_lt_u32 s66, s67
    s_cbranch_scc1 L_sn
    s_branch L_gdone
.section .rodata,"a"
.p2align 6
.amdhsa_kernel standalone__hybrid_graph_tf_exphormer__graph_kernel
  .amdhsa_next_free_vgpr 128
  .amdhsa_next_free_sgpr 102
  .amdhsa_accum_offset 128
  .amdhsa_group_segment_fixed_size 0
  .amdhsa_kernarg_size 104
  .amdhsa_user_sgpr_count 2
  .amdhsa_user_sgpr_kernarg_segment_ptr 1
  .amdhsa_system_sgpr_workgroup_id_x 1
.end_amdhsa_kernel
```

```asm
; @launch grid=(250,1,1) block=(1024,1,1) lds=163136
.amdgcn_target "amdgcn-amd-amdhsa--gfx950"
.text
.globl standalone__hybrid_graph_tf_exphormer__graph_kernel
.p2align 8
.type standalone__hybrid_graph_tf_exphormer__graph_kernel,@function
standalone__hybrid_graph_tf_exphormer__graph_kernel:
    s_cmp_ge_u32 s2, 250
    s_cbranch_scc1 L_exit
    s_load_dwordx16 s[32:47], s[0:1], 0
    s_load_dwordx8 s[48:55], s[0:1], 64
    s_load_dwordx2 s[56:57], s[0:1], 96
    s_getpc_b64 s[60:61]
    s_lshr_b32 s6, s2, 3
    v_lshl_add_u32 v1, v0, 5, s6
    v_cmp_gt_u32 vcc, 87, v1
    v_lshlrev_b32 v1, 7, v1
    s_and_saveexec_b64 s[58:59], vcc
    s_cbranch_execz L_nopf
    global_load_dword v15, v1, s[60:61]
L_nopf:
    s_mov_b64 exec, -1
    v_lshrrev_b32 v1, 6, v0
    v_mov_b32 v8, 33554432
    v_readfirstlane_b32 s3, v1
    v_cmp_gt_u32 vcc, 288, v0
    v_lshlrev_b32 v4, 4, v0
    v_add_u32 v4, 152192, v4
    v_cndmask_b32 v8, 0, v8, vcc
    v_mov_b32 v9, v8
    v_mov_b64 v[10:11], v[8:9]
    v_cmp_gt_u32 vcc, 524, v0
    s_and_saveexec_b64 s[58:59], vcc
    ds_write_b128 v4, v[8:11]
    s_mov_b64 exec, -1
    v_and_b32 v0, 63, v0
    v_and_b32 v2, 31, v0
    v_lshlrev_b32 v2, 4, v2
    s_and_b32 s59, s2, 7
    s_mul_i32 s60, s59, 31
    s_min_u32 s59, s59, 2
    s_add_u32 s6, s6, s60
    s_add_u32 s6, s6, s59
    s_mov_b32 s27, 0x20000
    s_mov_b32 s31, 0x20000
    s_xor_b32 s3, s3, 8
    s_cmp_eq_u32 s3, 8
    s_cbranch_scc0 L_e1
    s_setprio 3
    v_lshlrev_b32 v5, 4, v0
    v_lshlrev_b32 v6, 3, v0
    s_mul_i32 s58, s2, 2560
    s_mov_b32 s26, 640000
    s_mov_b32 s30, 640000
    s_mov_b32 s59, 1048576
    s_waitcnt lgkmcnt(0)
    s_mov_b64 s[28:29], s[36:37]
    s_mov_b64 s[24:25], s[34:35]
    buffer_load_dwordx4 v[26:29], v5, s[28:31], s58 offen
    buffer_load_dwordx4 v[30:33], v5, s[28:31], s58 offen offset:1024
    buffer_load_dwordx2 v[34:35], v6, s[28:31], s58 offen offset:2048
    buffer_load_dwordx4 v[16:19], v5, s[24:27], s58 offen
    buffer_load_dwordx4 v[20:23], v5, s[24:27], s58 offen offset:1024
    buffer_load_dwordx2 v[24:25], v6, s[24:27], s58 offen offset:2048
    s_load_dword s40, s[56:57], s59
    s_branch L_bar
L_e1:
    s_mov_b32 s26, 131072
    s_sub_u32 s60, s3, 9
    s_cmp_lt_u32 s60, 3
    s_cbranch_scc0 L_e2
    s_cmp_ge_u32 s2, 128
    s_cbranch_scc1 L_barw
    s_setprio 3
    s_and_b32 s58, s2, 7
    s_lshr_b32 s59, s2, 4
    s_bfe_u32 s61, s2, 0x10003
    s_cmp_eq_u32 s60, 2
    s_cselect_b32 s58, s59, s58
    s_cselect_b32 s61, s61, s60
    s_lshl_b32 s58, s58, 14
    s_lshl_b32 s61, s61, 11
    s_add_u32 s58, s58, s61
    s_add_u32 s59, s58, 4096
    v_and_b32 v4, 32, v0
    v_lshl_add_u32 v4, v4, 8, v2
    s_mul_i32 s61, s60, 8448
    s_add_u32 m0, s61, 105600
    s_cmp_eq_u32 s60, 2
    s_waitcnt lgkmcnt(0)
    s_cselect_b64 s[24:25], s[48:49], s[46:47]
    buffer_load_dwordx4 v4, s[24:27], s58 offen offset:0 lds
    s_add_u32 m0, m0, 544
    s_nop 0
    buffer_load_dwordx4 v4, s[24:27], s58 offen offset:512 lds
    s_add_u32 m0, m0, 544
    s_nop 0
    buffer_load_dwordx4 v4, s[24:27], s58 offen offset:1024 lds
    s_add_u32 m0, m0, 544
    s_nop 0
    buffer_load_dwordx4 v4, s[24:27], s58 offen offset:1536 lds
    s_add_u32 m0, m0, 2592
    s_nop 0
    buffer_load_dwordx4 v4, s[24:27], s59 offen offset:0 lds
    s_add_u32 m0, m0, 544
    s_nop 0
    buffer_load_dwordx4 v4, s[24:27], s59 offen offset:512 lds
    s_add_u32 m0, m0, 544
    s_nop 0
    buffer_load_dwordx4 v4, s[24:27], s59 offen offset:1024 lds
    s_add_u32 m0, m0, 544
    s_nop 0
    buffer_load_dwordx4 v4, s[24:27], s59 offen offset:1536 lds
    s_branch L_bar
L_e2:
    s_cmp_eq_u32 s3, 12
    s_cbranch_scc0 L_e3
    s_cmp_lt_u32 s2, 122
    s_cbranch_scc1 L_barw
    s_setprio 3
    s_sub_u32 s58, s2, 122
    s_and_b32 s59, s58, 7
    s_lshl_b32 s59, s59, 14
    s_bfe_u32 s60, s58, 0x30003
    s_lshl_b32 s60, s60, 6
    s_add_u32 s59, s59, s60
    v_and_b32 v4, 15, v0
    v_lshlrev_b32 v4, 2, v4
    v_and_b32 v5, 48, v0
    v_lshl_add_u32 v4, v5, 8, v4
    s_cmp_lt_u32 s58, 64
    s_waitcnt lgkmcnt(0)
    s_cselect_b64 s[24:25], s[50:51], s[44:45]
    buffer_load_dword v16, v4, s[24:27], s59 offen offset:0
    buffer_load_dword v17, v4, s[24:27], s59 offen offset:512
    buffer_load_dword v18, v4, s[24:27], s59 offen offset:1024
    buffer_load_dword v19, v4, s[24:27], s59 offen offset:1536
    buffer_load_dword v20, v4, s[24:27], s59 offen offset:2048
    buffer_load_dword v21, v4, s[24:27], s59 offen offset:2560
    buffer_load_dword v22, v4, s[24:27], s59 offen offset:3072
    buffer_load_dword v23, v4, s[24:27], s59 offen offset:3584
    s_branch L_bar
L_e3:
    s_cmp_lt_u32 s3, 8
    s_cbranch_scc0 L_barw
    s_mul_i32 s58, s6, 640
    s_lshl_b32 s59, s3, 6
    s_add_u32 s59, s59, s58
    s_lshr_b32 s60, s3, 2
    s_lshl_b32 s60, s60, 6
    s_and_b32 s61, s3, 3
    s_lshl_b32 s61, s61, 3
    s_add_u32 s60, s60, s61
    s_add_u32 s60, s60, s58
    s_add_u32 s60, s60, 512
    s_add_u32 s61, s60, 32
    s_waitcnt lgkmcnt(0)
    s_mov_b64 s[62:63], s[38:39]
    s_mov_b64 s[8:9], s[32:33]
    s_load_dwordx16 s[32:47], s[62:63], s59
    s_load_dwordx2 s[64:65], s[62:63], s60
    s_load_dwordx2 s[66:67], s[62:63], s61
    s_barrier
    s_branch L_preA
L_barw:
    s_waitcnt lgkmcnt(0)
L_bar:
    s_barrier
    s_mov_b64 s[8:9], s[32:33]
    s_and_b32 s4, s3, 7
    s_mul_i32 s5, s6, 40
    v_mov_b32 v3, 159424
    s_mov_b32 s10, 5120000
    s_mov_b32 s11, 0x20000
    s_add_u32 s16, s56, 0
    s_addc_u32 s17, s57, 0
    s_mov_b32 s18, 4194304
    s_mov_b32 s19, 0x20000
    s_cmp_eq_u32 s3, 9
    s_cbranch_scc1 L_mtask
    s_cmp_gt_u32 s3, 9
    s_cbranch_scc1 L_other
    v_lshlrev_b32 v5, 4, v0
    v_lshlrev_b32 v6, 3, v0
    v_mov_b32 v8, 1
    v_mov_b32 v9, 4
    v_mov_b32 v10, 159552
    v_add_u32 v11, 159552, v5
    v_mov_b32 v59, 160576
    v_add_u32 v74, 160576, v5
    v_add_u32 v75, 160576, v6
    s_lshl_b32 s61, s2, 10
    s_add_u32 s61, s61, 2097152
    s_waitcnt vmcnt(5)
    v_mul_u32_u24 v36, 52429, v26
    v_lshrrev_b32 v36, 21, v36
    v_lshl_add_u32 v36, v36, 2, v10
    ds_add_u32 v36, v8
    v_mul_u32_u24 v37, 52429, v27
    v_lshrrev_b32 v37, 21, v37
    v_lshl_add_u32 v37, v37, 2, v10
    ds_add_u32 v37, v8
    v_mul_u32_u24 v38, 52429, v28
    v_lshrrev_b32 v38, 21, v38
    v_lshl_add_u32 v38, v38, 2, v10
    ds_add_u32 v38, v8
    v_mul_u32_u24 v39, 52429, v29
    v_lshrrev_b32 v39, 21, v39
    v_lshl_add_u32 v39, v39, 2, v10
    ds_add_u32 v39, v8
    s_waitcnt vmcnt(4)
    v_mul_u32_u24 v40, 52429, v30
    v_lshrrev_b32 v40, 21, v40
    v_lshl_add_u32 v40, v40, 2, v10
    ds_add_u32 v40, v8
    v_mul_u32_u24 v41, 52429, v31
    v_lshrrev_b32 v41, 21, v41
    v_lshl_add_u32 v41, v41, 2, v10
    ds_add_u32 v41, v8
    v_mul_u32_u24 v42, 52429, v32
    v_lshrrev_b32 v42, 21, v42
    v_lshl_add_u32 v42, v42, 2, v10
    ds_add_u32 v42, v8
    v_mul_u32_u24 v43, 52429, v33
    v_lshrrev_b32 v43, 21, v43
    v_lshl_add_u32 v43, v43, 2, v10
    ds_add_u32 v43, v8
    s_waitcnt vmcnt(3)
    v_mul_u32_u24 v44, 52429, v34
    v_lshrrev_b32 v44, 21, v44
    v_lshl_add_u32 v44, v44, 2, v10
    ds_add_u32 v44, v8
    v_mul_u32_u24 v45, 52429, v35
    v_lshrrev_b32 v45, 21, v45
    v_lshl_add_u32 v45, v45, 2, v10
    ds_add_u32 v45, v8
    ds_read_b128 v[12:15], v11
    s_waitcnt vmcnt(0)
    v_lshl_or_b32 v16, v26, 16, v16
    v_lshl_or_b32 v17, v27, 16, v17
    v_lshl_or_b32 v18, v28, 16, v18
    v_lshl_or_b32 v19, v29, 16, v19
    v_lshl_or_b32 v20, v30, 16, v20
    v_lshl_or_b32 v21, v31, 16, v21
    v_lshl_or_b32 v22, v32, 16, v22
    v_lshl_or_b32 v23, v33, 16, v23
    v_lshl_or_b32 v24, v34, 16, v24
    v_lshl_or_b32 v25, v35, 16, v25
    s_waitcnt lgkmcnt(0)
    v_add_u32 v56, v12, v13
    v_add3_u32 v57, v56, v14, v15
    s_add_u32 s40, s40, 0x400
    s_and_b32 s40, s40, 4294966272
    v_add_u32_dpp v58, v57, v57 row_shr:1 row_mask:0xf bank_mask:0xf bound_ctrl:1
    s_nop 1
    v_add_u32_dpp v58, v58, v58 row_shr:2 row_mask:0xf bank_mask:0xf bound_ctrl:1
    s_nop 1
    v_add_u32_dpp v58, v58, v58 row_shr:4 row_mask:0xf bank_mask:0xf bound_ctrl:1
    s_nop 1
    v_add_u32_dpp v58, v58, v58 row_shr:8 row_mask:0xf bank_mask:0xf bound_ctrl:1
    s_nop 1
    v_add_u32_dpp v58, v58, v58 row_bcast:15 row_mask:0xa bank_mask:0xf
    s_nop 1
    v_add_u32_dpp v58, v58, v58 row_bcast:31 row_mask:0xc bank_mask:0xf
    v_sub_u32 v60, v58, v57
    v_add_u32 v61, v60, v12
    v_add_u32 v62, v60, v56
    v_add_u32 v63, v62, v14
    v_lshl_add_u32 v64, v60, 2, v59
    v_lshl_add_u32 v65, v61, 2, v59
    v_lshl_add_u32 v66, v62, 2, v59
    v_lshl_add_u32 v67, v63, 2, v59
    ds_write_b128 v11, v[64:67]
    ds_add_rtn_u32 v46, v36, v9
    ds_add_rtn_u32 v47, v37, v9
    ds_add_rtn_u32 v48, v38, v9
    ds_add_rtn_u32 v49, v39, v9
    ds_add_rtn_u32 v50, v40, v9
    ds_add_rtn_u32 v51, v41, v9
    ds_add_rtn_u32 v52, v42, v9
    ds_add_rtn_u32 v53, v43, v9
    ds_add_rtn_u32 v54, v44, v9
    ds_add_rtn_u32 v55, v45, v9
    v_or_b32 v60, s40, v60
    v_or_b32 v61, s40, v61
    v_or_b32 v62, s40, v62
    v_or_b32 v63, s40, v63
    s_or_b32 s60, s40, 1
    v_mov_b32 v12, s60
    s_waitcnt lgkmcnt(8)
    ds_write_b32 v46, v16
    ds_write_b32 v47, v17
    s_waitcnt lgkmcnt(8)
    ds_write_b32 v48, v18
    ds_write_b32 v49, v19
    s_waitcnt lgkmcnt(8)
    ds_write_b32 v50, v20
    ds_write_b32 v51, v21
    s_waitcnt lgkmcnt(8)
    ds_write_b32 v52, v22
    ds_write_b32 v53, v23
    s_waitcnt lgkmcnt(8)
    ds_write_b32 v54, v24
    ds_write_b32 v55, v25
    ds_read_b128 v[64:67], v74
    ds_read_b128 v[68:71], v74 offset:1024
    ds_read_b64 v[72:73], v75 offset:2048
    s_waitcnt lgkmcnt(2)
    buffer_store_dwordx4 v[64:67], v5, s[16:19], s58 offen sc1
    s_waitcnt lgkmcnt(1)
    buffer_store_dwordx4 v[68:71], v5, s[16:19], s58 offen offset:1024 sc1
    s_waitcnt lgkmcnt(0)
    buffer_store_dwordx2 v[72:73], v6, s[16:19], s58 offen offset:2048 sc1
    s_mov_b32 s59, 0
Lw_1:
    ds_read_b32 v4, v3 offset:56
    s_waitcnt lgkmcnt(0)
    v_cmp_gt_u32 vcc, 2, v4
    s_cbranch_vccz Lk_2
    s_add_u32 s59, s59, 1
    s_cmp_lt_u32 s59, 4194304
    s_cbranch_scc1 Lw_1
    s_branch L_end
Lk_2:
    s_waitcnt vmcnt(0)
    buffer_store_dwordx4 v[60:63], v5, s[16:19], s61 offen sc1
    ds_write_b32 v3, v12 offset:32
    s_branch L_preB
L_mtask:
    s_cmp_ge_u32 s2, 128
    s_cbranch_scc1 L_taskd
    v_and_b32 v4, 7, v0
    v_mul_u32_u24 v1, 1056, v4
    v_and_b32 v4, 8, v0
    v_lshl_add_u32 v1, v4, 6, v1
    v_and_b32 v4, 48, v0
    v_add_u32 v1, v4, v1
    v_add_u32 v5, 105600, v1
    s_lshr_b32 s58, s2, 4
    s_lshl_b32 s58, s58, 3
    s_and_b32 s59, s2, 7
    s_add_u32 s58, s58, s59
    s_lshl_b32 s58, s58, 1
    s_bfe_u32 s59, s2, 0x10003
    s_add_u32 s58, s58, s59
    s_lshl_b32 s58, s58, 10
    s_add_u32 s58, s58, 655360
    v_lshlrev_b32 v6, 4, v0
    s_waitcnt vmcnt(0)
    s_mov_b32 s59, 0
Lw_3:
    ds_read_b32 v4, v3 offset:8
    s_waitcnt lgkmcnt(0)
    v_cmp_gt_u32 vcc, 2, v4
    s_cbranch_vccz Lk_4
    s_add_u32 s59, s59, 1
    s_cmp_lt_u32 s59, 4194304
    s_cbranch_scc1 Lw_3
    s_branch L_end
Lk_4:
    ds_read_b128 v[32:35], v5 offset:0
    ds_read_b128 v[36:39], v5 offset:8448
    ds_read_b128 v[40:43], v5 offset:16896
    ds_read_b128 v[44:47], v5 offset:64
    ds_read_b128 v[48:51], v5 offset:8512
    ds_read_b128 v[52:55], v5 offset:16960
    ds_read_b128 v[56:59], v5 offset:128
    ds_read_b128 v[60:63], v5 offset:8576
    ds_read_b128 v[64:67], v5 offset:17024
    ds_read_b128 v[68:71], v5 offset:192
    ds_read_b128 v[72:75], v5 offset:8640
    ds_read_b128 v[76:79], v5 offset:17088
    s_waitcnt lgkmcnt(9)
    ds_read_b128 v[80:83], v5 offset:256
    ds_read_b128 v[84:87], v5 offset:8704
    ds_read_b128 v[88:91], v5 offset:17152
    v_mfma_f32_16x16x32_bf16 v[8:11], v[32:35], v[40:43], 0
    v_mfma_f32_16x16x32_bf16 v[12:15], v[36:39], v[40:43], 0
    s_waitcnt lgkmcnt(9)
    ds_read_b128 v[92:95], v5 offset:320
    ds_read_b128 v[96:99], v5 offset:8768
    ds_read_b128 v[100:103], v5 offset:17216
    v_mfma_f32_16x16x32_bf16 v[8:11], v[44:47], v[52:55], v[8:11]
    v_mfma_f32_16x16x32_bf16 v[12:15], v[48:51], v[52:55], v[12:15]
    s_waitcnt lgkmcnt(9)
    ds_read_b128 v[104:107], v5 offset:384
    ds_read_b128 v[108:111], v5 offset:8832
    ds_read_b128 v[112:115], v5 offset:17280
    v_mfma_f32_16x16x32_bf16 v[8:11], v[56:59], v[64:67], v[8:11]
    v_mfma_f32_16x16x32_bf16 v[12:15], v[60:63], v[64:67], v[12:15]
    s_waitcnt lgkmcnt(9)
    ds_read_b128 v[116:119], v5 offset:448
    ds_read_b128 v[120:123], v5 offset:8896
    ds_read_b128 v[124:127], v5 offset:17344
    v_mfma_f32_16x16x32_bf16 v[8:11], v[68:71], v[76:79], v[8:11]
    v_mfma_f32_16x16x32_bf16 v[12:15], v[72:75], v[76:79], v[12:15]
    s_waitcnt lgkmcnt(9)
    v_mfma_f32_16x16x32_bf16 v[8:11], v[80:83], v[88:91], v[8:11]
    v_mfma_f32_16x16x32_bf16 v[12:15], v[84:87], v[88:91], v[12:15]
    s_waitcnt lgkmcnt(6)
    v_mfma_f32_16x16x32_bf16 v[8:11], v[92:95], v[100:103], v[8:11]
    v_mfma_f32_16x16x32_bf16 v[12:15], v[96:99], v[100:103], v[12:15]
    s_waitcnt lgkmcnt(3)
    v_mfma_f32_16x16x32_bf16 v[8:11], v[104:107], v[112:115], v[8:11]
    v_mfma_f32_16x16x32_bf16 v[12:15], v[108:111], v[112:115], v[12:15]
    s_waitcnt lgkmcnt(0)
    v_mfma_f32_16x16x32_bf16 v[8:11], v[116:119], v[124:127], v[8:11]
    v_mfma_f32_16x16x32_bf16 v[12:15], v[120:123], v[124:127], v[12:15]
    s_nop 6
    v_cvt_pk_bf16_f32 v16, v8, v9
    v_cvt_pk_bf16_f32 v17, v10, v11
    v_cvt_pk_bf16_f32 v18, v12, v13
    v_cvt_pk_bf16_f32 v19, v14, v15
    buffer_store_dwordx4 v[16:19], v6, s[16:19], s58 offen sc1
    s_branch L_taskw
L_other:
    s_cmp_gt_u32 s3, 12
    s_cbranch_scc1 L_dis
    s_cmp_eq_u32 s3, 12
    s_cbranch_scc1 L_wtask
    s_waitcnt vmcnt(0)
    s_mov_b64 exec, 1
    v_mov_b32 v4, 1
    ds_add_u32 v3, v4 offset:8
    s_mov_b64 exec, -1
    s_branch L_preB
L_wtask:
    s_cmp_lt_u32 s2, 122
    s_cbranch_scc1 L_taskd
    s_sub_u32 s58, s2, 122
    s_lshl_b32 s58, s58, 11
    s_add_u32 s58, s58, 786432
    v_lshlrev_b32 v6, 4, v0
    s_mov_b32 s70, 0x05040100
    s_mov_b32 s71, 0x07060302
    s_waitcnt vmcnt(0)
    v_perm_b32 v60, v17, v16, s70
    v_perm_b32 v64, v17, v16, s71
    v_perm_b32 v61, v19, v18, s70
    v_perm_b32 v65, v19, v18, s71
    v_perm_b32 v62, v21, v20, s70
    v_perm_b32 v66, v21, v20, s71
    v_perm_b32 v63, v23, v22, s70
    v_perm_b32 v67, v23, v22, s71
    buffer_store_dwordx4 v[60:63], v6, s[16:19], s58 offen sc1
    buffer_store_dwordx4 v[64:67], v6, s[16:19], s58 offen offset:1024 sc1
L_taskw:
    s_waitcnt vmcnt(0)
L_taskd:
    s_mov_b64 exec, 1
    v_mov_b32 v4, 1
    ds_add_u32 v3, v4 offset:56
    s_mov_b64 exec, -1
    s_branch L_preB
L_dis:
    s_mov_b64 s[28:29], s[42:43]
    s_mov_b32 s30, 20000
    s_sub_u32 s58, s3, 13
    s_mul_i32 s58, s58, 7168
    v_lshlrev_b32 v4, 4, v0
    s_add_u32 m0, s58, 131072
    s_add_u32 s59, s58, 0
    s_waitcnt vmcnt(1)
    buffer_load_dwordx4 v4, s[28:31], s59 offen offset:0 lds
    s_waitcnt vmcnt(1)
    buffer_load_dwordx4 v4, s[28:31], s59 offen offset:1024 lds
    s_waitcnt vmcnt(1)
    buffer_load_dwordx4 v4, s[28:31], s59 offen offset:2048 lds
    s_waitcnt vmcnt(1)
    buffer_load_dwordx4 v4, s[28:31], s59 offen offset:3072 lds
    s_add_u32 m0, s58, 135168
    s_add_u32 s59, s58, 4096
    s_waitcnt vmcnt(1)
    buffer_load_dwordx4 v4, s[28:31], s59 offen offset:0 lds
    s_waitcnt vmcnt(1)
    buffer_load_dwordx4 v4, s[28:31], s59 offen offset:1024 lds
    s_cmp_eq_u32 s3, 15
    s_cbranch_scc1 L_preB
    s_waitcnt vmcnt(1)
    buffer_load_dwordx4 v4, s[28:31], s59 offen offset:2048 lds
L_preB:
    s_setprio 3
    v_and_b32 v4, 3, v0
    v_mov_b32 v5, 0x0c0c0c0c
    v_mov_b32 v6, 0x0c0c0302
    v_mov_b32 v7, 0x03020c0c
    v_cmp_eq_u32 s[58:59], 0, v4
    v_cmp_eq_u32 s[60:61], 2, v4
    v_cmp_eq_u32 vcc, 1, v4
    v_cndmask_b32 v10, v5, v6, s[58:59]
    v_cndmask_b32 v11, v5, v6, s[60:61]
    v_cndmask_b32 v10, v10, v7, vcc
    v_cmp_eq_u32 vcc, 3, v4
    s_nop 1
    v_cndmask_b32 v11, v11, v7, vcc
    v_and_b32 v10, 0xfdfdfdfd, v10
    v_and_b32 v11, 0xfdfdfdfd, v11
    s_movk_i32 s7, 512
    s_lshl_b32 s58, s4, 5
    v_lshrrev_b32 v5, 1, v0
    v_add_u32 v5, s58, v5
    v_cmp_gt_u32 vcc, 250, v5
    v_and_b32 v56, 1, v0
    s_mov_b64 s[64:65], vcc
    v_lshlrev_b32 v54, 10, v5
    v_mul_u32_u24 v49, 2560, v5
    v_lshl_add_u32 v49, v56, 4, v49
    v_lshlrev_b32 v56, 2, v56
    v_lshrrev_b32 v5, 3, v0
    v_and_b32 v6, 7, v0
    v_cmp_gt_u32 s[62:63], 5, v6
    v_lshl_add_u32 v50, v6, 3, v5
    v_mul_u32_u24 v55, 72, v5
    v_add_u32 v55, 72, v55
    v_lshrrev_b32 v5, 4, v50
    v_mul_u32_u24 v9, 8448, v5
    v_lshl_add_u32 v9, v5, 26, v9
    v_cmp_le_u32 vcc, 32, v50
    v_and_b32 v5, 7, v50
    v_and_b32 v6, 3, v50
    v_cndmask_b32 v5, v5, v6, vcc
    v_mul_u32_u24 v5, 1056, v5
    v_bfe_u32 v6, v50, 3, 1
    v_bfe_u32 v7, v50, 2, 1
    v_cndmask_b32 v6, v6, v7, vcc
    v_lshl_add_u32 v5, v6, 9, v5
    v_mov_b32 v52, 131072
    v_add3_u32 v9, v9, v5, v52
    v_lshrrev_b32 v5, 5, v0
    v_lshl_add_u32 v15, v5, 3, v2
    v_mov_b32 v62, 1
    s_lshl_b32 s58, s5, 2
    s_sub_u32 s58, 159104, s58
    v_mov_b32 v53, s58
    v_add_u32 v5, s5, v50
    v_lshl_add_u32 v8, v5, 1, v52
    v_lshlrev_b32 v50, 2, v50
    v_add_u32 v50, 159104, v50
    v_min_u32 v5, 1, v0
    v_lshl_add_u32 v61, v0, 2, v3
    v_lshl_add_u32 v61, v5, 16, v61
    v_mov_b32 v57, 156800
    v_mov_b32 v60, 152192
    s_lshl_b32 s60, s6, 2
    s_add_u32 s60, s60, 2097152
    s_add_u32 s61, s60, 0
    v_mov_b64 v[58:59], 0
    v_mov_b64 v[16:17], 0
    v_mov_b64 v[18:19], 0
    v_mov_b64 v[20:21], 0
    v_mov_b64 v[22:23], 0
    s_mov_b32 s59, 0
Lw_5:
    ds_read_b32 v4, v3 offset:60
    s_waitcnt lgkmcnt(0)
    v_cmp_gt_u32 vcc, 8, v4
    s_cbranch_vccz Lk_6
    s_sleep 2
    s_add_u32 s59, s59, 1
    s_cmp_lt_u32 s59, 4194304
    s_cbranch_scc1 Lw_5
    s_branch L_end
Lk_6:
    s_mov_b32 s59, 0
Lw_7:
    ds_read_b32 v4, v3 offset:32
    s_waitcnt lgkmcnt(0)
    v_cmp_gt_u32 vcc, 1, v4
    s_cbranch_vccz Lk_8
    s_sleep 1
    s_add_u32 s59, s59, 1
    s_cmp_lt_u32 s59, 4194304
    s_cbranch_scc1 Lw_7
    s_branch L_end
Lk_8:
    v_readfirstlane_b32 s40, v4
    s_mov_b32 s59, 0
    s_mov_b64 exec, s[64:65]
    s_bitset0_b32 s40, 0
L_spoll:
    buffer_load_dwordx2 v[58:59], v54, s[16:19], s60 offen sc1
    s_add_u32 s59, s59, 1
    s_cmp_gt_u32 s59, 0x40000
    s_cbranch_scc1 L_end
    s_add_u32 s60, s60, 262144
    s_min_u32 s60, s60, s61
    s_waitcnt vmcnt(0)
    v_xor_b32 v58, s40, v58
    v_xor_b32 v59, s40, v59
    v_or_b32 v5, v58, v59
    v_cmpx_lt_u32 vcc, 0x3ff, v5
    s_cbranch_execz L_sok
    s_sleep 8
    s_branch L_spoll
L_sok:
    s_mov_b64 exec, -1
    ds_add_u32 v61, v62 offset:52
    v_lshl_add_u32 v49, v58, 2, v49
    v_sub_u32 v48, v59, v58
    v_sub_u32 v48, v48, v56
    v_cmpx_lt_i32 vcc, 0, v48
    s_cbranch_execz L_entld
    buffer_load_dwordx4 v[16:19], v49, s[16:19], 0 offen offset:0 sc1
    v_cmpx_lt_i32 vcc, 8, v48
    s_cbranch_execz L_entld
    buffer_load_dwordx4 v[20:23], v49, s[16:19], 0 offen offset:32 sc1
    v_cmpx_lt_i32 vcc, 16, v48
    s_cbranch_execz L_entld
    ds_write_b32 v3, v62 offset:28
L_entld:
    s_mov_b64 exec, -1
    s_waitcnt vmcnt(0)
    v_cmpx_lt_i32 vcc, 0, v48
    v_mad_u32_u16 v24, v16, 4, v53 op_sel:[1,0,0,0]
    ds_add_rtn_u32 v32, v24, v62
    v_cmpx_lt_i32 vcc, 1, v48
    v_mad_u32_u16 v25, v17, 4, v53 op_sel:[1,0,0,0]
    ds_add_rtn_u32 v33, v25, v62
    v_cmpx_lt_i32 vcc, 2, v48
    v_mad_u32_u16 v26, v18, 4, v53 op_sel:[1,0,0,0]
    ds_add_rtn_u32 v34, v26, v62
    v_cmpx_lt_i32 vcc, 3, v48
    v_mad_u32_u16 v27, v19, 4, v53 op_sel:[1,0,0,0]
    ds_add_rtn_u32 v35, v27, v62
    v_cmpx_lt_i32 vcc, 8, v48
    s_cbranch_execz L_l1
    s_waitcnt lgkmcnt(2)
    v_mad_u32_u16 v28, v20, 4, v53 op_sel:[1,0,0,0]
    ds_add_rtn_u32 v36, v28, v62
    v_cmpx_lt_i32 vcc, 9, v48
    s_cbranch_execz L_l1
    v_mad_u32_u16 v29, v21, 4, v53 op_sel:[1,0,0,0]
    ds_add_rtn_u32 v37, v29, v62
    v_cmpx_lt_i32 vcc, 10, v48
    s_cbranch_execz L_l1
    v_mad_u32_u16 v30, v22, 4, v53 op_sel:[1,0,0,0]
    ds_add_rtn_u32 v38, v30, v62
    v_cmpx_lt_i32 vcc, 11, v48
    s_cbranch_execz L_l1
    v_mad_u32_u16 v31, v23, 4, v53 op_sel:[1,0,0,0]
    ds_add_rtn_u32 v39, v31, v62
L_l1:
    s_mov_b64 exec, -1
    ds_add_u32 v61, v62 offset:12
    v_mad_u32_u16 v40, v16, 2, v52
    v_mad_u32_u16 v16, v16, s7, 0
    v_mad_u32_u16 v41, v17, 2, v52
    v_mad_u32_u16 v17, v17, s7, 0
    v_mad_u32_u16 v42, v18, 2, v52
    v_mad_u32_u16 v18, v18, s7, 0
    v_mad_u32_u16 v43, v19, 2, v52
    v_mad_u32_u16 v19, v19, s7, 0
    v_mad_u32_u16 v44, v20, 2, v52
    v_mad_u32_u16 v20, v20, s7, 0
    v_mad_u32_u16 v45, v21, 2, v52
    v_mad_u32_u16 v21, v21, s7, 0
    v_mad_u32_u16 v46, v22, 2, v52
    v_mad_u32_u16 v22, v22, s7, 0
    v_mad_u32_u16 v47, v23, 2, v52
    v_mad_u32_u16 v23, v23, s7, 0
    s_mov_b32 s59, 0
Lw_9:
    ds_read_b32 v4, v3 offset:12
    s_waitcnt lgkmcnt(0)
    v_cmp_gt_u32 vcc, 8, v4
    s_cbranch_vccz Lk_10
    s_add_u32 s59, s59, 1
    s_cmp_lt_u32 s59, 4194304
    s_cbranch_scc1 Lw_9
    s_branch L_end
Lk_10:
    ds_read_b32 v12, v50
    ds_read_b32 v5, v3 offset:28
    ds_read_u16 v8, v8
    ds_read_u16 v40, v40
    ds_read_u16 v41, v41
    ds_read_u16 v42, v42
    ds_read_u16 v43, v43
    ds_read_u16 v44, v44
    ds_read_u16 v45, v45
    ds_read_u16 v46, v46
    ds_read_u16 v47, v47
    s_lshl_b32 s58, s2, 4
    s_add_u32 s58, s58, s3
    s_cmp_eq_u32 s58, 15
    s_cbranch_scc0 L_noep
    v_mov_b32 v6, s40
    v_mov_b32 v7, 1048576
    s_mov_b64 exec, 1
    buffer_store_dword v6, v7, s[16:19], 0 offen sc1
    s_mov_b64 exec, -1
L_noep:
    s_waitcnt lgkmcnt(10)
    v_add_u32 v12, 1, v12
    v_lshrrev_b32 v12, 1, v12
    v_max_u32 v12, 1, v12
    v_cndmask_b32 v12, 0, v12, s[62:63]
    s_lshl_b32 s67, s4, 3
    s_movk_i32 s58, 2304
    v_add_u32_dpp v51, v12, v12 row_shl:1 row_mask:0xf bank_mask:0xf bound_ctrl:1
    s_nop 1
    v_add_u32_dpp v51, v51, v51 row_shl:2 row_mask:0xf bank_mask:0xf bound_ctrl:1
    s_nop 1
    v_add_u32_dpp v51, v12, v51 row_shl:4 row_mask:0xf bank_mask:0x5 bound_ctrl:1
    s_waitcnt lgkmcnt(0)
    v_lshlrev_b32 v8, 16, v8
    v_lshl_add_u32 v5, v5, 10, v51
    v_sub_u32 v6, v55, v51
    v_cmp_le_u32 vcc, 72, v5
    v_lshlrev_b32 v6, 1, v6
    v_subrev_u32 v12, 1, v12
    s_cbranch_vccnz L_slow
    v_and_b32 v12, 0xff, v12
    v_lshl_add_u32 v9, v12, 18, v9
    s_mov_b64 exec, s[62:63]
    ds_write_b32 v50, v6 offset:160
    s_mov_b64 exec, -1
    s_sub_u32 s63, s67, 1
    v_readlane_b32 s67, v51, s67
    v_cmpx_lt_i32 vcc, 0, v48
    ds_read_b32 v24, v24 offset:160
    v_cmpx_lt_i32 vcc, 1, v48
    ds_read_b32 v25, v25 offset:160
    v_cmpx_lt_i32 vcc, 2, v48
    ds_read_b32 v26, v26 offset:160
    v_cmpx_lt_i32 vcc, 3, v48
    ds_read_b32 v27, v27 offset:160
    v_cmpx_lt_i32 vcc, 8, v48
    s_cbranch_execz L_l2
    s_waitcnt lgkmcnt(2)
    ds_read_b32 v28, v28 offset:160
    v_cmpx_lt_i32 vcc, 9, v48
    s_cbranch_execz L_l2
    ds_read_b32 v29, v29 offset:160
    v_cmpx_lt_i32 vcc, 10, v48
    s_cbranch_execz L_l2
    ds_read_b32 v30, v30 offset:160
    v_cmpx_lt_i32 vcc, 11, v48
    s_cbranch_execz L_l2
    ds_read_b32 v31, v31 offset:160
L_l2:
    s_mov_b64 exec, -1
    s_lshr_b32 s66, s67, 3
    s_add_u32 s60, s66, 1
    s_lshl_b32 s60, s60, 3
    s_sub_u32 s67, s60, s67
    s_sub_u32 s62, s67, 1
    s_add_u32 s61, s4, 1
    s_mul_i32 s61, s61, 72
    s_sub_u32 s60, s61, s60
    s_lshl_b32 s60, s60, 2
    s_waitcnt lgkmcnt(0)
    v_cmpx_lt_i32 vcc, 0, v48
    v_add_u32 v24, v24, v32
    v_lshl_add_u32 v5, v24, 1, v57
    ds_write_b16 v5, v40
    v_lshrrev_b32 v6, 1, v24
    v_lshl_add_u32 v6, v6, 2, v60
    v_and_b32 v7, 1, v24
    v_mad_u32_u24 v6, v7, s58, v6
    ds_write_b32 v6, v16
    v_cmpx_lt_i32 vcc, 1, v48
    v_add_u32 v25, v25, v33
    v_lshl_add_u32 v5, v25, 1, v57
    ds_write_b16 v5, v41
    v_lshrrev_b32 v6, 1, v25
    v_lshl_add_u32 v6, v6, 2, v60
    v_and_b32 v7, 1, v25
    v_mad_u32_u24 v6, v7, s58, v6
    ds_write_b32 v6, v17
    v_cmpx_lt_i32 vcc, 2, v48
    v_add_u32 v26, v26, v34
    v_lshl_add_u32 v5, v26, 1, v57
    ds_write_b16 v5, v42
    v_lshrrev_b32 v6, 1, v26
    v_lshl_add_u32 v6, v6, 2, v60
    v_and_b32 v7, 1, v26
    v_mad_u32_u24 v6, v7, s58, v6
    ds_write_b32 v6, v18
    v_cmpx_lt_i32 vcc, 3, v48
    v_add_u32 v27, v27, v35
    v_lshl_add_u32 v5, v27, 1, v57
    ds_write_b16 v5, v43
    v_lshrrev_b32 v6, 1, v27
    v_lshl_add_u32 v6, v6, 2, v60
    v_and_b32 v7, 1, v27
    v_mad_u32_u24 v6, v7, s58, v6
    ds_write_b32 v6, v19
    v_cmpx_lt_i32 vcc, 8, v48
    s_cbranch_execz L_l3
    s_waitcnt lgkmcnt(2)
    v_add_u32 v28, v28, v36
    v_lshl_add_u32 v5, v28, 1, v57
    ds_write_b16 v5, v44
    v_lshrrev_b32 v6, 1, v28
    v_lshl_add_u32 v6, v6, 2, v60
    v_and_b32 v7, 1, v28
    v_mad_u32_u24 v6, v7, s58, v6
    ds_write_b32 v6, v20
    v_cmpx_lt_i32 vcc, 9, v48
    s_cbranch_execz L_l3
    v_add_u32 v29, v29, v37
    v_lshl_add_u32 v5, v29, 1, v57
    ds_write_b16 v5, v45
    v_lshrrev_b32 v6, 1, v29
    v_lshl_add_u32 v6, v6, 2, v60
    v_and_b32 v7, 1, v29
    v_mad_u32_u24 v6, v7, s58, v6
    ds_write_b32 v6, v21
    v_cmpx_lt_i32 vcc, 10, v48
    s_cbranch_execz L_l3
    v_add_u32 v30, v30, v38
    v_lshl_add_u32 v5, v30, 1, v57
    ds_write_b16 v5, v46
    v_lshrrev_b32 v6, 1, v30
    v_lshl_add_u32 v6, v6, 2, v60
    v_and_b32 v7, 1, v30
    v_mad_u32_u24 v6, v7, s58, v6
    ds_write_b32 v6, v22
    v_cmpx_lt_i32 vcc, 11, v48
    s_cbranch_execz L_l3
    v_add_u32 v31, v31, v39
    v_lshl_add_u32 v5, v31, 1, v57
    ds_write_b16 v5, v47
    v_lshrrev_b32 v6, 1, v31
    v_lshl_add_u32 v6, v6, 2, v60
    v_and_b32 v7, 1, v31
    v_mad_u32_u24 v6, v7, s58, v6
    ds_write_b32 v6, v23
L_l3:
    s_mov_b64 exec, -1
    ds_add_u32 v61, v62 offset:16
    v_lshrrev_b32 v5, 5, v0
    v_mad_u32_u24 v13, v5, s58, v60
    v_add_u32 v13, s60, v13
    v_lshl_add_u32 v14, v5, 1, v57
    v_and_b32 v5, 28, v0
    v_add3_u32 v14, v14, v5, s60
    s_mov_b32 s65, 201487168
    s_mov_b32 s64, 0
    s_mov_b32 s59, 0
Lw_11:
    ds_read_b32 v4, v3 offset:16
    s_waitcnt lgkmcnt(0)
    v_cmp_gt_u32 vcc, 8, v4
    s_cbranch_vccz Lk_12
    s_add_u32 s59, s59, 1
    s_cmp_lt_u32 s59, 4194304
    s_cbranch_scc1 Lw_11
    s_branch L_end
Lk_12:
    v_mov_b32 v12, v3
    v_mov_b32 v3, v2
    s_mov_b64 vcc, 0
    s_setprio 1
    s_cmp_lt_u32 s4, 4
    s_cbranch_scc1 L_old
    s_setprio 2
L_old:
    ds_read_b128 v[56:59], v13 offset:0
    ds_read_b128 v[60:63], v13 offset:16
    ds_read_u16 v1, v14
    ds_read_b128 v[48:51], v13 offset:32
    ds_read_b128 v[52:55], v13 offset:48
    s_waitcnt lgkmcnt(3)
L_p0:
    s_cmp_ge_u32 s67, 4
    s_cbranch_scc1 L_p4
    s_cmp_gt_u32 s67, 1
    s_cbranch_scc1 Lps_13
    v_add_u32 v57, v57, v2
    buffer_load_dwordx4 v[20:23], v57, s[8:11], 0 offen
Lps_13:
    s_cmp_gt_u32 s67, 2
    s_cbranch_scc1 Lps_14
    v_add_u32 v58, v58, v2
    buffer_load_dwordx4 v[24:27], v58, s[8:11], 0 offen
Lps_14:
    s_cmp_gt_u32 s67, 3
    s_cbranch_scc1 Lps_15
    v_add_u32 v59, v59, v2
    buffer_load_dwordx4 v[28:31], v59, s[8:11], 0 offen
Lps_15:
L_p4:
    s_cmp_gt_u32 s67, 4
    s_cbranch_scc1 Lps_16
    v_add_u32 v60, v60, v2
    buffer_load_dwordx4 v[32:35], v60, s[8:11], 0 offen
Lps_16:
    s_cmp_gt_u32 s67, 5
    s_cbranch_scc1 Lps_17
    v_add_u32 v61, v61, v2
    buffer_load_dwordx4 v[36:39], v61, s[8:11], 0 offen
Lps_17:
    s_cmp_gt_u32 s67, 6
    s_cbranch_scc1 Lps_18
    v_add_u32 v62, v62, v2
    buffer_load_dwordx4 v[40:43], v62, s[8:11], 0 offen
Lps_18:
    s_cmp_gt_u32 s67, 7
    s_cbranch_scc1 Lps_19
    v_add_u32 v63, v63, v2
    buffer_load_dwordx4 v[44:47], v63, s[8:11], 0 offen
Lps_19:
    s_cmp_eq_u32 s66, 0
    s_cbranch_scc1 L_drain
L_gl:
    s_waitcnt lgkmcnt(1)
    v_perm_b32 v6, v1, v1, v10
    v_perm_b32 v7, v1, v1, v11
    ds_read_u16 v1, v14 offset:32
    s_waitcnt vmcnt(6)
    v_lshl_add_u64 v[4:5], v[48:49], 0, v[2:3]
    s_sub_u32 s62, s62, 2
    s_cbranch_scc1 Lfs_0
    v_mfma_f32_4x4x4_16b_bf16 v[56:59], v[6:7], v[16:17], v[56:59] cbsz:3 abid:0
    v_mfma_f32_4x4x4_16b_bf16 v[60:63], v[6:7], v[18:19], v[60:63] cbsz:3 abid:0
    buffer_load_dwordx4 v[16:19], v4, s[8:11], 0 offen
    v_mfma_f32_4x4x4_16b_bf16 v[56:59], v[6:7], v[20:21], v[56:59] cbsz:3 abid:1
    v_mfma_f32_4x4x4_16b_bf16 v[60:63], v[6:7], v[22:23], v[60:63] cbsz:3 abid:1
    buffer_load_dwordx4 v[20:23], v5, s[8:11], 0 offen
Lbs_0:
    s_waitcnt vmcnt(6)
    v_lshl_add_u64 v[4:5], v[50:51], 0, v[2:3]
    s_sub_u32 s62, s62, 2
    s_cbranch_scc1 Lfs_2
    v_mfma_f32_4x4x4_16b_bf16 v[56:59], v[6:7], v[24:25], v[56:59] cbsz:3 abid:2
    v_mfma_f32_4x4x4_16b_bf16 v[60:63], v[6:7], v[26:27], v[60:63] cbsz:3 abid:2
    buffer_load_dwordx4 v[24:27], v4, s[8:11], 0 offen
    v_mfma_f32_4x4x4_16b_bf16 v[56:59], v[6:7], v[28:29], v[56:59] cbsz:3 abid:3
    v_mfma_f32_4x4x4_16b_bf16 v[60:63], v[6:7], v[30:31], v[60:63] cbsz:3 abid:3
    buffer_load_dwordx4 v[28:31], v5, s[8:11], 0 offen
Lbs_2:
    ds_read_b128 v[48:51], v13 offset:64
    s_waitcnt vmcnt(6) lgkmcnt(2)
    v_lshl_add_u64 v[4:5], v[52:53], 0, v[2:3]
    s_sub_u32 s62, s62, 2
    s_cbranch_scc1 Lfs_4
    v_mfma_f32_4x4x4_16b_bf16 v[56:59], v[6:7], v[32:33], v[56:59] cbsz:3 abid:4
    v_mfma_f32_4x4x4_16b_bf16 v[60:63], v[6:7], v[34:35], v[60:63] cbsz:3 abid:4
    buffer_load_dwordx4 v[32:35], v4, s[8:11], 0 offen
    v_mfma_f32_4x4x4_16b_bf16 v[56:59], v[6:7], v[36:37], v[56:59] cbsz:3 abid:5
    v_mfma_f32_4x4x4_16b_bf16 v[60:63], v[6:7], v[38:39], v[60:63] cbsz:3 abid:5
    buffer_load_dwordx4 v[36:39], v5, s[8:11], 0 offen
Lbs_4:
    s_waitcnt vmcnt(6)
    v_lshl_add_u64 v[4:5], v[54:55], 0, v[2:3]
    s_sub_u32 s62, s62, 2
    s_cbranch_scc1 Lfs_6
    v_mfma_f32_4x4x4_16b_bf16 v[56:59], v[6:7], v[40:41], v[56:59] cbsz:3 abid:6
    v_mfma_f32_4x4x4_16b_bf16 v[60:63], v[6:7], v[42:43], v[60:63] cbsz:3 abid:6
    buffer_load_dwordx4 v[40:43], v4, s[8:11], 0 offen
    v_mfma_f32_4x4x4_16b_bf16 v[56:59], v[6:7], v[44:45], v[56:59] cbsz:3 abid:7
    v_mfma_f32_4x4x4_16b_bf16 v[60:63], v[6:7], v[46:47], v[60:63] cbsz:3 abid:7
    buffer_load_dwordx4 v[44:47], v5, s[8:11], 0 offen
Lbs_6:
    ds_read_b128 v[52:55], v13 offset:80
    v_add_u32 v13, 32, v13
    v_add_u32 v14, 32, v14
    s_sub_u32 s66, s66, 1
    s_cmp_eq_u32 s66, 3
    s_cbranch_scc0 L_nf
    s_setprio 1
L_nf:
    s_cmp_lg_u32 s66, 0
    s_cbranch_scc1 L_gl
L_drain:
    s_waitcnt lgkmcnt(0)
    v_perm_b32 v6, v1, v1, v10
    v_perm_b32 v7, v1, v1, v11
    ds_read_u16 v1, v14 offset:32
    s_waitcnt vmcnt(7)
    v_mfma_f32_4x4x4_16b_bf16 v[56:59], v[6:7], v[16:17], v[56:59] cbsz:3 abid:0
    v_mfma_f32_4x4x4_16b_bf16 v[60:63], v[6:7], v[18:19], v[60:63] cbsz:3 abid:0
    s_sub_u32 s62, s62, 1
    s_cbranch_scc1 Lfd_0
Lbd_0:
    s_waitcnt vmcnt(6)
    v_mfma_f32_4x4x4_16b_bf16 v[56:59], v[6:7], v[20:21], v[56:59] cbsz:3 abid:1
    v_mfma_f32_4x4x4_16b_bf16 v[60:63], v[6:7], v[22:23], v[60:63] cbsz:3 abid:1
    s_sub_u32 s62, s62, 1
    s_cbranch_scc1 Lfd_1
Lbd_1:
    s_waitcnt vmcnt(5)
    v_mfma_f32_4x4x4_16b_bf16 v[56:59], v[6:7], v[24:25], v[56:59] cbsz:3 abid:2
    v_mfma_f32_4x4x4_16b_bf16 v[60:63], v[6:7], v[26:27], v[60:63] cbsz:3 abid:2
    s_sub_u32 s62, s62, 1
    s_cbranch_scc1 Lfd_2
Lbd_2:
    s_waitcnt vmcnt(4)
    v_mfma_f32_4x4x4_16b_bf16 v[56:59], v[6:7], v[28:29], v[56:59] cbsz:3 abid:3
    v_mfma_f32_4x4x4_16b_bf16 v[60:63], v[6:7], v[30:31], v[60:63] cbsz:3 abid:3
    s_sub_u32 s62, s62, 1
    s_cbranch_scc1 Lfd_3
Lbd_3:
    s_waitcnt vmcnt(3)
    v_mfma_f32_4x4x4_16b_bf16 v[56:59], v[6:7], v[32:33], v[56:59] cbsz:3 abid:4
    v_mfma_f32_4x4x4_16b_bf16 v[60:63], v[6:7], v[34:35], v[60:63] cbsz:3 abid:4
    s_sub_u32 s62, s62, 1
    s_cbranch_scc1 Lfd_4
Lbd_4:
    s_waitcnt vmcnt(2)
    v_mfma_f32_4x4x4_16b_bf16 v[56:59], v[6:7], v[36:37], v[56:59] cbsz:3 abid:5
    v_mfma_f32_4x4x4_16b_bf16 v[60:63], v[6:7], v[38:39], v[60:63] cbsz:3 abid:5
    s_sub_u32 s62, s62, 1
    s_cbranch_scc1 Lfd_5
Lbd_5:
    s_waitcnt vmcnt(1)
    v_mfma_f32_4x4x4_16b_bf16 v[56:59], v[6:7], v[40:41], v[56:59] cbsz:3 abid:6
    v_mfma_f32_4x4x4_16b_bf16 v[60:63], v[6:7], v[42:43], v[60:63] cbsz:3 abid:6
    s_sub_u32 s62, s62, 1
    s_cbranch_scc1 Lfd_6
Lbd_6:
    s_waitcnt vmcnt(0)
    v_mfma_f32_4x4x4_16b_bf16 v[56:59], v[6:7], v[44:45], v[56:59] cbsz:3 abid:7
    v_mfma_f32_4x4x4_16b_bf16 v[60:63], v[6:7], v[46:47], v[60:63] cbsz:3 abid:7
    s_nop 1
    s_call_b64 s[68:69], L_flush
L_gdone:
    s_endpgm
Lfs_0:
    s_add_u32 s62, s62, 2
    v_mfma_f32_4x4x4_16b_bf16 v[56:59], v[6:7], v[16:17], v[56:59] cbsz:3 abid:0
    v_mfma_f32_4x4x4_16b_bf16 v[60:63], v[6:7], v[18:19], v[60:63] cbsz:3 abid:0
    buffer_load_dwordx4 v[16:19], v4, s[8:11], 0 offen
    s_sub_u32 s62, s62, 1
    s_cbranch_scc0 Lsk_20
    s_call_b64 s[68:69], L_flush
Lsk_20:
    v_mfma_f32_4x4x4_16b_bf16 v[56:59], v[6:7], v[20:21], v[56:59] cbsz:3 abid:1
    v_mfma_f32_4x4x4_16b_bf16 v[60:63], v[6:7], v[22:23], v[60:63] cbsz:3 abid:1
    buffer_load_dwordx4 v[20:23], v5, s[8:11], 0 offen
    s_sub_u32 s62, s62, 1
    s_cbranch_scc0 Lbs_0
    s_call_b64 s[68:69], L_flush
    s_branch Lbs_0
Lfs_2:
    s_add_u32 s62, s62, 2
    v_mfma_f32_4x4x4_16b_bf16 v[56:59], v[6:7], v[24:25], v[56:59] cbsz:3 abid:2
    v_mfma_f32_4x4x4_16b_bf16 v[60:63], v[6:7], v[26:27], v[60:63] cbsz:3 abid:2
    buffer_load_dwordx4 v[24:27], v4, s[8:11], 0 offen
    s_sub_u32 s62, s62, 1
    s_cbranch_scc0 Lsk_22
    s_call_b64 s[68:69], L_flush
Lsk_22:
    v_mfma_f32_4x4x4_16b_bf16 v[56:59], v[6:7], v[28:29], v[56:59] cbsz:3 abid:3
    v_mfma_f32_4x4x4_16b_bf16 v[60:63], v[6:7], v[30:31], v[60:63] cbsz:3 abid:3
    buffer_load_dwordx4 v[28:31], v5, s[8:11], 0 offen
    s_sub_u32 s62, s62, 1
    s_cbranch_scc0 Lbs_2
    s_call_b64 s[68:69], L_flush
    s_branch Lbs_2
Lfs_4:
    s_add_u32 s62, s62, 2
    v_mfma_f32_4x4x4_16b_bf16 v[56:59], v[6:7], v[32:33], v[56:59] cbsz:3 abid:4
    v_mfma_f32_4x4x4_16b_bf16 v[60:63], v[6:7], v[34:35], v[60:63] cbsz:3 abid:4
    buffer_load_dwordx4 v[32:35], v4, s[8:11], 0 offen
    s_sub_u32 s62, s62, 1
    s_cbranch_scc0 Lsk_24
    s_call_b64 s[68:69], L_flush
Lsk_24:
    v_mfma_f32_4x4x4_16b_bf16 v[56:59], v[6:7], v[36:37], v[56:59] cbsz:3 abid:5
    v_mfma_f32_4x4x4_16b_bf16 v[60:63], v[6:7], v[38:39], v[60:63] cbsz:3 abid:5
    buffer_load_dwordx4 v[36:39], v5, s[8:11], 0 offen
    s_sub_u32 s62, s62, 1
    s_cbranch_scc0 Lbs_4
    s_call_b64 s[68:69], L_flush
    s_branch Lbs_4
Lfs_6:
    s_add_u32 s62, s62, 2
    v_mfma_f32_4x4x4_16b_bf16 v[56:59], v[6:7], v[40:41], v[56:59] cbsz:3 abid:6
    v_mfma_f32_4x4x4_16b_bf16 v[60:63], v[6:7], v[42:43], v[60:63] cbsz:3 abid:6
    buffer_load_dwordx4 v[40:43], v4, s[8:11], 0 offen
    s_sub_u32 s62, s62, 1
    s_cbranch_scc0 Lsk_26
    s_call_b64 s[68:69], L_flush
Lsk_26:
    v_mfma_f32_4x4x4_16b_bf16 v[56:59], v[6:7], v[44:45], v[56:59] cbsz:3 abid:7
    v_mfma_f32_4x4x4_16b_bf16 v[60:63], v[6:7], v[46:47], v[60:63] cbsz:3 abid:7
    buffer_load_dwordx4 v[44:47], v5, s[8:11], 0 offen
    s_sub_u32 s62, s62, 1
    s_cbranch_scc0 Lbs_6
    s_call_b64 s[68:69], L_flush
    s_branch Lbs_6
Lfd_0:
    s_call_b64 s[68:69], L_flush
    s_branch Lbd_0
Lfd_1:
    s_call_b64 s[68:69], L_flush
    s_branch Lbd_1
Lfd_2:
    s_call_b64 s[68:69], L_flush
    s_branch Lbd_2
Lfd_3:
    s_call_b64 s[68:69], L_flush
    s_branch Lbd_3
Lfd_4:
    s_call_b64 s[68:69], L_flush
    s_branch Lbd_4
Lfd_5:
    s_call_b64 s[68:69], L_flush
    s_branch Lbd_5
Lfd_6:
    s_call_b64 s[68:69], L_flush
    s_branch Lbd_6
L_flush:
    s_and_b32 s101, s65, 0x3ffff
    s_add_u32 s63, s63, 1
    v_permlane32_swap_b32 v56, v60
    v_permlane32_swap_b32 v57, v61
    v_permlane32_swap_b32 v58, v62
    v_permlane32_swap_b32 v59, v63
    s_lshr_b32 s62, s65, 26
    v_pk_add_f32 v[56:57], v[56:57], v[60:61]
    v_pk_add_f32 v[58:59], v[58:59], v[62:63]
    v_add_u32 v62, s101, v15
    v_pk_mul_f32 v[56:57], v[56:57], s[64:65] op_sel_hi:[1,0]
    v_pk_mul_f32 v[58:59], v[58:59], s[64:65] op_sel_hi:[1,0]
    v_lshl_add_u32 v63, s62, 2, v12
    v_cvt_pk_bf16_f32 v60, v56, v57
    v_cvt_pk_bf16_f32 v61, v58, v59
    ds_write_b64 v62, v[60:61]
    s_mov_b64 exec, 1
    ds_inc_u32 v63, v63 offset:36
    s_mov_b64 exec, -1
    v_readlane_b32 s65, v9, s63
    v_readlane_b32 s64, v8, s63
    v_mov_b64 v[56:57], 0
    v_mov_b64 v[58:59], 0
    v_mov_b64 v[60:61], 0
    v_mov_b64 v[62:63], 0
    s_bfe_u32 s62, s65, 0x80012
    s_setpc_b64 s[68:69]
L_preA:
    s_setprio 2
    s_mul_i32 s5, s6, 40
    v_mov_b32 v3, 159424
    s_mov_b32 s10, 5120000
    s_mov_b32 s11, 0x20000
    s_add_u32 s16, s56, 0
    s_addc_u32 s17, s57, 0
    s_mov_b32 s18, 4194304
    s_mov_b32 s19, 0x20000
    v_and_b32 v6, 32, v0
    v_lshl_add_u32 v5, v6, 7, v2
    v_lshl_add_u32 v6, v6, 6, v2
    s_add_u32 s58, s3, s5
    s_mul_i32 s59, s3, 1056
    s_add_u32 m0, s59, 84480
    s_lshl_b32 s58, s58, 9
    buffer_load_dwordx4 v5, s[8:11], s58 offen lds
    s_add_u32 m0, s59, 92928
    s_add_u32 s58, s58, 8192
    buffer_load_dwordx4 v5, s[8:11], s58 offen lds
    s_cmp_ge_u32 s3, 4
    s_cbranch_scc1 L_xa2
    s_add_u32 m0, s59, 101376
    s_add_u32 s58, s58, 8192
    buffer_load_dwordx4 v6, s[8:11], s58 offen lds
L_xa2:
    v_and_b32 v4, 7, v0
    v_mul_u32_u24 v1, 1056, v4
    v_and_b32 v4, 8, v0
    v_lshl_add_u32 v1, v4, 6, v1
    v_and_b32 v4, 48, v0
    v_add_u32 v1, v4, v1
    v_add_u32 v12, 84480, v1
    s_mov_b64 s[20:21], s[52:53]
    s_mov_b32 s22, 5120000
    s_mov_b32 s23, 0x20000
    v_lshlrev_b32 v14, 4, v0
    s_lshl_b32 s61, s3, 6
    s_add_u32 s61, s61, 105600
    v_add_u32 v13, s61, v1
    s_lshl_b32 s100, s3, 14
    s_add_u32 s100, s100, 655360
    s_waitcnt lgkmcnt(0)
    v_lshl_add_u32 v104, s32, 9, v2
    v_lshl_add_u32 v105, s33, 9, v2
    v_lshl_add_u32 v106, s34, 9, v2
    v_lshl_add_u32 v107, s35, 9, v2
    v_lshl_add_u32 v108, s36, 9, v2
    v_lshl_add_u32 v109, s37, 9, v2
    v_lshl_add_u32 v110, s38, 9, v2
    v_lshl_add_u32 v111, s39, 9, v2
    v_lshl_add_u32 v112, s64, 9, v2
    v_lshl_add_u32 v113, s65, 9, v2
    s_mov_b32 exec_lo, 0
    v_lshl_add_u32 v104, s40, 9, v2
    v_lshl_add_u32 v105, s41, 9, v2
    v_lshl_add_u32 v106, s42, 9, v2
    v_lshl_add_u32 v107, s43, 9, v2
    v_lshl_add_u32 v108, s44, 9, v2
    v_lshl_add_u32 v109, s45, 9, v2
    v_lshl_add_u32 v110, s46, 9, v2
    v_lshl_add_u32 v111, s47, 9, v2
    v_lshl_add_u32 v112, s66, 9, v2
    v_lshl_add_u32 v113, s67, 9, v2
    s_mov_b64 exec, -1
    s_mul_i32 s67, s3, 2112
    s_mul_i32 s66, s3, 8448
    s_add_u32 m0, s66, 0
    s_waitcnt vmcnt(1)
    buffer_load_dwordx4 v104, s[8:11], 0 offen lds
    s_add_u32 m0, s66, 1056
    s_waitcnt vmcnt(1)
    buffer_load_dwordx4 v105, s[8:11], 0 offen lds
    v_and_b32 v4, 3, v0
    v_mov_b32 v5, 0x0c0c0c0c
    v_mov_b32 v6, 0x0c0c0302
    v_mov_b32 v7, 0x03020c0c
    v_cmp_eq_u32 s[58:59], 0, v4
    v_cmp_eq_u32 s[60:61], 2, v4
    v_cmp_eq_u32 vcc, 1, v4
    v_cndmask_b32 v8, v5, v6, s[58:59]
    v_cndmask_b32 v9, v5, v6, s[60:61]
    v_cndmask_b32 v8, v8, v7, vcc
    v_cmp_eq_u32 vcc, 3, v4
    s_nop 1
    v_cndmask_b32 v9, v9, v7, vcc
    v_mov_b32 v10, v8
    v_mov_b32 v11, v9
    v_and_b32 v8, 0xfdfdfdfd, v8
    v_and_b32 v9, 0xfdfdfdfd, v9
    s_add_u32 m0, s66, 2112
    s_waitcnt vmcnt(1)
    buffer_load_dwordx4 v106, s[8:11], 0 offen lds
    s_mov_b64 exec, 1
    v_mov_b32 v4, 1
    ds_add_u32 v3, v4 offset:0
    s_mov_b64 exec, -1
    s_add_u32 m0, s66, 3168
    s_waitcnt vmcnt(1)
    buffer_load_dwordx4 v107, s[8:11], 0 offen lds
    s_add_u32 m0, s66, 4224
    s_waitcnt vmcnt(1)
    buffer_load_dwordx4 v108, s[8:11], 0 offen lds
    s_add_u32 m0, s66, 5280
    s_waitcnt vmcnt(1)
    buffer_load_dwordx4 v109, s[8:11], 0 offen lds
    s_add_u32 m0, s66, 6336
    s_waitcnt vmcnt(1)
    buffer_load_dwordx4 v110, s[8:11], 0 offen lds
    s_mov_b64 exec, 1
    v_mov_b32 v4, 1
    ds_add_u32 v3, v4 offset:60
    s_mov_b64 exec, -1
    s_mov_b32 s59, 0
Lw_28:
    ds_read_b32 v4, v3 offset:0
    s_waitcnt lgkmcnt(0)
    v_cmp_gt_u32 vcc, 8, v4
    s_cbranch_vccz Lk_29
    s_add_u32 s59, s59, 1
    s_cmp_lt_u32 s59, 4194304
    s_cbranch_scc1 Lw_28
    s_branch L_end
Lk_29:
    ds_read_b128 v[80:83], v12 offset:0
    ds_read_b128 v[84:87], v12 offset:8448
    ds_read_b128 v[88:91], v12 offset:16896
    s_add_u32 m0, s66, 7392
    s_waitcnt vmcnt(1)
    buffer_load_dwordx4 v111, s[8:11], 0 offen lds
    s_waitcnt vmcnt(1)
    ds_read_b32 v4, v3 offset:52
    s_add_u32 m0, s67, 67584
    s_waitcnt vmcnt(1)
    buffer_load_dwordx4 v112, s[8:11], 0 offen lds
    s_waitcnt lgkmcnt(0)
    v_cmp_gt_u32 vcc, 8, v4
    s_cbranch_vccz L_eu9
    s_waitcnt vmcnt(1)
    ds_read_b32 v4, v3 offset:52
    s_add_u32 m0, s67, 68640
    s_waitcnt vmcnt(1)
    buffer_load_dwordx4 v113, s[8:11], 0 offen lds
    s_mov_b32 s59, 0
Lw_30:
    ds_read_b32 v4, v3 offset:52
    s_waitcnt lgkmcnt(0)
    v_cmp_gt_u32 vcc, 8, v4
    s_cbranch_vccz Lk_31
    s_sleep 1
    s_add_u32 s59, s59, 1
    s_cmp_lt_u32 s59, 4194304
    s_cbranch_scc1 Lw_30
    s_branch L_end
Lk_31:
    s_branch L_eu10
L_eu9:
    s_add_u32 m0, s67, 68640
    s_waitcnt vmcnt(63)
    buffer_load_dwordx4 v113, s[8:11], 0 offen lds
L_eu10:
    s_setprio 3
    buffer_load_dwordx4 v[16:19], v14, s[16:19], s100 offen offset:0 sc1
    buffer_load_dwordx4 v[20:23], v14, s[16:19], s100 offen offset:1024 sc1
    buffer_load_dwordx4 v[24:27], v14, s[16:19], s100 offen offset:2048 sc1
    buffer_load_dwordx4 v[28:31], v14, s[16:19], s100 offen offset:3072 sc1
    s_add_u32 s100, s100, 4096
    buffer_load_dwordx4 v[32:35], v14, s[16:19], s100 offen offset:0 sc1
    buffer_load_dwordx4 v[36:39], v14, s[16:19], s100 offen offset:1024 sc1
    buffer_load_dwordx4 v[40:43], v14, s[16:19], s100 offen offset:2048 sc1
    buffer_load_dwordx4 v[44:47], v14, s[16:19], s100 offen offset:3072 sc1
    s_add_u32 s100, s100, 4096
    buffer_load_dwordx4 v[48:51], v14, s[16:19], s100 offen offset:0 sc1
    buffer_load_dwordx4 v[52:55], v14, s[16:19], s100 offen offset:1024 sc1
    buffer_load_dwordx4 v[56:59], v14, s[16:19], s100 offen offset:2048 sc1
    buffer_load_dwordx4 v[60:63], v14, s[16:19], s100 offen offset:3072 sc1
    s_add_u32 s100, s100, 4096
    buffer_load_dwordx4 v[64:67], v14, s[16:19], s100 offen offset:0 sc1
    buffer_load_dwordx4 v[68:71], v14, s[16:19], s100 offen offset:1024 sc1
    buffer_load_dwordx4 v[72:75], v14, s[16:19], s100 offen offset:2048 sc1
    buffer_load_dwordx4 v[76:79], v14, s[16:19], s100 offen offset:3072 sc1
    s_setprio 0
    ds_read_b128 v[92:95], v12 offset:64
    ds_read_b128 v[96:99], v12 offset:8512
    ds_read_b128 v[100:103], v12 offset:16960
    s_waitcnt vmcnt(14) lgkmcnt(3)
    v_mfma_f32_16x16x32_bf16 v[104:107], v[16:19], v[80:83], 0
    v_mfma_f32_16x16x32_bf16 v[108:111], v[20:23], v[80:83], 0
    v_mfma_f32_16x16x32_bf16 v[112:115], v[16:19], v[84:87], 0
    v_mfma_f32_16x16x32_bf16 v[116:119], v[20:23], v[84:87], 0
    v_mfma_f32_16x16x32_bf16 v[120:123], v[16:19], v[88:91], 0
    v_mfma_f32_16x16x32_bf16 v[124:127], v[20:23], v[88:91], 0
    ds_read_b128 v[80:83], v12 offset:128
    ds_read_b128 v[84:87], v12 offset:8576
    ds_read_b128 v[88:91], v12 offset:17024
    s_waitcnt vmcnt(12) lgkmcnt(3)
    v_mfma_f32_16x16x32_bf16 v[104:107], v[24:27], v[92:95], v[104:107]
    v_mfma_f32_16x16x32_bf16 v[108:111], v[28:31], v[92:95], v[108:111]
    v_mfma_f32_16x16x32_bf16 v[112:115], v[24:27], v[96:99], v[112:115]
    v_mfma_f32_16x16x32_bf16 v[116:119], v[28:31], v[96:99], v[116:119]
    v_mfma_f32_16x16x32_bf16 v[120:123], v[24:27], v[100:103], v[120:123]
    v_mfma_f32_16x16x32_bf16 v[124:127], v[28:31], v[100:103], v[124:127]
    ds_read_b128 v[92:95], v12 offset:192
    ds_read_b128 v[96:99], v12 offset:8640
    ds_read_b128 v[100:103], v12 offset:17088
    s_waitcnt vmcnt(10) lgkmcnt(3)
    v_mfma_f32_16x16x32_bf16 v[104:107], v[32:35], v[80:83], v[104:107]
    v_mfma_f32_16x16x32_bf16 v[108:111], v[36:39], v[80:83], v[108:111]
    v_mfma_f32_16x16x32_bf16 v[112:115], v[32:35], v[84:87], v[112:115]
    v_mfma_f32_16x16x32_bf16 v[116:119], v[36:39], v[84:87], v[116:119]
    v_mfma_f32_16x16x32_bf16 v[120:123], v[32:35], v[88:91], v[120:123]
    v_mfma_f32_16x16x32_bf16 v[124:127], v[36:39], v[88:91], v[124:127]
    ds_read_b128 v[80:83], v12 offset:256
    ds_read_b128 v[84:87], v12 offset:8704
    ds_read_b128 v[88:91], v12 offset:17152
    s_waitcnt vmcnt(8) lgkmcnt(3)
    v_mfma_f32_16x16x32_bf16 v[104:107], v[40:43], v[92:95], v[104:107]
    v_mfma_f32_16x16x32_bf16 v[108:111], v[44:47], v[92:95], v[108:111]
    v_mfma_f32_16x16x32_bf16 v[112:115], v[40:43], v[96:99], v[112:115]
    v_mfma_f32_16x16x32_bf16 v[116:119], v[44:47], v[96:99], v[116:119]
    v_mfma_f32_16x16x32_bf16 v[120:123], v[40:43], v[100:103], v[120:123]
    v_mfma_f32_16x16x32_bf16 v[124:127], v[44:47], v[100:103], v[124:127]
    ds_read_b128 v[92:95], v12 offset:320
    ds_read_b128 v[96:99], v12 offset:8768
    ds_read_b128 v[100:103], v12 offset:17216
    s_waitcnt vmcnt(6) lgkmcnt(3)
    v_mfma_f32_16x16x32_bf16 v[104:107], v[48:51], v[80:83], v[104:107]
    v_mfma_f32_16x16x32_bf16 v[108:111], v[52:55], v[80:83], v[108:111]
    v_mfma_f32_16x16x32_bf16 v[112:115], v[48:51], v[84:87], v[112:115]
    v_mfma_f32_16x16x32_bf16 v[116:119], v[52:55], v[84:87], v[116:119]
    v_mfma_f32_16x16x32_bf16 v[120:123], v[48:51], v[88:91], v[120:123]
    v_mfma_f32_16x16x32_bf16 v[124:127], v[52:55], v[88:91], v[124:127]
    ds_read_b128 v[80:83], v12 offset:384
    ds_read_b128 v[84:87], v12 offset:8832
    ds_read_b128 v[88:91], v12 offset:17280
    s_waitcnt vmcnt(4) lgkmcnt(3)
    v_mfma_f32_16x16x32_bf16 v[104:107], v[56:59], v[92:95], v[104:107]
    v_mfma_f32_16x16x32_bf16 v[108:111], v[60:63], v[92:95], v[108:111]
    v_mfma_f32_16x16x32_bf16 v[112:115], v[56:59], v[96:99], v[112:115]
    v_mfma_f32_16x16x32_bf16 v[116:119], v[60:63], v[96:99], v[116:119]
    v_mfma_f32_16x16x32_bf16 v[120:123], v[56:59], v[100:103], v[120:123]
    v_mfma_f32_16x16x32_bf16 v[124:127], v[60:63], v[100:103], v[124:127]
    ds_read_b128 v[92:95], v12 offset:448
    ds_read_b128 v[96:99], v12 offset:8896
    ds_read_b128 v[100:103], v12 offset:17344
    s_waitcnt vmcnt(2) lgkmcnt(3)
    v_mfma_f32_16x16x32_bf16 v[104:107], v[64:67], v[80:83], v[104:107]
    v_mfma_f32_16x16x32_bf16 v[108:111], v[68:71], v[80:83], v[108:111]
    v_mfma_f32_16x16x32_bf16 v[112:115], v[64:67], v[84:87], v[112:115]
    v_mfma_f32_16x16x32_bf16 v[116:119], v[68:71], v[84:87], v[116:119]
    v_mfma_f32_16x16x32_bf16 v[120:123], v[64:67], v[88:91], v[120:123]
    v_mfma_f32_16x16x32_bf16 v[124:127], v[68:71], v[88:91], v[124:127]
    s_waitcnt vmcnt(0) lgkmcnt(0)
    v_mfma_f32_16x16x32_bf16 v[104:107], v[72:75], v[92:95], v[104:107]
    v_mfma_f32_16x16x32_bf16 v[108:111], v[76:79], v[92:95], v[108:111]
    v_mfma_f32_16x16x32_bf16 v[112:115], v[72:75], v[96:99], v[112:115]
    v_mfma_f32_16x16x32_bf16 v[116:119], v[76:79], v[96:99], v[116:119]
    v_mfma_f32_16x16x32_bf16 v[120:123], v[72:75], v[100:103], v[120:123]
    v_mfma_f32_16x16x32_bf16 v[124:127], v[76:79], v[100:103], v[124:127]
    s_nop 3
    v_cvt_pk_bf16_f32 v80, v104, v105
    v_cvt_pk_bf16_f32 v81, v106, v107
    v_cvt_pk_bf16_f32 v82, v108, v109
    v_cvt_pk_bf16_f32 v83, v110, v111
    ds_write_b128 v13, v[80:83] offset:0
    v_cvt_pk_bf16_f32 v84, v112, v113
    v_cvt_pk_bf16_f32 v85, v114, v115
    v_cvt_pk_bf16_f32 v86, v116, v117
    v_cvt_pk_bf16_f32 v87, v118, v119
    ds_write_b128 v13, v[84:87] offset:8448
    v_cvt_pk_bf16_f32 v88, v120, v121
    v_cvt_pk_bf16_f32 v89, v122, v123
    v_cvt_pk_bf16_f32 v90, v124, v125
    v_cvt_pk_bf16_f32 v91, v126, v127
    ds_write_b128 v13, v[88:91] offset:16896
    s_mov_b64 exec, 1
    v_mov_b32 v4, 1
    ds_add_u32 v3, v4 offset:20
    s_mov_b64 exec, -1
    s_setprio 3
    s_add_u32 s100, s100, 118784
    buffer_load_dwordx4 v[16:19], v14, s[16:19], s100 offen offset:0 sc1
    buffer_load_dwordx4 v[20:23], v14, s[16:19], s100 offen offset:1024 sc1
    buffer_load_dwordx4 v[24:27], v14, s[16:19], s100 offen offset:2048 sc1
    buffer_load_dwordx4 v[28:31], v14, s[16:19], s100 offen offset:3072 sc1
    s_add_u32 s100, s100, 4096
    buffer_load_dwordx4 v[32:35], v14, s[16:19], s100 offen offset:0 sc1
    buffer_load_dwordx4 v[36:39], v14, s[16:19], s100 offen offset:1024 sc1
    buffer_load_dwordx4 v[40:43], v14, s[16:19], s100 offen offset:2048 sc1
    buffer_load_dwordx4 v[44:47], v14, s[16:19], s100 offen offset:3072 sc1
    s_add_u32 s100, s100, 4096
    buffer_load_dwordx4 v[48:51], v14, s[16:19], s100 offen offset:0 sc1
    buffer_load_dwordx4 v[52:55], v14, s[16:19], s100 offen offset:1024 sc1
    buffer_load_dwordx4 v[56:59], v14, s[16:19], s100 offen offset:2048 sc1
    buffer_load_dwordx4 v[60:63], v14, s[16:19], s100 offen offset:3072 sc1
    s_add_u32 s100, s100, 4096
    buffer_load_dwordx4 v[64:67], v14, s[16:19], s100 offen offset:0 sc1
    buffer_load_dwordx4 v[68:71], v14, s[16:19], s100 offen offset:1024 sc1
    buffer_load_dwordx4 v[72:75], v14, s[16:19], s100 offen offset:2048 sc1
    buffer_load_dwordx4 v[76:79], v14, s[16:19], s100 offen offset:3072 sc1
    s_setprio 0
    s_mov_b32 s63, s3
L_grp:
    s_mul_i32 s58, s63, 8448
    s_lshr_b32 s59, s63, 2
    s_mul_i32 s59, s59, 8448
    s_and_b32 s60, s63, 1
    s_bfe_u32 s61, s63, 0x10001
    s_cmp_ge_u32 s63, 8
    s_cselect_b32 s61, s60, s61
    s_cselect_b32 s60, 0, s60
    s_mul_i32 s60, s60, 4224
    s_lshl_b32 s61, s61, 9
    s_add_u32 s59, s59, s60
    s_add_u32 s59, s59, s61
    s_add_u32 s59, s59, 105600
    v_add_u32 v12, s58, v1
    v_bfe_u32 v4, v0, 2, 2
    v_mul_u32_u24 v4, 1056, v4
    v_and_b32 v5, 48, v0
    v_add3_u32 v13, v4, v5, s59
    v_lshl_add_u32 v14, v0, 3, s58
    v_lshl_add_u32 v2, v0, 3, s59
    s_cmp_ge_u32 s63, 8
    s_cbranch_scc1 L_grp2
    s_mov_b32 s59, 0
Lw_32:
    ds_read_b32 v4, v3 offset:20
    s_waitcnt lgkmcnt(0)
    v_cmp_gt_u32 vcc, 8, v4
    s_cbranch_vccz Lk_33
    s_sleep 1
    s_add_u32 s59, s59, 1
    s_cmp_lt_u32 s59, 4194304
    s_cbranch_scc1 Lw_32
    s_branch L_end
Lk_33:
L_grp2:
    s_waitcnt lgkmcnt(0)
    ds_read_b128 v[80:83], v12 offset:0
    ds_read_b128 v[84:87], v13 offset:0
    ds_read_b128 v[88:91], v12 offset:64
    ds_read_b128 v[92:95], v13 offset:64
    ds_read_b128 v[96:99], v12 offset:128
    ds_read_b128 v[100:103], v13 offset:128
    ds_read_b128 v[104:107], v12 offset:192
    ds_read_b128 v[108:111], v13 offset:192
    ds_read_b128 v[112:115], v12 offset:256
    ds_read_b128 v[116:119], v13 offset:256
    ds_read_b128 v[120:123], v12 offset:320
    ds_read_b128 v[124:127], v13 offset:320
    s_waitcnt lgkmcnt(10)
    v_mfma_f32_16x16x32_bf16 v[4:7], v[80:83], v[84:87], 0
    ds_read_b128 v[80:83], v12 offset:384
    ds_read_b128 v[84:87], v13 offset:384
    s_waitcnt lgkmcnt(10)
    v_mfma_f32_16x16x32_bf16 v[4:7], v[88:91], v[92:95], v[4:7]
    ds_read_b128 v[88:91], v12 offset:448
    ds_read_b128 v[92:95], v13 offset:448
    s_waitcnt lgkmcnt(10)
    v_mfma_f32_16x16x32_bf16 v[4:7], v[96:99], v[100:103], v[4:7]
    s_waitcnt lgkmcnt(8)
    v_mfma_f32_16x16x32_bf16 v[4:7], v[104:107], v[108:111], v[4:7]
    s_waitcnt lgkmcnt(6)
    v_mfma_f32_16x16x32_bf16 v[4:7], v[112:115], v[116:119], v[4:7]
    s_waitcnt lgkmcnt(4)
    v_mfma_f32_16x16x32_bf16 v[4:7], v[120:123], v[124:127], v[4:7]
    s_waitcnt lgkmcnt(2)
    v_mfma_f32_16x16x32_bf16 v[4:7], v[80:83], v[84:87], v[4:7]
    s_waitcnt lgkmcnt(0)
    v_mfma_f32_16x16x32_bf16 v[4:7], v[88:91], v[92:95], v[4:7]
    ds_read_b64 v[96:97], v14 offset:2112
    ds_read_b64 v[98:99], v14 offset:6336
    ds_read_b64 v[100:101], v14 offset:2624
    ds_read_b64 v[102:103], v14 offset:6848
    ds_read_b64 v[104:105], v14 offset:3168
    ds_read_b64 v[106:107], v14 offset:7392
    ds_read_b64 v[108:109], v14 offset:3680
    ds_read_b64 v[110:111], v14 offset:7904
    ds_read_b64 v[80:81], v14 offset:0
    ds_read_b64 v[82:83], v14 offset:4224
    ds_read_b64 v[84:85], v14 offset:512
    ds_read_b64 v[86:87], v14 offset:4736
    ds_read_b64 v[88:89], v14 offset:1056
    ds_read_b64 v[90:91], v14 offset:5280
    ds_read_b64 v[92:93], v14 offset:1568
    s_waitcnt lgkmcnt(14)
    ds_read_b64 v[94:95], v14 offset:5792
    v_mul_f32 v4, 0x3db8aa3b, v4
    v_mul_f32 v5, 0x3db8aa3b, v5
    v_mul_f32 v6, 0x3db8aa3b, v6
    v_mul_f32 v7, 0x3db8aa3b, v7
    v_exp_f32 v4, v4
    v_exp_f32 v5, v5
    v_exp_f32 v6, v6
    v_exp_f32 v7, v7
    v_add_f32 v12, v4, v5
    v_add_f32 v13, v6, v7
    v_add_f32 v12, v12, v13
    v_add_f32 v12, 0x3089705f, v12
    v_rcp_f32 v12, v12
    s_add_u32 s63, s63, 8
    v_mul_f32 v4, v4, v12
    v_mul_f32 v5, v5, v12
    v_mul_f32 v6, v6, v12
    v_mul_f32 v7, v7, v12
    v_cvt_pk_bf16_f32 v4, v4, v5
    v_cvt_pk_bf16_f32 v6, v6, v7
    v_perm_b32 v112, v4, v4, v8
    v_perm_b32 v113, v4, v4, v9
    v_perm_b32 v114, v4, v4, v10
    v_perm_b32 v115, v4, v4, v11
    v_perm_b32 v116, v6, v6, v8
    v_perm_b32 v117, v6, v6, v9
    v_perm_b32 v118, v6, v6, v10
    v_perm_b32 v119, v6, v6, v11
    s_waitcnt lgkmcnt(0)
    v_mfma_f32_4x4x4_16b_bf16 v[120:123], v[112:113], v[80:81], 0 cbsz:4 abid:0
    v_mfma_f32_4x4x4_16b_bf16 v[124:127], v[112:113], v[82:83], 0 cbsz:4 abid:5
    v_mfma_f32_4x4x4_16b_bf16 v[4:7], v[112:113], v[84:85], 0 cbsz:4 abid:10
    v_mfma_f32_4x4x4_16b_bf16 v[12:15], v[112:113], v[86:87], 0 cbsz:4 abid:15
    v_mfma_f32_4x4x4_16b_bf16 v[120:123], v[114:115], v[88:89], v[120:123] cbsz:4 abid:0
    v_mfma_f32_4x4x4_16b_bf16 v[124:127], v[114:115], v[90:91], v[124:127] cbsz:4 abid:5
    v_mfma_f32_4x4x4_16b_bf16 v[4:7], v[114:115], v[92:93], v[4:7] cbsz:4 abid:10
    v_mfma_f32_4x4x4_16b_bf16 v[12:15], v[114:115], v[94:95], v[12:15] cbsz:4 abid:15
    v_mfma_f32_4x4x4_16b_bf16 v[120:123], v[116:117], v[96:97], v[120:123] cbsz:4 abid:0
    v_mfma_f32_4x4x4_16b_bf16 v[124:127], v[116:117], v[98:99], v[124:127] cbsz:4 abid:5
    v_mfma_f32_4x4x4_16b_bf16 v[4:7], v[116:117], v[100:101], v[4:7] cbsz:4 abid:10
    v_mfma_f32_4x4x4_16b_bf16 v[12:15], v[116:117], v[102:103], v[12:15] cbsz:4 abid:15
    v_mfma_f32_4x4x4_16b_bf16 v[120:123], v[118:119], v[104:105], v[120:123] cbsz:4 abid:0
    v_mfma_f32_4x4x4_16b_bf16 v[124:127], v[118:119], v[106:107], v[124:127] cbsz:4 abid:5
    v_mfma_f32_4x4x4_16b_bf16 v[4:7], v[118:119], v[108:109], v[4:7] cbsz:4 abid:10
    v_mfma_f32_4x4x4_16b_bf16 v[12:15], v[118:119], v[110:111], v[12:15] cbsz:4 abid:15
    s_nop 1
    v_cvt_pk_bf16_f32 v112, v120, v121
    v_cvt_pk_bf16_f32 v113, v122, v123
    ds_write_b64 v2, v[112:113] offset:0
    v_cvt_pk_bf16_f32 v114, v124, v125
    v_cvt_pk_bf16_f32 v115, v126, v127
    ds_write_b64 v2, v[114:115] offset:1056
    v_cvt_pk_bf16_f32 v116, v4, v5
    v_cvt_pk_bf16_f32 v117, v6, v7
    ds_write_b64 v2, v[116:117] offset:2112
    v_cvt_pk_bf16_f32 v118, v12, v13
    v_cvt_pk_bf16_f32 v119, v14, v15
    ds_write_b64 v2, v[118:119] offset:3168
    s_cmp_lt_u32 s63, 10
    s_cbranch_scc1 L_grp
    s_mov_b64 exec, 1
    v_mov_b32 v4, 1
    ds_add_u32 v3, v4 offset:24
    s_mov_b64 exec, -1
    v_add_u32 v12, 105600, v1
    v_lshlrev_b32 v14, 4, v0
    v_and_b32 v6, 15, v0
    v_lshlrev_b32 v6, 2, v6
    v_and_b32 v5, 48, v0
    v_lshl_add_u32 v8, v5, 7, v6
    v_and_b32 v5, 32, v0
    v_lshl_add_u32 v9, v5, 6, v6
    v_and_b32 v5, 16, v0
    v_lshl_add_u32 v9, v5, 22, v9
    s_lshl_b32 s60, s5, 9
    s_lshl_b32 s61, s3, 6
    s_add_u32 s60, s60, s61
    s_mov_b32 s59, 0
Lw_34:
    ds_read_b32 v4, v3 offset:24
    s_waitcnt lgkmcnt(0)
    v_cmp_gt_u32 vcc, 8, v4
    s_cbranch_vccz Lk_35
    s_sleep 1
    s_add_u32 s59, s59, 1
    s_cmp_lt_u32 s59, 4194304
    s_cbranch_scc1 Lw_34
    s_branch L_end
Lk_35:
    ds_read_b128 v[80:83], v12 offset:0
    ds_read_b128 v[84:87], v12 offset:8448
    ds_read_b128 v[88:91], v12 offset:16896
    ds_read_b128 v[92:95], v12 offset:64
    ds_read_b128 v[96:99], v12 offset:8512
    ds_read_b128 v[100:103], v12 offset:16960
    s_waitcnt vmcnt(14) lgkmcnt(3)
    v_mfma_f32_16x16x32_bf16 v[104:107], v[80:83], v[16:19], 0
    v_mfma_f32_16x16x32_bf16 v[108:111], v[80:83], v[20:23], 0
    v_mfma_f32_16x16x32_bf16 v[112:115], v[84:87], v[16:19], 0
    v_mfma_f32_16x16x32_bf16 v[116:119], v[84:87], v[20:23], 0
    v_mfma_f32_16x16x32_bf16 v[120:123], v[88:91], v[16:19], 0
    v_mfma_f32_16x16x32_bf16 v[124:127], v[88:91], v[20:23], 0
    ds_read_b128 v[80:83], v12 offset:128
    ds_read_b128 v[84:87], v12 offset:8576
    ds_read_b128 v[88:91], v12 offset:17024
    s_waitcnt vmcnt(12) lgkmcnt(3)
    v_mfma_f32_16x16x32_bf16 v[104:107], v[92:95], v[24:27], v[104:107]
    v_mfma_f32_16x16x32_bf16 v[108:111], v[92:95], v[28:31], v[108:111]
    v_mfma_f32_16x16x32_bf16 v[112:115], v[96:99], v[24:27], v[112:115]
    v_mfma_f32_16x16x32_bf16 v[116:119], v[96:99], v[28:31], v[116:119]
    v_mfma_f32_16x16x32_bf16 v[120:123], v[100:103], v[24:27], v[120:123]
    v_mfma_f32_16x16x32_bf16 v[124:127], v[100:103], v[28:31], v[124:127]
    ds_read_b128 v[92:95], v12 offset:192
    ds_read_b128 v[96:99], v12 offset:8640
    ds_read_b128 v[100:103], v12 offset:17088
    s_waitcnt vmcnt(10) lgkmcnt(3)
    v_mfma_f32_16x16x32_bf16 v[104:107], v[80:83], v[32:35], v[104:107]
    v_mfma_f32_16x16x32_bf16 v[108:111], v[80:83], v[36:39], v[108:111]
    v_mfma_f32_16x16x32_bf16 v[112:115], v[84:87], v[32:35], v[112:115]
    v_mfma_f32_16x16x32_bf16 v[116:119], v[84:87], v[36:39], v[116:119]
    v_mfma_f32_16x16x32_bf16 v[120:123], v[88:91], v[32:35], v[120:123]
    v_mfma_f32_16x16x32_bf16 v[124:127], v[88:91], v[36:39], v[124:127]
    ds_read_b128 v[80:83], v12 offset:256
    ds_read_b128 v[84:87], v12 offset:8704
    ds_read_b128 v[88:91], v12 offset:17152
    s_waitcnt vmcnt(8) lgkmcnt(3)
    v_mfma_f32_16x16x32_bf16 v[104:107], v[92:95], v[40:43], v[104:107]
    v_mfma_f32_16x16x32_bf16 v[108:111], v[92:95], v[44:47], v[108:111]
    v_mfma_f32_16x16x32_bf16 v[112:115], v[96:99], v[40:43], v[112:115]
    v_mfma_f32_16x16x32_bf16 v[116:119], v[96:99], v[44:47], v[116:119]
    v_mfma_f32_16x16x32_bf16 v[120:123], v[100:103], v[40:43], v[120:123]
    v_mfma_f32_16x16x32_bf16 v[124:127], v[100:103], v[44:47], v[124:127]
    ds_read_b128 v[92:95], v12 offset:320
    ds_read_b128 v[96:99], v12 offset:8768
    ds_read_b128 v[100:103], v12 offset:17216
    s_waitcnt vmcnt(6) lgkmcnt(3)
    v_mfma_f32_16x16x32_bf16 v[104:107], v[80:83], v[48:51], v[104:107]
    v_mfma_f32_16x16x32_bf16 v[108:111], v[80:83], v[52:55], v[108:111]
    v_mfma_f32_16x16x32_bf16 v[112:115], v[84:87], v[48:51], v[112:115]
    v_mfma_f32_16x16x32_bf16 v[116:119], v[84:87], v[52:55], v[116:119]
    v_mfma_f32_16x16x32_bf16 v[120:123], v[88:91], v[48:51], v[120:123]
    v_mfma_f32_16x16x32_bf16 v[124:127], v[88:91], v[52:55], v[124:127]
    ds_read_b128 v[80:83], v12 offset:384
    ds_read_b128 v[84:87], v12 offset:8832
    ds_read_b128 v[88:91], v12 offset:17280
    s_waitcnt vmcnt(4) lgkmcnt(3)
    v_mfma_f32_16x16x32_bf16 v[104:107], v[92:95], v[56:59], v[104:107]
    v_mfma_f32_16x16x32_bf16 v[108:111], v[92:95], v[60:63], v[108:111]
    v_mfma_f32_16x16x32_bf16 v[112:115], v[96:99], v[56:59], v[112:115]
    v_mfma_f32_16x16x32_bf16 v[116:119], v[96:99], v[60:63], v[116:119]
    v_mfma_f32_16x16x32_bf16 v[120:123], v[100:103], v[56:59], v[120:123]
    v_mfma_f32_16x16x32_bf16 v[124:127], v[100:103], v[60:63], v[124:127]
    ds_read_b128 v[92:95], v12 offset:448
    ds_read_b128 v[96:99], v12 offset:8896
    ds_read_b128 v[100:103], v12 offset:17344
    s_waitcnt vmcnt(2) lgkmcnt(3)
    v_mfma_f32_16x16x32_bf16 v[104:107], v[80:83], v[64:67], v[104:107]
    v_mfma_f32_16x16x32_bf16 v[108:111], v[80:83], v[68:71], v[108:111]
    v_mfma_f32_16x16x32_bf16 v[112:115], v[84:87], v[64:67], v[112:115]
    v_mfma_f32_16x16x32_bf16 v[116:119], v[84:87], v[68:71], v[116:119]
    v_mfma_f32_16x16x32_bf16 v[120:123], v[88:91], v[64:67], v[120:123]
    v_mfma_f32_16x16x32_bf16 v[124:127], v[88:91], v[68:71], v[124:127]
    s_waitcnt vmcnt(0) lgkmcnt(0)
    v_mfma_f32_16x16x32_bf16 v[104:107], v[92:95], v[72:75], v[104:107]
    v_mfma_f32_16x16x32_bf16 v[108:111], v[92:95], v[76:79], v[108:111]
    v_mfma_f32_16x16x32_bf16 v[112:115], v[96:99], v[72:75], v[112:115]
    v_mfma_f32_16x16x32_bf16 v[116:119], v[96:99], v[76:79], v[116:119]
    v_mfma_f32_16x16x32_bf16 v[120:123], v[100:103], v[72:75], v[120:123]
    v_mfma_f32_16x16x32_bf16 v[124:127], v[100:103], v[76:79], v[124:127]
    s_setprio 3
    s_add_u32 s100, s100, 118784
    buffer_load_dwordx4 v[16:19], v14, s[16:19], s100 offen offset:0 sc1
    buffer_load_dwordx4 v[20:23], v14, s[16:19], s100 offen offset:1024 sc1
    buffer_load_dwordx4 v[24:27], v14, s[16:19], s100 offen offset:2048 sc1
    buffer_load_dwordx4 v[28:31], v14, s[16:19], s100 offen offset:3072 sc1
    s_add_u32 s100, s100, 4096
    buffer_load_dwordx4 v[32:35], v14, s[16:19], s100 offen offset:0 sc1
    buffer_load_dwordx4 v[36:39], v14, s[16:19], s100 offen offset:1024 sc1
    buffer_load_dwordx4 v[40:43], v14, s[16:19], s100 offen offset:2048 sc1
    buffer_load_dwordx4 v[44:47], v14, s[16:19], s100 offen offset:3072 sc1
    s_add_u32 s100, s100, 4096
    buffer_load_dwordx4 v[48:51], v14, s[16:19], s100 offen offset:0 sc1
    buffer_load_dwordx4 v[52:55], v14, s[16:19], s100 offen offset:1024 sc1
    buffer_load_dwordx4 v[56:59], v14, s[16:19], s100 offen offset:2048 sc1
    buffer_load_dwordx4 v[60:63], v14, s[16:19], s100 offen offset:3072 sc1
    s_add_u32 s100, s100, 4096
    buffer_load_dwordx4 v[64:67], v14, s[16:19], s100 offen offset:0 sc1
    buffer_load_dwordx4 v[68:71], v14, s[16:19], s100 offen offset:1024 sc1
    buffer_load_dwordx4 v[72:75], v14, s[16:19], s100 offen offset:2048 sc1
    buffer_load_dwordx4 v[76:79], v14, s[16:19], s100 offen offset:3072 sc1
    s_setprio 0
    v_add_u32 v12, 131072, v1
    s_mov_b32 s59, 0
Lw_36:
    ds_read_b32 v4, v3 offset:36
    s_waitcnt lgkmcnt(0)
    v_cmp_gt_u32 vcc, 16, v4
    s_cbranch_vccz Lk_37
    s_sleep 2
    s_add_u32 s59, s59, 1
    s_cmp_lt_u32 s59, 16777216
    s_cbranch_scc1 Lw_36
    s_branch L_end
Lk_37:
    ds_read_b128 v[80:83], v12 offset:0
    ds_read_b128 v[84:87], v12 offset:64
    ds_read_b128 v[88:91], v12 offset:128
    ds_read_b128 v[92:95], v12 offset:192
    ds_read_b128 v[96:99], v12 offset:256
    ds_read_b128 v[100:103], v12 offset:320
    s_waitcnt vmcnt(14) lgkmcnt(5)
    v_mfma_f32_16x16x32_bf16 v[104:107], v[80:83], v[16:19], v[104:107]
    v_mfma_f32_16x16x32_bf16 v[108:111], v[80:83], v[20:23], v[108:111]
    ds_read_b128 v[80:83], v12 offset:384
    s_waitcnt vmcnt(12) lgkmcnt(5)
    v_mfma_f32_16x16x32_bf16 v[104:107], v[84:87], v[24:27], v[104:107]
    v_mfma_f32_16x16x32_bf16 v[108:111], v[84:87], v[28:31], v[108:111]
    ds_read_b128 v[84:87], v12 offset:448
    s_waitcnt vmcnt(10) lgkmcnt(5)
    v_mfma_f32_16x16x32_bf16 v[104:107], v[88:91], v[32:35], v[104:107]
    v_mfma_f32_16x16x32_bf16 v[108:111], v[88:91], v[36:39], v[108:111]
    s_waitcnt vmcnt(8) lgkmcnt(4)
    v_mfma_f32_16x16x32_bf16 v[104:107], v[92:95], v[40:43], v[104:107]
    v_mfma_f32_16x16x32_bf16 v[108:111], v[92:95], v[44:47], v[108:111]
    s_waitcnt vmcnt(6) lgkmcnt(3)
    v_mfma_f32_16x16x32_bf16 v[104:107], v[96:99], v[48:51], v[104:107]
    v_mfma_f32_16x16x32_bf16 v[108:111], v[96:99], v[52:55], v[108:111]
    s_waitcnt vmcnt(4) lgkmcnt(2)
    v_mfma_f32_16x16x32_bf16 v[104:107], v[100:103], v[56:59], v[104:107]
    v_mfma_f32_16x16x32_bf16 v[108:111], v[100:103], v[60:63], v[108:111]
    s_waitcnt vmcnt(2) lgkmcnt(1)
    v_mfma_f32_16x16x32_bf16 v[104:107], v[80:83], v[64:67], v[104:107]
    v_mfma_f32_16x16x32_bf16 v[108:111], v[80:83], v[68:71], v[108:111]
    s_waitcnt vmcnt(0) lgkmcnt(0)
    v_mfma_f32_16x16x32_bf16 v[104:107], v[84:87], v[72:75], v[104:107]
    v_mfma_f32_16x16x32_bf16 v[108:111], v[84:87], v[76:79], v[108:111]
    s_nop 7
    v_cvt_pk_bf16_f32 v104, v104, v108
    buffer_store_dword v104, v8, s[20:23], s60 offen offset:0 sc1
    v_cvt_pk_bf16_f32 v105, v105, v109
    buffer_store_dword v105, v8, s[20:23], s60 offen offset:512 sc1
    v_cvt_pk_bf16_f32 v106, v106, v110
    buffer_store_dword v106, v8, s[20:23], s60 offen offset:1024 sc1
    v_cvt_pk_bf16_f32 v107, v107, v111
    buffer_store_dword v107, v8, s[20:23], s60 offen offset:1536 sc1
    s_add_u32 s60, s60, 8192
    s_mov_b32 s59, 0
Lw_38:
    ds_read_b32 v4, v3 offset:40
    s_waitcnt lgkmcnt(0)
    v_cmp_gt_u32 vcc, 16, v4
    s_cbranch_vccz Lk_39
    s_sleep 2
    s_add_u32 s59, s59, 1
    s_cmp_lt_u32 s59, 16777216
    s_cbranch_scc1 Lw_38
    s_branch L_end
Lk_39:
    ds_read_b128 v[80:83], v12 offset:8448
    ds_read_b128 v[84:87], v12 offset:8512
    ds_read_b128 v[88:91], v12 offset:8576
    ds_read_b128 v[92:95], v12 offset:8640
    ds_read_b128 v[96:99], v12 offset:8704
    ds_read_b128 v[100:103], v12 offset:8768
    s_waitcnt lgkmcnt(5)
    v_mfma_f32_16x16x32_bf16 v[112:115], v[80:83], v[16:19], v[112:115]
    v_mfma_f32_16x16x32_bf16 v[116:119], v[80:83], v[20:23], v[116:119]
    ds_read_b128 v[80:83], v12 offset:8832
    s_waitcnt lgkmcnt(5)
    v_mfma_f32_16x16x32_bf16 v[112:115], v[84:87], v[24:27], v[112:115]
    v_mfma_f32_16x16x32_bf16 v[116:119], v[84:87], v[28:31], v[116:119]
    ds_read_b128 v[84:87], v12 offset:8896
    s_waitcnt lgkmcnt(5)
    v_mfma_f32_16x16x32_bf16 v[112:115], v[88:91], v[32:35], v[112:115]
    v_mfma_f32_16x16x32_bf16 v[116:119], v[88:91], v[36:39], v[116:119]
    s_waitcnt lgkmcnt(4)
    v_mfma_f32_16x16x32_bf16 v[112:115], v[92:95], v[40:43], v[112:115]
    v_mfma_f32_16x16x32_bf16 v[116:119], v[92:95], v[44:47], v[116:119]
    s_waitcnt lgkmcnt(3)
    v_mfma_f32_16x16x32_bf16 v[112:115], v[96:99], v[48:51], v[112:115]
    v_mfma_f32_16x16x32_bf16 v[116:119], v[96:99], v[52:55], v[116:119]
    s_waitcnt lgkmcnt(2)
    v_mfma_f32_16x16x32_bf16 v[112:115], v[100:103], v[56:59], v[112:115]
    v_mfma_f32_16x16x32_bf16 v[116:119], v[100:103], v[60:63], v[116:119]
    s_waitcnt lgkmcnt(1)
    v_mfma_f32_16x16x32_bf16 v[112:115], v[80:83], v[64:67], v[112:115]
    v_mfma_f32_16x16x32_bf16 v[116:119], v[80:83], v[68:71], v[116:119]
    s_waitcnt lgkmcnt(0)
    v_mfma_f32_16x16x32_bf16 v[112:115], v[84:87], v[72:75], v[112:115]
    v_mfma_f32_16x16x32_bf16 v[116:119], v[84:87], v[76:79], v[116:119]
    s_nop 7
    v_cvt_pk_bf16_f32 v112, v112, v116
    buffer_store_dword v112, v8, s[20:23], s60 offen offset:0 sc1
    v_cvt_pk_bf16_f32 v113, v113, v117
    buffer_store_dword v113, v8, s[20:23], s60 offen offset:512 sc1
    v_cvt_pk_bf16_f32 v114, v114, v118
    buffer_store_dword v114, v8, s[20:23], s60 offen offset:1024 sc1
    v_cvt_pk_bf16_f32 v115, v115, v119
    buffer_store_dword v115, v8, s[20:23], s60 offen offset:1536 sc1
    s_add_u32 s60, s60, 8192
    s_mov_b32 s59, 0
Lw_40:
    ds_read_b32 v4, v3 offset:44
    s_waitcnt lgkmcnt(0)
    v_cmp_gt_u32 vcc, 8, v4
    s_cbranch_vccz Lk_41
    s_add_u32 s59, s59, 1
    s_cmp_lt_u32 s59, 16777216
    s_cbranch_scc1 Lw_40
    s_branch L_end
Lk_41:
    ds_read_b128 v[80:83], v12 offset:16896
    ds_read_b128 v[84:87], v12 offset:16960
    ds_read_b128 v[88:91], v12 offset:17024
    ds_read_b128 v[92:95], v12 offset:17088
    ds_read_b128 v[96:99], v12 offset:17152
    ds_read_b128 v[100:103], v12 offset:17216
    s_waitcnt lgkmcnt(5)
    v_mfma_f32_16x16x32_bf16 v[120:123], v[80:83], v[16:19], v[120:123]
    v_mfma_f32_16x16x32_bf16 v[124:127], v[80:83], v[20:23], v[124:127]
    ds_read_b128 v[80:83], v12 offset:17280
    s_waitcnt lgkmcnt(5)
    v_mfma_f32_16x16x32_bf16 v[120:123], v[84:87], v[24:27], v[120:123]
    v_mfma_f32_16x16x32_bf16 v[124:127], v[84:87], v[28:31], v[124:127]
    ds_read_b128 v[84:87], v12 offset:17344
    s_waitcnt lgkmcnt(5)
    v_mfma_f32_16x16x32_bf16 v[120:123], v[88:91], v[32:35], v[120:123]
    v_mfma_f32_16x16x32_bf16 v[124:127], v[88:91], v[36:39], v[124:127]
    s_waitcnt lgkmcnt(4)
    v_mfma_f32_16x16x32_bf16 v[120:123], v[92:95], v[40:43], v[120:123]
    v_mfma_f32_16x16x32_bf16 v[124:127], v[92:95], v[44:47], v[124:127]
    s_waitcnt lgkmcnt(3)
    v_mfma_f32_16x16x32_bf16 v[120:123], v[96:99], v[48:51], v[120:123]
    v_mfma_f32_16x16x32_bf16 v[124:127], v[96:99], v[52:55], v[124:127]
    s_waitcnt lgkmcnt(2)
    v_mfma_f32_16x16x32_bf16 v[120:123], v[100:103], v[56:59], v[120:123]
    v_mfma_f32_16x16x32_bf16 v[124:127], v[100:103], v[60:63], v[124:127]
    s_waitcnt lgkmcnt(1)
    v_mfma_f32_16x16x32_bf16 v[120:123], v[80:83], v[64:67], v[120:123]
    v_mfma_f32_16x16x32_bf16 v[124:127], v[80:83], v[68:71], v[124:127]
    s_waitcnt lgkmcnt(0)
    v_mfma_f32_16x16x32_bf16 v[120:123], v[84:87], v[72:75], v[120:123]
    v_mfma_f32_16x16x32_bf16 v[124:127], v[84:87], v[76:79], v[124:127]
    s_nop 7
    v_cvt_pk_bf16_f32 v120, v120, v124
    buffer_store_dword v120, v9, s[20:23], s60 offen offset:0 sc1
    v_cvt_pk_bf16_f32 v121, v121, v125
    buffer_store_dword v121, v9, s[20:23], s60 offen offset:512 sc1
    v_cvt_pk_bf16_f32 v122, v122, v126
    buffer_store_dword v122, v9, s[20:23], s60 offen offset:1024 sc1
    v_cvt_pk_bf16_f32 v123, v123, v127
    buffer_store_dword v123, v9, s[20:23], s60 offen offset:1536 sc1
L_end:
L_exit:
    s_endpgm
L_slow:
    s_setprio 0
    ds_add_u32 v61, v62 offset:16
    s_mov_b32 s59, 0
Lw_42:
    ds_read_b32 v4, v3 offset:16
    s_waitcnt lgkmcnt(0)
    v_cmp_gt_u32 vcc, 8, v4
    s_cbranch_vccz Lk_43
    s_add_u32 s59, s59, 1
    s_cmp_lt_u32 s59, 4194304
    s_cbranch_scc1 Lw_42
    s_branch L_end
Lk_43:
    v_mov_b32 v12, v3
    s_mov_b64 s[24:25], s[34:35]
    s_mov_b32 s26, 640000
    s_mov_b64 s[28:29], s[36:37]
    s_mov_b32 s30, 640000
    s_mov_b64 s[12:13], s[42:43]
    s_mov_b32 s14, 20000
    s_mov_b32 s15, 0x20000
    s_sub_u32 s63, s67, 1
    s_mov_b32 s65, 201487168
    s_mov_b32 s64, 0
    s_call_b64 s[68:69], L_flush
    s_add_u32 s66, s4, s5
    s_add_u32 s67, s66, 40
    v_lshlrev_b32 v16, 2, v0
    v_and_b32 v17, 32, v0
    v_lshl_add_u32 v17, v17, 22, v2
    v_mov_b32 v24, 0
L_sn:
    s_mov_b32 s60, 0
L_sc:
    buffer_load_dword v18, v16, s[28:31], s60 offen
    buffer_load_dword v19, v16, s[24:27], s60 offen
    s_waitcnt vmcnt(0)
    v_cmp_eq_u32 vcc, s66, v18
    s_cbranch_vccz L_sx
L_se:
    s_ff1_i32_b64 s58, vcc
    s_bitset0_b64 vcc, s58
    v_readlane_b32 s59, v19, s58
    s_nop 0
    s_lshl_b32 s61, s59, 9
    s_lshl_b32 s59, s59, 1
    buffer_load_dwordx4 v[20:23], v17, s[8:11], s61 offen
    buffer_load_ushort v1, v24, s[12:15], s59 offen
    s_waitcnt vmcnt(0)
    v_perm_b32 v6, v1, v1, v10
    v_perm_b32 v7, v1, v1, v11
    s_nop 1
    v_mfma_f32_4x4x4_16b_bf16 v[56:59], v[6:7], v[20:21], v[56:59]
    v_mfma_f32_4x4x4_16b_bf16 v[60:63], v[6:7], v[22:23], v[60:63]
    s_cmp_lg_u64 vcc, 0
    s_cbranch_scc1 L_se
L_sx:
    s_add_u32 s60, s60, 256
    s_cmp_lt_u32 s60, 640000
    s_cbranch_scc1 L_sc
    s_call_b64 s[68:69], L_flush
    s_add_u32 s66, s66, 8
    s_cmp_lt_u32 s66, s67
    s_cbranch_scc1 L_sn
    s_branch L_gdone
.section .rodata,"a"
.p2align 6
.amdhsa_kernel standalone__hybrid_graph_tf_exphormer__graph_kernel
  .amdhsa_next_free_vgpr 128
  .amdhsa_next_free_sgpr 102
  .amdhsa_accum_offset 128
  .amdhsa_group_segment_fixed_size 0
  .amdhsa_kernarg_size 104
  .amdhsa_user_sgpr_count 2
  .amdhsa_user_sgpr_kernarg_segment_ptr 1
  .amdhsa_system_sgpr_workgroup_id_x 1
.end_amdhsa_kernel
```

```asm
; @launch grid=(250,1,1) block=(1024,1,1) lds=161984
.amdgcn_target "amdgcn-amd-amdhsa--gfx950"
.text
.globl standalone__hybrid_graph_tf_exphormer__graph_kernel
.p2align 8
.type standalone__hybrid_graph_tf_exphormer__graph_kernel,@function
standalone__hybrid_graph_tf_exphormer__graph_kernel:
    s_cmp_ge_u32 s2, 250
    s_cbranch_scc1 L_exit
    s_load_dwordx16 s[32:47], s[0:1], 0
    s_load_dwordx8 s[48:55], s[0:1], 64
    s_load_dwordx2 s[56:57], s[0:1], 96
    s_getpc_b64 s[60:61]
    s_lshr_b32 s6, s2, 3
    v_lshl_add_u32 v1, v0, 5, s6
    v_cmp_gt_u32 vcc, 85, v1
    v_lshlrev_b32 v1, 7, v1
    s_and_saveexec_b64 s[58:59], vcc
    s_cbranch_execz L_nopf
    global_load_dword v15, v1, s[60:61]
L_nopf:
    s_mov_b64 exec, -1
    v_lshrrev_b32 v1, 6, v0
    v_mov_b32 v8, 33554432
    v_readfirstlane_b32 s3, v1
    v_cmp_gt_u32 vcc, 288, v0
    v_lshlrev_b32 v5, 4, v0
    v_add_u32 v4, 152064, v5
    v_cndmask_b32 v8, 0, v8, vcc
    v_mov_b32 v9, v8
    v_mov_b64 v[10:11], v[8:9]
    v_cmp_gt_u32 vcc, 556, v0
    s_and_saveexec_b64 s[58:59], vcc
    ds_write_b128 v4, v[8:11]
    s_mov_b64 exec, -1
    v_and_b32 v0, 63, v0
    v_and_b32 v2, 31, v0
    v_lshlrev_b32 v2, 4, v2
    s_and_b32 s59, s2, 7
    s_mul_i32 s60, s59, 31
    s_min_u32 s59, s59, 2
    s_add_u32 s6, s6, s60
    s_add_u32 s6, s6, s59
    s_mov_b32 s27, 0x20000
    s_mov_b32 s31, 0x20000
    s_xor_b32 s3, s3, 8
    s_and_b32 s4, s3, 7
    s_cmp_lt_u32 s3, 8
    s_cbranch_scc1 L_e3
    s_setprio 3
    s_cmp_ge_u32 s2, 64
    s_cbranch_scc1 L_e1
    v_lshrrev_b32 v6, 2, v5
    s_mul_i32 s58, s2, 10000
    s_add_u32 s60, s58, 8192
    s_mov_b32 s26, 640000
    s_mov_b32 s30, 640000
    s_mov_b32 s59, 1048576
    s_mov_b32 s63, 1
    s_waitcnt lgkmcnt(0)
    s_mov_b64 s[28:29], s[36:37]
    s_mov_b64 s[24:25], s[34:35]
    buffer_load_dwordx4 v[22:25], v5, s[28:31], s58 offen
    buffer_load_dword v26, v6, s[28:31], s60 offen
    buffer_load_dwordx4 v[16:19], v5, s[24:27], s58 offen
    buffer_load_dword v20, v6, s[24:27], s60 offen
L_ep:
    s_load_dword s40, s[56:57], s59
    s_branch L_bar
L_e1:
    s_mov_b32 s26, 131072
    s_sub_u32 s60, s3, 9
    s_cmp_lt_u32 s60, 3
    s_cbranch_scc1 L_e1b
    s_mov_b32 s63, 0
    s_cmp_eq_u32 s3, 8
    s_cbranch_scc0 L_barw
    s_mov_b32 s63, 5
    s_mov_b32 s59, 1048576
    s_waitcnt lgkmcnt(0)
    s_branch L_ep
L_e1b:
    s_sub_u32 s62, s2, 64
    s_cmp_ge_u32 s62, 128
    s_cbranch_scc1 L_e2
    s_and_b32 s58, s62, 7
    s_lshr_b32 s59, s62, 4
    s_bfe_u32 s61, s62, 0x10003
    s_cmp_eq_u32 s60, 2
    s_cselect_b32 s58, s59, s58
    s_cselect_b32 s61, s61, s60
    s_lshl_b32 s58, s58, 14
    s_lshl_b32 s61, s61, 11
    s_add_u32 s58, s58, s61
    s_add_u32 s59, s58, 4096
    v_and_b32 v4, 32, v0
    v_lshl_add_u32 v4, v4, 8, v2
    s_mul_i32 s61, s60, 8448
    s_add_u32 m0, s61, 105600
    s_cmp_eq_u32 s60, 0
    s_cselect_b32 s63, 2, 3
    s_cmp_eq_u32 s60, 2
    s_waitcnt lgkmcnt(0)
    s_cselect_b64 s[24:25], s[48:49], s[46:47]
    buffer_load_dwordx4 v4, s[24:27], s58 offen offset:0 lds
    s_add_u32 m0, m0, 544
    s_nop 0
    buffer_load_dwordx4 v4, s[24:27], s58 offen offset:512 lds
    s_add_u32 m0, m0, 544
    s_nop 0
    buffer_load_dwordx4 v4, s[24:27], s58 offen offset:1024 lds
    s_add_u32 m0, m0, 544
    s_nop 0
    buffer_load_dwordx4 v4, s[24:27], s58 offen offset:1536 lds
    s_add_u32 m0, m0, 2592
    s_nop 0
    buffer_load_dwordx4 v4, s[24:27], s59 offen offset:0 lds
    s_add_u32 m0, m0, 544
    s_nop 0
    buffer_load_dwordx4 v4, s[24:27], s59 offen offset:512 lds
    s_add_u32 m0, m0, 544
    s_nop 0
    buffer_load_dwordx4 v4, s[24:27], s59 offen offset:1024 lds
    s_add_u32 m0, m0, 544
    s_nop 0
    buffer_load_dwordx4 v4, s[24:27], s59 offen offset:1536 lds
    s_branch L_bar
L_e2:
    s_mul_i32 s60, s60, 58
    s_add_u32 s62, s62, s60
    s_sub_u32 s62, s62, 128
    s_mov_b32 s63, 3
    s_cmp_ge_u32 s62, 128
    s_cbranch_scc1 L_barw
    s_mov_b32 s63, 4
    s_and_b32 s59, s62, 7
    s_lshl_b32 s59, s59, 14
    s_bfe_u32 s60, s62, 0x30003
    s_lshl_b32 s60, s60, 6
    s_add_u32 s59, s59, s60
    v_and_b32 v4, 15, v0
    v_lshlrev_b32 v4, 2, v4
    v_and_b32 v5, 48, v0
    v_lshl_add_u32 v4, v5, 8, v4
    s_cmp_lt_u32 s62, 64
    s_waitcnt lgkmcnt(0)
    s_cselect_b64 s[24:25], s[50:51], s[44:45]
    buffer_load_dword v16, v4, s[24:27], s59 offen offset:0
    buffer_load_dword v17, v4, s[24:27], s59 offen offset:512
    buffer_load_dword v18, v4, s[24:27], s59 offen offset:1024
    buffer_load_dword v19, v4, s[24:27], s59 offen offset:1536
    buffer_load_dword v20, v4, s[24:27], s59 offen offset:2048
    buffer_load_dword v21, v4, s[24:27], s59 offen offset:2560
    buffer_load_dword v22, v4, s[24:27], s59 offen offset:3072
    buffer_load_dword v23, v4, s[24:27], s59 offen offset:3584
    s_branch L_bar
L_e3:
    s_mul_i32 s58, s6, 640
    s_lshl_b32 s59, s3, 6
    s_add_u32 s59, s59, s58
    s_lshr_b32 s60, s3, 2
    s_lshl_b32 s60, s60, 6
    s_and_b32 s61, s3, 3
    s_lshl_b32 s61, s61, 3
    s_add_u32 s60, s60, s61
    s_add_u32 s60, s60, s58
    s_add_u32 s60, s60, 512
    s_add_u32 s61, s60, 32
    s_waitcnt lgkmcnt(0)
    s_mov_b64 s[62:63], s[38:39]
    s_mov_b64 s[8:9], s[32:33]
    s_load_dwordx16 s[32:47], s[62:63], s59
    s_load_dwordx2 s[64:65], s[62:63], s60
    s_load_dwordx2 s[66:67], s[62:63], s61
    s_barrier
    s_branch L_preA
L_barw:
    s_waitcnt lgkmcnt(0)
L_bar:
    s_barrier
    s_mov_b64 s[8:9], s[32:33]
    s_mul_i32 s5, s6, 40
    v_mov_b32 v3, 159296
    s_mov_b32 s10, 5120000
    s_mov_b32 s11, 0x20000
    s_mov_b64 s[16:17], s[56:57]
    s_mov_b32 s18, 1310720
    s_mov_b32 s19, 0x20000
    v_min_u32 v4, 1, v0
    v_lshl_add_u32 v61, v0, 2, v3
    v_lshl_add_u32 v61, v4, 16, v61
    v_mov_b32 v62, 1
    s_cmp_eq_u32 s63, 1
    s_cbranch_scc0 L_notprod
    v_mov_b32 v9, 4
    v_mov_b32 v10, 159936
    v_lshl_add_u32 v11, v0, 4, v10
    v_cmp_gt_u32 vcc, 7232, v5
    v_add_u32 v59, 105600, v5
    s_mul_i32 s58, s2, 10240
    s_mov_b64 s[66:67], vcc
    s_waitcnt vmcnt(3)
    v_mul_u32_u24 v28, 52429, v22
    v_lshrrev_b32 v28, 21, v28
    v_lshl_add_u32 v28, v28, 2, v10
    ds_add_rtn_u32 v34, v28, v9
    v_mul_u32_u24 v29, 52429, v23
    v_lshrrev_b32 v29, 21, v29
    v_lshl_add_u32 v29, v29, 2, v10
    ds_add_rtn_u32 v35, v29, v9
    v_mul_u32_u24 v30, 52429, v24
    v_lshrrev_b32 v30, 21, v30
    v_lshl_add_u32 v30, v30, 2, v10
    ds_add_rtn_u32 v36, v30, v9
    v_mul_u32_u24 v31, 52429, v25
    v_lshrrev_b32 v31, 21, v31
    v_lshl_add_u32 v31, v31, 2, v10
    ds_add_rtn_u32 v37, v31, v9
    s_waitcnt vmcnt(2)
    s_mov_b64 exec, s[66:67]
    v_mul_u32_u24 v32, 52429, v26
    v_lshrrev_b32 v32, 21, v32
    v_lshl_add_u32 v32, v32, 2, v10
    ds_add_rtn_u32 v38, v32, v9
    s_mov_b64 exec, -1
    ds_add_u32 v61, v62 offset:64
    s_waitcnt vmcnt(0)
    v_lshl_or_b32 v16, v22, 16, v16
    v_lshl_or_b32 v17, v23, 16, v17
    v_lshl_or_b32 v18, v24, 16, v18
    v_lshl_or_b32 v19, v25, 16, v19
    v_lshl_or_b32 v20, v26, 16, v20
    s_mov_b32 s59, 0
Lw_1:
    ds_read_b32 v4, v3 offset:64
    s_waitcnt lgkmcnt(0)
    v_cmp_gt_u32 vcc, 8, v4
    s_cbranch_vccz Lk_2
    s_add_u32 s59, s59, 1
    s_cmp_lt_u32 s59, 4194304
    s_cbranch_scc1 Lw_1
    s_branch L_end
Lk_2:
    ds_read_b128 v[12:15], v11
    s_add_u32 s40, s40, 4096
    s_and_b32 s40, s40, 4294963200
    s_waitcnt lgkmcnt(0)
    v_add_u32 v56, v12, v13
    v_add3_u32 v57, v56, v14, v15
    s_nop 1
    v_add_u32_dpp v58, v57, v57 row_shr:1 row_mask:0xf bank_mask:0xf bound_ctrl:1
    s_nop 1
    v_add_u32_dpp v58, v58, v58 row_shr:2 row_mask:0xf bank_mask:0xf bound_ctrl:1
    s_nop 1
    v_add_u32_dpp v58, v58, v58 row_shr:4 row_mask:0xf bank_mask:0xf bound_ctrl:1
    s_nop 1
    v_add_u32_dpp v58, v58, v58 row_shr:8 row_mask:0xf bank_mask:0xf bound_ctrl:1
    s_nop 1
    v_add_u32_dpp v58, v58, v58 row_bcast:15 row_mask:0xa bank_mask:0xf
    s_nop 1
    v_add_u32_dpp v58, v58, v58 row_bcast:31 row_mask:0xc bank_mask:0xf
    v_sub_u32 v64, v58, v57
    v_add_u32 v65, v64, v12
    v_add_u32 v66, v64, v56
    v_add_u32 v67, v66, v14
    ds_write_b128 v11, v[64:67] offset:1024
    ds_read_b32 v40, v28 offset:1024
    ds_read_b32 v41, v29 offset:1024
    ds_read_b32 v42, v30 offset:1024
    ds_read_b32 v43, v31 offset:1024
    s_mov_b64 exec, s[66:67]
    ds_read_b32 v44, v32 offset:1024
    s_mov_b64 exec, -1
    s_mov_b32 s60, 105600
    s_waitcnt lgkmcnt(4)
    v_add3_u32 v40, v40, v34, s60
    ds_write_b32 v40, v16
    s_waitcnt lgkmcnt(4)
    v_add3_u32 v41, v41, v35, s60
    ds_write_b32 v41, v17
    s_waitcnt lgkmcnt(4)
    v_add3_u32 v42, v42, v36, s60
    ds_write_b32 v42, v18
    s_waitcnt lgkmcnt(4)
    v_add3_u32 v43, v43, v37, s60
    ds_write_b32 v43, v19
    s_mov_b64 exec, s[66:67]
    s_waitcnt lgkmcnt(4)
    v_add3_u32 v44, v44, v38, s60
    ds_write_b32 v44, v20
    s_mov_b64 exec, -1
    ds_add_u32 v61, v62 offset:68
    v_lshrrev_b32 v64, 2, v64
    v_or_b32 v64, s40, v64
    v_lshrrev_b32 v65, 2, v65
    v_or_b32 v65, s40, v65
    v_lshrrev_b32 v66, 2, v66
    v_or_b32 v66, s40, v66
    v_lshrrev_b32 v67, 2, v67
    v_or_b32 v67, s40, v67
    s_mov_b32 s59, 0
Lw_3:
    ds_read_b32 v4, v3 offset:68
    s_waitcnt lgkmcnt(0)
    v_cmp_gt_u32 vcc, 8, v4
    s_cbranch_vccz Lk_4
    s_add_u32 s59, s59, 1
    s_cmp_lt_u32 s59, 4194304
    s_cbranch_scc1 Lw_3
    s_branch L_end
Lk_4:
    ds_read_b128 v[12:15], v59
    ds_read_b128 v[68:71], v59 offset:8192
    s_add_u32 s60, s58, 8192
    s_cmp_ge_u32 s4, 2
    s_waitcnt lgkmcnt(1)
    buffer_store_dwordx4 v[12:15], v5, s[16:19], s58 offen sc1
    s_cbranch_scc1 L_cp1
    s_waitcnt lgkmcnt(0)
    buffer_store_dwordx4 v[68:71], v5, s[16:19], s60 offen sc1
L_cp1:
    s_waitcnt vmcnt(0)
    ds_add_u32 v61, v62 offset:56
    s_cmp_eq_u32 s4, 0
    s_cbranch_scc0 L_dis0
    s_lshl_b32 s61, s2, 10
    s_add_u32 s61, s61, 1114112
    s_or_b32 s60, s40, 1
    v_mov_b32 v8, s60
    s_mov_b32 s59, 0
Lw_5:
    ds_read_b32 v4, v3 offset:56
    s_waitcnt lgkmcnt(0)
    v_cmp_gt_u32 vcc, 8, v4
    s_cbranch_vccz Lk_6
    s_add_u32 s59, s59, 1
    s_cmp_lt_u32 s59, 4194304
    s_cbranch_scc1 Lw_5
    s_branch L_end
Lk_6:
    buffer_store_dwordx4 v[64:67], v5, s[16:19], s61 offen sc1
    ds_write_b32 v3, v8 offset:32
    s_branch L_preB
L_notprod:
    s_cmp_eq_u32 s63, 0
    s_cbranch_scc1 L_dis0
    s_cmp_eq_u32 s63, 3
    s_cbranch_scc1 L_taskw
    s_cmp_eq_u32 s63, 4
    s_cbranch_scc1 L_wtask
    s_cmp_eq_u32 s63, 5
    s_cbranch_scc1 L_flag
    v_and_b32 v4, 7, v0
    v_mul_u32_u24 v1, 1056, v4
    v_and_b32 v4, 8, v0
    v_lshl_add_u32 v1, v4, 6, v1
    v_and_b32 v4, 48, v0
    v_add_u32 v1, v4, v1
    v_add_u32 v5, 105600, v1
    s_lshr_b32 s58, s62, 4
    s_lshl_b32 s58, s58, 3
    s_and_b32 s59, s62, 7
    s_add_u32 s58, s58, s59
    s_lshl_b32 s58, s58, 1
    s_bfe_u32 s59, s62, 0x10003
    s_add_u32 s58, s58, s59
    s_lshl_b32 s58, s58, 10
    s_add_u32 s58, s58, 655360
    v_lshlrev_b32 v6, 4, v0
    s_waitcnt vmcnt(0)
    s_mov_b32 s59, 0
Lw_7:
    ds_read_b32 v4, v3 offset:56
    s_waitcnt lgkmcnt(0)
    v_cmp_gt_u32 vcc, 2, v4
    s_cbranch_vccz Lk_8
    s_add_u32 s59, s59, 1
    s_cmp_lt_u32 s59, 4194304
    s_cbranch_scc1 Lw_7
    s_branch L_end
Lk_8:
    ds_read_b128 v[16:19], v5 offset:0
    ds_read_b128 v[20:23], v5 offset:8448
    ds_read_b128 v[24:27], v5 offset:16896
    ds_read_b128 v[28:31], v5 offset:64
    ds_read_b128 v[32:35], v5 offset:8512
    ds_read_b128 v[36:39], v5 offset:16960
    ds_read_b128 v[40:43], v5 offset:128
    ds_read_b128 v[44:47], v5 offset:8576
    ds_read_b128 v[48:51], v5 offset:17024
    ds_read_b128 v[64:67], v5 offset:192
    ds_read_b128 v[68:71], v5 offset:8640
    ds_read_b128 v[72:75], v5 offset:17088
    s_waitcnt lgkmcnt(9)
    ds_read_b128 v[76:79], v5 offset:256
    ds_read_b128 v[80:83], v5 offset:8704
    ds_read_b128 v[84:87], v5 offset:17152
    v_mfma_f32_16x16x32_bf16 v[8:11], v[16:19], v[24:27], 0
    v_mfma_f32_16x16x32_bf16 v[12:15], v[20:23], v[24:27], 0
    s_waitcnt lgkmcnt(9)
    ds_read_b128 v[88:91], v5 offset:320
    ds_read_b128 v[92:95], v5 offset:8768
    ds_read_b128 v[96:99], v5 offset:17216
    v_mfma_f32_16x16x32_bf16 v[8:11], v[28:31], v[36:39], v[8:11]
    v_mfma_f32_16x16x32_bf16 v[12:15], v[32:35], v[36:39], v[12:15]
    s_waitcnt lgkmcnt(9)
    ds_read_b128 v[100:103], v5 offset:384
    ds_read_b128 v[104:107], v5 offset:8832
    ds_read_b128 v[108:111], v5 offset:17280
    v_mfma_f32_16x16x32_bf16 v[8:11], v[40:43], v[48:51], v[8:11]
    v_mfma_f32_16x16x32_bf16 v[12:15], v[44:47], v[48:51], v[12:15]
    s_waitcnt lgkmcnt(9)
    ds_read_b128 v[112:115], v5 offset:448
    ds_read_b128 v[116:119], v5 offset:8896
    ds_read_b128 v[120:123], v5 offset:17344
    v_mfma_f32_16x16x32_bf16 v[8:11], v[64:67], v[72:75], v[8:11]
    v_mfma_f32_16x16x32_bf16 v[12:15], v[68:71], v[72:75], v[12:15]
    s_waitcnt lgkmcnt(9)
    v_mfma_f32_16x16x32_bf16 v[8:11], v[76:79], v[84:87], v[8:11]
    v_mfma_f32_16x16x32_bf16 v[12:15], v[80:83], v[84:87], v[12:15]
    s_waitcnt lgkmcnt(6)
    v_mfma_f32_16x16x32_bf16 v[8:11], v[88:91], v[96:99], v[8:11]
    v_mfma_f32_16x16x32_bf16 v[12:15], v[92:95], v[96:99], v[12:15]
    s_waitcnt lgkmcnt(3)
    v_mfma_f32_16x16x32_bf16 v[8:11], v[100:103], v[108:111], v[8:11]
    v_mfma_f32_16x16x32_bf16 v[12:15], v[104:107], v[108:111], v[12:15]
    s_waitcnt lgkmcnt(0)
    v_mfma_f32_16x16x32_bf16 v[8:11], v[112:115], v[120:123], v[8:11]
    v_mfma_f32_16x16x32_bf16 v[12:15], v[116:119], v[120:123], v[12:15]
    s_nop 6
    v_cvt_pk_bf16_f32 v16, v8, v9
    v_cvt_pk_bf16_f32 v17, v10, v11
    v_cvt_pk_bf16_f32 v18, v12, v13
    v_cvt_pk_bf16_f32 v19, v14, v15
    buffer_store_dwordx4 v[16:19], v6, s[16:19], s58 offen sc1
    s_branch L_taskw
L_wtask:
    s_lshl_b32 s58, s62, 11
    s_add_u32 s58, s58, 786432
    v_lshlrev_b32 v6, 4, v0
    s_mov_b32 s70, 0x05040100
    s_mov_b32 s71, 0x07060302
    s_waitcnt vmcnt(0)
    v_perm_b32 v64, v17, v16, s70
    v_perm_b32 v68, v17, v16, s71
    v_perm_b32 v65, v19, v18, s70
    v_perm_b32 v69, v19, v18, s71
    v_perm_b32 v66, v21, v20, s70
    v_perm_b32 v70, v21, v20, s71
    v_perm_b32 v67, v23, v22, s70
    v_perm_b32 v71, v23, v22, s71
    buffer_store_dwordx4 v[64:67], v6, s[16:19], s58 offen sc1
    buffer_store_dwordx4 v[68:71], v6, s[16:19], s58 offen offset:1024 sc1
L_taskw:
    s_waitcnt vmcnt(0)
    ds_add_u32 v61, v62 offset:56
    s_branch L_preB
L_flag:
    s_waitcnt lgkmcnt(0)
    s_add_u32 s40, s40, 4096
    s_and_b32 s40, s40, 4294963200
    s_mul_i32 s61, s2, 16
    s_add_u32 s61, s61, 1178624
    s_or_b32 s60, s40, 1
    v_mov_b32 v8, s60
    v_mov_b32 v10, s40
    v_mov_b32 v11, s40
    v_mov_b32 v9, 0
    s_mov_b32 s59, 0
Lw_9:
    ds_read_b32 v4, v3 offset:56
    s_waitcnt lgkmcnt(0)
    v_cmp_gt_u32 vcc, 3, v4
    s_cbranch_vccz Lk_10
    s_add_u32 s59, s59, 1
    s_cmp_lt_u32 s59, 4194304
    s_cbranch_scc1 Lw_9
    s_branch L_end
Lk_10:
    s_mov_b64 exec, 1
    buffer_store_dwordx2 v[10:11], v9, s[16:19], s61 offen sc1
    ds_write_b32 v3, v8 offset:32
    s_mov_b64 exec, -1
    s_branch L_preB
L_dis0:
    s_cmp_lt_u32 s3, 13
    s_cbranch_scc1 L_preB
    s_mov_b64 s[28:29], s[42:43]
    s_mov_b32 s30, 20000
    s_sub_u32 s58, s3, 13
    s_mul_i32 s58, s58, 7168
    v_lshlrev_b32 v4, 4, v0
    s_add_u32 m0, s58, 130944
    s_add_u32 s59, s58, 0
    s_waitcnt vmcnt(1)
    buffer_load_dwordx4 v4, s[28:31], s59 offen offset:0 lds
    s_waitcnt vmcnt(1)
    buffer_load_dwordx4 v4, s[28:31], s59 offen offset:1024 lds
    s_waitcnt vmcnt(1)
    buffer_load_dwordx4 v4, s[28:31], s59 offen offset:2048 lds
    s_waitcnt vmcnt(1)
    buffer_load_dwordx4 v4, s[28:31], s59 offen offset:3072 lds
    s_add_u32 m0, s58, 135040
    s_add_u32 s59, s58, 4096
    s_waitcnt vmcnt(1)
    buffer_load_dwordx4 v4, s[28:31], s59 offen offset:0 lds
    s_waitcnt vmcnt(1)
    buffer_load_dwordx4 v4, s[28:31], s59 offen offset:1024 lds
    s_cmp_eq_u32 s3, 15
    s_cbranch_scc1 L_preB
    s_waitcnt vmcnt(1)
    buffer_load_dwordx4 v4, s[28:31], s59 offen offset:2048 lds
L_preB:
    s_setprio 3
    v_and_b32 v4, 3, v0
    v_mov_b32 v5, 0x0c0c0c0c
    v_mov_b32 v6, 0x0c0c0302
    v_mov_b32 v7, 0x03020c0c
    v_cmp_eq_u32 s[58:59], 0, v4
    v_cmp_eq_u32 s[60:61], 2, v4
    v_cmp_eq_u32 vcc, 1, v4
    v_cndmask_b32 v10, v5, v6, s[58:59]
    v_cndmask_b32 v11, v5, v6, s[60:61]
    v_cndmask_b32 v10, v10, v7, vcc
    v_cmp_eq_u32 vcc, 3, v4
    s_nop 1
    v_cndmask_b32 v11, v11, v7, vcc
    v_and_b32 v10, 0xfdfdfdfd, v10
    v_and_b32 v11, 0xfdfdfdfd, v11
    s_movk_i32 s7, 512
    s_lshl_b32 s58, s4, 3
    v_lshrrev_b32 v5, 3, v0
    v_and_b32 v6, 7, v0
    v_add_u32 v7, s58, v5
    v_mul_u32_u24 v49, 10240, v7
    v_lshl_add_u32 v49, v6, 4, v49
    v_lshlrev_b32 v56, 2, v6
    s_lshl_b32 s60, s6, 2
    s_add_u32 s60, s60, 1114112
    v_lshl_add_u32 v54, v7, 10, s60
    v_mad_u32_u24 v7, v7, 3, v6
    v_cmp_ge_u32 vcc, 186, v7
    v_cmp_gt_u32 s[64:65], 4, v6
    v_mul_u32_u24 v7, 16, v7
    s_and_b64 s[64:65], s[64:65], vcc
    v_cmp_eq_u32 vcc, 0, v6
    v_add_u32 v7, 1179632, v7
    s_or_b64 s[64:65], s[64:65], vcc
    v_cndmask_b32 v54, v7, v54, vcc
    v_cmp_gt_u32 s[62:63], 5, v6
    v_lshl_add_u32 v50, v6, 3, v5
    v_mul_u32_u24 v55, 72, v5
    v_add_u32 v55, 72, v55
    v_lshrrev_b32 v5, 4, v50
    v_mul_u32_u24 v9, 8448, v5
    v_lshl_add_u32 v9, v5, 26, v9
    v_cmp_le_u32 vcc, 32, v50
    v_and_b32 v5, 7, v50
    v_and_b32 v6, 3, v50
    v_cndmask_b32 v5, v5, v6, vcc
    v_mul_u32_u24 v5, 1056, v5
    v_bfe_u32 v6, v50, 3, 1
    v_bfe_u32 v7, v50, 2, 1
    v_cndmask_b32 v6, v6, v7, vcc
    v_lshl_add_u32 v5, v6, 9, v5
    v_mov_b32 v52, 130944
    v_add3_u32 v9, v9, v5, v52
    v_lshrrev_b32 v5, 5, v0
    v_lshl_add_u32 v15, v5, 3, v2
    s_lshl_b32 s58, s5, 2
    s_sub_u32 s58, 158976, s58
    v_mov_b32 v53, s58
    v_add_u32 v5, s5, v50
    v_lshl_add_u32 v8, v5, 1, v52
    v_lshlrev_b32 v50, 2, v50
    v_add_u32 v50, 158976, v50
    v_mov_b32 v57, 156672
    v_mov_b32 v60, 152064
    v_mov_b64 v[16:17], 0
    v_mov_b64 v[18:19], 0
    s_mov_b32 s59, 0
Lw_11:
    ds_read_b32 v4, v3 offset:60
    s_waitcnt lgkmcnt(0)
    v_cmp_gt_u32 vcc, 8, v4
    s_cbranch_vccz Lk_12
    s_sleep 2
    s_add_u32 s59, s59, 1
    s_cmp_lt_u32 s59, 4194304
    s_cbranch_scc1 Lw_11
    s_branch L_end
Lk_12:
    s_mov_b32 s59, 0
Lw_13:
    ds_read_b32 v4, v3 offset:32
    s_waitcnt lgkmcnt(0)
    v_cmp_gt_u32 vcc, 1, v4
    s_cbranch_vccz Lk_14
    s_sleep 1
    s_add_u32 s59, s59, 1
    s_cmp_lt_u32 s59, 4194304
    s_cbranch_scc1 Lw_13
    s_branch L_end
Lk_14:
    v_readfirstlane_b32 s40, v4
    s_mov_b32 s59, 0
    s_mov_b64 exec, s[64:65]
    s_bitset0_b32 s40, 0
L_spoll:
    buffer_load_dwordx2 v[58:59], v54, s[16:19], 0 offen sc1
    s_add_u32 s59, s59, 1
    s_cmp_gt_u32 s59, 0x40000
    s_cbranch_scc1 L_end
    s_waitcnt vmcnt(0)
    v_xor_b32 v58, s40, v58
    v_xor_b32 v59, s40, v59
    v_or_b32 v5, v58, v59
    v_cmpx_lt_u32 vcc, 4095, v5
    s_cbranch_execz L_sok
    s_sleep 8
    s_branch L_spoll
L_sok:
    s_mov_b64 exec, -1
    ds_add_u32 v61, v62 offset:52
    v_sub_u32 v48, v59, v58
    v_lshl_or_b32 v48, v48, 16, v58
    s_nop 1
    v_mov_b32_dpp v48, v48 quad_perm:[0,0,0,0] row_mask:0xf bank_mask:0xf
    s_nop 1
    v_mov_b32_dpp v48, v48 row_shr:4 row_mask:0xf bank_mask:0xa
    v_mad_u32_u16 v49, v48, 4, v49
    v_lshrrev_b32 v48, 16, v48
    v_sub_u32 v48, v48, v56
    v_cmpx_lt_i32 vcc, 0, v48
    s_cbranch_execz L_entld
    buffer_load_dwordx4 v[16:19], v49, s[16:19], 0 offen sc1
    v_cmpx_lt_i32 vcc, 32, v48
    ds_write_b32 v3, v62 offset:28
L_entld:
    s_mov_b64 exec, -1
    s_waitcnt vmcnt(0)
    v_cmpx_lt_i32 vcc, 0, v48
    v_mad_u32_u16 v24, v16, 4, v53 op_sel:[1,0,0,0]
    ds_add_rtn_u32 v32, v24, v62
    v_cmpx_lt_i32 vcc, 1, v48
    v_mad_u32_u16 v25, v17, 4, v53 op_sel:[1,0,0,0]
    ds_add_rtn_u32 v33, v25, v62
    v_cmpx_lt_i32 vcc, 2, v48
    v_mad_u32_u16 v26, v18, 4, v53 op_sel:[1,0,0,0]
    ds_add_rtn_u32 v34, v26, v62
    v_cmpx_lt_i32 vcc, 3, v48
    v_mad_u32_u16 v27, v19, 4, v53 op_sel:[1,0,0,0]
    ds_add_rtn_u32 v35, v27, v62
    s_mov_b64 exec, -1
    ds_add_u32 v61, v62 offset:12
    v_mad_u32_u16 v40, v16, 2, v52
    v_mad_u32_u16 v16, v16, s7, 0
    v_mad_u32_u16 v41, v17, 2, v52
    v_mad_u32_u16 v17, v17, s7, 0
    v_mad_u32_u16 v42, v18, 2, v52
    v_mad_u32_u16 v18, v18, s7, 0
    v_mad_u32_u16 v43, v19, 2, v52
    v_mad_u32_u16 v19, v19, s7, 0
    s_mov_b32 s59, 0
Lw_15:
    ds_read_b32 v4, v3 offset:12
    s_waitcnt lgkmcnt(0)
    v_cmp_gt_u32 vcc, 8, v4
    s_cbranch_vccz Lk_16
    s_add_u32 s59, s59, 1
    s_cmp_lt_u32 s59, 4194304
    s_cbranch_scc1 Lw_15
    s_branch L_end
Lk_16:
    ds_read_b32 v12, v50
    ds_read_b32 v5, v3 offset:28
    ds_read_u16 v8, v8
    ds_read_u16 v40, v40
    ds_read_u16 v41, v41
    ds_read_u16 v42, v42
    ds_read_u16 v43, v43
    s_lshl_b32 s58, s2, 4
    s_add_u32 s58, s58, s3
    s_cmp_eq_u32 s58, 15
    s_cbranch_scc0 L_noep
    v_mov_b32 v6, s40
    v_mov_b32 v7, 1048576
    s_mov_b64 exec, 1
    buffer_store_dword v6, v7, s[16:19], 0 offen sc1
    s_mov_b64 exec, -1
L_noep:
    s_waitcnt lgkmcnt(6)
    v_add_u32 v12, 1, v12
    v_lshrrev_b32 v12, 1, v12
    v_max_u32 v12, 1, v12
    v_cndmask_b32 v12, 0, v12, s[62:63]
    s_lshl_b32 s67, s4, 3
    s_movk_i32 s58, 2304
    v_add_u32_dpp v51, v12, v12 row_shl:1 row_mask:0xf bank_mask:0xf bound_ctrl:1
    s_nop 1
    v_add_u32_dpp v51, v51, v51 row_shl:2 row_mask:0xf bank_mask:0xf bound_ctrl:1
    s_nop 1
    v_add_u32_dpp v51, v12, v51 row_shl:4 row_mask:0xf bank_mask:0x5 bound_ctrl:1
    s_waitcnt lgkmcnt(0)
    v_lshlrev_b32 v8, 16, v8
    v_lshl_add_u32 v5, v5, 10, v51
    v_sub_u32 v6, v55, v51
    v_cmp_le_u32 vcc, 72, v5
    v_lshlrev_b32 v6, 1, v6
    v_subrev_u32 v12, 1, v12
    s_cbranch_vccnz L_slow
    v_and_b32 v12, 0xff, v12
    v_lshl_add_u32 v9, v12, 18, v9
    s_mov_b64 exec, s[62:63]
    ds_write_b32 v50, v6 offset:160
    s_mov_b64 exec, -1
    s_sub_u32 s63, s67, 1
    v_readlane_b32 s67, v51, s67
    v_cmpx_lt_i32 vcc, 0, v48
    ds_read_b32 v24, v24 offset:160
    v_cmpx_lt_i32 vcc, 1, v48
    ds_read_b32 v25, v25 offset:160
    v_cmpx_lt_i32 vcc, 2, v48
    ds_read_b32 v26, v26 offset:160
    v_cmpx_lt_i32 vcc, 3, v48
    ds_read_b32 v27, v27 offset:160
    s_mov_b64 exec, -1
    s_lshr_b32 s66, s67, 3
    s_add_u32 s60, s66, 1
    s_lshl_b32 s60, s60, 3
    s_sub_u32 s67, s60, s67
    s_sub_u32 s62, s67, 1
    s_add_u32 s61, s4, 1
    s_mul_i32 s61, s61, 72
    s_sub_u32 s60, s61, s60
    s_lshl_b32 s60, s60, 2
    s_waitcnt lgkmcnt(0)
    v_cmpx_lt_i32 vcc, 0, v48
    v_add_u32 v24, v24, v32
    v_lshl_add_u32 v5, v24, 1, v57
    ds_write_b16 v5, v40
    v_lshrrev_b32 v6, 1, v24
    v_lshl_add_u32 v6, v6, 2, v60
    v_and_b32 v7, 1, v24
    v_mad_u32_u24 v6, v7, s58, v6
    ds_write_b32 v6, v16
    v_cmpx_lt_i32 vcc, 1, v48
    v_add_u32 v25, v25, v33
    v_lshl_add_u32 v5, v25, 1, v57
    ds_write_b16 v5, v41
    v_lshrrev_b32 v6, 1, v25
    v_lshl_add_u32 v6, v6, 2, v60
    v_and_b32 v7, 1, v25
    v_mad_u32_u24 v6, v7, s58, v6
    ds_write_b32 v6, v17
    v_cmpx_lt_i32 vcc, 2, v48
    v_add_u32 v26, v26, v34
    v_lshl_add_u32 v5, v26, 1, v57
    ds_write_b16 v5, v42
    v_lshrrev_b32 v6, 1, v26
    v_lshl_add_u32 v6, v6, 2, v60
    v_and_b32 v7, 1, v26
    v_mad_u32_u24 v6, v7, s58, v6
    ds_write_b32 v6, v18
    v_cmpx_lt_i32 vcc, 3, v48
    v_add_u32 v27, v27, v35
    v_lshl_add_u32 v5, v27, 1, v57
    ds_write_b16 v5, v43
    v_lshrrev_b32 v6, 1, v27
    v_lshl_add_u32 v6, v6, 2, v60
    v_and_b32 v7, 1, v27
    v_mad_u32_u24 v6, v7, s58, v6
    ds_write_b32 v6, v19
    s_mov_b64 exec, -1
    ds_add_u32 v61, v62 offset:16
    v_lshrrev_b32 v5, 5, v0
    v_mad_u32_u24 v13, v5, s58, v60
    v_add_u32 v13, s60, v13
    v_lshl_add_u32 v14, v5, 1, v57
    v_and_b32 v5, 28, v0
    v_add3_u32 v14, v14, v5, s60
    s_mov_b32 s65, 201486528
    s_mov_b32 s64, 0
    s_mov_b32 s59, 0
Lw_17:
    ds_read_b32 v4, v3 offset:16
    s_waitcnt lgkmcnt(0)
    v_cmp_gt_u32 vcc, 8, v4
    s_cbranch_vccz Lk_18
    s_add_u32 s59, s59, 1
    s_cmp_lt_u32 s59, 4194304
    s_cbranch_scc1 Lw_17
    s_branch L_end
Lk_18:
    v_mov_b32 v12, v3
    v_mov_b32 v3, v2
    s_setprio 1
    s_cmp_lt_u32 s4, 4
    s_cbranch_scc1 L_old
    s_setprio 2
L_old:
    ds_read_b128 v[56:59], v13 offset:0
    ds_read_b128 v[60:63], v13 offset:16
    ds_read_u16 v1, v14
    ds_read_b128 v[48:51], v13 offset:32
    ds_read_b128 v[52:55], v13 offset:48
    s_waitcnt lgkmcnt(3)
L_p0:
    s_cmp_ge_u32 s67, 4
    s_cbranch_scc1 L_p4
    s_cmp_gt_u32 s67, 1
    s_cbranch_scc1 Lps_19
    v_add_u32 v57, v57, v2
    buffer_load_dwordx4 v[20:23], v57, s[8:11], 0 offen
Lps_19:
    s_cmp_gt_u32 s67, 2
    s_cbranch_scc1 Lps_20
    v_add_u32 v58, v58, v2
    buffer_load_dwordx4 v[24:27], v58, s[8:11], 0 offen
Lps_20:
    s_cmp_gt_u32 s67, 3
    s_cbranch_scc1 Lps_21
    v_add_u32 v59, v59, v2
    buffer_load_dwordx4 v[28:31], v59, s[8:11], 0 offen
Lps_21:
L_p4:
    s_cmp_gt_u32 s67, 4
    s_cbranch_scc1 Lps_22
    v_add_u32 v60, v60, v2
    buffer_load_dwordx4 v[32:35], v60, s[8:11], 0 offen
Lps_22:
    s_cmp_gt_u32 s67, 5
    s_cbranch_scc1 Lps_23
    v_add_u32 v61, v61, v2
    buffer_load_dwordx4 v[36:39], v61, s[8:11], 0 offen
Lps_23:
    s_cmp_gt_u32 s67, 6
    s_cbranch_scc1 Lps_24
    v_add_u32 v62, v62, v2
    buffer_load_dwordx4 v[40:43], v62, s[8:11], 0 offen
Lps_24:
    s_cmp_gt_u32 s67, 7
    s_cbranch_scc1 Lps_25
    v_add_u32 v63, v63, v2
    buffer_load_dwordx4 v[44:47], v63, s[8:11], 0 offen
Lps_25:
    s_cmp_eq_u32 s66, 0
    s_cbranch_scc1 L_drain
L_gl:
    s_waitcnt lgkmcnt(1)
    v_perm_b32 v6, v1, v1, v10
    v_perm_b32 v7, v1, v1, v11
    ds_read_u16 v1, v14 offset:32
    s_waitcnt vmcnt(6)
    v_lshl_add_u64 v[4:5], v[48:49], 0, v[2:3]
    s_sub_u32 s62, s62, 2
    s_cbranch_scc1 Lfs_0
    v_mfma_f32_4x4x4_16b_bf16 v[56:59], v[6:7], v[16:17], v[56:59] cbsz:3 abid:0
    v_mfma_f32_4x4x4_16b_bf16 v[60:63], v[6:7], v[18:19], v[60:63] cbsz:3 abid:0
    buffer_load_dwordx4 v[16:19], v4, s[8:11], 0 offen
    v_mfma_f32_4x4x4_16b_bf16 v[56:59], v[6:7], v[20:21], v[56:59] cbsz:3 abid:1
    v_mfma_f32_4x4x4_16b_bf16 v[60:63], v[6:7], v[22:23], v[60:63] cbsz:3 abid:1
    buffer_load_dwordx4 v[20:23], v5, s[8:11], 0 offen
Lbs_0:
    s_waitcnt vmcnt(6)
    v_lshl_add_u64 v[4:5], v[50:51], 0, v[2:3]
    s_sub_u32 s62, s62, 2
    s_cbranch_scc1 Lfs_2
    v_mfma_f32_4x4x4_16b_bf16 v[56:59], v[6:7], v[24:25], v[56:59] cbsz:3 abid:2
    v_mfma_f32_4x4x4_16b_bf16 v[60:63], v[6:7], v[26:27], v[60:63] cbsz:3 abid:2
    buffer_load_dwordx4 v[24:27], v4, s[8:11], 0 offen
    v_mfma_f32_4x4x4_16b_bf16 v[56:59], v[6:7], v[28:29], v[56:59] cbsz:3 abid:3
    v_mfma_f32_4x4x4_16b_bf16 v[60:63], v[6:7], v[30:31], v[60:63] cbsz:3 abid:3
    buffer_load_dwordx4 v[28:31], v5, s[8:11], 0 offen
Lbs_2:
    ds_read_b128 v[48:51], v13 offset:64
    s_waitcnt vmcnt(6) lgkmcnt(2)
    v_lshl_add_u64 v[4:5], v[52:53], 0, v[2:3]
    s_sub_u32 s62, s62, 2
    s_cbranch_scc1 Lfs_4
    v_mfma_f32_4x4x4_16b_bf16 v[56:59], v[6:7], v[32:33], v[56:59] cbsz:3 abid:4
    v_mfma_f32_4x4x4_16b_bf16 v[60:63], v[6:7], v[34:35], v[60:63] cbsz:3 abid:4
    buffer_load_dwordx4 v[32:35], v4, s[8:11], 0 offen
    v_mfma_f32_4x4x4_16b_bf16 v[56:59], v[6:7], v[36:37], v[56:59] cbsz:3 abid:5
    v_mfma_f32_4x4x4_16b_bf16 v[60:63], v[6:7], v[38:39], v[60:63] cbsz:3 abid:5
    buffer_load_dwordx4 v[36:39], v5, s[8:11], 0 offen
Lbs_4:
    s_waitcnt vmcnt(6)
    v_lshl_add_u64 v[4:5], v[54:55], 0, v[2:3]
    s_sub_u32 s62, s62, 2
    s_cbranch_scc1 Lfs_6
    v_mfma_f32_4x4x4_16b_bf16 v[56:59], v[6:7], v[40:41], v[56:59] cbsz:3 abid:6
    v_mfma_f32_4x4x4_16b_bf16 v[60:63], v[6:7], v[42:43], v[60:63] cbsz:3 abid:6
    buffer_load_dwordx4 v[40:43], v4, s[8:11], 0 offen
    v_mfma_f32_4x4x4_16b_bf16 v[56:59], v[6:7], v[44:45], v[56:59] cbsz:3 abid:7
    v_mfma_f32_4x4x4_16b_bf16 v[60:63], v[6:7], v[46:47], v[60:63] cbsz:3 abid:7
    buffer_load_dwordx4 v[44:47], v5, s[8:11], 0 offen
Lbs_6:
    ds_read_b128 v[52:55], v13 offset:80
    v_add_u32 v13, 32, v13
    v_add_u32 v14, 32, v14
    s_sub_u32 s66, s66, 1
    s_cmp_eq_u32 s66, 3
    s_cbranch_scc0 L_nf
    s_setprio 1
L_nf:
    s_cmp_lg_u32 s66, 0
    s_cbranch_scc1 L_gl
L_drain:
    s_waitcnt lgkmcnt(0)
    v_perm_b32 v6, v1, v1, v10
    v_perm_b32 v7, v1, v1, v11
    ds_read_u16 v1, v14 offset:32
    s_waitcnt vmcnt(7)
    v_mfma_f32_4x4x4_16b_bf16 v[56:59], v[6:7], v[16:17], v[56:59] cbsz:3 abid:0
    v_mfma_f32_4x4x4_16b_bf16 v[60:63], v[6:7], v[18:19], v[60:63] cbsz:3 abid:0
    s_sub_u32 s62, s62, 1
    s_cbranch_scc1 Lfd_0
Lbd_0:
    s_waitcnt vmcnt(6)
    v_mfma_f32_4x4x4_16b_bf16 v[56:59], v[6:7], v[20:21], v[56:59] cbsz:3 abid:1
    v_mfma_f32_4x4x4_16b_bf16 v[60:63], v[6:7], v[22:23], v[60:63] cbsz:3 abid:1
    s_sub_u32 s62, s62, 1
    s_cbranch_scc1 Lfd_1
Lbd_1:
    s_waitcnt vmcnt(5)
    v_mfma_f32_4x4x4_16b_bf16 v[56:59], v[6:7], v[24:25], v[56:59] cbsz:3 abid:2
    v_mfma_f32_4x4x4_16b_bf16 v[60:63], v[6:7], v[26:27], v[60:63] cbsz:3 abid:2
    s_sub_u32 s62, s62, 1
    s_cbranch_scc1 Lfd_2
Lbd_2:
    s_waitcnt vmcnt(4)
    v_mfma_f32_4x4x4_16b_bf16 v[56:59], v[6:7], v[28:29], v[56:59] cbsz:3 abid:3
    v_mfma_f32_4x4x4_16b_bf16 v[60:63], v[6:7], v[30:31], v[60:63] cbsz:3 abid:3
    s_sub_u32 s62, s62, 1
    s_cbranch_scc1 Lfd_3
Lbd_3:
    s_waitcnt vmcnt(3)
    v_mfma_f32_4x4x4_16b_bf16 v[56:59], v[6:7], v[32:33], v[56:59] cbsz:3 abid:4
    v_mfma_f32_4x4x4_16b_bf16 v[60:63], v[6:7], v[34:35], v[60:63] cbsz:3 abid:4
    s_sub_u32 s62, s62, 1
    s_cbranch_scc1 Lfd_4
Lbd_4:
    s_waitcnt vmcnt(2)
    v_mfma_f32_4x4x4_16b_bf16 v[56:59], v[6:7], v[36:37], v[56:59] cbsz:3 abid:5
    v_mfma_f32_4x4x4_16b_bf16 v[60:63], v[6:7], v[38:39], v[60:63] cbsz:3 abid:5
    s_sub_u32 s62, s62, 1
    s_cbranch_scc1 Lfd_5
Lbd_5:
    s_waitcnt vmcnt(1)
    v_mfma_f32_4x4x4_16b_bf16 v[56:59], v[6:7], v[40:41], v[56:59] cbsz:3 abid:6
    v_mfma_f32_4x4x4_16b_bf16 v[60:63], v[6:7], v[42:43], v[60:63] cbsz:3 abid:6
    s_sub_u32 s62, s62, 1
    s_cbranch_scc1 Lfd_6
Lbd_6:
    s_waitcnt vmcnt(0)
    v_mfma_f32_4x4x4_16b_bf16 v[56:59], v[6:7], v[44:45], v[56:59] cbsz:3 abid:7
    v_mfma_f32_4x4x4_16b_bf16 v[60:63], v[6:7], v[46:47], v[60:63] cbsz:3 abid:7
    s_nop 1
    s_call_b64 s[68:69], L_flush
L_gdone:
    s_endpgm
Lfs_0:
    s_add_u32 s62, s62, 2
    v_mfma_f32_4x4x4_16b_bf16 v[56:59], v[6:7], v[16:17], v[56:59] cbsz:3 abid:0
    v_mfma_f32_4x4x4_16b_bf16 v[60:63], v[6:7], v[18:19], v[60:63] cbsz:3 abid:0
    buffer_load_dwordx4 v[16:19], v4, s[8:11], 0 offen
    s_sub_u32 s62, s62, 1
    s_cbranch_scc0 Lsk_26
    s_call_b64 s[68:69], L_flush
Lsk_26:
    v_mfma_f32_4x4x4_16b_bf16 v[56:59], v[6:7], v[20:21], v[56:59] cbsz:3 abid:1
    v_mfma_f32_4x4x4_16b_bf16 v[60:63], v[6:7], v[22:23], v[60:63] cbsz:3 abid:1
    buffer_load_dwordx4 v[20:23], v5, s[8:11], 0 offen
    s_sub_u32 s62, s62, 1
    s_cbranch_scc0 Lbs_0
    s_call_b64 s[68:69], L_flush
    s_branch Lbs_0
Lfs_2:
    s_add_u32 s62, s62, 2
    v_mfma_f32_4x4x4_16b_bf16 v[56:59], v[6:7], v[24:25], v[56:59] cbsz:3 abid:2
    v_mfma_f32_4x4x4_16b_bf16 v[60:63], v[6:7], v[26:27], v[60:63] cbsz:3 abid:2
    buffer_load_dwordx4 v[24:27], v4, s[8:11], 0 offen
    s_sub_u32 s62, s62, 1
    s_cbranch_scc0 Lsk_28
    s_call_b64 s[68:69], L_flush
Lsk_28:
    v_mfma_f32_4x4x4_16b_bf16 v[56:59], v[6:7], v[28:29], v[56:59] cbsz:3 abid:3
    v_mfma_f32_4x4x4_16b_bf16 v[60:63], v[6:7], v[30:31], v[60:63] cbsz:3 abid:3
    buffer_load_dwordx4 v[28:31], v5, s[8:11], 0 offen
    s_sub_u32 s62, s62, 1
    s_cbranch_scc0 Lbs_2
    s_call_b64 s[68:69], L_flush
    s_branch Lbs_2
Lfs_4:
    s_add_u32 s62, s62, 2
    v_mfma_f32_4x4x4_16b_bf16 v[56:59], v[6:7], v[32:33], v[56:59] cbsz:3 abid:4
    v_mfma_f32_4x4x4_16b_bf16 v[60:63], v[6:7], v[34:35], v[60:63] cbsz:3 abid:4
    buffer_load_dwordx4 v[32:35], v4, s[8:11], 0 offen
    s_sub_u32 s62, s62, 1
    s_cbranch_scc0 Lsk_30
    s_call_b64 s[68:69], L_flush
Lsk_30:
    v_mfma_f32_4x4x4_16b_bf16 v[56:59], v[6:7], v[36:37], v[56:59] cbsz:3 abid:5
    v_mfma_f32_4x4x4_16b_bf16 v[60:63], v[6:7], v[38:39], v[60:63] cbsz:3 abid:5
    buffer_load_dwordx4 v[36:39], v5, s[8:11], 0 offen
    s_sub_u32 s62, s62, 1
    s_cbranch_scc0 Lbs_4
    s_call_b64 s[68:69], L_flush
    s_branch Lbs_4
Lfs_6:
    s_add_u32 s62, s62, 2
    v_mfma_f32_4x4x4_16b_bf16 v[56:59], v[6:7], v[40:41], v[56:59] cbsz:3 abid:6
    v_mfma_f32_4x4x4_16b_bf16 v[60:63], v[6:7], v[42:43], v[60:63] cbsz:3 abid:6
    buffer_load_dwordx4 v[40:43], v4, s[8:11], 0 offen
    s_sub_u32 s62, s62, 1
    s_cbranch_scc0 Lsk_32
    s_call_b64 s[68:69], L_flush
Lsk_32:
    v_mfma_f32_4x4x4_16b_bf16 v[56:59], v[6:7], v[44:45], v[56:59] cbsz:3 abid:7
    v_mfma_f32_4x4x4_16b_bf16 v[60:63], v[6:7], v[46:47], v[60:63] cbsz:3 abid:7
    buffer_load_dwordx4 v[44:47], v5, s[8:11], 0 offen
    s_sub_u32 s62, s62, 1
    s_cbranch_scc0 Lbs_6
    s_call_b64 s[68:69], L_flush
    s_branch Lbs_6
Lfd_0:
    s_call_b64 s[68:69], L_flush
    s_branch Lbd_0
Lfd_1:
    s_call_b64 s[68:69], L_flush
    s_branch Lbd_1
Lfd_2:
    s_call_b64 s[68:69], L_flush
    s_branch Lbd_2
Lfd_3:
    s_call_b64 s[68:69], L_flush
    s_branch Lbd_3
Lfd_4:
    s_call_b64 s[68:69], L_flush
    s_branch Lbd_4
Lfd_5:
    s_call_b64 s[68:69], L_flush
    s_branch Lbd_5
Lfd_6:
    s_call_b64 s[68:69], L_flush
    s_branch Lbd_6
L_flush:
    s_and_b32 s101, s65, 0x3ffff
    s_add_u32 s63, s63, 1
    v_permlane32_swap_b32 v56, v60
    v_permlane32_swap_b32 v57, v61
    v_permlane32_swap_b32 v58, v62
    v_permlane32_swap_b32 v59, v63
    s_lshr_b32 s62, s65, 26
    v_pk_add_f32 v[56:57], v[56:57], v[60:61]
    v_pk_add_f32 v[58:59], v[58:59], v[62:63]
    v_add_u32 v62, s101, v15
    v_pk_mul_f32 v[56:57], v[56:57], s[64:65] op_sel_hi:[1,0]
    v_pk_mul_f32 v[58:59], v[58:59], s[64:65] op_sel_hi:[1,0]
    v_lshl_add_u32 v63, s62, 2, v12
    v_cvt_pk_bf16_f32 v60, v56, v57
    v_cvt_pk_bf16_f32 v61, v58, v59
    ds_write_b64 v62, v[60:61]
    s_mov_b64 exec, 1
    ds_inc_u32 v63, v63 offset:36
    s_mov_b64 exec, -1
    v_readlane_b32 s65, v9, s63
    v_readlane_b32 s64, v8, s63
    v_mov_b64 v[56:57], 0
    v_mov_b64 v[58:59], 0
    v_mov_b64 v[60:61], 0
    v_mov_b64 v[62:63], 0
    s_bfe_u32 s62, s65, 0x80012
    s_setpc_b64 s[68:69]
L_preA:
    s_setprio 2
    s_mul_i32 s5, s6, 40
    v_mov_b32 v3, 159296
    s_mov_b32 s10, 5120000
    s_mov_b32 s11, 0x20000
    s_mov_b64 s[16:17], s[56:57]
    s_mov_b32 s18, 1310720
    s_mov_b32 s19, 0x20000
    v_and_b32 v6, 32, v0
    v_lshl_add_u32 v5, v6, 7, v2
    v_lshl_add_u32 v6, v6, 6, v2
    s_add_u32 s58, s3, s5
    s_mul_i32 s59, s3, 1056
    s_add_u32 m0, s59, 84480
    s_lshl_b32 s58, s58, 9
    buffer_load_dwordx4 v5, s[8:11], s58 offen lds
    s_add_u32 m0, s59, 92928
    s_add_u32 s58, s58, 8192
    s_waitcnt vmcnt(2)
    buffer_load_dwordx4 v5, s[8:11], s58 offen lds
    s_cmp_ge_u32 s3, 4
    s_cbranch_scc1 L_xa2
    s_add_u32 m0, s59, 101376
    s_add_u32 s58, s58, 8192
    s_waitcnt vmcnt(2)
    buffer_load_dwordx4 v6, s[8:11], s58 offen lds
L_xa2:
    v_and_b32 v4, 7, v0
    v_mul_u32_u24 v1, 1056, v4
    v_and_b32 v4, 8, v0
    v_lshl_add_u32 v1, v4, 6, v1
    v_and_b32 v4, 48, v0
    v_add_u32 v1, v4, v1
    v_add_u32 v12, 84480, v1
    s_mov_b64 s[20:21], s[52:53]
    s_mov_b32 s22, 5120000
    s_mov_b32 s23, 0x20000
    v_lshlrev_b32 v14, 4, v0
    s_lshl_b32 s61, s3, 6
    s_add_u32 s61, s61, 105600
    v_add_u32 v13, s61, v1
    s_lshl_b32 s100, s3, 14
    s_add_u32 s100, s100, 655360
    s_waitcnt lgkmcnt(0)
    v_lshl_add_u32 v104, s32, 9, v2
    v_lshl_add_u32 v105, s33, 9, v2
    v_lshl_add_u32 v106, s34, 9, v2
    v_lshl_add_u32 v107, s35, 9, v2
    v_lshl_add_u32 v108, s36, 9, v2
    v_lshl_add_u32 v109, s37, 9, v2
    v_lshl_add_u32 v110, s38, 9, v2
    v_lshl_add_u32 v111, s39, 9, v2
    v_lshl_add_u32 v112, s64, 9, v2
    v_lshl_add_u32 v113, s65, 9, v2
    s_mov_b32 exec_lo, 0
    v_lshl_add_u32 v104, s40, 9, v2
    v_lshl_add_u32 v105, s41, 9, v2
    v_lshl_add_u32 v106, s42, 9, v2
    v_lshl_add_u32 v107, s43, 9, v2
    v_lshl_add_u32 v108, s44, 9, v2
    v_lshl_add_u32 v109, s45, 9, v2
    v_lshl_add_u32 v110, s46, 9, v2
    v_lshl_add_u32 v111, s47, 9, v2
    v_lshl_add_u32 v112, s66, 9, v2
    v_lshl_add_u32 v113, s67, 9, v2
    s_mov_b64 exec, -1
    s_mul_i32 s67, s3, 2112
    s_mul_i32 s66, s3, 8448
    s_add_u32 m0, s66, 0
    s_waitcnt vmcnt(1)
    buffer_load_dwordx4 v104, s[8:11], 0 offen lds
    s_add_u32 m0, s66, 1056
    s_waitcnt vmcnt(1)
    buffer_load_dwordx4 v105, s[8:11], 0 offen lds
    v_and_b32 v4, 3, v0
    v_mov_b32 v5, 0x0c0c0c0c
    v_mov_b32 v6, 0x0c0c0302
    v_mov_b32 v7, 0x03020c0c
    v_cmp_eq_u32 s[58:59], 0, v4
    v_cmp_eq_u32 s[60:61], 2, v4
    v_cmp_eq_u32 vcc, 1, v4
    v_cndmask_b32 v8, v5, v6, s[58:59]
    v_cndmask_b32 v9, v5, v6, s[60:61]
    v_cndmask_b32 v8, v8, v7, vcc
    v_cmp_eq_u32 vcc, 3, v4
    s_nop 1
    v_cndmask_b32 v9, v9, v7, vcc
    v_mov_b32 v10, v8
    v_mov_b32 v11, v9
    v_and_b32 v8, 0xfdfdfdfd, v8
    v_and_b32 v9, 0xfdfdfdfd, v9
    s_add_u32 m0, s66, 2112
    s_waitcnt vmcnt(1)
    buffer_load_dwordx4 v106, s[8:11], 0 offen lds
    s_mov_b64 exec, 1
    v_mov_b32 v4, 1
    ds_add_u32 v3, v4 offset:0
    s_mov_b64 exec, -1
    s_add_u32 m0, s66, 3168
    s_waitcnt vmcnt(1)
    buffer_load_dwordx4 v107, s[8:11], 0 offen lds
    s_add_u32 m0, s66, 4224
    s_waitcnt vmcnt(1)
    buffer_load_dwordx4 v108, s[8:11], 0 offen lds
    s_mov_b32 s59, 0
Lw_34:
    ds_read_b32 v4, v3 offset:0
    s_waitcnt lgkmcnt(0)
    v_cmp_gt_u32 vcc, 8, v4
    s_cbranch_vccz Lk_35
    s_add_u32 s59, s59, 1
    s_cmp_lt_u32 s59, 4194304
    s_cbranch_scc1 Lw_34
    s_branch L_end
Lk_35:
    ds_read_b128 v[80:83], v12 offset:0
    ds_read_b128 v[84:87], v12 offset:8448
    ds_read_b128 v[88:91], v12 offset:16896
    s_add_u32 m0, s66, 5280
    s_waitcnt vmcnt(1)
    buffer_load_dwordx4 v109, s[8:11], 0 offen lds
    s_mov_b64 exec, 1
    v_mov_b32 v4, 1
    ds_add_u32 v3, v4 offset:60
    s_mov_b64 exec, -1
    s_waitcnt vmcnt(1)
    ds_read_b32 v4, v3 offset:52
    s_add_u32 m0, s66, 6336
    s_waitcnt vmcnt(1)
    buffer_load_dwordx4 v110, s[8:11], 0 offen lds
    s_waitcnt lgkmcnt(0)
    v_cmp_gt_u32 vcc, 8, v4
    s_cbranch_vccz L_eu7
    s_waitcnt vmcnt(1)
    ds_read_b32 v4, v3 offset:52
    s_add_u32 m0, s66, 7392
    s_waitcnt vmcnt(1)
    buffer_load_dwordx4 v111, s[8:11], 0 offen lds
    s_waitcnt lgkmcnt(0)
    v_cmp_gt_u32 vcc, 8, v4
    s_cbranch_vccz L_eu8
    s_waitcnt vmcnt(1)
    ds_read_b32 v4, v3 offset:52
    s_add_u32 m0, s67, 67584
    s_waitcnt vmcnt(1)
    buffer_load_dwordx4 v112, s[8:11], 0 offen lds
    s_waitcnt lgkmcnt(0)
    v_cmp_gt_u32 vcc, 8, v4
    s_cbranch_vccz L_eu9
    s_waitcnt vmcnt(1)
    ds_read_b32 v4, v3 offset:52
    s_add_u32 m0, s67, 68640
    s_waitcnt vmcnt(1)
    buffer_load_dwordx4 v113, s[8:11], 0 offen lds
    s_mov_b32 s59, 0
Lw_36:
    ds_read_b32 v4, v3 offset:52
    s_waitcnt lgkmcnt(0)
    v_cmp_gt_u32 vcc, 8, v4
    s_cbranch_vccz Lk_37
    s_sleep 1
    s_add_u32 s59, s59, 1
    s_cmp_lt_u32 s59, 4194304
    s_cbranch_scc1 Lw_36
    s_branch L_end
Lk_37:
    s_branch L_eu10
L_eu7:
    s_add_u32 m0, s66, 7392
    s_waitcnt vmcnt(63)
    buffer_load_dwordx4 v111, s[8:11], 0 offen lds
L_eu8:
    s_add_u32 m0, s67, 67584
    s_waitcnt vmcnt(63)
    buffer_load_dwordx4 v112, s[8:11], 0 offen lds
L_eu9:
    s_add_u32 m0, s67, 68640
    s_waitcnt vmcnt(63)
    buffer_load_dwordx4 v113, s[8:11], 0 offen lds
L_eu10:
    s_setprio 3
    buffer_load_dwordx4 v[16:19], v14, s[16:19], s100 offen offset:0 sc1
    buffer_load_dwordx4 v[20:23], v14, s[16:19], s100 offen offset:1024 sc1
    buffer_load_dwordx4 v[24:27], v14, s[16:19], s100 offen offset:2048 sc1
    buffer_load_dwordx4 v[28:31], v14, s[16:19], s100 offen offset:3072 sc1
    s_add_u32 s100, s100, 4096
    buffer_load_dwordx4 v[32:35], v14, s[16:19], s100 offen offset:0 sc1
    buffer_load_dwordx4 v[36:39], v14, s[16:19], s100 offen offset:1024 sc1
    buffer_load_dwordx4 v[40:43], v14, s[16:19], s100 offen offset:2048 sc1
    buffer_load_dwordx4 v[44:47], v14, s[16:19], s100 offen offset:3072 sc1
    s_add_u32 s100, s100, 4096
    buffer_load_dwordx4 v[48:51], v14, s[16:19], s100 offen offset:0 sc1
    buffer_load_dwordx4 v[52:55], v14, s[16:19], s100 offen offset:1024 sc1
    buffer_load_dwordx4 v[56:59], v14, s[16:19], s100 offen offset:2048 sc1
    buffer_load_dwordx4 v[60:63], v14, s[16:19], s100 offen offset:3072 sc1
    s_add_u32 s100, s100, 4096
    buffer_load_dwordx4 v[64:67], v14, s[16:19], s100 offen offset:0 sc1
    buffer_load_dwordx4 v[68:71], v14, s[16:19], s100 offen offset:1024 sc1
    buffer_load_dwordx4 v[72:75], v14, s[16:19], s100 offen offset:2048 sc1
    buffer_load_dwordx4 v[76:79], v14, s[16:19], s100 offen offset:3072 sc1
    s_setprio 0
    ds_read_b128 v[92:95], v12 offset:64
    ds_read_b128 v[96:99], v12 offset:8512
    ds_read_b128 v[100:103], v12 offset:16960
    s_waitcnt vmcnt(14) lgkmcnt(3)
    v_mfma_f32_16x16x32_bf16 v[104:107], v[16:19], v[80:83], 0
    v_mfma_f32_16x16x32_bf16 v[108:111], v[20:23], v[80:83], 0
    v_mfma_f32_16x16x32_bf16 v[112:115], v[16:19], v[84:87], 0
    v_mfma_f32_16x16x32_bf16 v[116:119], v[20:23], v[84:87], 0
    v_mfma_f32_16x16x32_bf16 v[120:123], v[16:19], v[88:91], 0
    v_mfma_f32_16x16x32_bf16 v[124:127], v[20:23], v[88:91], 0
    ds_read_b128 v[80:83], v12 offset:128
    ds_read_b128 v[84:87], v12 offset:8576
    ds_read_b128 v[88:91], v12 offset:17024
    s_waitcnt vmcnt(12) lgkmcnt(3)
    v_mfma_f32_16x16x32_bf16 v[104:107], v[24:27], v[92:95], v[104:107]
    v_mfma_f32_16x16x32_bf16 v[108:111], v[28:31], v[92:95], v[108:111]
    v_mfma_f32_16x16x32_bf16 v[112:115], v[24:27], v[96:99], v[112:115]
    v_mfma_f32_16x16x32_bf16 v[116:119], v[28:31], v[96:99], v[116:119]
    v_mfma_f32_16x16x32_bf16 v[120:123], v[24:27], v[100:103], v[120:123]
    v_mfma_f32_16x16x32_bf16 v[124:127], v[28:31], v[100:103], v[124:127]
    ds_read_b128 v[92:95], v12 offset:192
    ds_read_b128 v[96:99], v12 offset:8640
    ds_read_b128 v[100:103], v12 offset:17088
    s_waitcnt vmcnt(10) lgkmcnt(3)
    v_mfma_f32_16x16x32_bf16 v[104:107], v[32:35], v[80:83], v[104:107]
    v_mfma_f32_16x16x32_bf16 v[108:111], v[36:39], v[80:83], v[108:111]
    v_mfma_f32_16x16x32_bf16 v[112:115], v[32:35], v[84:87], v[112:115]
    v_mfma_f32_16x16x32_bf16 v[116:119], v[36:39], v[84:87], v[116:119]
    v_mfma_f32_16x16x32_bf16 v[120:123], v[32:35], v[88:91], v[120:123]
    v_mfma_f32_16x16x32_bf16 v[124:127], v[36:39], v[88:91], v[124:127]
    ds_read_b128 v[80:83], v12 offset:256
    ds_read_b128 v[84:87], v12 offset:8704
    ds_read_b128 v[88:91], v12 offset:17152
    s_waitcnt vmcnt(8) lgkmcnt(3)
    v_mfma_f32_16x16x32_bf16 v[104:107], v[40:43], v[92:95], v[104:107]
    v_mfma_f32_16x16x32_bf16 v[108:111], v[44:47], v[92:95], v[108:111]
    v_mfma_f32_16x16x32_bf16 v[112:115], v[40:43], v[96:99], v[112:115]
    v_mfma_f32_16x16x32_bf16 v[116:119], v[44:47], v[96:99], v[116:119]
    v_mfma_f32_16x16x32_bf16 v[120:123], v[40:43], v[100:103], v[120:123]
    v_mfma_f32_16x16x32_bf16 v[124:127], v[44:47], v[100:103], v[124:127]
    ds_read_b128 v[92:95], v12 offset:320
    ds_read_b128 v[96:99], v12 offset:8768
    ds_read_b128 v[100:103], v12 offset:17216
    s_waitcnt vmcnt(6) lgkmcnt(3)
    v_mfma_f32_16x16x32_bf16 v[104:107], v[48:51], v[80:83], v[104:107]
    v_mfma_f32_16x16x32_bf16 v[108:111], v[52:55], v[80:83], v[108:111]
    v_mfma_f32_16x16x32_bf16 v[112:115], v[48:51], v[84:87], v[112:115]
    v_mfma_f32_16x16x32_bf16 v[116:119], v[52:55], v[84:87], v[116:119]
    v_mfma_f32_16x16x32_bf16 v[120:123], v[48:51], v[88:91], v[120:123]
    v_mfma_f32_16x16x32_bf16 v[124:127], v[52:55], v[88:91], v[124:127]
    s_setprio 3
    s_add_u32 s100, s100, 118784
    buffer_load_dwordx4 v[16:19], v14, s[16:19], s100 offen offset:0 sc1
    buffer_load_dwordx4 v[20:23], v14, s[16:19], s100 offen offset:1024 sc1
    buffer_load_dwordx4 v[24:27], v14, s[16:19], s100 offen offset:2048 sc1
    buffer_load_dwordx4 v[28:31], v14, s[16:19], s100 offen offset:3072 sc1
    s_setprio 0
    ds_read_b128 v[80:83], v12 offset:384
    ds_read_b128 v[84:87], v12 offset:8832
    ds_read_b128 v[88:91], v12 offset:17280
    s_waitcnt vmcnt(8) lgkmcnt(3)
    v_mfma_f32_16x16x32_bf16 v[104:107], v[56:59], v[92:95], v[104:107]
    v_mfma_f32_16x16x32_bf16 v[108:111], v[60:63], v[92:95], v[108:111]
    v_mfma_f32_16x16x32_bf16 v[112:115], v[56:59], v[96:99], v[112:115]
    v_mfma_f32_16x16x32_bf16 v[116:119], v[60:63], v[96:99], v[116:119]
    v_mfma_f32_16x16x32_bf16 v[120:123], v[56:59], v[100:103], v[120:123]
    v_mfma_f32_16x16x32_bf16 v[124:127], v[60:63], v[100:103], v[124:127]
    s_setprio 3
    s_add_u32 s100, s100, 4096
    buffer_load_dwordx4 v[32:35], v14, s[16:19], s100 offen offset:0 sc1
    buffer_load_dwordx4 v[36:39], v14, s[16:19], s100 offen offset:1024 sc1
    buffer_load_dwordx4 v[40:43], v14, s[16:19], s100 offen offset:2048 sc1
    buffer_load_dwordx4 v[44:47], v14, s[16:19], s100 offen offset:3072 sc1
    s_setprio 0
    ds_read_b128 v[92:95], v12 offset:448
    ds_read_b128 v[96:99], v12 offset:8896
    ds_read_b128 v[100:103], v12 offset:17344
    s_waitcnt vmcnt(10) lgkmcnt(3)
    v_mfma_f32_16x16x32_bf16 v[104:107], v[64:67], v[80:83], v[104:107]
    v_mfma_f32_16x16x32_bf16 v[108:111], v[68:71], v[80:83], v[108:111]
    v_mfma_f32_16x16x32_bf16 v[112:115], v[64:67], v[84:87], v[112:115]
    v_mfma_f32_16x16x32_bf16 v[116:119], v[68:71], v[84:87], v[116:119]
    v_mfma_f32_16x16x32_bf16 v[120:123], v[64:67], v[88:91], v[120:123]
    v_mfma_f32_16x16x32_bf16 v[124:127], v[68:71], v[88:91], v[124:127]
    s_setprio 3
    s_add_u32 s100, s100, 4096
    buffer_load_dwordx4 v[48:51], v14, s[16:19], s100 offen offset:0 sc1
    buffer_load_dwordx4 v[52:55], v14, s[16:19], s100 offen offset:1024 sc1
    buffer_load_dwordx4 v[56:59], v14, s[16:19], s100 offen offset:2048 sc1
    buffer_load_dwordx4 v[60:63], v14, s[16:19], s100 offen offset:3072 sc1
    s_setprio 0
    s_waitcnt vmcnt(12) lgkmcnt(0)
    v_mfma_f32_16x16x32_bf16 v[104:107], v[72:75], v[92:95], v[104:107]
    v_mfma_f32_16x16x32_bf16 v[108:111], v[76:79], v[92:95], v[108:111]
    v_mfma_f32_16x16x32_bf16 v[112:115], v[72:75], v[96:99], v[112:115]
    v_mfma_f32_16x16x32_bf16 v[116:119], v[76:79], v[96:99], v[116:119]
    v_mfma_f32_16x16x32_bf16 v[120:123], v[72:75], v[100:103], v[120:123]
    v_mfma_f32_16x16x32_bf16 v[124:127], v[76:79], v[100:103], v[124:127]
    s_setprio 3
    s_add_u32 s100, s100, 4096
    buffer_load_dwordx4 v[64:67], v14, s[16:19], s100 offen offset:0 sc1
    buffer_load_dwordx4 v[68:71], v14, s[16:19], s100 offen offset:1024 sc1
    buffer_load_dwordx4 v[72:75], v14, s[16:19], s100 offen offset:2048 sc1
    buffer_load_dwordx4 v[76:79], v14, s[16:19], s100 offen offset:3072 sc1
    s_setprio 0
    s_nop 3
    v_cvt_pk_bf16_f32 v80, v104, v105
    v_cvt_pk_bf16_f32 v81, v106, v107
    v_cvt_pk_bf16_f32 v82, v108, v109
    v_cvt_pk_bf16_f32 v83, v110, v111
    ds_write_b128 v13, v[80:83] offset:0
    v_cvt_pk_bf16_f32 v84, v112, v113
    v_cvt_pk_bf16_f32 v85, v114, v115
    v_cvt_pk_bf16_f32 v86, v116, v117
    v_cvt_pk_bf16_f32 v87, v118, v119
    ds_write_b128 v13, v[84:87] offset:8448
    v_cvt_pk_bf16_f32 v88, v120, v121
    v_cvt_pk_bf16_f32 v89, v122, v123
    v_cvt_pk_bf16_f32 v90, v124, v125
    v_cvt_pk_bf16_f32 v91, v126, v127
    ds_write_b128 v13, v[88:91] offset:16896
    s_mov_b64 exec, 1
    v_mov_b32 v4, 1
    ds_add_u32 v3, v4 offset:20
    s_mov_b64 exec, -1
    s_setprio 3
    s_setprio 0
    s_mov_b32 s63, s3
L_grp:
    s_mul_i32 s58, s63, 8448
    s_lshr_b32 s59, s63, 2
    s_mul_i32 s59, s59, 8448
    s_and_b32 s60, s63, 1
    s_bfe_u32 s61, s63, 0x10001
    s_cmp_ge_u32 s63, 8
    s_cselect_b32 s61, s60, s61
    s_cselect_b32 s60, 0, s60
    s_mul_i32 s60, s60, 4224
    s_lshl_b32 s61, s61, 9
    s_add_u32 s59, s59, s60
    s_add_u32 s59, s59, s61
    s_add_u32 s59, s59, 105600
    v_add_u32 v12, s58, v1
    v_bfe_u32 v4, v0, 2, 2
    v_mul_u32_u24 v4, 1056, v4
    v_and_b32 v5, 48, v0
    v_add3_u32 v13, v4, v5, s59
    v_lshl_add_u32 v14, v0, 3, s58
    v_lshl_add_u32 v2, v0, 3, s59
    s_cmp_ge_u32 s63, 8
    s_cbranch_scc1 L_grp2
    s_mov_b32 s59, 0
Lw_38:
    ds_read_b32 v4, v3 offset:20
    s_waitcnt lgkmcnt(0)
    v_cmp_gt_u32 vcc, 8, v4
    s_cbranch_vccz Lk_39
    s_sleep 1
    s_add_u32 s59, s59, 1
    s_cmp_lt_u32 s59, 4194304
    s_cbranch_scc1 Lw_38
    s_branch L_end
Lk_39:
L_grp2:
    s_waitcnt lgkmcnt(0)
    ds_read_b128 v[80:83], v12 offset:0
    ds_read_b128 v[84:87], v13 offset:0
    ds_read_b128 v[88:91], v12 offset:64
    ds_read_b128 v[92:95], v13 offset:64
    ds_read_b128 v[96:99], v12 offset:128
    ds_read_b128 v[100:103], v13 offset:128
    ds_read_b128 v[104:107], v12 offset:192
    ds_read_b128 v[108:111], v13 offset:192
    ds_read_b128 v[112:115], v12 offset:256
    ds_read_b128 v[116:119], v13 offset:256
    ds_read_b128 v[120:123], v12 offset:320
    ds_read_b128 v[124:127], v13 offset:320
    s_waitcnt lgkmcnt(10)
    v_mfma_f32_16x16x32_bf16 v[4:7], v[80:83], v[84:87], 0
    ds_read_b128 v[80:83], v12 offset:384
    ds_read_b128 v[84:87], v13 offset:384
    s_waitcnt lgkmcnt(10)
    v_mfma_f32_16x16x32_bf16 v[4:7], v[88:91], v[92:95], v[4:7]
    ds_read_b128 v[88:91], v12 offset:448
    ds_read_b128 v[92:95], v13 offset:448
    s_waitcnt lgkmcnt(10)
    v_mfma_f32_16x16x32_bf16 v[4:7], v[96:99], v[100:103], v[4:7]
    s_waitcnt lgkmcnt(8)
    v_mfma_f32_16x16x32_bf16 v[4:7], v[104:107], v[108:111], v[4:7]
    s_waitcnt lgkmcnt(6)
    v_mfma_f32_16x16x32_bf16 v[4:7], v[112:115], v[116:119], v[4:7]
    s_waitcnt lgkmcnt(4)
    v_mfma_f32_16x16x32_bf16 v[4:7], v[120:123], v[124:127], v[4:7]
    s_waitcnt lgkmcnt(2)
    v_mfma_f32_16x16x32_bf16 v[4:7], v[80:83], v[84:87], v[4:7]
    s_waitcnt lgkmcnt(0)
    v_mfma_f32_16x16x32_bf16 v[4:7], v[88:91], v[92:95], v[4:7]
    ds_read_b64 v[96:97], v14 offset:2112
    ds_read_b64 v[98:99], v14 offset:6336
    ds_read_b64 v[100:101], v14 offset:2624
    ds_read_b64 v[102:103], v14 offset:6848
    ds_read_b64 v[104:105], v14 offset:3168
    ds_read_b64 v[106:107], v14 offset:7392
    ds_read_b64 v[108:109], v14 offset:3680
    ds_read_b64 v[110:111], v14 offset:7904
    ds_read_b64 v[80:81], v14 offset:0
    ds_read_b64 v[82:83], v14 offset:4224
    ds_read_b64 v[84:85], v14 offset:512
    ds_read_b64 v[86:87], v14 offset:4736
    ds_read_b64 v[88:89], v14 offset:1056
    ds_read_b64 v[90:91], v14 offset:5280
    ds_read_b64 v[92:93], v14 offset:1568
    s_waitcnt lgkmcnt(14)
    ds_read_b64 v[94:95], v14 offset:5792
    v_mul_f32 v4, 0x3db8aa3b, v4
    v_mul_f32 v5, 0x3db8aa3b, v5
    v_mul_f32 v6, 0x3db8aa3b, v6
    v_mul_f32 v7, 0x3db8aa3b, v7
    v_exp_f32 v4, v4
    v_exp_f32 v5, v5
    v_exp_f32 v6, v6
    v_exp_f32 v7, v7
    v_add_f32 v12, v4, v5
    v_add_f32 v13, v6, v7
    v_add_f32 v12, v12, v13
    v_add_f32 v12, 0x3089705f, v12
    v_rcp_f32 v12, v12
    s_add_u32 s63, s63, 8
    v_mul_f32 v4, v4, v12
    v_mul_f32 v5, v5, v12
    v_mul_f32 v6, v6, v12
    v_mul_f32 v7, v7, v12
    v_cvt_pk_bf16_f32 v4, v4, v5
    v_cvt_pk_bf16_f32 v6, v6, v7
    v_perm_b32 v112, v4, v4, v8
    v_perm_b32 v113, v4, v4, v9
    v_perm_b32 v114, v4, v4, v10
    v_perm_b32 v115, v4, v4, v11
    v_perm_b32 v116, v6, v6, v8
    v_perm_b32 v117, v6, v6, v9
    v_perm_b32 v118, v6, v6, v10
    v_perm_b32 v119, v6, v6, v11
    s_waitcnt lgkmcnt(0)
    v_mfma_f32_4x4x4_16b_bf16 v[120:123], v[112:113], v[80:81], 0 cbsz:4 abid:0
    v_mfma_f32_4x4x4_16b_bf16 v[124:127], v[112:113], v[82:83], 0 cbsz:4 abid:5
    v_mfma_f32_4x4x4_16b_bf16 v[4:7], v[112:113], v[84:85], 0 cbsz:4 abid:10
    v_mfma_f32_4x4x4_16b_bf16 v[12:15], v[112:113], v[86:87], 0 cbsz:4 abid:15
    v_mfma_f32_4x4x4_16b_bf16 v[120:123], v[114:115], v[88:89], v[120:123] cbsz:4 abid:0
    v_mfma_f32_4x4x4_16b_bf16 v[124:127], v[114:115], v[90:91], v[124:127] cbsz:4 abid:5
    v_mfma_f32_4x4x4_16b_bf16 v[4:7], v[114:115], v[92:93], v[4:7] cbsz:4 abid:10
    v_mfma_f32_4x4x4_16b_bf16 v[12:15], v[114:115], v[94:95], v[12:15] cbsz:4 abid:15
    v_mfma_f32_4x4x4_16b_bf16 v[120:123], v[116:117], v[96:97], v[120:123] cbsz:4 abid:0
    v_mfma_f32_4x4x4_16b_bf16 v[124:127], v[116:117], v[98:99], v[124:127] cbsz:4 abid:5
    v_mfma_f32_4x4x4_16b_bf16 v[4:7], v[116:117], v[100:101], v[4:7] cbsz:4 abid:10
    v_mfma_f32_4x4x4_16b_bf16 v[12:15], v[116:117], v[102:103], v[12:15] cbsz:4 abid:15
    v_mfma_f32_4x4x4_16b_bf16 v[120:123], v[118:119], v[104:105], v[120:123] cbsz:4 abid:0
    v_mfma_f32_4x4x4_16b_bf16 v[124:127], v[118:119], v[106:107], v[124:127] cbsz:4 abid:5
    v_mfma_f32_4x4x4_16b_bf16 v[4:7], v[118:119], v[108:109], v[4:7] cbsz:4 abid:10
    v_mfma_f32_4x4x4_16b_bf16 v[12:15], v[118:119], v[110:111], v[12:15] cbsz:4 abid:15
    s_nop 1
    v_cvt_pk_bf16_f32 v112, v120, v121
    v_cvt_pk_bf16_f32 v113, v122, v123
    ds_write_b64 v2, v[112:113] offset:0
    v_cvt_pk_bf16_f32 v114, v124, v125
    v_cvt_pk_bf16_f32 v115, v126, v127
    ds_write_b64 v2, v[114:115] offset:1056
    v_cvt_pk_bf16_f32 v116, v4, v5
    v_cvt_pk_bf16_f32 v117, v6, v7
    ds_write_b64 v2, v[116:117] offset:2112
    v_cvt_pk_bf16_f32 v118, v12, v13
    v_cvt_pk_bf16_f32 v119, v14, v15
    ds_write_b64 v2, v[118:119] offset:3168
    s_cmp_lt_u32 s63, 10
    s_cbranch_scc1 L_grp
L_grpx:
    s_mov_b64 exec, 1
    v_mov_b32 v4, 1
    ds_add_u32 v3, v4 offset:24
    s_mov_b64 exec, -1
    v_add_u32 v12, 105600, v1
    v_lshlrev_b32 v14, 4, v0
    v_and_b32 v6, 15, v0
    v_lshlrev_b32 v6, 2, v6
    v_and_b32 v5, 48, v0
    v_lshl_add_u32 v8, v5, 7, v6
    v_and_b32 v5, 32, v0
    v_lshl_add_u32 v9, v5, 6, v6
    v_and_b32 v5, 16, v0
    v_lshl_add_u32 v9, v5, 22, v9
    s_lshl_b32 s60, s5, 9
    s_lshl_b32 s61, s3, 6
    s_add_u32 s60, s60, s61
    s_mov_b32 s59, 0
Lw_40:
    ds_read_b32 v4, v3 offset:24
    s_waitcnt lgkmcnt(0)
    v_cmp_gt_u32 vcc, 8, v4
    s_cbranch_vccz Lk_41
    s_sleep 1
    s_add_u32 s59, s59, 1
    s_cmp_lt_u32 s59, 4194304
    s_cbranch_scc1 Lw_40
    s_branch L_end
Lk_41:
    ds_read_b128 v[80:83], v12 offset:0
    ds_read_b128 v[84:87], v12 offset:8448
    ds_read_b128 v[88:91], v12 offset:16896
    ds_read_b128 v[92:95], v12 offset:64
    ds_read_b128 v[96:99], v12 offset:8512
    ds_read_b128 v[100:103], v12 offset:16960
    s_waitcnt vmcnt(14) lgkmcnt(3)
    v_mfma_f32_16x16x32_bf16 v[104:107], v[80:83], v[16:19], 0
    v_mfma_f32_16x16x32_bf16 v[108:111], v[80:83], v[20:23], 0
    v_mfma_f32_16x16x32_bf16 v[112:115], v[84:87], v[16:19], 0
    v_mfma_f32_16x16x32_bf16 v[116:119], v[84:87], v[20:23], 0
    v_mfma_f32_16x16x32_bf16 v[120:123], v[88:91], v[16:19], 0
    v_mfma_f32_16x16x32_bf16 v[124:127], v[88:91], v[20:23], 0
    ds_read_b128 v[80:83], v12 offset:128
    ds_read_b128 v[84:87], v12 offset:8576
    ds_read_b128 v[88:91], v12 offset:17024
    s_waitcnt vmcnt(12) lgkmcnt(3)
    v_mfma_f32_16x16x32_bf16 v[104:107], v[92:95], v[24:27], v[104:107]
    v_mfma_f32_16x16x32_bf16 v[108:111], v[92:95], v[28:31], v[108:111]
    v_mfma_f32_16x16x32_bf16 v[112:115], v[96:99], v[24:27], v[112:115]
    v_mfma_f32_16x16x32_bf16 v[116:119], v[96:99], v[28:31], v[116:119]
    v_mfma_f32_16x16x32_bf16 v[120:123], v[100:103], v[24:27], v[120:123]
    v_mfma_f32_16x16x32_bf16 v[124:127], v[100:103], v[28:31], v[124:127]
    ds_read_b128 v[92:95], v12 offset:192
    ds_read_b128 v[96:99], v12 offset:8640
    ds_read_b128 v[100:103], v12 offset:17088
    s_waitcnt vmcnt(10) lgkmcnt(3)
    v_mfma_f32_16x16x32_bf16 v[104:107], v[80:83], v[32:35], v[104:107]
    v_mfma_f32_16x16x32_bf16 v[108:111], v[80:83], v[36:39], v[108:111]
    v_mfma_f32_16x16x32_bf16 v[112:115], v[84:87], v[32:35], v[112:115]
    v_mfma_f32_16x16x32_bf16 v[116:119], v[84:87], v[36:39], v[116:119]
    v_mfma_f32_16x16x32_bf16 v[120:123], v[88:91], v[32:35], v[120:123]
    v_mfma_f32_16x16x32_bf16 v[124:127], v[88:91], v[36:39], v[124:127]
    ds_read_b128 v[80:83], v12 offset:256
    ds_read_b128 v[84:87], v12 offset:8704
    ds_read_b128 v[88:91], v12 offset:17152
    s_waitcnt vmcnt(8) lgkmcnt(3)
    v_mfma_f32_16x16x32_bf16 v[104:107], v[92:95], v[40:43], v[104:107]
    v_mfma_f32_16x16x32_bf16 v[108:111], v[92:95], v[44:47], v[108:111]
    v_mfma_f32_16x16x32_bf16 v[112:115], v[96:99], v[40:43], v[112:115]
    v_mfma_f32_16x16x32_bf16 v[116:119], v[96:99], v[44:47], v[116:119]
    v_mfma_f32_16x16x32_bf16 v[120:123], v[100:103], v[40:43], v[120:123]
    v_mfma_f32_16x16x32_bf16 v[124:127], v[100:103], v[44:47], v[124:127]
    ds_read_b128 v[92:95], v12 offset:320
    ds_read_b128 v[96:99], v12 offset:8768
    ds_read_b128 v[100:103], v12 offset:17216
    s_waitcnt vmcnt(6) lgkmcnt(3)
    v_mfma_f32_16x16x32_bf16 v[104:107], v[80:83], v[48:51], v[104:107]
    v_mfma_f32_16x16x32_bf16 v[108:111], v[80:83], v[52:55], v[108:111]
    v_mfma_f32_16x16x32_bf16 v[112:115], v[84:87], v[48:51], v[112:115]
    v_mfma_f32_16x16x32_bf16 v[116:119], v[84:87], v[52:55], v[116:119]
    v_mfma_f32_16x16x32_bf16 v[120:123], v[88:91], v[48:51], v[120:123]
    v_mfma_f32_16x16x32_bf16 v[124:127], v[88:91], v[52:55], v[124:127]
    s_setprio 3
    s_add_u32 s100, s100, 118784
    buffer_load_dwordx4 v[16:19], v14, s[16:19], s100 offen offset:0 sc1
    buffer_load_dwordx4 v[20:23], v14, s[16:19], s100 offen offset:1024 sc1
    buffer_load_dwordx4 v[24:27], v14, s[16:19], s100 offen offset:2048 sc1
    buffer_load_dwordx4 v[28:31], v14, s[16:19], s100 offen offset:3072 sc1
    s_setprio 0
    ds_read_b128 v[80:83], v12 offset:384
    ds_read_b128 v[84:87], v12 offset:8832
    ds_read_b128 v[88:91], v12 offset:17280
    s_waitcnt vmcnt(8) lgkmcnt(3)
    v_mfma_f32_16x16x32_bf16 v[104:107], v[92:95], v[56:59], v[104:107]
    v_mfma_f32_16x16x32_bf16 v[108:111], v[92:95], v[60:63], v[108:111]
    v_mfma_f32_16x16x32_bf16 v[112:115], v[96:99], v[56:59], v[112:115]
    v_mfma_f32_16x16x32_bf16 v[116:119], v[96:99], v[60:63], v[116:119]
    v_mfma_f32_16x16x32_bf16 v[120:123], v[100:103], v[56:59], v[120:123]
    v_mfma_f32_16x16x32_bf16 v[124:127], v[100:103], v[60:63], v[124:127]
    s_setprio 3
    s_add_u32 s100, s100, 4096
    buffer_load_dwordx4 v[32:35], v14, s[16:19], s100 offen offset:0 sc1
    buffer_load_dwordx4 v[36:39], v14, s[16:19], s100 offen offset:1024 sc1
    buffer_load_dwordx4 v[40:43], v14, s[16:19], s100 offen offset:2048 sc1
    buffer_load_dwordx4 v[44:47], v14, s[16:19], s100 offen offset:3072 sc1
    s_setprio 0
    ds_read_b128 v[92:95], v12 offset:448
    ds_read_b128 v[96:99], v12 offset:8896
    ds_read_b128 v[100:103], v12 offset:17344
    s_waitcnt vmcnt(10) lgkmcnt(3)
    v_mfma_f32_16x16x32_bf16 v[104:107], v[80:83], v[64:67], v[104:107]
    v_mfma_f32_16x16x32_bf16 v[108:111], v[80:83], v[68:71], v[108:111]
    v_mfma_f32_16x16x32_bf16 v[112:115], v[84:87], v[64:67], v[112:115]
    v_mfma_f32_16x16x32_bf16 v[116:119], v[84:87], v[68:71], v[116:119]
    v_mfma_f32_16x16x32_bf16 v[120:123], v[88:91], v[64:67], v[120:123]
    v_mfma_f32_16x16x32_bf16 v[124:127], v[88:91], v[68:71], v[124:127]
    s_setprio 3
    s_add_u32 s100, s100, 4096
    buffer_load_dwordx4 v[48:51], v14, s[16:19], s100 offen offset:0 sc1
    buffer_load_dwordx4 v[52:55], v14, s[16:19], s100 offen offset:1024 sc1
    buffer_load_dwordx4 v[56:59], v14, s[16:19], s100 offen offset:2048 sc1
    buffer_load_dwordx4 v[60:63], v14, s[16:19], s100 offen offset:3072 sc1
    s_setprio 0
    s_waitcnt vmcnt(12) lgkmcnt(0)
    v_mfma_f32_16x16x32_bf16 v[104:107], v[92:95], v[72:75], v[104:107]
    v_mfma_f32_16x16x32_bf16 v[108:111], v[92:95], v[76:79], v[108:111]
    v_mfma_f32_16x16x32_bf16 v[112:115], v[96:99], v[72:75], v[112:115]
    v_mfma_f32_16x16x32_bf16 v[116:119], v[96:99], v[76:79], v[116:119]
    v_mfma_f32_16x16x32_bf16 v[120:123], v[100:103], v[72:75], v[120:123]
    v_mfma_f32_16x16x32_bf16 v[124:127], v[100:103], v[76:79], v[124:127]
    s_setprio 3
    s_add_u32 s100, s100, 4096
    buffer_load_dwordx4 v[64:67], v14, s[16:19], s100 offen offset:0 sc1
    buffer_load_dwordx4 v[68:71], v14, s[16:19], s100 offen offset:1024 sc1
    buffer_load_dwordx4 v[72:75], v14, s[16:19], s100 offen offset:2048 sc1
    buffer_load_dwordx4 v[76:79], v14, s[16:19], s100 offen offset:3072 sc1
    s_setprio 0
    s_setprio 3
    s_setprio 0
    v_add_u32 v12, 130944, v1
    s_mov_b32 s59, 0
Lw_42:
    ds_read_b32 v4, v3 offset:36
    s_waitcnt lgkmcnt(0)
    v_cmp_gt_u32 vcc, 16, v4
    s_cbranch_vccz Lk_43
    s_sleep 3
    s_add_u32 s59, s59, 1
    s_cmp_lt_u32 s59, 16777216
    s_cbranch_scc1 Lw_42
    s_branch L_end
Lk_43:
    ds_read_b128 v[80:83], v12 offset:0
    ds_read_b128 v[84:87], v12 offset:64
    ds_read_b128 v[88:91], v12 offset:128
    ds_read_b128 v[92:95], v12 offset:192
    ds_read_b128 v[96:99], v12 offset:256
    ds_read_b128 v[100:103], v12 offset:320
    s_waitcnt vmcnt(14) lgkmcnt(5)
    v_mfma_f32_16x16x32_bf16 v[104:107], v[80:83], v[16:19], v[104:107]
    v_mfma_f32_16x16x32_bf16 v[108:111], v[80:83], v[20:23], v[108:111]
    ds_read_b128 v[80:83], v12 offset:384
    s_waitcnt vmcnt(12) lgkmcnt(5)
    v_mfma_f32_16x16x32_bf16 v[104:107], v[84:87], v[24:27], v[104:107]
    v_mfma_f32_16x16x32_bf16 v[108:111], v[84:87], v[28:31], v[108:111]
    ds_read_b128 v[84:87], v12 offset:448
    s_waitcnt vmcnt(10) lgkmcnt(5)
    v_mfma_f32_16x16x32_bf16 v[104:107], v[88:91], v[32:35], v[104:107]
    v_mfma_f32_16x16x32_bf16 v[108:111], v[88:91], v[36:39], v[108:111]
    s_waitcnt vmcnt(8) lgkmcnt(4)
    v_mfma_f32_16x16x32_bf16 v[104:107], v[92:95], v[40:43], v[104:107]
    v_mfma_f32_16x16x32_bf16 v[108:111], v[92:95], v[44:47], v[108:111]
    s_waitcnt vmcnt(6) lgkmcnt(3)
    v_mfma_f32_16x16x32_bf16 v[104:107], v[96:99], v[48:51], v[104:107]
    v_mfma_f32_16x16x32_bf16 v[108:111], v[96:99], v[52:55], v[108:111]
    s_waitcnt vmcnt(4) lgkmcnt(2)
    v_mfma_f32_16x16x32_bf16 v[104:107], v[100:103], v[56:59], v[104:107]
    v_mfma_f32_16x16x32_bf16 v[108:111], v[100:103], v[60:63], v[108:111]
    s_waitcnt vmcnt(2) lgkmcnt(1)
    v_mfma_f32_16x16x32_bf16 v[104:107], v[80:83], v[64:67], v[104:107]
    v_mfma_f32_16x16x32_bf16 v[108:111], v[80:83], v[68:71], v[108:111]
    s_waitcnt vmcnt(0) lgkmcnt(0)
    v_mfma_f32_16x16x32_bf16 v[104:107], v[84:87], v[72:75], v[104:107]
    v_mfma_f32_16x16x32_bf16 v[108:111], v[84:87], v[76:79], v[108:111]
    s_nop 7
    v_cvt_pk_bf16_f32 v104, v104, v108
    buffer_store_dword v104, v8, s[20:23], s60 offen offset:0 sc1
    v_cvt_pk_bf16_f32 v105, v105, v109
    buffer_store_dword v105, v8, s[20:23], s60 offen offset:512 sc1
    v_cvt_pk_bf16_f32 v106, v106, v110
    buffer_store_dword v106, v8, s[20:23], s60 offen offset:1024 sc1
    v_cvt_pk_bf16_f32 v107, v107, v111
    buffer_store_dword v107, v8, s[20:23], s60 offen offset:1536 sc1
    s_add_u32 s60, s60, 8192
    s_mov_b32 s59, 0
Lw_44:
    ds_read_b32 v4, v3 offset:40
    s_waitcnt lgkmcnt(0)
    v_cmp_gt_u32 vcc, 16, v4
    s_cbranch_vccz Lk_45
    s_sleep 3
    s_add_u32 s59, s59, 1
    s_cmp_lt_u32 s59, 16777216
    s_cbranch_scc1 Lw_44
    s_branch L_end
Lk_45:
    ds_read_b128 v[80:83], v12 offset:8448
    ds_read_b128 v[84:87], v12 offset:8512
    ds_read_b128 v[88:91], v12 offset:8576
    ds_read_b128 v[92:95], v12 offset:8640
    ds_read_b128 v[96:99], v12 offset:8704
    ds_read_b128 v[100:103], v12 offset:8768
    s_waitcnt lgkmcnt(5)
    v_mfma_f32_16x16x32_bf16 v[112:115], v[80:83], v[16:19], v[112:115]
    v_mfma_f32_16x16x32_bf16 v[116:119], v[80:83], v[20:23], v[116:119]
    ds_read_b128 v[80:83], v12 offset:8832
    s_waitcnt lgkmcnt(5)
    v_mfma_f32_16x16x32_bf16 v[112:115], v[84:87], v[24:27], v[112:115]
    v_mfma_f32_16x16x32_bf16 v[116:119], v[84:87], v[28:31], v[116:119]
    ds_read_b128 v[84:87], v12 offset:8896
    s_waitcnt lgkmcnt(5)
    v_mfma_f32_16x16x32_bf16 v[112:115], v[88:91], v[32:35], v[112:115]
    v_mfma_f32_16x16x32_bf16 v[116:119], v[88:91], v[36:39], v[116:119]
    s_waitcnt lgkmcnt(4)
    v_mfma_f32_16x16x32_bf16 v[112:115], v[92:95], v[40:43], v[112:115]
    v_mfma_f32_16x16x32_bf16 v[116:119], v[92:95], v[44:47], v[116:119]
    s_waitcnt lgkmcnt(3)
    v_mfma_f32_16x16x32_bf16 v[112:115], v[96:99], v[48:51], v[112:115]
    v_mfma_f32_16x16x32_bf16 v[116:119], v[96:99], v[52:55], v[116:119]
    s_waitcnt lgkmcnt(2)
    v_mfma_f32_16x16x32_bf16 v[112:115], v[100:103], v[56:59], v[112:115]
    v_mfma_f32_16x16x32_bf16 v[116:119], v[100:103], v[60:63], v[116:119]
    s_waitcnt lgkmcnt(1)
    v_mfma_f32_16x16x32_bf16 v[112:115], v[80:83], v[64:67], v[112:115]
    v_mfma_f32_16x16x32_bf16 v[116:119], v[80:83], v[68:71], v[116:119]
    s_waitcnt lgkmcnt(0)
    v_mfma_f32_16x16x32_bf16 v[112:115], v[84:87], v[72:75], v[112:115]
    v_mfma_f32_16x16x32_bf16 v[116:119], v[84:87], v[76:79], v[116:119]
    s_nop 7
    v_cvt_pk_bf16_f32 v112, v112, v116
    buffer_store_dword v112, v8, s[20:23], s60 offen offset:0 sc1
    v_cvt_pk_bf16_f32 v113, v113, v117
    buffer_store_dword v113, v8, s[20:23], s60 offen offset:512 sc1
    v_cvt_pk_bf16_f32 v114, v114, v118
    buffer_store_dword v114, v8, s[20:23], s60 offen offset:1024 sc1
    v_cvt_pk_bf16_f32 v115, v115, v119
    buffer_store_dword v115, v8, s[20:23], s60 offen offset:1536 sc1
    s_add_u32 s60, s60, 8192
    s_mov_b32 s59, 0
Lw_46:
    ds_read_b32 v4, v3 offset:44
    s_waitcnt lgkmcnt(0)
    v_cmp_gt_u32 vcc, 8, v4
    s_cbranch_vccz Lk_47
    s_add_u32 s59, s59, 1
    s_cmp_lt_u32 s59, 16777216
    s_cbranch_scc1 Lw_46
    s_branch L_end
Lk_47:
    ds_read_b128 v[80:83], v12 offset:16896
    ds_read_b128 v[84:87], v12 offset:16960
    ds_read_b128 v[88:91], v12 offset:17024
    ds_read_b128 v[92:95], v12 offset:17088
    ds_read_b128 v[96:99], v12 offset:17152
    ds_read_b128 v[100:103], v12 offset:17216
    s_waitcnt lgkmcnt(5)
    v_mfma_f32_16x16x32_bf16 v[120:123], v[80:83], v[16:19], v[120:123]
    v_mfma_f32_16x16x32_bf16 v[124:127], v[80:83], v[20:23], v[124:127]
    ds_read_b128 v[80:83], v12 offset:17280
    s_waitcnt lgkmcnt(5)
    v_mfma_f32_16x16x32_bf16 v[120:123], v[84:87], v[24:27], v[120:123]
    v_mfma_f32_16x16x32_bf16 v[124:127], v[84:87], v[28:31], v[124:127]
    ds_read_b128 v[84:87], v12 offset:17344
    s_waitcnt lgkmcnt(5)
    v_mfma_f32_16x16x32_bf16 v[120:123], v[88:91], v[32:35], v[120:123]
    v_mfma_f32_16x16x32_bf16 v[124:127], v[88:91], v[36:39], v[124:127]
    s_waitcnt lgkmcnt(4)
    v_mfma_f32_16x16x32_bf16 v[120:123], v[92:95], v[40:43], v[120:123]
    v_mfma_f32_16x16x32_bf16 v[124:127], v[92:95], v[44:47], v[124:127]
    s_waitcnt lgkmcnt(3)
    v_mfma_f32_16x16x32_bf16 v[120:123], v[96:99], v[48:51], v[120:123]
    v_mfma_f32_16x16x32_bf16 v[124:127], v[96:99], v[52:55], v[124:127]
    s_waitcnt lgkmcnt(2)
    v_mfma_f32_16x16x32_bf16 v[120:123], v[100:103], v[56:59], v[120:123]
    v_mfma_f32_16x16x32_bf16 v[124:127], v[100:103], v[60:63], v[124:127]
    s_waitcnt lgkmcnt(1)
    v_mfma_f32_16x16x32_bf16 v[120:123], v[80:83], v[64:67], v[120:123]
    v_mfma_f32_16x16x32_bf16 v[124:127], v[80:83], v[68:71], v[124:127]
    s_waitcnt lgkmcnt(0)
    v_mfma_f32_16x16x32_bf16 v[120:123], v[84:87], v[72:75], v[120:123]
    v_mfma_f32_16x16x32_bf16 v[124:127], v[84:87], v[76:79], v[124:127]
    s_nop 7
    v_cvt_pk_bf16_f32 v120, v120, v124
    buffer_store_dword v120, v9, s[20:23], s60 offen offset:0 sc1
    v_cvt_pk_bf16_f32 v121, v121, v125
    buffer_store_dword v121, v9, s[20:23], s60 offen offset:512 sc1
    v_cvt_pk_bf16_f32 v122, v122, v126
    buffer_store_dword v122, v9, s[20:23], s60 offen offset:1024 sc1
    v_cvt_pk_bf16_f32 v123, v123, v127
    buffer_store_dword v123, v9, s[20:23], s60 offen offset:1536 sc1
L_end:
L_exit:
    s_endpgm
L_slow:
    s_setprio 0
    ds_add_u32 v61, v62 offset:16
    s_mov_b32 s59, 0
Lw_48:
    ds_read_b32 v4, v3 offset:16
    s_waitcnt lgkmcnt(0)
    v_cmp_gt_u32 vcc, 8, v4
    s_cbranch_vccz Lk_49
    s_add_u32 s59, s59, 1
    s_cmp_lt_u32 s59, 4194304
    s_cbranch_scc1 Lw_48
    s_branch L_end
Lk_49:
    v_mov_b32 v12, v3
    s_mov_b64 s[24:25], s[34:35]
    s_mov_b32 s26, 640000
    s_mov_b64 s[28:29], s[36:37]
    s_mov_b32 s30, 640000
    s_mov_b64 s[12:13], s[42:43]
    s_mov_b32 s14, 20000
    s_mov_b32 s15, 0x20000
    s_sub_u32 s63, s67, 1
    s_mov_b32 s65, 201486528
    s_mov_b32 s64, 0
    s_call_b64 s[68:69], L_flush
    s_add_u32 s66, s4, s5
    s_add_u32 s67, s66, 40
    v_lshlrev_b32 v16, 2, v0
    v_and_b32 v17, 32, v0
    v_lshl_add_u32 v17, v17, 22, v2
    v_mov_b32 v24, 0
L_sn:
    s_mov_b32 s60, 0
L_sc:
    buffer_load_dword v18, v16, s[28:31], s60 offen
    buffer_load_dword v19, v16, s[24:27], s60 offen
    s_waitcnt vmcnt(0)
    v_cmp_eq_u32 vcc, s66, v18
    s_cbranch_vccz L_sx
L_se:
    s_ff1_i32_b64 s58, vcc
    s_bitset0_b64 vcc, s58
    v_readlane_b32 s59, v19, s58
    s_nop 0
    s_lshl_b32 s61, s59, 9
    s_lshl_b32 s59, s59, 1
    buffer_load_dwordx4 v[20:23], v17, s[8:11], s61 offen
    buffer_load_ushort v1, v24, s[12:15], s59 offen
    s_waitcnt vmcnt(0)
    v_perm_b32 v6, v1, v1, v10
    v_perm_b32 v7, v1, v1, v11
    s_nop 1
    v_mfma_f32_4x4x4_16b_bf16 v[56:59], v[6:7], v[20:21], v[56:59]
    v_mfma_f32_4x4x4_16b_bf16 v[60:63], v[6:7], v[22:23], v[60:63]
    s_cmp_lg_u64 vcc, 0
    s_cbranch_scc1 L_se
L_sx:
    s_add_u32 s60, s60, 256
    s_cmp_lt_u32 s60, 640000
    s_cbranch_scc1 L_sc
    s_call_b64 s[68:69], L_flush
    s_add_u32 s66, s66, 8
    s_cmp_lt_u32 s66, s67
    s_cbranch_scc1 L_sn
    s_branch L_gdone
.section .rodata,"a"
.p2align 6
.amdhsa_kernel standalone__hybrid_graph_tf_exphormer__graph_kernel
  .amdhsa_next_free_vgpr 128
  .amdhsa_next_free_sgpr 102
  .amdhsa_accum_offset 128
  .amdhsa_group_segment_fixed_size 0
  .amdhsa_kernarg_size 104
  .amdhsa_user_sgpr_count 2
  .amdhsa_user_sgpr_kernarg_segment_ptr 1
  .amdhsa_system_sgpr_workgroup_id_x 1
.end_amdhsa_kernel
```

```asm
; @launch grid=(250,1,1) block=(1024,1,1) lds=161984
.amdgcn_target "amdgcn-amd-amdhsa--gfx950"
.text
.globl standalone__hybrid_graph_tf_exphormer__graph_kernel
.p2align 8
.type standalone__hybrid_graph_tf_exphormer__graph_kernel,@function
standalone__hybrid_graph_tf_exphormer__graph_kernel:
    s_cmp_ge_u32 s2, 250
    s_cbranch_scc1 L_exit
    s_load_dwordx16 s[32:47], s[0:1], 0
    s_load_dwordx8 s[48:55], s[0:1], 64
    s_load_dwordx2 s[56:57], s[0:1], 96
    s_getpc_b64 s[60:61]
    s_lshr_b32 s6, s2, 3
    v_lshl_add_u32 v1, v0, 5, s6
    v_cmp_gt_u32 vcc, 85, v1
    v_lshlrev_b32 v1, 7, v1
    s_and_saveexec_b64 s[58:59], vcc
    s_cbranch_execz L_nopf
    global_load_dword v15, v1, s[60:61]
L_nopf:
    s_mov_b64 exec, -1
    v_lshrrev_b32 v1, 6, v0
    v_mov_b32 v8, 33554432
    v_readfirstlane_b32 s3, v1
    v_cmp_gt_u32 vcc, 288, v0
    v_lshlrev_b32 v5, 4, v0
    v_add_u32 v4, 152064, v5
    v_cndmask_b32 v8, 0, v8, vcc
    v_mov_b32 v9, v8
    v_mov_b64 v[10:11], v[8:9]
    v_cmp_gt_u32 vcc, 556, v0
    s_and_saveexec_b64 s[58:59], vcc
    ds_write_b128 v4, v[8:11]
    s_mov_b64 exec, -1
    v_and_b32 v0, 63, v0
    v_and_b32 v2, 31, v0
    v_lshlrev_b32 v2, 4, v2
    s_and_b32 s59, s2, 7
    s_mul_i32 s60, s59, 31
    s_min_u32 s59, s59, 2
    s_add_u32 s6, s6, s60
    s_add_u32 s6, s6, s59
    s_mov_b32 s27, 0x20000
    s_mov_b32 s31, 0x20000
    s_xor_b32 s3, s3, 8
    s_and_b32 s4, s3, 7
    s_cmp_lt_u32 s3, 8
    s_cbranch_scc1 L_e3
    s_setprio 3
    s_cmp_ge_u32 s2, 64
    s_cbranch_scc1 L_e1
    v_lshrrev_b32 v6, 2, v5
    s_mul_i32 s58, s2, 10000
    s_add_u32 s60, s58, 8192
    s_mov_b32 s26, 640000
    s_mov_b32 s30, 640000
    s_mov_b32 s59, 1048576
    s_mov_b32 s63, 1
    s_waitcnt lgkmcnt(0)
    s_mov_b64 s[28:29], s[36:37]
    s_mov_b64 s[24:25], s[34:35]
    buffer_load_dwordx4 v[22:25], v5, s[28:31], s58 offen
    buffer_load_dword v26, v6, s[28:31], s60 offen
    s_setprio 2
    buffer_load_dwordx4 v[16:19], v5, s[24:27], s58 offen
    buffer_load_dword v20, v6, s[24:27], s60 offen
    s_setprio 3
L_ep:
    s_load_dword s40, s[56:57], s59
    s_branch L_bar
L_e1:
    s_mov_b32 s26, 131072
    s_sub_u32 s60, s3, 9
    s_cmp_lt_u32 s60, 3
    s_cbranch_scc1 L_e1b
    s_mov_b32 s63, 0
    s_cmp_eq_u32 s3, 8
    s_cbranch_scc0 L_barw
    s_mov_b32 s63, 5
    s_mov_b32 s59, 1048576
    s_waitcnt lgkmcnt(0)
    s_branch L_ep
L_e1b:
    s_sub_u32 s62, s2, 64
    s_cmp_ge_u32 s62, 128
    s_cbranch_scc1 L_e2
    s_and_b32 s58, s62, 7
    s_lshr_b32 s59, s62, 4
    s_bfe_u32 s61, s62, 0x10003
    s_cmp_eq_u32 s60, 2
    s_cselect_b32 s58, s59, s58
    s_cselect_b32 s61, s61, s60
    s_lshl_b32 s58, s58, 14
    s_lshl_b32 s61, s61, 11
    s_add_u32 s58, s58, s61
    s_add_u32 s59, s58, 4096
    v_and_b32 v4, 32, v0
    v_lshl_add_u32 v4, v4, 8, v2
    s_mul_i32 s61, s60, 8448
    s_add_u32 m0, s61, 105600
    s_cmp_eq_u32 s60, 0
    s_cselect_b32 s63, 2, 3
    s_cmp_eq_u32 s60, 2
    s_waitcnt lgkmcnt(0)
    s_cselect_b64 s[24:25], s[48:49], s[46:47]
    buffer_load_dwordx4 v4, s[24:27], s58 offen offset:0 lds
    s_add_u32 m0, m0, 544
    s_nop 0
    buffer_load_dwordx4 v4, s[24:27], s58 offen offset:512 lds
    s_add_u32 m0, m0, 544
    s_nop 0
    buffer_load_dwordx4 v4, s[24:27], s58 offen offset:1024 lds
    s_add_u32 m0, m0, 544
    s_nop 0
    buffer_load_dwordx4 v4, s[24:27], s58 offen offset:1536 lds
    s_add_u32 m0, m0, 2592
    s_nop 0
    buffer_load_dwordx4 v4, s[24:27], s59 offen offset:0 lds
    s_add_u32 m0, m0, 544
    s_nop 0
    buffer_load_dwordx4 v4, s[24:27], s59 offen offset:512 lds
    s_add_u32 m0, m0, 544
    s_nop 0
    buffer_load_dwordx4 v4, s[24:27], s59 offen offset:1024 lds
    s_add_u32 m0, m0, 544
    s_nop 0
    buffer_load_dwordx4 v4, s[24:27], s59 offen offset:1536 lds
    s_branch L_bar
L_e2:
    s_mul_i32 s60, s60, 58
    s_add_u32 s62, s62, s60
    s_sub_u32 s62, s62, 128
    s_mov_b32 s63, 3
    s_cmp_ge_u32 s62, 128
    s_cbranch_scc1 L_barw
    s_mov_b32 s63, 4
    s_and_b32 s59, s62, 7
    s_lshl_b32 s59, s59, 14
    s_bfe_u32 s60, s62, 0x30003
    s_lshl_b32 s60, s60, 6
    s_add_u32 s59, s59, s60
    v_and_b32 v4, 15, v0
    v_lshlrev_b32 v4, 2, v4
    v_and_b32 v5, 48, v0
    v_lshl_add_u32 v4, v5, 8, v4
    s_cmp_lt_u32 s62, 64
    s_waitcnt lgkmcnt(0)
    s_cselect_b64 s[24:25], s[50:51], s[44:45]
    buffer_load_dword v16, v4, s[24:27], s59 offen offset:0
    buffer_load_dword v17, v4, s[24:27], s59 offen offset:512
    buffer_load_dword v18, v4, s[24:27], s59 offen offset:1024
    buffer_load_dword v19, v4, s[24:27], s59 offen offset:1536
    buffer_load_dword v20, v4, s[24:27], s59 offen offset:2048
    buffer_load_dword v21, v4, s[24:27], s59 offen offset:2560
    buffer_load_dword v22, v4, s[24:27], s59 offen offset:3072
    buffer_load_dword v23, v4, s[24:27], s59 offen offset:3584
    s_branch L_bar
L_e3:
    s_mul_i32 s58, s6, 640
    s_lshl_b32 s59, s3, 6
    s_add_u32 s59, s59, s58
    s_lshr_b32 s60, s3, 2
    s_lshl_b32 s60, s60, 6
    s_and_b32 s61, s3, 3
    s_lshl_b32 s61, s61, 3
    s_add_u32 s60, s60, s61
    s_add_u32 s60, s60, s58
    s_add_u32 s60, s60, 512
    s_add_u32 s61, s60, 32
    s_waitcnt lgkmcnt(0)
    s_mov_b64 s[62:63], s[38:39]
    s_mov_b64 s[8:9], s[32:33]
    s_load_dwordx16 s[32:47], s[62:63], s59
    s_load_dwordx2 s[64:65], s[62:63], s60
    s_load_dwordx2 s[66:67], s[62:63], s61
    s_barrier
    s_branch L_preA
L_barw:
    s_waitcnt lgkmcnt(0)
L_bar:
    s_barrier
    s_mov_b64 s[8:9], s[32:33]
    s_mul_i32 s5, s6, 40
    v_mov_b32 v3, 159296
    s_mov_b32 s10, 5120000
    s_mov_b32 s11, 0x20000
    s_mov_b64 s[16:17], s[56:57]
    s_mov_b32 s18, 1310720
    s_mov_b32 s19, 0x20000
    v_min_u32 v4, 1, v0
    v_lshl_add_u32 v61, v0, 2, v3
    v_lshl_add_u32 v61, v4, 16, v61
    v_mov_b32 v62, 1
    s_cmp_eq_u32 s63, 1
    s_cbranch_scc0 L_notprod
    v_mov_b32 v9, 4
    v_mov_b32 v10, 159936
    v_lshl_add_u32 v11, v0, 4, v10
    v_cmp_gt_u32 vcc, 7232, v5
    v_add_u32 v59, 105600, v5
    s_mul_i32 s58, s2, 10240
    s_mov_b64 s[66:67], vcc
    s_waitcnt vmcnt(3)
    v_mul_u32_u24 v28, 52429, v22
    v_lshrrev_b32 v28, 21, v28
    v_lshl_add_u32 v28, v28, 2, v10
    ds_add_rtn_u32 v34, v28, v9
    v_mul_u32_u24 v29, 52429, v23
    v_lshrrev_b32 v29, 21, v29
    v_lshl_add_u32 v29, v29, 2, v10
    ds_add_rtn_u32 v35, v29, v9
    v_mul_u32_u24 v30, 52429, v24
    v_lshrrev_b32 v30, 21, v30
    v_lshl_add_u32 v30, v30, 2, v10
    ds_add_rtn_u32 v36, v30, v9
    v_mul_u32_u24 v31, 52429, v25
    v_lshrrev_b32 v31, 21, v31
    v_lshl_add_u32 v31, v31, 2, v10
    ds_add_rtn_u32 v37, v31, v9
    s_waitcnt vmcnt(2)
    s_mov_b64 exec, s[66:67]
    v_mul_u32_u24 v32, 52429, v26
    v_lshrrev_b32 v32, 21, v32
    v_lshl_add_u32 v32, v32, 2, v10
    ds_add_rtn_u32 v38, v32, v9
    s_mov_b64 exec, -1
    s_waitcnt lgkmcnt(0)
    s_barrier
    ds_read_b128 v[12:15], v11
    s_add_u32 s40, s40, 4096
    s_and_b32 s40, s40, 4294963200
    s_waitcnt lgkmcnt(0)
    v_add_u32 v56, v12, v13
    v_add3_u32 v57, v56, v14, v15
    s_nop 1
    v_add_u32_dpp v58, v57, v57 row_shr:1 row_mask:0xf bank_mask:0xf bound_ctrl:1
    s_nop 1
    v_add_u32_dpp v58, v58, v58 row_shr:2 row_mask:0xf bank_mask:0xf bound_ctrl:1
    s_nop 1
    v_add_u32_dpp v58, v58, v58 row_shr:4 row_mask:0xf bank_mask:0xf bound_ctrl:1
    s_nop 1
    v_add_u32_dpp v58, v58, v58 row_shr:8 row_mask:0xf bank_mask:0xf bound_ctrl:1
    s_nop 1
    v_add_u32_dpp v58, v58, v58 row_bcast:15 row_mask:0xa bank_mask:0xf
    s_nop 1
    v_add_u32_dpp v58, v58, v58 row_bcast:31 row_mask:0xc bank_mask:0xf
    v_sub_u32 v64, v58, v57
    v_add_u32 v65, v64, v12
    v_add_u32 v66, v64, v56
    v_add_u32 v67, v66, v14
    ds_write_b128 v11, v[64:67] offset:1024
    ds_read_b32 v40, v28 offset:1024
    ds_read_b32 v41, v29 offset:1024
    ds_read_b32 v42, v30 offset:1024
    ds_read_b32 v43, v31 offset:1024
    s_mov_b64 exec, s[66:67]
    ds_read_b32 v44, v32 offset:1024
    s_mov_b64 exec, -1
    s_mov_b32 s60, 105600
    s_waitcnt vmcnt(0)
    v_lshl_or_b32 v16, v22, 16, v16
    v_lshl_or_b32 v17, v23, 16, v17
    v_lshl_or_b32 v18, v24, 16, v18
    v_lshl_or_b32 v19, v25, 16, v19
    v_lshl_or_b32 v20, v26, 16, v20
    s_waitcnt lgkmcnt(4)
    v_add3_u32 v40, v40, v34, s60
    ds_write_b32 v40, v16
    s_waitcnt lgkmcnt(4)
    v_add3_u32 v41, v41, v35, s60
    ds_write_b32 v41, v17
    s_waitcnt lgkmcnt(4)
    v_add3_u32 v42, v42, v36, s60
    ds_write_b32 v42, v18
    s_waitcnt lgkmcnt(4)
    v_add3_u32 v43, v43, v37, s60
    ds_write_b32 v43, v19
    s_mov_b64 exec, s[66:67]
    s_waitcnt lgkmcnt(4)
    v_add3_u32 v44, v44, v38, s60
    ds_write_b32 v44, v20
    s_mov_b64 exec, -1
    v_lshrrev_b32 v64, 2, v64
    v_or_b32 v64, s40, v64
    v_lshrrev_b32 v65, 2, v65
    v_or_b32 v65, s40, v65
    v_lshrrev_b32 v66, 2, v66
    v_or_b32 v66, s40, v66
    v_lshrrev_b32 v67, 2, v67
    v_or_b32 v67, s40, v67
    s_waitcnt lgkmcnt(0)
    s_barrier
    ds_read_b128 v[12:15], v59
    ds_read_b128 v[68:71], v59 offset:8192
    s_add_u32 s60, s58, 8192
    s_cmp_ge_u32 s4, 2
    s_waitcnt lgkmcnt(1)
    buffer_store_dwordx4 v[12:15], v5, s[16:19], s58 offen sc1
    s_cbranch_scc1 L_cp1
    s_waitcnt lgkmcnt(0)
    buffer_store_dwordx4 v[68:71], v5, s[16:19], s60 offen sc1
L_cp1:
    s_waitcnt vmcnt(0)
    ds_add_u32 v61, v62 offset:56
    s_cmp_eq_u32 s4, 0
    s_cbranch_scc0 L_preB
    s_lshl_b32 s61, s2, 10
    s_add_u32 s61, s61, 1114112
    s_or_b32 s60, s40, 1
    v_mov_b32 v8, s60
    s_mov_b32 s59, 0
Lw_1:
    ds_read_b32 v4, v3 offset:56
    s_waitcnt lgkmcnt(0)
    v_cmp_gt_u32 vcc, 8, v4
    s_cbranch_vccz Lk_2
    s_add_u32 s59, s59, 1
    s_cmp_lt_u32 s59, 4194304
    s_cbranch_scc1 Lw_1
    s_branch L_end
Lk_2:
    buffer_store_dwordx4 v[64:67], v5, s[16:19], s61 offen sc1
    ds_write_b32 v3, v8 offset:32
    s_branch L_preB
L_notprod:
    s_cmp_eq_u32 s63, 0
    s_cbranch_scc1 L_preB
    s_cmp_eq_u32 s63, 3
    s_cbranch_scc1 L_taskw
    s_cmp_eq_u32 s63, 4
    s_cbranch_scc1 L_wtask
    s_cmp_eq_u32 s63, 5
    s_cbranch_scc1 L_flag
    v_and_b32 v4, 7, v0
    v_mul_u32_u24 v1, 1056, v4
    v_and_b32 v4, 8, v0
    v_lshl_add_u32 v1, v4, 6, v1
    v_and_b32 v4, 48, v0
    v_add_u32 v1, v4, v1
    v_add_u32 v5, 105600, v1
    s_lshr_b32 s58, s62, 4
    s_lshl_b32 s58, s58, 3
    s_and_b32 s59, s62, 7
    s_add_u32 s58, s58, s59
    s_lshl_b32 s58, s58, 1
    s_bfe_u32 s59, s62, 0x10003
    s_add_u32 s58, s58, s59
    s_lshl_b32 s58, s58, 10
    s_add_u32 s58, s58, 655360
    v_lshlrev_b32 v6, 4, v0
    s_waitcnt vmcnt(0)
    s_mov_b32 s59, 0
Lw_3:
    ds_read_b32 v4, v3 offset:56
    s_waitcnt lgkmcnt(0)
    v_cmp_gt_u32 vcc, 2, v4
    s_cbranch_vccz Lk_4
    s_add_u32 s59, s59, 1
    s_cmp_lt_u32 s59, 4194304
    s_cbranch_scc1 Lw_3
    s_branch L_end
Lk_4:
    ds_read_b128 v[16:19], v5 offset:0
    ds_read_b128 v[20:23], v5 offset:8448
    ds_read_b128 v[24:27], v5 offset:16896
    ds_read_b128 v[28:31], v5 offset:64
    ds_read_b128 v[32:35], v5 offset:8512
    ds_read_b128 v[36:39], v5 offset:16960
    ds_read_b128 v[40:43], v5 offset:128
    ds_read_b128 v[44:47], v5 offset:8576
    ds_read_b128 v[48:51], v5 offset:17024
    ds_read_b128 v[64:67], v5 offset:192
    ds_read_b128 v[68:71], v5 offset:8640
    ds_read_b128 v[72:75], v5 offset:17088
    s_waitcnt lgkmcnt(9)
    ds_read_b128 v[76:79], v5 offset:256
    ds_read_b128 v[80:83], v5 offset:8704
    ds_read_b128 v[84:87], v5 offset:17152
    v_mfma_f32_16x16x32_bf16 v[8:11], v[16:19], v[24:27], 0
    v_mfma_f32_16x16x32_bf16 v[12:15], v[20:23], v[24:27], 0
    s_waitcnt lgkmcnt(9)
    ds_read_b128 v[88:91], v5 offset:320
    ds_read_b128 v[92:95], v5 offset:8768
    ds_read_b128 v[96:99], v5 offset:17216
    v_mfma_f32_16x16x32_bf16 v[8:11], v[28:31], v[36:39], v[8:11]
    v_mfma_f32_16x16x32_bf16 v[12:15], v[32:35], v[36:39], v[12:15]
    s_waitcnt lgkmcnt(9)
    ds_read_b128 v[100:103], v5 offset:384
    ds_read_b128 v[104:107], v5 offset:8832
    ds_read_b128 v[108:111], v5 offset:17280
    v_mfma_f32_16x16x32_bf16 v[8:11], v[40:43], v[48:51], v[8:11]
    v_mfma_f32_16x16x32_bf16 v[12:15], v[44:47], v[48:51], v[12:15]
    s_waitcnt lgkmcnt(9)
    ds_read_b128 v[112:115], v5 offset:448
    ds_read_b128 v[116:119], v5 offset:8896
    ds_read_b128 v[120:123], v5 offset:17344
    v_mfma_f32_16x16x32_bf16 v[8:11], v[64:67], v[72:75], v[8:11]
    v_mfma_f32_16x16x32_bf16 v[12:15], v[68:71], v[72:75], v[12:15]
    s_waitcnt lgkmcnt(9)
    v_mfma_f32_16x16x32_bf16 v[8:11], v[76:79], v[84:87], v[8:11]
    v_mfma_f32_16x16x32_bf16 v[12:15], v[80:83], v[84:87], v[12:15]
    s_waitcnt lgkmcnt(6)
    v_mfma_f32_16x16x32_bf16 v[8:11], v[88:91], v[96:99], v[8:11]
    v_mfma_f32_16x16x32_bf16 v[12:15], v[92:95], v[96:99], v[12:15]
    s_waitcnt lgkmcnt(3)
    v_mfma_f32_16x16x32_bf16 v[8:11], v[100:103], v[108:111], v[8:11]
    v_mfma_f32_16x16x32_bf16 v[12:15], v[104:107], v[108:111], v[12:15]
    s_waitcnt lgkmcnt(0)
    v_mfma_f32_16x16x32_bf16 v[8:11], v[112:115], v[120:123], v[8:11]
    v_mfma_f32_16x16x32_bf16 v[12:15], v[116:119], v[120:123], v[12:15]
    s_nop 6
    v_cvt_pk_bf16_f32 v16, v8, v9
    v_cvt_pk_bf16_f32 v17, v10, v11
    v_cvt_pk_bf16_f32 v18, v12, v13
    v_cvt_pk_bf16_f32 v19, v14, v15
    buffer_store_dwordx4 v[16:19], v6, s[16:19], s58 offen sc1
    s_branch L_taskw
L_wtask:
    s_lshl_b32 s58, s62, 11
    s_add_u32 s58, s58, 786432
    v_lshlrev_b32 v6, 4, v0
    s_mov_b32 s70, 0x05040100
    s_mov_b32 s71, 0x07060302
    s_waitcnt vmcnt(0)
    v_perm_b32 v64, v17, v16, s70
    v_perm_b32 v68, v17, v16, s71
    v_perm_b32 v65, v19, v18, s70
    v_perm_b32 v69, v19, v18, s71
    v_perm_b32 v66, v21, v20, s70
    v_perm_b32 v70, v21, v20, s71
    v_perm_b32 v67, v23, v22, s70
    v_perm_b32 v71, v23, v22, s71
    buffer_store_dwordx4 v[64:67], v6, s[16:19], s58 offen sc1
    buffer_store_dwordx4 v[68:71], v6, s[16:19], s58 offen offset:1024 sc1
L_taskw:
    s_waitcnt vmcnt(0)
    ds_add_u32 v61, v62 offset:56
    s_branch L_preB
L_flag:
    s_waitcnt vmcnt(0) lgkmcnt(0)
    s_add_u32 s40, s40, 4096
    s_and_b32 s40, s40, 4294963200
    s_mul_i32 s61, s2, 16
    s_add_u32 s61, s61, 1178624
    s_or_b32 s60, s40, 1
    v_mov_b32 v8, s60
    v_mov_b32 v10, s40
    v_mov_b32 v11, s40
    v_mov_b32 v9, 0
    s_mov_b32 s59, 0
Lw_5:
    ds_read_b32 v4, v3 offset:56
    s_waitcnt lgkmcnt(0)
    v_cmp_gt_u32 vcc, 3, v4
    s_cbranch_vccz Lk_6
    s_add_u32 s59, s59, 1
    s_cmp_lt_u32 s59, 4194304
    s_cbranch_scc1 Lw_5
    s_branch L_end
Lk_6:
    s_mov_b64 exec, 1
    buffer_store_dwordx2 v[10:11], v9, s[16:19], s61 offen sc1
    ds_write_b32 v3, v8 offset:32
    s_mov_b64 exec, -1
L_preB:
    s_setprio 3
    s_mov_b64 s[28:29], s[42:43]
    s_mov_b32 s30, 20000
    s_setprio 3
    s_lshl_b32 s58, s4, 10
    v_lshlrev_b32 v5, 4, v0
    s_add_u32 m0, s58, 130944
    s_add_u32 s59, s58, 0
    buffer_load_dwordx4 v5, s[28:31], s59 offen lds
    s_add_u32 m0, s58, 139136
    s_add_u32 s59, s58, 8192
    buffer_load_dwordx4 v5, s[28:31], s59 offen lds
    s_cmp_lt_u32 s4, 4
    s_cbranch_scc1 L_disd
    s_add_u32 m0, s58, 143232
    s_add_u32 s59, s58, 12288
    buffer_load_dwordx4 v5, s[28:31], s59 offen lds
L_disd:
    s_setprio 3
    v_and_b32 v4, 3, v0
    v_mov_b32 v5, 0x0c0c0c0c
    v_mov_b32 v6, 0x0c0c0302
    v_mov_b32 v7, 0x03020c0c
    v_cmp_eq_u32 s[58:59], 0, v4
    v_cmp_eq_u32 s[60:61], 2, v4
    v_cmp_eq_u32 vcc, 1, v4
    v_cndmask_b32 v10, v5, v6, s[58:59]
    v_cndmask_b32 v11, v5, v6, s[60:61]
    v_cndmask_b32 v10, v10, v7, vcc
    v_cmp_eq_u32 vcc, 3, v4
    s_nop 1
    v_cndmask_b32 v11, v11, v7, vcc
    v_and_b32 v10, 0xfdfdfdfd, v10
    v_and_b32 v11, 0xfdfdfdfd, v11
    s_movk_i32 s7, 512
    s_lshl_b32 s58, s4, 3
    v_lshrrev_b32 v5, 3, v0
    v_and_b32 v6, 7, v0
    v_add_u32 v7, s58, v5
    v_mul_u32_u24 v49, 10240, v7
    v_lshl_add_u32 v49, v6, 4, v49
    v_lshlrev_b32 v56, 2, v6
    s_lshl_b32 s60, s6, 2
    s_add_u32 s60, s60, 1114112
    v_lshl_add_u32 v54, v7, 10, s60
    v_mad_u32_u24 v7, v7, 3, v6
    v_cmp_ge_u32 vcc, 186, v7
    v_cmp_gt_u32 s[64:65], 4, v6
    v_mul_u32_u24 v7, 16, v7
    s_and_b64 s[64:65], s[64:65], vcc
    v_cmp_eq_u32 vcc, 0, v6
    v_add_u32 v7, 1179632, v7
    s_or_b64 s[64:65], s[64:65], vcc
    v_cndmask_b32 v54, v7, v54, vcc
    v_cmp_gt_u32 s[62:63], 5, v6
    v_lshl_add_u32 v50, v6, 3, v5
    v_mul_u32_u24 v55, 72, v5
    v_add_u32 v55, 72, v55
    v_lshrrev_b32 v5, 4, v50
    v_mul_u32_u24 v9, 8448, v5
    v_lshl_add_u32 v9, v5, 26, v9
    v_cmp_le_u32 vcc, 32, v50
    v_and_b32 v5, 7, v50
    v_and_b32 v6, 3, v50
    v_cndmask_b32 v5, v5, v6, vcc
    v_mul_u32_u24 v5, 1056, v5
    v_bfe_u32 v6, v50, 3, 1
    v_bfe_u32 v7, v50, 2, 1
    v_cndmask_b32 v6, v6, v7, vcc
    v_lshl_add_u32 v5, v6, 9, v5
    v_mov_b32 v52, 130944
    v_add3_u32 v9, v9, v5, v52
    v_lshrrev_b32 v5, 5, v0
    v_lshl_add_u32 v15, v5, 3, v2
    s_lshl_b32 s58, s5, 2
    s_sub_u32 s58, 158976, s58
    v_mov_b32 v53, s58
    v_add_u32 v5, s5, v50
    v_lshl_add_u32 v8, v5, 1, v52
    v_lshlrev_b32 v50, 2, v50
    v_add_u32 v50, 158976, v50
    v_mov_b32 v57, 156672
    v_mov_b32 v60, 152064
    v_mov_b64 v[16:17], 0
    v_mov_b64 v[18:19], 0
    s_mov_b32 s59, 0
Lw_7:
    ds_read_b32 v4, v3 offset:60
    s_waitcnt lgkmcnt(0)
    v_cmp_gt_u32 vcc, 8, v4
    s_cbranch_vccz Lk_8
    s_sleep 2
    s_add_u32 s59, s59, 1
    s_cmp_lt_u32 s59, 4194304
    s_cbranch_scc1 Lw_7
    s_branch L_end
Lk_8:
    s_mov_b32 s59, 0
Lw_9:
    ds_read_b32 v4, v3 offset:32
    s_waitcnt lgkmcnt(0)
    v_cmp_gt_u32 vcc, 1, v4
    s_cbranch_vccz Lk_10
    s_sleep 1
    s_add_u32 s59, s59, 1
    s_cmp_lt_u32 s59, 4194304
    s_cbranch_scc1 Lw_9
    s_branch L_end
Lk_10:
    v_readfirstlane_b32 s40, v4
    s_mov_b32 s59, 0
    s_mov_b64 exec, s[64:65]
    s_bitset0_b32 s40, 0
L_spoll:
    buffer_load_dwordx2 v[58:59], v54, s[16:19], 0 offen sc1
    s_add_u32 s59, s59, 1
    s_cmp_gt_u32 s59, 0x40000
    s_cbranch_scc1 L_end
    s_waitcnt vmcnt(0)
    v_xor_b32 v58, s40, v58
    v_xor_b32 v59, s40, v59
    v_or_b32 v5, v58, v59
    v_cmpx_lt_u32 vcc, 4095, v5
    s_cbranch_execz L_sok
    s_sleep 8
    s_branch L_spoll
L_sok:
    s_mov_b64 exec, -1
    ds_add_u32 v61, v62 offset:52
    v_sub_u32 v48, v59, v58
    v_lshl_or_b32 v48, v48, 16, v58
    s_nop 1
    v_mov_b32_dpp v48, v48 quad_perm:[0,0,0,0] row_mask:0xf bank_mask:0xf
    s_nop 1
    v_mov_b32_dpp v48, v48 row_shr:4 row_mask:0xf bank_mask:0xa
    v_mad_u32_u16 v49, v48, 4, v49
    v_lshrrev_b32 v48, 16, v48
    v_sub_u32 v48, v48, v56
    v_cmpx_lt_i32 vcc, 0, v48
    s_cbranch_execz L_entld
    buffer_load_dwordx4 v[16:19], v49, s[16:19], 0 offen sc1
    v_cmpx_lt_i32 vcc, 32, v48
    ds_write_b32 v3, v62 offset:28
L_entld:
    s_mov_b64 exec, -1
    s_waitcnt vmcnt(0)
    v_cmpx_lt_i32 vcc, 0, v48
    v_mad_u32_u16 v24, v16, 4, v53 op_sel:[1,0,0,0]
    ds_add_rtn_u32 v32, v24, v62
    v_cmpx_lt_i32 vcc, 1, v48
    v_mad_u32_u16 v25, v17, 4, v53 op_sel:[1,0,0,0]
    ds_add_rtn_u32 v33, v25, v62
    v_cmpx_lt_i32 vcc, 2, v48
    v_mad_u32_u16 v26, v18, 4, v53 op_sel:[1,0,0,0]
    ds_add_rtn_u32 v34, v26, v62
    v_cmpx_lt_i32 vcc, 3, v48
    v_mad_u32_u16 v27, v19, 4, v53 op_sel:[1,0,0,0]
    ds_add_rtn_u32 v35, v27, v62
    s_mov_b64 exec, -1
    ds_add_u32 v61, v62 offset:12
    v_mad_u32_u16 v40, v16, 2, v52
    v_mad_u32_u16 v16, v16, s7, 0
    v_mad_u32_u16 v41, v17, 2, v52
    v_mad_u32_u16 v17, v17, s7, 0
    v_mad_u32_u16 v42, v18, 2, v52
    v_mad_u32_u16 v18, v18, s7, 0
    v_mad_u32_u16 v43, v19, 2, v52
    v_mad_u32_u16 v19, v19, s7, 0
    s_mov_b32 s59, 0
Lw_11:
    ds_read_b32 v4, v3 offset:12
    s_waitcnt lgkmcnt(0)
    v_cmp_gt_u32 vcc, 8, v4
    s_cbranch_vccz Lk_12
    s_add_u32 s59, s59, 1
    s_cmp_lt_u32 s59, 4194304
    s_cbranch_scc1 Lw_11
    s_branch L_end
Lk_12:
    ds_read_b32 v12, v50
    ds_read_b32 v5, v3 offset:28
    ds_read_u16 v8, v8
    ds_read_u16 v40, v40
    ds_read_u16 v41, v41
    ds_read_u16 v42, v42
    ds_read_u16 v43, v43
    s_lshl_b32 s58, s2, 4
    s_add_u32 s58, s58, s3
    s_cmp_eq_u32 s58, 15
    s_cbranch_scc0 L_noep
    v_mov_b32 v6, s40
    v_mov_b32 v7, 1048576
    s_mov_b64 exec, 1
    buffer_store_dword v6, v7, s[16:19], 0 offen sc1
    s_mov_b64 exec, -1
L_noep:
    s_waitcnt lgkmcnt(6)
    v_add_u32 v12, 1, v12
    v_lshrrev_b32 v12, 1, v12
    v_max_u32 v12, 1, v12
    v_cndmask_b32 v12, 0, v12, s[62:63]
    s_lshl_b32 s67, s4, 3
    s_movk_i32 s58, 2304
    v_add_u32_dpp v51, v12, v12 row_shl:1 row_mask:0xf bank_mask:0xf bound_ctrl:1
    s_nop 1
    v_add_u32_dpp v51, v51, v51 row_shl:2 row_mask:0xf bank_mask:0xf bound_ctrl:1
    s_nop 1
    v_add_u32_dpp v51, v12, v51 row_shl:4 row_mask:0xf bank_mask:0x5 bound_ctrl:1
    s_waitcnt lgkmcnt(0)
    v_lshlrev_b32 v8, 16, v8
    v_lshl_add_u32 v5, v5, 10, v51
    v_sub_u32 v6, v55, v51
    v_cmp_le_u32 vcc, 72, v5
    v_lshlrev_b32 v6, 1, v6
    v_subrev_u32 v12, 1, v12
    s_cbranch_vccnz L_slow
    v_and_b32 v12, 0xff, v12
    v_lshl_add_u32 v9, v12, 18, v9
    s_mov_b64 exec, s[62:63]
    ds_write_b32 v50, v6 offset:160
    s_mov_b64 exec, -1
    s_sub_u32 s63, s67, 1
    v_readlane_b32 s67, v51, s67
    v_cmpx_lt_i32 vcc, 0, v48
    ds_read_b32 v24, v24 offset:160
    v_cmpx_lt_i32 vcc, 1, v48
    ds_read_b32 v25, v25 offset:160
    v_cmpx_lt_i32 vcc, 2, v48
    ds_read_b32 v26, v26 offset:160
    v_cmpx_lt_i32 vcc, 3, v48
    ds_read_b32 v27, v27 offset:160
    s_mov_b64 exec, -1
    s_lshr_b32 s66, s67, 3
    s_add_u32 s60, s66, 1
    s_lshl_b32 s60, s60, 3
    s_sub_u32 s67, s60, s67
    s_sub_u32 s62, s67, 1
    s_add_u32 s61, s4, 1
    s_mul_i32 s61, s61, 72
    s_sub_u32 s60, s61, s60
    s_lshl_b32 s60, s60, 2
    s_waitcnt lgkmcnt(0)
    v_cmpx_lt_i32 vcc, 0, v48
    v_add_u32 v24, v24, v32
    v_lshl_add_u32 v5, v24, 1, v57
    ds_write_b16 v5, v40
    v_lshrrev_b32 v6, 1, v24
    v_lshl_add_u32 v6, v6, 2, v60
    v_and_b32 v7, 1, v24
    v_mad_u32_u24 v6, v7, s58, v6
    ds_write_b32 v6, v16
    v_cmpx_lt_i32 vcc, 1, v48
    v_add_u32 v25, v25, v33
    v_lshl_add_u32 v5, v25, 1, v57
    ds_write_b16 v5, v41
    v_lshrrev_b32 v6, 1, v25
    v_lshl_add_u32 v6, v6, 2, v60
    v_and_b32 v7, 1, v25
    v_mad_u32_u24 v6, v7, s58, v6
    ds_write_b32 v6, v17
    v_cmpx_lt_i32 vcc, 2, v48
    v_add_u32 v26, v26, v34
    v_lshl_add_u32 v5, v26, 1, v57
    ds_write_b16 v5, v42
    v_lshrrev_b32 v6, 1, v26
    v_lshl_add_u32 v6, v6, 2, v60
    v_and_b32 v7, 1, v26
    v_mad_u32_u24 v6, v7, s58, v6
    ds_write_b32 v6, v18
    v_cmpx_lt_i32 vcc, 3, v48
    v_add_u32 v27, v27, v35
    v_lshl_add_u32 v5, v27, 1, v57
    ds_write_b16 v5, v43
    v_lshrrev_b32 v6, 1, v27
    v_lshl_add_u32 v6, v6, 2, v60
    v_and_b32 v7, 1, v27
    v_mad_u32_u24 v6, v7, s58, v6
    ds_write_b32 v6, v19
    s_mov_b64 exec, -1
    ds_add_u32 v61, v62 offset:16
    v_lshrrev_b32 v5, 5, v0
    v_mad_u32_u24 v13, v5, s58, v60
    v_add_u32 v13, s60, v13
    v_lshl_add_u32 v14, v5, 1, v57
    v_and_b32 v5, 28, v0
    v_add3_u32 v14, v14, v5, s60
    s_mov_b32 s65, 201486528
    s_mov_b32 s64, 0
    s_mov_b32 s59, 0
Lw_13:
    ds_read_b32 v4, v3 offset:16
    s_waitcnt lgkmcnt(0)
    v_cmp_gt_u32 vcc, 8, v4
    s_cbranch_vccz Lk_14
    s_add_u32 s59, s59, 1
    s_cmp_lt_u32 s59, 4194304
    s_cbranch_scc1 Lw_13
    s_branch L_end
Lk_14:
    v_mov_b32 v12, v3
    v_mov_b32 v3, v2
    s_setprio 1
    s_cmp_lt_u32 s4, 4
    s_cbranch_scc1 L_old
    s_setprio 2
L_old:
    ds_read_b128 v[56:59], v13 offset:0
    ds_read_b128 v[60:63], v13 offset:16
    ds_read_u16 v1, v14
    ds_read_b128 v[48:51], v13 offset:32
    ds_read_b128 v[52:55], v13 offset:48
    s_waitcnt lgkmcnt(3)
L_p0:
    s_cmp_ge_u32 s67, 4
    s_cbranch_scc1 L_p4
    s_cmp_gt_u32 s67, 1
    s_cbranch_scc1 Lps_15
    v_add_u32 v57, v57, v2
    buffer_load_dwordx4 v[20:23], v57, s[8:11], 0 offen
Lps_15:
    s_cmp_gt_u32 s67, 2
    s_cbranch_scc1 Lps_16
    v_add_u32 v58, v58, v2
    buffer_load_dwordx4 v[24:27], v58, s[8:11], 0 offen
Lps_16:
    s_cmp_gt_u32 s67, 3
    s_cbranch_scc1 Lps_17
    v_add_u32 v59, v59, v2
    buffer_load_dwordx4 v[28:31], v59, s[8:11], 0 offen
Lps_17:
L_p4:
    s_cmp_gt_u32 s67, 4
    s_cbranch_scc1 Lps_18
    v_add_u32 v60, v60, v2
    buffer_load_dwordx4 v[32:35], v60, s[8:11], 0 offen
Lps_18:
    s_cmp_gt_u32 s67, 5
    s_cbranch_scc1 Lps_19
    v_add_u32 v61, v61, v2
    buffer_load_dwordx4 v[36:39], v61, s[8:11], 0 offen
Lps_19:
    s_cmp_gt_u32 s67, 6
    s_cbranch_scc1 Lps_20
    v_add_u32 v62, v62, v2
    buffer_load_dwordx4 v[40:43], v62, s[8:11], 0 offen
Lps_20:
    s_cmp_gt_u32 s67, 7
    s_cbranch_scc1 Lps_21
    v_add_u32 v63, v63, v2
    buffer_load_dwordx4 v[44:47], v63, s[8:11], 0 offen
Lps_21:
    s_cmp_eq_u32 s66, 0
    s_cbranch_scc1 L_drain
L_gl:
    s_waitcnt lgkmcnt(1)
    v_perm_b32 v6, v1, v1, v10
    v_perm_b32 v7, v1, v1, v11
    ds_read_u16 v1, v14 offset:32
    s_waitcnt vmcnt(6)
    v_lshl_add_u64 v[4:5], v[48:49], 0, v[2:3]
    s_sub_u32 s62, s62, 2
    s_cbranch_scc1 Lfs_0
    v_mfma_f32_4x4x4_16b_bf16 v[56:59], v[6:7], v[16:17], v[56:59] cbsz:3 abid:0
    v_mfma_f32_4x4x4_16b_bf16 v[60:63], v[6:7], v[18:19], v[60:63] cbsz:3 abid:0
    buffer_load_dwordx4 v[16:19], v4, s[8:11], 0 offen
    v_mfma_f32_4x4x4_16b_bf16 v[56:59], v[6:7], v[20:21], v[56:59] cbsz:3 abid:1
    v_mfma_f32_4x4x4_16b_bf16 v[60:63], v[6:7], v[22:23], v[60:63] cbsz:3 abid:1
    buffer_load_dwordx4 v[20:23], v5, s[8:11], 0 offen
Lbs_0:
    s_waitcnt vmcnt(6)
    v_lshl_add_u64 v[4:5], v[50:51], 0, v[2:3]
    s_sub_u32 s62, s62, 2
    s_cbranch_scc1 Lfs_2
    v_mfma_f32_4x4x4_16b_bf16 v[56:59], v[6:7], v[24:25], v[56:59] cbsz:3 abid:2
    v_mfma_f32_4x4x4_16b_bf16 v[60:63], v[6:7], v[26:27], v[60:63] cbsz:3 abid:2
    buffer_load_dwordx4 v[24:27], v4, s[8:11], 0 offen
    v_mfma_f32_4x4x4_16b_bf16 v[56:59], v[6:7], v[28:29], v[56:59] cbsz:3 abid:3
    v_mfma_f32_4x4x4_16b_bf16 v[60:63], v[6:7], v[30:31], v[60:63] cbsz:3 abid:3
    buffer_load_dwordx4 v[28:31], v5, s[8:11], 0 offen
Lbs_2:
    ds_read_b128 v[48:51], v13 offset:64
    s_waitcnt vmcnt(6) lgkmcnt(2)
    v_lshl_add_u64 v[4:5], v[52:53], 0, v[2:3]
    s_sub_u32 s62, s62, 2
    s_cbranch_scc1 Lfs_4
    v_mfma_f32_4x4x4_16b_bf16 v[56:59], v[6:7], v[32:33], v[56:59] cbsz:3 abid:4
    v_mfma_f32_4x4x4_16b_bf16 v[60:63], v[6:7], v[34:35], v[60:63] cbsz:3 abid:4
    buffer_load_dwordx4 v[32:35], v4, s[8:11], 0 offen
    v_mfma_f32_4x4x4_16b_bf16 v[56:59], v[6:7], v[36:37], v[56:59] cbsz:3 abid:5
    v_mfma_f32_4x4x4_16b_bf16 v[60:63], v[6:7], v[38:39], v[60:63] cbsz:3 abid:5
    buffer_load_dwordx4 v[36:39], v5, s[8:11], 0 offen
Lbs_4:
    s_waitcnt vmcnt(6)
    v_lshl_add_u64 v[4:5], v[54:55], 0, v[2:3]
    s_sub_u32 s62, s62, 2
    s_cbranch_scc1 Lfs_6
    v_mfma_f32_4x4x4_16b_bf16 v[56:59], v[6:7], v[40:41], v[56:59] cbsz:3 abid:6
    v_mfma_f32_4x4x4_16b_bf16 v[60:63], v[6:7], v[42:43], v[60:63] cbsz:3 abid:6
    buffer_load_dwordx4 v[40:43], v4, s[8:11], 0 offen
    v_mfma_f32_4x4x4_16b_bf16 v[56:59], v[6:7], v[44:45], v[56:59] cbsz:3 abid:7
    v_mfma_f32_4x4x4_16b_bf16 v[60:63], v[6:7], v[46:47], v[60:63] cbsz:3 abid:7
    buffer_load_dwordx4 v[44:47], v5, s[8:11], 0 offen
Lbs_6:
    ds_read_b128 v[52:55], v13 offset:80
    v_add_u32 v13, 32, v13
    v_add_u32 v14, 32, v14
    s_sub_u32 s66, s66, 1
    s_cmp_eq_u32 s66, 3
    s_cbranch_scc0 L_nf
    s_setprio 1
L_nf:
    s_cmp_lg_u32 s66, 0
    s_cbranch_scc1 L_gl
L_drain:
    s_waitcnt lgkmcnt(0)
    v_perm_b32 v6, v1, v1, v10
    v_perm_b32 v7, v1, v1, v11
    ds_read_u16 v1, v14 offset:32
    s_waitcnt vmcnt(7)
    v_mfma_f32_4x4x4_16b_bf16 v[56:59], v[6:7], v[16:17], v[56:59] cbsz:3 abid:0
    v_mfma_f32_4x4x4_16b_bf16 v[60:63], v[6:7], v[18:19], v[60:63] cbsz:3 abid:0
    s_sub_u32 s62, s62, 1
    s_cbranch_scc1 Lfd_0
Lbd_0:
    s_waitcnt vmcnt(6)
    v_mfma_f32_4x4x4_16b_bf16 v[56:59], v[6:7], v[20:21], v[56:59] cbsz:3 abid:1
    v_mfma_f32_4x4x4_16b_bf16 v[60:63], v[6:7], v[22:23], v[60:63] cbsz:3 abid:1
    s_sub_u32 s62, s62, 1
    s_cbranch_scc1 Lfd_1
Lbd_1:
    s_waitcnt vmcnt(5)
    v_mfma_f32_4x4x4_16b_bf16 v[56:59], v[6:7], v[24:25], v[56:59] cbsz:3 abid:2
    v_mfma_f32_4x4x4_16b_bf16 v[60:63], v[6:7], v[26:27], v[60:63] cbsz:3 abid:2
    s_sub_u32 s62, s62, 1
    s_cbranch_scc1 Lfd_2
Lbd_2:
    s_waitcnt vmcnt(4)
    v_mfma_f32_4x4x4_16b_bf16 v[56:59], v[6:7], v[28:29], v[56:59] cbsz:3 abid:3
    v_mfma_f32_4x4x4_16b_bf16 v[60:63], v[6:7], v[30:31], v[60:63] cbsz:3 abid:3
    s_sub_u32 s62, s62, 1
    s_cbranch_scc1 Lfd_3
Lbd_3:
    s_waitcnt vmcnt(3)
    v_mfma_f32_4x4x4_16b_bf16 v[56:59], v[6:7], v[32:33], v[56:59] cbsz:3 abid:4
    v_mfma_f32_4x4x4_16b_bf16 v[60:63], v[6:7], v[34:35], v[60:63] cbsz:3 abid:4
    s_sub_u32 s62, s62, 1
    s_cbranch_scc1 Lfd_4
Lbd_4:
    s_waitcnt vmcnt(2)
    v_mfma_f32_4x4x4_16b_bf16 v[56:59], v[6:7], v[36:37], v[56:59] cbsz:3 abid:5
    v_mfma_f32_4x4x4_16b_bf16 v[60:63], v[6:7], v[38:39], v[60:63] cbsz:3 abid:5
    s_sub_u32 s62, s62, 1
    s_cbranch_scc1 Lfd_5
Lbd_5:
    s_waitcnt vmcnt(1)
    v_mfma_f32_4x4x4_16b_bf16 v[56:59], v[6:7], v[40:41], v[56:59] cbsz:3 abid:6
    v_mfma_f32_4x4x4_16b_bf16 v[60:63], v[6:7], v[42:43], v[60:63] cbsz:3 abid:6
    s_sub_u32 s62, s62, 1
    s_cbranch_scc1 Lfd_6
Lbd_6:
    s_waitcnt vmcnt(0)
    v_mfma_f32_4x4x4_16b_bf16 v[56:59], v[6:7], v[44:45], v[56:59] cbsz:3 abid:7
    v_mfma_f32_4x4x4_16b_bf16 v[60:63], v[6:7], v[46:47], v[60:63] cbsz:3 abid:7
    s_nop 1
    s_call_b64 s[68:69], L_flush
L_gdone:
    s_endpgm
Lfs_0:
    s_add_u32 s62, s62, 2
    v_mfma_f32_4x4x4_16b_bf16 v[56:59], v[6:7], v[16:17], v[56:59] cbsz:3 abid:0
    v_mfma_f32_4x4x4_16b_bf16 v[60:63], v[6:7], v[18:19], v[60:63] cbsz:3 abid:0
    buffer_load_dwordx4 v[16:19], v4, s[8:11], 0 offen
    s_sub_u32 s62, s62, 1
    s_cbranch_scc0 Lsk_22
    s_call_b64 s[68:69], L_flush
Lsk_22:
    v_mfma_f32_4x4x4_16b_bf16 v[56:59], v[6:7], v[20:21], v[56:59] cbsz:3 abid:1
    v_mfma_f32_4x4x4_16b_bf16 v[60:63], v[6:7], v[22:23], v[60:63] cbsz:3 abid:1
    buffer_load_dwordx4 v[20:23], v5, s[8:11], 0 offen
    s_sub_u32 s62, s62, 1
    s_cbranch_scc0 Lbs_0
    s_call_b64 s[68:69], L_flush
    s_branch Lbs_0
Lfs_2:
    s_add_u32 s62, s62, 2
    v_mfma_f32_4x4x4_16b_bf16 v[56:59], v[6:7], v[24:25], v[56:59] cbsz:3 abid:2
    v_mfma_f32_4x4x4_16b_bf16 v[60:63], v[6:7], v[26:27], v[60:63] cbsz:3 abid:2
    buffer_load_dwordx4 v[24:27], v4, s[8:11], 0 offen
    s_sub_u32 s62, s62, 1
    s_cbranch_scc0 Lsk_24
    s_call_b64 s[68:69], L_flush
Lsk_24:
    v_mfma_f32_4x4x4_16b_bf16 v[56:59], v[6:7], v[28:29], v[56:59] cbsz:3 abid:3
    v_mfma_f32_4x4x4_16b_bf16 v[60:63], v[6:7], v[30:31], v[60:63] cbsz:3 abid:3
    buffer_load_dwordx4 v[28:31], v5, s[8:11], 0 offen
    s_sub_u32 s62, s62, 1
    s_cbranch_scc0 Lbs_2
    s_call_b64 s[68:69], L_flush
    s_branch Lbs_2
Lfs_4:
    s_add_u32 s62, s62, 2
    v_mfma_f32_4x4x4_16b_bf16 v[56:59], v[6:7], v[32:33], v[56:59] cbsz:3 abid:4
    v_mfma_f32_4x4x4_16b_bf16 v[60:63], v[6:7], v[34:35], v[60:63] cbsz:3 abid:4
    buffer_load_dwordx4 v[32:35], v4, s[8:11], 0 offen
    s_sub_u32 s62, s62, 1
    s_cbranch_scc0 Lsk_26
    s_call_b64 s[68:69], L_flush
Lsk_26:
    v_mfma_f32_4x4x4_16b_bf16 v[56:59], v[6:7], v[36:37], v[56:59] cbsz:3 abid:5
    v_mfma_f32_4x4x4_16b_bf16 v[60:63], v[6:7], v[38:39], v[60:63] cbsz:3 abid:5
    buffer_load_dwordx4 v[36:39], v5, s[8:11], 0 offen
    s_sub_u32 s62, s62, 1
    s_cbranch_scc0 Lbs_4
    s_call_b64 s[68:69], L_flush
    s_branch Lbs_4
Lfs_6:
    s_add_u32 s62, s62, 2
    v_mfma_f32_4x4x4_16b_bf16 v[56:59], v[6:7], v[40:41], v[56:59] cbsz:3 abid:6
    v_mfma_f32_4x4x4_16b_bf16 v[60:63], v[6:7], v[42:43], v[60:63] cbsz:3 abid:6
    buffer_load_dwordx4 v[40:43], v4, s[8:11], 0 offen
    s_sub_u32 s62, s62, 1
    s_cbranch_scc0 Lsk_28
    s_call_b64 s[68:69], L_flush
Lsk_28:
    v_mfma_f32_4x4x4_16b_bf16 v[56:59], v[6:7], v[44:45], v[56:59] cbsz:3 abid:7
    v_mfma_f32_4x4x4_16b_bf16 v[60:63], v[6:7], v[46:47], v[60:63] cbsz:3 abid:7
    buffer_load_dwordx4 v[44:47], v5, s[8:11], 0 offen
    s_sub_u32 s62, s62, 1
    s_cbranch_scc0 Lbs_6
    s_call_b64 s[68:69], L_flush
    s_branch Lbs_6
Lfd_0:
    s_call_b64 s[68:69], L_flush
    s_branch Lbd_0
Lfd_1:
    s_call_b64 s[68:69], L_flush
    s_branch Lbd_1
Lfd_2:
    s_call_b64 s[68:69], L_flush
    s_branch Lbd_2
Lfd_3:
    s_call_b64 s[68:69], L_flush
    s_branch Lbd_3
Lfd_4:
    s_call_b64 s[68:69], L_flush
    s_branch Lbd_4
Lfd_5:
    s_call_b64 s[68:69], L_flush
    s_branch Lbd_5
Lfd_6:
    s_call_b64 s[68:69], L_flush
    s_branch Lbd_6
L_flush:
    s_and_b32 s101, s65, 0x3ffff
    s_add_u32 s63, s63, 1
    v_permlane32_swap_b32 v56, v60
    v_permlane32_swap_b32 v57, v61
    v_permlane32_swap_b32 v58, v62
    v_permlane32_swap_b32 v59, v63
    s_lshr_b32 s62, s65, 26
    v_pk_add_f32 v[56:57], v[56:57], v[60:61]
    v_pk_add_f32 v[58:59], v[58:59], v[62:63]
    v_add_u32 v62, s101, v15
    v_pk_mul_f32 v[56:57], v[56:57], s[64:65] op_sel_hi:[1,0]
    v_pk_mul_f32 v[58:59], v[58:59], s[64:65] op_sel_hi:[1,0]
    v_lshl_add_u32 v63, s62, 2, v12
    v_cvt_pk_bf16_f32 v60, v56, v57
    v_cvt_pk_bf16_f32 v61, v58, v59
    ds_write_b64 v62, v[60:61]
    s_mov_b64 exec, 1
    ds_inc_u32 v63, v63 offset:36
    s_mov_b64 exec, -1
    v_readlane_b32 s65, v9, s63
    v_readlane_b32 s64, v8, s63
    v_mov_b64 v[56:57], 0
    v_mov_b64 v[58:59], 0
    v_mov_b64 v[60:61], 0
    v_mov_b64 v[62:63], 0
    s_bfe_u32 s62, s65, 0x80012
    s_setpc_b64 s[68:69]
L_preA:
    s_setprio 2
    s_mul_i32 s5, s6, 40
    v_mov_b32 v3, 159296
    s_mov_b32 s10, 5120000
    s_mov_b32 s11, 0x20000
    s_mov_b64 s[16:17], s[56:57]
    s_mov_b32 s18, 1310720
    s_mov_b32 s19, 0x20000
    s_cmp_ge_u32 s2, 64
    s_cbranch_scc1 L_nopb
    s_barrier
    s_barrier
L_nopb:
    v_and_b32 v6, 32, v0
    v_lshl_add_u32 v5, v6, 7, v2
    v_lshl_add_u32 v6, v6, 6, v2
    s_add_u32 s58, s3, s5
    s_mul_i32 s59, s3, 1056
    s_add_u32 m0, s59, 84480
    s_lshl_b32 s58, s58, 9
    buffer_load_dwordx4 v5, s[8:11], s58 offen lds
    s_add_u32 m0, s59, 92928
    s_add_u32 s58, s58, 8192
    s_waitcnt vmcnt(2)
    buffer_load_dwordx4 v5, s[8:11], s58 offen lds
    s_cmp_ge_u32 s3, 4
    s_cbranch_scc1 L_xa2
    s_add_u32 m0, s59, 101376
    s_add_u32 s58, s58, 8192
    s_waitcnt vmcnt(2)
    buffer_load_dwordx4 v6, s[8:11], s58 offen lds
L_xa2:
    v_and_b32 v4, 7, v0
    v_mul_u32_u24 v1, 1056, v4
    v_and_b32 v4, 8, v0
    v_lshl_add_u32 v1, v4, 6, v1
    v_and_b32 v4, 48, v0
    v_add_u32 v1, v4, v1
    v_add_u32 v12, 84480, v1
    s_mov_b64 s[20:21], s[52:53]
    s_mov_b32 s22, 5120000
    s_mov_b32 s23, 0x20000
    v_lshlrev_b32 v14, 4, v0
    s_lshl_b32 s61, s3, 6
    s_add_u32 s61, s61, 105600
    v_add_u32 v13, s61, v1
    s_lshl_b32 s100, s3, 14
    s_add_u32 s100, s100, 655360
    s_waitcnt lgkmcnt(0)
    v_lshl_add_u32 v104, s32, 9, v2
    v_lshl_add_u32 v105, s33, 9, v2
    v_lshl_add_u32 v106, s34, 9, v2
    v_lshl_add_u32 v107, s35, 9, v2
    v_lshl_add_u32 v108, s36, 9, v2
    v_lshl_add_u32 v109, s37, 9, v2
    v_lshl_add_u32 v110, s38, 9, v2
    v_lshl_add_u32 v111, s39, 9, v2
    v_lshl_add_u32 v112, s64, 9, v2
    v_lshl_add_u32 v113, s65, 9, v2
    s_mov_b32 exec_lo, 0
    v_lshl_add_u32 v104, s40, 9, v2
    v_lshl_add_u32 v105, s41, 9, v2
    v_lshl_add_u32 v106, s42, 9, v2
    v_lshl_add_u32 v107, s43, 9, v2
    v_lshl_add_u32 v108, s44, 9, v2
    v_lshl_add_u32 v109, s45, 9, v2
    v_lshl_add_u32 v110, s46, 9, v2
    v_lshl_add_u32 v111, s47, 9, v2
    v_lshl_add_u32 v112, s66, 9, v2
    v_lshl_add_u32 v113, s67, 9, v2
    s_mov_b64 exec, -1
    s_mul_i32 s67, s3, 2112
    s_mul_i32 s66, s3, 8448
    s_cmp_lt_u32 s2, 64
    s_cbranch_scc1 Lth_30
    s_waitcnt vmcnt(1)
Lth_30:
    s_add_u32 m0, s66, 0
    s_waitcnt vmcnt(2)
    buffer_load_dwordx4 v104, s[8:11], 0 offen lds
    s_cmp_lt_u32 s2, 64
    s_cbranch_scc1 Lth_31
    s_waitcnt vmcnt(1)
Lth_31:
    s_add_u32 m0, s66, 1056
    s_waitcnt vmcnt(2)
    buffer_load_dwordx4 v105, s[8:11], 0 offen lds
    v_and_b32 v4, 3, v0
    v_mov_b32 v5, 0x0c0c0c0c
    v_mov_b32 v6, 0x0c0c0302
    v_mov_b32 v7, 0x03020c0c
    v_cmp_eq_u32 s[58:59], 0, v4
    v_cmp_eq_u32 s[60:61], 2, v4
    v_cmp_eq_u32 vcc, 1, v4
    v_cndmask_b32 v8, v5, v6, s[58:59]
    v_cndmask_b32 v9, v5, v6, s[60:61]
    v_cndmask_b32 v8, v8, v7, vcc
    v_cmp_eq_u32 vcc, 3, v4
    s_nop 1
    v_cndmask_b32 v9, v9, v7, vcc
    v_mov_b32 v10, v8
    v_mov_b32 v11, v9
    v_and_b32 v8, 0xfdfdfdfd, v8
    v_and_b32 v9, 0xfdfdfdfd, v9
    s_cmp_lt_u32 s2, 64
    s_cbranch_scc1 Lth_32
    s_waitcnt vmcnt(1)
Lth_32:
    s_add_u32 m0, s66, 2112
    s_waitcnt vmcnt(2)
    buffer_load_dwordx4 v106, s[8:11], 0 offen lds
    s_cmp_lt_u32 s2, 64
    s_cbranch_scc1 Lth_33
    s_waitcnt vmcnt(1)
Lth_33:
    s_add_u32 m0, s66, 3168
    s_waitcnt vmcnt(2)
    buffer_load_dwordx4 v107, s[8:11], 0 offen lds
    s_mov_b64 exec, 1
    v_mov_b32 v4, 1
    ds_add_u32 v3, v4 offset:0
    s_mov_b64 exec, -1
    s_cmp_lt_u32 s2, 64
    s_cbranch_scc1 Lth_34
    s_waitcnt vmcnt(1)
Lth_34:
    s_add_u32 m0, s66, 4224
    s_waitcnt vmcnt(2)
    buffer_load_dwordx4 v108, s[8:11], 0 offen lds
    s_mov_b32 s59, 0
Lw_35:
    ds_read_b32 v4, v3 offset:0
    s_waitcnt lgkmcnt(0)
    v_cmp_gt_u32 vcc, 8, v4
    s_cbranch_vccz Lk_36
    s_add_u32 s59, s59, 1
    s_cmp_lt_u32 s59, 4194304
    s_cbranch_scc1 Lw_35
    s_branch L_end
Lk_36:
    ds_read_b128 v[80:83], v12 offset:0
    ds_read_b128 v[84:87], v12 offset:8448
    ds_read_b128 v[88:91], v12 offset:16896
    s_cmp_lt_u32 s2, 64
    s_cbranch_scc1 Lth_37
    s_waitcnt vmcnt(1)
Lth_37:
    s_add_u32 m0, s66, 5280
    s_waitcnt vmcnt(2)
    buffer_load_dwordx4 v109, s[8:11], 0 offen lds
    s_mov_b64 exec, 1
    v_mov_b32 v4, 1
    ds_add_u32 v3, v4 offset:60
    s_mov_b64 exec, -1
    s_cmp_lt_u32 s2, 64
    s_cbranch_scc1 Lth_38
    s_waitcnt vmcnt(1)
Lth_38:
    s_waitcnt vmcnt(2)
    ds_read_b32 v4, v3 offset:52
    s_add_u32 m0, s66, 6336
    s_waitcnt vmcnt(2)
    buffer_load_dwordx4 v110, s[8:11], 0 offen lds
    s_waitcnt lgkmcnt(0)
    v_cmp_gt_u32 vcc, 8, v4
    s_cbranch_vccz L_eu7
    s_cmp_lt_u32 s2, 64
    s_cbranch_scc1 Lth_39
    s_waitcnt vmcnt(1)
Lth_39:
    s_waitcnt vmcnt(2)
    ds_read_b32 v4, v3 offset:52
    s_add_u32 m0, s66, 7392
    s_waitcnt vmcnt(2)
    buffer_load_dwordx4 v111, s[8:11], 0 offen lds
    s_waitcnt lgkmcnt(0)
    v_cmp_gt_u32 vcc, 8, v4
    s_cbranch_vccz L_eu8
    s_cmp_lt_u32 s2, 64
    s_cbranch_scc1 Lth_40
    s_waitcnt vmcnt(1)
Lth_40:
    s_waitcnt vmcnt(2)
    ds_read_b32 v4, v3 offset:52
    s_add_u32 m0, s67, 67584
    s_waitcnt vmcnt(2)
    buffer_load_dwordx4 v112, s[8:11], 0 offen lds
    s_waitcnt lgkmcnt(0)
    v_cmp_gt_u32 vcc, 8, v4
    s_cbranch_vccz L_eu9
    s_cmp_lt_u32 s2, 64
    s_cbranch_scc1 Lth_41
    s_waitcnt vmcnt(1)
Lth_41:
    s_waitcnt vmcnt(2)
    ds_read_b32 v4, v3 offset:52
    s_add_u32 m0, s67, 68640
    s_waitcnt vmcnt(2)
    buffer_load_dwordx4 v113, s[8:11], 0 offen lds
    s_mov_b32 s59, 0
Lw_42:
    ds_read_b32 v4, v3 offset:52
    s_waitcnt lgkmcnt(0)
    v_cmp_gt_u32 vcc, 8, v4
    s_cbranch_vccz Lk_43
    s_sleep 1
    s_add_u32 s59, s59, 1
    s_cmp_lt_u32 s59, 4194304
    s_cbranch_scc1 Lw_42
    s_branch L_end
Lk_43:
    s_branch L_eu10
L_eu7:
    s_add_u32 m0, s66, 7392
    s_waitcnt vmcnt(63)
    buffer_load_dwordx4 v111, s[8:11], 0 offen lds
L_eu8:
    s_add_u32 m0, s67, 67584
    s_waitcnt vmcnt(63)
    buffer_load_dwordx4 v112, s[8:11], 0 offen lds
L_eu9:
    s_add_u32 m0, s67, 68640
    s_waitcnt vmcnt(63)
    buffer_load_dwordx4 v113, s[8:11], 0 offen lds
L_eu10:
    s_setprio 3
    buffer_load_dwordx4 v[16:19], v14, s[16:19], s100 offen offset:0 sc1
    buffer_load_dwordx4 v[20:23], v14, s[16:19], s100 offen offset:1024 sc1
    buffer_load_dwordx4 v[24:27], v14, s[16:19], s100 offen offset:2048 sc1
    buffer_load_dwordx4 v[28:31], v14, s[16:19], s100 offen offset:3072 sc1
    s_add_u32 s100, s100, 4096
    buffer_load_dwordx4 v[32:35], v14, s[16:19], s100 offen offset:0 sc1
    buffer_load_dwordx4 v[36:39], v14, s[16:19], s100 offen offset:1024 sc1
    buffer_load_dwordx4 v[40:43], v14, s[16:19], s100 offen offset:2048 sc1
    buffer_load_dwordx4 v[44:47], v14, s[16:19], s100 offen offset:3072 sc1
    s_add_u32 s100, s100, 4096
    buffer_load_dwordx4 v[48:51], v14, s[16:19], s100 offen offset:0 sc1
    buffer_load_dwordx4 v[52:55], v14, s[16:19], s100 offen offset:1024 sc1
    buffer_load_dwordx4 v[56:59], v14, s[16:19], s100 offen offset:2048 sc1
    buffer_load_dwordx4 v[60:63], v14, s[16:19], s100 offen offset:3072 sc1
    s_add_u32 s100, s100, 4096
    buffer_load_dwordx4 v[64:67], v14, s[16:19], s100 offen offset:0 sc1
    buffer_load_dwordx4 v[68:71], v14, s[16:19], s100 offen offset:1024 sc1
    buffer_load_dwordx4 v[72:75], v14, s[16:19], s100 offen offset:2048 sc1
    buffer_load_dwordx4 v[76:79], v14, s[16:19], s100 offen offset:3072 sc1
    s_setprio 0
    ds_read_b128 v[92:95], v12 offset:64
    ds_read_b128 v[96:99], v12 offset:8512
    ds_read_b128 v[100:103], v12 offset:16960
    s_waitcnt vmcnt(14) lgkmcnt(3)
    v_mfma_f32_16x16x32_bf16 v[104:107], v[16:19], v[80:83], 0
    v_mfma_f32_16x16x32_bf16 v[108:111], v[20:23], v[80:83], 0
    v_mfma_f32_16x16x32_bf16 v[112:115], v[16:19], v[84:87], 0
    v_mfma_f32_16x16x32_bf16 v[116:119], v[20:23], v[84:87], 0
    v_mfma_f32_16x16x32_bf16 v[120:123], v[16:19], v[88:91], 0
    v_mfma_f32_16x16x32_bf16 v[124:127], v[20:23], v[88:91], 0
    ds_read_b128 v[80:83], v12 offset:128
    ds_read_b128 v[84:87], v12 offset:8576
    ds_read_b128 v[88:91], v12 offset:17024
    s_waitcnt vmcnt(12) lgkmcnt(3)
    v_mfma_f32_16x16x32_bf16 v[104:107], v[24:27], v[92:95], v[104:107]
    v_mfma_f32_16x16x32_bf16 v[108:111], v[28:31], v[92:95], v[108:111]
    v_mfma_f32_16x16x32_bf16 v[112:115], v[24:27], v[96:99], v[112:115]
    v_mfma_f32_16x16x32_bf16 v[116:119], v[28:31], v[96:99], v[116:119]
    v_mfma_f32_16x16x32_bf16 v[120:123], v[24:27], v[100:103], v[120:123]
    v_mfma_f32_16x16x32_bf16 v[124:127], v[28:31], v[100:103], v[124:127]
    ds_read_b128 v[92:95], v12 offset:192
    ds_read_b128 v[96:99], v12 offset:8640
    ds_read_b128 v[100:103], v12 offset:17088
    s_waitcnt vmcnt(10) lgkmcnt(3)
    v_mfma_f32_16x16x32_bf16 v[104:107], v[32:35], v[80:83], v[104:107]
    v_mfma_f32_16x16x32_bf16 v[108:111], v[36:39], v[80:83], v[108:111]
    v_mfma_f32_16x16x32_bf16 v[112:115], v[32:35], v[84:87], v[112:115]
    v_mfma_f32_16x16x32_bf16 v[116:119], v[36:39], v[84:87], v[116:119]
    v_mfma_f32_16x16x32_bf16 v[120:123], v[32:35], v[88:91], v[120:123]
    v_mfma_f32_16x16x32_bf16 v[124:127], v[36:39], v[88:91], v[124:127]
    ds_read_b128 v[80:83], v12 offset:256
    ds_read_b128 v[84:87], v12 offset:8704
    ds_read_b128 v[88:91], v12 offset:17152
    s_waitcnt vmcnt(8) lgkmcnt(3)
    v_mfma_f32_16x16x32_bf16 v[104:107], v[40:43], v[92:95], v[104:107]
    v_mfma_f32_16x16x32_bf16 v[108:111], v[44:47], v[92:95], v[108:111]
    v_mfma_f32_16x16x32_bf16 v[112:115], v[40:43], v[96:99], v[112:115]
    v_mfma_f32_16x16x32_bf16 v[116:119], v[44:47], v[96:99], v[116:119]
    v_mfma_f32_16x16x32_bf16 v[120:123], v[40:43], v[100:103], v[120:123]
    v_mfma_f32_16x16x32_bf16 v[124:127], v[44:47], v[100:103], v[124:127]
    ds_read_b128 v[92:95], v12 offset:320
    ds_read_b128 v[96:99], v12 offset:8768
    ds_read_b128 v[100:103], v12 offset:17216
    s_waitcnt vmcnt(6) lgkmcnt(3)
    v_mfma_f32_16x16x32_bf16 v[104:107], v[48:51], v[80:83], v[104:107]
    v_mfma_f32_16x16x32_bf16 v[108:111], v[52:55], v[80:83], v[108:111]
    v_mfma_f32_16x16x32_bf16 v[112:115], v[48:51], v[84:87], v[112:115]
    v_mfma_f32_16x16x32_bf16 v[116:119], v[52:55], v[84:87], v[116:119]
    v_mfma_f32_16x16x32_bf16 v[120:123], v[48:51], v[88:91], v[120:123]
    v_mfma_f32_16x16x32_bf16 v[124:127], v[52:55], v[88:91], v[124:127]
    s_setprio 3
    s_add_u32 s100, s100, 118784
    buffer_load_dwordx4 v[16:19], v14, s[16:19], s100 offen offset:0 sc1
    buffer_load_dwordx4 v[20:23], v14, s[16:19], s100 offen offset:1024 sc1
    buffer_load_dwordx4 v[24:27], v14, s[16:19], s100 offen offset:2048 sc1
    buffer_load_dwordx4 v[28:31], v14, s[16:19], s100 offen offset:3072 sc1
    s_setprio 0
    ds_read_b128 v[80:83], v12 offset:384
    ds_read_b128 v[84:87], v12 offset:8832
    ds_read_b128 v[88:91], v12 offset:17280
    s_waitcnt vmcnt(8) lgkmcnt(3)
    v_mfma_f32_16x16x32_bf16 v[104:107], v[56:59], v[92:95], v[104:107]
    v_mfma_f32_16x16x32_bf16 v[108:111], v[60:63], v[92:95], v[108:111]
    v_mfma_f32_16x16x32_bf16 v[112:115], v[56:59], v[96:99], v[112:115]
    v_mfma_f32_16x16x32_bf16 v[116:119], v[60:63], v[96:99], v[116:119]
    v_mfma_f32_16x16x32_bf16 v[120:123], v[56:59], v[100:103], v[120:123]
    v_mfma_f32_16x16x32_bf16 v[124:127], v[60:63], v[100:103], v[124:127]
    s_setprio 3
    s_add_u32 s100, s100, 4096
    buffer_load_dwordx4 v[32:35], v14, s[16:19], s100 offen offset:0 sc1
    buffer_load_dwordx4 v[36:39], v14, s[16:19], s100 offen offset:1024 sc1
    buffer_load_dwordx4 v[40:43], v14, s[16:19], s100 offen offset:2048 sc1
    buffer_load_dwordx4 v[44:47], v14, s[16:19], s100 offen offset:3072 sc1
    s_setprio 0
    ds_read_b128 v[92:95], v12 offset:448
    ds_read_b128 v[96:99], v12 offset:8896
    ds_read_b128 v[100:103], v12 offset:17344
    s_waitcnt vmcnt(10) lgkmcnt(3)
    v_mfma_f32_16x16x32_bf16 v[104:107], v[64:67], v[80:83], v[104:107]
    v_mfma_f32_16x16x32_bf16 v[108:111], v[68:71], v[80:83], v[108:111]
    v_mfma_f32_16x16x32_bf16 v[112:115], v[64:67], v[84:87], v[112:115]
    v_mfma_f32_16x16x32_bf16 v[116:119], v[68:71], v[84:87], v[116:119]
    v_mfma_f32_16x16x32_bf16 v[120:123], v[64:67], v[88:91], v[120:123]
    v_mfma_f32_16x16x32_bf16 v[124:127], v[68:71], v[88:91], v[124:127]
    s_setprio 3
    s_add_u32 s100, s100, 4096
    buffer_load_dwordx4 v[48:51], v14, s[16:19], s100 offen offset:0 sc1
    buffer_load_dwordx4 v[52:55], v14, s[16:19], s100 offen offset:1024 sc1
    buffer_load_dwordx4 v[56:59], v14, s[16:19], s100 offen offset:2048 sc1
    buffer_load_dwordx4 v[60:63], v14, s[16:19], s100 offen offset:3072 sc1
    s_setprio 0
    s_waitcnt vmcnt(12) lgkmcnt(0)
    v_mfma_f32_16x16x32_bf16 v[104:107], v[72:75], v[92:95], v[104:107]
    v_mfma_f32_16x16x32_bf16 v[108:111], v[76:79], v[92:95], v[108:111]
    v_mfma_f32_16x16x32_bf16 v[112:115], v[72:75], v[96:99], v[112:115]
    v_mfma_f32_16x16x32_bf16 v[116:119], v[76:79], v[96:99], v[116:119]
    v_mfma_f32_16x16x32_bf16 v[120:123], v[72:75], v[100:103], v[120:123]
    v_mfma_f32_16x16x32_bf16 v[124:127], v[76:79], v[100:103], v[124:127]
    s_setprio 3
    s_add_u32 s100, s100, 4096
    buffer_load_dwordx4 v[64:67], v14, s[16:19], s100 offen offset:0 sc1
    buffer_load_dwordx4 v[68:71], v14, s[16:19], s100 offen offset:1024 sc1
    buffer_load_dwordx4 v[72:75], v14, s[16:19], s100 offen offset:2048 sc1
    buffer_load_dwordx4 v[76:79], v14, s[16:19], s100 offen offset:3072 sc1
    s_setprio 0
    s_nop 3
    v_cvt_pk_bf16_f32 v80, v104, v105
    v_cvt_pk_bf16_f32 v81, v106, v107
    v_cvt_pk_bf16_f32 v82, v108, v109
    v_cvt_pk_bf16_f32 v83, v110, v111
    ds_write_b128 v13, v[80:83] offset:0
    v_cvt_pk_bf16_f32 v84, v112, v113
    v_cvt_pk_bf16_f32 v85, v114, v115
    v_cvt_pk_bf16_f32 v86, v116, v117
    v_cvt_pk_bf16_f32 v87, v118, v119
    ds_write_b128 v13, v[84:87] offset:8448
    v_cvt_pk_bf16_f32 v88, v120, v121
    v_cvt_pk_bf16_f32 v89, v122, v123
    v_cvt_pk_bf16_f32 v90, v124, v125
    v_cvt_pk_bf16_f32 v91, v126, v127
    ds_write_b128 v13, v[88:91] offset:16896
    s_mov_b64 exec, 1
    v_mov_b32 v4, 1
    ds_add_u32 v3, v4 offset:20
    s_mov_b64 exec, -1
    s_setprio 3
    s_setprio 0
    s_mov_b32 s63, s3
L_grp:
    s_mul_i32 s58, s63, 8448
    s_lshr_b32 s59, s63, 2
    s_mul_i32 s59, s59, 8448
    s_and_b32 s60, s63, 1
    s_bfe_u32 s61, s63, 0x10001
    s_cmp_ge_u32 s63, 8
    s_cselect_b32 s61, s60, s61
    s_cselect_b32 s60, 0, s60
    s_mul_i32 s60, s60, 4224
    s_lshl_b32 s61, s61, 9
    s_add_u32 s59, s59, s60
    s_add_u32 s59, s59, s61
    s_add_u32 s59, s59, 105600
    v_add_u32 v12, s58, v1
    v_bfe_u32 v4, v0, 2, 2
    v_mul_u32_u24 v4, 1056, v4
    v_and_b32 v5, 48, v0
    v_add3_u32 v13, v4, v5, s59
    v_lshl_add_u32 v14, v0, 3, s58
    v_lshl_add_u32 v2, v0, 3, s59
    s_cmp_ge_u32 s63, 8
    s_cbranch_scc1 L_grp2
    s_mov_b32 s59, 0
Lw_44:
    ds_read_b32 v4, v3 offset:20
    s_waitcnt lgkmcnt(0)
    v_cmp_gt_u32 vcc, 8, v4
    s_cbranch_vccz Lk_45
    s_sleep 1
    s_add_u32 s59, s59, 1
    s_cmp_lt_u32 s59, 4194304
    s_cbranch_scc1 Lw_44
    s_branch L_end
Lk_45:
L_grp2:
    s_waitcnt lgkmcnt(0)
    ds_read_b128 v[80:83], v12 offset:0
    ds_read_b128 v[84:87], v13 offset:0
    ds_read_b128 v[88:91], v12 offset:64
    ds_read_b128 v[92:95], v13 offset:64
    ds_read_b128 v[96:99], v12 offset:128
    ds_read_b128 v[100:103], v13 offset:128
    ds_read_b128 v[104:107], v12 offset:192
    ds_read_b128 v[108:111], v13 offset:192
    ds_read_b128 v[112:115], v12 offset:256
    ds_read_b128 v[116:119], v13 offset:256
    ds_read_b128 v[120:123], v12 offset:320
    ds_read_b128 v[124:127], v13 offset:320
    s_waitcnt lgkmcnt(10)
    v_mfma_f32_16x16x32_bf16 v[4:7], v[80:83], v[84:87], 0
    ds_read_b128 v[80:83], v12 offset:384
    ds_read_b128 v[84:87], v13 offset:384
    s_waitcnt lgkmcnt(10)
    v_mfma_f32_16x16x32_bf16 v[4:7], v[88:91], v[92:95], v[4:7]
    ds_read_b128 v[88:91], v12 offset:448
    ds_read_b128 v[92:95], v13 offset:448
    s_waitcnt lgkmcnt(10)
    v_mfma_f32_16x16x32_bf16 v[4:7], v[96:99], v[100:103], v[4:7]
    s_waitcnt lgkmcnt(8)
    v_mfma_f32_16x16x32_bf16 v[4:7], v[104:107], v[108:111], v[4:7]
    s_waitcnt lgkmcnt(6)
    v_mfma_f32_16x16x32_bf16 v[4:7], v[112:115], v[116:119], v[4:7]
    s_waitcnt lgkmcnt(4)
    v_mfma_f32_16x16x32_bf16 v[4:7], v[120:123], v[124:127], v[4:7]
    s_waitcnt lgkmcnt(2)
    v_mfma_f32_16x16x32_bf16 v[4:7], v[80:83], v[84:87], v[4:7]
    s_waitcnt lgkmcnt(0)
    v_mfma_f32_16x16x32_bf16 v[4:7], v[88:91], v[92:95], v[4:7]
    ds_read_b64 v[96:97], v14 offset:2112
    ds_read_b64 v[98:99], v14 offset:6336
    ds_read_b64 v[100:101], v14 offset:2624
    ds_read_b64 v[102:103], v14 offset:6848
    ds_read_b64 v[104:105], v14 offset:3168
    ds_read_b64 v[106:107], v14 offset:7392
    ds_read_b64 v[108:109], v14 offset:3680
    ds_read_b64 v[110:111], v14 offset:7904
    ds_read_b64 v[80:81], v14 offset:0
    ds_read_b64 v[82:83], v14 offset:4224
    ds_read_b64 v[84:85], v14 offset:512
    ds_read_b64 v[86:87], v14 offset:4736
    ds_read_b64 v[88:89], v14 offset:1056
    ds_read_b64 v[90:91], v14 offset:5280
    ds_read_b64 v[92:93], v14 offset:1568
    s_waitcnt lgkmcnt(14)
    ds_read_b64 v[94:95], v14 offset:5792
    v_mul_f32 v4, 0x3db8aa3b, v4
    v_mul_f32 v5, 0x3db8aa3b, v5
    v_mul_f32 v6, 0x3db8aa3b, v6
    v_mul_f32 v7, 0x3db8aa3b, v7
    v_exp_f32 v4, v4
    v_exp_f32 v5, v5
    v_exp_f32 v6, v6
    v_exp_f32 v7, v7
    v_add_f32 v12, v4, v5
    v_add_f32 v13, v6, v7
    v_add_f32 v12, v12, v13
    v_add_f32 v12, 0x3089705f, v12
    v_rcp_f32 v12, v12
    s_add_u32 s63, s63, 8
    v_mul_f32 v4, v4, v12
    v_mul_f32 v5, v5, v12
    v_mul_f32 v6, v6, v12
    v_mul_f32 v7, v7, v12
    v_cvt_pk_bf16_f32 v4, v4, v5
    v_cvt_pk_bf16_f32 v6, v6, v7
    v_perm_b32 v112, v4, v4, v8
    v_perm_b32 v113, v4, v4, v9
    v_perm_b32 v114, v4, v4, v10
    v_perm_b32 v115, v4, v4, v11
    v_perm_b32 v116, v6, v6, v8
    v_perm_b32 v117, v6, v6, v9
    v_perm_b32 v118, v6, v6, v10
    v_perm_b32 v119, v6, v6, v11
    s_waitcnt lgkmcnt(0)
    v_mfma_f32_4x4x4_16b_bf16 v[120:123], v[112:113], v[80:81], 0 cbsz:4 abid:0
    v_mfma_f32_4x4x4_16b_bf16 v[124:127], v[112:113], v[82:83], 0 cbsz:4 abid:5
    v_mfma_f32_4x4x4_16b_bf16 v[4:7], v[112:113], v[84:85], 0 cbsz:4 abid:10
    v_mfma_f32_4x4x4_16b_bf16 v[12:15], v[112:113], v[86:87], 0 cbsz:4 abid:15
    v_mfma_f32_4x4x4_16b_bf16 v[120:123], v[114:115], v[88:89], v[120:123] cbsz:4 abid:0
    v_mfma_f32_4x4x4_16b_bf16 v[124:127], v[114:115], v[90:91], v[124:127] cbsz:4 abid:5
    v_mfma_f32_4x4x4_16b_bf16 v[4:7], v[114:115], v[92:93], v[4:7] cbsz:4 abid:10
    v_mfma_f32_4x4x4_16b_bf16 v[12:15], v[114:115], v[94:95], v[12:15] cbsz:4 abid:15
    v_mfma_f32_4x4x4_16b_bf16 v[120:123], v[116:117], v[96:97], v[120:123] cbsz:4 abid:0
    v_mfma_f32_4x4x4_16b_bf16 v[124:127], v[116:117], v[98:99], v[124:127] cbsz:4 abid:5
    v_mfma_f32_4x4x4_16b_bf16 v[4:7], v[116:117], v[100:101], v[4:7] cbsz:4 abid:10
    v_mfma_f32_4x4x4_16b_bf16 v[12:15], v[116:117], v[102:103], v[12:15] cbsz:4 abid:15
    v_mfma_f32_4x4x4_16b_bf16 v[120:123], v[118:119], v[104:105], v[120:123] cbsz:4 abid:0
    v_mfma_f32_4x4x4_16b_bf16 v[124:127], v[118:119], v[106:107], v[124:127] cbsz:4 abid:5
    v_mfma_f32_4x4x4_16b_bf16 v[4:7], v[118:119], v[108:109], v[4:7] cbsz:4 abid:10
    v_mfma_f32_4x4x4_16b_bf16 v[12:15], v[118:119], v[110:111], v[12:15] cbsz:4 abid:15
    s_nop 1
    v_cvt_pk_bf16_f32 v112, v120, v121
    v_cvt_pk_bf16_f32 v113, v122, v123
    ds_write_b64 v2, v[112:113] offset:0
    v_cvt_pk_bf16_f32 v114, v124, v125
    v_cvt_pk_bf16_f32 v115, v126, v127
    ds_write_b64 v2, v[114:115] offset:1056
    v_cvt_pk_bf16_f32 v116, v4, v5
    v_cvt_pk_bf16_f32 v117, v6, v7
    ds_write_b64 v2, v[116:117] offset:2112
    v_cvt_pk_bf16_f32 v118, v12, v13
    v_cvt_pk_bf16_f32 v119, v14, v15
    ds_write_b64 v2, v[118:119] offset:3168
    s_cmp_lt_u32 s63, 10
    s_cbranch_scc1 L_grp
L_grpx:
    s_mov_b64 exec, 1
    v_mov_b32 v4, 1
    ds_add_u32 v3, v4 offset:24
    s_mov_b64 exec, -1
    v_add_u32 v12, 105600, v1
    v_lshlrev_b32 v14, 4, v0
    v_and_b32 v6, 15, v0
    v_lshlrev_b32 v6, 2, v6
    v_and_b32 v5, 48, v0
    v_lshl_add_u32 v8, v5, 7, v6
    v_and_b32 v5, 32, v0
    v_lshl_add_u32 v9, v5, 6, v6
    v_and_b32 v5, 16, v0
    v_lshl_add_u32 v9, v5, 22, v9
    s_lshl_b32 s60, s5, 9
    s_lshl_b32 s61, s3, 6
    s_add_u32 s60, s60, s61
    s_mov_b32 s59, 0
Lw_46:
    ds_read_b32 v4, v3 offset:24
    s_waitcnt lgkmcnt(0)
    v_cmp_gt_u32 vcc, 8, v4
    s_cbranch_vccz Lk_47
    s_sleep 1
    s_add_u32 s59, s59, 1
    s_cmp_lt_u32 s59, 4194304
    s_cbranch_scc1 Lw_46
    s_branch L_end
Lk_47:
    ds_read_b128 v[80:83], v12 offset:0
    ds_read_b128 v[84:87], v12 offset:8448
    ds_read_b128 v[88:91], v12 offset:16896
    ds_read_b128 v[92:95], v12 offset:64
    ds_read_b128 v[96:99], v12 offset:8512
    ds_read_b128 v[100:103], v12 offset:16960
    s_waitcnt vmcnt(14) lgkmcnt(3)
    v_mfma_f32_16x16x32_bf16 v[104:107], v[80:83], v[16:19], 0
    v_mfma_f32_16x16x32_bf16 v[108:111], v[80:83], v[20:23], 0
    v_mfma_f32_16x16x32_bf16 v[112:115], v[84:87], v[16:19], 0
    v_mfma_f32_16x16x32_bf16 v[116:119], v[84:87], v[20:23], 0
    v_mfma_f32_16x16x32_bf16 v[120:123], v[88:91], v[16:19], 0
    v_mfma_f32_16x16x32_bf16 v[124:127], v[88:91], v[20:23], 0
    ds_read_b128 v[80:83], v12 offset:128
    ds_read_b128 v[84:87], v12 offset:8576
    ds_read_b128 v[88:91], v12 offset:17024
    s_waitcnt vmcnt(12) lgkmcnt(3)
    v_mfma_f32_16x16x32_bf16 v[104:107], v[92:95], v[24:27], v[104:107]
    v_mfma_f32_16x16x32_bf16 v[108:111], v[92:95], v[28:31], v[108:111]
    v_mfma_f32_16x16x32_bf16 v[112:115], v[96:99], v[24:27], v[112:115]
    v_mfma_f32_16x16x32_bf16 v[116:119], v[96:99], v[28:31], v[116:119]
    v_mfma_f32_16x16x32_bf16 v[120:123], v[100:103], v[24:27], v[120:123]
    v_mfma_f32_16x16x32_bf16 v[124:127], v[100:103], v[28:31], v[124:127]
    ds_read_b128 v[92:95], v12 offset:192
    ds_read_b128 v[96:99], v12 offset:8640
    ds_read_b128 v[100:103], v12 offset:17088
    s_waitcnt vmcnt(10) lgkmcnt(3)
    v_mfma_f32_16x16x32_bf16 v[104:107], v[80:83], v[32:35], v[104:107]
    v_mfma_f32_16x16x32_bf16 v[108:111], v[80:83], v[36:39], v[108:111]
    v_mfma_f32_16x16x32_bf16 v[112:115], v[84:87], v[32:35], v[112:115]
    v_mfma_f32_16x16x32_bf16 v[116:119], v[84:87], v[36:39], v[116:119]
    v_mfma_f32_16x16x32_bf16 v[120:123], v[88:91], v[32:35], v[120:123]
    v_mfma_f32_16x16x32_bf16 v[124:127], v[88:91], v[36:39], v[124:127]
    ds_read_b128 v[80:83], v12 offset:256
    ds_read_b128 v[84:87], v12 offset:8704
    ds_read_b128 v[88:91], v12 offset:17152
    s_waitcnt vmcnt(8) lgkmcnt(3)
    v_mfma_f32_16x16x32_bf16 v[104:107], v[92:95], v[40:43], v[104:107]
    v_mfma_f32_16x16x32_bf16 v[108:111], v[92:95], v[44:47], v[108:111]
    v_mfma_f32_16x16x32_bf16 v[112:115], v[96:99], v[40:43], v[112:115]
    v_mfma_f32_16x16x32_bf16 v[116:119], v[96:99], v[44:47], v[116:119]
    v_mfma_f32_16x16x32_bf16 v[120:123], v[100:103], v[40:43], v[120:123]
    v_mfma_f32_16x16x32_bf16 v[124:127], v[100:103], v[44:47], v[124:127]
    ds_read_b128 v[92:95], v12 offset:320
    ds_read_b128 v[96:99], v12 offset:8768
    ds_read_b128 v[100:103], v12 offset:17216
    s_waitcnt vmcnt(6) lgkmcnt(3)
    v_mfma_f32_16x16x32_bf16 v[104:107], v[80:83], v[48:51], v[104:107]
    v_mfma_f32_16x16x32_bf16 v[108:111], v[80:83], v[52:55], v[108:111]
    v_mfma_f32_16x16x32_bf16 v[112:115], v[84:87], v[48:51], v[112:115]
    v_mfma_f32_16x16x32_bf16 v[116:119], v[84:87], v[52:55], v[116:119]
    v_mfma_f32_16x16x32_bf16 v[120:123], v[88:91], v[48:51], v[120:123]
    v_mfma_f32_16x16x32_bf16 v[124:127], v[88:91], v[52:55], v[124:127]
    s_setprio 3
    s_add_u32 s100, s100, 118784
    buffer_load_dwordx4 v[16:19], v14, s[16:19], s100 offen offset:0 sc1
    buffer_load_dwordx4 v[20:23], v14, s[16:19], s100 offen offset:1024 sc1
    buffer_load_dwordx4 v[24:27], v14, s[16:19], s100 offen offset:2048 sc1
    buffer_load_dwordx4 v[28:31], v14, s[16:19], s100 offen offset:3072 sc1
    s_setprio 0
    ds_read_b128 v[80:83], v12 offset:384
    ds_read_b128 v[84:87], v12 offset:8832
    ds_read_b128 v[88:91], v12 offset:17280
    s_waitcnt vmcnt(8) lgkmcnt(3)
    v_mfma_f32_16x16x32_bf16 v[104:107], v[92:95], v[56:59], v[104:107]
    v_mfma_f32_16x16x32_bf16 v[108:111], v[92:95], v[60:63], v[108:111]
    v_mfma_f32_16x16x32_bf16 v[112:115], v[96:99], v[56:59], v[112:115]
    v_mfma_f32_16x16x32_bf16 v[116:119], v[96:99], v[60:63], v[116:119]
    v_mfma_f32_16x16x32_bf16 v[120:123], v[100:103], v[56:59], v[120:123]
    v_mfma_f32_16x16x32_bf16 v[124:127], v[100:103], v[60:63], v[124:127]
    s_setprio 3
    s_add_u32 s100, s100, 4096
    buffer_load_dwordx4 v[32:35], v14, s[16:19], s100 offen offset:0 sc1
    buffer_load_dwordx4 v[36:39], v14, s[16:19], s100 offen offset:1024 sc1
    buffer_load_dwordx4 v[40:43], v14, s[16:19], s100 offen offset:2048 sc1
    buffer_load_dwordx4 v[44:47], v14, s[16:19], s100 offen offset:3072 sc1
    s_setprio 0
    ds_read_b128 v[92:95], v12 offset:448
    ds_read_b128 v[96:99], v12 offset:8896
    ds_read_b128 v[100:103], v12 offset:17344
    s_waitcnt vmcnt(10) lgkmcnt(3)
    v_mfma_f32_16x16x32_bf16 v[104:107], v[80:83], v[64:67], v[104:107]
    v_mfma_f32_16x16x32_bf16 v[108:111], v[80:83], v[68:71], v[108:111]
    v_mfma_f32_16x16x32_bf16 v[112:115], v[84:87], v[64:67], v[112:115]
    v_mfma_f32_16x16x32_bf16 v[116:119], v[84:87], v[68:71], v[116:119]
    v_mfma_f32_16x16x32_bf16 v[120:123], v[88:91], v[64:67], v[120:123]
    v_mfma_f32_16x16x32_bf16 v[124:127], v[88:91], v[68:71], v[124:127]
    s_setprio 3
    s_add_u32 s100, s100, 4096
    buffer_load_dwordx4 v[48:51], v14, s[16:19], s100 offen offset:0 sc1
    buffer_load_dwordx4 v[52:55], v14, s[16:19], s100 offen offset:1024 sc1
    buffer_load_dwordx4 v[56:59], v14, s[16:19], s100 offen offset:2048 sc1
    buffer_load_dwordx4 v[60:63], v14, s[16:19], s100 offen offset:3072 sc1
    s_setprio 0
    s_waitcnt vmcnt(12) lgkmcnt(0)
    v_mfma_f32_16x16x32_bf16 v[104:107], v[92:95], v[72:75], v[104:107]
    v_mfma_f32_16x16x32_bf16 v[108:111], v[92:95], v[76:79], v[108:111]
    v_mfma_f32_16x16x32_bf16 v[112:115], v[96:99], v[72:75], v[112:115]
    v_mfma_f32_16x16x32_bf16 v[116:119], v[96:99], v[76:79], v[116:119]
    v_mfma_f32_16x16x32_bf16 v[120:123], v[100:103], v[72:75], v[120:123]
    v_mfma_f32_16x16x32_bf16 v[124:127], v[100:103], v[76:79], v[124:127]
    s_setprio 3
    s_add_u32 s100, s100, 4096
    buffer_load_dwordx4 v[64:67], v14, s[16:19], s100 offen offset:0 sc1
    buffer_load_dwordx4 v[68:71], v14, s[16:19], s100 offen offset:1024 sc1
    buffer_load_dwordx4 v[72:75], v14, s[16:19], s100 offen offset:2048 sc1
    buffer_load_dwordx4 v[76:79], v14, s[16:19], s100 offen offset:3072 sc1
    s_setprio 0
    s_setprio 3
    s_setprio 0
    v_add_u32 v12, 130944, v1
    s_mov_b32 s59, 0
Lw_48:
    ds_read_b32 v4, v3 offset:36
    s_waitcnt lgkmcnt(0)
    v_cmp_gt_u32 vcc, 16, v4
    s_cbranch_vccz Lk_49
    s_sleep 3
    s_add_u32 s59, s59, 1
    s_cmp_lt_u32 s59, 16777216
    s_cbranch_scc1 Lw_48
    s_branch L_end
Lk_49:
    ds_read_b128 v[80:83], v12 offset:0
    ds_read_b128 v[84:87], v12 offset:64
    ds_read_b128 v[88:91], v12 offset:128
    ds_read_b128 v[92:95], v12 offset:192
    ds_read_b128 v[96:99], v12 offset:256
    ds_read_b128 v[100:103], v12 offset:320
    s_waitcnt vmcnt(14) lgkmcnt(5)
    v_mfma_f32_16x16x32_bf16 v[104:107], v[80:83], v[16:19], v[104:107]
    v_mfma_f32_16x16x32_bf16 v[108:111], v[80:83], v[20:23], v[108:111]
    ds_read_b128 v[80:83], v12 offset:384
    s_waitcnt vmcnt(12) lgkmcnt(5)
    v_mfma_f32_16x16x32_bf16 v[104:107], v[84:87], v[24:27], v[104:107]
    v_mfma_f32_16x16x32_bf16 v[108:111], v[84:87], v[28:31], v[108:111]
    ds_read_b128 v[84:87], v12 offset:448
    s_waitcnt vmcnt(10) lgkmcnt(5)
    v_mfma_f32_16x16x32_bf16 v[104:107], v[88:91], v[32:35], v[104:107]
    v_mfma_f32_16x16x32_bf16 v[108:111], v[88:91], v[36:39], v[108:111]
    s_waitcnt vmcnt(8) lgkmcnt(4)
    v_mfma_f32_16x16x32_bf16 v[104:107], v[92:95], v[40:43], v[104:107]
    v_mfma_f32_16x16x32_bf16 v[108:111], v[92:95], v[44:47], v[108:111]
    s_waitcnt vmcnt(6) lgkmcnt(3)
    v_mfma_f32_16x16x32_bf16 v[104:107], v[96:99], v[48:51], v[104:107]
    v_mfma_f32_16x16x32_bf16 v[108:111], v[96:99], v[52:55], v[108:111]
    s_waitcnt vmcnt(4) lgkmcnt(2)
    v_mfma_f32_16x16x32_bf16 v[104:107], v[100:103], v[56:59], v[104:107]
    v_mfma_f32_16x16x32_bf16 v[108:111], v[100:103], v[60:63], v[108:111]
    s_waitcnt vmcnt(2) lgkmcnt(1)
    v_mfma_f32_16x16x32_bf16 v[104:107], v[80:83], v[64:67], v[104:107]
    v_mfma_f32_16x16x32_bf16 v[108:111], v[80:83], v[68:71], v[108:111]
    s_waitcnt vmcnt(0) lgkmcnt(0)
    v_mfma_f32_16x16x32_bf16 v[104:107], v[84:87], v[72:75], v[104:107]
    v_mfma_f32_16x16x32_bf16 v[108:111], v[84:87], v[76:79], v[108:111]
    s_nop 7
    v_cvt_pk_bf16_f32 v104, v104, v108
    buffer_store_dword v104, v8, s[20:23], s60 offen offset:0 sc1
    v_cvt_pk_bf16_f32 v105, v105, v109
    buffer_store_dword v105, v8, s[20:23], s60 offen offset:512 sc1
    v_cvt_pk_bf16_f32 v106, v106, v110
    buffer_store_dword v106, v8, s[20:23], s60 offen offset:1024 sc1
    v_cvt_pk_bf16_f32 v107, v107, v111
    buffer_store_dword v107, v8, s[20:23], s60 offen offset:1536 sc1
    s_add_u32 s60, s60, 8192
    s_mov_b32 s59, 0
Lw_50:
    ds_read_b32 v4, v3 offset:40
    s_waitcnt lgkmcnt(0)
    v_cmp_gt_u32 vcc, 16, v4
    s_cbranch_vccz Lk_51
    s_sleep 3
    s_add_u32 s59, s59, 1
    s_cmp_lt_u32 s59, 16777216
    s_cbranch_scc1 Lw_50
    s_branch L_end
Lk_51:
    ds_read_b128 v[80:83], v12 offset:8448
    ds_read_b128 v[84:87], v12 offset:8512
    ds_read_b128 v[88:91], v12 offset:8576
    ds_read_b128 v[92:95], v12 offset:8640
    ds_read_b128 v[96:99], v12 offset:8704
    ds_read_b128 v[100:103], v12 offset:8768
    s_waitcnt lgkmcnt(5)
    v_mfma_f32_16x16x32_bf16 v[112:115], v[80:83], v[16:19], v[112:115]
    v_mfma_f32_16x16x32_bf16 v[116:119], v[80:83], v[20:23], v[116:119]
    ds_read_b128 v[80:83], v12 offset:8832
    s_waitcnt lgkmcnt(5)
    v_mfma_f32_16x16x32_bf16 v[112:115], v[84:87], v[24:27], v[112:115]
    v_mfma_f32_16x16x32_bf16 v[116:119], v[84:87], v[28:31], v[116:119]
    ds_read_b128 v[84:87], v12 offset:8896
    s_waitcnt lgkmcnt(5)
    v_mfma_f32_16x16x32_bf16 v[112:115], v[88:91], v[32:35], v[112:115]
    v_mfma_f32_16x16x32_bf16 v[116:119], v[88:91], v[36:39], v[116:119]
    s_waitcnt lgkmcnt(4)
    v_mfma_f32_16x16x32_bf16 v[112:115], v[92:95], v[40:43], v[112:115]
    v_mfma_f32_16x16x32_bf16 v[116:119], v[92:95], v[44:47], v[116:119]
    s_waitcnt lgkmcnt(3)
    v_mfma_f32_16x16x32_bf16 v[112:115], v[96:99], v[48:51], v[112:115]
    v_mfma_f32_16x16x32_bf16 v[116:119], v[96:99], v[52:55], v[116:119]
    s_waitcnt lgkmcnt(2)
    v_mfma_f32_16x16x32_bf16 v[112:115], v[100:103], v[56:59], v[112:115]
    v_mfma_f32_16x16x32_bf16 v[116:119], v[100:103], v[60:63], v[116:119]
    s_waitcnt lgkmcnt(1)
    v_mfma_f32_16x16x32_bf16 v[112:115], v[80:83], v[64:67], v[112:115]
    v_mfma_f32_16x16x32_bf16 v[116:119], v[80:83], v[68:71], v[116:119]
    s_waitcnt lgkmcnt(0)
    v_mfma_f32_16x16x32_bf16 v[112:115], v[84:87], v[72:75], v[112:115]
    v_mfma_f32_16x16x32_bf16 v[116:119], v[84:87], v[76:79], v[116:119]
    s_nop 7
    v_cvt_pk_bf16_f32 v112, v112, v116
    buffer_store_dword v112, v8, s[20:23], s60 offen offset:0 sc1
    v_cvt_pk_bf16_f32 v113, v113, v117
    buffer_store_dword v113, v8, s[20:23], s60 offen offset:512 sc1
    v_cvt_pk_bf16_f32 v114, v114, v118
    buffer_store_dword v114, v8, s[20:23], s60 offen offset:1024 sc1
    v_cvt_pk_bf16_f32 v115, v115, v119
    buffer_store_dword v115, v8, s[20:23], s60 offen offset:1536 sc1
    s_add_u32 s60, s60, 8192
    s_mov_b32 s59, 0
Lw_52:
    ds_read_b32 v4, v3 offset:44
    s_waitcnt lgkmcnt(0)
    v_cmp_gt_u32 vcc, 8, v4
    s_cbranch_vccz Lk_53
    s_add_u32 s59, s59, 1
    s_cmp_lt_u32 s59, 16777216
    s_cbranch_scc1 Lw_52
    s_branch L_end
Lk_53:
    ds_read_b128 v[80:83], v12 offset:16896
    ds_read_b128 v[84:87], v12 offset:16960
    ds_read_b128 v[88:91], v12 offset:17024
    ds_read_b128 v[92:95], v12 offset:17088
    ds_read_b128 v[96:99], v12 offset:17152
    ds_read_b128 v[100:103], v12 offset:17216
    s_waitcnt lgkmcnt(5)
    v_mfma_f32_16x16x32_bf16 v[120:123], v[80:83], v[16:19], v[120:123]
    v_mfma_f32_16x16x32_bf16 v[124:127], v[80:83], v[20:23], v[124:127]
    ds_read_b128 v[80:83], v12 offset:17280
    s_waitcnt lgkmcnt(5)
    v_mfma_f32_16x16x32_bf16 v[120:123], v[84:87], v[24:27], v[120:123]
    v_mfma_f32_16x16x32_bf16 v[124:127], v[84:87], v[28:31], v[124:127]
    ds_read_b128 v[84:87], v12 offset:17344
    s_waitcnt lgkmcnt(5)
    v_mfma_f32_16x16x32_bf16 v[120:123], v[88:91], v[32:35], v[120:123]
    v_mfma_f32_16x16x32_bf16 v[124:127], v[88:91], v[36:39], v[124:127]
    s_waitcnt lgkmcnt(4)
    v_mfma_f32_16x16x32_bf16 v[120:123], v[92:95], v[40:43], v[120:123]
    v_mfma_f32_16x16x32_bf16 v[124:127], v[92:95], v[44:47], v[124:127]
    s_waitcnt lgkmcnt(3)
    v_mfma_f32_16x16x32_bf16 v[120:123], v[96:99], v[48:51], v[120:123]
    v_mfma_f32_16x16x32_bf16 v[124:127], v[96:99], v[52:55], v[124:127]
    s_waitcnt lgkmcnt(2)
    v_mfma_f32_16x16x32_bf16 v[120:123], v[100:103], v[56:59], v[120:123]
    v_mfma_f32_16x16x32_bf16 v[124:127], v[100:103], v[60:63], v[124:127]
    s_waitcnt lgkmcnt(1)
    v_mfma_f32_16x16x32_bf16 v[120:123], v[80:83], v[64:67], v[120:123]
    v_mfma_f32_16x16x32_bf16 v[124:127], v[80:83], v[68:71], v[124:127]
    s_waitcnt lgkmcnt(0)
    v_mfma_f32_16x16x32_bf16 v[120:123], v[84:87], v[72:75], v[120:123]
    v_mfma_f32_16x16x32_bf16 v[124:127], v[84:87], v[76:79], v[124:127]
    s_nop 7
    v_cvt_pk_bf16_f32 v120, v120, v124
    buffer_store_dword v120, v9, s[20:23], s60 offen offset:0 sc1
    v_cvt_pk_bf16_f32 v121, v121, v125
    buffer_store_dword v121, v9, s[20:23], s60 offen offset:512 sc1
    v_cvt_pk_bf16_f32 v122, v122, v126
    buffer_store_dword v122, v9, s[20:23], s60 offen offset:1024 sc1
    v_cvt_pk_bf16_f32 v123, v123, v127
    buffer_store_dword v123, v9, s[20:23], s60 offen offset:1536 sc1
L_end:
L_exit:
    s_endpgm
L_slow:
    s_setprio 0
    ds_add_u32 v61, v62 offset:16
    s_mov_b32 s59, 0
Lw_54:
    ds_read_b32 v4, v3 offset:16
    s_waitcnt lgkmcnt(0)
    v_cmp_gt_u32 vcc, 8, v4
    s_cbranch_vccz Lk_55
    s_add_u32 s59, s59, 1
    s_cmp_lt_u32 s59, 4194304
    s_cbranch_scc1 Lw_54
    s_branch L_end
Lk_55:
    v_mov_b32 v12, v3
    s_mov_b64 s[24:25], s[34:35]
    s_mov_b32 s26, 640000
    s_mov_b64 s[28:29], s[36:37]
    s_mov_b32 s30, 640000
    s_mov_b64 s[12:13], s[42:43]
    s_mov_b32 s14, 20000
    s_mov_b32 s15, 0x20000
    s_sub_u32 s63, s67, 1
    s_mov_b32 s65, 201486528
    s_mov_b32 s64, 0
    s_call_b64 s[68:69], L_flush
    s_add_u32 s66, s4, s5
    s_add_u32 s67, s66, 40
    v_lshlrev_b32 v16, 2, v0
    v_and_b32 v17, 32, v0
    v_lshl_add_u32 v17, v17, 22, v2
    v_mov_b32 v24, 0
L_sn:
    s_mov_b32 s60, 0
L_sc:
    buffer_load_dword v18, v16, s[28:31], s60 offen
    buffer_load_dword v19, v16, s[24:27], s60 offen
    s_waitcnt vmcnt(0)
    v_cmp_eq_u32 vcc, s66, v18
    s_cbranch_vccz L_sx
L_se:
    s_ff1_i32_b64 s58, vcc
    s_bitset0_b64 vcc, s58
    v_readlane_b32 s59, v19, s58
    s_nop 0
    s_lshl_b32 s61, s59, 9
    s_lshl_b32 s59, s59, 1
    buffer_load_dwordx4 v[20:23], v17, s[8:11], s61 offen
    buffer_load_ushort v1, v24, s[12:15], s59 offen
    s_waitcnt vmcnt(0)
    v_perm_b32 v6, v1, v1, v10
    v_perm_b32 v7, v1, v1, v11
    s_nop 1
    v_mfma_f32_4x4x4_16b_bf16 v[56:59], v[6:7], v[20:21], v[56:59]
    v_mfma_f32_4x4x4_16b_bf16 v[60:63], v[6:7], v[22:23], v[60:63]
    s_cmp_lg_u64 vcc, 0
    s_cbranch_scc1 L_se
L_sx:
    s_add_u32 s60, s60, 256
    s_cmp_lt_u32 s60, 640000
    s_cbranch_scc1 L_sc
    s_call_b64 s[68:69], L_flush
    s_add_u32 s66, s66, 8
    s_cmp_lt_u32 s66, s67
    s_cbranch_scc1 L_sn
    s_branch L_gdone
.section .rodata,"a"
.p2align 6
.amdhsa_kernel standalone__hybrid_graph_tf_exphormer__graph_kernel
  .amdhsa_next_free_vgpr 128
  .amdhsa_next_free_sgpr 102
  .amdhsa_accum_offset 128
  .amdhsa_group_segment_fixed_size 0
  .amdhsa_kernarg_size 104
  .amdhsa_user_sgpr_count 2
  .amdhsa_user_sgpr_kernarg_segment_ptr 1
  .amdhsa_system_sgpr_workgroup_id_x 1
.end_amdhsa_kernel
```

```asm
; @launch grid=(250,1,1) block=(1024,1,1) lds=161984
.amdgcn_target "amdgcn-amd-amdhsa--gfx950"
.text
.globl standalone__hybrid_graph_tf_exphormer__graph_kernel
.p2align 8
.type standalone__hybrid_graph_tf_exphormer__graph_kernel,@function
standalone__hybrid_graph_tf_exphormer__graph_kernel:
    s_cmp_ge_u32 s2, 250
    s_cbranch_scc1 L_exit
    s_load_dwordx16 s[32:47], s[0:1], 0
    s_load_dwordx8 s[48:55], s[0:1], 64
    s_load_dwordx2 s[56:57], s[0:1], 96
    s_getpc_b64 s[60:61]
    s_lshr_b32 s6, s2, 3
    v_lshl_add_u32 v1, v0, 5, s6
    v_cmp_gt_u32 vcc, 85, v1
    v_lshlrev_b32 v1, 7, v1
    s_and_saveexec_b64 s[58:59], vcc
    s_cbranch_execz L_nopf
    global_load_dword v15, v1, s[60:61]
L_nopf:
    s_mov_b64 exec, -1
    v_lshrrev_b32 v1, 6, v0
    v_mov_b32 v8, 33554432
    v_readfirstlane_b32 s3, v1
    v_cmp_gt_u32 vcc, 288, v0
    v_lshlrev_b32 v5, 4, v0
    v_add_u32 v4, 152064, v5
    v_cndmask_b32 v8, 0, v8, vcc
    v_mov_b32 v9, v8
    v_mov_b64 v[10:11], v[8:9]
    v_cmp_gt_u32 vcc, 556, v0
    s_and_saveexec_b64 s[58:59], vcc
    ds_write_b128 v4, v[8:11]
    s_mov_b64 exec, -1
    v_and_b32 v0, 63, v0
    v_and_b32 v2, 31, v0
    v_lshlrev_b32 v2, 4, v2
    s_and_b32 s59, s2, 7
    s_mul_i32 s60, s59, 31
    s_min_u32 s59, s59, 2
    s_add_u32 s6, s6, s60
    s_add_u32 s6, s6, s59
    s_mov_b32 s27, 0x20000
    s_mov_b32 s31, 0x20000
    s_xor_b32 s3, s3, 8
    s_and_b32 s4, s3, 7
    s_cmp_lt_u32 s3, 8
    s_cbranch_scc1 L_e3
    s_setprio 3
    s_cmp_ge_u32 s2, 64
    s_cbranch_scc1 L_e1
    v_lshrrev_b32 v6, 2, v5
    s_mul_i32 s58, s2, 10000
    s_add_u32 s60, s58, 8192
    s_mov_b32 s26, 640000
    s_mov_b32 s30, 640000
    s_mov_b32 s59, 1048576
    s_mov_b32 s63, 1
    s_waitcnt lgkmcnt(0)
    s_mov_b64 s[28:29], s[36:37]
    s_mov_b64 s[24:25], s[34:35]
    buffer_load_dwordx4 v[22:25], v5, s[28:31], s58 offen
    buffer_load_dword v26, v6, s[28:31], s60 offen
    s_setprio 2
    buffer_load_dwordx4 v[16:19], v5, s[24:27], s58 offen
    buffer_load_dword v20, v6, s[24:27], s60 offen
    s_setprio 3
L_ep:
    s_load_dword s40, s[56:57], s59
    s_branch L_bar
L_e1:
    s_mov_b32 s26, 131072
    s_sub_u32 s60, s3, 9
    s_cmp_lt_u32 s60, 3
    s_cbranch_scc1 L_e1b
    s_mov_b32 s63, 0
    s_cmp_eq_u32 s3, 8
    s_cbranch_scc0 L_barw
    s_mov_b32 s63, 5
    s_mov_b32 s59, 1048576
    s_waitcnt lgkmcnt(0)
    s_branch L_ep
L_e1b:
    s_sub_u32 s62, s2, 64
    s_cmp_ge_u32 s62, 128
    s_cbranch_scc1 L_e2
    s_and_b32 s58, s62, 7
    s_lshr_b32 s59, s62, 4
    s_bfe_u32 s61, s62, 0x10003
    s_cmp_eq_u32 s60, 2
    s_cselect_b32 s58, s59, s58
    s_cselect_b32 s61, s61, s60
    s_lshl_b32 s58, s58, 14
    s_lshl_b32 s61, s61, 11
    s_add_u32 s58, s58, s61
    s_add_u32 s59, s58, 4096
    v_and_b32 v4, 32, v0
    v_lshl_add_u32 v4, v4, 8, v2
    s_mul_i32 s61, s60, 8448
    s_add_u32 m0, s61, 105600
    s_cmp_eq_u32 s60, 0
    s_cselect_b32 s63, 2, 3
    s_cmp_eq_u32 s60, 2
    s_waitcnt lgkmcnt(0)
    s_cselect_b64 s[24:25], s[48:49], s[46:47]
    buffer_load_dwordx4 v4, s[24:27], s58 offen offset:0 lds
    s_add_u32 m0, m0, 544
    s_nop 0
    buffer_load_dwordx4 v4, s[24:27], s58 offen offset:512 lds
    s_add_u32 m0, m0, 544
    s_nop 0
    buffer_load_dwordx4 v4, s[24:27], s58 offen offset:1024 lds
    s_add_u32 m0, m0, 544
    s_nop 0
    buffer_load_dwordx4 v4, s[24:27], s58 offen offset:1536 lds
    s_add_u32 m0, m0, 2592
    s_nop 0
    buffer_load_dwordx4 v4, s[24:27], s59 offen offset:0 lds
    s_add_u32 m0, m0, 544
    s_nop 0
    buffer_load_dwordx4 v4, s[24:27], s59 offen offset:512 lds
    s_add_u32 m0, m0, 544
    s_nop 0
    buffer_load_dwordx4 v4, s[24:27], s59 offen offset:1024 lds
    s_add_u32 m0, m0, 544
    s_nop 0
    buffer_load_dwordx4 v4, s[24:27], s59 offen offset:1536 lds
    s_branch L_bar
L_e2:
    s_mul_i32 s60, s60, 58
    s_add_u32 s62, s62, s60
    s_sub_u32 s62, s62, 128
    s_mov_b32 s63, 3
    s_cmp_ge_u32 s62, 128
    s_cbranch_scc1 L_barw
    s_mov_b32 s63, 4
    s_and_b32 s59, s62, 7
    s_lshl_b32 s59, s59, 14
    s_bfe_u32 s60, s62, 0x30003
    s_lshl_b32 s60, s60, 6
    s_add_u32 s59, s59, s60
    v_and_b32 v4, 15, v0
    v_lshlrev_b32 v4, 2, v4
    v_and_b32 v5, 48, v0
    v_lshl_add_u32 v4, v5, 8, v4
    s_cmp_lt_u32 s62, 64
    s_waitcnt lgkmcnt(0)
    s_cselect_b64 s[24:25], s[50:51], s[44:45]
    buffer_load_dword v16, v4, s[24:27], s59 offen offset:0
    buffer_load_dword v17, v4, s[24:27], s59 offen offset:512
    buffer_load_dword v18, v4, s[24:27], s59 offen offset:1024
    buffer_load_dword v19, v4, s[24:27], s59 offen offset:1536
    buffer_load_dword v20, v4, s[24:27], s59 offen offset:2048
    buffer_load_dword v21, v4, s[24:27], s59 offen offset:2560
    buffer_load_dword v22, v4, s[24:27], s59 offen offset:3072
    buffer_load_dword v23, v4, s[24:27], s59 offen offset:3584
    s_branch L_bar
L_e3:
    s_mul_i32 s58, s6, 640
    s_lshl_b32 s59, s3, 6
    s_add_u32 s59, s59, s58
    s_lshr_b32 s60, s3, 2
    s_lshl_b32 s60, s60, 6
    s_and_b32 s61, s3, 3
    s_lshl_b32 s61, s61, 3
    s_add_u32 s60, s60, s61
    s_add_u32 s60, s60, s58
    s_add_u32 s60, s60, 512
    s_add_u32 s61, s60, 32
    s_waitcnt lgkmcnt(0)
    s_mov_b64 s[62:63], s[38:39]
    s_mov_b64 s[8:9], s[32:33]
    s_load_dwordx16 s[32:47], s[62:63], s59
    s_load_dwordx2 s[64:65], s[62:63], s60
    s_load_dwordx2 s[66:67], s[62:63], s61
    s_barrier
    s_branch L_preA
L_barw:
    s_waitcnt lgkmcnt(0)
L_bar:
    s_barrier
    s_mov_b64 s[8:9], s[32:33]
    s_mul_i32 s5, s6, 40
    v_mov_b32 v3, 159296
    s_mov_b32 s10, 5120000
    s_mov_b32 s11, 0x20000
    s_mov_b64 s[16:17], s[56:57]
    s_mov_b32 s18, 1441792
    s_mov_b32 s19, 0x20000
    v_min_u32 v4, 1, v0
    v_lshl_add_u32 v61, v0, 2, v3
    v_lshl_add_u32 v61, v4, 16, v61
    v_mov_b32 v62, 1
    s_cmp_eq_u32 s63, 1
    s_cbranch_scc0 L_notprod
    v_mov_b32 v9, 4
    v_mov_b32 v10, 159936
    v_lshl_add_u32 v11, v0, 4, v10
    v_cmp_gt_u32 vcc, 7232, v5
    v_add_u32 v59, 105600, v5
    s_mul_i32 s58, s2, 10240
    s_mov_b64 s[66:67], vcc
    s_waitcnt vmcnt(3)
    v_mul_u32_u24 v28, 52429, v22
    v_lshrrev_b32 v28, 21, v28
    v_lshl_add_u32 v28, v28, 2, v10
    ds_add_rtn_u32 v34, v28, v9
    v_mul_u32_u24 v29, 52429, v23
    v_lshrrev_b32 v29, 21, v29
    v_lshl_add_u32 v29, v29, 2, v10
    ds_add_rtn_u32 v35, v29, v9
    v_mul_u32_u24 v30, 52429, v24
    v_lshrrev_b32 v30, 21, v30
    v_lshl_add_u32 v30, v30, 2, v10
    ds_add_rtn_u32 v36, v30, v9
    v_mul_u32_u24 v31, 52429, v25
    v_lshrrev_b32 v31, 21, v31
    v_lshl_add_u32 v31, v31, 2, v10
    ds_add_rtn_u32 v37, v31, v9
    s_waitcnt vmcnt(2)
    s_mov_b64 exec, s[66:67]
    v_mul_u32_u24 v32, 52429, v26
    v_lshrrev_b32 v32, 21, v32
    v_lshl_add_u32 v32, v32, 2, v10
    ds_add_rtn_u32 v38, v32, v9
    s_mov_b64 exec, -1
    s_waitcnt lgkmcnt(0)
    s_barrier
    ds_read_b128 v[12:15], v11
    s_add_u32 s40, s40, 4096
    s_and_b32 s40, s40, 4294963200
    s_waitcnt lgkmcnt(0)
    v_add_u32 v56, v12, v13
    v_add3_u32 v57, v56, v14, v15
    s_nop 1
    v_add_u32_dpp v58, v57, v57 row_shr:1 row_mask:0xf bank_mask:0xf bound_ctrl:1
    s_nop 1
    v_add_u32_dpp v58, v58, v58 row_shr:2 row_mask:0xf bank_mask:0xf bound_ctrl:1
    s_nop 1
    v_add_u32_dpp v58, v58, v58 row_shr:4 row_mask:0xf bank_mask:0xf bound_ctrl:1
    s_nop 1
    v_add_u32_dpp v58, v58, v58 row_shr:8 row_mask:0xf bank_mask:0xf bound_ctrl:1
    s_nop 1
    v_add_u32_dpp v58, v58, v58 row_bcast:15 row_mask:0xa bank_mask:0xf
    s_nop 1
    v_add_u32_dpp v58, v58, v58 row_bcast:31 row_mask:0xc bank_mask:0xf
    v_sub_u32 v64, v58, v57
    v_add_u32 v65, v64, v12
    v_add_u32 v66, v64, v56
    v_add_u32 v67, v66, v14
    ds_write_b128 v11, v[64:67] offset:1024
    ds_read_b32 v40, v28 offset:1024
    ds_read_b32 v41, v29 offset:1024
    ds_read_b32 v42, v30 offset:1024
    ds_read_b32 v43, v31 offset:1024
    s_mov_b64 exec, s[66:67]
    ds_read_b32 v44, v32 offset:1024
    s_mov_b64 exec, -1
    s_mov_b32 s60, 105600
    s_waitcnt vmcnt(0)
    v_lshl_or_b32 v16, v22, 16, v16
    v_lshl_or_b32 v17, v23, 16, v17
    v_lshl_or_b32 v18, v24, 16, v18
    v_lshl_or_b32 v19, v25, 16, v19
    v_lshl_or_b32 v20, v26, 16, v20
    s_waitcnt lgkmcnt(4)
    v_add3_u32 v40, v40, v34, s60
    ds_write_b32 v40, v16
    s_waitcnt lgkmcnt(4)
    v_add3_u32 v41, v41, v35, s60
    ds_write_b32 v41, v17
    s_waitcnt lgkmcnt(4)
    v_add3_u32 v42, v42, v36, s60
    ds_write_b32 v42, v18
    s_waitcnt lgkmcnt(4)
    v_add3_u32 v43, v43, v37, s60
    ds_write_b32 v43, v19
    s_mov_b64 exec, s[66:67]
    s_waitcnt lgkmcnt(4)
    v_add3_u32 v44, v44, v38, s60
    ds_write_b32 v44, v20
    s_mov_b64 exec, -1
    v_lshrrev_b32 v64, 2, v64
    v_or_b32 v64, s40, v64
    v_lshrrev_b32 v65, 2, v65
    v_or_b32 v65, s40, v65
    v_lshrrev_b32 v66, 2, v66
    v_or_b32 v66, s40, v66
    v_lshrrev_b32 v67, 2, v67
    v_or_b32 v67, s40, v67
    s_waitcnt lgkmcnt(0)
    s_barrier
    ds_read_b128 v[12:15], v59
    ds_read_b128 v[68:71], v59 offset:8192
    s_add_u32 s60, s58, 8192
    s_cmp_ge_u32 s4, 2
    s_waitcnt lgkmcnt(1)
    buffer_store_dwordx4 v[12:15], v5, s[16:19], s58 offen sc1
    s_cbranch_scc1 L_cp1
    s_waitcnt lgkmcnt(0)
    buffer_store_dwordx4 v[68:71], v5, s[16:19], s60 offen sc1
L_cp1:
    s_waitcnt vmcnt(0)
    ds_add_u32 v61, v62 offset:56
    s_cmp_eq_u32 s4, 0
    s_cbranch_scc0 L_preB
    s_lshl_b32 s61, s2, 10
    s_add_u32 s61, s61, 1114112
    s_or_b32 s60, s40, 1
    v_mov_b32 v8, s60
    s_mov_b32 s59, 0
Lw_1:
    ds_read_b32 v4, v3 offset:56
    s_waitcnt lgkmcnt(0)
    v_cmp_gt_u32 vcc, 8, v4
    s_cbranch_vccz Lk_2
    s_add_u32 s59, s59, 1
    s_cmp_lt_u32 s59, 4194304
    s_cbranch_scc1 Lw_1
    s_branch L_end
Lk_2:
    buffer_store_dwordx4 v[64:67], v5, s[16:19], s61 offen sc1
    ds_write_b32 v3, v8 offset:32
    s_branch L_preB
L_notprod:
    s_cmp_eq_u32 s63, 0
    s_cbranch_scc1 L_preB
    s_cmp_eq_u32 s63, 3
    s_cbranch_scc1 L_taskw
    s_cmp_eq_u32 s63, 4
    s_cbranch_scc1 L_wtask
    s_cmp_eq_u32 s63, 5
    s_cbranch_scc1 L_flag
    v_and_b32 v4, 7, v0
    v_mul_u32_u24 v1, 1056, v4
    v_and_b32 v4, 8, v0
    v_lshl_add_u32 v1, v4, 6, v1
    v_and_b32 v4, 48, v0
    v_add_u32 v1, v4, v1
    v_add_u32 v5, 105600, v1
    s_lshr_b32 s58, s62, 4
    s_lshl_b32 s58, s58, 3
    s_and_b32 s59, s62, 7
    s_add_u32 s58, s58, s59
    s_lshl_b32 s58, s58, 1
    s_bfe_u32 s59, s62, 0x10003
    s_add_u32 s58, s58, s59
    s_lshl_b32 s58, s58, 10
    s_add_u32 s58, s58, 655360
    v_lshlrev_b32 v6, 4, v0
    s_waitcnt vmcnt(0)
    s_mov_b32 s59, 0
Lw_3:
    ds_read_b32 v4, v3 offset:56
    s_waitcnt lgkmcnt(0)
    v_cmp_gt_u32 vcc, 2, v4
    s_cbranch_vccz Lk_4
    s_add_u32 s59, s59, 1
    s_cmp_lt_u32 s59, 4194304
    s_cbranch_scc1 Lw_3
    s_branch L_end
Lk_4:
    ds_read_b128 v[16:19], v5 offset:0
    ds_read_b128 v[20:23], v5 offset:8448
    ds_read_b128 v[24:27], v5 offset:16896
    ds_read_b128 v[28:31], v5 offset:64
    ds_read_b128 v[32:35], v5 offset:8512
    ds_read_b128 v[36:39], v5 offset:16960
    ds_read_b128 v[40:43], v5 offset:128
    ds_read_b128 v[44:47], v5 offset:8576
    ds_read_b128 v[48:51], v5 offset:17024
    ds_read_b128 v[64:67], v5 offset:192
    ds_read_b128 v[68:71], v5 offset:8640
    ds_read_b128 v[72:75], v5 offset:17088
    s_waitcnt lgkmcnt(9)
    ds_read_b128 v[76:79], v5 offset:256
    ds_read_b128 v[80:83], v5 offset:8704
    ds_read_b128 v[84:87], v5 offset:17152
    v_mfma_f32_16x16x32_bf16 v[8:11], v[16:19], v[24:27], 0
    v_mfma_f32_16x16x32_bf16 v[12:15], v[20:23], v[24:27], 0
    s_waitcnt lgkmcnt(9)
    ds_read_b128 v[88:91], v5 offset:320
    ds_read_b128 v[92:95], v5 offset:8768
    ds_read_b128 v[96:99], v5 offset:17216
    v_mfma_f32_16x16x32_bf16 v[8:11], v[28:31], v[36:39], v[8:11]
    v_mfma_f32_16x16x32_bf16 v[12:15], v[32:35], v[36:39], v[12:15]
    s_waitcnt lgkmcnt(9)
    ds_read_b128 v[100:103], v5 offset:384
    ds_read_b128 v[104:107], v5 offset:8832
    ds_read_b128 v[108:111], v5 offset:17280
    v_mfma_f32_16x16x32_bf16 v[8:11], v[40:43], v[48:51], v[8:11]
    v_mfma_f32_16x16x32_bf16 v[12:15], v[44:47], v[48:51], v[12:15]
    s_waitcnt lgkmcnt(9)
    ds_read_b128 v[112:115], v5 offset:448
    ds_read_b128 v[116:119], v5 offset:8896
    ds_read_b128 v[120:123], v5 offset:17344
    v_mfma_f32_16x16x32_bf16 v[8:11], v[64:67], v[72:75], v[8:11]
    v_mfma_f32_16x16x32_bf16 v[12:15], v[68:71], v[72:75], v[12:15]
    s_waitcnt lgkmcnt(9)
    v_mfma_f32_16x16x32_bf16 v[8:11], v[76:79], v[84:87], v[8:11]
    v_mfma_f32_16x16x32_bf16 v[12:15], v[80:83], v[84:87], v[12:15]
    s_waitcnt lgkmcnt(6)
    v_mfma_f32_16x16x32_bf16 v[8:11], v[88:91], v[96:99], v[8:11]
    v_mfma_f32_16x16x32_bf16 v[12:15], v[92:95], v[96:99], v[12:15]
    s_waitcnt lgkmcnt(3)
    v_mfma_f32_16x16x32_bf16 v[8:11], v[100:103], v[108:111], v[8:11]
    v_mfma_f32_16x16x32_bf16 v[12:15], v[104:107], v[108:111], v[12:15]
    s_waitcnt lgkmcnt(0)
    v_mfma_f32_16x16x32_bf16 v[8:11], v[112:115], v[120:123], v[8:11]
    v_mfma_f32_16x16x32_bf16 v[12:15], v[116:119], v[120:123], v[12:15]
    s_nop 6
    v_cvt_pk_bf16_f32 v16, v8, v9
    v_cvt_pk_bf16_f32 v17, v10, v11
    v_cvt_pk_bf16_f32 v18, v12, v13
    v_cvt_pk_bf16_f32 v19, v14, v15
    buffer_store_dwordx4 v[16:19], v6, s[16:19], s58 offen sc1
    s_branch L_taskw
L_wtask:
    s_lshl_b32 s58, s62, 11
    s_add_u32 s58, s58, 786432
    v_lshlrev_b32 v6, 4, v0
    s_mov_b32 s70, 0x05040100
    s_mov_b32 s71, 0x07060302
    s_waitcnt vmcnt(0)
    v_perm_b32 v64, v17, v16, s70
    v_perm_b32 v68, v17, v16, s71
    v_perm_b32 v65, v19, v18, s70
    v_perm_b32 v69, v19, v18, s71
    v_perm_b32 v66, v21, v20, s70
    v_perm_b32 v70, v21, v20, s71
    v_perm_b32 v67, v23, v22, s70
    v_perm_b32 v71, v23, v22, s71
    buffer_store_dwordx4 v[64:67], v6, s[16:19], s58 offen sc1
    buffer_store_dwordx4 v[68:71], v6, s[16:19], s58 offen offset:1024 sc1
L_taskw:
    s_waitcnt vmcnt(0)
    ds_add_u32 v61, v62 offset:56
    s_branch L_preB
L_flag:
    s_waitcnt vmcnt(0) lgkmcnt(0)
    s_add_u32 s40, s40, 4096
    s_and_b32 s40, s40, 4294963200
    s_mul_i32 s61, s2, 16
    s_add_u32 s61, s61, 1178624
    s_or_b32 s60, s40, 1
    v_mov_b32 v8, s60
    v_mov_b32 v10, s40
    v_mov_b32 v11, s40
    v_lshlrev_b32 v9, 15, v0
    s_mov_b32 s59, 0
Lw_5:
    ds_read_b32 v4, v3 offset:56
    s_waitcnt lgkmcnt(0)
    v_cmp_gt_u32 vcc, 3, v4
    s_cbranch_vccz Lk_6
    s_add_u32 s59, s59, 1
    s_cmp_lt_u32 s59, 4194304
    s_cbranch_scc1 Lw_5
    s_branch L_end
Lk_6:
    s_mov_b64 exec, 255
    buffer_store_dwordx2 v[10:11], v9, s[16:19], s61 offen sc1
    ds_write_b32 v3, v8 offset:32
    s_mov_b64 exec, -1
L_preB:
    s_setprio 3
    s_mov_b64 s[28:29], s[42:43]
    s_mov_b32 s30, 20000
    s_setprio 3
    s_lshl_b32 s58, s4, 10
    v_lshlrev_b32 v5, 4, v0
    s_add_u32 m0, s58, 130944
    s_add_u32 s59, s58, 0
    buffer_load_dwordx4 v5, s[28:31], s59 offen lds
    s_add_u32 m0, s58, 139136
    s_add_u32 s59, s58, 8192
    buffer_load_dwordx4 v5, s[28:31], s59 offen lds
    s_cmp_lt_u32 s4, 4
    s_cbranch_scc1 L_disd
    s_add_u32 m0, s58, 143232
    s_add_u32 s59, s58, 12288
    buffer_load_dwordx4 v5, s[28:31], s59 offen lds
L_disd:
    s_setprio 3
    v_and_b32 v4, 3, v0
    v_mov_b32 v5, 0x0c0c0c0c
    v_mov_b32 v6, 0x0c0c0302
    v_mov_b32 v7, 0x03020c0c
    v_cmp_eq_u32 s[58:59], 0, v4
    v_cmp_eq_u32 s[60:61], 2, v4
    v_cmp_eq_u32 vcc, 1, v4
    v_cndmask_b32 v10, v5, v6, s[58:59]
    v_cndmask_b32 v11, v5, v6, s[60:61]
    v_cndmask_b32 v10, v10, v7, vcc
    v_cmp_eq_u32 vcc, 3, v4
    s_nop 1
    v_cndmask_b32 v11, v11, v7, vcc
    v_and_b32 v10, 0xfdfdfdfd, v10
    v_and_b32 v11, 0xfdfdfdfd, v11
    s_movk_i32 s7, 512
    s_lshl_b32 s58, s4, 3
    v_lshrrev_b32 v5, 3, v0
    v_and_b32 v6, 7, v0
    v_add_u32 v7, s58, v5
    v_mul_u32_u24 v49, 10240, v7
    v_lshl_add_u32 v49, v6, 4, v49
    v_lshlrev_b32 v56, 2, v6
    s_lshl_b32 s60, s6, 2
    s_add_u32 s60, s60, 1114112
    v_lshl_add_u32 v54, v7, 10, s60
    v_mad_u32_u24 v7, v7, 3, v6
    v_cmp_ge_u32 vcc, 186, v7
    v_cmp_gt_u32 s[64:65], 4, v6
    v_mul_u32_u24 v7, 16, v7
    s_and_b64 s[64:65], s[64:65], vcc
    v_cmp_eq_u32 vcc, 0, v6
    s_and_b32 s58, s2, 7
    s_lshl_b32 s58, s58, 15
    s_add_u32 s58, s58, 1179632
    v_add_u32 v7, s58, v7
    s_or_b64 s[64:65], s[64:65], vcc
    v_cndmask_b32 v54, v7, v54, vcc
    v_cmp_gt_u32 s[62:63], 5, v6
    v_lshl_add_u32 v50, v6, 3, v5
    v_mul_u32_u24 v55, 72, v5
    v_add_u32 v55, 72, v55
    v_lshrrev_b32 v5, 4, v50
    v_mul_u32_u24 v9, 8448, v5
    v_lshl_add_u32 v9, v5, 26, v9
    v_cmp_le_u32 vcc, 32, v50
    v_and_b32 v5, 7, v50
    v_and_b32 v6, 3, v50
    v_cndmask_b32 v5, v5, v6, vcc
    v_mul_u32_u24 v5, 1056, v5
    v_bfe_u32 v6, v50, 3, 1
    v_bfe_u32 v7, v50, 2, 1
    v_cndmask_b32 v6, v6, v7, vcc
    v_lshl_add_u32 v5, v6, 9, v5
    v_mov_b32 v52, 130944
    v_add3_u32 v9, v9, v5, v52
    v_lshrrev_b32 v5, 5, v0
    v_lshl_add_u32 v15, v5, 3, v2
    s_lshl_b32 s58, s5, 2
    s_sub_u32 s58, 158976, s58
    v_mov_b32 v53, s58
    v_add_u32 v5, s5, v50
    v_lshl_add_u32 v8, v5, 1, v52
    v_lshlrev_b32 v50, 2, v50
    v_add_u32 v50, 158976, v50
    v_mov_b32 v57, 156672
    v_mov_b32 v60, 152064
    v_mov_b64 v[16:17], 0
    v_mov_b64 v[18:19], 0
    s_mov_b32 s59, 0
Lw_7:
    ds_read_b32 v4, v3 offset:60
    s_waitcnt lgkmcnt(0)
    v_cmp_gt_u32 vcc, 8, v4
    s_cbranch_vccz Lk_8
    s_sleep 2
    s_add_u32 s59, s59, 1
    s_cmp_lt_u32 s59, 4194304
    s_cbranch_scc1 Lw_7
    s_branch L_end
Lk_8:
    s_mov_b32 s59, 0
Lw_9:
    ds_read_b32 v4, v3 offset:32
    s_waitcnt lgkmcnt(0)
    v_cmp_gt_u32 vcc, 1, v4
    s_cbranch_vccz Lk_10
    s_sleep 1
    s_add_u32 s59, s59, 1
    s_cmp_lt_u32 s59, 4194304
    s_cbranch_scc1 Lw_9
    s_branch L_end
Lk_10:
    v_readfirstlane_b32 s40, v4
    s_mov_b32 s59, 0
    s_bitset0_b32 s40, 0
    s_and_b32 exec_lo, s64, 0xfefefefe
    s_and_b32 exec_hi, s65, 0xfefefefe
L_spolla:
    buffer_load_dwordx2 v[58:59], v54, s[16:19], 0 offen sc1
    s_add_u32 s59, s59, 1
    s_cmp_gt_u32 s59, 0x40000
    s_cbranch_scc1 L_end
    s_waitcnt vmcnt(0)
    v_xor_b32 v58, s40, v58
    v_xor_b32 v59, s40, v59
    v_or_b32 v5, v58, v59
    v_cmpx_lt_u32 vcc, 4095, v5
    s_cbranch_execz L_soka
    s_sleep 8
    s_branch L_spolla
L_soka:
    s_mov_b64 exec, -1
    ds_add_u32 v61, v62 offset:52
    s_mov_b32 exec_lo, 0x01010101
    s_mov_b32 exec_hi, 0x01010101
L_spollb:
    buffer_load_dwordx2 v[58:59], v54, s[16:19], 0 offen sc1
    s_add_u32 s59, s59, 1
    s_cmp_gt_u32 s59, 0x40000
    s_cbranch_scc1 L_end
    s_waitcnt vmcnt(0)
    v_xor_b32 v58, s40, v58
    v_xor_b32 v59, s40, v59
    v_or_b32 v5, v58, v59
    v_cmpx_lt_u32 vcc, 4095, v5
    s_cbranch_execz L_sokb
    s_sleep 8
    s_branch L_spollb
L_sokb:
    s_mov_b64 exec, -1
    v_sub_u32 v48, v59, v58
    v_lshl_or_b32 v48, v48, 16, v58
    s_nop 1
    v_mov_b32_dpp v48, v48 quad_perm:[0,0,0,0] row_mask:0xf bank_mask:0xf
    s_nop 1
    v_mov_b32_dpp v48, v48 row_shr:4 row_mask:0xf bank_mask:0xa
    v_mad_u32_u16 v49, v48, 4, v49
    v_lshrrev_b32 v48, 16, v48
    v_sub_u32 v48, v48, v56
    v_cmpx_lt_i32 vcc, 0, v48
    s_cbranch_execz L_entld
    buffer_load_dwordx4 v[16:19], v49, s[16:19], 0 offen sc1
    v_cmpx_lt_i32 vcc, 32, v48
    ds_write_b32 v3, v62 offset:28
L_entld:
    s_mov_b64 exec, -1
    s_waitcnt vmcnt(0)
    v_cmpx_lt_i32 vcc, 0, v48
    v_mad_u32_u16 v24, v16, 4, v53 op_sel:[1,0,0,0]
    ds_add_rtn_u32 v32, v24, v62
    v_cmpx_lt_i32 vcc, 1, v48
    v_mad_u32_u16 v25, v17, 4, v53 op_sel:[1,0,0,0]
    ds_add_rtn_u32 v33, v25, v62
    v_cmpx_lt_i32 vcc, 2, v48
    v_mad_u32_u16 v26, v18, 4, v53 op_sel:[1,0,0,0]
    ds_add_rtn_u32 v34, v26, v62
    v_cmpx_lt_i32 vcc, 3, v48
    v_mad_u32_u16 v27, v19, 4, v53 op_sel:[1,0,0,0]
    ds_add_rtn_u32 v35, v27, v62
    s_mov_b64 exec, -1
    ds_add_u32 v61, v62 offset:12
    v_mad_u32_u16 v40, v16, 2, v52
    v_mad_u32_u16 v16, v16, s7, 0
    v_mad_u32_u16 v41, v17, 2, v52
    v_mad_u32_u16 v17, v17, s7, 0
    v_mad_u32_u16 v42, v18, 2, v52
    v_mad_u32_u16 v18, v18, s7, 0
    v_mad_u32_u16 v43, v19, 2, v52
    v_mad_u32_u16 v19, v19, s7, 0
    s_mov_b32 s59, 0
Lw_11:
    ds_read_b32 v4, v3 offset:12
    s_waitcnt lgkmcnt(0)
    v_cmp_gt_u32 vcc, 8, v4
    s_cbranch_vccz Lk_12
    s_add_u32 s59, s59, 1
    s_cmp_lt_u32 s59, 4194304
    s_cbranch_scc1 Lw_11
    s_branch L_end
Lk_12:
    ds_read_b32 v12, v50
    ds_read_b32 v5, v3 offset:28
    ds_read_u16 v8, v8
    ds_read_u16 v40, v40
    ds_read_u16 v41, v41
    ds_read_u16 v42, v42
    ds_read_u16 v43, v43
    s_lshl_b32 s58, s2, 4
    s_add_u32 s58, s58, s3
    s_cmp_eq_u32 s58, 15
    s_cbranch_scc0 L_noep
    v_mov_b32 v6, s40
    v_mov_b32 v7, 1048576
    s_mov_b64 exec, 1
    buffer_store_dword v6, v7, s[16:19], 0 offen sc1
    s_mov_b64 exec, -1
L_noep:
    s_waitcnt lgkmcnt(6)
    v_add_u32 v12, 1, v12
    v_lshrrev_b32 v12, 1, v12
    v_max_u32 v12, 1, v12
    v_cndmask_b32 v12, 0, v12, s[62:63]
    s_lshl_b32 s67, s4, 3
    s_movk_i32 s58, 2304
    v_add_u32_dpp v51, v12, v12 row_shl:1 row_mask:0xf bank_mask:0xf bound_ctrl:1
    s_nop 1
    v_add_u32_dpp v51, v51, v51 row_shl:2 row_mask:0xf bank_mask:0xf bound_ctrl:1
    s_nop 1
    v_add_u32_dpp v51, v12, v51 row_shl:4 row_mask:0xf bank_mask:0x5 bound_ctrl:1
    s_waitcnt lgkmcnt(0)
    v_lshlrev_b32 v8, 16, v8
    v_lshl_add_u32 v5, v5, 10, v51
    v_sub_u32 v6, v55, v51
    v_cmp_le_u32 vcc, 72, v5
    v_lshlrev_b32 v6, 1, v6
    v_subrev_u32 v12, 1, v12
    s_cbranch_vccnz L_slow
    v_and_b32 v12, 0xff, v12
    v_lshl_add_u32 v9, v12, 18, v9
    s_mov_b64 exec, s[62:63]
    ds_write_b32 v50, v6 offset:160
    s_mov_b64 exec, -1
    s_sub_u32 s63, s67, 1
    v_readlane_b32 s67, v51, s67
    v_cmpx_lt_i32 vcc, 0, v48
    ds_read_b32 v24, v24 offset:160
    v_cmpx_lt_i32 vcc, 1, v48
    ds_read_b32 v25, v25 offset:160
    v_cmpx_lt_i32 vcc, 2, v48
    ds_read_b32 v26, v26 offset:160
    v_cmpx_lt_i32 vcc, 3, v48
    ds_read_b32 v27, v27 offset:160
    s_mov_b64 exec, -1
    s_lshr_b32 s66, s67, 3
    s_add_u32 s60, s66, 1
    s_lshl_b32 s60, s60, 3
    s_sub_u32 s67, s60, s67
    s_sub_u32 s62, s67, 1
    s_add_u32 s61, s4, 1
    s_mul_i32 s61, s61, 72
    s_sub_u32 s60, s61, s60
    s_lshl_b32 s60, s60, 2
    s_waitcnt lgkmcnt(0)
    v_cmpx_lt_i32 vcc, 0, v48
    v_add_u32 v24, v24, v32
    v_lshl_add_u32 v5, v24, 1, v57
    ds_write_b16 v5, v40
    v_lshrrev_b32 v6, 1, v24
    v_lshl_add_u32 v6, v6, 2, v60
    v_and_b32 v7, 1, v24
    v_mad_u32_u24 v6, v7, s58, v6
    ds_write_b32 v6, v16
    v_cmpx_lt_i32 vcc, 1, v48
    v_add_u32 v25, v25, v33
    v_lshl_add_u32 v5, v25, 1, v57
    ds_write_b16 v5, v41
    v_lshrrev_b32 v6, 1, v25
    v_lshl_add_u32 v6, v6, 2, v60
    v_and_b32 v7, 1, v25
    v_mad_u32_u24 v6, v7, s58, v6
    ds_write_b32 v6, v17
    v_cmpx_lt_i32 vcc, 2, v48
    v_add_u32 v26, v26, v34
    v_lshl_add_u32 v5, v26, 1, v57
    ds_write_b16 v5, v42
    v_lshrrev_b32 v6, 1, v26
    v_lshl_add_u32 v6, v6, 2, v60
    v_and_b32 v7, 1, v26
    v_mad_u32_u24 v6, v7, s58, v6
    ds_write_b32 v6, v18
    v_cmpx_lt_i32 vcc, 3, v48
    v_add_u32 v27, v27, v35
    v_lshl_add_u32 v5, v27, 1, v57
    ds_write_b16 v5, v43
    v_lshrrev_b32 v6, 1, v27
    v_lshl_add_u32 v6, v6, 2, v60
    v_and_b32 v7, 1, v27
    v_mad_u32_u24 v6, v7, s58, v6
    ds_write_b32 v6, v19
    s_mov_b64 exec, -1
    ds_add_u32 v61, v62 offset:16
    v_lshrrev_b32 v5, 5, v0
    v_mad_u32_u24 v13, v5, s58, v60
    v_add_u32 v13, s60, v13
    v_lshl_add_u32 v14, v5, 1, v57
    v_and_b32 v5, 28, v0
    v_add3_u32 v14, v14, v5, s60
    s_mov_b32 s65, 201486528
    s_mov_b32 s64, 0
    s_mov_b32 s59, 0
Lw_13:
    ds_read_b32 v4, v3 offset:16
    s_waitcnt lgkmcnt(0)
    v_cmp_gt_u32 vcc, 8, v4
    s_cbranch_vccz Lk_14
    s_add_u32 s59, s59, 1
    s_cmp_lt_u32 s59, 4194304
    s_cbranch_scc1 Lw_13
    s_branch L_end
Lk_14:
    v_mov_b32 v12, v3
    v_mov_b32 v3, v2
    s_setprio 1
    s_cmp_lt_u32 s4, 4
    s_cbranch_scc1 L_old
    s_setprio 2
L_old:
    ds_read_b128 v[56:59], v13 offset:0
    ds_read_b128 v[60:63], v13 offset:16
    ds_read_u16 v1, v14
    ds_read_b128 v[48:51], v13 offset:32
    ds_read_b128 v[52:55], v13 offset:48
    s_waitcnt lgkmcnt(3)
L_p0:
    s_cmp_ge_u32 s67, 4
    s_cbranch_scc1 L_p4
    s_cmp_gt_u32 s67, 1
    s_cbranch_scc1 Lps_15
    v_add_u32 v57, v57, v2
    buffer_load_dwordx4 v[20:23], v57, s[8:11], 0 offen
Lps_15:
    s_cmp_gt_u32 s67, 2
    s_cbranch_scc1 Lps_16
    v_add_u32 v58, v58, v2
    buffer_load_dwordx4 v[24:27], v58, s[8:11], 0 offen
Lps_16:
    s_cmp_gt_u32 s67, 3
    s_cbranch_scc1 Lps_17
    v_add_u32 v59, v59, v2
    buffer_load_dwordx4 v[28:31], v59, s[8:11], 0 offen
Lps_17:
L_p4:
    s_cmp_gt_u32 s67, 4
    s_cbranch_scc1 Lps_18
    v_add_u32 v60, v60, v2
    buffer_load_dwordx4 v[32:35], v60, s[8:11], 0 offen
Lps_18:
    s_cmp_gt_u32 s67, 5
    s_cbranch_scc1 Lps_19
    v_add_u32 v61, v61, v2
    buffer_load_dwordx4 v[36:39], v61, s[8:11], 0 offen
Lps_19:
    s_cmp_gt_u32 s67, 6
    s_cbranch_scc1 Lps_20
    v_add_u32 v62, v62, v2
    buffer_load_dwordx4 v[40:43], v62, s[8:11], 0 offen
Lps_20:
    s_cmp_gt_u32 s67, 7
    s_cbranch_scc1 Lps_21
    v_add_u32 v63, v63, v2
    buffer_load_dwordx4 v[44:47], v63, s[8:11], 0 offen
Lps_21:
    s_cmp_eq_u32 s66, 0
    s_cbranch_scc1 L_drain
L_gl:
    s_waitcnt lgkmcnt(1)
    v_perm_b32 v6, v1, v1, v10
    v_perm_b32 v7, v1, v1, v11
    ds_read_u16 v1, v14 offset:32
    s_waitcnt vmcnt(6)
    v_lshl_add_u64 v[4:5], v[48:49], 0, v[2:3]
    s_sub_u32 s62, s62, 2
    s_cbranch_scc1 Lfs_0
    v_mfma_f32_4x4x4_16b_bf16 v[56:59], v[6:7], v[16:17], v[56:59] cbsz:3 abid:0
    v_mfma_f32_4x4x4_16b_bf16 v[60:63], v[6:7], v[18:19], v[60:63] cbsz:3 abid:0
    buffer_load_dwordx4 v[16:19], v4, s[8:11], 0 offen
    v_mfma_f32_4x4x4_16b_bf16 v[56:59], v[6:7], v[20:21], v[56:59] cbsz:3 abid:1
    v_mfma_f32_4x4x4_16b_bf16 v[60:63], v[6:7], v[22:23], v[60:63] cbsz:3 abid:1
    buffer_load_dwordx4 v[20:23], v5, s[8:11], 0 offen
Lbs_0:
    s_waitcnt vmcnt(6)
    v_lshl_add_u64 v[4:5], v[50:51], 0, v[2:3]
    s_sub_u32 s62, s62, 2
    s_cbranch_scc1 Lfs_2
    v_mfma_f32_4x4x4_16b_bf16 v[56:59], v[6:7], v[24:25], v[56:59] cbsz:3 abid:2
    v_mfma_f32_4x4x4_16b_bf16 v[60:63], v[6:7], v[26:27], v[60:63] cbsz:3 abid:2
    buffer_load_dwordx4 v[24:27], v4, s[8:11], 0 offen
    v_mfma_f32_4x4x4_16b_bf16 v[56:59], v[6:7], v[28:29], v[56:59] cbsz:3 abid:3
    v_mfma_f32_4x4x4_16b_bf16 v[60:63], v[6:7], v[30:31], v[60:63] cbsz:3 abid:3
    buffer_load_dwordx4 v[28:31], v5, s[8:11], 0 offen
Lbs_2:
    ds_read_b128 v[48:51], v13 offset:64
    s_waitcnt vmcnt(6) lgkmcnt(2)
    v_lshl_add_u64 v[4:5], v[52:53], 0, v[2:3]
    s_sub_u32 s62, s62, 2
    s_cbranch_scc1 Lfs_4
    v_mfma_f32_4x4x4_16b_bf16 v[56:59], v[6:7], v[32:33], v[56:59] cbsz:3 abid:4
    v_mfma_f32_4x4x4_16b_bf16 v[60:63], v[6:7], v[34:35], v[60:63] cbsz:3 abid:4
    buffer_load_dwordx4 v[32:35], v4, s[8:11], 0 offen
    v_mfma_f32_4x4x4_16b_bf16 v[56:59], v[6:7], v[36:37], v[56:59] cbsz:3 abid:5
    v_mfma_f32_4x4x4_16b_bf16 v[60:63], v[6:7], v[38:39], v[60:63] cbsz:3 abid:5
    buffer_load_dwordx4 v[36:39], v5, s[8:11], 0 offen
Lbs_4:
    s_waitcnt vmcnt(6)
    v_lshl_add_u64 v[4:5], v[54:55], 0, v[2:3]
    s_sub_u32 s62, s62, 2
    s_cbranch_scc1 Lfs_6
    v_mfma_f32_4x4x4_16b_bf16 v[56:59], v[6:7], v[40:41], v[56:59] cbsz:3 abid:6
    v_mfma_f32_4x4x4_16b_bf16 v[60:63], v[6:7], v[42:43], v[60:63] cbsz:3 abid:6
    buffer_load_dwordx4 v[40:43], v4, s[8:11], 0 offen
    v_mfma_f32_4x4x4_16b_bf16 v[56:59], v[6:7], v[44:45], v[56:59] cbsz:3 abid:7
    v_mfma_f32_4x4x4_16b_bf16 v[60:63], v[6:7], v[46:47], v[60:63] cbsz:3 abid:7
    buffer_load_dwordx4 v[44:47], v5, s[8:11], 0 offen
Lbs_6:
    ds_read_b128 v[52:55], v13 offset:80
    v_add_u32 v13, 32, v13
    v_add_u32 v14, 32, v14
    s_sub_u32 s66, s66, 1
    s_cmp_eq_u32 s66, 3
    s_cbranch_scc0 L_nf
    s_setprio 1
L_nf:
    s_cmp_lg_u32 s66, 0
    s_cbranch_scc1 L_gl
L_drain:
    s_waitcnt lgkmcnt(0)
    v_perm_b32 v6, v1, v1, v10
    v_perm_b32 v7, v1, v1, v11
    ds_read_u16 v1, v14 offset:32
    s_waitcnt vmcnt(7)
    v_mfma_f32_4x4x4_16b_bf16 v[56:59], v[6:7], v[16:17], v[56:59] cbsz:3 abid:0
    v_mfma_f32_4x4x4_16b_bf16 v[60:63], v[6:7], v[18:19], v[60:63] cbsz:3 abid:0
    s_sub_u32 s62, s62, 1
    s_cbranch_scc1 Lfd_0
Lbd_0:
    s_waitcnt vmcnt(6)
    v_mfma_f32_4x4x4_16b_bf16 v[56:59], v[6:7], v[20:21], v[56:59] cbsz:3 abid:1
    v_mfma_f32_4x4x4_16b_bf16 v[60:63], v[6:7], v[22:23], v[60:63] cbsz:3 abid:1
    s_sub_u32 s62, s62, 1
    s_cbranch_scc1 Lfd_1
Lbd_1:
    s_waitcnt vmcnt(5)
    v_mfma_f32_4x4x4_16b_bf16 v[56:59], v[6:7], v[24:25], v[56:59] cbsz:3 abid:2
    v_mfma_f32_4x4x4_16b_bf16 v[60:63], v[6:7], v[26:27], v[60:63] cbsz:3 abid:2
    s_sub_u32 s62, s62, 1
    s_cbranch_scc1 Lfd_2
Lbd_2:
    s_waitcnt vmcnt(4)
    v_mfma_f32_4x4x4_16b_bf16 v[56:59], v[6:7], v[28:29], v[56:59] cbsz:3 abid:3
    v_mfma_f32_4x4x4_16b_bf16 v[60:63], v[6:7], v[30:31], v[60:63] cbsz:3 abid:3
    s_sub_u32 s62, s62, 1
    s_cbranch_scc1 Lfd_3
Lbd_3:
    s_waitcnt vmcnt(3)
    v_mfma_f32_4x4x4_16b_bf16 v[56:59], v[6:7], v[32:33], v[56:59] cbsz:3 abid:4
    v_mfma_f32_4x4x4_16b_bf16 v[60:63], v[6:7], v[34:35], v[60:63] cbsz:3 abid:4
    s_sub_u32 s62, s62, 1
    s_cbranch_scc1 Lfd_4
Lbd_4:
    s_waitcnt vmcnt(2)
    v_mfma_f32_4x4x4_16b_bf16 v[56:59], v[6:7], v[36:37], v[56:59] cbsz:3 abid:5
    v_mfma_f32_4x4x4_16b_bf16 v[60:63], v[6:7], v[38:39], v[60:63] cbsz:3 abid:5
    s_sub_u32 s62, s62, 1
    s_cbranch_scc1 Lfd_5
Lbd_5:
    s_waitcnt vmcnt(1)
    v_mfma_f32_4x4x4_16b_bf16 v[56:59], v[6:7], v[40:41], v[56:59] cbsz:3 abid:6
    v_mfma_f32_4x4x4_16b_bf16 v[60:63], v[6:7], v[42:43], v[60:63] cbsz:3 abid:6
    s_sub_u32 s62, s62, 1
    s_cbranch_scc1 Lfd_6
Lbd_6:
    s_waitcnt vmcnt(0)
    v_mfma_f32_4x4x4_16b_bf16 v[56:59], v[6:7], v[44:45], v[56:59] cbsz:3 abid:7
    v_mfma_f32_4x4x4_16b_bf16 v[60:63], v[6:7], v[46:47], v[60:63] cbsz:3 abid:7
    s_nop 1
    s_call_b64 s[68:69], L_flush
L_gdone:
    s_endpgm
Lfs_0:
    s_add_u32 s62, s62, 2
    v_mfma_f32_4x4x4_16b_bf16 v[56:59], v[6:7], v[16:17], v[56:59] cbsz:3 abid:0
    v_mfma_f32_4x4x4_16b_bf16 v[60:63], v[6:7], v[18:19], v[60:63] cbsz:3 abid:0
    buffer_load_dwordx4 v[16:19], v4, s[8:11], 0 offen
    s_sub_u32 s62, s62, 1
    s_cbranch_scc0 Lsk_22
    s_call_b64 s[68:69], L_flush
Lsk_22:
    v_mfma_f32_4x4x4_16b_bf16 v[56:59], v[6:7], v[20:21], v[56:59] cbsz:3 abid:1
    v_mfma_f32_4x4x4_16b_bf16 v[60:63], v[6:7], v[22:23], v[60:63] cbsz:3 abid:1
    buffer_load_dwordx4 v[20:23], v5, s[8:11], 0 offen
    s_sub_u32 s62, s62, 1
    s_cbranch_scc0 Lbs_0
    s_call_b64 s[68:69], L_flush
    s_branch Lbs_0
Lfs_2:
    s_add_u32 s62, s62, 2
    v_mfma_f32_4x4x4_16b_bf16 v[56:59], v[6:7], v[24:25], v[56:59] cbsz:3 abid:2
    v_mfma_f32_4x4x4_16b_bf16 v[60:63], v[6:7], v[26:27], v[60:63] cbsz:3 abid:2
    buffer_load_dwordx4 v[24:27], v4, s[8:11], 0 offen
    s_sub_u32 s62, s62, 1
    s_cbranch_scc0 Lsk_24
    s_call_b64 s[68:69], L_flush
Lsk_24:
    v_mfma_f32_4x4x4_16b_bf16 v[56:59], v[6:7], v[28:29], v[56:59] cbsz:3 abid:3
    v_mfma_f32_4x4x4_16b_bf16 v[60:63], v[6:7], v[30:31], v[60:63] cbsz:3 abid:3
    buffer_load_dwordx4 v[28:31], v5, s[8:11], 0 offen
    s_sub_u32 s62, s62, 1
    s_cbranch_scc0 Lbs_2
    s_call_b64 s[68:69], L_flush
    s_branch Lbs_2
Lfs_4:
    s_add_u32 s62, s62, 2
    v_mfma_f32_4x4x4_16b_bf16 v[56:59], v[6:7], v[32:33], v[56:59] cbsz:3 abid:4
    v_mfma_f32_4x4x4_16b_bf16 v[60:63], v[6:7], v[34:35], v[60:63] cbsz:3 abid:4
    buffer_load_dwordx4 v[32:35], v4, s[8:11], 0 offen
    s_sub_u32 s62, s62, 1
    s_cbranch_scc0 Lsk_26
    s_call_b64 s[68:69], L_flush
Lsk_26:
    v_mfma_f32_4x4x4_16b_bf16 v[56:59], v[6:7], v[36:37], v[56:59] cbsz:3 abid:5
    v_mfma_f32_4x4x4_16b_bf16 v[60:63], v[6:7], v[38:39], v[60:63] cbsz:3 abid:5
    buffer_load_dwordx4 v[36:39], v5, s[8:11], 0 offen
    s_sub_u32 s62, s62, 1
    s_cbranch_scc0 Lbs_4
    s_call_b64 s[68:69], L_flush
    s_branch Lbs_4
Lfs_6:
    s_add_u32 s62, s62, 2
    v_mfma_f32_4x4x4_16b_bf16 v[56:59], v[6:7], v[40:41], v[56:59] cbsz:3 abid:6
    v_mfma_f32_4x4x4_16b_bf16 v[60:63], v[6:7], v[42:43], v[60:63] cbsz:3 abid:6
    buffer_load_dwordx4 v[40:43], v4, s[8:11], 0 offen
    s_sub_u32 s62, s62, 1
    s_cbranch_scc0 Lsk_28
    s_call_b64 s[68:69], L_flush
Lsk_28:
    v_mfma_f32_4x4x4_16b_bf16 v[56:59], v[6:7], v[44:45], v[56:59] cbsz:3 abid:7
    v_mfma_f32_4x4x4_16b_bf16 v[60:63], v[6:7], v[46:47], v[60:63] cbsz:3 abid:7
    buffer_load_dwordx4 v[44:47], v5, s[8:11], 0 offen
    s_sub_u32 s62, s62, 1
    s_cbranch_scc0 Lbs_6
    s_call_b64 s[68:69], L_flush
    s_branch Lbs_6
Lfd_0:
    s_call_b64 s[68:69], L_flush
    s_branch Lbd_0
Lfd_1:
    s_call_b64 s[68:69], L_flush
    s_branch Lbd_1
Lfd_2:
    s_call_b64 s[68:69], L_flush
    s_branch Lbd_2
Lfd_3:
    s_call_b64 s[68:69], L_flush
    s_branch Lbd_3
Lfd_4:
    s_call_b64 s[68:69], L_flush
    s_branch Lbd_4
Lfd_5:
    s_call_b64 s[68:69], L_flush
    s_branch Lbd_5
Lfd_6:
    s_call_b64 s[68:69], L_flush
    s_branch Lbd_6
L_flush:
    s_and_b32 s101, s65, 0x3ffff
    s_add_u32 s63, s63, 1
    v_permlane32_swap_b32 v56, v60
    v_permlane32_swap_b32 v57, v61
    v_permlane32_swap_b32 v58, v62
    v_permlane32_swap_b32 v59, v63
    s_lshr_b32 s62, s65, 26
    v_pk_add_f32 v[56:57], v[56:57], v[60:61]
    v_pk_add_f32 v[58:59], v[58:59], v[62:63]
    v_add_u32 v62, s101, v15
    v_pk_mul_f32 v[56:57], v[56:57], s[64:65] op_sel_hi:[1,0]
    v_pk_mul_f32 v[58:59], v[58:59], s[64:65] op_sel_hi:[1,0]
    v_lshl_add_u32 v63, s62, 2, v12
    v_cvt_pk_bf16_f32 v60, v56, v57
    v_cvt_pk_bf16_f32 v61, v58, v59
    ds_write_b64 v62, v[60:61]
    s_mov_b64 exec, 1
    ds_inc_u32 v63, v63 offset:36
    s_mov_b64 exec, -1
    v_readlane_b32 s65, v9, s63
    v_readlane_b32 s64, v8, s63
    v_mov_b64 v[56:57], 0
    v_mov_b64 v[58:59], 0
    v_mov_b64 v[60:61], 0
    v_mov_b64 v[62:63], 0
    s_bfe_u32 s62, s65, 0x80012
    s_setpc_b64 s[68:69]
L_preA:
    s_setprio 2
    s_mul_i32 s5, s6, 40
    v_mov_b32 v3, 159296
    s_mov_b32 s10, 5120000
    s_mov_b32 s11, 0x20000
    s_mov_b64 s[16:17], s[56:57]
    s_mov_b32 s18, 1441792
    s_mov_b32 s19, 0x20000
    s_cmp_ge_u32 s2, 64
    s_cbranch_scc1 L_nopb
    s_barrier
    s_barrier
L_nopb:
    v_and_b32 v6, 32, v0
    v_lshl_add_u32 v5, v6, 7, v2
    v_lshl_add_u32 v6, v6, 6, v2
    s_add_u32 s58, s3, s5
    s_mul_i32 s59, s3, 1056
    s_add_u32 m0, s59, 84480
    s_lshl_b32 s58, s58, 9
    buffer_load_dwordx4 v5, s[8:11], s58 offen lds
    s_add_u32 m0, s59, 92928
    s_add_u32 s58, s58, 8192
    s_waitcnt vmcnt(2)
    buffer_load_dwordx4 v5, s[8:11], s58 offen lds
    s_cmp_ge_u32 s3, 4
    s_cbranch_scc1 L_xa2
    s_add_u32 m0, s59, 101376
    s_add_u32 s58, s58, 8192
    s_waitcnt vmcnt(2)
    buffer_load_dwordx4 v6, s[8:11], s58 offen lds
L_xa2:
    v_and_b32 v4, 7, v0
    v_mul_u32_u24 v1, 1056, v4
    v_and_b32 v4, 8, v0
    v_lshl_add_u32 v1, v4, 6, v1
    v_and_b32 v4, 48, v0
    v_add_u32 v1, v4, v1
    v_add_u32 v12, 84480, v1
    s_mov_b64 s[20:21], s[52:53]
    s_mov_b32 s22, 5120000
    s_mov_b32 s23, 0x20000
    v_lshlrev_b32 v14, 4, v0
    s_lshl_b32 s61, s3, 6
    s_add_u32 s61, s61, 105600
    v_add_u32 v13, s61, v1
    s_lshl_b32 s100, s3, 14
    s_add_u32 s100, s100, 655360
    s_waitcnt lgkmcnt(0)
    v_lshl_add_u32 v104, s32, 9, v2
    v_lshl_add_u32 v105, s33, 9, v2
    v_lshl_add_u32 v106, s34, 9, v2
    v_lshl_add_u32 v107, s35, 9, v2
    v_lshl_add_u32 v108, s36, 9, v2
    v_lshl_add_u32 v109, s37, 9, v2
    v_lshl_add_u32 v110, s38, 9, v2
    v_lshl_add_u32 v111, s39, 9, v2
    v_lshl_add_u32 v112, s64, 9, v2
    v_lshl_add_u32 v113, s65, 9, v2
    s_mov_b32 exec_lo, 0
    v_lshl_add_u32 v104, s40, 9, v2
    v_lshl_add_u32 v105, s41, 9, v2
    v_lshl_add_u32 v106, s42, 9, v2
    v_lshl_add_u32 v107, s43, 9, v2
    v_lshl_add_u32 v108, s44, 9, v2
    v_lshl_add_u32 v109, s45, 9, v2
    v_lshl_add_u32 v110, s46, 9, v2
    v_lshl_add_u32 v111, s47, 9, v2
    v_lshl_add_u32 v112, s66, 9, v2
    v_lshl_add_u32 v113, s67, 9, v2
    s_mov_b64 exec, -1
    s_mul_i32 s67, s3, 2112
    s_mul_i32 s66, s3, 8448
    s_cmp_lt_u32 s2, 64
    s_cbranch_scc1 Lth_30
    s_waitcnt vmcnt(1)
Lth_30:
    s_add_u32 m0, s66, 0
    s_waitcnt vmcnt(2)
    buffer_load_dwordx4 v104, s[8:11], 0 offen lds
    s_cmp_lt_u32 s2, 64
    s_cbranch_scc1 Lth_31
    s_waitcnt vmcnt(1)
Lth_31:
    s_add_u32 m0, s66, 1056
    s_waitcnt vmcnt(2)
    buffer_load_dwordx4 v105, s[8:11], 0 offen lds
    v_and_b32 v4, 3, v0
    v_mov_b32 v5, 0x0c0c0c0c
    v_mov_b32 v6, 0x0c0c0302
    v_mov_b32 v7, 0x03020c0c
    v_cmp_eq_u32 s[58:59], 0, v4
    v_cmp_eq_u32 s[60:61], 2, v4
    v_cmp_eq_u32 vcc, 1, v4
    v_cndmask_b32 v8, v5, v6, s[58:59]
    v_cndmask_b32 v9, v5, v6, s[60:61]
    v_cndmask_b32 v8, v8, v7, vcc
    v_cmp_eq_u32 vcc, 3, v4
    s_nop 1
    v_cndmask_b32 v9, v9, v7, vcc
    v_mov_b32 v10, v8
    v_mov_b32 v11, v9
    v_and_b32 v8, 0xfdfdfdfd, v8
    v_and_b32 v9, 0xfdfdfdfd, v9
    s_cmp_lt_u32 s2, 64
    s_cbranch_scc1 Lth_32
    s_waitcnt vmcnt(1)
Lth_32:
    s_add_u32 m0, s66, 2112
    s_waitcnt vmcnt(2)
    buffer_load_dwordx4 v106, s[8:11], 0 offen lds
    s_cmp_lt_u32 s2, 64
    s_cbranch_scc1 Lth_33
    s_waitcnt vmcnt(1)
Lth_33:
    s_add_u32 m0, s66, 3168
    s_waitcnt vmcnt(2)
    buffer_load_dwordx4 v107, s[8:11], 0 offen lds
    s_mov_b64 exec, 1
    v_mov_b32 v4, 1
    ds_add_u32 v3, v4 offset:0
    s_mov_b64 exec, -1
    s_cmp_lt_u32 s2, 64
    s_cbranch_scc1 Lth_34
    s_waitcnt vmcnt(1)
Lth_34:
    s_add_u32 m0, s66, 4224
    s_waitcnt vmcnt(2)
    buffer_load_dwordx4 v108, s[8:11], 0 offen lds
    s_mov_b32 s59, 0
Lw_35:
    ds_read_b32 v4, v3 offset:0
    s_waitcnt lgkmcnt(0)
    v_cmp_gt_u32 vcc, 8, v4
    s_cbranch_vccz Lk_36
    s_add_u32 s59, s59, 1
    s_cmp_lt_u32 s59, 4194304
    s_cbranch_scc1 Lw_35
    s_branch L_end
Lk_36:
    ds_read_b128 v[80:83], v12 offset:0
    ds_read_b128 v[84:87], v12 offset:8448
    ds_read_b128 v[88:91], v12 offset:16896
    s_cmp_lt_u32 s2, 64
    s_cbranch_scc1 Lth_37
    s_waitcnt vmcnt(1)
Lth_37:
    s_add_u32 m0, s66, 5280
    s_waitcnt vmcnt(2)
    buffer_load_dwordx4 v109, s[8:11], 0 offen lds
    s_mov_b64 exec, 1
    v_mov_b32 v4, 1
    ds_add_u32 v3, v4 offset:60
    s_mov_b64 exec, -1
    s_cmp_lt_u32 s2, 64
    s_cbranch_scc1 Lth_38
    s_waitcnt vmcnt(1)
Lth_38:
    s_waitcnt vmcnt(2)
    ds_read_b32 v4, v3 offset:52
    s_add_u32 m0, s66, 6336
    s_waitcnt vmcnt(2)
    buffer_load_dwordx4 v110, s[8:11], 0 offen lds
    s_waitcnt lgkmcnt(0)
    v_cmp_gt_u32 vcc, 8, v4
    s_cbranch_vccz L_eu7
    s_cmp_lt_u32 s2, 64
    s_cbranch_scc1 Lth_39
    s_waitcnt vmcnt(1)
Lth_39:
    s_waitcnt vmcnt(2)
    ds_read_b32 v4, v3 offset:52
    s_add_u32 m0, s66, 7392
    s_waitcnt vmcnt(2)
    buffer_load_dwordx4 v111, s[8:11], 0 offen lds
    s_waitcnt lgkmcnt(0)
    v_cmp_gt_u32 vcc, 8, v4
    s_cbranch_vccz L_eu8
    s_cmp_lt_u32 s2, 64
    s_cbranch_scc1 Lth_40
    s_waitcnt vmcnt(1)
Lth_40:
    s_waitcnt vmcnt(2)
    ds_read_b32 v4, v3 offset:52
    s_add_u32 m0, s67, 67584
    s_waitcnt vmcnt(2)
    buffer_load_dwordx4 v112, s[8:11], 0 offen lds
    s_waitcnt lgkmcnt(0)
    v_cmp_gt_u32 vcc, 8, v4
    s_cbranch_vccz L_eu9
    s_cmp_lt_u32 s2, 64
    s_cbranch_scc1 Lth_41
    s_waitcnt vmcnt(1)
Lth_41:
    s_waitcnt vmcnt(2)
    ds_read_b32 v4, v3 offset:52
    s_add_u32 m0, s67, 68640
    s_waitcnt vmcnt(2)
    buffer_load_dwordx4 v113, s[8:11], 0 offen lds
    s_mov_b32 s59, 0
Lw_42:
    ds_read_b32 v4, v3 offset:52
    s_waitcnt lgkmcnt(0)
    v_cmp_gt_u32 vcc, 8, v4
    s_cbranch_vccz Lk_43
    s_sleep 1
    s_add_u32 s59, s59, 1
    s_cmp_lt_u32 s59, 4194304
    s_cbranch_scc1 Lw_42
    s_branch L_end
Lk_43:
    s_branch L_eu10
L_eu7:
    s_add_u32 m0, s66, 7392
    s_waitcnt vmcnt(63)
    buffer_load_dwordx4 v111, s[8:11], 0 offen lds
L_eu8:
    s_add_u32 m0, s67, 67584
    s_waitcnt vmcnt(63)
    buffer_load_dwordx4 v112, s[8:11], 0 offen lds
L_eu9:
    s_add_u32 m0, s67, 68640
    s_waitcnt vmcnt(63)
    buffer_load_dwordx4 v113, s[8:11], 0 offen lds
L_eu10:
    s_setprio 3
    buffer_load_dwordx4 v[16:19], v14, s[16:19], s100 offen offset:0 sc1
    buffer_load_dwordx4 v[20:23], v14, s[16:19], s100 offen offset:1024 sc1
    buffer_load_dwordx4 v[24:27], v14, s[16:19], s100 offen offset:2048 sc1
    buffer_load_dwordx4 v[28:31], v14, s[16:19], s100 offen offset:3072 sc1
    s_add_u32 s100, s100, 4096
    buffer_load_dwordx4 v[32:35], v14, s[16:19], s100 offen offset:0 sc1
    buffer_load_dwordx4 v[36:39], v14, s[16:19], s100 offen offset:1024 sc1
    buffer_load_dwordx4 v[40:43], v14, s[16:19], s100 offen offset:2048 sc1
    buffer_load_dwordx4 v[44:47], v14, s[16:19], s100 offen offset:3072 sc1
    s_add_u32 s100, s100, 4096
    buffer_load_dwordx4 v[48:51], v14, s[16:19], s100 offen offset:0 sc1
    buffer_load_dwordx4 v[52:55], v14, s[16:19], s100 offen offset:1024 sc1
    buffer_load_dwordx4 v[56:59], v14, s[16:19], s100 offen offset:2048 sc1
    buffer_load_dwordx4 v[60:63], v14, s[16:19], s100 offen offset:3072 sc1
    s_add_u32 s100, s100, 4096
    buffer_load_dwordx4 v[64:67], v14, s[16:19], s100 offen offset:0 sc1
    buffer_load_dwordx4 v[68:71], v14, s[16:19], s100 offen offset:1024 sc1
    buffer_load_dwordx4 v[72:75], v14, s[16:19], s100 offen offset:2048 sc1
    buffer_load_dwordx4 v[76:79], v14, s[16:19], s100 offen offset:3072 sc1
    s_setprio 0
    ds_read_b128 v[92:95], v12 offset:64
    ds_read_b128 v[96:99], v12 offset:8512
    ds_read_b128 v[100:103], v12 offset:16960
    s_waitcnt vmcnt(14) lgkmcnt(3)
    v_mfma_f32_16x16x32_bf16 v[104:107], v[16:19], v[80:83], 0
    v_mfma_f32_16x16x32_bf16 v[108:111], v[20:23], v[80:83], 0
    v_mfma_f32_16x16x32_bf16 v[112:115], v[16:19], v[84:87], 0
    v_mfma_f32_16x16x32_bf16 v[116:119], v[20:23], v[84:87], 0
    v_mfma_f32_16x16x32_bf16 v[120:123], v[16:19], v[88:91], 0
    v_mfma_f32_16x16x32_bf16 v[124:127], v[20:23], v[88:91], 0
    ds_read_b128 v[80:83], v12 offset:128
    ds_read_b128 v[84:87], v12 offset:8576
    ds_read_b128 v[88:91], v12 offset:17024
    s_waitcnt vmcnt(12) lgkmcnt(3)
    v_mfma_f32_16x16x32_bf16 v[104:107], v[24:27], v[92:95], v[104:107]
    v_mfma_f32_16x16x32_bf16 v[108:111], v[28:31], v[92:95], v[108:111]
    v_mfma_f32_16x16x32_bf16 v[112:115], v[24:27], v[96:99], v[112:115]
    v_mfma_f32_16x16x32_bf16 v[116:119], v[28:31], v[96:99], v[116:119]
    v_mfma_f32_16x16x32_bf16 v[120:123], v[24:27], v[100:103], v[120:123]
    v_mfma_f32_16x16x32_bf16 v[124:127], v[28:31], v[100:103], v[124:127]
    ds_read_b128 v[92:95], v12 offset:192
    ds_read_b128 v[96:99], v12 offset:8640
    ds_read_b128 v[100:103], v12 offset:17088
    s_waitcnt vmcnt(10) lgkmcnt(3)
    v_mfma_f32_16x16x32_bf16 v[104:107], v[32:35], v[80:83], v[104:107]
    v_mfma_f32_16x16x32_bf16 v[108:111], v[36:39], v[80:83], v[108:111]
    v_mfma_f32_16x16x32_bf16 v[112:115], v[32:35], v[84:87], v[112:115]
    v_mfma_f32_16x16x32_bf16 v[116:119], v[36:39], v[84:87], v[116:119]
    v_mfma_f32_16x16x32_bf16 v[120:123], v[32:35], v[88:91], v[120:123]
    v_mfma_f32_16x16x32_bf16 v[124:127], v[36:39], v[88:91], v[124:127]
    ds_read_b128 v[80:83], v12 offset:256
    ds_read_b128 v[84:87], v12 offset:8704
    ds_read_b128 v[88:91], v12 offset:17152
    s_waitcnt vmcnt(8) lgkmcnt(3)
    v_mfma_f32_16x16x32_bf16 v[104:107], v[40:43], v[92:95], v[104:107]
    v_mfma_f32_16x16x32_bf16 v[108:111], v[44:47], v[92:95], v[108:111]
    v_mfma_f32_16x16x32_bf16 v[112:115], v[40:43], v[96:99], v[112:115]
    v_mfma_f32_16x16x32_bf16 v[116:119], v[44:47], v[96:99], v[116:119]
    v_mfma_f32_16x16x32_bf16 v[120:123], v[40:43], v[100:103], v[120:123]
    v_mfma_f32_16x16x32_bf16 v[124:127], v[44:47], v[100:103], v[124:127]
    ds_read_b128 v[92:95], v12 offset:320
    ds_read_b128 v[96:99], v12 offset:8768
    ds_read_b128 v[100:103], v12 offset:17216
    s_waitcnt vmcnt(6) lgkmcnt(3)
    v_mfma_f32_16x16x32_bf16 v[104:107], v[48:51], v[80:83], v[104:107]
    v_mfma_f32_16x16x32_bf16 v[108:111], v[52:55], v[80:83], v[108:111]
    v_mfma_f32_16x16x32_bf16 v[112:115], v[48:51], v[84:87], v[112:115]
    v_mfma_f32_16x16x32_bf16 v[116:119], v[52:55], v[84:87], v[116:119]
    v_mfma_f32_16x16x32_bf16 v[120:123], v[48:51], v[88:91], v[120:123]
    v_mfma_f32_16x16x32_bf16 v[124:127], v[52:55], v[88:91], v[124:127]
    s_setprio 3
    s_add_u32 s100, s100, 118784
    buffer_load_dwordx4 v[16:19], v14, s[16:19], s100 offen offset:0 sc1
    buffer_load_dwordx4 v[20:23], v14, s[16:19], s100 offen offset:1024 sc1
    buffer_load_dwordx4 v[24:27], v14, s[16:19], s100 offen offset:2048 sc1
    buffer_load_dwordx4 v[28:31], v14, s[16:19], s100 offen offset:3072 sc1
    s_setprio 0
    ds_read_b128 v[80:83], v12 offset:384
    ds_read_b128 v[84:87], v12 offset:8832
    ds_read_b128 v[88:91], v12 offset:17280
    s_waitcnt vmcnt(8) lgkmcnt(3)
    v_mfma_f32_16x16x32_bf16 v[104:107], v[56:59], v[92:95], v[104:107]
    v_mfma_f32_16x16x32_bf16 v[108:111], v[60:63], v[92:95], v[108:111]
    v_mfma_f32_16x16x32_bf16 v[112:115], v[56:59], v[96:99], v[112:115]
    v_mfma_f32_16x16x32_bf16 v[116:119], v[60:63], v[96:99], v[116:119]
    v_mfma_f32_16x16x32_bf16 v[120:123], v[56:59], v[100:103], v[120:123]
    v_mfma_f32_16x16x32_bf16 v[124:127], v[60:63], v[100:103], v[124:127]
    s_setprio 3
    s_add_u32 s100, s100, 4096
    buffer_load_dwordx4 v[32:35], v14, s[16:19], s100 offen offset:0 sc1
    buffer_load_dwordx4 v[36:39], v14, s[16:19], s100 offen offset:1024 sc1
    buffer_load_dwordx4 v[40:43], v14, s[16:19], s100 offen offset:2048 sc1
    buffer_load_dwordx4 v[44:47], v14, s[16:19], s100 offen offset:3072 sc1
    s_setprio 0
    ds_read_b128 v[92:95], v12 offset:448
    ds_read_b128 v[96:99], v12 offset:8896
    ds_read_b128 v[100:103], v12 offset:17344
    s_waitcnt vmcnt(10) lgkmcnt(3)
    v_mfma_f32_16x16x32_bf16 v[104:107], v[64:67], v[80:83], v[104:107]
    v_mfma_f32_16x16x32_bf16 v[108:111], v[68:71], v[80:83], v[108:111]
    v_mfma_f32_16x16x32_bf16 v[112:115], v[64:67], v[84:87], v[112:115]
    v_mfma_f32_16x16x32_bf16 v[116:119], v[68:71], v[84:87], v[116:119]
    v_mfma_f32_16x16x32_bf16 v[120:123], v[64:67], v[88:91], v[120:123]
    v_mfma_f32_16x16x32_bf16 v[124:127], v[68:71], v[88:91], v[124:127]
    s_setprio 3
    s_add_u32 s100, s100, 4096
    buffer_load_dwordx4 v[48:51], v14, s[16:19], s100 offen offset:0 sc1
    buffer_load_dwordx4 v[52:55], v14, s[16:19], s100 offen offset:1024 sc1
    buffer_load_dwordx4 v[56:59], v14, s[16:19], s100 offen offset:2048 sc1
    buffer_load_dwordx4 v[60:63], v14, s[16:19], s100 offen offset:3072 sc1
    s_setprio 0
    s_waitcnt vmcnt(12) lgkmcnt(0)
    v_mfma_f32_16x16x32_bf16 v[104:107], v[72:75], v[92:95], v[104:107]
    v_mfma_f32_16x16x32_bf16 v[108:111], v[76:79], v[92:95], v[108:111]
    v_mfma_f32_16x16x32_bf16 v[112:115], v[72:75], v[96:99], v[112:115]
    v_mfma_f32_16x16x32_bf16 v[116:119], v[76:79], v[96:99], v[116:119]
    v_mfma_f32_16x16x32_bf16 v[120:123], v[72:75], v[100:103], v[120:123]
    v_mfma_f32_16x16x32_bf16 v[124:127], v[76:79], v[100:103], v[124:127]
    s_setprio 3
    s_add_u32 s100, s100, 4096
    buffer_load_dwordx4 v[64:67], v14, s[16:19], s100 offen offset:0 sc1
    buffer_load_dwordx4 v[68:71], v14, s[16:19], s100 offen offset:1024 sc1
    buffer_load_dwordx4 v[72:75], v14, s[16:19], s100 offen offset:2048 sc1
    buffer_load_dwordx4 v[76:79], v14, s[16:19], s100 offen offset:3072 sc1
    s_setprio 0
    s_nop 3
    v_cvt_pk_bf16_f32 v80, v104, v105
    v_cvt_pk_bf16_f32 v81, v106, v107
    v_cvt_pk_bf16_f32 v82, v108, v109
    v_cvt_pk_bf16_f32 v83, v110, v111
    ds_write_b128 v13, v[80:83] offset:0
    v_cvt_pk_bf16_f32 v84, v112, v113
    v_cvt_pk_bf16_f32 v85, v114, v115
    v_cvt_pk_bf16_f32 v86, v116, v117
    v_cvt_pk_bf16_f32 v87, v118, v119
    ds_write_b128 v13, v[84:87] offset:8448
    v_cvt_pk_bf16_f32 v88, v120, v121
    v_cvt_pk_bf16_f32 v89, v122, v123
    v_cvt_pk_bf16_f32 v90, v124, v125
    v_cvt_pk_bf16_f32 v91, v126, v127
    ds_write_b128 v13, v[88:91] offset:16896
    s_mov_b64 exec, 1
    v_mov_b32 v4, 1
    ds_add_u32 v3, v4 offset:20
    s_mov_b64 exec, -1
    s_setprio 3
    s_setprio 0
L_late1:
    s_mov_b32 s63, s3
L_grp:
    s_mul_i32 s58, s63, 8448
    s_lshr_b32 s59, s63, 2
    s_mul_i32 s59, s59, 8448
    s_and_b32 s60, s63, 1
    s_bfe_u32 s61, s63, 0x10001
    s_cmp_ge_u32 s63, 8
    s_cselect_b32 s61, s60, s61
    s_cselect_b32 s60, 0, s60
    s_mul_i32 s60, s60, 4224
    s_lshl_b32 s61, s61, 9
    s_add_u32 s59, s59, s60
    s_add_u32 s59, s59, s61
    s_add_u32 s59, s59, 105600
    v_add_u32 v12, s58, v1
    v_bfe_u32 v4, v0, 2, 2
    v_mul_u32_u24 v4, 1056, v4
    v_and_b32 v5, 48, v0
    v_add3_u32 v13, v4, v5, s59
    v_lshl_add_u32 v14, v0, 3, s58
    v_lshl_add_u32 v2, v0, 3, s59
    s_cmp_ge_u32 s63, 8
    s_cbranch_scc1 L_grp2
    s_mov_b32 s59, 0
Lw_44:
    ds_read_b32 v4, v3 offset:20
    s_waitcnt lgkmcnt(0)
    v_cmp_gt_u32 vcc, 8, v4
    s_cbranch_vccz Lk_45
    s_sleep 1
    s_add_u32 s59, s59, 1
    s_cmp_lt_u32 s59, 4194304
    s_cbranch_scc1 Lw_44
    s_branch L_end
Lk_45:
L_grp2:
    s_waitcnt lgkmcnt(0)
    ds_read_b128 v[80:83], v12 offset:0
    ds_read_b128 v[84:87], v13 offset:0
    ds_read_b128 v[88:91], v12 offset:64
    ds_read_b128 v[92:95], v13 offset:64
    ds_read_b128 v[96:99], v12 offset:128
    ds_read_b128 v[100:103], v13 offset:128
    ds_read_b128 v[104:107], v12 offset:192
    ds_read_b128 v[108:111], v13 offset:192
    ds_read_b128 v[112:115], v12 offset:256
    ds_read_b128 v[116:119], v13 offset:256
    ds_read_b128 v[120:123], v12 offset:320
    ds_read_b128 v[124:127], v13 offset:320
    s_waitcnt lgkmcnt(10)
    v_mfma_f32_16x16x32_bf16 v[4:7], v[80:83], v[84:87], 0
    ds_read_b128 v[80:83], v12 offset:384
    ds_read_b128 v[84:87], v13 offset:384
    s_waitcnt lgkmcnt(10)
    v_mfma_f32_16x16x32_bf16 v[4:7], v[88:91], v[92:95], v[4:7]
    ds_read_b128 v[88:91], v12 offset:448
    ds_read_b128 v[92:95], v13 offset:448
    s_waitcnt lgkmcnt(10)
    v_mfma_f32_16x16x32_bf16 v[4:7], v[96:99], v[100:103], v[4:7]
    s_waitcnt lgkmcnt(8)
    v_mfma_f32_16x16x32_bf16 v[4:7], v[104:107], v[108:111], v[4:7]
    s_waitcnt lgkmcnt(6)
    v_mfma_f32_16x16x32_bf16 v[4:7], v[112:115], v[116:119], v[4:7]
    s_waitcnt lgkmcnt(4)
    v_mfma_f32_16x16x32_bf16 v[4:7], v[120:123], v[124:127], v[4:7]
    s_waitcnt lgkmcnt(2)
    v_mfma_f32_16x16x32_bf16 v[4:7], v[80:83], v[84:87], v[4:7]
    s_waitcnt lgkmcnt(0)
    v_mfma_f32_16x16x32_bf16 v[4:7], v[88:91], v[92:95], v[4:7]
    ds_read_b64 v[96:97], v14 offset:2112
    ds_read_b64 v[98:99], v14 offset:6336
    ds_read_b64 v[100:101], v14 offset:2624
    ds_read_b64 v[102:103], v14 offset:6848
    ds_read_b64 v[104:105], v14 offset:3168
    ds_read_b64 v[106:107], v14 offset:7392
    ds_read_b64 v[108:109], v14 offset:3680
    ds_read_b64 v[110:111], v14 offset:7904
    ds_read_b64 v[80:81], v14 offset:0
    ds_read_b64 v[82:83], v14 offset:4224
    ds_read_b64 v[84:85], v14 offset:512
    ds_read_b64 v[86:87], v14 offset:4736
    ds_read_b64 v[88:89], v14 offset:1056
    ds_read_b64 v[90:91], v14 offset:5280
    ds_read_b64 v[92:93], v14 offset:1568
    s_waitcnt lgkmcnt(14)
    ds_read_b64 v[94:95], v14 offset:5792
    v_mul_f32 v4, 0x3db8aa3b, v4
    v_mul_f32 v5, 0x3db8aa3b, v5
    v_mul_f32 v6, 0x3db8aa3b, v6
    v_mul_f32 v7, 0x3db8aa3b, v7
    v_exp_f32 v4, v4
    v_exp_f32 v5, v5
    v_exp_f32 v6, v6
    v_exp_f32 v7, v7
    v_add_f32 v12, v4, v5
    v_add_f32 v13, v6, v7
    v_add_f32 v12, v12, v13
    v_add_f32 v12, 0x3089705f, v12
    v_rcp_f32 v12, v12
    s_add_u32 s63, s63, 8
    v_mul_f32 v4, v4, v12
    v_mul_f32 v5, v5, v12
    v_mul_f32 v6, v6, v12
    v_mul_f32 v7, v7, v12
    v_cvt_pk_bf16_f32 v4, v4, v5
    v_cvt_pk_bf16_f32 v6, v6, v7
    v_perm_b32 v112, v4, v4, v8
    v_perm_b32 v113, v4, v4, v9
    v_perm_b32 v114, v4, v4, v10
    v_perm_b32 v115, v4, v4, v11
    v_perm_b32 v116, v6, v6, v8
    v_perm_b32 v117, v6, v6, v9
    v_perm_b32 v118, v6, v6, v10
    v_perm_b32 v119, v6, v6, v11
    s_waitcnt lgkmcnt(0)
    v_mfma_f32_4x4x4_16b_bf16 v[120:123], v[112:113], v[80:81], 0 cbsz:4 abid:0
    v_mfma_f32_4x4x4_16b_bf16 v[124:127], v[112:113], v[82:83], 0 cbsz:4 abid:5
    v_mfma_f32_4x4x4_16b_bf16 v[4:7], v[112:113], v[84:85], 0 cbsz:4 abid:10
    v_mfma_f32_4x4x4_16b_bf16 v[12:15], v[112:113], v[86:87], 0 cbsz:4 abid:15
    v_mfma_f32_4x4x4_16b_bf16 v[120:123], v[114:115], v[88:89], v[120:123] cbsz:4 abid:0
    v_mfma_f32_4x4x4_16b_bf16 v[124:127], v[114:115], v[90:91], v[124:127] cbsz:4 abid:5
    v_mfma_f32_4x4x4_16b_bf16 v[4:7], v[114:115], v[92:93], v[4:7] cbsz:4 abid:10
    v_mfma_f32_4x4x4_16b_bf16 v[12:15], v[114:115], v[94:95], v[12:15] cbsz:4 abid:15
    v_mfma_f32_4x4x4_16b_bf16 v[120:123], v[116:117], v[96:97], v[120:123] cbsz:4 abid:0
    v_mfma_f32_4x4x4_16b_bf16 v[124:127], v[116:117], v[98:99], v[124:127] cbsz:4 abid:5
    v_mfma_f32_4x4x4_16b_bf16 v[4:7], v[116:117], v[100:101], v[4:7] cbsz:4 abid:10
    v_mfma_f32_4x4x4_16b_bf16 v[12:15], v[116:117], v[102:103], v[12:15] cbsz:4 abid:15
    v_mfma_f32_4x4x4_16b_bf16 v[120:123], v[118:119], v[104:105], v[120:123] cbsz:4 abid:0
    v_mfma_f32_4x4x4_16b_bf16 v[124:127], v[118:119], v[106:107], v[124:127] cbsz:4 abid:5
    v_mfma_f32_4x4x4_16b_bf16 v[4:7], v[118:119], v[108:109], v[4:7] cbsz:4 abid:10
    v_mfma_f32_4x4x4_16b_bf16 v[12:15], v[118:119], v[110:111], v[12:15] cbsz:4 abid:15
    s_nop 1
    v_cvt_pk_bf16_f32 v112, v120, v121
    v_cvt_pk_bf16_f32 v113, v122, v123
    ds_write_b64 v2, v[112:113] offset:0
    v_cvt_pk_bf16_f32 v114, v124, v125
    v_cvt_pk_bf16_f32 v115, v126, v127
    ds_write_b64 v2, v[114:115] offset:1056
    v_cvt_pk_bf16_f32 v116, v4, v5
    v_cvt_pk_bf16_f32 v117, v6, v7
    ds_write_b64 v2, v[116:117] offset:2112
    v_cvt_pk_bf16_f32 v118, v12, v13
    v_cvt_pk_bf16_f32 v119, v14, v15
    ds_write_b64 v2, v[118:119] offset:3168
    s_cmp_lt_u32 s63, 10
    s_cbranch_scc1 L_grp
L_grpx:
    s_mov_b64 exec, 1
    v_mov_b32 v4, 1
    ds_add_u32 v3, v4 offset:24
    s_mov_b64 exec, -1
    v_add_u32 v12, 105600, v1
    v_lshlrev_b32 v14, 4, v0
    v_and_b32 v6, 15, v0
    v_lshlrev_b32 v6, 2, v6
    v_and_b32 v5, 48, v0
    v_lshl_add_u32 v8, v5, 7, v6
    v_and_b32 v5, 32, v0
    v_lshl_add_u32 v9, v5, 6, v6
    v_and_b32 v5, 16, v0
    v_lshl_add_u32 v9, v5, 22, v9
    s_lshl_b32 s60, s5, 9
    s_lshl_b32 s61, s3, 6
    s_add_u32 s60, s60, s61
    s_mov_b32 s59, 0
Lw_46:
    ds_read_b32 v4, v3 offset:24
    s_waitcnt lgkmcnt(0)
    v_cmp_gt_u32 vcc, 8, v4
    s_cbranch_vccz Lk_47
    s_sleep 1
    s_add_u32 s59, s59, 1
    s_cmp_lt_u32 s59, 4194304
    s_cbranch_scc1 Lw_46
    s_branch L_end
Lk_47:
    ds_read_b128 v[80:83], v12 offset:0
    ds_read_b128 v[84:87], v12 offset:8448
    ds_read_b128 v[88:91], v12 offset:16896
    ds_read_b128 v[92:95], v12 offset:64
    ds_read_b128 v[96:99], v12 offset:8512
    ds_read_b128 v[100:103], v12 offset:16960
    s_waitcnt vmcnt(14) lgkmcnt(3)
    v_mfma_f32_16x16x32_bf16 v[104:107], v[80:83], v[16:19], 0
    v_mfma_f32_16x16x32_bf16 v[108:111], v[80:83], v[20:23], 0
    v_mfma_f32_16x16x32_bf16 v[112:115], v[84:87], v[16:19], 0
    v_mfma_f32_16x16x32_bf16 v[116:119], v[84:87], v[20:23], 0
    v_mfma_f32_16x16x32_bf16 v[120:123], v[88:91], v[16:19], 0
    v_mfma_f32_16x16x32_bf16 v[124:127], v[88:91], v[20:23], 0
    ds_read_b128 v[80:83], v12 offset:128
    ds_read_b128 v[84:87], v12 offset:8576
    ds_read_b128 v[88:91], v12 offset:17024
    s_waitcnt vmcnt(12) lgkmcnt(3)
    v_mfma_f32_16x16x32_bf16 v[104:107], v[92:95], v[24:27], v[104:107]
    v_mfma_f32_16x16x32_bf16 v[108:111], v[92:95], v[28:31], v[108:111]
    v_mfma_f32_16x16x32_bf16 v[112:115], v[96:99], v[24:27], v[112:115]
    v_mfma_f32_16x16x32_bf16 v[116:119], v[96:99], v[28:31], v[116:119]
    v_mfma_f32_16x16x32_bf16 v[120:123], v[100:103], v[24:27], v[120:123]
    v_mfma_f32_16x16x32_bf16 v[124:127], v[100:103], v[28:31], v[124:127]
    ds_read_b128 v[92:95], v12 offset:192
    ds_read_b128 v[96:99], v12 offset:8640
    ds_read_b128 v[100:103], v12 offset:17088
    s_waitcnt vmcnt(10) lgkmcnt(3)
    v_mfma_f32_16x16x32_bf16 v[104:107], v[80:83], v[32:35], v[104:107]
    v_mfma_f32_16x16x32_bf16 v[108:111], v[80:83], v[36:39], v[108:111]
    v_mfma_f32_16x16x32_bf16 v[112:115], v[84:87], v[32:35], v[112:115]
    v_mfma_f32_16x16x32_bf16 v[116:119], v[84:87], v[36:39], v[116:119]
    v_mfma_f32_16x16x32_bf16 v[120:123], v[88:91], v[32:35], v[120:123]
    v_mfma_f32_16x16x32_bf16 v[124:127], v[88:91], v[36:39], v[124:127]
    ds_read_b128 v[80:83], v12 offset:256
    ds_read_b128 v[84:87], v12 offset:8704
    ds_read_b128 v[88:91], v12 offset:17152
    s_waitcnt vmcnt(8) lgkmcnt(3)
    v_mfma_f32_16x16x32_bf16 v[104:107], v[92:95], v[40:43], v[104:107]
    v_mfma_f32_16x16x32_bf16 v[108:111], v[92:95], v[44:47], v[108:111]
    v_mfma_f32_16x16x32_bf16 v[112:115], v[96:99], v[40:43], v[112:115]
    v_mfma_f32_16x16x32_bf16 v[116:119], v[96:99], v[44:47], v[116:119]
    v_mfma_f32_16x16x32_bf16 v[120:123], v[100:103], v[40:43], v[120:123]
    v_mfma_f32_16x16x32_bf16 v[124:127], v[100:103], v[44:47], v[124:127]
    ds_read_b128 v[92:95], v12 offset:320
    ds_read_b128 v[96:99], v12 offset:8768
    ds_read_b128 v[100:103], v12 offset:17216
    s_waitcnt vmcnt(6) lgkmcnt(3)
    v_mfma_f32_16x16x32_bf16 v[104:107], v[80:83], v[48:51], v[104:107]
    v_mfma_f32_16x16x32_bf16 v[108:111], v[80:83], v[52:55], v[108:111]
    v_mfma_f32_16x16x32_bf16 v[112:115], v[84:87], v[48:51], v[112:115]
    v_mfma_f32_16x16x32_bf16 v[116:119], v[84:87], v[52:55], v[116:119]
    v_mfma_f32_16x16x32_bf16 v[120:123], v[88:91], v[48:51], v[120:123]
    v_mfma_f32_16x16x32_bf16 v[124:127], v[88:91], v[52:55], v[124:127]
    s_setprio 3
    s_add_u32 s100, s100, 118784
    buffer_load_dwordx4 v[16:19], v14, s[16:19], s100 offen offset:0 sc1
    buffer_load_dwordx4 v[20:23], v14, s[16:19], s100 offen offset:1024 sc1
    buffer_load_dwordx4 v[24:27], v14, s[16:19], s100 offen offset:2048 sc1
    buffer_load_dwordx4 v[28:31], v14, s[16:19], s100 offen offset:3072 sc1
    s_setprio 0
    ds_read_b128 v[80:83], v12 offset:384
    ds_read_b128 v[84:87], v12 offset:8832
    ds_read_b128 v[88:91], v12 offset:17280
    s_waitcnt vmcnt(8) lgkmcnt(3)
    v_mfma_f32_16x16x32_bf16 v[104:107], v[92:95], v[56:59], v[104:107]
    v_mfma_f32_16x16x32_bf16 v[108:111], v[92:95], v[60:63], v[108:111]
    v_mfma_f32_16x16x32_bf16 v[112:115], v[96:99], v[56:59], v[112:115]
    v_mfma_f32_16x16x32_bf16 v[116:119], v[96:99], v[60:63], v[116:119]
    v_mfma_f32_16x16x32_bf16 v[120:123], v[100:103], v[56:59], v[120:123]
    v_mfma_f32_16x16x32_bf16 v[124:127], v[100:103], v[60:63], v[124:127]
    s_setprio 3
    s_add_u32 s100, s100, 4096
    buffer_load_dwordx4 v[32:35], v14, s[16:19], s100 offen offset:0 sc1
    buffer_load_dwordx4 v[36:39], v14, s[16:19], s100 offen offset:1024 sc1
    buffer_load_dwordx4 v[40:43], v14, s[16:19], s100 offen offset:2048 sc1
    buffer_load_dwordx4 v[44:47], v14, s[16:19], s100 offen offset:3072 sc1
    s_setprio 0
    ds_read_b128 v[92:95], v12 offset:448
    ds_read_b128 v[96:99], v12 offset:8896
    ds_read_b128 v[100:103], v12 offset:17344
    s_waitcnt vmcnt(10) lgkmcnt(3)
    v_mfma_f32_16x16x32_bf16 v[104:107], v[80:83], v[64:67], v[104:107]
    v_mfma_f32_16x16x32_bf16 v[108:111], v[80:83], v[68:71], v[108:111]
    v_mfma_f32_16x16x32_bf16 v[112:115], v[84:87], v[64:67], v[112:115]
    v_mfma_f32_16x16x32_bf16 v[116:119], v[84:87], v[68:71], v[116:119]
    v_mfma_f32_16x16x32_bf16 v[120:123], v[88:91], v[64:67], v[120:123]
    v_mfma_f32_16x16x32_bf16 v[124:127], v[88:91], v[68:71], v[124:127]
    s_setprio 3
    s_add_u32 s100, s100, 4096
    buffer_load_dwordx4 v[48:51], v14, s[16:19], s100 offen offset:0 sc1
    buffer_load_dwordx4 v[52:55], v14, s[16:19], s100 offen offset:1024 sc1
    buffer_load_dwordx4 v[56:59], v14, s[16:19], s100 offen offset:2048 sc1
    buffer_load_dwordx4 v[60:63], v14, s[16:19], s100 offen offset:3072 sc1
    s_setprio 0
    s_waitcnt vmcnt(12) lgkmcnt(0)
    v_mfma_f32_16x16x32_bf16 v[104:107], v[92:95], v[72:75], v[104:107]
    v_mfma_f32_16x16x32_bf16 v[108:111], v[92:95], v[76:79], v[108:111]
    v_mfma_f32_16x16x32_bf16 v[112:115], v[96:99], v[72:75], v[112:115]
    v_mfma_f32_16x16x32_bf16 v[116:119], v[96:99], v[76:79], v[116:119]
    v_mfma_f32_16x16x32_bf16 v[120:123], v[100:103], v[72:75], v[120:123]
    v_mfma_f32_16x16x32_bf16 v[124:127], v[100:103], v[76:79], v[124:127]
    s_setprio 3
    s_add_u32 s100, s100, 4096
    buffer_load_dwordx4 v[64:67], v14, s[16:19], s100 offen offset:0 sc1
    buffer_load_dwordx4 v[68:71], v14, s[16:19], s100 offen offset:1024 sc1
    buffer_load_dwordx4 v[72:75], v14, s[16:19], s100 offen offset:2048 sc1
    buffer_load_dwordx4 v[76:79], v14, s[16:19], s100 offen offset:3072 sc1
    s_setprio 0
    s_setprio 3
    s_setprio 0
    v_add_u32 v12, 130944, v1
    s_mov_b32 s59, 0
Lw_48:
    ds_read_b32 v4, v3 offset:36
    s_waitcnt lgkmcnt(0)
    v_cmp_gt_u32 vcc, 16, v4
    s_cbranch_vccz Lk_49
    s_sleep 3
    s_add_u32 s59, s59, 1
    s_cmp_lt_u32 s59, 16777216
    s_cbranch_scc1 Lw_48
    s_branch L_end
Lk_49:
    ds_read_b128 v[80:83], v12 offset:0
    ds_read_b128 v[84:87], v12 offset:64
    ds_read_b128 v[88:91], v12 offset:128
    ds_read_b128 v[92:95], v12 offset:192
    ds_read_b128 v[96:99], v12 offset:256
    ds_read_b128 v[100:103], v12 offset:320
    s_waitcnt vmcnt(14) lgkmcnt(5)
    v_mfma_f32_16x16x32_bf16 v[104:107], v[80:83], v[16:19], v[104:107]
    v_mfma_f32_16x16x32_bf16 v[108:111], v[80:83], v[20:23], v[108:111]
    ds_read_b128 v[80:83], v12 offset:384
    s_waitcnt vmcnt(12) lgkmcnt(5)
    v_mfma_f32_16x16x32_bf16 v[104:107], v[84:87], v[24:27], v[104:107]
    v_mfma_f32_16x16x32_bf16 v[108:111], v[84:87], v[28:31], v[108:111]
    ds_read_b128 v[84:87], v12 offset:448
    s_waitcnt vmcnt(10) lgkmcnt(5)
    v_mfma_f32_16x16x32_bf16 v[104:107], v[88:91], v[32:35], v[104:107]
    v_mfma_f32_16x16x32_bf16 v[108:111], v[88:91], v[36:39], v[108:111]
    s_waitcnt vmcnt(8) lgkmcnt(4)
    v_mfma_f32_16x16x32_bf16 v[104:107], v[92:95], v[40:43], v[104:107]
    v_mfma_f32_16x16x32_bf16 v[108:111], v[92:95], v[44:47], v[108:111]
    s_waitcnt vmcnt(6) lgkmcnt(3)
    v_mfma_f32_16x16x32_bf16 v[104:107], v[96:99], v[48:51], v[104:107]
    v_mfma_f32_16x16x32_bf16 v[108:111], v[96:99], v[52:55], v[108:111]
    s_waitcnt vmcnt(4) lgkmcnt(2)
    v_mfma_f32_16x16x32_bf16 v[104:107], v[100:103], v[56:59], v[104:107]
    v_mfma_f32_16x16x32_bf16 v[108:111], v[100:103], v[60:63], v[108:111]
    s_waitcnt vmcnt(2) lgkmcnt(1)
    v_mfma_f32_16x16x32_bf16 v[104:107], v[80:83], v[64:67], v[104:107]
    v_mfma_f32_16x16x32_bf16 v[108:111], v[80:83], v[68:71], v[108:111]
    s_waitcnt vmcnt(0) lgkmcnt(0)
    v_mfma_f32_16x16x32_bf16 v[104:107], v[84:87], v[72:75], v[104:107]
    v_mfma_f32_16x16x32_bf16 v[108:111], v[84:87], v[76:79], v[108:111]
    s_nop 7
    v_cvt_pk_bf16_f32 v104, v104, v108
    buffer_store_dword v104, v8, s[20:23], s60 offen offset:0 sc1
    v_cvt_pk_bf16_f32 v105, v105, v109
    buffer_store_dword v105, v8, s[20:23], s60 offen offset:512 sc1
    v_cvt_pk_bf16_f32 v106, v106, v110
    buffer_store_dword v106, v8, s[20:23], s60 offen offset:1024 sc1
    v_cvt_pk_bf16_f32 v107, v107, v111
    buffer_store_dword v107, v8, s[20:23], s60 offen offset:1536 sc1
    s_add_u32 s60, s60, 8192
    s_mov_b32 s59, 0
Lw_50:
    ds_read_b32 v4, v3 offset:40
    s_waitcnt lgkmcnt(0)
    v_cmp_gt_u32 vcc, 16, v4
    s_cbranch_vccz Lk_51
    s_sleep 3
    s_add_u32 s59, s59, 1
    s_cmp_lt_u32 s59, 16777216
    s_cbranch_scc1 Lw_50
    s_branch L_end
Lk_51:
    ds_read_b128 v[80:83], v12 offset:8448
    ds_read_b128 v[84:87], v12 offset:8512
    ds_read_b128 v[88:91], v12 offset:8576
    ds_read_b128 v[92:95], v12 offset:8640
    ds_read_b128 v[96:99], v12 offset:8704
    ds_read_b128 v[100:103], v12 offset:8768
    s_waitcnt lgkmcnt(5)
    v_mfma_f32_16x16x32_bf16 v[112:115], v[80:83], v[16:19], v[112:115]
    v_mfma_f32_16x16x32_bf16 v[116:119], v[80:83], v[20:23], v[116:119]
    ds_read_b128 v[80:83], v12 offset:8832
    s_waitcnt lgkmcnt(5)
    v_mfma_f32_16x16x32_bf16 v[112:115], v[84:87], v[24:27], v[112:115]
    v_mfma_f32_16x16x32_bf16 v[116:119], v[84:87], v[28:31], v[116:119]
    ds_read_b128 v[84:87], v12 offset:8896
    s_waitcnt lgkmcnt(5)
    v_mfma_f32_16x16x32_bf16 v[112:115], v[88:91], v[32:35], v[112:115]
    v_mfma_f32_16x16x32_bf16 v[116:119], v[88:91], v[36:39], v[116:119]
    s_waitcnt lgkmcnt(4)
    v_mfma_f32_16x16x32_bf16 v[112:115], v[92:95], v[40:43], v[112:115]
    v_mfma_f32_16x16x32_bf16 v[116:119], v[92:95], v[44:47], v[116:119]
    s_waitcnt lgkmcnt(3)
    v_mfma_f32_16x16x32_bf16 v[112:115], v[96:99], v[48:51], v[112:115]
    v_mfma_f32_16x16x32_bf16 v[116:119], v[96:99], v[52:55], v[116:119]
    s_waitcnt lgkmcnt(2)
    v_mfma_f32_16x16x32_bf16 v[112:115], v[100:103], v[56:59], v[112:115]
    v_mfma_f32_16x16x32_bf16 v[116:119], v[100:103], v[60:63], v[116:119]
    s_waitcnt lgkmcnt(1)
    v_mfma_f32_16x16x32_bf16 v[112:115], v[80:83], v[64:67], v[112:115]
    v_mfma_f32_16x16x32_bf16 v[116:119], v[80:83], v[68:71], v[116:119]
    s_waitcnt lgkmcnt(0)
    v_mfma_f32_16x16x32_bf16 v[112:115], v[84:87], v[72:75], v[112:115]
    v_mfma_f32_16x16x32_bf16 v[116:119], v[84:87], v[76:79], v[116:119]
    s_nop 7
    v_cvt_pk_bf16_f32 v112, v112, v116
    buffer_store_dword v112, v8, s[20:23], s60 offen offset:0 sc1
    v_cvt_pk_bf16_f32 v113, v113, v117
    buffer_store_dword v113, v8, s[20:23], s60 offen offset:512 sc1
    v_cvt_pk_bf16_f32 v114, v114, v118
    buffer_store_dword v114, v8, s[20:23], s60 offen offset:1024 sc1
    v_cvt_pk_bf16_f32 v115, v115, v119
    buffer_store_dword v115, v8, s[20:23], s60 offen offset:1536 sc1
    s_add_u32 s60, s60, 8192
    s_mov_b32 s59, 0
Lw_52:
    ds_read_b32 v4, v3 offset:44
    s_waitcnt lgkmcnt(0)
    v_cmp_gt_u32 vcc, 8, v4
    s_cbranch_vccz Lk_53
    s_add_u32 s59, s59, 1
    s_cmp_lt_u32 s59, 16777216
    s_cbranch_scc1 Lw_52
    s_branch L_end
Lk_53:
    ds_read_b128 v[80:83], v12 offset:16896
    ds_read_b128 v[84:87], v12 offset:16960
    ds_read_b128 v[88:91], v12 offset:17024
    ds_read_b128 v[92:95], v12 offset:17088
    ds_read_b128 v[96:99], v12 offset:17152
    ds_read_b128 v[100:103], v12 offset:17216
    s_waitcnt lgkmcnt(5)
    v_mfma_f32_16x16x32_bf16 v[120:123], v[80:83], v[16:19], v[120:123]
    v_mfma_f32_16x16x32_bf16 v[124:127], v[80:83], v[20:23], v[124:127]
    ds_read_b128 v[80:83], v12 offset:17280
    s_waitcnt lgkmcnt(5)
    v_mfma_f32_16x16x32_bf16 v[120:123], v[84:87], v[24:27], v[120:123]
    v_mfma_f32_16x16x32_bf16 v[124:127], v[84:87], v[28:31], v[124:127]
    ds_read_b128 v[84:87], v12 offset:17344
    s_waitcnt lgkmcnt(5)
    v_mfma_f32_16x16x32_bf16 v[120:123], v[88:91], v[32:35], v[120:123]
    v_mfma_f32_16x16x32_bf16 v[124:127], v[88:91], v[36:39], v[124:127]
    s_waitcnt lgkmcnt(4)
    v_mfma_f32_16x16x32_bf16 v[120:123], v[92:95], v[40:43], v[120:123]
    v_mfma_f32_16x16x32_bf16 v[124:127], v[92:95], v[44:47], v[124:127]
    s_waitcnt lgkmcnt(3)
    v_mfma_f32_16x16x32_bf16 v[120:123], v[96:99], v[48:51], v[120:123]
    v_mfma_f32_16x16x32_bf16 v[124:127], v[96:99], v[52:55], v[124:127]
    s_waitcnt lgkmcnt(2)
    v_mfma_f32_16x16x32_bf16 v[120:123], v[100:103], v[56:59], v[120:123]
    v_mfma_f32_16x16x32_bf16 v[124:127], v[100:103], v[60:63], v[124:127]
    s_waitcnt lgkmcnt(1)
    v_mfma_f32_16x16x32_bf16 v[120:123], v[80:83], v[64:67], v[120:123]
    v_mfma_f32_16x16x32_bf16 v[124:127], v[80:83], v[68:71], v[124:127]
    s_waitcnt lgkmcnt(0)
    v_mfma_f32_16x16x32_bf16 v[120:123], v[84:87], v[72:75], v[120:123]
    v_mfma_f32_16x16x32_bf16 v[124:127], v[84:87], v[76:79], v[124:127]
    s_nop 7
    v_cvt_pk_bf16_f32 v120, v120, v124
    buffer_store_dword v120, v9, s[20:23], s60 offen offset:0 sc1
    v_cvt_pk_bf16_f32 v121, v121, v125
    buffer_store_dword v121, v9, s[20:23], s60 offen offset:512 sc1
    v_cvt_pk_bf16_f32 v122, v122, v126
    buffer_store_dword v122, v9, s[20:23], s60 offen offset:1024 sc1
    v_cvt_pk_bf16_f32 v123, v123, v127
    buffer_store_dword v123, v9, s[20:23], s60 offen offset:1536 sc1
L_end:
L_exit:
    s_endpgm
L_slow:
    s_setprio 0
    ds_add_u32 v61, v62 offset:16
    s_mov_b32 s59, 0
Lw_54:
    ds_read_b32 v4, v3 offset:16
    s_waitcnt lgkmcnt(0)
    v_cmp_gt_u32 vcc, 8, v4
    s_cbranch_vccz Lk_55
    s_add_u32 s59, s59, 1
    s_cmp_lt_u32 s59, 4194304
    s_cbranch_scc1 Lw_54
    s_branch L_end
Lk_55:
    v_mov_b32 v12, v3
    s_mov_b64 s[24:25], s[34:35]
    s_mov_b32 s26, 640000
    s_mov_b64 s[28:29], s[36:37]
    s_mov_b32 s30, 640000
    s_mov_b64 s[12:13], s[42:43]
    s_mov_b32 s14, 20000
    s_mov_b32 s15, 0x20000
    s_sub_u32 s63, s67, 1
    s_mov_b32 s65, 201486528
    s_mov_b32 s64, 0
    s_call_b64 s[68:69], L_flush
    s_add_u32 s66, s4, s5
    s_add_u32 s67, s66, 40
    v_lshlrev_b32 v16, 2, v0
    v_and_b32 v17, 32, v0
    v_lshl_add_u32 v17, v17, 22, v2
    v_mov_b32 v24, 0
L_sn:
    s_mov_b32 s60, 0
L_sc:
    buffer_load_dword v18, v16, s[28:31], s60 offen
    buffer_load_dword v19, v16, s[24:27], s60 offen
    s_waitcnt vmcnt(0)
    v_cmp_eq_u32 vcc, s66, v18
    s_cbranch_vccz L_sx
L_se:
    s_ff1_i32_b64 s58, vcc
    s_bitset0_b64 vcc, s58
    v_readlane_b32 s59, v19, s58
    s_nop 0
    s_lshl_b32 s61, s59, 9
    s_lshl_b32 s59, s59, 1
    buffer_load_dwordx4 v[20:23], v17, s[8:11], s61 offen
    buffer_load_ushort v1, v24, s[12:15], s59 offen
    s_waitcnt vmcnt(0)
    v_perm_b32 v6, v1, v1, v10
    v_perm_b32 v7, v1, v1, v11
    s_nop 1
    v_mfma_f32_4x4x4_16b_bf16 v[56:59], v[6:7], v[20:21], v[56:59]
    v_mfma_f32_4x4x4_16b_bf16 v[60:63], v[6:7], v[22:23], v[60:63]
    s_cmp_lg_u64 vcc, 0
    s_cbranch_scc1 L_se
L_sx:
    s_add_u32 s60, s60, 256
    s_cmp_lt_u32 s60, 640000
    s_cbranch_scc1 L_sc
    s_call_b64 s[68:69], L_flush
    s_add_u32 s66, s66, 8
    s_cmp_lt_u32 s66, s67
    s_cbranch_scc1 L_sn
    s_branch L_gdone
.section .rodata,"a"
.p2align 6
.amdhsa_kernel standalone__hybrid_graph_tf_exphormer__graph_kernel
  .amdhsa_next_free_vgpr 128
  .amdhsa_next_free_sgpr 102
  .amdhsa_accum_offset 128
  .amdhsa_group_segment_fixed_size 0
  .amdhsa_kernarg_size 104
  .amdhsa_user_sgpr_count 2
  .amdhsa_user_sgpr_kernarg_segment_ptr 1
  .amdhsa_system_sgpr_workgroup_id_x 1
.end_amdhsa_kernel
```

```asm
; @launch grid=(250,1,1) block=(1024,1,1) lds=161984
.amdgcn_target "amdgcn-amd-amdhsa--gfx950"
.text
.globl standalone__hybrid_graph_tf_exphormer__graph_kernel
.p2align 8
.type standalone__hybrid_graph_tf_exphormer__graph_kernel,@function
standalone__hybrid_graph_tf_exphormer__graph_kernel:
    s_cmp_ge_u32 s2, 250
    s_cbranch_scc1 L_exit
    s_load_dwordx16 s[32:47], s[0:1], 0
    s_load_dwordx8 s[48:55], s[0:1], 64
    s_load_dwordx2 s[56:57], s[0:1], 96
    s_getpc_b64 s[60:61]
    s_lshr_b32 s6, s2, 3
    v_lshl_add_u32 v1, v0, 5, s6
    v_cmp_gt_u32 vcc, 85, v1
    v_lshlrev_b32 v1, 7, v1
    s_and_saveexec_b64 s[58:59], vcc
    s_cbranch_execz L_nopf
    global_load_dword v15, v1, s[60:61]
L_nopf:
    s_mov_b64 exec, -1
    v_lshrrev_b32 v1, 6, v0
    v_mov_b32 v8, 33554432
    v_readfirstlane_b32 s3, v1
    v_cmp_gt_u32 vcc, 288, v0
    v_lshlrev_b32 v5, 4, v0
    v_add_u32 v4, 152064, v5
    v_cndmask_b32 v8, 0, v8, vcc
    v_mov_b32 v9, v8
    v_mov_b64 v[10:11], v[8:9]
    v_cmp_gt_u32 vcc, 556, v0
    s_and_saveexec_b64 s[58:59], vcc
    ds_write_b128 v4, v[8:11]
    s_mov_b64 exec, -1
    v_and_b32 v0, 63, v0
    v_and_b32 v2, 31, v0
    v_lshlrev_b32 v2, 4, v2
    s_and_b32 s59, s2, 7
    s_mul_i32 s60, s59, 31
    s_min_u32 s59, s59, 2
    s_add_u32 s6, s6, s60
    s_add_u32 s6, s6, s59
    s_mov_b32 s27, 0x20000
    s_mov_b32 s31, 0x20000
    s_xor_b32 s3, s3, 8
    s_and_b32 s4, s3, 7
    s_cmp_lt_u32 s3, 8
    s_cbranch_scc1 L_e3
    s_setprio 3
    s_cmp_ge_u32 s2, 64
    s_cbranch_scc1 L_e1
    v_lshrrev_b32 v6, 2, v5
    s_mul_i32 s58, s2, 10000
    s_add_u32 s60, s58, 8192
    s_mov_b32 s26, 640000
    s_mov_b32 s30, 640000
    s_mov_b32 s59, 1048576
    s_mov_b32 s63, 1
    s_waitcnt lgkmcnt(0)
    s_mov_b64 s[28:29], s[36:37]
    s_mov_b64 s[24:25], s[34:35]
    buffer_load_dwordx4 v[22:25], v5, s[28:31], s58 offen
    buffer_load_dword v26, v6, s[28:31], s60 offen
    s_setprio 2
    buffer_load_dwordx4 v[16:19], v5, s[24:27], s58 offen
    buffer_load_dword v20, v6, s[24:27], s60 offen
    s_setprio 3
L_ep:
    s_load_dword s40, s[56:57], s59
    s_branch L_bar
L_e1:
    s_mov_b32 s26, 131072
    s_sub_u32 s60, s3, 9
    s_cmp_lt_u32 s60, 3
    s_cbranch_scc1 L_e1b
    s_mov_b32 s63, 0
    s_cmp_eq_u32 s3, 8
    s_cbranch_scc0 L_barw
    s_mov_b32 s63, 5
    s_mov_b32 s59, 1048576
    s_waitcnt lgkmcnt(0)
    s_branch L_ep
L_e1b:
    s_sub_u32 s62, s2, 64
    s_cmp_ge_u32 s62, 128
    s_cbranch_scc1 L_e2
    s_and_b32 s58, s62, 7
    s_lshr_b32 s59, s62, 4
    s_bfe_u32 s61, s62, 0x10003
    s_cmp_eq_u32 s60, 2
    s_cselect_b32 s58, s59, s58
    s_cselect_b32 s61, s61, s60
    s_lshl_b32 s58, s58, 14
    s_lshl_b32 s61, s61, 11
    s_add_u32 s58, s58, s61
    s_add_u32 s59, s58, 4096
    v_and_b32 v4, 32, v0
    v_lshl_add_u32 v4, v4, 8, v2
    s_mul_i32 s61, s60, 8448
    s_add_u32 m0, s61, 105600
    s_cmp_eq_u32 s60, 0
    s_cselect_b32 s63, 2, 3
    s_cmp_eq_u32 s60, 2
    s_waitcnt lgkmcnt(0)
    s_cselect_b64 s[24:25], s[48:49], s[46:47]
    buffer_load_dwordx4 v4, s[24:27], s58 offen offset:0 lds
    s_add_u32 m0, m0, 544
    s_nop 0
    buffer_load_dwordx4 v4, s[24:27], s58 offen offset:512 lds
    s_add_u32 m0, m0, 544
    s_nop 0
    buffer_load_dwordx4 v4, s[24:27], s58 offen offset:1024 lds
    s_add_u32 m0, m0, 544
    s_nop 0
    buffer_load_dwordx4 v4, s[24:27], s58 offen offset:1536 lds
    s_add_u32 m0, m0, 2592
    s_nop 0
    buffer_load_dwordx4 v4, s[24:27], s59 offen offset:0 lds
    s_add_u32 m0, m0, 544
    s_nop 0
    buffer_load_dwordx4 v4, s[24:27], s59 offen offset:512 lds
    s_add_u32 m0, m0, 544
    s_nop 0
    buffer_load_dwordx4 v4, s[24:27], s59 offen offset:1024 lds
    s_add_u32 m0, m0, 544
    s_nop 0
    buffer_load_dwordx4 v4, s[24:27], s59 offen offset:1536 lds
    s_branch L_bar
L_e2:
    s_mul_i32 s60, s60, 58
    s_add_u32 s62, s62, s60
    s_sub_u32 s62, s62, 128
    s_mov_b32 s63, 3
    s_cmp_ge_u32 s62, 128
    s_cbranch_scc1 L_barw
    s_mov_b32 s63, 4
    s_and_b32 s59, s62, 7
    s_lshl_b32 s59, s59, 14
    s_bfe_u32 s60, s62, 0x30003
    s_lshl_b32 s60, s60, 6
    s_add_u32 s59, s59, s60
    v_and_b32 v4, 15, v0
    v_lshlrev_b32 v4, 2, v4
    v_and_b32 v5, 48, v0
    v_lshl_add_u32 v4, v5, 8, v4
    s_cmp_lt_u32 s62, 64
    s_waitcnt lgkmcnt(0)
    s_cselect_b64 s[24:25], s[50:51], s[44:45]
    buffer_load_dword v16, v4, s[24:27], s59 offen offset:0
    buffer_load_dword v17, v4, s[24:27], s59 offen offset:512
    buffer_load_dword v18, v4, s[24:27], s59 offen offset:1024
    buffer_load_dword v19, v4, s[24:27], s59 offen offset:1536
    buffer_load_dword v20, v4, s[24:27], s59 offen offset:2048
    buffer_load_dword v21, v4, s[24:27], s59 offen offset:2560
    buffer_load_dword v22, v4, s[24:27], s59 offen offset:3072
    buffer_load_dword v23, v4, s[24:27], s59 offen offset:3584
    s_branch L_bar
L_e3:
    s_mul_i32 s58, s6, 640
    s_lshl_b32 s59, s3, 6
    s_add_u32 s59, s59, s58
    s_lshr_b32 s60, s3, 2
    s_lshl_b32 s60, s60, 6
    s_and_b32 s61, s3, 3
    s_lshl_b32 s61, s61, 3
    s_add_u32 s60, s60, s61
    s_add_u32 s60, s60, s58
    s_add_u32 s60, s60, 512
    s_add_u32 s61, s60, 32
    s_waitcnt lgkmcnt(0)
    s_mov_b64 s[62:63], s[38:39]
    s_mov_b64 s[8:9], s[32:33]
    s_load_dwordx16 s[32:47], s[62:63], s59
    s_load_dwordx2 s[64:65], s[62:63], s60
    s_load_dwordx2 s[66:67], s[62:63], s61
    s_barrier
    s_branch L_preA
L_barw:
    s_waitcnt lgkmcnt(0)
L_bar:
    s_barrier
    s_mov_b64 s[8:9], s[32:33]
    s_mul_i32 s5, s6, 40
    v_mov_b32 v3, 159296
    s_mov_b32 s10, 5120000
    s_mov_b32 s11, 0x20000
    s_mov_b64 s[16:17], s[56:57]
    s_mov_b32 s18, 1441792
    s_mov_b32 s19, 0x20000
    v_min_u32 v4, 1, v0
    v_lshl_add_u32 v61, v0, 2, v3
    v_lshl_add_u32 v61, v4, 16, v61
    v_mov_b32 v62, 1
    s_cmp_eq_u32 s63, 1
    s_cbranch_scc0 L_notprod
    v_mov_b32 v9, 4
    v_mov_b32 v10, 159936
    v_lshl_add_u32 v11, v0, 4, v10
    v_cmp_gt_u32 vcc, 7232, v5
    v_add_u32 v59, 105600, v5
    s_mul_i32 s58, s2, 10240
    s_mov_b64 s[66:67], vcc
    s_waitcnt vmcnt(3)
    v_mul_u32_u24 v28, 52429, v22
    v_lshrrev_b32 v28, 21, v28
    v_lshl_add_u32 v28, v28, 2, v10
    ds_add_rtn_u32 v34, v28, v9
    v_mul_u32_u24 v29, 52429, v23
    v_lshrrev_b32 v29, 21, v29
    v_lshl_add_u32 v29, v29, 2, v10
    ds_add_rtn_u32 v35, v29, v9
    v_mul_u32_u24 v30, 52429, v24
    v_lshrrev_b32 v30, 21, v30
    v_lshl_add_u32 v30, v30, 2, v10
    ds_add_rtn_u32 v36, v30, v9
    v_mul_u32_u24 v31, 52429, v25
    v_lshrrev_b32 v31, 21, v31
    v_lshl_add_u32 v31, v31, 2, v10
    ds_add_rtn_u32 v37, v31, v9
    s_waitcnt vmcnt(2)
    s_mov_b64 exec, s[66:67]
    v_mul_u32_u24 v32, 52429, v26
    v_lshrrev_b32 v32, 21, v32
    v_lshl_add_u32 v32, v32, 2, v10
    ds_add_rtn_u32 v38, v32, v9
    s_mov_b64 exec, -1
    s_waitcnt lgkmcnt(0)
    s_barrier
    ds_read_b128 v[12:15], v11
    s_add_u32 s40, s40, 4096
    s_and_b32 s40, s40, 4294963200
    s_waitcnt lgkmcnt(0)
    v_add_u32 v56, v12, v13
    v_add3_u32 v57, v56, v14, v15
    s_nop 1
    v_add_u32_dpp v58, v57, v57 row_shr:1 row_mask:0xf bank_mask:0xf bound_ctrl:1
    s_nop 1
    v_add_u32_dpp v58, v58, v58 row_shr:2 row_mask:0xf bank_mask:0xf bound_ctrl:1
    s_nop 1
    v_add_u32_dpp v58, v58, v58 row_shr:4 row_mask:0xf bank_mask:0xf bound_ctrl:1
    s_nop 1
    v_add_u32_dpp v58, v58, v58 row_shr:8 row_mask:0xf bank_mask:0xf bound_ctrl:1
    s_nop 1
    v_add_u32_dpp v58, v58, v58 row_bcast:15 row_mask:0xa bank_mask:0xf
    s_nop 1
    v_add_u32_dpp v58, v58, v58 row_bcast:31 row_mask:0xc bank_mask:0xf
    v_sub_u32 v64, v58, v57
    v_add_u32 v65, v64, v12
    v_add_u32 v66, v64, v56
    v_add_u32 v67, v66, v14
    ds_write_b128 v11, v[64:67] offset:1024
    ds_read_b32 v40, v28 offset:1024
    ds_read_b32 v41, v29 offset:1024
    ds_read_b32 v42, v30 offset:1024
    ds_read_b32 v43, v31 offset:1024
    s_mov_b64 exec, s[66:67]
    ds_read_b32 v44, v32 offset:1024
    s_mov_b64 exec, -1
    s_mov_b32 s60, 105600
    s_waitcnt vmcnt(0)
    v_lshl_or_b32 v16, v22, 16, v16
    v_lshl_or_b32 v17, v23, 16, v17
    v_lshl_or_b32 v18, v24, 16, v18
    v_lshl_or_b32 v19, v25, 16, v19
    v_lshl_or_b32 v20, v26, 16, v20
    s_waitcnt lgkmcnt(4)
    v_add3_u32 v40, v40, v34, s60
    ds_write_b32 v40, v16
    s_waitcnt lgkmcnt(4)
    v_add3_u32 v41, v41, v35, s60
    ds_write_b32 v41, v17
    s_waitcnt lgkmcnt(4)
    v_add3_u32 v42, v42, v36, s60
    ds_write_b32 v42, v18
    s_waitcnt lgkmcnt(4)
    v_add3_u32 v43, v43, v37, s60
    ds_write_b32 v43, v19
    s_mov_b64 exec, s[66:67]
    s_waitcnt lgkmcnt(4)
    v_add3_u32 v44, v44, v38, s60
    ds_write_b32 v44, v20
    s_mov_b64 exec, -1
    v_lshrrev_b32 v64, 2, v64
    v_or_b32 v64, s40, v64
    v_lshrrev_b32 v65, 2, v65
    v_or_b32 v65, s40, v65
    v_lshrrev_b32 v66, 2, v66
    v_or_b32 v66, s40, v66
    v_lshrrev_b32 v67, 2, v67
    v_or_b32 v67, s40, v67
    s_waitcnt lgkmcnt(0)
    s_barrier
    ds_read_b128 v[12:15], v59
    ds_read_b128 v[68:71], v59 offset:8192
    s_add_u32 s60, s58, 8192
    s_cmp_ge_u32 s4, 2
    s_waitcnt lgkmcnt(1)
    buffer_store_dwordx4 v[12:15], v5, s[16:19], s58 offen sc1
    s_cbranch_scc1 L_cp1
    s_waitcnt lgkmcnt(0)
    buffer_store_dwordx4 v[68:71], v5, s[16:19], s60 offen sc1
L_cp1:
    s_waitcnt vmcnt(0)
    ds_add_u32 v61, v62 offset:56
    s_cmp_eq_u32 s4, 0
    s_cbranch_scc0 L_preB
    s_lshl_b32 s61, s2, 10
    s_add_u32 s61, s61, 1114112
    s_or_b32 s60, s40, 1
    v_mov_b32 v8, s60
    s_mov_b32 s59, 0
Lw_1:
    ds_read_b32 v4, v3 offset:56
    s_waitcnt lgkmcnt(0)
    v_cmp_gt_u32 vcc, 8, v4
    s_cbranch_vccz Lk_2
    s_add_u32 s59, s59, 1
    s_cmp_lt_u32 s59, 4194304
    s_cbranch_scc1 Lw_1
    s_branch L_end
Lk_2:
    buffer_store_dwordx4 v[64:67], v5, s[16:19], s61 offen sc1
    ds_write_b32 v3, v8 offset:32
    s_branch L_preB
L_notprod:
    s_cmp_eq_u32 s63, 0
    s_cbranch_scc1 L_preB
    s_cmp_eq_u32 s63, 3
    s_cbranch_scc1 L_taskw
    s_cmp_eq_u32 s63, 4
    s_cbranch_scc1 L_wtask
    s_cmp_eq_u32 s63, 5
    s_cbranch_scc1 L_flag
    v_and_b32 v4, 7, v0
    v_mul_u32_u24 v1, 1056, v4
    v_and_b32 v4, 8, v0
    v_lshl_add_u32 v1, v4, 6, v1
    v_and_b32 v4, 48, v0
    v_add_u32 v1, v4, v1
    v_add_u32 v5, 105600, v1
    s_lshr_b32 s58, s62, 4
    s_lshl_b32 s58, s58, 3
    s_and_b32 s59, s62, 7
    s_add_u32 s58, s58, s59
    s_lshl_b32 s58, s58, 1
    s_bfe_u32 s59, s62, 0x10003
    s_add_u32 s58, s58, s59
    s_lshl_b32 s58, s58, 10
    s_add_u32 s58, s58, 655360
    v_lshlrev_b32 v6, 4, v0
    s_waitcnt vmcnt(0)
    s_mov_b32 s59, 0
Lw_3:
    ds_read_b32 v4, v3 offset:56
    s_waitcnt lgkmcnt(0)
    v_cmp_gt_u32 vcc, 2, v4
    s_cbranch_vccz Lk_4
    s_add_u32 s59, s59, 1
    s_cmp_lt_u32 s59, 4194304
    s_cbranch_scc1 Lw_3
    s_branch L_end
Lk_4:
    ds_read_b128 v[16:19], v5 offset:0
    ds_read_b128 v[20:23], v5 offset:8448
    ds_read_b128 v[24:27], v5 offset:16896
    ds_read_b128 v[28:31], v5 offset:64
    ds_read_b128 v[32:35], v5 offset:8512
    ds_read_b128 v[36:39], v5 offset:16960
    ds_read_b128 v[40:43], v5 offset:128
    ds_read_b128 v[44:47], v5 offset:8576
    ds_read_b128 v[48:51], v5 offset:17024
    ds_read_b128 v[64:67], v5 offset:192
    ds_read_b128 v[68:71], v5 offset:8640
    ds_read_b128 v[72:75], v5 offset:17088
    s_waitcnt lgkmcnt(9)
    ds_read_b128 v[76:79], v5 offset:256
    ds_read_b128 v[80:83], v5 offset:8704
    ds_read_b128 v[84:87], v5 offset:17152
    v_mfma_f32_16x16x32_bf16 v[8:11], v[16:19], v[24:27], 0
    v_mfma_f32_16x16x32_bf16 v[12:15], v[20:23], v[24:27], 0
    s_waitcnt lgkmcnt(9)
    ds_read_b128 v[88:91], v5 offset:320
    ds_read_b128 v[92:95], v5 offset:8768
    ds_read_b128 v[96:99], v5 offset:17216
    v_mfma_f32_16x16x32_bf16 v[8:11], v[28:31], v[36:39], v[8:11]
    v_mfma_f32_16x16x32_bf16 v[12:15], v[32:35], v[36:39], v[12:15]
    s_waitcnt lgkmcnt(9)
    ds_read_b128 v[100:103], v5 offset:384
    ds_read_b128 v[104:107], v5 offset:8832
    ds_read_b128 v[108:111], v5 offset:17280
    v_mfma_f32_16x16x32_bf16 v[8:11], v[40:43], v[48:51], v[8:11]
    v_mfma_f32_16x16x32_bf16 v[12:15], v[44:47], v[48:51], v[12:15]
    s_waitcnt lgkmcnt(9)
    ds_read_b128 v[112:115], v5 offset:448
    ds_read_b128 v[116:119], v5 offset:8896
    ds_read_b128 v[120:123], v5 offset:17344
    v_mfma_f32_16x16x32_bf16 v[8:11], v[64:67], v[72:75], v[8:11]
    v_mfma_f32_16x16x32_bf16 v[12:15], v[68:71], v[72:75], v[12:15]
    s_waitcnt lgkmcnt(9)
    v_mfma_f32_16x16x32_bf16 v[8:11], v[76:79], v[84:87], v[8:11]
    v_mfma_f32_16x16x32_bf16 v[12:15], v[80:83], v[84:87], v[12:15]
    s_waitcnt lgkmcnt(6)
    v_mfma_f32_16x16x32_bf16 v[8:11], v[88:91], v[96:99], v[8:11]
    v_mfma_f32_16x16x32_bf16 v[12:15], v[92:95], v[96:99], v[12:15]
    s_waitcnt lgkmcnt(3)
    v_mfma_f32_16x16x32_bf16 v[8:11], v[100:103], v[108:111], v[8:11]
    v_mfma_f32_16x16x32_bf16 v[12:15], v[104:107], v[108:111], v[12:15]
    s_waitcnt lgkmcnt(0)
    v_mfma_f32_16x16x32_bf16 v[8:11], v[112:115], v[120:123], v[8:11]
    v_mfma_f32_16x16x32_bf16 v[12:15], v[116:119], v[120:123], v[12:15]
    s_nop 6
    v_cvt_pk_bf16_f32 v16, v8, v9
    v_cvt_pk_bf16_f32 v17, v10, v11
    v_cvt_pk_bf16_f32 v18, v12, v13
    v_cvt_pk_bf16_f32 v19, v14, v15
    buffer_store_dwordx4 v[16:19], v6, s[16:19], s58 offen sc1
    s_branch L_taskw
L_wtask:
    s_lshl_b32 s58, s62, 11
    s_add_u32 s58, s58, 786432
    v_lshlrev_b32 v6, 4, v0
    s_mov_b32 s70, 0x05040100
    s_mov_b32 s71, 0x07060302
    s_waitcnt vmcnt(0)
    v_perm_b32 v64, v17, v16, s70
    v_perm_b32 v68, v17, v16, s71
    v_perm_b32 v65, v19, v18, s70
    v_perm_b32 v69, v19, v18, s71
    v_perm_b32 v66, v21, v20, s70
    v_perm_b32 v70, v21, v20, s71
    v_perm_b32 v67, v23, v22, s70
    v_perm_b32 v71, v23, v22, s71
    buffer_store_dwordx4 v[64:67], v6, s[16:19], s58 offen sc1
    buffer_store_dwordx4 v[68:71], v6, s[16:19], s58 offen offset:1024 sc1
L_taskw:
    s_waitcnt vmcnt(0)
    ds_add_u32 v61, v62 offset:56
    s_branch L_preB
L_flag:
    s_waitcnt vmcnt(0) lgkmcnt(0)
    s_add_u32 s40, s40, 4096
    s_and_b32 s40, s40, 4294963200
    s_mul_i32 s61, s2, 16
    s_add_u32 s61, s61, 1178624
    s_or_b32 s60, s40, 1
    v_mov_b32 v8, s60
    v_mov_b32 v10, s40
    v_mov_b32 v11, s40
    v_lshlrev_b32 v9, 15, v0
    s_mov_b32 s59, 0
Lw_5:
    ds_read_b32 v4, v3 offset:56
    s_waitcnt lgkmcnt(0)
    v_cmp_gt_u32 vcc, 3, v4
    s_cbranch_vccz Lk_6
    s_add_u32 s59, s59, 1
    s_cmp_lt_u32 s59, 4194304
    s_cbranch_scc1 Lw_5
    s_branch L_end
Lk_6:
    s_mov_b64 exec, 255
    buffer_store_dwordx2 v[10:11], v9, s[16:19], s61 offen sc1
    ds_write_b32 v3, v8 offset:32
    s_mov_b64 exec, -1
L_preB:
    s_setprio 3
    s_mov_b64 s[28:29], s[42:43]
    s_mov_b32 s30, 20000
    s_setprio 3
    s_lshl_b32 s58, s4, 10
    v_lshlrev_b32 v5, 4, v0
    s_add_u32 m0, s58, 130944
    s_add_u32 s59, s58, 0
    buffer_load_dwordx4 v5, s[28:31], s59 offen lds
    s_add_u32 m0, s58, 139136
    s_add_u32 s59, s58, 8192
    buffer_load_dwordx4 v5, s[28:31], s59 offen lds
    s_cmp_lt_u32 s4, 4
    s_cbranch_scc1 L_disd
    s_add_u32 m0, s58, 143232
    s_add_u32 s59, s58, 12288
    buffer_load_dwordx4 v5, s[28:31], s59 offen lds
L_disd:
    s_setprio 3
    v_and_b32 v4, 3, v0
    v_mov_b32 v5, 0x0c0c0c0c
    v_mov_b32 v6, 0x0c0c0302
    v_mov_b32 v7, 0x03020c0c
    v_cmp_eq_u32 s[58:59], 0, v4
    v_cmp_eq_u32 s[60:61], 2, v4
    v_cmp_eq_u32 vcc, 1, v4
    v_cndmask_b32 v10, v5, v6, s[58:59]
    v_cndmask_b32 v11, v5, v6, s[60:61]
    v_cndmask_b32 v10, v10, v7, vcc
    v_cmp_eq_u32 vcc, 3, v4
    s_nop 1
    v_cndmask_b32 v11, v11, v7, vcc
    v_and_b32 v10, 0xfdfdfdfd, v10
    v_and_b32 v11, 0xfdfdfdfd, v11
    s_movk_i32 s7, 512
    s_lshl_b32 s58, s4, 3
    v_lshrrev_b32 v5, 3, v0
    v_and_b32 v6, 7, v0
    v_add_u32 v7, s58, v5
    v_mul_u32_u24 v49, 10240, v7
    v_lshl_add_u32 v49, v6, 4, v49
    v_lshlrev_b32 v56, 2, v6
    s_lshl_b32 s60, s6, 2
    s_add_u32 s60, s60, 1114112
    v_lshl_add_u32 v54, v7, 10, s60
    v_mad_u32_u24 v7, v7, 3, v6
    v_cmp_ge_u32 vcc, 186, v7
    v_cmp_gt_u32 s[64:65], 4, v6
    v_mul_u32_u24 v7, 16, v7
    s_and_b64 s[64:65], s[64:65], vcc
    v_cmp_eq_u32 vcc, 0, v6
    s_and_b32 s58, s2, 7
    s_lshl_b32 s58, s58, 15
    s_add_u32 s58, s58, 1179632
    v_add_u32 v7, s58, v7
    s_or_b64 s[64:65], s[64:65], vcc
    v_cndmask_b32 v54, v7, v54, vcc
    v_cmp_gt_u32 s[62:63], 5, v6
    v_lshl_add_u32 v50, v6, 3, v5
    v_mul_u32_u24 v55, 72, v5
    v_add_u32 v55, 72, v55
    v_lshrrev_b32 v5, 4, v50
    v_mul_u32_u24 v9, 8448, v5
    v_lshl_add_u32 v9, v5, 26, v9
    v_cmp_le_u32 vcc, 32, v50
    v_and_b32 v5, 7, v50
    v_and_b32 v6, 3, v50
    v_cndmask_b32 v5, v5, v6, vcc
    v_mul_u32_u24 v5, 1056, v5
    v_bfe_u32 v6, v50, 3, 1
    v_bfe_u32 v7, v50, 2, 1
    v_cndmask_b32 v6, v6, v7, vcc
    v_lshl_add_u32 v5, v6, 9, v5
    v_mov_b32 v52, 130944
    v_add3_u32 v9, v9, v5, v52
    v_lshrrev_b32 v5, 5, v0
    v_lshl_add_u32 v15, v5, 3, v2
    s_lshl_b32 s58, s5, 2
    s_sub_u32 s58, 158976, s58
    v_mov_b32 v53, s58
    v_add_u32 v5, s5, v50
    v_lshl_add_u32 v8, v5, 1, v52
    v_lshlrev_b32 v50, 2, v50
    v_add_u32 v50, 158976, v50
    v_mov_b32 v57, 156672
    v_mov_b32 v60, 152064
    v_mov_b64 v[16:17], 0
    v_mov_b64 v[18:19], 0
    s_mov_b32 s59, 0
Lw_7:
    ds_read_b32 v4, v3 offset:60
    s_waitcnt lgkmcnt(0)
    v_cmp_gt_u32 vcc, 8, v4
    s_cbranch_vccz Lk_8
    s_sleep 2
    s_add_u32 s59, s59, 1
    s_cmp_lt_u32 s59, 4194304
    s_cbranch_scc1 Lw_7
    s_branch L_end
Lk_8:
    s_mov_b32 s59, 0
Lw_9:
    ds_read_b32 v4, v3 offset:32
    s_waitcnt lgkmcnt(0)
    v_cmp_gt_u32 vcc, 1, v4
    s_cbranch_vccz Lk_10
    s_sleep 1
    s_add_u32 s59, s59, 1
    s_cmp_lt_u32 s59, 4194304
    s_cbranch_scc1 Lw_9
    s_branch L_end
Lk_10:
    v_readfirstlane_b32 s40, v4
    s_mov_b32 s59, 0
    s_bitset0_b32 s40, 0
    s_and_b32 exec_lo, s64, 0xfefefefe
    s_and_b32 exec_hi, s65, 0xfefefefe
L_spolla:
    buffer_load_dwordx2 v[58:59], v54, s[16:19], 0 offen sc1
    s_add_u32 s59, s59, 1
    s_cmp_gt_u32 s59, 0x40000
    s_cbranch_scc1 L_end
    s_waitcnt vmcnt(0)
    v_xor_b32 v58, s40, v58
    v_xor_b32 v59, s40, v59
    v_or_b32 v5, v58, v59
    v_cmpx_lt_u32 vcc, 4095, v5
    s_cbranch_execz L_soka
    s_sleep 8
    s_branch L_spolla
L_soka:
    s_mov_b64 exec, -1
    ds_add_u32 v61, v62 offset:52
    s_mov_b32 exec_lo, 0x01010101
    s_mov_b32 exec_hi, 0x01010101
L_spollb:
    buffer_load_dwordx2 v[58:59], v54, s[16:19], 0 offen sc1
    s_add_u32 s59, s59, 1
    s_cmp_gt_u32 s59, 0x40000
    s_cbranch_scc1 L_end
    s_waitcnt vmcnt(0)
    v_xor_b32 v58, s40, v58
    v_xor_b32 v59, s40, v59
    v_or_b32 v5, v58, v59
    v_cmpx_lt_u32 vcc, 4095, v5
    s_cbranch_execz L_sokb
    s_sleep 8
    s_branch L_spollb
L_sokb:
    s_mov_b64 exec, -1
    v_sub_u32 v48, v59, v58
    v_lshl_or_b32 v48, v48, 16, v58
    s_nop 1
    v_mov_b32_dpp v48, v48 quad_perm:[0,0,0,0] row_mask:0xf bank_mask:0xf
    s_nop 1
    v_mov_b32_dpp v48, v48 row_shr:4 row_mask:0xf bank_mask:0xa
    v_mad_u32_u16 v49, v48, 4, v49
    v_lshrrev_b32 v48, 16, v48
    v_sub_u32 v48, v48, v56
    v_cmpx_lt_i32 vcc, 0, v48
    s_cbranch_execz L_entld
    buffer_load_dwordx4 v[16:19], v49, s[16:19], 0 offen sc1
    v_cmpx_lt_i32 vcc, 32, v48
    ds_write_b32 v3, v62 offset:28
L_entld:
    s_mov_b64 exec, -1
    s_waitcnt vmcnt(0)
    v_cmpx_lt_i32 vcc, 0, v48
    v_mad_u32_u16 v24, v16, 4, v53 op_sel:[1,0,0,0]
    ds_add_rtn_u32 v32, v24, v62
    v_cmpx_lt_i32 vcc, 1, v48
    v_mad_u32_u16 v25, v17, 4, v53 op_sel:[1,0,0,0]
    ds_add_rtn_u32 v33, v25, v62
    v_cmpx_lt_i32 vcc, 2, v48
    v_mad_u32_u16 v26, v18, 4, v53 op_sel:[1,0,0,0]
    ds_add_rtn_u32 v34, v26, v62
    v_cmpx_lt_i32 vcc, 3, v48
    v_mad_u32_u16 v27, v19, 4, v53 op_sel:[1,0,0,0]
    ds_add_rtn_u32 v35, v27, v62
    s_mov_b64 exec, -1
    ds_add_u32 v61, v62 offset:12
    v_mad_u32_u16 v40, v16, 2, v52
    v_mad_u32_u16 v16, v16, s7, 0
    v_mad_u32_u16 v41, v17, 2, v52
    v_mad_u32_u16 v17, v17, s7, 0
    v_mad_u32_u16 v42, v18, 2, v52
    v_mad_u32_u16 v18, v18, s7, 0
    v_mad_u32_u16 v43, v19, 2, v52
    v_mad_u32_u16 v19, v19, s7, 0
    s_mov_b32 s59, 0
Lw_11:
    ds_read_b32 v4, v3 offset:12
    s_waitcnt lgkmcnt(0)
    v_cmp_gt_u32 vcc, 8, v4
    s_cbranch_vccz Lk_12
    s_add_u32 s59, s59, 1
    s_cmp_lt_u32 s59, 4194304
    s_cbranch_scc1 Lw_11
    s_branch L_end
Lk_12:
    ds_read_b32 v12, v50
    ds_read_b32 v5, v3 offset:28
    ds_read_u16 v8, v8
    ds_read_u16 v40, v40
    ds_read_u16 v41, v41
    ds_read_u16 v42, v42
    ds_read_u16 v43, v43
    s_lshl_b32 s58, s2, 4
    s_add_u32 s58, s58, s3
    s_cmp_eq_u32 s58, 15
    s_cbranch_scc0 L_noep
    v_mov_b32 v6, s40
    v_mov_b32 v7, 1048576
    s_mov_b64 exec, 1
    buffer_store_dword v6, v7, s[16:19], 0 offen sc1
    s_mov_b64 exec, -1
L_noep:
    s_waitcnt lgkmcnt(6)
    v_add_u32 v12, 1, v12
    v_lshrrev_b32 v12, 1, v12
    v_max_u32 v12, 1, v12
    v_cndmask_b32 v12, 0, v12, s[62:63]
    s_lshl_b32 s67, s4, 3
    s_movk_i32 s58, 2304
    v_add_u32_dpp v51, v12, v12 row_shl:1 row_mask:0xf bank_mask:0xf bound_ctrl:1
    s_nop 1
    v_add_u32_dpp v51, v51, v51 row_shl:2 row_mask:0xf bank_mask:0xf bound_ctrl:1
    s_nop 1
    v_add_u32_dpp v51, v12, v51 row_shl:4 row_mask:0xf bank_mask:0x5 bound_ctrl:1
    s_waitcnt lgkmcnt(0)
    v_lshlrev_b32 v8, 16, v8
    v_lshl_add_u32 v5, v5, 10, v51
    v_sub_u32 v6, v55, v51
    v_cmp_le_u32 vcc, 72, v5
    v_lshlrev_b32 v6, 1, v6
    v_subrev_u32 v12, 1, v12
    s_cbranch_vccnz L_slow
    v_and_b32 v12, 0xff, v12
    v_lshl_add_u32 v9, v12, 18, v9
    s_mov_b64 exec, s[62:63]
    ds_write_b32 v50, v6 offset:160
    s_mov_b64 exec, -1
    s_sub_u32 s63, s67, 1
    v_readlane_b32 s67, v51, s67
    v_cmpx_lt_i32 vcc, 0, v48
    ds_read_b32 v24, v24 offset:160
    v_cmpx_lt_i32 vcc, 1, v48
    ds_read_b32 v25, v25 offset:160
    v_cmpx_lt_i32 vcc, 2, v48
    ds_read_b32 v26, v26 offset:160
    v_cmpx_lt_i32 vcc, 3, v48
    ds_read_b32 v27, v27 offset:160
    s_mov_b64 exec, -1
    s_lshr_b32 s66, s67, 3
    s_add_u32 s60, s66, 1
    s_lshl_b32 s60, s60, 3
    s_sub_u32 s67, s60, s67
    s_sub_u32 s62, s67, 1
    s_add_u32 s61, s4, 1
    s_mul_i32 s61, s61, 72
    s_sub_u32 s60, s61, s60
    s_lshl_b32 s60, s60, 2
    s_waitcnt lgkmcnt(0)
    v_cmpx_lt_i32 vcc, 0, v48
    v_add_u32 v24, v24, v32
    v_lshl_add_u32 v5, v24, 1, v57
    ds_write_b16 v5, v40
    v_lshrrev_b32 v6, 1, v24
    v_lshl_add_u32 v6, v6, 2, v60
    v_and_b32 v7, 1, v24
    v_mad_u32_u24 v6, v7, s58, v6
    ds_write_b32 v6, v16
    v_cmpx_lt_i32 vcc, 1, v48
    v_add_u32 v25, v25, v33
    v_lshl_add_u32 v5, v25, 1, v57
    ds_write_b16 v5, v41
    v_lshrrev_b32 v6, 1, v25
    v_lshl_add_u32 v6, v6, 2, v60
    v_and_b32 v7, 1, v25
    v_mad_u32_u24 v6, v7, s58, v6
    ds_write_b32 v6, v17
    v_cmpx_lt_i32 vcc, 2, v48
    v_add_u32 v26, v26, v34
    v_lshl_add_u32 v5, v26, 1, v57
    ds_write_b16 v5, v42
    v_lshrrev_b32 v6, 1, v26
    v_lshl_add_u32 v6, v6, 2, v60
    v_and_b32 v7, 1, v26
    v_mad_u32_u24 v6, v7, s58, v6
    ds_write_b32 v6, v18
    v_cmpx_lt_i32 vcc, 3, v48
    v_add_u32 v27, v27, v35
    v_lshl_add_u32 v5, v27, 1, v57
    ds_write_b16 v5, v43
    v_lshrrev_b32 v6, 1, v27
    v_lshl_add_u32 v6, v6, 2, v60
    v_and_b32 v7, 1, v27
    v_mad_u32_u24 v6, v7, s58, v6
    ds_write_b32 v6, v19
    s_mov_b64 exec, -1
    ds_add_u32 v61, v62 offset:16
    v_lshrrev_b32 v5, 5, v0
    v_mad_u32_u24 v13, v5, s58, v60
    v_add_u32 v13, s60, v13
    v_lshl_add_u32 v14, v5, 1, v57
    v_and_b32 v5, 28, v0
    v_add3_u32 v14, v14, v5, s60
    s_mov_b32 s65, 201486528
    s_mov_b32 s64, 0
    s_mov_b32 s59, 0
Lw_13:
    ds_read_b32 v4, v3 offset:16
    s_waitcnt lgkmcnt(0)
    v_cmp_gt_u32 vcc, 8, v4
    s_cbranch_vccz Lk_14
    s_add_u32 s59, s59, 1
    s_cmp_lt_u32 s59, 4194304
    s_cbranch_scc1 Lw_13
    s_branch L_end
Lk_14:
    v_mov_b32 v12, v3
    v_mov_b32 v3, v2
    s_setprio 1
    s_cmp_lt_u32 s4, 4
    s_cbranch_scc1 L_old
    s_setprio 2
L_old:
    ds_read_b128 v[56:59], v13 offset:0
    ds_read_b128 v[60:63], v13 offset:16
    ds_read_u16 v1, v14
    ds_read_b128 v[48:51], v13 offset:32
    ds_read_b128 v[52:55], v13 offset:48
    s_waitcnt lgkmcnt(3)
L_p0:
    s_cmp_ge_u32 s67, 4
    s_cbranch_scc1 L_p4
    s_cmp_gt_u32 s67, 1
    s_cbranch_scc1 Lps_15
    v_add_u32 v57, v57, v2
    buffer_load_dwordx4 v[20:23], v57, s[8:11], 0 offen
Lps_15:
    s_cmp_gt_u32 s67, 2
    s_cbranch_scc1 Lps_16
    v_add_u32 v58, v58, v2
    buffer_load_dwordx4 v[24:27], v58, s[8:11], 0 offen
Lps_16:
    s_cmp_gt_u32 s67, 3
    s_cbranch_scc1 Lps_17
    v_add_u32 v59, v59, v2
    buffer_load_dwordx4 v[28:31], v59, s[8:11], 0 offen
Lps_17:
L_p4:
    s_cmp_gt_u32 s67, 4
    s_cbranch_scc1 Lps_18
    v_add_u32 v60, v60, v2
    buffer_load_dwordx4 v[32:35], v60, s[8:11], 0 offen
Lps_18:
    s_cmp_gt_u32 s67, 5
    s_cbranch_scc1 Lps_19
    v_add_u32 v61, v61, v2
    buffer_load_dwordx4 v[36:39], v61, s[8:11], 0 offen
Lps_19:
    s_cmp_gt_u32 s67, 6
    s_cbranch_scc1 Lps_20
    v_add_u32 v62, v62, v2
    buffer_load_dwordx4 v[40:43], v62, s[8:11], 0 offen
Lps_20:
    s_cmp_gt_u32 s67, 7
    s_cbranch_scc1 Lps_21
    v_add_u32 v63, v63, v2
    buffer_load_dwordx4 v[44:47], v63, s[8:11], 0 offen
Lps_21:
    s_cmp_eq_u32 s66, 0
    s_cbranch_scc1 L_drain
L_gl:
    s_waitcnt lgkmcnt(1)
    v_perm_b32 v6, v1, v1, v10
    v_perm_b32 v7, v1, v1, v11
    ds_read_u16 v1, v14 offset:32
    s_waitcnt vmcnt(6)
    v_lshl_add_u64 v[4:5], v[48:49], 0, v[2:3]
    s_sub_u32 s62, s62, 2
    s_cbranch_scc1 Lfs_0
    v_mfma_f32_4x4x4_16b_bf16 v[56:59], v[6:7], v[16:17], v[56:59] cbsz:3 abid:0
    v_mfma_f32_4x4x4_16b_bf16 v[60:63], v[6:7], v[18:19], v[60:63] cbsz:3 abid:0
    buffer_load_dwordx4 v[16:19], v4, s[8:11], 0 offen
    v_mfma_f32_4x4x4_16b_bf16 v[56:59], v[6:7], v[20:21], v[56:59] cbsz:3 abid:1
    v_mfma_f32_4x4x4_16b_bf16 v[60:63], v[6:7], v[22:23], v[60:63] cbsz:3 abid:1
    buffer_load_dwordx4 v[20:23], v5, s[8:11], 0 offen
Lbs_0:
    s_waitcnt vmcnt(6)
    v_lshl_add_u64 v[4:5], v[50:51], 0, v[2:3]
    s_sub_u32 s62, s62, 2
    s_cbranch_scc1 Lfs_2
    v_mfma_f32_4x4x4_16b_bf16 v[56:59], v[6:7], v[24:25], v[56:59] cbsz:3 abid:2
    v_mfma_f32_4x4x4_16b_bf16 v[60:63], v[6:7], v[26:27], v[60:63] cbsz:3 abid:2
    buffer_load_dwordx4 v[24:27], v4, s[8:11], 0 offen
    v_mfma_f32_4x4x4_16b_bf16 v[56:59], v[6:7], v[28:29], v[56:59] cbsz:3 abid:3
    v_mfma_f32_4x4x4_16b_bf16 v[60:63], v[6:7], v[30:31], v[60:63] cbsz:3 abid:3
    buffer_load_dwordx4 v[28:31], v5, s[8:11], 0 offen
Lbs_2:
    ds_read_b128 v[48:51], v13 offset:64
    s_waitcnt vmcnt(6) lgkmcnt(2)
    v_lshl_add_u64 v[4:5], v[52:53], 0, v[2:3]
    s_sub_u32 s62, s62, 2
    s_cbranch_scc1 Lfs_4
    v_mfma_f32_4x4x4_16b_bf16 v[56:59], v[6:7], v[32:33], v[56:59] cbsz:3 abid:4
    v_mfma_f32_4x4x4_16b_bf16 v[60:63], v[6:7], v[34:35], v[60:63] cbsz:3 abid:4
    buffer_load_dwordx4 v[32:35], v4, s[8:11], 0 offen
    v_mfma_f32_4x4x4_16b_bf16 v[56:59], v[6:7], v[36:37], v[56:59] cbsz:3 abid:5
    v_mfma_f32_4x4x4_16b_bf16 v[60:63], v[6:7], v[38:39], v[60:63] cbsz:3 abid:5
    buffer_load_dwordx4 v[36:39], v5, s[8:11], 0 offen
Lbs_4:
    s_waitcnt vmcnt(6)
    v_lshl_add_u64 v[4:5], v[54:55], 0, v[2:3]
    s_sub_u32 s62, s62, 2
    s_cbranch_scc1 Lfs_6
    v_mfma_f32_4x4x4_16b_bf16 v[56:59], v[6:7], v[40:41], v[56:59] cbsz:3 abid:6
    v_mfma_f32_4x4x4_16b_bf16 v[60:63], v[6:7], v[42:43], v[60:63] cbsz:3 abid:6
    buffer_load_dwordx4 v[40:43], v4, s[8:11], 0 offen
    v_mfma_f32_4x4x4_16b_bf16 v[56:59], v[6:7], v[44:45], v[56:59] cbsz:3 abid:7
    v_mfma_f32_4x4x4_16b_bf16 v[60:63], v[6:7], v[46:47], v[60:63] cbsz:3 abid:7
    buffer_load_dwordx4 v[44:47], v5, s[8:11], 0 offen
Lbs_6:
    ds_read_b128 v[52:55], v13 offset:80
    v_add_u32 v13, 32, v13
    v_add_u32 v14, 32, v14
    s_sub_u32 s66, s66, 1
    s_cmp_eq_u32 s66, 3
    s_cbranch_scc0 L_nf
    s_setprio 1
L_nf:
    s_cmp_lg_u32 s66, 0
    s_cbranch_scc1 L_gl
L_drain:
    s_waitcnt lgkmcnt(0)
    v_perm_b32 v6, v1, v1, v10
    v_perm_b32 v7, v1, v1, v11
    ds_read_u16 v1, v14 offset:32
    s_waitcnt vmcnt(7)
    v_mfma_f32_4x4x4_16b_bf16 v[56:59], v[6:7], v[16:17], v[56:59] cbsz:3 abid:0
    v_mfma_f32_4x4x4_16b_bf16 v[60:63], v[6:7], v[18:19], v[60:63] cbsz:3 abid:0
    s_sub_u32 s62, s62, 1
    s_cbranch_scc1 Lfd_0
Lbd_0:
    s_waitcnt vmcnt(6)
    v_mfma_f32_4x4x4_16b_bf16 v[56:59], v[6:7], v[20:21], v[56:59] cbsz:3 abid:1
    v_mfma_f32_4x4x4_16b_bf16 v[60:63], v[6:7], v[22:23], v[60:63] cbsz:3 abid:1
    s_sub_u32 s62, s62, 1
    s_cbranch_scc1 Lfd_1
Lbd_1:
    s_waitcnt vmcnt(5)
    v_mfma_f32_4x4x4_16b_bf16 v[56:59], v[6:7], v[24:25], v[56:59] cbsz:3 abid:2
    v_mfma_f32_4x4x4_16b_bf16 v[60:63], v[6:7], v[26:27], v[60:63] cbsz:3 abid:2
    s_sub_u32 s62, s62, 1
    s_cbranch_scc1 Lfd_2
Lbd_2:
    s_waitcnt vmcnt(4)
    v_mfma_f32_4x4x4_16b_bf16 v[56:59], v[6:7], v[28:29], v[56:59] cbsz:3 abid:3
    v_mfma_f32_4x4x4_16b_bf16 v[60:63], v[6:7], v[30:31], v[60:63] cbsz:3 abid:3
    s_sub_u32 s62, s62, 1
    s_cbranch_scc1 Lfd_3
Lbd_3:
    s_waitcnt vmcnt(3)
    v_mfma_f32_4x4x4_16b_bf16 v[56:59], v[6:7], v[32:33], v[56:59] cbsz:3 abid:4
    v_mfma_f32_4x4x4_16b_bf16 v[60:63], v[6:7], v[34:35], v[60:63] cbsz:3 abid:4
    s_sub_u32 s62, s62, 1
    s_cbranch_scc1 Lfd_4
Lbd_4:
    s_waitcnt vmcnt(2)
    v_mfma_f32_4x4x4_16b_bf16 v[56:59], v[6:7], v[36:37], v[56:59] cbsz:3 abid:5
    v_mfma_f32_4x4x4_16b_bf16 v[60:63], v[6:7], v[38:39], v[60:63] cbsz:3 abid:5
    s_sub_u32 s62, s62, 1
    s_cbranch_scc1 Lfd_5
Lbd_5:
    s_waitcnt vmcnt(1)
    v_mfma_f32_4x4x4_16b_bf16 v[56:59], v[6:7], v[40:41], v[56:59] cbsz:3 abid:6
    v_mfma_f32_4x4x4_16b_bf16 v[60:63], v[6:7], v[42:43], v[60:63] cbsz:3 abid:6
    s_sub_u32 s62, s62, 1
    s_cbranch_scc1 Lfd_6
Lbd_6:
    s_waitcnt vmcnt(0)
    v_mfma_f32_4x4x4_16b_bf16 v[56:59], v[6:7], v[44:45], v[56:59] cbsz:3 abid:7
    v_mfma_f32_4x4x4_16b_bf16 v[60:63], v[6:7], v[46:47], v[60:63] cbsz:3 abid:7
    s_nop 1
    s_call_b64 s[68:69], L_flush
L_gdone:
    s_endpgm
Lfs_0:
    s_add_u32 s62, s62, 2
    v_mfma_f32_4x4x4_16b_bf16 v[56:59], v[6:7], v[16:17], v[56:59] cbsz:3 abid:0
    v_mfma_f32_4x4x4_16b_bf16 v[60:63], v[6:7], v[18:19], v[60:63] cbsz:3 abid:0
    buffer_load_dwordx4 v[16:19], v4, s[8:11], 0 offen
    s_sub_u32 s62, s62, 1
    s_cbranch_scc0 Lsk_22
    s_call_b64 s[68:69], L_flush
Lsk_22:
    v_mfma_f32_4x4x4_16b_bf16 v[56:59], v[6:7], v[20:21], v[56:59] cbsz:3 abid:1
    v_mfma_f32_4x4x4_16b_bf16 v[60:63], v[6:7], v[22:23], v[60:63] cbsz:3 abid:1
    buffer_load_dwordx4 v[20:23], v5, s[8:11], 0 offen
    s_sub_u32 s62, s62, 1
    s_cbranch_scc0 Lbs_0
    s_call_b64 s[68:69], L_flush
    s_branch Lbs_0
Lfs_2:
    s_add_u32 s62, s62, 2
    v_mfma_f32_4x4x4_16b_bf16 v[56:59], v[6:7], v[24:25], v[56:59] cbsz:3 abid:2
    v_mfma_f32_4x4x4_16b_bf16 v[60:63], v[6:7], v[26:27], v[60:63] cbsz:3 abid:2
    buffer_load_dwordx4 v[24:27], v4, s[8:11], 0 offen
    s_sub_u32 s62, s62, 1
    s_cbranch_scc0 Lsk_24
    s_call_b64 s[68:69], L_flush
Lsk_24:
    v_mfma_f32_4x4x4_16b_bf16 v[56:59], v[6:7], v[28:29], v[56:59] cbsz:3 abid:3
    v_mfma_f32_4x4x4_16b_bf16 v[60:63], v[6:7], v[30:31], v[60:63] cbsz:3 abid:3
    buffer_load_dwordx4 v[28:31], v5, s[8:11], 0 offen
    s_sub_u32 s62, s62, 1
    s_cbranch_scc0 Lbs_2
    s_call_b64 s[68:69], L_flush
    s_branch Lbs_2
Lfs_4:
    s_add_u32 s62, s62, 2
    v_mfma_f32_4x4x4_16b_bf16 v[56:59], v[6:7], v[32:33], v[56:59] cbsz:3 abid:4
    v_mfma_f32_4x4x4_16b_bf16 v[60:63], v[6:7], v[34:35], v[60:63] cbsz:3 abid:4
    buffer_load_dwordx4 v[32:35], v4, s[8:11], 0 offen
    s_sub_u32 s62, s62, 1
    s_cbranch_scc0 Lsk_26
    s_call_b64 s[68:69], L_flush
Lsk_26:
    v_mfma_f32_4x4x4_16b_bf16 v[56:59], v[6:7], v[36:37], v[56:59] cbsz:3 abid:5
    v_mfma_f32_4x4x4_16b_bf16 v[60:63], v[6:7], v[38:39], v[60:63] cbsz:3 abid:5
    buffer_load_dwordx4 v[36:39], v5, s[8:11], 0 offen
    s_sub_u32 s62, s62, 1
    s_cbranch_scc0 Lbs_4
    s_call_b64 s[68:69], L_flush
    s_branch Lbs_4
Lfs_6:
    s_add_u32 s62, s62, 2
    v_mfma_f32_4x4x4_16b_bf16 v[56:59], v[6:7], v[40:41], v[56:59] cbsz:3 abid:6
    v_mfma_f32_4x4x4_16b_bf16 v[60:63], v[6:7], v[42:43], v[60:63] cbsz:3 abid:6
    buffer_load_dwordx4 v[40:43], v4, s[8:11], 0 offen
    s_sub_u32 s62, s62, 1
    s_cbranch_scc0 Lsk_28
    s_call_b64 s[68:69], L_flush
Lsk_28:
    v_mfma_f32_4x4x4_16b_bf16 v[56:59], v[6:7], v[44:45], v[56:59] cbsz:3 abid:7
    v_mfma_f32_4x4x4_16b_bf16 v[60:63], v[6:7], v[46:47], v[60:63] cbsz:3 abid:7
    buffer_load_dwordx4 v[44:47], v5, s[8:11], 0 offen
    s_sub_u32 s62, s62, 1
    s_cbranch_scc0 Lbs_6
    s_call_b64 s[68:69], L_flush
    s_branch Lbs_6
Lfd_0:
    s_call_b64 s[68:69], L_flush
    s_branch Lbd_0
Lfd_1:
    s_call_b64 s[68:69], L_flush
    s_branch Lbd_1
Lfd_2:
    s_call_b64 s[68:69], L_flush
    s_branch Lbd_2
Lfd_3:
    s_call_b64 s[68:69], L_flush
    s_branch Lbd_3
Lfd_4:
    s_call_b64 s[68:69], L_flush
    s_branch Lbd_4
Lfd_5:
    s_call_b64 s[68:69], L_flush
    s_branch Lbd_5
Lfd_6:
    s_call_b64 s[68:69], L_flush
    s_branch Lbd_6
L_flush:
    s_and_b32 s101, s65, 0x3ffff
    s_add_u32 s63, s63, 1
    v_permlane32_swap_b32 v56, v60
    v_permlane32_swap_b32 v57, v61
    v_permlane32_swap_b32 v58, v62
    v_permlane32_swap_b32 v59, v63
    s_lshr_b32 s62, s65, 26
    v_pk_add_f32 v[56:57], v[56:57], v[60:61]
    v_pk_add_f32 v[58:59], v[58:59], v[62:63]
    v_add_u32 v62, s101, v15
    v_pk_mul_f32 v[56:57], v[56:57], s[64:65] op_sel_hi:[1,0]
    v_pk_mul_f32 v[58:59], v[58:59], s[64:65] op_sel_hi:[1,0]
    v_lshl_add_u32 v63, s62, 2, v12
    v_cvt_pk_bf16_f32 v60, v56, v57
    v_cvt_pk_bf16_f32 v61, v58, v59
    ds_write_b64 v62, v[60:61]
    s_mov_b64 exec, 1
    ds_inc_u32 v63, v63 offset:36
    s_mov_b64 exec, -1
    v_readlane_b32 s65, v9, s63
    v_readlane_b32 s64, v8, s63
    v_mov_b64 v[56:57], 0
    v_mov_b64 v[58:59], 0
    v_mov_b64 v[60:61], 0
    v_mov_b64 v[62:63], 0
    s_bfe_u32 s62, s65, 0x80012
    s_setpc_b64 s[68:69]
L_preA:
    s_setprio 2
    s_mul_i32 s5, s6, 40
    v_mov_b32 v3, 159296
    s_mov_b32 s10, 5120000
    s_mov_b32 s11, 0x20000
    s_mov_b64 s[16:17], s[56:57]
    s_mov_b32 s18, 1441792
    s_mov_b32 s19, 0x20000
    v_and_b32 v6, 32, v0
    v_lshl_add_u32 v5, v6, 7, v2
    v_lshl_add_u32 v6, v6, 6, v2
    s_add_u32 s58, s3, s5
    s_mul_i32 s59, s3, 1056
    s_add_u32 m0, s59, 84480
    s_lshl_b32 s58, s58, 9
    buffer_load_dwordx4 v5, s[8:11], s58 offen lds
    s_add_u32 m0, s59, 92928
    s_add_u32 s58, s58, 8192
    s_waitcnt vmcnt(2)
    buffer_load_dwordx4 v5, s[8:11], s58 offen lds
    s_cmp_ge_u32 s3, 4
    s_cbranch_scc1 L_xa2
    s_add_u32 m0, s59, 101376
    s_add_u32 s58, s58, 8192
    s_waitcnt vmcnt(2)
    buffer_load_dwordx4 v6, s[8:11], s58 offen lds
L_xa2:
    v_and_b32 v4, 7, v0
    v_mul_u32_u24 v1, 1056, v4
    v_and_b32 v4, 8, v0
    v_lshl_add_u32 v1, v4, 6, v1
    v_and_b32 v4, 48, v0
    v_add_u32 v1, v4, v1
    v_add_u32 v12, 84480, v1
    s_mov_b64 s[20:21], s[52:53]
    s_mov_b32 s22, 5120000
    s_mov_b32 s23, 0x20000
    v_lshlrev_b32 v14, 4, v0
    s_lshl_b32 s61, s3, 6
    s_add_u32 s61, s61, 105600
    v_add_u32 v13, s61, v1
    s_lshl_b32 s100, s3, 14
    s_add_u32 s100, s100, 655360
    s_waitcnt lgkmcnt(0)
    v_lshl_add_u32 v104, s32, 9, v2
    v_lshl_add_u32 v105, s33, 9, v2
    v_lshl_add_u32 v106, s34, 9, v2
    v_lshl_add_u32 v107, s35, 9, v2
    v_lshl_add_u32 v108, s36, 9, v2
    v_lshl_add_u32 v109, s37, 9, v2
    v_lshl_add_u32 v110, s38, 9, v2
    v_lshl_add_u32 v111, s39, 9, v2
    v_lshl_add_u32 v112, s64, 9, v2
    v_lshl_add_u32 v113, s65, 9, v2
    s_mov_b32 exec_lo, 0
    v_lshl_add_u32 v104, s40, 9, v2
    v_lshl_add_u32 v105, s41, 9, v2
    v_lshl_add_u32 v106, s42, 9, v2
    v_lshl_add_u32 v107, s43, 9, v2
    v_lshl_add_u32 v108, s44, 9, v2
    v_lshl_add_u32 v109, s45, 9, v2
    v_lshl_add_u32 v110, s46, 9, v2
    v_lshl_add_u32 v111, s47, 9, v2
    v_lshl_add_u32 v112, s66, 9, v2
    v_lshl_add_u32 v113, s67, 9, v2
    s_mov_b64 exec, -1
    s_cmp_ge_u32 s2, 64
    s_cbranch_scc1 L_nopb
    s_barrier
    s_barrier
L_nopb:
    s_mul_i32 s67, s3, 2112
    s_mul_i32 s66, s3, 8448
    s_cmp_lt_u32 s2, 64
    s_cbranch_scc1 Lth_30
    s_waitcnt vmcnt(1)
Lth_30:
    s_add_u32 m0, s66, 0
    s_waitcnt vmcnt(2)
    buffer_load_dwordx4 v104, s[8:11], 0 offen lds
    s_cmp_lt_u32 s2, 64
    s_cbranch_scc1 Lth_31
    s_waitcnt vmcnt(1)
Lth_31:
    s_add_u32 m0, s66, 1056
    s_waitcnt vmcnt(2)
    buffer_load_dwordx4 v105, s[8:11], 0 offen lds
    v_and_b32 v4, 3, v0
    v_mov_b32 v5, 0x0c0c0c0c
    v_mov_b32 v6, 0x0c0c0302
    v_mov_b32 v7, 0x03020c0c
    v_cmp_eq_u32 s[58:59], 0, v4
    v_cmp_eq_u32 s[60:61], 2, v4
    v_cmp_eq_u32 vcc, 1, v4
    v_cndmask_b32 v8, v5, v6, s[58:59]
    v_cndmask_b32 v9, v5, v6, s[60:61]
    v_cndmask_b32 v8, v8, v7, vcc
    v_cmp_eq_u32 vcc, 3, v4
    s_nop 1
    v_cndmask_b32 v9, v9, v7, vcc
    v_mov_b32 v10, v8
    v_mov_b32 v11, v9
    v_and_b32 v8, 0xfdfdfdfd, v8
    v_and_b32 v9, 0xfdfdfdfd, v9
    s_cmp_lt_u32 s2, 64
    s_cbranch_scc1 Lth_32
    s_waitcnt vmcnt(1)
Lth_32:
    s_add_u32 m0, s66, 2112
    s_waitcnt vmcnt(2)
    buffer_load_dwordx4 v106, s[8:11], 0 offen lds
    s_cmp_lt_u32 s2, 64
    s_cbranch_scc1 Lth_33
    s_waitcnt vmcnt(1)
Lth_33:
    s_add_u32 m0, s66, 3168
    s_waitcnt vmcnt(2)
    buffer_load_dwordx4 v107, s[8:11], 0 offen lds
    s_mov_b64 exec, 1
    v_mov_b32 v4, 1
    ds_add_u32 v3, v4 offset:0
    s_mov_b64 exec, -1
    s_cmp_lt_u32 s2, 64
    s_cbranch_scc1 Lth_34
    s_waitcnt vmcnt(1)
Lth_34:
    s_add_u32 m0, s66, 4224
    s_waitcnt vmcnt(2)
    buffer_load_dwordx4 v108, s[8:11], 0 offen lds
    s_mov_b32 s59, 0
Lw_35:
    ds_read_b32 v4, v3 offset:0
    s_waitcnt lgkmcnt(0)
    v_cmp_gt_u32 vcc, 8, v4
    s_cbranch_vccz Lk_36
    s_add_u32 s59, s59, 1
    s_cmp_lt_u32 s59, 4194304
    s_cbranch_scc1 Lw_35
    s_branch L_end
Lk_36:
    ds_read_b128 v[80:83], v12 offset:0
    ds_read_b128 v[84:87], v12 offset:8448
    ds_read_b128 v[88:91], v12 offset:16896
    s_cmp_lt_u32 s2, 64
    s_cbranch_scc1 Lth_37
    s_waitcnt vmcnt(1)
Lth_37:
    s_add_u32 m0, s66, 5280
    s_waitcnt vmcnt(2)
    buffer_load_dwordx4 v109, s[8:11], 0 offen lds
    s_mov_b64 exec, 1
    v_mov_b32 v4, 1
    ds_add_u32 v3, v4 offset:60
    s_mov_b64 exec, -1
    s_cmp_lt_u32 s2, 64
    s_cbranch_scc1 Lth_38
    s_waitcnt vmcnt(1)
Lth_38:
    s_waitcnt vmcnt(2)
    ds_read_b32 v4, v3 offset:52
    s_add_u32 m0, s66, 6336
    s_waitcnt vmcnt(2)
    buffer_load_dwordx4 v110, s[8:11], 0 offen lds
    s_waitcnt lgkmcnt(0)
    v_cmp_gt_u32 vcc, 8, v4
    s_cbranch_vccz L_eu7
    s_cmp_lt_u32 s2, 64
    s_cbranch_scc1 Lth_39
    s_waitcnt vmcnt(1)
Lth_39:
    s_waitcnt vmcnt(2)
    ds_read_b32 v4, v3 offset:52
    s_add_u32 m0, s66, 7392
    s_waitcnt vmcnt(2)
    buffer_load_dwordx4 v111, s[8:11], 0 offen lds
    s_waitcnt lgkmcnt(0)
    v_cmp_gt_u32 vcc, 8, v4
    s_cbranch_vccz L_eu8
    s_cmp_lt_u32 s2, 64
    s_cbranch_scc1 Lth_40
    s_waitcnt vmcnt(1)
Lth_40:
    s_waitcnt vmcnt(2)
    ds_read_b32 v4, v3 offset:52
    s_add_u32 m0, s67, 67584
    s_waitcnt vmcnt(2)
    buffer_load_dwordx4 v112, s[8:11], 0 offen lds
    s_waitcnt lgkmcnt(0)
    v_cmp_gt_u32 vcc, 8, v4
    s_cbranch_vccz L_eu9
    s_cmp_lt_u32 s2, 64
    s_cbranch_scc1 Lth_41
    s_waitcnt vmcnt(1)
Lth_41:
    s_waitcnt vmcnt(2)
    ds_read_b32 v4, v3 offset:52
    s_add_u32 m0, s67, 68640
    s_waitcnt vmcnt(2)
    buffer_load_dwordx4 v113, s[8:11], 0 offen lds
    s_mov_b32 s59, 0
Lw_42:
    ds_read_b32 v4, v3 offset:52
    s_waitcnt lgkmcnt(0)
    v_cmp_gt_u32 vcc, 8, v4
    s_cbranch_vccz Lk_43
    s_sleep 1
    s_add_u32 s59, s59, 1
    s_cmp_lt_u32 s59, 4194304
    s_cbranch_scc1 Lw_42
    s_branch L_end
Lk_43:
    s_branch L_eu10
L_eu7:
    s_add_u32 m0, s66, 7392
    s_waitcnt vmcnt(63)
    buffer_load_dwordx4 v111, s[8:11], 0 offen lds
L_eu8:
    s_add_u32 m0, s67, 67584
    s_waitcnt vmcnt(63)
    buffer_load_dwordx4 v112, s[8:11], 0 offen lds
L_eu9:
    s_add_u32 m0, s67, 68640
    s_waitcnt vmcnt(63)
    buffer_load_dwordx4 v113, s[8:11], 0 offen lds
L_eu10:
    s_setprio 3
    buffer_load_dwordx4 v[16:19], v14, s[16:19], s100 offen offset:0 sc1
    buffer_load_dwordx4 v[20:23], v14, s[16:19], s100 offen offset:1024 sc1
    buffer_load_dwordx4 v[24:27], v14, s[16:19], s100 offen offset:2048 sc1
    buffer_load_dwordx4 v[28:31], v14, s[16:19], s100 offen offset:3072 sc1
    s_add_u32 s100, s100, 4096
    buffer_load_dwordx4 v[32:35], v14, s[16:19], s100 offen offset:0 sc1
    buffer_load_dwordx4 v[36:39], v14, s[16:19], s100 offen offset:1024 sc1
    buffer_load_dwordx4 v[40:43], v14, s[16:19], s100 offen offset:2048 sc1
    buffer_load_dwordx4 v[44:47], v14, s[16:19], s100 offen offset:3072 sc1
    s_add_u32 s100, s100, 4096
    buffer_load_dwordx4 v[48:51], v14, s[16:19], s100 offen offset:0 sc1
    buffer_load_dwordx4 v[52:55], v14, s[16:19], s100 offen offset:1024 sc1
    buffer_load_dwordx4 v[56:59], v14, s[16:19], s100 offen offset:2048 sc1
    buffer_load_dwordx4 v[60:63], v14, s[16:19], s100 offen offset:3072 sc1
    s_add_u32 s100, s100, 4096
    buffer_load_dwordx4 v[64:67], v14, s[16:19], s100 offen offset:0 sc1
    buffer_load_dwordx4 v[68:71], v14, s[16:19], s100 offen offset:1024 sc1
    buffer_load_dwordx4 v[72:75], v14, s[16:19], s100 offen offset:2048 sc1
    buffer_load_dwordx4 v[76:79], v14, s[16:19], s100 offen offset:3072 sc1
    s_setprio 0
    ds_read_b128 v[92:95], v12 offset:64
    ds_read_b128 v[96:99], v12 offset:8512
    ds_read_b128 v[100:103], v12 offset:16960
    s_waitcnt vmcnt(14) lgkmcnt(3)
    v_mfma_f32_16x16x32_bf16 v[104:107], v[16:19], v[80:83], 0
    v_mfma_f32_16x16x32_bf16 v[108:111], v[20:23], v[80:83], 0
    v_mfma_f32_16x16x32_bf16 v[112:115], v[16:19], v[84:87], 0
    v_mfma_f32_16x16x32_bf16 v[116:119], v[20:23], v[84:87], 0
    v_mfma_f32_16x16x32_bf16 v[120:123], v[16:19], v[88:91], 0
    v_mfma_f32_16x16x32_bf16 v[124:127], v[20:23], v[88:91], 0
    ds_read_b128 v[80:83], v12 offset:128
    ds_read_b128 v[84:87], v12 offset:8576
    ds_read_b128 v[88:91], v12 offset:17024
    s_waitcnt vmcnt(12) lgkmcnt(3)
    v_mfma_f32_16x16x32_bf16 v[104:107], v[24:27], v[92:95], v[104:107]
    v_mfma_f32_16x16x32_bf16 v[108:111], v[28:31], v[92:95], v[108:111]
    v_mfma_f32_16x16x32_bf16 v[112:115], v[24:27], v[96:99], v[112:115]
    v_mfma_f32_16x16x32_bf16 v[116:119], v[28:31], v[96:99], v[116:119]
    v_mfma_f32_16x16x32_bf16 v[120:123], v[24:27], v[100:103], v[120:123]
    v_mfma_f32_16x16x32_bf16 v[124:127], v[28:31], v[100:103], v[124:127]
    ds_read_b128 v[92:95], v12 offset:192
    ds_read_b128 v[96:99], v12 offset:8640
    ds_read_b128 v[100:103], v12 offset:17088
    s_waitcnt vmcnt(10) lgkmcnt(3)
    v_mfma_f32_16x16x32_bf16 v[104:107], v[32:35], v[80:83], v[104:107]
    v_mfma_f32_16x16x32_bf16 v[108:111], v[36:39], v[80:83], v[108:111]
    v_mfma_f32_16x16x32_bf16 v[112:115], v[32:35], v[84:87], v[112:115]
    v_mfma_f32_16x16x32_bf16 v[116:119], v[36:39], v[84:87], v[116:119]
    v_mfma_f32_16x16x32_bf16 v[120:123], v[32:35], v[88:91], v[120:123]
    v_mfma_f32_16x16x32_bf16 v[124:127], v[36:39], v[88:91], v[124:127]
    ds_read_b128 v[80:83], v12 offset:256
    ds_read_b128 v[84:87], v12 offset:8704
    ds_read_b128 v[88:91], v12 offset:17152
    s_waitcnt vmcnt(8) lgkmcnt(3)
    v_mfma_f32_16x16x32_bf16 v[104:107], v[40:43], v[92:95], v[104:107]
    v_mfma_f32_16x16x32_bf16 v[108:111], v[44:47], v[92:95], v[108:111]
    v_mfma_f32_16x16x32_bf16 v[112:115], v[40:43], v[96:99], v[112:115]
    v_mfma_f32_16x16x32_bf16 v[116:119], v[44:47], v[96:99], v[116:119]
    v_mfma_f32_16x16x32_bf16 v[120:123], v[40:43], v[100:103], v[120:123]
    v_mfma_f32_16x16x32_bf16 v[124:127], v[44:47], v[100:103], v[124:127]
    ds_read_b128 v[92:95], v12 offset:320
    ds_read_b128 v[96:99], v12 offset:8768
    ds_read_b128 v[100:103], v12 offset:17216
    s_waitcnt vmcnt(6) lgkmcnt(3)
    v_mfma_f32_16x16x32_bf16 v[104:107], v[48:51], v[80:83], v[104:107]
    v_mfma_f32_16x16x32_bf16 v[108:111], v[52:55], v[80:83], v[108:111]
    v_mfma_f32_16x16x32_bf16 v[112:115], v[48:51], v[84:87], v[112:115]
    v_mfma_f32_16x16x32_bf16 v[116:119], v[52:55], v[84:87], v[116:119]
    v_mfma_f32_16x16x32_bf16 v[120:123], v[48:51], v[88:91], v[120:123]
    v_mfma_f32_16x16x32_bf16 v[124:127], v[52:55], v[88:91], v[124:127]
    s_setprio 3
    s_add_u32 s100, s100, 118784
    buffer_load_dwordx4 v[16:19], v14, s[16:19], s100 offen offset:0 sc1
    buffer_load_dwordx4 v[20:23], v14, s[16:19], s100 offen offset:1024 sc1
    buffer_load_dwordx4 v[24:27], v14, s[16:19], s100 offen offset:2048 sc1
    buffer_load_dwordx4 v[28:31], v14, s[16:19], s100 offen offset:3072 sc1
    s_setprio 0
    ds_read_b128 v[80:83], v12 offset:384
    ds_read_b128 v[84:87], v12 offset:8832
    ds_read_b128 v[88:91], v12 offset:17280
    s_waitcnt vmcnt(8) lgkmcnt(3)
    v_mfma_f32_16x16x32_bf16 v[104:107], v[56:59], v[92:95], v[104:107]
    v_mfma_f32_16x16x32_bf16 v[108:111], v[60:63], v[92:95], v[108:111]
    v_mfma_f32_16x16x32_bf16 v[112:115], v[56:59], v[96:99], v[112:115]
    v_mfma_f32_16x16x32_bf16 v[116:119], v[60:63], v[96:99], v[116:119]
    v_mfma_f32_16x16x32_bf16 v[120:123], v[56:59], v[100:103], v[120:123]
    v_mfma_f32_16x16x32_bf16 v[124:127], v[60:63], v[100:103], v[124:127]
    s_setprio 3
    s_add_u32 s100, s100, 4096
    buffer_load_dwordx4 v[32:35], v14, s[16:19], s100 offen offset:0 sc1
    buffer_load_dwordx4 v[36:39], v14, s[16:19], s100 offen offset:1024 sc1
    buffer_load_dwordx4 v[40:43], v14, s[16:19], s100 offen offset:2048 sc1
    buffer_load_dwordx4 v[44:47], v14, s[16:19], s100 offen offset:3072 sc1
    s_setprio 0
    ds_read_b128 v[92:95], v12 offset:448
    ds_read_b128 v[96:99], v12 offset:8896
    ds_read_b128 v[100:103], v12 offset:17344
    s_waitcnt vmcnt(10) lgkmcnt(3)
    v_mfma_f32_16x16x32_bf16 v[104:107], v[64:67], v[80:83], v[104:107]
    v_mfma_f32_16x16x32_bf16 v[108:111], v[68:71], v[80:83], v[108:111]
    v_mfma_f32_16x16x32_bf16 v[112:115], v[64:67], v[84:87], v[112:115]
    v_mfma_f32_16x16x32_bf16 v[116:119], v[68:71], v[84:87], v[116:119]
    v_mfma_f32_16x16x32_bf16 v[120:123], v[64:67], v[88:91], v[120:123]
    v_mfma_f32_16x16x32_bf16 v[124:127], v[68:71], v[88:91], v[124:127]
    s_setprio 3
    s_add_u32 s100, s100, 4096
    buffer_load_dwordx4 v[48:51], v14, s[16:19], s100 offen offset:0 sc1
    buffer_load_dwordx4 v[52:55], v14, s[16:19], s100 offen offset:1024 sc1
    buffer_load_dwordx4 v[56:59], v14, s[16:19], s100 offen offset:2048 sc1
    buffer_load_dwordx4 v[60:63], v14, s[16:19], s100 offen offset:3072 sc1
    s_setprio 0
    s_waitcnt vmcnt(12) lgkmcnt(0)
    v_mfma_f32_16x16x32_bf16 v[104:107], v[72:75], v[92:95], v[104:107]
    v_mfma_f32_16x16x32_bf16 v[108:111], v[76:79], v[92:95], v[108:111]
    v_mfma_f32_16x16x32_bf16 v[112:115], v[72:75], v[96:99], v[112:115]
    v_mfma_f32_16x16x32_bf16 v[116:119], v[76:79], v[96:99], v[116:119]
    v_mfma_f32_16x16x32_bf16 v[120:123], v[72:75], v[100:103], v[120:123]
    v_mfma_f32_16x16x32_bf16 v[124:127], v[76:79], v[100:103], v[124:127]
    s_setprio 3
    s_add_u32 s100, s100, 4096
    buffer_load_dwordx4 v[64:67], v14, s[16:19], s100 offen offset:0 sc1
    buffer_load_dwordx4 v[68:71], v14, s[16:19], s100 offen offset:1024 sc1
    buffer_load_dwordx4 v[72:75], v14, s[16:19], s100 offen offset:2048 sc1
    buffer_load_dwordx4 v[76:79], v14, s[16:19], s100 offen offset:3072 sc1
    s_setprio 0
    s_nop 3
    v_cvt_pk_bf16_f32 v80, v104, v105
    v_cvt_pk_bf16_f32 v81, v106, v107
    v_cvt_pk_bf16_f32 v82, v108, v109
    v_cvt_pk_bf16_f32 v83, v110, v111
    ds_write_b128 v13, v[80:83] offset:0
    v_cvt_pk_bf16_f32 v84, v112, v113
    v_cvt_pk_bf16_f32 v85, v114, v115
    v_cvt_pk_bf16_f32 v86, v116, v117
    v_cvt_pk_bf16_f32 v87, v118, v119
    ds_write_b128 v13, v[84:87] offset:8448
    v_cvt_pk_bf16_f32 v88, v120, v121
    v_cvt_pk_bf16_f32 v89, v122, v123
    v_cvt_pk_bf16_f32 v90, v124, v125
    v_cvt_pk_bf16_f32 v91, v126, v127
    ds_write_b128 v13, v[88:91] offset:16896
    s_mov_b64 exec, 1
    v_mov_b32 v4, 1
    ds_add_u32 v3, v4 offset:20
    s_mov_b64 exec, -1
    s_setprio 3
    s_setprio 0
L_late1:
    s_mov_b32 s63, s3
L_grp:
    s_mul_i32 s58, s63, 8448
    s_lshr_b32 s59, s63, 2
    s_mul_i32 s59, s59, 8448
    s_and_b32 s60, s63, 1
    s_bfe_u32 s61, s63, 0x10001
    s_cmp_ge_u32 s63, 8
    s_cselect_b32 s61, s60, s61
    s_cselect_b32 s60, 0, s60
    s_mul_i32 s60, s60, 4224
    s_lshl_b32 s61, s61, 9
    s_add_u32 s59, s59, s60
    s_add_u32 s59, s59, s61
    s_add_u32 s59, s59, 105600
    v_add_u32 v12, s58, v1
    v_bfe_u32 v4, v0, 2, 2
    v_mul_u32_u24 v4, 1056, v4
    v_and_b32 v5, 48, v0
    v_add3_u32 v13, v4, v5, s59
    v_lshl_add_u32 v14, v0, 3, s58
    v_lshl_add_u32 v2, v0, 3, s59
    s_cmp_ge_u32 s63, 8
    s_cbranch_scc1 L_grp2
    s_mov_b32 s59, 0
Lw_44:
    ds_read_b32 v4, v3 offset:20
    s_waitcnt lgkmcnt(0)
    v_cmp_gt_u32 vcc, 8, v4
    s_cbranch_vccz Lk_45
    s_sleep 1
    s_add_u32 s59, s59, 1
    s_cmp_lt_u32 s59, 4194304
    s_cbranch_scc1 Lw_44
    s_branch L_end
Lk_45:
L_grp2:
    s_waitcnt lgkmcnt(0)
    ds_read_b128 v[80:83], v12 offset:0
    ds_read_b128 v[84:87], v13 offset:0
    ds_read_b128 v[88:91], v12 offset:64
    ds_read_b128 v[92:95], v13 offset:64
    ds_read_b128 v[96:99], v12 offset:128
    ds_read_b128 v[100:103], v13 offset:128
    ds_read_b128 v[104:107], v12 offset:192
    ds_read_b128 v[108:111], v13 offset:192
    ds_read_b128 v[112:115], v12 offset:256
    ds_read_b128 v[116:119], v13 offset:256
    ds_read_b128 v[120:123], v12 offset:320
    ds_read_b128 v[124:127], v13 offset:320
    s_waitcnt lgkmcnt(10)
    v_mfma_f32_16x16x32_bf16 v[4:7], v[80:83], v[84:87], 0
    ds_read_b128 v[80:83], v12 offset:384
    ds_read_b128 v[84:87], v13 offset:384
    s_waitcnt lgkmcnt(10)
    v_mfma_f32_16x16x32_bf16 v[4:7], v[88:91], v[92:95], v[4:7]
    ds_read_b128 v[88:91], v12 offset:448
    ds_read_b128 v[92:95], v13 offset:448
    s_waitcnt lgkmcnt(10)
    v_mfma_f32_16x16x32_bf16 v[4:7], v[96:99], v[100:103], v[4:7]
    s_waitcnt lgkmcnt(8)
    v_mfma_f32_16x16x32_bf16 v[4:7], v[104:107], v[108:111], v[4:7]
    s_waitcnt lgkmcnt(6)
    v_mfma_f32_16x16x32_bf16 v[4:7], v[112:115], v[116:119], v[4:7]
    s_waitcnt lgkmcnt(4)
    v_mfma_f32_16x16x32_bf16 v[4:7], v[120:123], v[124:127], v[4:7]
    s_waitcnt lgkmcnt(2)
    v_mfma_f32_16x16x32_bf16 v[4:7], v[80:83], v[84:87], v[4:7]
    s_waitcnt lgkmcnt(0)
    v_mfma_f32_16x16x32_bf16 v[4:7], v[88:91], v[92:95], v[4:7]
    ds_read_b64 v[96:97], v14 offset:2112
    ds_read_b64 v[98:99], v14 offset:6336
    ds_read_b64 v[100:101], v14 offset:2624
    ds_read_b64 v[102:103], v14 offset:6848
    ds_read_b64 v[104:105], v14 offset:3168
    ds_read_b64 v[106:107], v14 offset:7392
    ds_read_b64 v[108:109], v14 offset:3680
    ds_read_b64 v[110:111], v14 offset:7904
    ds_read_b64 v[80:81], v14 offset:0
    ds_read_b64 v[82:83], v14 offset:4224
    ds_read_b64 v[84:85], v14 offset:512
    ds_read_b64 v[86:87], v14 offset:4736
    ds_read_b64 v[88:89], v14 offset:1056
    ds_read_b64 v[90:91], v14 offset:5280
    ds_read_b64 v[92:93], v14 offset:1568
    s_waitcnt lgkmcnt(14)
    ds_read_b64 v[94:95], v14 offset:5792
    v_mul_f32 v4, 0x3db8aa3b, v4
    v_mul_f32 v5, 0x3db8aa3b, v5
    v_mul_f32 v6, 0x3db8aa3b, v6
    v_mul_f32 v7, 0x3db8aa3b, v7
    v_exp_f32 v4, v4
    v_exp_f32 v5, v5
    v_exp_f32 v6, v6
    v_exp_f32 v7, v7
    v_add_f32 v12, v4, v5
    v_add_f32 v13, v6, v7
    v_add_f32 v12, v12, v13
    v_add_f32 v12, 0x3089705f, v12
    v_rcp_f32 v12, v12
    s_add_u32 s63, s63, 8
    v_mul_f32 v4, v4, v12
    v_mul_f32 v5, v5, v12
    v_mul_f32 v6, v6, v12
    v_mul_f32 v7, v7, v12
    v_cvt_pk_bf16_f32 v4, v4, v5
    v_cvt_pk_bf16_f32 v6, v6, v7
    v_perm_b32 v112, v4, v4, v8
    v_perm_b32 v113, v4, v4, v9
    v_perm_b32 v114, v4, v4, v10
    v_perm_b32 v115, v4, v4, v11
    v_perm_b32 v116, v6, v6, v8
    v_perm_b32 v117, v6, v6, v9
    v_perm_b32 v118, v6, v6, v10
    v_perm_b32 v119, v6, v6, v11
    s_waitcnt lgkmcnt(0)
    v_mfma_f32_4x4x4_16b_bf16 v[120:123], v[112:113], v[80:81], 0 cbsz:4 abid:0
    v_mfma_f32_4x4x4_16b_bf16 v[124:127], v[112:113], v[82:83], 0 cbsz:4 abid:5
    v_mfma_f32_4x4x4_16b_bf16 v[4:7], v[112:113], v[84:85], 0 cbsz:4 abid:10
    v_mfma_f32_4x4x4_16b_bf16 v[12:15], v[112:113], v[86:87], 0 cbsz:4 abid:15
    v_mfma_f32_4x4x4_16b_bf16 v[120:123], v[114:115], v[88:89], v[120:123] cbsz:4 abid:0
    v_mfma_f32_4x4x4_16b_bf16 v[124:127], v[114:115], v[90:91], v[124:127] cbsz:4 abid:5
    v_mfma_f32_4x4x4_16b_bf16 v[4:7], v[114:115], v[92:93], v[4:7] cbsz:4 abid:10
    v_mfma_f32_4x4x4_16b_bf16 v[12:15], v[114:115], v[94:95], v[12:15] cbsz:4 abid:15
    v_mfma_f32_4x4x4_16b_bf16 v[120:123], v[116:117], v[96:97], v[120:123] cbsz:4 abid:0
    v_mfma_f32_4x4x4_16b_bf16 v[124:127], v[116:117], v[98:99], v[124:127] cbsz:4 abid:5
    v_mfma_f32_4x4x4_16b_bf16 v[4:7], v[116:117], v[100:101], v[4:7] cbsz:4 abid:10
    v_mfma_f32_4x4x4_16b_bf16 v[12:15], v[116:117], v[102:103], v[12:15] cbsz:4 abid:15
    v_mfma_f32_4x4x4_16b_bf16 v[120:123], v[118:119], v[104:105], v[120:123] cbsz:4 abid:0
    v_mfma_f32_4x4x4_16b_bf16 v[124:127], v[118:119], v[106:107], v[124:127] cbsz:4 abid:5
    v_mfma_f32_4x4x4_16b_bf16 v[4:7], v[118:119], v[108:109], v[4:7] cbsz:4 abid:10
    v_mfma_f32_4x4x4_16b_bf16 v[12:15], v[118:119], v[110:111], v[12:15] cbsz:4 abid:15
    s_nop 1
    v_cvt_pk_bf16_f32 v112, v120, v121
    v_cvt_pk_bf16_f32 v113, v122, v123
    ds_write_b64 v2, v[112:113] offset:0
    v_cvt_pk_bf16_f32 v114, v124, v125
    v_cvt_pk_bf16_f32 v115, v126, v127
    ds_write_b64 v2, v[114:115] offset:1056
    v_cvt_pk_bf16_f32 v116, v4, v5
    v_cvt_pk_bf16_f32 v117, v6, v7
    ds_write_b64 v2, v[116:117] offset:2112
    v_cvt_pk_bf16_f32 v118, v12, v13
    v_cvt_pk_bf16_f32 v119, v14, v15
    ds_write_b64 v2, v[118:119] offset:3168
    s_cmp_lt_u32 s63, 10
    s_cbranch_scc1 L_grp
L_grpx:
    s_mov_b64 exec, 1
    v_mov_b32 v4, 1
    ds_add_u32 v3, v4 offset:24
    s_mov_b64 exec, -1
    v_add_u32 v12, 105600, v1
    v_lshlrev_b32 v14, 4, v0
    v_and_b32 v6, 15, v0
    v_lshlrev_b32 v6, 2, v6
    v_and_b32 v5, 48, v0
    v_lshl_add_u32 v8, v5, 7, v6
    v_and_b32 v5, 32, v0
    v_lshl_add_u32 v9, v5, 6, v6
    v_and_b32 v5, 16, v0
    v_lshl_add_u32 v9, v5, 22, v9
    s_lshl_b32 s60, s5, 9
    s_lshl_b32 s61, s3, 6
    s_add_u32 s60, s60, s61
    s_mov_b32 s59, 0
Lw_46:
    ds_read_b32 v4, v3 offset:24
    s_waitcnt lgkmcnt(0)
    v_cmp_gt_u32 vcc, 8, v4
    s_cbranch_vccz Lk_47
    s_sleep 1
    s_add_u32 s59, s59, 1
    s_cmp_lt_u32 s59, 4194304
    s_cbranch_scc1 Lw_46
    s_branch L_end
Lk_47:
    ds_read_b128 v[80:83], v12 offset:0
    ds_read_b128 v[84:87], v12 offset:8448
    ds_read_b128 v[88:91], v12 offset:16896
    ds_read_b128 v[92:95], v12 offset:64
    ds_read_b128 v[96:99], v12 offset:8512
    ds_read_b128 v[100:103], v12 offset:16960
    s_waitcnt vmcnt(14) lgkmcnt(3)
    v_mfma_f32_16x16x32_bf16 v[104:107], v[80:83], v[16:19], 0
    v_mfma_f32_16x16x32_bf16 v[108:111], v[80:83], v[20:23], 0
    v_mfma_f32_16x16x32_bf16 v[112:115], v[84:87], v[16:19], 0
    v_mfma_f32_16x16x32_bf16 v[116:119], v[84:87], v[20:23], 0
    v_mfma_f32_16x16x32_bf16 v[120:123], v[88:91], v[16:19], 0
    v_mfma_f32_16x16x32_bf16 v[124:127], v[88:91], v[20:23], 0
    ds_read_b128 v[80:83], v12 offset:128
    ds_read_b128 v[84:87], v12 offset:8576
    ds_read_b128 v[88:91], v12 offset:17024
    s_waitcnt vmcnt(12) lgkmcnt(3)
    v_mfma_f32_16x16x32_bf16 v[104:107], v[92:95], v[24:27], v[104:107]
    v_mfma_f32_16x16x32_bf16 v[108:111], v[92:95], v[28:31], v[108:111]
    v_mfma_f32_16x16x32_bf16 v[112:115], v[96:99], v[24:27], v[112:115]
    v_mfma_f32_16x16x32_bf16 v[116:119], v[96:99], v[28:31], v[116:119]
    v_mfma_f32_16x16x32_bf16 v[120:123], v[100:103], v[24:27], v[120:123]
    v_mfma_f32_16x16x32_bf16 v[124:127], v[100:103], v[28:31], v[124:127]
    ds_read_b128 v[92:95], v12 offset:192
    ds_read_b128 v[96:99], v12 offset:8640
    ds_read_b128 v[100:103], v12 offset:17088
    s_waitcnt vmcnt(10) lgkmcnt(3)
    v_mfma_f32_16x16x32_bf16 v[104:107], v[80:83], v[32:35], v[104:107]
    v_mfma_f32_16x16x32_bf16 v[108:111], v[80:83], v[36:39], v[108:111]
    v_mfma_f32_16x16x32_bf16 v[112:115], v[84:87], v[32:35], v[112:115]
    v_mfma_f32_16x16x32_bf16 v[116:119], v[84:87], v[36:39], v[116:119]
    v_mfma_f32_16x16x32_bf16 v[120:123], v[88:91], v[32:35], v[120:123]
    v_mfma_f32_16x16x32_bf16 v[124:127], v[88:91], v[36:39], v[124:127]
    ds_read_b128 v[80:83], v12 offset:256
    ds_read_b128 v[84:87], v12 offset:8704
    ds_read_b128 v[88:91], v12 offset:17152
    s_waitcnt vmcnt(8) lgkmcnt(3)
    v_mfma_f32_16x16x32_bf16 v[104:107], v[92:95], v[40:43], v[104:107]
    v_mfma_f32_16x16x32_bf16 v[108:111], v[92:95], v[44:47], v[108:111]
    v_mfma_f32_16x16x32_bf16 v[112:115], v[96:99], v[40:43], v[112:115]
    v_mfma_f32_16x16x32_bf16 v[116:119], v[96:99], v[44:47], v[116:119]
    v_mfma_f32_16x16x32_bf16 v[120:123], v[100:103], v[40:43], v[120:123]
    v_mfma_f32_16x16x32_bf16 v[124:127], v[100:103], v[44:47], v[124:127]
    ds_read_b128 v[92:95], v12 offset:320
    ds_read_b128 v[96:99], v12 offset:8768
    ds_read_b128 v[100:103], v12 offset:17216
    s_waitcnt vmcnt(6) lgkmcnt(3)
    v_mfma_f32_16x16x32_bf16 v[104:107], v[80:83], v[48:51], v[104:107]
    v_mfma_f32_16x16x32_bf16 v[108:111], v[80:83], v[52:55], v[108:111]
    v_mfma_f32_16x16x32_bf16 v[112:115], v[84:87], v[48:51], v[112:115]
    v_mfma_f32_16x16x32_bf16 v[116:119], v[84:87], v[52:55], v[116:119]
    v_mfma_f32_16x16x32_bf16 v[120:123], v[88:91], v[48:51], v[120:123]
    v_mfma_f32_16x16x32_bf16 v[124:127], v[88:91], v[52:55], v[124:127]
    s_setprio 3
    s_add_u32 s100, s100, 118784
    buffer_load_dwordx4 v[16:19], v14, s[16:19], s100 offen offset:0 sc1
    buffer_load_dwordx4 v[20:23], v14, s[16:19], s100 offen offset:1024 sc1
    buffer_load_dwordx4 v[24:27], v14, s[16:19], s100 offen offset:2048 sc1
    buffer_load_dwordx4 v[28:31], v14, s[16:19], s100 offen offset:3072 sc1
    s_setprio 0
    ds_read_b128 v[80:83], v12 offset:384
    ds_read_b128 v[84:87], v12 offset:8832
    ds_read_b128 v[88:91], v12 offset:17280
    s_waitcnt vmcnt(8) lgkmcnt(3)
    v_mfma_f32_16x16x32_bf16 v[104:107], v[92:95], v[56:59], v[104:107]
    v_mfma_f32_16x16x32_bf16 v[108:111], v[92:95], v[60:63], v[108:111]
    v_mfma_f32_16x16x32_bf16 v[112:115], v[96:99], v[56:59], v[112:115]
    v_mfma_f32_16x16x32_bf16 v[116:119], v[96:99], v[60:63], v[116:119]
    v_mfma_f32_16x16x32_bf16 v[120:123], v[100:103], v[56:59], v[120:123]
    v_mfma_f32_16x16x32_bf16 v[124:127], v[100:103], v[60:63], v[124:127]
    s_setprio 3
    s_add_u32 s100, s100, 4096
    buffer_load_dwordx4 v[32:35], v14, s[16:19], s100 offen offset:0 sc1
    buffer_load_dwordx4 v[36:39], v14, s[16:19], s100 offen offset:1024 sc1
    buffer_load_dwordx4 v[40:43], v14, s[16:19], s100 offen offset:2048 sc1
    buffer_load_dwordx4 v[44:47], v14, s[16:19], s100 offen offset:3072 sc1
    s_setprio 0
    ds_read_b128 v[92:95], v12 offset:448
    ds_read_b128 v[96:99], v12 offset:8896
    ds_read_b128 v[100:103], v12 offset:17344
    s_waitcnt vmcnt(10) lgkmcnt(3)
    v_mfma_f32_16x16x32_bf16 v[104:107], v[80:83], v[64:67], v[104:107]
    v_mfma_f32_16x16x32_bf16 v[108:111], v[80:83], v[68:71], v[108:111]
    v_mfma_f32_16x16x32_bf16 v[112:115], v[84:87], v[64:67], v[112:115]
    v_mfma_f32_16x16x32_bf16 v[116:119], v[84:87], v[68:71], v[116:119]
    v_mfma_f32_16x16x32_bf16 v[120:123], v[88:91], v[64:67], v[120:123]
    v_mfma_f32_16x16x32_bf16 v[124:127], v[88:91], v[68:71], v[124:127]
    s_setprio 3
    s_add_u32 s100, s100, 4096
    buffer_load_dwordx4 v[48:51], v14, s[16:19], s100 offen offset:0 sc1
    buffer_load_dwordx4 v[52:55], v14, s[16:19], s100 offen offset:1024 sc1
    buffer_load_dwordx4 v[56:59], v14, s[16:19], s100 offen offset:2048 sc1
    buffer_load_dwordx4 v[60:63], v14, s[16:19], s100 offen offset:3072 sc1
    s_setprio 0
    s_waitcnt vmcnt(12) lgkmcnt(0)
    v_mfma_f32_16x16x32_bf16 v[104:107], v[92:95], v[72:75], v[104:107]
    v_mfma_f32_16x16x32_bf16 v[108:111], v[92:95], v[76:79], v[108:111]
    v_mfma_f32_16x16x32_bf16 v[112:115], v[96:99], v[72:75], v[112:115]
    v_mfma_f32_16x16x32_bf16 v[116:119], v[96:99], v[76:79], v[116:119]
    v_mfma_f32_16x16x32_bf16 v[120:123], v[100:103], v[72:75], v[120:123]
    v_mfma_f32_16x16x32_bf16 v[124:127], v[100:103], v[76:79], v[124:127]
    s_setprio 3
    s_add_u32 s100, s100, 4096
    buffer_load_dwordx4 v[64:67], v14, s[16:19], s100 offen offset:0 sc1
    buffer_load_dwordx4 v[68:71], v14, s[16:19], s100 offen offset:1024 sc1
    buffer_load_dwordx4 v[72:75], v14, s[16:19], s100 offen offset:2048 sc1
    buffer_load_dwordx4 v[76:79], v14, s[16:19], s100 offen offset:3072 sc1
    s_setprio 0
    s_setprio 3
    s_setprio 0
    v_add_u32 v12, 130944, v1
    s_mov_b32 s59, 0
Lw_48:
    ds_read_b32 v4, v3 offset:36
    s_waitcnt lgkmcnt(0)
    v_cmp_gt_u32 vcc, 16, v4
    s_cbranch_vccz Lk_49
    s_sleep 3
    s_add_u32 s59, s59, 1
    s_cmp_lt_u32 s59, 16777216
    s_cbranch_scc1 Lw_48
    s_branch L_end
Lk_49:
    ds_read_b128 v[80:83], v12 offset:0
    ds_read_b128 v[84:87], v12 offset:64
    ds_read_b128 v[88:91], v12 offset:128
    ds_read_b128 v[92:95], v12 offset:192
    ds_read_b128 v[96:99], v12 offset:256
    ds_read_b128 v[100:103], v12 offset:320
    s_waitcnt vmcnt(14) lgkmcnt(5)
    v_mfma_f32_16x16x32_bf16 v[104:107], v[80:83], v[16:19], v[104:107]
    v_mfma_f32_16x16x32_bf16 v[108:111], v[80:83], v[20:23], v[108:111]
    ds_read_b128 v[80:83], v12 offset:384
    s_waitcnt vmcnt(12) lgkmcnt(5)
    v_mfma_f32_16x16x32_bf16 v[104:107], v[84:87], v[24:27], v[104:107]
    v_mfma_f32_16x16x32_bf16 v[108:111], v[84:87], v[28:31], v[108:111]
    ds_read_b128 v[84:87], v12 offset:448
    s_waitcnt vmcnt(10) lgkmcnt(5)
    v_mfma_f32_16x16x32_bf16 v[104:107], v[88:91], v[32:35], v[104:107]
    v_mfma_f32_16x16x32_bf16 v[108:111], v[88:91], v[36:39], v[108:111]
    s_waitcnt vmcnt(8) lgkmcnt(4)
    v_mfma_f32_16x16x32_bf16 v[104:107], v[92:95], v[40:43], v[104:107]
    v_mfma_f32_16x16x32_bf16 v[108:111], v[92:95], v[44:47], v[108:111]
    s_waitcnt vmcnt(6) lgkmcnt(3)
    v_mfma_f32_16x16x32_bf16 v[104:107], v[96:99], v[48:51], v[104:107]
    v_mfma_f32_16x16x32_bf16 v[108:111], v[96:99], v[52:55], v[108:111]
    s_waitcnt vmcnt(4) lgkmcnt(2)
    v_mfma_f32_16x16x32_bf16 v[104:107], v[100:103], v[56:59], v[104:107]
    v_mfma_f32_16x16x32_bf16 v[108:111], v[100:103], v[60:63], v[108:111]
    s_waitcnt vmcnt(2) lgkmcnt(1)
    v_mfma_f32_16x16x32_bf16 v[104:107], v[80:83], v[64:67], v[104:107]
    v_mfma_f32_16x16x32_bf16 v[108:111], v[80:83], v[68:71], v[108:111]
    s_waitcnt vmcnt(0) lgkmcnt(0)
    v_mfma_f32_16x16x32_bf16 v[104:107], v[84:87], v[72:75], v[104:107]
    v_mfma_f32_16x16x32_bf16 v[108:111], v[84:87], v[76:79], v[108:111]
    s_nop 7
    v_cvt_pk_bf16_f32 v104, v104, v108
    buffer_store_dword v104, v8, s[20:23], s60 offen offset:0 sc1
    v_cvt_pk_bf16_f32 v105, v105, v109
    buffer_store_dword v105, v8, s[20:23], s60 offen offset:512 sc1
    v_cvt_pk_bf16_f32 v106, v106, v110
    buffer_store_dword v106, v8, s[20:23], s60 offen offset:1024 sc1
    v_cvt_pk_bf16_f32 v107, v107, v111
    buffer_store_dword v107, v8, s[20:23], s60 offen offset:1536 sc1
    s_add_u32 s60, s60, 8192
    s_mov_b32 s59, 0
Lw_50:
    ds_read_b32 v4, v3 offset:40
    s_waitcnt lgkmcnt(0)
    v_cmp_gt_u32 vcc, 16, v4
    s_cbranch_vccz Lk_51
    s_sleep 3
    s_add_u32 s59, s59, 1
    s_cmp_lt_u32 s59, 16777216
    s_cbranch_scc1 Lw_50
    s_branch L_end
Lk_51:
    ds_read_b128 v[80:83], v12 offset:8448
    ds_read_b128 v[84:87], v12 offset:8512
    ds_read_b128 v[88:91], v12 offset:8576
    ds_read_b128 v[92:95], v12 offset:8640
    ds_read_b128 v[96:99], v12 offset:8704
    ds_read_b128 v[100:103], v12 offset:8768
    s_waitcnt lgkmcnt(5)
    v_mfma_f32_16x16x32_bf16 v[112:115], v[80:83], v[16:19], v[112:115]
    v_mfma_f32_16x16x32_bf16 v[116:119], v[80:83], v[20:23], v[116:119]
    ds_read_b128 v[80:83], v12 offset:8832
    s_waitcnt lgkmcnt(5)
    v_mfma_f32_16x16x32_bf16 v[112:115], v[84:87], v[24:27], v[112:115]
    v_mfma_f32_16x16x32_bf16 v[116:119], v[84:87], v[28:31], v[116:119]
    ds_read_b128 v[84:87], v12 offset:8896
    s_waitcnt lgkmcnt(5)
    v_mfma_f32_16x16x32_bf16 v[112:115], v[88:91], v[32:35], v[112:115]
    v_mfma_f32_16x16x32_bf16 v[116:119], v[88:91], v[36:39], v[116:119]
    s_waitcnt lgkmcnt(4)
    v_mfma_f32_16x16x32_bf16 v[112:115], v[92:95], v[40:43], v[112:115]
    v_mfma_f32_16x16x32_bf16 v[116:119], v[92:95], v[44:47], v[116:119]
    s_waitcnt lgkmcnt(3)
    v_mfma_f32_16x16x32_bf16 v[112:115], v[96:99], v[48:51], v[112:115]
    v_mfma_f32_16x16x32_bf16 v[116:119], v[96:99], v[52:55], v[116:119]
    s_waitcnt lgkmcnt(2)
    v_mfma_f32_16x16x32_bf16 v[112:115], v[100:103], v[56:59], v[112:115]
    v_mfma_f32_16x16x32_bf16 v[116:119], v[100:103], v[60:63], v[116:119]
    s_waitcnt lgkmcnt(1)
    v_mfma_f32_16x16x32_bf16 v[112:115], v[80:83], v[64:67], v[112:115]
    v_mfma_f32_16x16x32_bf16 v[116:119], v[80:83], v[68:71], v[116:119]
    s_waitcnt lgkmcnt(0)
    v_mfma_f32_16x16x32_bf16 v[112:115], v[84:87], v[72:75], v[112:115]
    v_mfma_f32_16x16x32_bf16 v[116:119], v[84:87], v[76:79], v[116:119]
    s_nop 7
    v_cvt_pk_bf16_f32 v112, v112, v116
    buffer_store_dword v112, v8, s[20:23], s60 offen offset:0 sc1
    v_cvt_pk_bf16_f32 v113, v113, v117
    buffer_store_dword v113, v8, s[20:23], s60 offen offset:512 sc1
    v_cvt_pk_bf16_f32 v114, v114, v118
    buffer_store_dword v114, v8, s[20:23], s60 offen offset:1024 sc1
    v_cvt_pk_bf16_f32 v115, v115, v119
    buffer_store_dword v115, v8, s[20:23], s60 offen offset:1536 sc1
    s_add_u32 s60, s60, 8192
    s_mov_b32 s59, 0
Lw_52:
    ds_read_b32 v4, v3 offset:44
    s_waitcnt lgkmcnt(0)
    v_cmp_gt_u32 vcc, 8, v4
    s_cbranch_vccz Lk_53
    s_add_u32 s59, s59, 1
    s_cmp_lt_u32 s59, 16777216
    s_cbranch_scc1 Lw_52
    s_branch L_end
Lk_53:
    ds_read_b128 v[80:83], v12 offset:16896
    ds_read_b128 v[84:87], v12 offset:16960
    ds_read_b128 v[88:91], v12 offset:17024
    ds_read_b128 v[92:95], v12 offset:17088
    ds_read_b128 v[96:99], v12 offset:17152
    ds_read_b128 v[100:103], v12 offset:17216
    s_waitcnt lgkmcnt(5)
    v_mfma_f32_16x16x32_bf16 v[120:123], v[80:83], v[16:19], v[120:123]
    v_mfma_f32_16x16x32_bf16 v[124:127], v[80:83], v[20:23], v[124:127]
    ds_read_b128 v[80:83], v12 offset:17280
    s_waitcnt lgkmcnt(5)
    v_mfma_f32_16x16x32_bf16 v[120:123], v[84:87], v[24:27], v[120:123]
    v_mfma_f32_16x16x32_bf16 v[124:127], v[84:87], v[28:31], v[124:127]
    ds_read_b128 v[84:87], v12 offset:17344
    s_waitcnt lgkmcnt(5)
    v_mfma_f32_16x16x32_bf16 v[120:123], v[88:91], v[32:35], v[120:123]
    v_mfma_f32_16x16x32_bf16 v[124:127], v[88:91], v[36:39], v[124:127]
    s_waitcnt lgkmcnt(4)
    v_mfma_f32_16x16x32_bf16 v[120:123], v[92:95], v[40:43], v[120:123]
    v_mfma_f32_16x16x32_bf16 v[124:127], v[92:95], v[44:47], v[124:127]
    s_waitcnt lgkmcnt(3)
    v_mfma_f32_16x16x32_bf16 v[120:123], v[96:99], v[48:51], v[120:123]
    v_mfma_f32_16x16x32_bf16 v[124:127], v[96:99], v[52:55], v[124:127]
    s_waitcnt lgkmcnt(2)
    v_mfma_f32_16x16x32_bf16 v[120:123], v[100:103], v[56:59], v[120:123]
    v_mfma_f32_16x16x32_bf16 v[124:127], v[100:103], v[60:63], v[124:127]
    s_waitcnt lgkmcnt(1)
    v_mfma_f32_16x16x32_bf16 v[120:123], v[80:83], v[64:67], v[120:123]
    v_mfma_f32_16x16x32_bf16 v[124:127], v[80:83], v[68:71], v[124:127]
    s_waitcnt lgkmcnt(0)
    v_mfma_f32_16x16x32_bf16 v[120:123], v[84:87], v[72:75], v[120:123]
    v_mfma_f32_16x16x32_bf16 v[124:127], v[84:87], v[76:79], v[124:127]
    s_nop 7
    v_cvt_pk_bf16_f32 v120, v120, v124
    buffer_store_dword v120, v9, s[20:23], s60 offen offset:0 sc1
    v_cvt_pk_bf16_f32 v121, v121, v125
    buffer_store_dword v121, v9, s[20:23], s60 offen offset:512 sc1
    v_cvt_pk_bf16_f32 v122, v122, v126
    buffer_store_dword v122, v9, s[20:23], s60 offen offset:1024 sc1
    v_cvt_pk_bf16_f32 v123, v123, v127
    buffer_store_dword v123, v9, s[20:23], s60 offen offset:1536 sc1
L_end:
L_exit:
    s_endpgm
L_slow:
    s_setprio 0
    ds_add_u32 v61, v62 offset:16
    s_mov_b32 s59, 0
Lw_54:
    ds_read_b32 v4, v3 offset:16
    s_waitcnt lgkmcnt(0)
    v_cmp_gt_u32 vcc, 8, v4
    s_cbranch_vccz Lk_55
    s_add_u32 s59, s59, 1
    s_cmp_lt_u32 s59, 4194304
    s_cbranch_scc1 Lw_54
    s_branch L_end
Lk_55:
    v_mov_b32 v12, v3
    s_mov_b64 s[24:25], s[34:35]
    s_mov_b32 s26, 640000
    s_mov_b64 s[28:29], s[36:37]
    s_mov_b32 s30, 640000
    s_mov_b64 s[12:13], s[42:43]
    s_mov_b32 s14, 20000
    s_mov_b32 s15, 0x20000
    s_sub_u32 s63, s67, 1
    s_mov_b32 s65, 201486528
    s_mov_b32 s64, 0
    s_call_b64 s[68:69], L_flush
    s_add_u32 s66, s4, s5
    s_add_u32 s67, s66, 40
    v_lshlrev_b32 v16, 2, v0
    v_and_b32 v17, 32, v0
    v_lshl_add_u32 v17, v17, 22, v2
    v_mov_b32 v24, 0
L_sn:
    s_mov_b32 s60, 0
L_sc:
    buffer_load_dword v18, v16, s[28:31], s60 offen
    buffer_load_dword v19, v16, s[24:27], s60 offen
    s_waitcnt vmcnt(0)
    v_cmp_eq_u32 vcc, s66, v18
    s_cbranch_vccz L_sx
L_se:
    s_ff1_i32_b64 s58, vcc
    s_bitset0_b64 vcc, s58
    v_readlane_b32 s59, v19, s58
    s_nop 0
    s_lshl_b32 s61, s59, 9
    s_lshl_b32 s59, s59, 1
    buffer_load_dwordx4 v[20:23], v17, s[8:11], s61 offen
    buffer_load_ushort v1, v24, s[12:15], s59 offen
    s_waitcnt vmcnt(0)
    v_perm_b32 v6, v1, v1, v10
    v_perm_b32 v7, v1, v1, v11
    s_nop 1
    v_mfma_f32_4x4x4_16b_bf16 v[56:59], v[6:7], v[20:21], v[56:59]
    v_mfma_f32_4x4x4_16b_bf16 v[60:63], v[6:7], v[22:23], v[60:63]
    s_cmp_lg_u64 vcc, 0
    s_cbranch_scc1 L_se
L_sx:
    s_add_u32 s60, s60, 256
    s_cmp_lt_u32 s60, 640000
    s_cbranch_scc1 L_sc
    s_call_b64 s[68:69], L_flush
    s_add_u32 s66, s66, 8
    s_cmp_lt_u32 s66, s67
    s_cbranch_scc1 L_sn
    s_branch L_gdone
.section .rodata,"a"
.p2align 6
.amdhsa_kernel standalone__hybrid_graph_tf_exphormer__graph_kernel
  .amdhsa_next_free_vgpr 128
  .amdhsa_next_free_sgpr 102
  .amdhsa_accum_offset 128
  .amdhsa_group_segment_fixed_size 0
  .amdhsa_kernarg_size 104
  .amdhsa_user_sgpr_count 2
  .amdhsa_user_sgpr_kernarg_segment_ptr 1
  .amdhsa_system_sgpr_workgroup_id_x 1
.end_amdhsa_kernel
```

```asm
; @launch grid=(250,1,1) block=(1024,1,1) lds=161984
.amdgcn_target "amdgcn-amd-amdhsa--gfx950"
.text
.globl standalone__hybrid_graph_tf_exphormer__graph_kernel
.p2align 8
.type standalone__hybrid_graph_tf_exphormer__graph_kernel,@function
standalone__hybrid_graph_tf_exphormer__graph_kernel:
    s_cmp_ge_u32 s2, 250
    s_cbranch_scc1 L_exit
    s_load_dwordx16 s[32:47], s[0:1], 0
    s_load_dwordx8 s[48:55], s[0:1], 64
    s_load_dwordx2 s[56:57], s[0:1], 96
    s_getpc_b64 s[60:61]
    s_lshr_b32 s6, s2, 3
    v_lshl_add_u32 v1, v0, 5, s6
    v_cmp_gt_u32 vcc, 86, v1
    v_lshlrev_b32 v1, 7, v1
    s_and_saveexec_b64 s[58:59], vcc
    s_cbranch_execz L_nopf
    global_load_dword v15, v1, s[60:61]
L_nopf:
    s_mov_b64 exec, -1
    v_lshrrev_b32 v1, 6, v0
    v_mov_b32 v8, 33554432
    v_readfirstlane_b32 s3, v1
    v_cmp_gt_u32 vcc, 288, v0
    v_lshlrev_b32 v5, 4, v0
    v_add_u32 v4, 152064, v5
    v_cndmask_b32 v8, 0, v8, vcc
    v_mov_b32 v9, v8
    v_mov_b64 v[10:11], v[8:9]
    v_cmp_gt_u32 vcc, 556, v0
    s_and_saveexec_b64 s[58:59], vcc
    ds_write_b128 v4, v[8:11]
    s_mov_b64 exec, -1
    v_and_b32 v0, 63, v0
    v_and_b32 v2, 31, v0
    v_lshlrev_b32 v2, 4, v2
    s_and_b32 s59, s2, 7
    s_mul_i32 s60, s59, 31
    s_min_u32 s59, s59, 2
    s_add_u32 s6, s6, s60
    s_add_u32 s6, s6, s59
    s_mov_b32 s27, 0x20000
    s_mov_b32 s31, 0x20000
    s_xor_b32 s3, s3, 8
    s_and_b32 s4, s3, 7
    s_cmp_lt_u32 s3, 8
    s_cbranch_scc1 L_e3
    s_setprio 3
    s_cmp_ge_u32 s2, 64
    s_cbranch_scc1 L_e1
    v_lshrrev_b32 v6, 2, v5
    s_mul_i32 s58, s2, 10000
    s_add_u32 s60, s58, 8192
    s_mov_b32 s26, 640000
    s_mov_b32 s30, 640000
    s_mov_b32 s59, 1048576
    s_mov_b32 s63, 1
    s_waitcnt lgkmcnt(0)
    s_mov_b64 s[28:29], s[36:37]
    s_mov_b64 s[24:25], s[34:35]
    buffer_load_dwordx4 v[22:25], v5, s[28:31], s58 offen
    buffer_load_dword v26, v6, s[28:31], s60 offen
    s_setprio 2
    buffer_load_dwordx4 v[16:19], v5, s[24:27], s58 offen
    buffer_load_dword v20, v6, s[24:27], s60 offen
    s_setprio 3
L_ep:
    s_load_dword s40, s[56:57], s59
    s_branch L_bar
L_e1:
    s_mov_b32 s26, 131072
    s_sub_u32 s60, s3, 9
    s_cmp_lt_u32 s60, 3
    s_cbranch_scc1 L_e1b
    s_mov_b32 s63, 0
    s_cmp_eq_u32 s3, 8
    s_cbranch_scc0 L_barw
    s_mov_b32 s63, 5
    s_mov_b32 s59, 1048576
    s_waitcnt lgkmcnt(0)
    s_branch L_ep
L_e1b:
    s_sub_u32 s62, s2, 64
    s_cmp_ge_u32 s62, 128
    s_cbranch_scc1 L_e2
    s_and_b32 s58, s62, 7
    s_lshr_b32 s59, s62, 4
    s_bfe_u32 s61, s62, 0x10003
    s_cmp_eq_u32 s60, 2
    s_cselect_b32 s58, s59, s58
    s_cselect_b32 s61, s61, s60
    s_lshl_b32 s58, s58, 14
    s_lshl_b32 s61, s61, 11
    s_add_u32 s58, s58, s61
    s_add_u32 s59, s58, 4096
    v_and_b32 v4, 32, v0
    v_lshl_add_u32 v4, v4, 8, v2
    s_mul_i32 s61, s60, 8448
    s_add_u32 m0, s61, 105600
    s_cmp_eq_u32 s60, 0
    s_cselect_b32 s63, 2, 3
    s_cmp_eq_u32 s60, 2
    s_waitcnt lgkmcnt(0)
    s_cselect_b64 s[24:25], s[48:49], s[46:47]
    buffer_load_dwordx4 v4, s[24:27], s58 offen offset:0 lds
    s_add_u32 m0, m0, 544
    s_nop 0
    buffer_load_dwordx4 v4, s[24:27], s58 offen offset:512 lds
    s_add_u32 m0, m0, 544
    s_nop 0
    buffer_load_dwordx4 v4, s[24:27], s58 offen offset:1024 lds
    s_add_u32 m0, m0, 544
    s_nop 0
    buffer_load_dwordx4 v4, s[24:27], s58 offen offset:1536 lds
    s_add_u32 m0, m0, 2592
    s_nop 0
    buffer_load_dwordx4 v4, s[24:27], s59 offen offset:0 lds
    s_add_u32 m0, m0, 544
    s_nop 0
    buffer_load_dwordx4 v4, s[24:27], s59 offen offset:512 lds
    s_add_u32 m0, m0, 544
    s_nop 0
    buffer_load_dwordx4 v4, s[24:27], s59 offen offset:1024 lds
    s_add_u32 m0, m0, 544
    s_nop 0
    buffer_load_dwordx4 v4, s[24:27], s59 offen offset:1536 lds
    s_branch L_bar
L_e2:
    s_mul_i32 s60, s60, 58
    s_add_u32 s62, s62, s60
    s_sub_u32 s62, s62, 128
    s_mov_b32 s63, 3
    s_cmp_ge_u32 s62, 128
    s_cbranch_scc1 L_barw
    s_mov_b32 s63, 4
    s_and_b32 s59, s62, 7
    s_lshl_b32 s59, s59, 14
    s_bfe_u32 s60, s62, 0x30003
    s_lshl_b32 s60, s60, 6
    s_add_u32 s59, s59, s60
    v_and_b32 v4, 15, v0
    v_lshlrev_b32 v4, 2, v4
    v_and_b32 v5, 48, v0
    v_lshl_add_u32 v4, v5, 8, v4
    s_cmp_lt_u32 s62, 64
    s_waitcnt lgkmcnt(0)
    s_cselect_b64 s[24:25], s[50:51], s[44:45]
    buffer_load_dword v16, v4, s[24:27], s59 offen offset:0
    buffer_load_dword v17, v4, s[24:27], s59 offen offset:512
    buffer_load_dword v18, v4, s[24:27], s59 offen offset:1024
    buffer_load_dword v19, v4, s[24:27], s59 offen offset:1536
    buffer_load_dword v20, v4, s[24:27], s59 offen offset:2048
    buffer_load_dword v21, v4, s[24:27], s59 offen offset:2560
    buffer_load_dword v22, v4, s[24:27], s59 offen offset:3072
    buffer_load_dword v23, v4, s[24:27], s59 offen offset:3584
    s_branch L_bar
L_e3:
    s_mul_i32 s58, s6, 640
    s_lshl_b32 s59, s3, 6
    s_add_u32 s59, s59, s58
    s_lshr_b32 s60, s3, 2
    s_lshl_b32 s60, s60, 6
    s_and_b32 s61, s3, 3
    s_lshl_b32 s61, s61, 3
    s_add_u32 s60, s60, s61
    s_add_u32 s60, s60, s58
    s_add_u32 s60, s60, 512
    s_add_u32 s61, s60, 32
    s_waitcnt lgkmcnt(0)
    s_mov_b64 s[62:63], s[38:39]
    s_mov_b64 s[8:9], s[32:33]
    s_load_dwordx16 s[32:47], s[62:63], s59
    s_load_dwordx2 s[64:65], s[62:63], s60
    s_load_dwordx2 s[66:67], s[62:63], s61
    s_barrier
    s_branch L_preA
L_barw:
    s_waitcnt lgkmcnt(0)
L_bar:
    s_barrier
    s_mov_b64 s[8:9], s[32:33]
    s_mul_i32 s5, s6, 40
    v_mov_b32 v3, 159296
    s_mov_b32 s10, 5120000
    s_mov_b32 s11, 0x20000
    s_mov_b64 s[16:17], s[56:57]
    s_mov_b32 s18, 1441792
    s_mov_b32 s19, 0x20000
    v_min_u32 v4, 1, v0
    v_lshl_add_u32 v61, v0, 2, v3
    v_lshl_add_u32 v61, v4, 16, v61
    v_mov_b32 v62, 1
    s_cmp_eq_u32 s63, 1
    s_cbranch_scc0 L_notprod
    v_mov_b32 v9, 4
    v_mov_b32 v10, 159936
    v_lshl_add_u32 v11, v0, 4, v10
    v_cmp_gt_u32 vcc, 7232, v5
    v_add_u32 v59, 105600, v5
    s_mul_i32 s58, s2, 10240
    s_mov_b64 s[66:67], vcc
    s_waitcnt vmcnt(3)
    v_mul_u32_u24 v28, 52429, v22
    v_lshrrev_b32 v28, 21, v28
    v_lshl_add_u32 v28, v28, 2, v10
    ds_add_rtn_u32 v34, v28, v9
    v_mul_u32_u24 v29, 52429, v23
    v_lshrrev_b32 v29, 21, v29
    v_lshl_add_u32 v29, v29, 2, v10
    ds_add_rtn_u32 v35, v29, v9
    v_mul_u32_u24 v30, 52429, v24
    v_lshrrev_b32 v30, 21, v30
    v_lshl_add_u32 v30, v30, 2, v10
    ds_add_rtn_u32 v36, v30, v9
    v_mul_u32_u24 v31, 52429, v25
    v_lshrrev_b32 v31, 21, v31
    v_lshl_add_u32 v31, v31, 2, v10
    ds_add_rtn_u32 v37, v31, v9
    s_waitcnt vmcnt(2)
    s_mov_b64 exec, s[66:67]
    v_mul_u32_u24 v32, 52429, v26
    v_lshrrev_b32 v32, 21, v32
    v_lshl_add_u32 v32, v32, 2, v10
    ds_add_rtn_u32 v38, v32, v9
    s_mov_b64 exec, -1
    s_waitcnt lgkmcnt(0)
    s_barrier
    ds_read_b128 v[12:15], v11
    s_add_u32 s40, s40, 0x9e377000
    s_and_b32 s40, s40, 4294963200
    s_waitcnt lgkmcnt(0)
    v_add_u32 v56, v12, v13
    v_add3_u32 v57, v56, v14, v15
    s_nop 1
    v_add_u32_dpp v58, v57, v57 row_shr:1 row_mask:0xf bank_mask:0xf bound_ctrl:1
    s_nop 1
    v_add_u32_dpp v58, v58, v58 row_shr:2 row_mask:0xf bank_mask:0xf bound_ctrl:1
    s_nop 1
    v_add_u32_dpp v58, v58, v58 row_shr:4 row_mask:0xf bank_mask:0xf bound_ctrl:1
    s_nop 1
    v_add_u32_dpp v58, v58, v58 row_shr:8 row_mask:0xf bank_mask:0xf bound_ctrl:1
    s_nop 1
    v_add_u32_dpp v58, v58, v58 row_bcast:15 row_mask:0xa bank_mask:0xf
    s_nop 1
    v_add_u32_dpp v58, v58, v58 row_bcast:31 row_mask:0xc bank_mask:0xf
    v_sub_u32 v64, v58, v57
    v_add_u32 v65, v64, v12
    v_add_u32 v66, v64, v56
    v_add_u32 v67, v66, v14
    ds_write_b128 v11, v[64:67] offset:1024
    ds_read_b32 v40, v28 offset:1024
    ds_read_b32 v41, v29 offset:1024
    ds_read_b32 v42, v30 offset:1024
    ds_read_b32 v43, v31 offset:1024
    s_mov_b64 exec, s[66:67]
    ds_read_b32 v44, v32 offset:1024
    s_mov_b64 exec, -1
    s_mov_b32 s60, 105600
    s_waitcnt vmcnt(0)
    v_lshl_or_b32 v16, v22, 16, v16
    v_lshl_or_b32 v17, v23, 16, v17
    v_lshl_or_b32 v18, v24, 16, v18
    v_lshl_or_b32 v19, v25, 16, v19
    v_lshl_or_b32 v20, v26, 16, v20
    s_waitcnt lgkmcnt(4)
    v_add3_u32 v40, v40, v34, s60
    ds_write_b32 v40, v16
    s_waitcnt lgkmcnt(4)
    v_add3_u32 v41, v41, v35, s60
    ds_write_b32 v41, v17
    s_waitcnt lgkmcnt(4)
    v_add3_u32 v42, v42, v36, s60
    ds_write_b32 v42, v18
    s_waitcnt lgkmcnt(4)
    v_add3_u32 v43, v43, v37, s60
    ds_write_b32 v43, v19
    s_mov_b64 exec, s[66:67]
    s_waitcnt lgkmcnt(4)
    v_add3_u32 v44, v44, v38, s60
    ds_write_b32 v44, v20
    s_mov_b64 exec, -1
    v_lshrrev_b32 v64, 2, v64
    v_or_b32 v64, s40, v64
    v_lshrrev_b32 v65, 2, v65
    v_or_b32 v65, s40, v65
    v_lshrrev_b32 v66, 2, v66
    v_or_b32 v66, s40, v66
    v_lshrrev_b32 v67, 2, v67
    v_or_b32 v67, s40, v67
    s_waitcnt lgkmcnt(0)
    s_barrier
    ds_read_b128 v[12:15], v59
    ds_read_b128 v[68:71], v59 offset:8192
    s_add_u32 s60, s58, 8192
    s_cmp_ge_u32 s4, 2
    s_waitcnt lgkmcnt(1)
    buffer_store_dwordx4 v[12:15], v5, s[16:19], s58 offen sc1
    s_cbranch_scc1 L_cp1
    s_waitcnt lgkmcnt(0)
    buffer_store_dwordx4 v[68:71], v5, s[16:19], s60 offen sc1
L_cp1:
    s_waitcnt vmcnt(0)
    ds_add_u32 v61, v62 offset:56
    s_cmp_eq_u32 s4, 0
    s_cbranch_scc0 L_preB
    s_lshl_b32 s61, s2, 10
    s_add_u32 s61, s61, 1114112
    s_or_b32 s60, s40, 1
    v_mov_b32 v8, s60
    s_mov_b32 s59, 0
Lw_1:
    ds_read_b32 v4, v3 offset:56
    s_waitcnt lgkmcnt(0)
    v_cmp_gt_u32 vcc, 8, v4
    s_cbranch_vccz Lk_2
    s_add_u32 s59, s59, 1
    s_cmp_lt_u32 s59, 4194304
    s_cbranch_scc1 Lw_1
    s_branch L_end
Lk_2:
    buffer_store_dwordx4 v[64:67], v5, s[16:19], s61 offen sc1
    ds_write_b32 v3, v8 offset:32
    s_branch L_preB
L_notprod:
    s_cmp_eq_u32 s63, 0
    s_cbranch_scc1 L_preB
    s_cmp_eq_u32 s63, 3
    s_cbranch_scc1 L_taskw
    s_cmp_eq_u32 s63, 4
    s_cbranch_scc1 L_wtask
    s_cmp_eq_u32 s63, 5
    s_cbranch_scc1 L_flag
    v_and_b32 v4, 7, v0
    v_mul_u32_u24 v1, 1056, v4
    v_and_b32 v4, 8, v0
    v_lshl_add_u32 v1, v4, 6, v1
    v_and_b32 v4, 48, v0
    v_add_u32 v1, v4, v1
    v_add_u32 v5, 105600, v1
    s_lshr_b32 s58, s62, 4
    s_lshl_b32 s58, s58, 3
    s_and_b32 s59, s62, 7
    s_add_u32 s58, s58, s59
    s_lshl_b32 s58, s58, 1
    s_bfe_u32 s59, s62, 0x10003
    s_add_u32 s58, s58, s59
    s_lshl_b32 s58, s58, 10
    s_add_u32 s58, s58, 655360
    v_lshlrev_b32 v6, 4, v0
    s_waitcnt vmcnt(0)
    s_mov_b32 s59, 0
Lw_3:
    ds_read_b32 v4, v3 offset:56
    s_waitcnt lgkmcnt(0)
    v_cmp_gt_u32 vcc, 2, v4
    s_cbranch_vccz Lk_4
    s_add_u32 s59, s59, 1
    s_cmp_lt_u32 s59, 4194304
    s_cbranch_scc1 Lw_3
    s_branch L_end
Lk_4:
    ds_read_b128 v[16:19], v5 offset:0
    ds_read_b128 v[20:23], v5 offset:8448
    ds_read_b128 v[24:27], v5 offset:16896
    ds_read_b128 v[28:31], v5 offset:64
    ds_read_b128 v[32:35], v5 offset:8512
    ds_read_b128 v[36:39], v5 offset:16960
    ds_read_b128 v[40:43], v5 offset:128
    ds_read_b128 v[44:47], v5 offset:8576
    ds_read_b128 v[48:51], v5 offset:17024
    ds_read_b128 v[64:67], v5 offset:192
    ds_read_b128 v[68:71], v5 offset:8640
    ds_read_b128 v[72:75], v5 offset:17088
    s_waitcnt lgkmcnt(9)
    ds_read_b128 v[76:79], v5 offset:256
    ds_read_b128 v[80:83], v5 offset:8704
    ds_read_b128 v[84:87], v5 offset:17152
    v_mfma_f32_16x16x32_bf16 v[8:11], v[16:19], v[24:27], 0
    v_mfma_f32_16x16x32_bf16 v[12:15], v[20:23], v[24:27], 0
    s_waitcnt lgkmcnt(9)
    ds_read_b128 v[88:91], v5 offset:320
    ds_read_b128 v[92:95], v5 offset:8768
    ds_read_b128 v[96:99], v5 offset:17216
    v_mfma_f32_16x16x32_bf16 v[8:11], v[28:31], v[36:39], v[8:11]
    v_mfma_f32_16x16x32_bf16 v[12:15], v[32:35], v[36:39], v[12:15]
    s_waitcnt lgkmcnt(9)
    ds_read_b128 v[100:103], v5 offset:384
    ds_read_b128 v[104:107], v5 offset:8832
    ds_read_b128 v[108:111], v5 offset:17280
    v_mfma_f32_16x16x32_bf16 v[8:11], v[40:43], v[48:51], v[8:11]
    v_mfma_f32_16x16x32_bf16 v[12:15], v[44:47], v[48:51], v[12:15]
    s_waitcnt lgkmcnt(9)
    ds_read_b128 v[112:115], v5 offset:448
    ds_read_b128 v[116:119], v5 offset:8896
    ds_read_b128 v[120:123], v5 offset:17344
    v_mfma_f32_16x16x32_bf16 v[8:11], v[64:67], v[72:75], v[8:11]
    v_mfma_f32_16x16x32_bf16 v[12:15], v[68:71], v[72:75], v[12:15]
    s_waitcnt lgkmcnt(9)
    v_mfma_f32_16x16x32_bf16 v[8:11], v[76:79], v[84:87], v[8:11]
    v_mfma_f32_16x16x32_bf16 v[12:15], v[80:83], v[84:87], v[12:15]
    s_waitcnt lgkmcnt(6)
    v_mfma_f32_16x16x32_bf16 v[8:11], v[88:91], v[96:99], v[8:11]
    v_mfma_f32_16x16x32_bf16 v[12:15], v[92:95], v[96:99], v[12:15]
    s_waitcnt lgkmcnt(3)
    v_mfma_f32_16x16x32_bf16 v[8:11], v[100:103], v[108:111], v[8:11]
    v_mfma_f32_16x16x32_bf16 v[12:15], v[104:107], v[108:111], v[12:15]
    s_waitcnt lgkmcnt(0)
    v_mfma_f32_16x16x32_bf16 v[8:11], v[112:115], v[120:123], v[8:11]
    v_mfma_f32_16x16x32_bf16 v[12:15], v[116:119], v[120:123], v[12:15]
    s_nop 6
    v_cvt_pk_bf16_f32 v16, v8, v9
    v_cvt_pk_bf16_f32 v17, v10, v11
    v_cvt_pk_bf16_f32 v18, v12, v13
    v_cvt_pk_bf16_f32 v19, v14, v15
    buffer_store_dwordx4 v[16:19], v6, s[16:19], s58 offen sc1
    s_branch L_taskw
L_wtask:
    s_lshl_b32 s58, s62, 11
    s_add_u32 s58, s58, 786432
    v_lshlrev_b32 v6, 4, v0
    s_mov_b32 s70, 0x05040100
    s_mov_b32 s71, 0x07060302
    s_waitcnt vmcnt(0)
    v_perm_b32 v64, v17, v16, s70
    v_perm_b32 v68, v17, v16, s71
    v_perm_b32 v65, v19, v18, s70
    v_perm_b32 v69, v19, v18, s71
    v_perm_b32 v66, v21, v20, s70
    v_perm_b32 v70, v21, v20, s71
    v_perm_b32 v67, v23, v22, s70
    v_perm_b32 v71, v23, v22, s71
    buffer_store_dwordx4 v[64:67], v6, s[16:19], s58 offen sc1
    buffer_store_dwordx4 v[68:71], v6, s[16:19], s58 offen offset:1024 sc1
L_taskw:
    s_waitcnt vmcnt(0)
    ds_add_u32 v61, v62 offset:56
    s_branch L_preB
L_flag:
    s_waitcnt vmcnt(0) lgkmcnt(0)
    s_add_u32 s40, s40, 0x9e377000
    s_and_b32 s40, s40, 4294963200
    s_mul_i32 s61, s2, 16
    s_add_u32 s61, s61, 1178624
    s_or_b32 s60, s40, 1
    v_mov_b32 v8, s60
    v_mov_b32 v10, s40
    v_mov_b32 v11, s40
    v_lshlrev_b32 v9, 15, v0
    s_mov_b32 s59, 0
Lw_5:
    ds_read_b32 v4, v3 offset:56
    s_waitcnt lgkmcnt(0)
    v_cmp_gt_u32 vcc, 3, v4
    s_cbranch_vccz Lk_6
    s_add_u32 s59, s59, 1
    s_cmp_lt_u32 s59, 4194304
    s_cbranch_scc1 Lw_5
    s_branch L_end
Lk_6:
    s_mov_b64 exec, 255
    buffer_store_dwordx2 v[10:11], v9, s[16:19], s61 offen sc1
    ds_write_b32 v3, v8 offset:32
    s_mov_b64 exec, -1
L_preB:
    s_setprio 3
    s_mov_b64 s[28:29], s[42:43]
    s_mov_b32 s30, 20000
    s_setprio 3
    s_lshl_b32 s58, s4, 10
    v_lshlrev_b32 v5, 4, v0
    s_add_u32 m0, s58, 130944
    s_add_u32 s59, s58, 0
    buffer_load_dwordx4 v5, s[28:31], s59 offen lds
    s_add_u32 m0, s58, 139136
    s_add_u32 s59, s58, 8192
    buffer_load_dwordx4 v5, s[28:31], s59 offen lds
    s_cmp_lt_u32 s4, 4
    s_cbranch_scc1 L_disd
    s_add_u32 m0, s58, 143232
    s_add_u32 s59, s58, 12288
    buffer_load_dwordx4 v5, s[28:31], s59 offen lds
L_disd:
    s_setprio 3
    v_and_b32 v4, 3, v0
    v_mov_b32 v5, 0x0c0c0c0c
    v_mov_b32 v6, 0x0c0c0302
    v_mov_b32 v7, 0x03020c0c
    v_cmp_eq_u32 s[58:59], 0, v4
    v_cmp_eq_u32 s[60:61], 2, v4
    v_cmp_eq_u32 vcc, 1, v4
    v_cndmask_b32 v10, v5, v6, s[58:59]
    v_cndmask_b32 v11, v5, v6, s[60:61]
    v_cndmask_b32 v10, v10, v7, vcc
    v_cmp_eq_u32 vcc, 3, v4
    s_nop 1
    v_cndmask_b32 v11, v11, v7, vcc
    v_and_b32 v10, 0xfdfdfdfd, v10
    v_and_b32 v11, 0xfdfdfdfd, v11
    s_movk_i32 s7, 512
    s_lshl_b32 s58, s4, 3
    v_lshrrev_b32 v5, 3, v0
    v_and_b32 v6, 7, v0
    v_add_u32 v7, s58, v5
    v_mul_u32_u24 v49, 10240, v7
    v_lshl_add_u32 v49, v6, 4, v49
    v_lshlrev_b32 v56, 2, v6
    s_lshl_b32 s60, s6, 2
    s_add_u32 s60, s60, 1114112
    v_lshl_add_u32 v54, v7, 10, s60
    v_mad_u32_u24 v7, v7, 3, v6
    v_cmp_ge_u32 vcc, 186, v7
    v_cmp_gt_u32 s[64:65], 4, v6
    v_mul_u32_u24 v7, 16, v7
    s_and_b64 s[64:65], s[64:65], vcc
    v_cmp_eq_u32 vcc, 0, v6
    s_and_b32 s58, s2, 7
    s_lshl_b32 s58, s58, 15
    s_add_u32 s58, s58, 1179632
    v_add_u32 v7, s58, v7
    s_or_b64 s[64:65], s[64:65], vcc
    v_cndmask_b32 v54, v7, v54, vcc
    v_cmp_gt_u32 s[62:63], 5, v6
    v_lshl_add_u32 v50, v6, 3, v5
    v_mul_u32_u24 v55, 72, v5
    v_add_u32 v55, 72, v55
    v_lshrrev_b32 v5, 4, v50
    v_mul_u32_u24 v9, 8448, v5
    v_lshl_add_u32 v9, v5, 26, v9
    v_cmp_le_u32 vcc, 32, v50
    v_and_b32 v5, 7, v50
    v_and_b32 v6, 3, v50
    v_cndmask_b32 v5, v5, v6, vcc
    v_mul_u32_u24 v5, 1056, v5
    v_bfe_u32 v6, v50, 3, 1
    v_bfe_u32 v7, v50, 2, 1
    v_cndmask_b32 v6, v6, v7, vcc
    v_lshl_add_u32 v5, v6, 9, v5
    v_mov_b32 v52, 130944
    v_add3_u32 v9, v9, v5, v52
    v_lshrrev_b32 v5, 5, v0
    v_lshl_add_u32 v15, v5, 3, v2
    s_lshl_b32 s58, s5, 2
    s_sub_u32 s58, 158976, s58
    v_mov_b32 v53, s58
    v_add_u32 v5, s5, v50
    v_lshl_add_u32 v8, v5, 1, v52
    v_lshlrev_b32 v50, 2, v50
    v_add_u32 v50, 158976, v50
    v_mov_b32 v57, 156672
    v_mov_b32 v60, 152064
    v_mov_b64 v[16:17], 0
    v_mov_b64 v[18:19], 0
    s_mov_b32 s59, 0
Lw_7:
    ds_read_b32 v4, v3 offset:60
    s_waitcnt lgkmcnt(0)
    v_cmp_gt_u32 vcc, 8, v4
    s_cbranch_vccz Lk_8
    s_sleep 2
    s_add_u32 s59, s59, 1
    s_cmp_lt_u32 s59, 4194304
    s_cbranch_scc1 Lw_7
    s_branch L_end
Lk_8:
    s_mov_b32 s59, 0
Lw_9:
    ds_read_b32 v4, v3 offset:32
    s_waitcnt lgkmcnt(0)
    v_cmp_gt_u32 vcc, 1, v4
    s_cbranch_vccz Lk_10
    s_sleep 1
    s_add_u32 s59, s59, 1
    s_cmp_lt_u32 s59, 4194304
    s_cbranch_scc1 Lw_9
    s_branch L_end
Lk_10:
    v_readfirstlane_b32 s40, v4
    s_mov_b32 s59, 0
    s_bitset0_b32 s40, 0
    s_and_b32 exec_lo, s64, 0xfefefefe
    s_and_b32 exec_hi, s65, 0xfefefefe
L_spolla:
    buffer_load_dwordx2 v[58:59], v54, s[16:19], 0 offen sc1
    s_add_u32 s59, s59, 1
    s_cmp_gt_u32 s59, 0x40000
    s_cbranch_scc1 L_end
    s_waitcnt vmcnt(0)
    v_xor_b32 v58, s40, v58
    v_xor_b32 v59, s40, v59
    v_or_b32 v5, v58, v59
    v_cmpx_lt_u32 vcc, 4095, v5
    s_cbranch_execz L_soka
    s_sleep 8
    s_branch L_spolla
L_soka:
    s_mov_b64 exec, -1
    ds_add_u32 v61, v62 offset:52
    s_mov_b32 exec_lo, 0x01010101
    s_mov_b32 exec_hi, 0x01010101
L_spollb:
    buffer_load_dwordx2 v[58:59], v54, s[16:19], 0 offen sc1
    s_add_u32 s59, s59, 1
    s_cmp_gt_u32 s59, 0x40000
    s_cbranch_scc1 L_end
    s_waitcnt vmcnt(0)
    v_xor_b32 v58, s40, v58
    v_xor_b32 v59, s40, v59
    v_or_b32 v5, v58, v59
    v_cmpx_lt_u32 vcc, 4095, v5
    s_cbranch_execz L_sokb
    s_sleep 8
    s_branch L_spollb
L_sokb:
    s_mov_b64 exec, -1
    v_sub_u32 v48, v59, v58
    v_lshl_or_b32 v48, v48, 16, v58
    s_nop 1
    v_mov_b32_dpp v48, v48 quad_perm:[0,0,0,0] row_mask:0xf bank_mask:0xf
    s_nop 1
    v_mov_b32_dpp v48, v48 row_shr:4 row_mask:0xf bank_mask:0xa
    v_mad_u32_u16 v49, v48, 4, v49
    v_lshrrev_b32 v48, 16, v48
    v_sub_u32 v48, v48, v56
    v_cmpx_lt_i32 vcc, 0, v48
    s_cbranch_execz L_entld
    buffer_load_dwordx4 v[16:19], v49, s[16:19], 0 offen sc1
    v_cmpx_lt_i32 vcc, 32, v48
    ds_write_b32 v3, v62 offset:28
L_entld:
    s_mov_b64 exec, -1
    s_waitcnt vmcnt(0)
    v_cmpx_lt_i32 vcc, 0, v48
    v_mad_u32_u16 v24, v16, 4, v53 op_sel:[1,0,0,0]
    ds_add_rtn_u32 v32, v24, v62
    v_cmpx_lt_i32 vcc, 1, v48
    v_mad_u32_u16 v25, v17, 4, v53 op_sel:[1,0,0,0]
    ds_add_rtn_u32 v33, v25, v62
    v_cmpx_lt_i32 vcc, 2, v48
    v_mad_u32_u16 v26, v18, 4, v53 op_sel:[1,0,0,0]
    ds_add_rtn_u32 v34, v26, v62
    v_cmpx_lt_i32 vcc, 3, v48
    v_mad_u32_u16 v27, v19, 4, v53 op_sel:[1,0,0,0]
    ds_add_rtn_u32 v35, v27, v62
    s_mov_b64 exec, -1
    ds_add_u32 v61, v62 offset:12
    v_mad_u32_u16 v40, v16, 2, v52
    v_mad_u32_u16 v16, v16, s7, 0
    v_mad_u32_u16 v41, v17, 2, v52
    v_mad_u32_u16 v17, v17, s7, 0
    v_mad_u32_u16 v42, v18, 2, v52
    v_mad_u32_u16 v18, v18, s7, 0
    v_mad_u32_u16 v43, v19, 2, v52
    v_mad_u32_u16 v19, v19, s7, 0
    s_mov_b32 s59, 0
Lw_11:
    ds_read_b32 v4, v3 offset:12
    s_waitcnt lgkmcnt(0)
    v_cmp_gt_u32 vcc, 8, v4
    s_cbranch_vccz Lk_12
    s_add_u32 s59, s59, 1
    s_cmp_lt_u32 s59, 4194304
    s_cbranch_scc1 Lw_11
    s_branch L_end
Lk_12:
    ds_read_b32 v12, v50
    ds_read_b32 v5, v3 offset:28
    ds_read_u16 v8, v8
    ds_read_u16 v40, v40
    ds_read_u16 v41, v41
    ds_read_u16 v42, v42
    ds_read_u16 v43, v43
    s_lshl_b32 s58, s2, 4
    s_add_u32 s58, s58, s3
    s_cmp_eq_u32 s58, 15
    s_cbranch_scc0 L_noep
    v_mov_b32 v6, s40
    v_mov_b32 v7, 1048576
    s_mov_b64 exec, 1
    buffer_store_dword v6, v7, s[16:19], 0 offen sc1
    s_mov_b64 exec, -1
L_noep:
    s_waitcnt lgkmcnt(6)
    v_add_u32 v12, 1, v12
    v_lshrrev_b32 v12, 1, v12
    v_max_u32 v12, 1, v12
    v_cndmask_b32 v12, 0, v12, s[62:63]
    s_lshl_b32 s67, s4, 3
    s_movk_i32 s58, 2304
    v_add_u32_dpp v51, v12, v12 row_shl:1 row_mask:0xf bank_mask:0xf bound_ctrl:1
    s_nop 1
    v_add_u32_dpp v51, v51, v51 row_shl:2 row_mask:0xf bank_mask:0xf bound_ctrl:1
    s_nop 1
    v_add_u32_dpp v51, v12, v51 row_shl:4 row_mask:0xf bank_mask:0x5 bound_ctrl:1
    s_waitcnt lgkmcnt(0)
    v_lshlrev_b32 v8, 16, v8
    v_lshl_add_u32 v5, v5, 10, v51
    v_sub_u32 v6, v55, v51
    v_cmp_le_u32 vcc, 72, v5
    v_lshlrev_b32 v6, 1, v6
    v_subrev_u32 v12, 1, v12
    s_cbranch_vccnz L_slow
    v_and_b32 v12, 0xff, v12
    v_lshl_add_u32 v9, v12, 18, v9
    s_mov_b64 exec, s[62:63]
    ds_write_b32 v50, v6 offset:160
    s_mov_b64 exec, -1
    s_sub_u32 s63, s67, 1
    v_readlane_b32 s67, v51, s67
    v_cmpx_lt_i32 vcc, 0, v48
    ds_read_b32 v24, v24 offset:160
    v_cmpx_lt_i32 vcc, 1, v48
    ds_read_b32 v25, v25 offset:160
    v_cmpx_lt_i32 vcc, 2, v48
    ds_read_b32 v26, v26 offset:160
    v_cmpx_lt_i32 vcc, 3, v48
    ds_read_b32 v27, v27 offset:160
    s_mov_b64 exec, -1
    s_lshr_b32 s66, s67, 3
    s_add_u32 s60, s66, 1
    s_lshl_b32 s60, s60, 3
    s_sub_u32 s67, s60, s67
    s_sub_u32 s62, s67, 1
    s_add_u32 s61, s4, 1
    s_mul_i32 s61, s61, 72
    s_sub_u32 s60, s61, s60
    s_lshl_b32 s60, s60, 2
    s_waitcnt lgkmcnt(0)
    v_cmpx_lt_i32 vcc, 0, v48
    v_add_u32 v24, v24, v32
    v_lshl_add_u32 v5, v24, 1, v57
    ds_write_b16 v5, v40
    v_lshrrev_b32 v6, 1, v24
    v_lshl_add_u32 v6, v6, 2, v60
    v_and_b32 v7, 1, v24
    v_mad_u32_u24 v6, v7, s58, v6
    ds_write_b32 v6, v16
    v_cmpx_lt_i32 vcc, 1, v48
    v_add_u32 v25, v25, v33
    v_lshl_add_u32 v5, v25, 1, v57
    ds_write_b16 v5, v41
    v_lshrrev_b32 v6, 1, v25
    v_lshl_add_u32 v6, v6, 2, v60
    v_and_b32 v7, 1, v25
    v_mad_u32_u24 v6, v7, s58, v6
    ds_write_b32 v6, v17
    v_cmpx_lt_i32 vcc, 2, v48
    v_add_u32 v26, v26, v34
    v_lshl_add_u32 v5, v26, 1, v57
    ds_write_b16 v5, v42
    v_lshrrev_b32 v6, 1, v26
    v_lshl_add_u32 v6, v6, 2, v60
    v_and_b32 v7, 1, v26
    v_mad_u32_u24 v6, v7, s58, v6
    ds_write_b32 v6, v18
    v_cmpx_lt_i32 vcc, 3, v48
    v_add_u32 v27, v27, v35
    v_lshl_add_u32 v5, v27, 1, v57
    ds_write_b16 v5, v43
    v_lshrrev_b32 v6, 1, v27
    v_lshl_add_u32 v6, v6, 2, v60
    v_and_b32 v7, 1, v27
    v_mad_u32_u24 v6, v7, s58, v6
    ds_write_b32 v6, v19
    s_mov_b64 exec, -1
    ds_add_u32 v61, v62 offset:16
    v_lshrrev_b32 v5, 5, v0
    v_mad_u32_u24 v13, v5, s58, v60
    v_add_u32 v13, s60, v13
    v_lshl_add_u32 v14, v5, 1, v57
    v_and_b32 v5, 28, v0
    v_add3_u32 v14, v14, v5, s60
    s_mov_b32 s65, 201486528
    s_mov_b32 s64, 0
    s_mov_b32 s59, 0
Lw_13:
    ds_read_b32 v4, v3 offset:16
    s_waitcnt lgkmcnt(0)
    v_cmp_gt_u32 vcc, 8, v4
    s_cbranch_vccz Lk_14
    s_add_u32 s59, s59, 1
    s_cmp_lt_u32 s59, 4194304
    s_cbranch_scc1 Lw_13
    s_branch L_end
Lk_14:
    v_mov_b32 v12, v3
    v_mov_b32 v3, v2
    s_setprio 1
    s_cmp_lt_u32 s4, 4
    s_cbranch_scc1 L_old
    s_setprio 2
L_old:
    ds_read_b128 v[56:59], v13 offset:0
    ds_read_b128 v[60:63], v13 offset:16
    ds_read_u16 v1, v14
    ds_read_b128 v[48:51], v13 offset:32
    ds_read_b128 v[52:55], v13 offset:48
    s_waitcnt lgkmcnt(3)
L_p0:
    s_cmp_ge_u32 s67, 4
    s_cbranch_scc1 L_p4
    s_cmp_gt_u32 s67, 1
    s_cbranch_scc1 Lps_15
    v_add_u32 v57, v57, v2
    buffer_load_dwordx4 v[20:23], v57, s[8:11], 0 offen
Lps_15:
    s_cmp_gt_u32 s67, 2
    s_cbranch_scc1 Lps_16
    v_add_u32 v58, v58, v2
    buffer_load_dwordx4 v[24:27], v58, s[8:11], 0 offen
Lps_16:
    s_cmp_gt_u32 s67, 3
    s_cbranch_scc1 Lps_17
    v_add_u32 v59, v59, v2
    buffer_load_dwordx4 v[28:31], v59, s[8:11], 0 offen
Lps_17:
L_p4:
    s_cmp_gt_u32 s67, 4
    s_cbranch_scc1 Lps_18
    v_add_u32 v60, v60, v2
    buffer_load_dwordx4 v[32:35], v60, s[8:11], 0 offen
Lps_18:
    s_cmp_gt_u32 s67, 5
    s_cbranch_scc1 Lps_19
    v_add_u32 v61, v61, v2
    buffer_load_dwordx4 v[36:39], v61, s[8:11], 0 offen
Lps_19:
    s_cmp_gt_u32 s67, 6
    s_cbranch_scc1 Lps_20
    v_add_u32 v62, v62, v2
    buffer_load_dwordx4 v[40:43], v62, s[8:11], 0 offen
Lps_20:
    s_cmp_gt_u32 s67, 7
    s_cbranch_scc1 Lps_21
    v_add_u32 v63, v63, v2
    buffer_load_dwordx4 v[44:47], v63, s[8:11], 0 offen
Lps_21:
    s_cmp_eq_u32 s66, 0
    s_cbranch_scc1 L_drain
L_gl:
    s_waitcnt lgkmcnt(1)
    v_perm_b32 v6, v1, v1, v10
    v_perm_b32 v7, v1, v1, v11
    ds_read_u16 v1, v14 offset:32
    s_waitcnt vmcnt(6)
    v_lshl_add_u64 v[4:5], v[48:49], 0, v[2:3]
    s_sub_u32 s62, s62, 2
    s_cbranch_scc1 Lfs_0
    v_mfma_f32_4x4x4_16b_bf16 v[56:59], v[6:7], v[16:17], v[56:59] cbsz:3 abid:0
    v_mfma_f32_4x4x4_16b_bf16 v[60:63], v[6:7], v[18:19], v[60:63] cbsz:3 abid:0
    buffer_load_dwordx4 v[16:19], v4, s[8:11], 0 offen
    v_mfma_f32_4x4x4_16b_bf16 v[56:59], v[6:7], v[20:21], v[56:59] cbsz:3 abid:1
    v_mfma_f32_4x4x4_16b_bf16 v[60:63], v[6:7], v[22:23], v[60:63] cbsz:3 abid:1
    buffer_load_dwordx4 v[20:23], v5, s[8:11], 0 offen
Lbs_0:
    s_waitcnt vmcnt(6)
    v_lshl_add_u64 v[4:5], v[50:51], 0, v[2:3]
    s_sub_u32 s62, s62, 2
    s_cbranch_scc1 Lfs_2
    v_mfma_f32_4x4x4_16b_bf16 v[56:59], v[6:7], v[24:25], v[56:59] cbsz:3 abid:2
    v_mfma_f32_4x4x4_16b_bf16 v[60:63], v[6:7], v[26:27], v[60:63] cbsz:3 abid:2
    buffer_load_dwordx4 v[24:27], v4, s[8:11], 0 offen
    v_mfma_f32_4x4x4_16b_bf16 v[56:59], v[6:7], v[28:29], v[56:59] cbsz:3 abid:3
    v_mfma_f32_4x4x4_16b_bf16 v[60:63], v[6:7], v[30:31], v[60:63] cbsz:3 abid:3
    buffer_load_dwordx4 v[28:31], v5, s[8:11], 0 offen
Lbs_2:
    ds_read_b128 v[48:51], v13 offset:64
    s_waitcnt vmcnt(6) lgkmcnt(2)
    v_lshl_add_u64 v[4:5], v[52:53], 0, v[2:3]
    s_sub_u32 s62, s62, 2
    s_cbranch_scc1 Lfs_4
    v_mfma_f32_4x4x4_16b_bf16 v[56:59], v[6:7], v[32:33], v[56:59] cbsz:3 abid:4
    v_mfma_f32_4x4x4_16b_bf16 v[60:63], v[6:7], v[34:35], v[60:63] cbsz:3 abid:4
    buffer_load_dwordx4 v[32:35], v4, s[8:11], 0 offen
    v_mfma_f32_4x4x4_16b_bf16 v[56:59], v[6:7], v[36:37], v[56:59] cbsz:3 abid:5
    v_mfma_f32_4x4x4_16b_bf16 v[60:63], v[6:7], v[38:39], v[60:63] cbsz:3 abid:5
    buffer_load_dwordx4 v[36:39], v5, s[8:11], 0 offen
Lbs_4:
    s_waitcnt vmcnt(6)
    v_lshl_add_u64 v[4:5], v[54:55], 0, v[2:3]
    s_sub_u32 s62, s62, 2
    s_cbranch_scc1 Lfs_6
    v_mfma_f32_4x4x4_16b_bf16 v[56:59], v[6:7], v[40:41], v[56:59] cbsz:3 abid:6
    v_mfma_f32_4x4x4_16b_bf16 v[60:63], v[6:7], v[42:43], v[60:63] cbsz:3 abid:6
    buffer_load_dwordx4 v[40:43], v4, s[8:11], 0 offen
    v_mfma_f32_4x4x4_16b_bf16 v[56:59], v[6:7], v[44:45], v[56:59] cbsz:3 abid:7
    v_mfma_f32_4x4x4_16b_bf16 v[60:63], v[6:7], v[46:47], v[60:63] cbsz:3 abid:7
    buffer_load_dwordx4 v[44:47], v5, s[8:11], 0 offen
Lbs_6:
    ds_read_b128 v[52:55], v13 offset:80
    v_add_u32 v13, 32, v13
    v_add_u32 v14, 32, v14
    s_sub_u32 s66, s66, 1
    s_cmp_eq_u32 s66, 3
    s_cbranch_scc0 L_nf
    s_setprio 1
L_nf:
    s_cmp_lg_u32 s66, 0
    s_cbranch_scc1 L_gl
L_drain:
    s_waitcnt lgkmcnt(0)
    v_perm_b32 v6, v1, v1, v10
    v_perm_b32 v7, v1, v1, v11
    ds_read_u16 v1, v14 offset:32
    s_waitcnt vmcnt(7)
    v_mfma_f32_4x4x4_16b_bf16 v[56:59], v[6:7], v[16:17], v[56:59] cbsz:3 abid:0
    v_mfma_f32_4x4x4_16b_bf16 v[60:63], v[6:7], v[18:19], v[60:63] cbsz:3 abid:0
    s_sub_u32 s62, s62, 1
    s_cbranch_scc1 Lfd_0
Lbd_0:
    s_waitcnt vmcnt(6)
    v_mfma_f32_4x4x4_16b_bf16 v[56:59], v[6:7], v[20:21], v[56:59] cbsz:3 abid:1
    v_mfma_f32_4x4x4_16b_bf16 v[60:63], v[6:7], v[22:23], v[60:63] cbsz:3 abid:1
    s_sub_u32 s62, s62, 1
    s_cbranch_scc1 Lfd_1
Lbd_1:
    s_waitcnt vmcnt(5)
    v_mfma_f32_4x4x4_16b_bf16 v[56:59], v[6:7], v[24:25], v[56:59] cbsz:3 abid:2
    v_mfma_f32_4x4x4_16b_bf16 v[60:63], v[6:7], v[26:27], v[60:63] cbsz:3 abid:2
    s_sub_u32 s62, s62, 1
    s_cbranch_scc1 Lfd_2
Lbd_2:
    s_waitcnt vmcnt(4)
    v_mfma_f32_4x4x4_16b_bf16 v[56:59], v[6:7], v[28:29], v[56:59] cbsz:3 abid:3
    v_mfma_f32_4x4x4_16b_bf16 v[60:63], v[6:7], v[30:31], v[60:63] cbsz:3 abid:3
    s_sub_u32 s62, s62, 1
    s_cbranch_scc1 Lfd_3
Lbd_3:
    s_waitcnt vmcnt(3)
    v_mfma_f32_4x4x4_16b_bf16 v[56:59], v[6:7], v[32:33], v[56:59] cbsz:3 abid:4
    v_mfma_f32_4x4x4_16b_bf16 v[60:63], v[6:7], v[34:35], v[60:63] cbsz:3 abid:4
    s_sub_u32 s62, s62, 1
    s_cbranch_scc1 Lfd_4
Lbd_4:
    s_waitcnt vmcnt(2)
    v_mfma_f32_4x4x4_16b_bf16 v[56:59], v[6:7], v[36:37], v[56:59] cbsz:3 abid:5
    v_mfma_f32_4x4x4_16b_bf16 v[60:63], v[6:7], v[38:39], v[60:63] cbsz:3 abid:5
    s_sub_u32 s62, s62, 1
    s_cbranch_scc1 Lfd_5
Lbd_5:
    s_waitcnt vmcnt(1)
    v_mfma_f32_4x4x4_16b_bf16 v[56:59], v[6:7], v[40:41], v[56:59] cbsz:3 abid:6
    v_mfma_f32_4x4x4_16b_bf16 v[60:63], v[6:7], v[42:43], v[60:63] cbsz:3 abid:6
    s_sub_u32 s62, s62, 1
    s_cbranch_scc1 Lfd_6
Lbd_6:
    s_waitcnt vmcnt(0)
    v_mfma_f32_4x4x4_16b_bf16 v[56:59], v[6:7], v[44:45], v[56:59] cbsz:3 abid:7
    v_mfma_f32_4x4x4_16b_bf16 v[60:63], v[6:7], v[46:47], v[60:63] cbsz:3 abid:7
    s_nop 1
    s_call_b64 s[68:69], L_flush
L_gdone:
    s_endpgm
Lfs_0:
    s_add_u32 s62, s62, 2
    v_mfma_f32_4x4x4_16b_bf16 v[56:59], v[6:7], v[16:17], v[56:59] cbsz:3 abid:0
    v_mfma_f32_4x4x4_16b_bf16 v[60:63], v[6:7], v[18:19], v[60:63] cbsz:3 abid:0
    buffer_load_dwordx4 v[16:19], v4, s[8:11], 0 offen
    s_sub_u32 s62, s62, 1
    s_cbranch_scc0 Lsk_22
    s_call_b64 s[68:69], L_flush
Lsk_22:
    v_mfma_f32_4x4x4_16b_bf16 v[56:59], v[6:7], v[20:21], v[56:59] cbsz:3 abid:1
    v_mfma_f32_4x4x4_16b_bf16 v[60:63], v[6:7], v[22:23], v[60:63] cbsz:3 abid:1
    buffer_load_dwordx4 v[20:23], v5, s[8:11], 0 offen
    s_sub_u32 s62, s62, 1
    s_cbranch_scc0 Lbs_0
    s_call_b64 s[68:69], L_flush
    s_branch Lbs_0
Lfs_2:
    s_add_u32 s62, s62, 2
    v_mfma_f32_4x4x4_16b_bf16 v[56:59], v[6:7], v[24:25], v[56:59] cbsz:3 abid:2
    v_mfma_f32_4x4x4_16b_bf16 v[60:63], v[6:7], v[26:27], v[60:63] cbsz:3 abid:2
    buffer_load_dwordx4 v[24:27], v4, s[8:11], 0 offen
    s_sub_u32 s62, s62, 1
    s_cbranch_scc0 Lsk_24
    s_call_b64 s[68:69], L_flush
Lsk_24:
    v_mfma_f32_4x4x4_16b_bf16 v[56:59], v[6:7], v[28:29], v[56:59] cbsz:3 abid:3
    v_mfma_f32_4x4x4_16b_bf16 v[60:63], v[6:7], v[30:31], v[60:63] cbsz:3 abid:3
    buffer_load_dwordx4 v[28:31], v5, s[8:11], 0 offen
    s_sub_u32 s62, s62, 1
    s_cbranch_scc0 Lbs_2
    s_call_b64 s[68:69], L_flush
    s_branch Lbs_2
Lfs_4:
    s_add_u32 s62, s62, 2
    v_mfma_f32_4x4x4_16b_bf16 v[56:59], v[6:7], v[32:33], v[56:59] cbsz:3 abid:4
    v_mfma_f32_4x4x4_16b_bf16 v[60:63], v[6:7], v[34:35], v[60:63] cbsz:3 abid:4
    buffer_load_dwordx4 v[32:35], v4, s[8:11], 0 offen
    s_sub_u32 s62, s62, 1
    s_cbranch_scc0 Lsk_26
    s_call_b64 s[68:69], L_flush
Lsk_26:
    v_mfma_f32_4x4x4_16b_bf16 v[56:59], v[6:7], v[36:37], v[56:59] cbsz:3 abid:5
    v_mfma_f32_4x4x4_16b_bf16 v[60:63], v[6:7], v[38:39], v[60:63] cbsz:3 abid:5
    buffer_load_dwordx4 v[36:39], v5, s[8:11], 0 offen
    s_sub_u32 s62, s62, 1
    s_cbranch_scc0 Lbs_4
    s_call_b64 s[68:69], L_flush
    s_branch Lbs_4
Lfs_6:
    s_add_u32 s62, s62, 2
    v_mfma_f32_4x4x4_16b_bf16 v[56:59], v[6:7], v[40:41], v[56:59] cbsz:3 abid:6
    v_mfma_f32_4x4x4_16b_bf16 v[60:63], v[6:7], v[42:43], v[60:63] cbsz:3 abid:6
    buffer_load_dwordx4 v[40:43], v4, s[8:11], 0 offen
    s_sub_u32 s62, s62, 1
    s_cbranch_scc0 Lsk_28
    s_call_b64 s[68:69], L_flush
Lsk_28:
    v_mfma_f32_4x4x4_16b_bf16 v[56:59], v[6:7], v[44:45], v[56:59] cbsz:3 abid:7
    v_mfma_f32_4x4x4_16b_bf16 v[60:63], v[6:7], v[46:47], v[60:63] cbsz:3 abid:7
    buffer_load_dwordx4 v[44:47], v5, s[8:11], 0 offen
    s_sub_u32 s62, s62, 1
    s_cbranch_scc0 Lbs_6
    s_call_b64 s[68:69], L_flush
    s_branch Lbs_6
Lfd_0:
    s_call_b64 s[68:69], L_flush
    s_branch Lbd_0
Lfd_1:
    s_call_b64 s[68:69], L_flush
    s_branch Lbd_1
Lfd_2:
    s_call_b64 s[68:69], L_flush
    s_branch Lbd_2
Lfd_3:
    s_call_b64 s[68:69], L_flush
    s_branch Lbd_3
Lfd_4:
    s_call_b64 s[68:69], L_flush
    s_branch Lbd_4
Lfd_5:
    s_call_b64 s[68:69], L_flush
    s_branch Lbd_5
Lfd_6:
    s_call_b64 s[68:69], L_flush
    s_branch Lbd_6
L_flush:
    s_and_b32 s101, s65, 0x3ffff
    s_add_u32 s63, s63, 1
    v_permlane32_swap_b32 v56, v60
    v_permlane32_swap_b32 v57, v61
    v_permlane32_swap_b32 v58, v62
    v_permlane32_swap_b32 v59, v63
    s_lshr_b32 s62, s65, 26
    v_pk_add_f32 v[56:57], v[56:57], v[60:61]
    v_pk_add_f32 v[58:59], v[58:59], v[62:63]
    v_add_u32 v62, s101, v15
    v_pk_mul_f32 v[56:57], v[56:57], s[64:65] op_sel_hi:[1,0]
    v_pk_mul_f32 v[58:59], v[58:59], s[64:65] op_sel_hi:[1,0]
    v_lshl_add_u32 v63, s62, 2, v12
    v_cvt_pk_bf16_f32 v60, v56, v57
    v_cvt_pk_bf16_f32 v61, v58, v59
    ds_write_b64 v62, v[60:61]
    s_mov_b64 exec, 1
    ds_inc_u32 v63, v63 offset:36
    s_mov_b64 exec, -1
    v_readlane_b32 s65, v9, s63
    v_readlane_b32 s64, v8, s63
    v_mov_b64 v[56:57], 0
    v_mov_b64 v[58:59], 0
    v_mov_b64 v[60:61], 0
    v_mov_b64 v[62:63], 0
    s_bfe_u32 s62, s65, 0x80012
    s_setpc_b64 s[68:69]
L_preA:
    s_setprio 2
    s_mul_i32 s5, s6, 40
    v_mov_b32 v3, 159296
    s_mov_b32 s10, 5120000
    s_mov_b32 s11, 0x20000
    s_mov_b64 s[16:17], s[56:57]
    s_mov_b32 s18, 1441792
    s_mov_b32 s19, 0x20000
    v_and_b32 v6, 32, v0
    v_lshl_add_u32 v5, v6, 7, v2
    v_lshl_add_u32 v6, v6, 6, v2
    s_add_u32 s58, s3, s5
    s_mul_i32 s59, s3, 1056
    s_add_u32 m0, s59, 84480
    s_lshl_b32 s58, s58, 9
    buffer_load_dwordx4 v5, s[8:11], s58 offen lds
    s_add_u32 m0, s59, 92928
    s_add_u32 s58, s58, 8192
    s_waitcnt vmcnt(2)
    buffer_load_dwordx4 v5, s[8:11], s58 offen lds
    s_cmp_ge_u32 s3, 4
    s_cbranch_scc1 L_xa2
    s_add_u32 m0, s59, 101376
    s_add_u32 s58, s58, 8192
    s_waitcnt vmcnt(2)
    buffer_load_dwordx4 v6, s[8:11], s58 offen lds
L_xa2:
    v_and_b32 v4, 7, v0
    v_mul_u32_u24 v1, 1056, v4
    v_and_b32 v4, 8, v0
    v_lshl_add_u32 v1, v4, 6, v1
    v_and_b32 v4, 48, v0
    v_add_u32 v1, v4, v1
    v_add_u32 v12, 84480, v1
    s_mov_b64 s[20:21], s[52:53]
    s_mov_b32 s22, 5120000
    s_mov_b32 s23, 0x20000
    v_lshlrev_b32 v14, 4, v0
    s_lshl_b32 s61, s3, 6
    s_add_u32 s61, s61, 105600
    v_add_u32 v13, s61, v1
    s_lshl_b32 s100, s3, 14
    s_add_u32 s100, s100, 655360
    s_waitcnt lgkmcnt(0)
    v_lshl_add_u32 v104, s32, 9, v2
    v_lshl_add_u32 v105, s33, 9, v2
    v_lshl_add_u32 v106, s34, 9, v2
    v_lshl_add_u32 v107, s35, 9, v2
    v_lshl_add_u32 v108, s36, 9, v2
    v_lshl_add_u32 v109, s37, 9, v2
    v_lshl_add_u32 v110, s38, 9, v2
    v_lshl_add_u32 v111, s39, 9, v2
    v_lshl_add_u32 v112, s64, 9, v2
    v_lshl_add_u32 v113, s65, 9, v2
    s_mov_b32 exec_lo, 0
    v_lshl_add_u32 v104, s40, 9, v2
    v_lshl_add_u32 v105, s41, 9, v2
    v_lshl_add_u32 v106, s42, 9, v2
    v_lshl_add_u32 v107, s43, 9, v2
    v_lshl_add_u32 v108, s44, 9, v2
    v_lshl_add_u32 v109, s45, 9, v2
    v_lshl_add_u32 v110, s46, 9, v2
    v_lshl_add_u32 v111, s47, 9, v2
    v_lshl_add_u32 v112, s66, 9, v2
    v_lshl_add_u32 v113, s67, 9, v2
    s_mov_b64 exec, -1
    s_cmp_ge_u32 s2, 64
    s_cbranch_scc1 L_nopb
    s_barrier
    s_barrier
L_nopb:
    s_mul_i32 s67, s3, 2112
    s_mul_i32 s66, s3, 8448
    s_cmp_lt_u32 s2, 64
    s_cbranch_scc1 Lth_30
    s_waitcnt vmcnt(1)
Lth_30:
    s_add_u32 m0, s66, 0
    s_waitcnt vmcnt(2)
    buffer_load_dwordx4 v104, s[8:11], 0 offen lds
    s_cmp_lt_u32 s2, 64
    s_cbranch_scc1 Lth_31
    s_waitcnt vmcnt(1)
Lth_31:
    s_add_u32 m0, s66, 1056
    s_waitcnt vmcnt(2)
    buffer_load_dwordx4 v105, s[8:11], 0 offen lds
    v_and_b32 v4, 3, v0
    v_mov_b32 v5, 0x0c0c0c0c
    v_mov_b32 v6, 0x0c0c0302
    v_mov_b32 v7, 0x03020c0c
    v_cmp_eq_u32 s[58:59], 0, v4
    v_cmp_eq_u32 s[60:61], 2, v4
    v_cmp_eq_u32 vcc, 1, v4
    v_cndmask_b32 v8, v5, v6, s[58:59]
    v_cndmask_b32 v9, v5, v6, s[60:61]
    v_cndmask_b32 v8, v8, v7, vcc
    v_cmp_eq_u32 vcc, 3, v4
    s_nop 1
    v_cndmask_b32 v9, v9, v7, vcc
    v_mov_b32 v10, v8
    v_mov_b32 v11, v9
    v_and_b32 v8, 0xfdfdfdfd, v8
    v_and_b32 v9, 0xfdfdfdfd, v9
    s_cmp_lt_u32 s2, 64
    s_cbranch_scc1 Lth_32
    s_waitcnt vmcnt(1)
Lth_32:
    s_add_u32 m0, s66, 2112
    s_waitcnt vmcnt(2)
    buffer_load_dwordx4 v106, s[8:11], 0 offen lds
    s_cmp_lt_u32 s2, 64
    s_cbranch_scc1 Lth_33
    s_waitcnt vmcnt(1)
Lth_33:
    s_add_u32 m0, s66, 3168
    s_waitcnt vmcnt(2)
    buffer_load_dwordx4 v107, s[8:11], 0 offen lds
    s_mov_b64 exec, 1
    v_mov_b32 v4, 1
    ds_add_u32 v3, v4 offset:0
    s_mov_b64 exec, -1
    s_cmp_lt_u32 s2, 64
    s_cbranch_scc1 Lth_34
    s_waitcnt vmcnt(1)
Lth_34:
    s_add_u32 m0, s66, 4224
    s_waitcnt vmcnt(2)
    buffer_load_dwordx4 v108, s[8:11], 0 offen lds
    s_mov_b32 s59, 0
Lw_35:
    ds_read_b32 v4, v3 offset:0
    s_waitcnt lgkmcnt(0)
    v_cmp_gt_u32 vcc, 8, v4
    s_cbranch_vccz Lk_36
    s_add_u32 s59, s59, 1
    s_cmp_lt_u32 s59, 4194304
    s_cbranch_scc1 Lw_35
    s_branch L_end
Lk_36:
    ds_read_b128 v[80:83], v12 offset:0
    ds_read_b128 v[84:87], v12 offset:8448
    ds_read_b128 v[88:91], v12 offset:16896
    s_cmp_lt_u32 s2, 64
    s_cbranch_scc1 Lth_37
    s_waitcnt vmcnt(1)
Lth_37:
    s_add_u32 m0, s66, 5280
    s_waitcnt vmcnt(2)
    buffer_load_dwordx4 v109, s[8:11], 0 offen lds
    s_mov_b64 exec, 1
    v_mov_b32 v4, 1
    ds_add_u32 v3, v4 offset:60
    s_mov_b64 exec, -1
    s_cmp_lt_u32 s2, 64
    s_cbranch_scc1 Lth_38
    s_waitcnt vmcnt(1)
Lth_38:
    s_waitcnt vmcnt(2)
    ds_read_b32 v4, v3 offset:52
    s_add_u32 m0, s66, 6336
    s_waitcnt vmcnt(2)
    buffer_load_dwordx4 v110, s[8:11], 0 offen lds
    s_mov_b32 s62, 7
    s_waitcnt lgkmcnt(0)
    v_cmp_gt_u32 vcc, 8, v4
    s_cbranch_vccz L_eu10
    s_cmp_lt_u32 s2, 64
    s_cbranch_scc1 Lth_39
    s_waitcnt vmcnt(1)
Lth_39:
    s_waitcnt vmcnt(2)
    ds_read_b32 v4, v3 offset:52
    s_add_u32 m0, s66, 7392
    s_waitcnt vmcnt(2)
    buffer_load_dwordx4 v111, s[8:11], 0 offen lds
    s_mov_b32 s62, 8
    s_waitcnt lgkmcnt(0)
    v_cmp_gt_u32 vcc, 8, v4
    s_cbranch_vccz L_eu10
    s_cmp_lt_u32 s2, 64
    s_cbranch_scc1 Lth_40
    s_waitcnt vmcnt(1)
Lth_40:
    s_waitcnt vmcnt(2)
    ds_read_b32 v4, v3 offset:52
    s_add_u32 m0, s67, 67584
    s_waitcnt vmcnt(2)
    buffer_load_dwordx4 v112, s[8:11], 0 offen lds
    s_mov_b32 s62, 9
    s_waitcnt lgkmcnt(0)
    v_cmp_gt_u32 vcc, 8, v4
    s_cbranch_vccz L_eu10
    s_cmp_lt_u32 s2, 64
    s_cbranch_scc1 Lth_41
    s_waitcnt vmcnt(1)
Lth_41:
    s_waitcnt vmcnt(2)
    ds_read_b32 v4, v3 offset:52
    s_add_u32 m0, s67, 68640
    s_waitcnt vmcnt(2)
    buffer_load_dwordx4 v113, s[8:11], 0 offen lds
    s_mov_b32 s62, 10
    s_mov_b32 s59, 0
Lw_42:
    ds_read_b32 v4, v3 offset:52
    s_waitcnt lgkmcnt(0)
    v_cmp_gt_u32 vcc, 8, v4
    s_cbranch_vccz Lk_43
    s_sleep 1
    s_add_u32 s59, s59, 1
    s_cmp_lt_u32 s59, 4194304
    s_cbranch_scc1 Lw_42
    s_branch L_end
Lk_43:
L_eu10:
    s_setprio 3
    buffer_load_dwordx4 v[16:19], v14, s[16:19], s100 offen offset:0 sc1
    buffer_load_dwordx4 v[20:23], v14, s[16:19], s100 offen offset:1024 sc1
    buffer_load_dwordx4 v[24:27], v14, s[16:19], s100 offen offset:2048 sc1
    buffer_load_dwordx4 v[28:31], v14, s[16:19], s100 offen offset:3072 sc1
    s_add_u32 s100, s100, 4096
    buffer_load_dwordx4 v[32:35], v14, s[16:19], s100 offen offset:0 sc1
    s_cmp_gt_u32 s62, 7
    s_cbranch_scc1 Lem_44
    s_add_u32 m0, s66, 7392
    s_waitcnt vmcnt(63)
    buffer_load_dwordx4 v111, s[8:11], 0 offen lds
Lem_44:
    buffer_load_dwordx4 v[36:39], v14, s[16:19], s100 offen offset:1024 sc1
    buffer_load_dwordx4 v[40:43], v14, s[16:19], s100 offen offset:2048 sc1
    buffer_load_dwordx4 v[44:47], v14, s[16:19], s100 offen offset:3072 sc1
    s_add_u32 s100, s100, 4096
    buffer_load_dwordx4 v[48:51], v14, s[16:19], s100 offen offset:0 sc1
    buffer_load_dwordx4 v[52:55], v14, s[16:19], s100 offen offset:1024 sc1
    s_cmp_gt_u32 s62, 8
    s_cbranch_scc1 Lem_45
    s_add_u32 m0, s67, 67584
    s_waitcnt vmcnt(63)
    buffer_load_dwordx4 v112, s[8:11], 0 offen lds
Lem_45:
    buffer_load_dwordx4 v[56:59], v14, s[16:19], s100 offen offset:2048 sc1
    buffer_load_dwordx4 v[60:63], v14, s[16:19], s100 offen offset:3072 sc1
    s_add_u32 s100, s100, 4096
    buffer_load_dwordx4 v[64:67], v14, s[16:19], s100 offen offset:0 sc1
    buffer_load_dwordx4 v[68:71], v14, s[16:19], s100 offen offset:1024 sc1
    buffer_load_dwordx4 v[72:75], v14, s[16:19], s100 offen offset:2048 sc1
    buffer_load_dwordx4 v[76:79], v14, s[16:19], s100 offen offset:3072 sc1
    s_cmp_gt_u32 s62, 9
    s_cbranch_scc1 Lem_46
    s_add_u32 m0, s67, 68640
    s_waitcnt vmcnt(63)
    buffer_load_dwordx4 v113, s[8:11], 0 offen lds
Lem_46:
    s_setprio 0
    ds_read_b128 v[92:95], v12 offset:64
    ds_read_b128 v[96:99], v12 offset:8512
    ds_read_b128 v[100:103], v12 offset:16960
    s_waitcnt vmcnt(14) lgkmcnt(3)
    v_mfma_f32_16x16x32_bf16 v[104:107], v[16:19], v[80:83], 0
    v_mfma_f32_16x16x32_bf16 v[108:111], v[20:23], v[80:83], 0
    v_mfma_f32_16x16x32_bf16 v[112:115], v[16:19], v[84:87], 0
    v_mfma_f32_16x16x32_bf16 v[116:119], v[20:23], v[84:87], 0
    v_mfma_f32_16x16x32_bf16 v[120:123], v[16:19], v[88:91], 0
    v_mfma_f32_16x16x32_bf16 v[124:127], v[20:23], v[88:91], 0
    ds_read_b128 v[80:83], v12 offset:128
    ds_read_b128 v[84:87], v12 offset:8576
    ds_read_b128 v[88:91], v12 offset:17024
    s_waitcnt vmcnt(12) lgkmcnt(3)
    v_mfma_f32_16x16x32_bf16 v[104:107], v[24:27], v[92:95], v[104:107]
    v_mfma_f32_16x16x32_bf16 v[108:111], v[28:31], v[92:95], v[108:111]
    v_mfma_f32_16x16x32_bf16 v[112:115], v[24:27], v[96:99], v[112:115]
    v_mfma_f32_16x16x32_bf16 v[116:119], v[28:31], v[96:99], v[116:119]
    v_mfma_f32_16x16x32_bf16 v[120:123], v[24:27], v[100:103], v[120:123]
    v_mfma_f32_16x16x32_bf16 v[124:127], v[28:31], v[100:103], v[124:127]
    ds_read_b128 v[92:95], v12 offset:192
    ds_read_b128 v[96:99], v12 offset:8640
    ds_read_b128 v[100:103], v12 offset:17088
    s_waitcnt vmcnt(10) lgkmcnt(3)
    v_mfma_f32_16x16x32_bf16 v[104:107], v[32:35], v[80:83], v[104:107]
    v_mfma_f32_16x16x32_bf16 v[108:111], v[36:39], v[80:83], v[108:111]
    v_mfma_f32_16x16x32_bf16 v[112:115], v[32:35], v[84:87], v[112:115]
    v_mfma_f32_16x16x32_bf16 v[116:119], v[36:39], v[84:87], v[116:119]
    v_mfma_f32_16x16x32_bf16 v[120:123], v[32:35], v[88:91], v[120:123]
    v_mfma_f32_16x16x32_bf16 v[124:127], v[36:39], v[88:91], v[124:127]
    ds_read_b128 v[80:83], v12 offset:256
    ds_read_b128 v[84:87], v12 offset:8704
    ds_read_b128 v[88:91], v12 offset:17152
    s_waitcnt vmcnt(8) lgkmcnt(3)
    v_mfma_f32_16x16x32_bf16 v[104:107], v[40:43], v[92:95], v[104:107]
    v_mfma_f32_16x16x32_bf16 v[108:111], v[44:47], v[92:95], v[108:111]
    v_mfma_f32_16x16x32_bf16 v[112:115], v[40:43], v[96:99], v[112:115]
    v_mfma_f32_16x16x32_bf16 v[116:119], v[44:47], v[96:99], v[116:119]
    v_mfma_f32_16x16x32_bf16 v[120:123], v[40:43], v[100:103], v[120:123]
    v_mfma_f32_16x16x32_bf16 v[124:127], v[44:47], v[100:103], v[124:127]
    ds_read_b128 v[92:95], v12 offset:320
    ds_read_b128 v[96:99], v12 offset:8768
    ds_read_b128 v[100:103], v12 offset:17216
    s_waitcnt vmcnt(6) lgkmcnt(3)
    v_mfma_f32_16x16x32_bf16 v[104:107], v[48:51], v[80:83], v[104:107]
    v_mfma_f32_16x16x32_bf16 v[108:111], v[52:55], v[80:83], v[108:111]
    v_mfma_f32_16x16x32_bf16 v[112:115], v[48:51], v[84:87], v[112:115]
    v_mfma_f32_16x16x32_bf16 v[116:119], v[52:55], v[84:87], v[116:119]
    v_mfma_f32_16x16x32_bf16 v[120:123], v[48:51], v[88:91], v[120:123]
    v_mfma_f32_16x16x32_bf16 v[124:127], v[52:55], v[88:91], v[124:127]
    s_setprio 3
    s_add_u32 s100, s100, 118784
    buffer_load_dwordx4 v[16:19], v14, s[16:19], s100 offen offset:0 sc1
    buffer_load_dwordx4 v[20:23], v14, s[16:19], s100 offen offset:1024 sc1
    buffer_load_dwordx4 v[24:27], v14, s[16:19], s100 offen offset:2048 sc1
    buffer_load_dwordx4 v[28:31], v14, s[16:19], s100 offen offset:3072 sc1
    s_setprio 0
    ds_read_b128 v[80:83], v12 offset:384
    ds_read_b128 v[84:87], v12 offset:8832
    ds_read_b128 v[88:91], v12 offset:17280
    s_waitcnt vmcnt(8) lgkmcnt(3)
    v_mfma_f32_16x16x32_bf16 v[104:107], v[56:59], v[92:95], v[104:107]
    v_mfma_f32_16x16x32_bf16 v[108:111], v[60:63], v[92:95], v[108:111]
    v_mfma_f32_16x16x32_bf16 v[112:115], v[56:59], v[96:99], v[112:115]
    v_mfma_f32_16x16x32_bf16 v[116:119], v[60:63], v[96:99], v[116:119]
    v_mfma_f32_16x16x32_bf16 v[120:123], v[56:59], v[100:103], v[120:123]
    v_mfma_f32_16x16x32_bf16 v[124:127], v[60:63], v[100:103], v[124:127]
    s_setprio 3
    s_add_u32 s100, s100, 4096
    buffer_load_dwordx4 v[32:35], v14, s[16:19], s100 offen offset:0 sc1
    buffer_load_dwordx4 v[36:39], v14, s[16:19], s100 offen offset:1024 sc1
    buffer_load_dwordx4 v[40:43], v14, s[16:19], s100 offen offset:2048 sc1
    buffer_load_dwordx4 v[44:47], v14, s[16:19], s100 offen offset:3072 sc1
    s_setprio 0
    ds_read_b128 v[92:95], v12 offset:448
    ds_read_b128 v[96:99], v12 offset:8896
    ds_read_b128 v[100:103], v12 offset:17344
    s_waitcnt vmcnt(10) lgkmcnt(3)
    v_mfma_f32_16x16x32_bf16 v[104:107], v[64:67], v[80:83], v[104:107]
    v_mfma_f32_16x16x32_bf16 v[108:111], v[68:71], v[80:83], v[108:111]
    v_mfma_f32_16x16x32_bf16 v[112:115], v[64:67], v[84:87], v[112:115]
    v_mfma_f32_16x16x32_bf16 v[116:119], v[68:71], v[84:87], v[116:119]
    v_mfma_f32_16x16x32_bf16 v[120:123], v[64:67], v[88:91], v[120:123]
    v_mfma_f32_16x16x32_bf16 v[124:127], v[68:71], v[88:91], v[124:127]
    s_setprio 3
    s_add_u32 s100, s100, 4096
    buffer_load_dwordx4 v[48:51], v14, s[16:19], s100 offen offset:0 sc1
    buffer_load_dwordx4 v[52:55], v14, s[16:19], s100 offen offset:1024 sc1
    buffer_load_dwordx4 v[56:59], v14, s[16:19], s100 offen offset:2048 sc1
    buffer_load_dwordx4 v[60:63], v14, s[16:19], s100 offen offset:3072 sc1
    s_setprio 0
    s_waitcnt vmcnt(12) lgkmcnt(0)
    v_mfma_f32_16x16x32_bf16 v[104:107], v[72:75], v[92:95], v[104:107]
    v_mfma_f32_16x16x32_bf16 v[108:111], v[76:79], v[92:95], v[108:111]
    v_mfma_f32_16x16x32_bf16 v[112:115], v[72:75], v[96:99], v[112:115]
    v_mfma_f32_16x16x32_bf16 v[116:119], v[76:79], v[96:99], v[116:119]
    v_mfma_f32_16x16x32_bf16 v[120:123], v[72:75], v[100:103], v[120:123]
    v_mfma_f32_16x16x32_bf16 v[124:127], v[76:79], v[100:103], v[124:127]
    s_setprio 3
    s_add_u32 s100, s100, 4096
    buffer_load_dwordx4 v[64:67], v14, s[16:19], s100 offen offset:0 sc1
    buffer_load_dwordx4 v[68:71], v14, s[16:19], s100 offen offset:1024 sc1
    buffer_load_dwordx4 v[72:75], v14, s[16:19], s100 offen offset:2048 sc1
    buffer_load_dwordx4 v[76:79], v14, s[16:19], s100 offen offset:3072 sc1
    s_setprio 0
    s_nop 3
    v_cvt_pk_bf16_f32 v80, v104, v105
    v_cvt_pk_bf16_f32 v81, v106, v107
    v_cvt_pk_bf16_f32 v82, v108, v109
    v_cvt_pk_bf16_f32 v83, v110, v111
    ds_write_b128 v13, v[80:83] offset:0
    v_cvt_pk_bf16_f32 v84, v112, v113
    v_cvt_pk_bf16_f32 v85, v114, v115
    v_cvt_pk_bf16_f32 v86, v116, v117
    v_cvt_pk_bf16_f32 v87, v118, v119
    ds_write_b128 v13, v[84:87] offset:8448
    v_cvt_pk_bf16_f32 v88, v120, v121
    v_cvt_pk_bf16_f32 v89, v122, v123
    v_cvt_pk_bf16_f32 v90, v124, v125
    v_cvt_pk_bf16_f32 v91, v126, v127
    ds_write_b128 v13, v[88:91] offset:16896
    s_mov_b64 exec, 1
    v_mov_b32 v4, 1
    ds_add_u32 v3, v4 offset:20
    s_mov_b64 exec, -1
    s_setprio 3
    s_setprio 0
L_late1:
    s_mov_b32 s63, s3
L_grp:
    s_mul_i32 s58, s63, 8448
    s_lshr_b32 s59, s63, 2
    s_mul_i32 s59, s59, 8448
    s_and_b32 s60, s63, 1
    s_bfe_u32 s61, s63, 0x10001
    s_cmp_ge_u32 s63, 8
    s_cselect_b32 s61, s60, s61
    s_cselect_b32 s60, 0, s60
    s_mul_i32 s60, s60, 4224
    s_lshl_b32 s61, s61, 9
    s_add_u32 s59, s59, s60
    s_add_u32 s59, s59, s61
    s_add_u32 s59, s59, 105600
    v_add_u32 v12, s58, v1
    v_bfe_u32 v4, v0, 2, 2
    v_mul_u32_u24 v4, 1056, v4
    v_and_b32 v5, 48, v0
    v_add3_u32 v13, v4, v5, s59
    v_lshl_add_u32 v14, v0, 3, s58
    v_lshl_add_u32 v2, v0, 3, s59
    s_cmp_ge_u32 s63, 8
    s_cbranch_scc1 L_grp2
    s_mov_b32 s59, 0
Lw_47:
    ds_read_b32 v4, v3 offset:20
    s_waitcnt lgkmcnt(0)
    v_cmp_gt_u32 vcc, 8, v4
    s_cbranch_vccz Lk_48
    s_sleep 1
    s_add_u32 s59, s59, 1
    s_cmp_lt_u32 s59, 4194304
    s_cbranch_scc1 Lw_47
    s_branch L_end
Lk_48:
L_grp2:
    s_waitcnt lgkmcnt(0)
    ds_read_b128 v[80:83], v12 offset:0
    ds_read_b128 v[84:87], v13 offset:0
    ds_read_b128 v[88:91], v12 offset:64
    ds_read_b128 v[92:95], v13 offset:64
    ds_read_b128 v[96:99], v12 offset:128
    ds_read_b128 v[100:103], v13 offset:128
    ds_read_b128 v[104:107], v12 offset:192
    ds_read_b128 v[108:111], v13 offset:192
    ds_read_b128 v[112:115], v12 offset:256
    ds_read_b128 v[116:119], v13 offset:256
    ds_read_b128 v[120:123], v12 offset:320
    ds_read_b128 v[124:127], v13 offset:320
    s_waitcnt lgkmcnt(10)
    v_mfma_f32_16x16x32_bf16 v[4:7], v[80:83], v[84:87], 0
    ds_read_b128 v[80:83], v12 offset:384
    ds_read_b128 v[84:87], v13 offset:384
    s_waitcnt lgkmcnt(10)
    v_mfma_f32_16x16x32_bf16 v[4:7], v[88:91], v[92:95], v[4:7]
    ds_read_b128 v[88:91], v12 offset:448
    ds_read_b128 v[92:95], v13 offset:448
    s_waitcnt lgkmcnt(10)
    v_mfma_f32_16x16x32_bf16 v[4:7], v[96:99], v[100:103], v[4:7]
    s_waitcnt lgkmcnt(8)
    v_mfma_f32_16x16x32_bf16 v[4:7], v[104:107], v[108:111], v[4:7]
    s_waitcnt lgkmcnt(6)
    v_mfma_f32_16x16x32_bf16 v[4:7], v[112:115], v[116:119], v[4:7]
    s_waitcnt lgkmcnt(4)
    v_mfma_f32_16x16x32_bf16 v[4:7], v[120:123], v[124:127], v[4:7]
    s_waitcnt lgkmcnt(2)
    v_mfma_f32_16x16x32_bf16 v[4:7], v[80:83], v[84:87], v[4:7]
    s_waitcnt lgkmcnt(0)
    v_mfma_f32_16x16x32_bf16 v[4:7], v[88:91], v[92:95], v[4:7]
    ds_read_b64 v[96:97], v14 offset:2112
    ds_read_b64 v[98:99], v14 offset:6336
    ds_read_b64 v[100:101], v14 offset:2624
    ds_read_b64 v[102:103], v14 offset:6848
    ds_read_b64 v[104:105], v14 offset:3168
    ds_read_b64 v[106:107], v14 offset:7392
    ds_read_b64 v[108:109], v14 offset:3680
    ds_read_b64 v[110:111], v14 offset:7904
    ds_read_b64 v[80:81], v14 offset:0
    ds_read_b64 v[82:83], v14 offset:4224
    ds_read_b64 v[84:85], v14 offset:512
    ds_read_b64 v[86:87], v14 offset:4736
    ds_read_b64 v[88:89], v14 offset:1056
    ds_read_b64 v[90:91], v14 offset:5280
    ds_read_b64 v[92:93], v14 offset:1568
    s_waitcnt lgkmcnt(14)
    ds_read_b64 v[94:95], v14 offset:5792
    v_mul_f32 v4, 0x3db8aa3b, v4
    v_mul_f32 v5, 0x3db8aa3b, v5
    v_mul_f32 v6, 0x3db8aa3b, v6
    v_mul_f32 v7, 0x3db8aa3b, v7
    v_exp_f32 v4, v4
    v_exp_f32 v5, v5
    v_exp_f32 v6, v6
    v_exp_f32 v7, v7
    v_add_f32 v12, v4, v5
    v_add_f32 v13, v6, v7
    v_add_f32 v12, v12, v13
    v_add_f32 v12, 0x3089705f, v12
    v_rcp_f32 v12, v12
    s_add_u32 s63, s63, 8
    v_mul_f32 v4, v4, v12
    v_mul_f32 v5, v5, v12
    v_mul_f32 v6, v6, v12
    v_mul_f32 v7, v7, v12
    v_cvt_pk_bf16_f32 v4, v4, v5
    v_cvt_pk_bf16_f32 v6, v6, v7
    v_perm_b32 v112, v4, v4, v8
    v_perm_b32 v113, v4, v4, v9
    v_perm_b32 v114, v4, v4, v10
    v_perm_b32 v115, v4, v4, v11
    v_perm_b32 v116, v6, v6, v8
    v_perm_b32 v117, v6, v6, v9
    v_perm_b32 v118, v6, v6, v10
    v_perm_b32 v119, v6, v6, v11
    s_waitcnt lgkmcnt(0)
    v_mfma_f32_4x4x4_16b_bf16 v[120:123], v[112:113], v[80:81], 0 cbsz:4 abid:0
    v_mfma_f32_4x4x4_16b_bf16 v[124:127], v[112:113], v[82:83], 0 cbsz:4 abid:5
    v_mfma_f32_4x4x4_16b_bf16 v[4:7], v[112:113], v[84:85], 0 cbsz:4 abid:10
    v_mfma_f32_4x4x4_16b_bf16 v[12:15], v[112:113], v[86:87], 0 cbsz:4 abid:15
    v_mfma_f32_4x4x4_16b_bf16 v[120:123], v[114:115], v[88:89], v[120:123] cbsz:4 abid:0
    v_mfma_f32_4x4x4_16b_bf16 v[124:127], v[114:115], v[90:91], v[124:127] cbsz:4 abid:5
    v_mfma_f32_4x4x4_16b_bf16 v[4:7], v[114:115], v[92:93], v[4:7] cbsz:4 abid:10
    v_mfma_f32_4x4x4_16b_bf16 v[12:15], v[114:115], v[94:95], v[12:15] cbsz:4 abid:15
    v_mfma_f32_4x4x4_16b_bf16 v[120:123], v[116:117], v[96:97], v[120:123] cbsz:4 abid:0
    v_mfma_f32_4x4x4_16b_bf16 v[124:127], v[116:117], v[98:99], v[124:127] cbsz:4 abid:5
    v_mfma_f32_4x4x4_16b_bf16 v[4:7], v[116:117], v[100:101], v[4:7] cbsz:4 abid:10
    v_mfma_f32_4x4x4_16b_bf16 v[12:15], v[116:117], v[102:103], v[12:15] cbsz:4 abid:15
    v_mfma_f32_4x4x4_16b_bf16 v[120:123], v[118:119], v[104:105], v[120:123] cbsz:4 abid:0
    v_mfma_f32_4x4x4_16b_bf16 v[124:127], v[118:119], v[106:107], v[124:127] cbsz:4 abid:5
    v_mfma_f32_4x4x4_16b_bf16 v[4:7], v[118:119], v[108:109], v[4:7] cbsz:4 abid:10
    v_mfma_f32_4x4x4_16b_bf16 v[12:15], v[118:119], v[110:111], v[12:15] cbsz:4 abid:15
    s_nop 1
    v_cvt_pk_bf16_f32 v112, v120, v121
    v_cvt_pk_bf16_f32 v113, v122, v123
    ds_write_b64 v2, v[112:113] offset:0
    v_cvt_pk_bf16_f32 v114, v124, v125
    v_cvt_pk_bf16_f32 v115, v126, v127
    ds_write_b64 v2, v[114:115] offset:1056
    v_cvt_pk_bf16_f32 v116, v4, v5
    v_cvt_pk_bf16_f32 v117, v6, v7
    ds_write_b64 v2, v[116:117] offset:2112
    v_cvt_pk_bf16_f32 v118, v12, v13
    v_cvt_pk_bf16_f32 v119, v14, v15
    ds_write_b64 v2, v[118:119] offset:3168
    s_cmp_lt_u32 s63, 10
    s_cbranch_scc1 L_grp
L_grpx:
    s_mov_b64 exec, 1
    v_mov_b32 v4, 1
    ds_add_u32 v3, v4 offset:24
    s_mov_b64 exec, -1
    v_add_u32 v12, 105600, v1
    v_lshlrev_b32 v14, 4, v0
    v_and_b32 v6, 15, v0
    v_lshlrev_b32 v6, 2, v6
    v_and_b32 v5, 48, v0
    v_lshl_add_u32 v8, v5, 7, v6
    v_and_b32 v5, 32, v0
    v_lshl_add_u32 v9, v5, 6, v6
    v_and_b32 v5, 16, v0
    v_lshl_add_u32 v9, v5, 22, v9
    s_lshl_b32 s60, s5, 9
    s_lshl_b32 s61, s3, 6
    s_add_u32 s60, s60, s61
    s_mov_b32 s59, 0
Lw_49:
    ds_read_b32 v4, v3 offset:24
    s_waitcnt lgkmcnt(0)
    v_cmp_gt_u32 vcc, 8, v4
    s_cbranch_vccz Lk_50
    s_sleep 1
    s_add_u32 s59, s59, 1
    s_cmp_lt_u32 s59, 4194304
    s_cbranch_scc1 Lw_49
    s_branch L_end
Lk_50:
    ds_read_b128 v[80:83], v12 offset:0
    ds_read_b128 v[84:87], v12 offset:8448
    ds_read_b128 v[88:91], v12 offset:16896
    ds_read_b128 v[92:95], v12 offset:64
    ds_read_b128 v[96:99], v12 offset:8512
    ds_read_b128 v[100:103], v12 offset:16960
    s_waitcnt vmcnt(14) lgkmcnt(3)
    v_mfma_f32_16x16x32_bf16 v[104:107], v[80:83], v[16:19], 0
    v_mfma_f32_16x16x32_bf16 v[108:111], v[80:83], v[20:23], 0
    v_mfma_f32_16x16x32_bf16 v[112:115], v[84:87], v[16:19], 0
    v_mfma_f32_16x16x32_bf16 v[116:119], v[84:87], v[20:23], 0
    v_mfma_f32_16x16x32_bf16 v[120:123], v[88:91], v[16:19], 0
    v_mfma_f32_16x16x32_bf16 v[124:127], v[88:91], v[20:23], 0
    ds_read_b128 v[80:83], v12 offset:128
    ds_read_b128 v[84:87], v12 offset:8576
    ds_read_b128 v[88:91], v12 offset:17024
    s_waitcnt vmcnt(12) lgkmcnt(3)
    v_mfma_f32_16x16x32_bf16 v[104:107], v[92:95], v[24:27], v[104:107]
    v_mfma_f32_16x16x32_bf16 v[108:111], v[92:95], v[28:31], v[108:111]
    v_mfma_f32_16x16x32_bf16 v[112:115], v[96:99], v[24:27], v[112:115]
    v_mfma_f32_16x16x32_bf16 v[116:119], v[96:99], v[28:31], v[116:119]
    v_mfma_f32_16x16x32_bf16 v[120:123], v[100:103], v[24:27], v[120:123]
    v_mfma_f32_16x16x32_bf16 v[124:127], v[100:103], v[28:31], v[124:127]
    ds_read_b128 v[92:95], v12 offset:192
    ds_read_b128 v[96:99], v12 offset:8640
    ds_read_b128 v[100:103], v12 offset:17088
    s_waitcnt vmcnt(10) lgkmcnt(3)
    v_mfma_f32_16x16x32_bf16 v[104:107], v[80:83], v[32:35], v[104:107]
    v_mfma_f32_16x16x32_bf16 v[108:111], v[80:83], v[36:39], v[108:111]
    v_mfma_f32_16x16x32_bf16 v[112:115], v[84:87], v[32:35], v[112:115]
    v_mfma_f32_16x16x32_bf16 v[116:119], v[84:87], v[36:39], v[116:119]
    v_mfma_f32_16x16x32_bf16 v[120:123], v[88:91], v[32:35], v[120:123]
    v_mfma_f32_16x16x32_bf16 v[124:127], v[88:91], v[36:39], v[124:127]
    ds_read_b128 v[80:83], v12 offset:256
    ds_read_b128 v[84:87], v12 offset:8704
    ds_read_b128 v[88:91], v12 offset:17152
    s_waitcnt vmcnt(8) lgkmcnt(3)
    v_mfma_f32_16x16x32_bf16 v[104:107], v[92:95], v[40:43], v[104:107]
    v_mfma_f32_16x16x32_bf16 v[108:111], v[92:95], v[44:47], v[108:111]
    v_mfma_f32_16x16x32_bf16 v[112:115], v[96:99], v[40:43], v[112:115]
    v_mfma_f32_16x16x32_bf16 v[116:119], v[96:99], v[44:47], v[116:119]
    v_mfma_f32_16x16x32_bf16 v[120:123], v[100:103], v[40:43], v[120:123]
    v_mfma_f32_16x16x32_bf16 v[124:127], v[100:103], v[44:47], v[124:127]
    ds_read_b128 v[92:95], v12 offset:320
    ds_read_b128 v[96:99], v12 offset:8768
    ds_read_b128 v[100:103], v12 offset:17216
    s_waitcnt vmcnt(6) lgkmcnt(3)
    v_mfma_f32_16x16x32_bf16 v[104:107], v[80:83], v[48:51], v[104:107]
    v_mfma_f32_16x16x32_bf16 v[108:111], v[80:83], v[52:55], v[108:111]
    v_mfma_f32_16x16x32_bf16 v[112:115], v[84:87], v[48:51], v[112:115]
    v_mfma_f32_16x16x32_bf16 v[116:119], v[84:87], v[52:55], v[116:119]
    v_mfma_f32_16x16x32_bf16 v[120:123], v[88:91], v[48:51], v[120:123]
    v_mfma_f32_16x16x32_bf16 v[124:127], v[88:91], v[52:55], v[124:127]
    s_setprio 3
    s_add_u32 s100, s100, 118784
    buffer_load_dwordx4 v[16:19], v14, s[16:19], s100 offen offset:0 sc1
    buffer_load_dwordx4 v[20:23], v14, s[16:19], s100 offen offset:1024 sc1
    buffer_load_dwordx4 v[24:27], v14, s[16:19], s100 offen offset:2048 sc1
    buffer_load_dwordx4 v[28:31], v14, s[16:19], s100 offen offset:3072 sc1
    s_setprio 0
    ds_read_b128 v[80:83], v12 offset:384
    ds_read_b128 v[84:87], v12 offset:8832
    ds_read_b128 v[88:91], v12 offset:17280
    s_waitcnt vmcnt(8) lgkmcnt(3)
    v_mfma_f32_16x16x32_bf16 v[104:107], v[92:95], v[56:59], v[104:107]
    v_mfma_f32_16x16x32_bf16 v[108:111], v[92:95], v[60:63], v[108:111]
    v_mfma_f32_16x16x32_bf16 v[112:115], v[96:99], v[56:59], v[112:115]
    v_mfma_f32_16x16x32_bf16 v[116:119], v[96:99], v[60:63], v[116:119]
    v_mfma_f32_16x16x32_bf16 v[120:123], v[100:103], v[56:59], v[120:123]
    v_mfma_f32_16x16x32_bf16 v[124:127], v[100:103], v[60:63], v[124:127]
    s_setprio 3
    s_add_u32 s100, s100, 4096
    buffer_load_dwordx4 v[32:35], v14, s[16:19], s100 offen offset:0 sc1
    buffer_load_dwordx4 v[36:39], v14, s[16:19], s100 offen offset:1024 sc1
    buffer_load_dwordx4 v[40:43], v14, s[16:19], s100 offen offset:2048 sc1
    buffer_load_dwordx4 v[44:47], v14, s[16:19], s100 offen offset:3072 sc1
    s_setprio 0
    ds_read_b128 v[92:95], v12 offset:448
    ds_read_b128 v[96:99], v12 offset:8896
    ds_read_b128 v[100:103], v12 offset:17344
    s_waitcnt vmcnt(10) lgkmcnt(3)
    v_mfma_f32_16x16x32_bf16 v[104:107], v[80:83], v[64:67], v[104:107]
    v_mfma_f32_16x16x32_bf16 v[108:111], v[80:83], v[68:71], v[108:111]
    v_mfma_f32_16x16x32_bf16 v[112:115], v[84:87], v[64:67], v[112:115]
    v_mfma_f32_16x16x32_bf16 v[116:119], v[84:87], v[68:71], v[116:119]
    v_mfma_f32_16x16x32_bf16 v[120:123], v[88:91], v[64:67], v[120:123]
    v_mfma_f32_16x16x32_bf16 v[124:127], v[88:91], v[68:71], v[124:127]
    s_setprio 3
    s_add_u32 s100, s100, 4096
    buffer_load_dwordx4 v[48:51], v14, s[16:19], s100 offen offset:0 sc1
    buffer_load_dwordx4 v[52:55], v14, s[16:19], s100 offen offset:1024 sc1
    buffer_load_dwordx4 v[56:59], v14, s[16:19], s100 offen offset:2048 sc1
    buffer_load_dwordx4 v[60:63], v14, s[16:19], s100 offen offset:3072 sc1
    s_setprio 0
    s_waitcnt vmcnt(12) lgkmcnt(0)
    v_mfma_f32_16x16x32_bf16 v[104:107], v[92:95], v[72:75], v[104:107]
    v_mfma_f32_16x16x32_bf16 v[108:111], v[92:95], v[76:79], v[108:111]
    v_mfma_f32_16x16x32_bf16 v[112:115], v[96:99], v[72:75], v[112:115]
    v_mfma_f32_16x16x32_bf16 v[116:119], v[96:99], v[76:79], v[116:119]
    v_mfma_f32_16x16x32_bf16 v[120:123], v[100:103], v[72:75], v[120:123]
    v_mfma_f32_16x16x32_bf16 v[124:127], v[100:103], v[76:79], v[124:127]
    s_setprio 3
    s_add_u32 s100, s100, 4096
    buffer_load_dwordx4 v[64:67], v14, s[16:19], s100 offen offset:0 sc1
    buffer_load_dwordx4 v[68:71], v14, s[16:19], s100 offen offset:1024 sc1
    buffer_load_dwordx4 v[72:75], v14, s[16:19], s100 offen offset:2048 sc1
    buffer_load_dwordx4 v[76:79], v14, s[16:19], s100 offen offset:3072 sc1
    s_setprio 0
    s_setprio 3
    s_setprio 0
    v_add_u32 v12, 130944, v1
    s_mov_b32 s59, 0
Lw_51:
    ds_read_b32 v4, v3 offset:36
    s_waitcnt lgkmcnt(0)
    v_cmp_gt_u32 vcc, 16, v4
    s_cbranch_vccz Lk_52
    s_sleep 3
    s_add_u32 s59, s59, 1
    s_cmp_lt_u32 s59, 16777216
    s_cbranch_scc1 Lw_51
    s_branch L_end
Lk_52:
    ds_read_b128 v[80:83], v12 offset:0
    ds_read_b128 v[84:87], v12 offset:64
    ds_read_b128 v[88:91], v12 offset:128
    ds_read_b128 v[92:95], v12 offset:192
    ds_read_b128 v[96:99], v12 offset:256
    ds_read_b128 v[100:103], v12 offset:320
    s_waitcnt vmcnt(14) lgkmcnt(5)
    v_mfma_f32_16x16x32_bf16 v[104:107], v[80:83], v[16:19], v[104:107]
    v_mfma_f32_16x16x32_bf16 v[108:111], v[80:83], v[20:23], v[108:111]
    ds_read_b128 v[80:83], v12 offset:384
    s_waitcnt vmcnt(12) lgkmcnt(5)
    v_mfma_f32_16x16x32_bf16 v[104:107], v[84:87], v[24:27], v[104:107]
    v_mfma_f32_16x16x32_bf16 v[108:111], v[84:87], v[28:31], v[108:111]
    ds_read_b128 v[84:87], v12 offset:448
    s_waitcnt vmcnt(10) lgkmcnt(5)
    v_mfma_f32_16x16x32_bf16 v[104:107], v[88:91], v[32:35], v[104:107]
    v_mfma_f32_16x16x32_bf16 v[108:111], v[88:91], v[36:39], v[108:111]
    s_waitcnt vmcnt(8) lgkmcnt(4)
    v_mfma_f32_16x16x32_bf16 v[104:107], v[92:95], v[40:43], v[104:107]
    v_mfma_f32_16x16x32_bf16 v[108:111], v[92:95], v[44:47], v[108:111]
    s_waitcnt vmcnt(6) lgkmcnt(3)
    v_mfma_f32_16x16x32_bf16 v[104:107], v[96:99], v[48:51], v[104:107]
    v_mfma_f32_16x16x32_bf16 v[108:111], v[96:99], v[52:55], v[108:111]
    s_waitcnt vmcnt(4) lgkmcnt(2)
    v_mfma_f32_16x16x32_bf16 v[104:107], v[100:103], v[56:59], v[104:107]
    v_mfma_f32_16x16x32_bf16 v[108:111], v[100:103], v[60:63], v[108:111]
    s_waitcnt vmcnt(2) lgkmcnt(1)
    v_mfma_f32_16x16x32_bf16 v[104:107], v[80:83], v[64:67], v[104:107]
    v_mfma_f32_16x16x32_bf16 v[108:111], v[80:83], v[68:71], v[108:111]
    s_waitcnt vmcnt(0) lgkmcnt(0)
    v_mfma_f32_16x16x32_bf16 v[104:107], v[84:87], v[72:75], v[104:107]
    v_mfma_f32_16x16x32_bf16 v[108:111], v[84:87], v[76:79], v[108:111]
    s_nop 7
    v_cvt_pk_bf16_f32 v104, v104, v108
    buffer_store_dword v104, v8, s[20:23], s60 offen offset:0 sc1
    v_cvt_pk_bf16_f32 v105, v105, v109
    buffer_store_dword v105, v8, s[20:23], s60 offen offset:512 sc1
    v_cvt_pk_bf16_f32 v106, v106, v110
    buffer_store_dword v106, v8, s[20:23], s60 offen offset:1024 sc1
    v_cvt_pk_bf16_f32 v107, v107, v111
    buffer_store_dword v107, v8, s[20:23], s60 offen offset:1536 sc1
    s_add_u32 s60, s60, 8192
    s_mov_b32 s59, 0
Lw_53:
    ds_read_b32 v4, v3 offset:40
    s_waitcnt lgkmcnt(0)
    v_cmp_gt_u32 vcc, 16, v4
    s_cbranch_vccz Lk_54
    s_sleep 3
    s_add_u32 s59, s59, 1
    s_cmp_lt_u32 s59, 16777216
    s_cbranch_scc1 Lw_53
    s_branch L_end
Lk_54:
    ds_read_b128 v[80:83], v12 offset:8448
    ds_read_b128 v[84:87], v12 offset:8512
    ds_read_b128 v[88:91], v12 offset:8576
    ds_read_b128 v[92:95], v12 offset:8640
    ds_read_b128 v[96:99], v12 offset:8704
    ds_read_b128 v[100:103], v12 offset:8768
    s_waitcnt lgkmcnt(5)
    v_mfma_f32_16x16x32_bf16 v[112:115], v[80:83], v[16:19], v[112:115]
    v_mfma_f32_16x16x32_bf16 v[116:119], v[80:83], v[20:23], v[116:119]
    ds_read_b128 v[80:83], v12 offset:8832
    s_waitcnt lgkmcnt(5)
    v_mfma_f32_16x16x32_bf16 v[112:115], v[84:87], v[24:27], v[112:115]
    v_mfma_f32_16x16x32_bf16 v[116:119], v[84:87], v[28:31], v[116:119]
    ds_read_b128 v[84:87], v12 offset:8896
    s_waitcnt lgkmcnt(5)
    v_mfma_f32_16x16x32_bf16 v[112:115], v[88:91], v[32:35], v[112:115]
    v_mfma_f32_16x16x32_bf16 v[116:119], v[88:91], v[36:39], v[116:119]
    s_waitcnt lgkmcnt(4)
    v_mfma_f32_16x16x32_bf16 v[112:115], v[92:95], v[40:43], v[112:115]
    v_mfma_f32_16x16x32_bf16 v[116:119], v[92:95], v[44:47], v[116:119]
    s_waitcnt lgkmcnt(3)
    v_mfma_f32_16x16x32_bf16 v[112:115], v[96:99], v[48:51], v[112:115]
    v_mfma_f32_16x16x32_bf16 v[116:119], v[96:99], v[52:55], v[116:119]
    s_waitcnt lgkmcnt(2)
    v_mfma_f32_16x16x32_bf16 v[112:115], v[100:103], v[56:59], v[112:115]
    v_mfma_f32_16x16x32_bf16 v[116:119], v[100:103], v[60:63], v[116:119]
    s_waitcnt lgkmcnt(1)
    v_mfma_f32_16x16x32_bf16 v[112:115], v[80:83], v[64:67], v[112:115]
    v_mfma_f32_16x16x32_bf16 v[116:119], v[80:83], v[68:71], v[116:119]
    s_waitcnt lgkmcnt(0)
    v_mfma_f32_16x16x32_bf16 v[112:115], v[84:87], v[72:75], v[112:115]
    v_mfma_f32_16x16x32_bf16 v[116:119], v[84:87], v[76:79], v[116:119]
    s_nop 7
    v_cvt_pk_bf16_f32 v112, v112, v116
    buffer_store_dword v112, v8, s[20:23], s60 offen offset:0 sc1
    v_cvt_pk_bf16_f32 v113, v113, v117
    buffer_store_dword v113, v8, s[20:23], s60 offen offset:512 sc1
    v_cvt_pk_bf16_f32 v114, v114, v118
    buffer_store_dword v114, v8, s[20:23], s60 offen offset:1024 sc1
    v_cvt_pk_bf16_f32 v115, v115, v119
    buffer_store_dword v115, v8, s[20:23], s60 offen offset:1536 sc1
    s_add_u32 s60, s60, 8192
    s_mov_b32 s59, 0
Lw_55:
    ds_read_b32 v4, v3 offset:44
    s_waitcnt lgkmcnt(0)
    v_cmp_gt_u32 vcc, 8, v4
    s_cbranch_vccz Lk_56
    s_add_u32 s59, s59, 1
    s_cmp_lt_u32 s59, 16777216
    s_cbranch_scc1 Lw_55
    s_branch L_end
Lk_56:
    ds_read_b128 v[80:83], v12 offset:16896
    ds_read_b128 v[84:87], v12 offset:16960
    ds_read_b128 v[88:91], v12 offset:17024
    ds_read_b128 v[92:95], v12 offset:17088
    ds_read_b128 v[96:99], v12 offset:17152
    ds_read_b128 v[100:103], v12 offset:17216
    s_waitcnt lgkmcnt(5)
    v_mfma_f32_16x16x32_bf16 v[120:123], v[80:83], v[16:19], v[120:123]
    v_mfma_f32_16x16x32_bf16 v[124:127], v[80:83], v[20:23], v[124:127]
    ds_read_b128 v[80:83], v12 offset:17280
    s_waitcnt lgkmcnt(5)
    v_mfma_f32_16x16x32_bf16 v[120:123], v[84:87], v[24:27], v[120:123]
    v_mfma_f32_16x16x32_bf16 v[124:127], v[84:87], v[28:31], v[124:127]
    ds_read_b128 v[84:87], v12 offset:17344
    s_waitcnt lgkmcnt(5)
    v_mfma_f32_16x16x32_bf16 v[120:123], v[88:91], v[32:35], v[120:123]
    v_mfma_f32_16x16x32_bf16 v[124:127], v[88:91], v[36:39], v[124:127]
    s_waitcnt lgkmcnt(4)
    v_mfma_f32_16x16x32_bf16 v[120:123], v[92:95], v[40:43], v[120:123]
    v_mfma_f32_16x16x32_bf16 v[124:127], v[92:95], v[44:47], v[124:127]
    s_waitcnt lgkmcnt(3)
    v_mfma_f32_16x16x32_bf16 v[120:123], v[96:99], v[48:51], v[120:123]
    v_mfma_f32_16x16x32_bf16 v[124:127], v[96:99], v[52:55], v[124:127]
    s_waitcnt lgkmcnt(2)
    v_mfma_f32_16x16x32_bf16 v[120:123], v[100:103], v[56:59], v[120:123]
    v_mfma_f32_16x16x32_bf16 v[124:127], v[100:103], v[60:63], v[124:127]
    s_waitcnt lgkmcnt(1)
    v_mfma_f32_16x16x32_bf16 v[120:123], v[80:83], v[64:67], v[120:123]
    v_mfma_f32_16x16x32_bf16 v[124:127], v[80:83], v[68:71], v[124:127]
    s_waitcnt lgkmcnt(0)
    v_mfma_f32_16x16x32_bf16 v[120:123], v[84:87], v[72:75], v[120:123]
    v_mfma_f32_16x16x32_bf16 v[124:127], v[84:87], v[76:79], v[124:127]
    s_nop 7
    v_cvt_pk_bf16_f32 v120, v120, v124
    buffer_store_dword v120, v9, s[20:23], s60 offen offset:0 sc1
    v_cvt_pk_bf16_f32 v121, v121, v125
    buffer_store_dword v121, v9, s[20:23], s60 offen offset:512 sc1
    v_cvt_pk_bf16_f32 v122, v122, v126
    buffer_store_dword v122, v9, s[20:23], s60 offen offset:1024 sc1
    v_cvt_pk_bf16_f32 v123, v123, v127
    buffer_store_dword v123, v9, s[20:23], s60 offen offset:1536 sc1
L_end:
L_exit:
    s_endpgm
L_slow:
    s_setprio 0
    ds_add_u32 v61, v62 offset:16
    s_mov_b32 s59, 0
Lw_57:
    ds_read_b32 v4, v3 offset:16
    s_waitcnt lgkmcnt(0)
    v_cmp_gt_u32 vcc, 8, v4
    s_cbranch_vccz Lk_58
    s_add_u32 s59, s59, 1
    s_cmp_lt_u32 s59, 4194304
    s_cbranch_scc1 Lw_57
    s_branch L_end
Lk_58:
    v_mov_b32 v12, v3
    s_mov_b64 s[24:25], s[34:35]
    s_mov_b32 s26, 640000
    s_mov_b64 s[28:29], s[36:37]
    s_mov_b32 s30, 640000
    s_mov_b64 s[12:13], s[42:43]
    s_mov_b32 s14, 20000
    s_mov_b32 s15, 0x20000
    s_sub_u32 s63, s67, 1
    s_mov_b32 s65, 201486528
    s_mov_b32 s64, 0
    s_call_b64 s[68:69], L_flush
    s_add_u32 s66, s4, s5
    s_add_u32 s67, s66, 40
    v_lshlrev_b32 v16, 2, v0
    v_and_b32 v17, 32, v0
    v_lshl_add_u32 v17, v17, 22, v2
    v_mov_b32 v24, 0
L_sn:
    s_mov_b32 s60, 0
L_sc:
    buffer_load_dword v18, v16, s[28:31], s60 offen
    buffer_load_dword v19, v16, s[24:27], s60 offen
    s_waitcnt vmcnt(0)
    v_cmp_eq_u32 vcc, s66, v18
    s_cbranch_vccz L_sx
L_se:
    s_ff1_i32_b64 s58, vcc
    s_bitset0_b64 vcc, s58
    v_readlane_b32 s59, v19, s58
    s_nop 0
    s_lshl_b32 s61, s59, 9
    s_lshl_b32 s59, s59, 1
    buffer_load_dwordx4 v[20:23], v17, s[8:11], s61 offen
    buffer_load_ushort v1, v24, s[12:15], s59 offen
    s_waitcnt vmcnt(0)
    v_perm_b32 v6, v1, v1, v10
    v_perm_b32 v7, v1, v1, v11
    s_nop 1
    v_mfma_f32_4x4x4_16b_bf16 v[56:59], v[6:7], v[20:21], v[56:59]
    v_mfma_f32_4x4x4_16b_bf16 v[60:63], v[6:7], v[22:23], v[60:63]
    s_cmp_lg_u64 vcc, 0
    s_cbranch_scc1 L_se
L_sx:
    s_add_u32 s60, s60, 256
    s_cmp_lt_u32 s60, 640000
    s_cbranch_scc1 L_sc
    s_call_b64 s[68:69], L_flush
    s_add_u32 s66, s66, 8
    s_cmp_lt_u32 s66, s67
    s_cbranch_scc1 L_sn
    s_branch L_gdone
.section .rodata,"a"
.p2align 6
.amdhsa_kernel standalone__hybrid_graph_tf_exphormer__graph_kernel
  .amdhsa_next_free_vgpr 128
  .amdhsa_next_free_sgpr 102
  .amdhsa_accum_offset 128
  .amdhsa_group_segment_fixed_size 0
  .amdhsa_kernarg_size 104
  .amdhsa_user_sgpr_count 2
  .amdhsa_user_sgpr_kernarg_segment_ptr 1
  .amdhsa_system_sgpr_workgroup_id_x 1
.end_amdhsa_kernel
```

```asm
; @launch grid=(250,1,1) block=(1024,1,1) lds=161984
.amdgcn_target "amdgcn-amd-amdhsa--gfx950"
.text
.globl standalone__hybrid_graph_tf_exphormer__graph_kernel
.p2align 8
.type standalone__hybrid_graph_tf_exphormer__graph_kernel,@function
standalone__hybrid_graph_tf_exphormer__graph_kernel:
    s_cmp_ge_u32 s2, 250
    s_cbranch_scc1 L_exit
    s_load_dwordx16 s[32:47], s[0:1], 0
    s_load_dwordx8 s[48:55], s[0:1], 64
    s_load_dwordx2 s[56:57], s[0:1], 96
    s_getpc_b64 s[60:61]
    s_lshr_b32 s6, s2, 3
    v_lshl_add_u32 v1, v0, 5, s6
    v_cmp_gt_u32 vcc, 86, v1
    v_lshlrev_b32 v1, 7, v1
    s_and_saveexec_b64 s[58:59], vcc
    s_cbranch_execz L_nopf
    global_load_dword v15, v1, s[60:61]
L_nopf:
    s_mov_b64 exec, -1
    v_lshrrev_b32 v1, 6, v0
    v_mov_b32 v8, 33554432
    v_readfirstlane_b32 s3, v1
    v_cmp_gt_u32 vcc, 288, v0
    v_lshlrev_b32 v5, 4, v0
    v_add_u32 v4, 152064, v5
    v_cndmask_b32 v8, 0, v8, vcc
    v_mov_b32 v9, v8
    v_mov_b64 v[10:11], v[8:9]
    v_cmp_gt_u32 vcc, 556, v0
    s_and_saveexec_b64 s[58:59], vcc
    ds_write_b128 v4, v[8:11]
    s_mov_b64 exec, -1
    v_and_b32 v0, 63, v0
    v_and_b32 v2, 31, v0
    v_lshlrev_b32 v2, 4, v2
    s_and_b32 s59, s2, 7
    s_mul_i32 s60, s59, 31
    s_min_u32 s59, s59, 2
    s_add_u32 s6, s6, s60
    s_add_u32 s6, s6, s59
    s_mov_b32 s27, 0x20000
    s_mov_b32 s31, 0x20000
    s_xor_b32 s3, s3, 8
    s_and_b32 s4, s3, 7
    s_cmp_lt_u32 s3, 8
    s_cbranch_scc1 L_e3
    s_setprio 3
    s_cmp_ge_u32 s2, 64
    s_cbranch_scc1 L_e1
    v_lshrrev_b32 v6, 2, v5
    s_mul_i32 s58, s2, 10000
    s_add_u32 s60, s58, 8192
    s_mov_b32 s26, 640000
    s_mov_b32 s30, 640000
    s_mov_b32 s59, 1048576
    s_mov_b32 s63, 1
    s_waitcnt lgkmcnt(0)
    s_mov_b64 s[28:29], s[36:37]
    s_mov_b64 s[24:25], s[34:35]
    buffer_load_dwordx4 v[22:25], v5, s[28:31], s58 offen
    buffer_load_dword v26, v6, s[28:31], s60 offen
    s_setprio 2
    buffer_load_dwordx4 v[16:19], v5, s[24:27], s58 offen
    buffer_load_dword v20, v6, s[24:27], s60 offen
    s_setprio 3
L_ep:
    s_load_dword s40, s[56:57], s59
    s_branch L_bar
L_e1:
    s_mov_b32 s26, 131072
    s_sub_u32 s60, s3, 9
    s_cmp_lt_u32 s60, 3
    s_cbranch_scc1 L_e1b
    s_mov_b32 s63, 0
    s_cmp_eq_u32 s3, 8
    s_cbranch_scc0 L_barw
    s_mov_b32 s63, 5
    s_mov_b32 s59, 1048576
    s_waitcnt lgkmcnt(0)
    s_branch L_ep
L_e1b:
    s_sub_u32 s62, s2, 64
    s_cmp_ge_u32 s62, 128
    s_cbranch_scc1 L_e2
    s_and_b32 s58, s62, 7
    s_lshr_b32 s59, s62, 4
    s_bfe_u32 s61, s62, 0x10003
    s_cmp_eq_u32 s60, 2
    s_cselect_b32 s58, s59, s58
    s_cselect_b32 s61, s61, s60
    s_lshl_b32 s58, s58, 14
    s_lshl_b32 s61, s61, 11
    s_add_u32 s58, s58, s61
    s_add_u32 s59, s58, 4096
    v_and_b32 v4, 32, v0
    v_lshl_add_u32 v4, v4, 8, v2
    s_mul_i32 s61, s60, 8448
    s_add_u32 m0, s61, 105600
    s_cmp_eq_u32 s60, 0
    s_cselect_b32 s63, 2, 3
    s_cmp_eq_u32 s60, 2
    s_waitcnt lgkmcnt(0)
    s_cselect_b64 s[24:25], s[48:49], s[46:47]
    buffer_load_dwordx4 v4, s[24:27], s58 offen offset:0 lds
    s_add_u32 m0, m0, 544
    s_nop 0
    buffer_load_dwordx4 v4, s[24:27], s58 offen offset:512 lds
    s_add_u32 m0, m0, 544
    s_nop 0
    buffer_load_dwordx4 v4, s[24:27], s58 offen offset:1024 lds
    s_add_u32 m0, m0, 544
    s_nop 0
    buffer_load_dwordx4 v4, s[24:27], s58 offen offset:1536 lds
    s_add_u32 m0, m0, 2592
    s_nop 0
    buffer_load_dwordx4 v4, s[24:27], s59 offen offset:0 lds
    s_add_u32 m0, m0, 544
    s_nop 0
    buffer_load_dwordx4 v4, s[24:27], s59 offen offset:512 lds
    s_add_u32 m0, m0, 544
    s_nop 0
    buffer_load_dwordx4 v4, s[24:27], s59 offen offset:1024 lds
    s_add_u32 m0, m0, 544
    s_nop 0
    buffer_load_dwordx4 v4, s[24:27], s59 offen offset:1536 lds
    s_branch L_bar
L_e2:
    s_mul_i32 s60, s60, 58
    s_add_u32 s62, s62, s60
    s_sub_u32 s62, s62, 128
    s_mov_b32 s63, 3
    s_cmp_ge_u32 s62, 128
    s_cbranch_scc1 L_barw
    s_mov_b32 s63, 4
    s_and_b32 s59, s62, 7
    s_lshl_b32 s59, s59, 14
    s_bfe_u32 s60, s62, 0x30003
    s_lshl_b32 s60, s60, 6
    s_add_u32 s59, s59, s60
    v_and_b32 v4, 15, v0
    v_lshlrev_b32 v4, 2, v4
    v_and_b32 v5, 48, v0
    v_lshl_add_u32 v4, v5, 8, v4
    s_cmp_lt_u32 s62, 64
    s_waitcnt lgkmcnt(0)
    s_cselect_b64 s[24:25], s[50:51], s[44:45]
    buffer_load_dword v16, v4, s[24:27], s59 offen offset:0
    buffer_load_dword v17, v4, s[24:27], s59 offen offset:512
    buffer_load_dword v18, v4, s[24:27], s59 offen offset:1024
    buffer_load_dword v19, v4, s[24:27], s59 offen offset:1536
    buffer_load_dword v20, v4, s[24:27], s59 offen offset:2048
    buffer_load_dword v21, v4, s[24:27], s59 offen offset:2560
    buffer_load_dword v22, v4, s[24:27], s59 offen offset:3072
    buffer_load_dword v23, v4, s[24:27], s59 offen offset:3584
    s_branch L_bar
L_e3:
    s_mul_i32 s58, s6, 640
    s_lshl_b32 s59, s3, 6
    s_add_u32 s59, s59, s58
    s_lshr_b32 s60, s3, 2
    s_lshl_b32 s60, s60, 6
    s_and_b32 s61, s3, 3
    s_lshl_b32 s61, s61, 3
    s_add_u32 s60, s60, s61
    s_add_u32 s60, s60, s58
    s_add_u32 s60, s60, 512
    s_add_u32 s61, s60, 32
    s_waitcnt lgkmcnt(0)
    s_mov_b64 s[62:63], s[38:39]
    s_mov_b64 s[8:9], s[32:33]
    s_load_dwordx16 s[32:47], s[62:63], s59
    s_load_dwordx2 s[64:65], s[62:63], s60
    s_load_dwordx2 s[66:67], s[62:63], s61
    s_barrier
    s_branch L_preA
L_barw:
    s_waitcnt lgkmcnt(0)
L_bar:
    s_barrier
    s_mov_b64 s[8:9], s[32:33]
    s_mul_i32 s5, s6, 40
    v_mov_b32 v3, 159296
    s_mov_b32 s10, 5120000
    s_mov_b32 s11, 0x20000
    s_mov_b64 s[16:17], s[56:57]
    s_mov_b32 s18, 1441792
    s_mov_b32 s19, 0x20000
    v_mov_b32 v62, 1
    s_cmp_eq_u32 s63, 1
    s_cbranch_scc0 L_notprod
    v_mov_b32 v9, 4
    v_mov_b32 v10, 159936
    v_lshl_add_u32 v11, v0, 4, v10
    v_cmp_gt_u32 vcc, 7232, v5
    v_add_u32 v59, 105600, v5
    s_mul_i32 s58, s2, 10240
    s_mov_b64 s[66:67], vcc
    s_waitcnt vmcnt(3)
    v_mul_u32_u24 v28, 52429, v22
    v_lshrrev_b32 v28, 21, v28
    v_lshl_add_u32 v28, v28, 2, v10
    ds_add_rtn_u32 v34, v28, v9
    v_mul_u32_u24 v29, 52429, v23
    v_lshrrev_b32 v29, 21, v29
    v_lshl_add_u32 v29, v29, 2, v10
    ds_add_rtn_u32 v35, v29, v9
    v_mul_u32_u24 v30, 52429, v24
    v_lshrrev_b32 v30, 21, v30
    v_lshl_add_u32 v30, v30, 2, v10
    ds_add_rtn_u32 v36, v30, v9
    v_mul_u32_u24 v31, 52429, v25
    v_lshrrev_b32 v31, 21, v31
    v_lshl_add_u32 v31, v31, 2, v10
    ds_add_rtn_u32 v37, v31, v9
    s_waitcnt vmcnt(2)
    s_mov_b64 exec, s[66:67]
    v_mul_u32_u24 v32, 52429, v26
    v_lshrrev_b32 v32, 21, v32
    v_lshl_add_u32 v32, v32, 2, v10
    ds_add_rtn_u32 v38, v32, v9
    s_mov_b64 exec, -1
    s_waitcnt lgkmcnt(0)
    s_barrier
    ds_read_b128 v[12:15], v11
    s_add_u32 s40, s40, 0x9e377000
    s_and_b32 s40, s40, 4294963200
    s_waitcnt lgkmcnt(0)
    v_add_u32 v56, v12, v13
    v_add3_u32 v57, v56, v14, v15
    s_nop 1
    v_add_u32_dpp v58, v57, v57 row_shr:1 row_mask:0xf bank_mask:0xf bound_ctrl:1
    s_nop 1
    v_add_u32_dpp v58, v58, v58 row_shr:2 row_mask:0xf bank_mask:0xf bound_ctrl:1
    s_nop 1
    v_add_u32_dpp v58, v58, v58 row_shr:4 row_mask:0xf bank_mask:0xf bound_ctrl:1
    s_nop 1
    v_add_u32_dpp v58, v58, v58 row_shr:8 row_mask:0xf bank_mask:0xf bound_ctrl:1
    s_nop 1
    v_add_u32_dpp v58, v58, v58 row_bcast:15 row_mask:0xa bank_mask:0xf
    s_nop 1
    v_add_u32_dpp v58, v58, v58 row_bcast:31 row_mask:0xc bank_mask:0xf
    v_sub_u32 v64, v58, v57
    v_add_u32 v65, v64, v12
    v_add_u32 v66, v64, v56
    v_add_u32 v67, v66, v14
    ds_write_b128 v11, v[64:67] offset:1024
    ds_read_b32 v40, v28 offset:1024
    ds_read_b32 v41, v29 offset:1024
    ds_read_b32 v42, v30 offset:1024
    ds_read_b32 v43, v31 offset:1024
    s_mov_b64 exec, s[66:67]
    ds_read_b32 v44, v32 offset:1024
    s_mov_b64 exec, -1
    s_mov_b32 s60, 105600
    s_waitcnt vmcnt(0)
    v_lshl_or_b32 v16, v22, 16, v16
    v_lshl_or_b32 v17, v23, 16, v17
    v_lshl_or_b32 v18, v24, 16, v18
    v_lshl_or_b32 v19, v25, 16, v19
    v_lshl_or_b32 v20, v26, 16, v20
    s_waitcnt lgkmcnt(4)
    v_add3_u32 v40, v40, v34, s60
    ds_write_b32 v40, v16
    s_waitcnt lgkmcnt(4)
    v_add3_u32 v41, v41, v35, s60
    ds_write_b32 v41, v17
    s_waitcnt lgkmcnt(4)
    v_add3_u32 v42, v42, v36, s60
    ds_write_b32 v42, v18
    s_waitcnt lgkmcnt(4)
    v_add3_u32 v43, v43, v37, s60
    ds_write_b32 v43, v19
    s_mov_b64 exec, s[66:67]
    s_waitcnt lgkmcnt(4)
    v_add3_u32 v44, v44, v38, s60
    ds_write_b32 v44, v20
    s_mov_b64 exec, -1
    v_lshrrev_b32 v64, 2, v64
    v_or_b32 v64, s40, v64
    v_lshrrev_b32 v65, 2, v65
    v_or_b32 v65, s40, v65
    v_lshrrev_b32 v66, 2, v66
    v_or_b32 v66, s40, v66
    v_lshrrev_b32 v67, 2, v67
    v_or_b32 v67, s40, v67
    s_waitcnt lgkmcnt(0)
    s_barrier
    ds_read_b128 v[12:15], v59
    ds_read_b128 v[68:71], v59 offset:8192
    s_add_u32 s60, s58, 8192
    s_cmp_ge_u32 s4, 2
    s_waitcnt lgkmcnt(1)
    buffer_store_dwordx4 v[12:15], v5, s[16:19], s58 offen sc1
    s_cbranch_scc1 L_cp1
    s_waitcnt lgkmcnt(0)
    buffer_store_dwordx4 v[68:71], v5, s[16:19], s60 offen sc1
L_cp1:
    s_waitcnt vmcnt(0)
    s_mov_b64 exec, 1
    ds_add_u32 v3, v62 offset:56
    s_mov_b64 exec, -1
    s_cmp_eq_u32 s4, 0
    s_cbranch_scc0 L_preB
    s_lshl_b32 s61, s2, 10
    s_add_u32 s61, s61, 1114112
    s_or_b32 s60, s40, 1
    v_mov_b32 v8, s60
    s_mov_b32 s59, 0
Lw_1:
    ds_read_b32 v4, v3 offset:56
    s_waitcnt lgkmcnt(0)
    v_cmp_gt_u32 vcc, 8, v4
    s_cbranch_vccz Lk_2
    s_add_u32 s59, s59, 1
    s_cmp_lt_u32 s59, 4194304
    s_cbranch_scc1 Lw_1
    s_branch L_end
Lk_2:
    buffer_store_dwordx4 v[64:67], v5, s[16:19], s61 offen sc1
    ds_write_b32 v3, v8 offset:32
    s_branch L_preB
L_notprod:
    s_cmp_eq_u32 s63, 0
    s_cbranch_scc1 L_preB
    s_cmp_eq_u32 s63, 3
    s_cbranch_scc1 L_taskw
    s_cmp_eq_u32 s63, 4
    s_cbranch_scc1 L_wtask
    s_cmp_eq_u32 s63, 5
    s_cbranch_scc1 L_flag
    v_and_b32 v4, 7, v0
    v_mul_u32_u24 v1, 1056, v4
    v_and_b32 v4, 8, v0
    v_lshl_add_u32 v1, v4, 6, v1
    v_and_b32 v4, 48, v0
    v_add_u32 v1, v4, v1
    v_add_u32 v5, 105600, v1
    s_lshr_b32 s58, s62, 4
    s_lshl_b32 s58, s58, 3
    s_and_b32 s59, s62, 7
    s_add_u32 s58, s58, s59
    s_lshl_b32 s58, s58, 1
    s_bfe_u32 s59, s62, 0x10003
    s_add_u32 s58, s58, s59
    s_lshl_b32 s58, s58, 10
    s_add_u32 s58, s58, 655360
    v_lshlrev_b32 v6, 4, v0
    s_waitcnt vmcnt(0)
    s_mov_b32 s59, 0
Lw_3:
    ds_read_b32 v4, v3 offset:56
    s_waitcnt lgkmcnt(0)
    v_cmp_gt_u32 vcc, 2, v4
    s_cbranch_vccz Lk_4
    s_add_u32 s59, s59, 1
    s_cmp_lt_u32 s59, 4194304
    s_cbranch_scc1 Lw_3
    s_branch L_end
Lk_4:
    ds_read_b128 v[16:19], v5 offset:0
    ds_read_b128 v[20:23], v5 offset:8448
    ds_read_b128 v[24:27], v5 offset:16896
    ds_read_b128 v[28:31], v5 offset:64
    ds_read_b128 v[32:35], v5 offset:8512
    ds_read_b128 v[36:39], v5 offset:16960
    ds_read_b128 v[40:43], v5 offset:128
    ds_read_b128 v[44:47], v5 offset:8576
    ds_read_b128 v[48:51], v5 offset:17024
    ds_read_b128 v[64:67], v5 offset:192
    ds_read_b128 v[68:71], v5 offset:8640
    ds_read_b128 v[72:75], v5 offset:17088
    s_waitcnt lgkmcnt(9)
    ds_read_b128 v[76:79], v5 offset:256
    ds_read_b128 v[80:83], v5 offset:8704
    ds_read_b128 v[84:87], v5 offset:17152
    v_mfma_f32_16x16x32_bf16 v[8:11], v[16:19], v[24:27], 0
    v_mfma_f32_16x16x32_bf16 v[12:15], v[20:23], v[24:27], 0
    s_waitcnt lgkmcnt(9)
    ds_read_b128 v[88:91], v5 offset:320
    ds_read_b128 v[92:95], v5 offset:8768
    ds_read_b128 v[96:99], v5 offset:17216
    v_mfma_f32_16x16x32_bf16 v[8:11], v[28:31], v[36:39], v[8:11]
    v_mfma_f32_16x16x32_bf16 v[12:15], v[32:35], v[36:39], v[12:15]
    s_waitcnt lgkmcnt(9)
    ds_read_b128 v[100:103], v5 offset:384
    ds_read_b128 v[104:107], v5 offset:8832
    ds_read_b128 v[108:111], v5 offset:17280
    v_mfma_f32_16x16x32_bf16 v[8:11], v[40:43], v[48:51], v[8:11]
    v_mfma_f32_16x16x32_bf16 v[12:15], v[44:47], v[48:51], v[12:15]
    s_waitcnt lgkmcnt(9)
    ds_read_b128 v[112:115], v5 offset:448
    ds_read_b128 v[116:119], v5 offset:8896
    ds_read_b128 v[120:123], v5 offset:17344
    v_mfma_f32_16x16x32_bf16 v[8:11], v[64:67], v[72:75], v[8:11]
    v_mfma_f32_16x16x32_bf16 v[12:15], v[68:71], v[72:75], v[12:15]
    s_waitcnt lgkmcnt(9)
    v_mfma_f32_16x16x32_bf16 v[8:11], v[76:79], v[84:87], v[8:11]
    v_mfma_f32_16x16x32_bf16 v[12:15], v[80:83], v[84:87], v[12:15]
    s_waitcnt lgkmcnt(6)
    v_mfma_f32_16x16x32_bf16 v[8:11], v[88:91], v[96:99], v[8:11]
    v_mfma_f32_16x16x32_bf16 v[12:15], v[92:95], v[96:99], v[12:15]
    s_waitcnt lgkmcnt(3)
    v_mfma_f32_16x16x32_bf16 v[8:11], v[100:103], v[108:111], v[8:11]
    v_mfma_f32_16x16x32_bf16 v[12:15], v[104:107], v[108:111], v[12:15]
    s_waitcnt lgkmcnt(0)
    v_mfma_f32_16x16x32_bf16 v[8:11], v[112:115], v[120:123], v[8:11]
    v_mfma_f32_16x16x32_bf16 v[12:15], v[116:119], v[120:123], v[12:15]
    s_nop 6
    v_cvt_pk_bf16_f32 v16, v8, v9
    v_cvt_pk_bf16_f32 v17, v10, v11
    v_cvt_pk_bf16_f32 v18, v12, v13
    v_cvt_pk_bf16_f32 v19, v14, v15
    buffer_store_dwordx4 v[16:19], v6, s[16:19], s58 offen sc1
    s_branch L_taskw
L_wtask:
    s_lshl_b32 s58, s62, 11
    s_add_u32 s58, s58, 786432
    v_lshlrev_b32 v6, 4, v0
    s_mov_b32 s70, 0x05040100
    s_mov_b32 s71, 0x07060302
    s_waitcnt vmcnt(0)
    v_perm_b32 v64, v17, v16, s70
    v_perm_b32 v68, v17, v16, s71
    v_perm_b32 v65, v19, v18, s70
    v_perm_b32 v69, v19, v18, s71
    v_perm_b32 v66, v21, v20, s70
    v_perm_b32 v70, v21, v20, s71
    v_perm_b32 v67, v23, v22, s70
    v_perm_b32 v71, v23, v22, s71
    buffer_store_dwordx4 v[64:67], v6, s[16:19], s58 offen sc1
    buffer_store_dwordx4 v[68:71], v6, s[16:19], s58 offen offset:1024 sc1
L_taskw:
    s_waitcnt vmcnt(0)
    s_mov_b64 exec, 1
    ds_add_u32 v3, v62 offset:56
    s_mov_b64 exec, -1
    s_branch L_preB
L_flag:
    s_waitcnt vmcnt(0) lgkmcnt(0)
    s_add_u32 s40, s40, 0x9e377000
    s_and_b32 s40, s40, 4294963200
    s_mul_i32 s61, s2, 16
    s_add_u32 s61, s61, 1178624
    s_or_b32 s60, s40, 1
    v_mov_b32 v8, s60
    v_mov_b32 v10, s40
    v_mov_b32 v11, s40
    v_lshlrev_b32 v9, 15, v0
    s_mov_b32 s59, 0
Lw_5:
    ds_read_b32 v4, v3 offset:56
    s_waitcnt lgkmcnt(0)
    v_cmp_gt_u32 vcc, 3, v4
    s_cbranch_vccz Lk_6
    s_add_u32 s59, s59, 1
    s_cmp_lt_u32 s59, 4194304
    s_cbranch_scc1 Lw_5
    s_branch L_end
Lk_6:
    s_mov_b64 exec, 255
    buffer_store_dwordx2 v[10:11], v9, s[16:19], s61 offen sc1
    ds_write_b32 v3, v8 offset:32
    s_mov_b64 exec, -1
L_preB:
    s_setprio 3
    s_mov_b64 s[28:29], s[42:43]
    s_mov_b32 s30, 20000
    s_setprio 3
    s_lshl_b32 s58, s4, 10
    v_lshlrev_b32 v5, 4, v0
    s_add_u32 m0, s58, 130944
    s_add_u32 s59, s58, 0
    buffer_load_dwordx4 v5, s[28:31], s59 offen lds
    s_add_u32 m0, s58, 139136
    s_add_u32 s59, s58, 8192
    buffer_load_dwordx4 v5, s[28:31], s59 offen lds
    s_cmp_lt_u32 s4, 4
    s_cbranch_scc1 L_disd
    s_add_u32 m0, s58, 143232
    s_add_u32 s59, s58, 12288
    buffer_load_dwordx4 v5, s[28:31], s59 offen lds
L_disd:
    s_setprio 3
    v_and_b32 v4, 3, v0
    v_mov_b32 v5, 0x0c0c0c0c
    v_mov_b32 v6, 0x0c0c0302
    v_mov_b32 v7, 0x03020c0c
    v_cmp_eq_u32 s[58:59], 0, v4
    v_cmp_eq_u32 s[60:61], 2, v4
    v_cmp_eq_u32 vcc, 1, v4
    v_cndmask_b32 v10, v5, v6, s[58:59]
    v_cndmask_b32 v11, v5, v6, s[60:61]
    v_cndmask_b32 v10, v10, v7, vcc
    v_cmp_eq_u32 vcc, 3, v4
    s_nop 1
    v_cndmask_b32 v11, v11, v7, vcc
    v_and_b32 v10, 0xfdfdfdfd, v10
    v_and_b32 v11, 0xfdfdfdfd, v11
    s_movk_i32 s7, 512
    s_lshl_b32 s58, s4, 3
    v_lshrrev_b32 v5, 3, v0
    v_and_b32 v6, 7, v0
    v_add_u32 v7, s58, v5
    v_mul_u32_u24 v49, 10240, v7
    v_lshl_add_u32 v49, v6, 4, v49
    v_lshlrev_b32 v56, 2, v6
    s_lshl_b32 s60, s6, 2
    s_add_u32 s60, s60, 1114112
    v_lshl_add_u32 v54, v7, 10, s60
    v_mad_u32_u24 v7, v7, 3, v6
    v_cmp_ge_u32 vcc, 186, v7
    v_cmp_gt_u32 s[64:65], 4, v6
    v_mul_u32_u24 v7, 16, v7
    s_and_b64 s[64:65], s[64:65], vcc
    v_cmp_eq_u32 vcc, 0, v6
    s_and_b32 s58, s2, 7
    s_lshl_b32 s58, s58, 15
    s_add_u32 s58, s58, 1179632
    v_add_u32 v7, s58, v7
    s_or_b64 s[64:65], s[64:65], vcc
    v_cndmask_b32 v54, v7, v54, vcc
    v_cmp_gt_u32 s[62:63], 5, v6
    v_lshl_add_u32 v50, v6, 3, v5
    v_mul_u32_u24 v55, 72, v5
    v_add_u32 v55, 72, v55
    v_lshrrev_b32 v5, 4, v50
    v_mul_u32_u24 v9, 8448, v5
    v_lshl_add_u32 v9, v5, 26, v9
    v_cmp_le_u32 vcc, 32, v50
    v_and_b32 v5, 7, v50
    v_and_b32 v6, 3, v50
    v_cndmask_b32 v5, v5, v6, vcc
    v_mul_u32_u24 v5, 1056, v5
    v_bfe_u32 v6, v50, 3, 1
    v_bfe_u32 v7, v50, 2, 1
    v_cndmask_b32 v6, v6, v7, vcc
    v_lshl_add_u32 v5, v6, 9, v5
    v_mov_b32 v52, 130944
    v_add3_u32 v9, v9, v5, v52
    v_lshrrev_b32 v5, 5, v0
    v_lshl_add_u32 v15, v5, 3, v2
    s_lshl_b32 s58, s5, 2
    s_sub_u32 s58, 158976, s58
    v_mov_b32 v53, s58
    v_add_u32 v5, s5, v50
    v_lshl_add_u32 v8, v5, 1, v52
    v_lshlrev_b32 v50, 2, v50
    v_add_u32 v50, 158976, v50
    v_mov_b32 v57, 156672
    v_mov_b32 v60, 152064
    v_mov_b64 v[16:17], 0
    v_mov_b64 v[18:19], 0
    s_mov_b32 s59, 0
Lw_7:
    ds_read_b32 v4, v3 offset:60
    s_waitcnt lgkmcnt(0)
    v_cmp_gt_u32 vcc, 8, v4
    s_cbranch_vccz Lk_8
    s_sleep 2
    s_add_u32 s59, s59, 1
    s_cmp_lt_u32 s59, 4194304
    s_cbranch_scc1 Lw_7
    s_branch L_end
Lk_8:
    s_mov_b32 s59, 0
Lw_9:
    ds_read_b32 v4, v3 offset:32
    s_waitcnt lgkmcnt(0)
    v_cmp_gt_u32 vcc, 1, v4
    s_cbranch_vccz Lk_10
    s_sleep 1
    s_add_u32 s59, s59, 1
    s_cmp_lt_u32 s59, 4194304
    s_cbranch_scc1 Lw_9
    s_branch L_end
Lk_10:
    v_readfirstlane_b32 s40, v4
    s_mov_b32 s59, 0
    s_bitset0_b32 s40, 0
    s_and_b32 exec_lo, s64, 0xfefefefe
    s_and_b32 exec_hi, s65, 0xfefefefe
L_spolla:
    buffer_load_dwordx2 v[58:59], v54, s[16:19], 0 offen sc1
    s_add_u32 s59, s59, 1
    s_cmp_gt_u32 s59, 0x40000
    s_cbranch_scc1 L_end
    s_waitcnt vmcnt(0)
    v_xor_b32 v58, s40, v58
    v_xor_b32 v59, s40, v59
    v_or_b32 v5, v58, v59
    v_cmpx_lt_u32 vcc, 4095, v5
    s_cbranch_execz L_soka
    s_sleep 8
    s_branch L_spolla
L_soka:
    s_mov_b64 exec, -1
    s_mov_b64 exec, 1
    ds_add_u32 v3, v62 offset:52
    s_mov_b64 exec, -1
    s_mov_b32 exec_lo, 0x01010101
    s_mov_b32 exec_hi, 0x01010101
L_spollb:
    buffer_load_dwordx2 v[58:59], v54, s[16:19], 0 offen sc1
    s_add_u32 s59, s59, 1
    s_cmp_gt_u32 s59, 0x40000
    s_cbranch_scc1 L_end
    s_waitcnt vmcnt(0)
    v_xor_b32 v58, s40, v58
    v_xor_b32 v59, s40, v59
    v_or_b32 v5, v58, v59
    v_cmpx_lt_u32 vcc, 4095, v5
    s_cbranch_execz L_sokb
    s_sleep 8
    s_branch L_spollb
L_sokb:
    s_mov_b64 exec, -1
    v_sub_u32 v48, v59, v58
    v_lshl_or_b32 v48, v48, 16, v58
    s_nop 1
    v_mov_b32_dpp v48, v48 quad_perm:[0,0,0,0] row_mask:0xf bank_mask:0xf
    s_nop 1
    v_mov_b32_dpp v48, v48 row_shr:4 row_mask:0xf bank_mask:0xa
    v_mad_u32_u16 v49, v48, 4, v49
    v_lshrrev_b32 v48, 16, v48
    v_sub_u32 v48, v48, v56
    v_cmpx_lt_i32 vcc, 0, v48
    s_cbranch_execz L_entld
    buffer_load_dwordx4 v[16:19], v49, s[16:19], 0 offen sc1
    v_cmpx_lt_i32 vcc, 32, v48
    ds_write_b32 v3, v62 offset:28
L_entld:
    s_mov_b64 exec, -1
    s_waitcnt vmcnt(0)
    v_cmpx_lt_i32 vcc, 0, v48
    v_mad_u32_u16 v24, v16, 4, v53 op_sel:[1,0,0,0]
    ds_add_rtn_u32 v32, v24, v62
    v_cmpx_lt_i32 vcc, 1, v48
    v_mad_u32_u16 v25, v17, 4, v53 op_sel:[1,0,0,0]
    ds_add_rtn_u32 v33, v25, v62
    v_cmpx_lt_i32 vcc, 2, v48
    v_mad_u32_u16 v26, v18, 4, v53 op_sel:[1,0,0,0]
    ds_add_rtn_u32 v34, v26, v62
    v_cmpx_lt_i32 vcc, 3, v48
    v_mad_u32_u16 v27, v19, 4, v53 op_sel:[1,0,0,0]
    ds_add_rtn_u32 v35, v27, v62
    s_mov_b64 exec, -1
    s_mov_b64 exec, 1
    ds_add_u32 v3, v62 offset:12
    s_mov_b64 exec, -1
    v_mad_u32_u16 v40, v16, 2, v52
    v_mad_u32_u16 v16, v16, s7, 0
    v_mad_u32_u16 v41, v17, 2, v52
    v_mad_u32_u16 v17, v17, s7, 0
    v_mad_u32_u16 v42, v18, 2, v52
    v_mad_u32_u16 v18, v18, s7, 0
    v_mad_u32_u16 v43, v19, 2, v52
    v_mad_u32_u16 v19, v19, s7, 0
    s_mov_b32 s59, 0
Lw_11:
    ds_read_b32 v4, v3 offset:12
    s_waitcnt lgkmcnt(0)
    v_cmp_gt_u32 vcc, 8, v4
    s_cbranch_vccz Lk_12
    s_add_u32 s59, s59, 1
    s_cmp_lt_u32 s59, 4194304
    s_cbranch_scc1 Lw_11
    s_branch L_end
Lk_12:
    ds_read_b32 v12, v50
    ds_read_b32 v5, v3 offset:28
    ds_read_u16 v8, v8
    ds_read_u16 v40, v40
    ds_read_u16 v41, v41
    ds_read_u16 v42, v42
    ds_read_u16 v43, v43
    s_lshl_b32 s58, s2, 4
    s_add_u32 s58, s58, s3
    s_cmp_eq_u32 s58, 15
    s_cbranch_scc0 L_noep
    v_mov_b32 v6, s40
    v_mov_b32 v7, 1048576
    s_mov_b64 exec, 1
    buffer_store_dword v6, v7, s[16:19], 0 offen sc1
    s_mov_b64 exec, -1
L_noep:
    s_waitcnt lgkmcnt(6)
    v_add_u32 v12, 1, v12
    v_lshrrev_b32 v12, 1, v12
    v_max_u32 v12, 1, v12
    v_cndmask_b32 v12, 0, v12, s[62:63]
    s_lshl_b32 s67, s4, 3
    s_movk_i32 s58, 2304
    v_add_u32_dpp v51, v12, v12 row_shl:1 row_mask:0xf bank_mask:0xf bound_ctrl:1
    s_nop 1
    v_add_u32_dpp v51, v51, v51 row_shl:2 row_mask:0xf bank_mask:0xf bound_ctrl:1
    s_nop 1
    v_add_u32_dpp v51, v12, v51 row_shl:4 row_mask:0xf bank_mask:0x5 bound_ctrl:1
    s_waitcnt lgkmcnt(0)
    v_lshlrev_b32 v8, 16, v8
    v_lshl_add_u32 v5, v5, 10, v51
    v_sub_u32 v6, v55, v51
    v_cmp_le_u32 vcc, 72, v5
    v_lshlrev_b32 v6, 1, v6
    v_subrev_u32 v12, 1, v12
    s_cbranch_vccnz L_slow
    v_and_b32 v12, 0xff, v12
    v_lshl_add_u32 v9, v12, 18, v9
    s_mov_b64 exec, s[62:63]
    ds_write_b32 v50, v6 offset:160
    s_mov_b64 exec, -1
    s_sub_u32 s63, s67, 1
    v_readlane_b32 s67, v51, s67
    v_cmpx_lt_i32 vcc, 0, v48
    ds_read_b32 v24, v24 offset:160
    v_cmpx_lt_i32 vcc, 1, v48
    ds_read_b32 v25, v25 offset:160
    v_cmpx_lt_i32 vcc, 2, v48
    ds_read_b32 v26, v26 offset:160
    v_cmpx_lt_i32 vcc, 3, v48
    ds_read_b32 v27, v27 offset:160
    s_mov_b64 exec, -1
    s_lshr_b32 s66, s67, 3
    s_add_u32 s60, s66, 1
    s_lshl_b32 s60, s60, 3
    s_sub_u32 s67, s60, s67
    s_sub_u32 s62, s67, 1
    s_add_u32 s61, s4, 1
    s_mul_i32 s61, s61, 72
    s_sub_u32 s60, s61, s60
    s_lshl_b32 s60, s60, 2
    s_waitcnt lgkmcnt(0)
    v_cmpx_lt_i32 vcc, 0, v48
    v_add_u32 v24, v24, v32
    v_lshl_add_u32 v5, v24, 1, v57
    ds_write_b16 v5, v40
    v_lshrrev_b32 v6, 1, v24
    v_lshl_add_u32 v6, v6, 2, v60
    v_and_b32 v7, 1, v24
    v_mad_u32_u24 v6, v7, s58, v6
    ds_write_b32 v6, v16
    v_cmpx_lt_i32 vcc, 1, v48
    v_add_u32 v25, v25, v33
    v_lshl_add_u32 v5, v25, 1, v57
    ds_write_b16 v5, v41
    v_lshrrev_b32 v6, 1, v25
    v_lshl_add_u32 v6, v6, 2, v60
    v_and_b32 v7, 1, v25
    v_mad_u32_u24 v6, v7, s58, v6
    ds_write_b32 v6, v17
    v_cmpx_lt_i32 vcc, 2, v48
    v_add_u32 v26, v26, v34
    v_lshl_add_u32 v5, v26, 1, v57
    ds_write_b16 v5, v42
    v_lshrrev_b32 v6, 1, v26
    v_lshl_add_u32 v6, v6, 2, v60
    v_and_b32 v7, 1, v26
    v_mad_u32_u24 v6, v7, s58, v6
    ds_write_b32 v6, v18
    v_cmpx_lt_i32 vcc, 3, v48
    v_add_u32 v27, v27, v35
    v_lshl_add_u32 v5, v27, 1, v57
    ds_write_b16 v5, v43
    v_lshrrev_b32 v6, 1, v27
    v_lshl_add_u32 v6, v6, 2, v60
    v_and_b32 v7, 1, v27
    v_mad_u32_u24 v6, v7, s58, v6
    ds_write_b32 v6, v19
    s_mov_b64 exec, -1
    s_mov_b64 exec, 1
    ds_add_u32 v3, v62 offset:16
    s_mov_b64 exec, -1
    v_lshrrev_b32 v5, 5, v0
    v_mad_u32_u24 v13, v5, s58, v60
    v_add_u32 v13, s60, v13
    v_lshl_add_u32 v14, v5, 1, v57
    v_and_b32 v5, 28, v0
    v_add3_u32 v14, v14, v5, s60
    s_mov_b32 s65, 201486528
    s_mov_b32 s64, 0
    s_mov_b32 s59, 0
Lw_13:
    ds_read_b32 v4, v3 offset:16
    s_waitcnt lgkmcnt(0)
    v_cmp_gt_u32 vcc, 8, v4
    s_cbranch_vccz Lk_14
    s_add_u32 s59, s59, 1
    s_cmp_lt_u32 s59, 4194304
    s_cbranch_scc1 Lw_13
    s_branch L_end
Lk_14:
    v_mov_b32 v12, v3
    v_mov_b32 v3, v2
    s_setprio 1
    s_cmp_lt_u32 s4, 4
    s_cbranch_scc1 L_old
    s_setprio 2
L_old:
    ds_read_b128 v[56:59], v13 offset:0
    ds_read_b128 v[60:63], v13 offset:16
    ds_read_u16 v1, v14
    ds_read_b128 v[48:51], v13 offset:32
    ds_read_b128 v[52:55], v13 offset:48
    s_waitcnt lgkmcnt(3)
L_p0:
    s_cmp_ge_u32 s67, 4
    s_cbranch_scc1 L_p4
    s_cmp_gt_u32 s67, 1
    s_cbranch_scc1 Lps_15
    v_add_u32 v57, v57, v2
    buffer_load_dwordx4 v[20:23], v57, s[8:11], 0 offen
Lps_15:
    s_cmp_gt_u32 s67, 2
    s_cbranch_scc1 Lps_16
    v_add_u32 v58, v58, v2
    buffer_load_dwordx4 v[24:27], v58, s[8:11], 0 offen
Lps_16:
    s_cmp_gt_u32 s67, 3
    s_cbranch_scc1 Lps_17
    v_add_u32 v59, v59, v2
    buffer_load_dwordx4 v[28:31], v59, s[8:11], 0 offen
Lps_17:
L_p4:
    s_cmp_gt_u32 s67, 4
    s_cbranch_scc1 Lps_18
    v_add_u32 v60, v60, v2
    buffer_load_dwordx4 v[32:35], v60, s[8:11], 0 offen
Lps_18:
    s_cmp_gt_u32 s67, 5
    s_cbranch_scc1 Lps_19
    v_add_u32 v61, v61, v2
    buffer_load_dwordx4 v[36:39], v61, s[8:11], 0 offen
Lps_19:
    s_cmp_gt_u32 s67, 6
    s_cbranch_scc1 Lps_20
    v_add_u32 v62, v62, v2
    buffer_load_dwordx4 v[40:43], v62, s[8:11], 0 offen
Lps_20:
    s_cmp_gt_u32 s67, 7
    s_cbranch_scc1 Lps_21
    v_add_u32 v63, v63, v2
    buffer_load_dwordx4 v[44:47], v63, s[8:11], 0 offen
Lps_21:
    s_cmp_eq_u32 s66, 0
    s_cbranch_scc1 L_drain
L_gl:
    s_waitcnt lgkmcnt(1)
    v_perm_b32 v6, v1, v1, v10
    v_perm_b32 v7, v1, v1, v11
    ds_read_u16 v1, v14 offset:32
    s_waitcnt vmcnt(6)
    v_lshl_add_u64 v[4:5], v[48:49], 0, v[2:3]
    s_sub_u32 s62, s62, 2
    s_cbranch_scc1 Lfs_0
    v_mfma_f32_4x4x4_16b_bf16 v[56:59], v[6:7], v[16:17], v[56:59] cbsz:3 abid:0
    v_mfma_f32_4x4x4_16b_bf16 v[60:63], v[6:7], v[18:19], v[60:63] cbsz:3 abid:0
    buffer_load_dwordx4 v[16:19], v4, s[8:11], 0 offen
    v_mfma_f32_4x4x4_16b_bf16 v[56:59], v[6:7], v[20:21], v[56:59] cbsz:3 abid:1
    v_mfma_f32_4x4x4_16b_bf16 v[60:63], v[6:7], v[22:23], v[60:63] cbsz:3 abid:1
    buffer_load_dwordx4 v[20:23], v5, s[8:11], 0 offen
Lbs_0:
    s_waitcnt vmcnt(6)
    v_lshl_add_u64 v[4:5], v[50:51], 0, v[2:3]
    s_sub_u32 s62, s62, 2
    s_cbranch_scc1 Lfs_2
    v_mfma_f32_4x4x4_16b_bf16 v[56:59], v[6:7], v[24:25], v[56:59] cbsz:3 abid:2
    v_mfma_f32_4x4x4_16b_bf16 v[60:63], v[6:7], v[26:27], v[60:63] cbsz:3 abid:2
    buffer_load_dwordx4 v[24:27], v4, s[8:11], 0 offen
    v_mfma_f32_4x4x4_16b_bf16 v[56:59], v[6:7], v[28:29], v[56:59] cbsz:3 abid:3
    v_mfma_f32_4x4x4_16b_bf16 v[60:63], v[6:7], v[30:31], v[60:63] cbsz:3 abid:3
    buffer_load_dwordx4 v[28:31], v5, s[8:11], 0 offen
Lbs_2:
    ds_read_b128 v[48:51], v13 offset:64
    s_waitcnt vmcnt(6) lgkmcnt(2)
    v_lshl_add_u64 v[4:5], v[52:53], 0, v[2:3]
    s_sub_u32 s62, s62, 2
    s_cbranch_scc1 Lfs_4
    v_mfma_f32_4x4x4_16b_bf16 v[56:59], v[6:7], v[32:33], v[56:59] cbsz:3 abid:4
    v_mfma_f32_4x4x4_16b_bf16 v[60:63], v[6:7], v[34:35], v[60:63] cbsz:3 abid:4
    buffer_load_dwordx4 v[32:35], v4, s[8:11], 0 offen
    v_mfma_f32_4x4x4_16b_bf16 v[56:59], v[6:7], v[36:37], v[56:59] cbsz:3 abid:5
    v_mfma_f32_4x4x4_16b_bf16 v[60:63], v[6:7], v[38:39], v[60:63] cbsz:3 abid:5
    buffer_load_dwordx4 v[36:39], v5, s[8:11], 0 offen
Lbs_4:
    s_waitcnt vmcnt(6)
    v_lshl_add_u64 v[4:5], v[54:55], 0, v[2:3]
    s_sub_u32 s62, s62, 2
    s_cbranch_scc1 Lfs_6
    v_mfma_f32_4x4x4_16b_bf16 v[56:59], v[6:7], v[40:41], v[56:59] cbsz:3 abid:6
    v_mfma_f32_4x4x4_16b_bf16 v[60:63], v[6:7], v[42:43], v[60:63] cbsz:3 abid:6
    buffer_load_dwordx4 v[40:43], v4, s[8:11], 0 offen
    v_mfma_f32_4x4x4_16b_bf16 v[56:59], v[6:7], v[44:45], v[56:59] cbsz:3 abid:7
    v_mfma_f32_4x4x4_16b_bf16 v[60:63], v[6:7], v[46:47], v[60:63] cbsz:3 abid:7
    buffer_load_dwordx4 v[44:47], v5, s[8:11], 0 offen
Lbs_6:
    ds_read_b128 v[52:55], v13 offset:80
    v_add_u32 v13, 32, v13
    v_add_u32 v14, 32, v14
    s_sub_u32 s66, s66, 1
    s_cmp_eq_u32 s66, 3
    s_cbranch_scc0 L_nf
    s_setprio 1
L_nf:
    s_cmp_lg_u32 s66, 0
    s_cbranch_scc1 L_gl
L_drain:
    s_waitcnt lgkmcnt(0)
    v_perm_b32 v6, v1, v1, v10
    v_perm_b32 v7, v1, v1, v11
    ds_read_u16 v1, v14 offset:32
    s_waitcnt vmcnt(7)
    v_mfma_f32_4x4x4_16b_bf16 v[56:59], v[6:7], v[16:17], v[56:59] cbsz:3 abid:0
    v_mfma_f32_4x4x4_16b_bf16 v[60:63], v[6:7], v[18:19], v[60:63] cbsz:3 abid:0
    s_sub_u32 s62, s62, 1
    s_cbranch_scc1 Lfd_0
Lbd_0:
    s_waitcnt vmcnt(6)
    v_mfma_f32_4x4x4_16b_bf16 v[56:59], v[6:7], v[20:21], v[56:59] cbsz:3 abid:1
    v_mfma_f32_4x4x4_16b_bf16 v[60:63], v[6:7], v[22:23], v[60:63] cbsz:3 abid:1
    s_sub_u32 s62, s62, 1
    s_cbranch_scc1 Lfd_1
Lbd_1:
    s_waitcnt vmcnt(5)
    v_mfma_f32_4x4x4_16b_bf16 v[56:59], v[6:7], v[24:25], v[56:59] cbsz:3 abid:2
    v_mfma_f32_4x4x4_16b_bf16 v[60:63], v[6:7], v[26:27], v[60:63] cbsz:3 abid:2
    s_sub_u32 s62, s62, 1
    s_cbranch_scc1 Lfd_2
Lbd_2:
    s_waitcnt vmcnt(4)
    v_mfma_f32_4x4x4_16b_bf16 v[56:59], v[6:7], v[28:29], v[56:59] cbsz:3 abid:3
    v_mfma_f32_4x4x4_16b_bf16 v[60:63], v[6:7], v[30:31], v[60:63] cbsz:3 abid:3
    s_sub_u32 s62, s62, 1
    s_cbranch_scc1 Lfd_3
Lbd_3:
    s_waitcnt vmcnt(3)
    v_mfma_f32_4x4x4_16b_bf16 v[56:59], v[6:7], v[32:33], v[56:59] cbsz:3 abid:4
    v_mfma_f32_4x4x4_16b_bf16 v[60:63], v[6:7], v[34:35], v[60:63] cbsz:3 abid:4
    s_sub_u32 s62, s62, 1
    s_cbranch_scc1 Lfd_4
Lbd_4:
    s_waitcnt vmcnt(2)
    v_mfma_f32_4x4x4_16b_bf16 v[56:59], v[6:7], v[36:37], v[56:59] cbsz:3 abid:5
    v_mfma_f32_4x4x4_16b_bf16 v[60:63], v[6:7], v[38:39], v[60:63] cbsz:3 abid:5
    s_sub_u32 s62, s62, 1
    s_cbranch_scc1 Lfd_5
Lbd_5:
    s_waitcnt vmcnt(1)
    v_mfma_f32_4x4x4_16b_bf16 v[56:59], v[6:7], v[40:41], v[56:59] cbsz:3 abid:6
    v_mfma_f32_4x4x4_16b_bf16 v[60:63], v[6:7], v[42:43], v[60:63] cbsz:3 abid:6
    s_sub_u32 s62, s62, 1
    s_cbranch_scc1 Lfd_6
Lbd_6:
    s_waitcnt vmcnt(0)
    v_mfma_f32_4x4x4_16b_bf16 v[56:59], v[6:7], v[44:45], v[56:59] cbsz:3 abid:7
    v_mfma_f32_4x4x4_16b_bf16 v[60:63], v[6:7], v[46:47], v[60:63] cbsz:3 abid:7
    s_nop 1
    s_call_b64 s[68:69], L_flush
L_gdone:
    s_endpgm
Lfs_0:
    s_add_u32 s62, s62, 2
    v_mfma_f32_4x4x4_16b_bf16 v[56:59], v[6:7], v[16:17], v[56:59] cbsz:3 abid:0
    v_mfma_f32_4x4x4_16b_bf16 v[60:63], v[6:7], v[18:19], v[60:63] cbsz:3 abid:0
    buffer_load_dwordx4 v[16:19], v4, s[8:11], 0 offen
    s_sub_u32 s62, s62, 1
    s_cbranch_scc0 Lsk_22
    s_call_b64 s[68:69], L_flush
Lsk_22:
    v_mfma_f32_4x4x4_16b_bf16 v[56:59], v[6:7], v[20:21], v[56:59] cbsz:3 abid:1
    v_mfma_f32_4x4x4_16b_bf16 v[60:63], v[6:7], v[22:23], v[60:63] cbsz:3 abid:1
    buffer_load_dwordx4 v[20:23], v5, s[8:11], 0 offen
    s_sub_u32 s62, s62, 1
    s_cbranch_scc0 Lbs_0
    s_call_b64 s[68:69], L_flush
    s_branch Lbs_0
Lfs_2:
    s_add_u32 s62, s62, 2
    v_mfma_f32_4x4x4_16b_bf16 v[56:59], v[6:7], v[24:25], v[56:59] cbsz:3 abid:2
    v_mfma_f32_4x4x4_16b_bf16 v[60:63], v[6:7], v[26:27], v[60:63] cbsz:3 abid:2
    buffer_load_dwordx4 v[24:27], v4, s[8:11], 0 offen
    s_sub_u32 s62, s62, 1
    s_cbranch_scc0 Lsk_24
    s_call_b64 s[68:69], L_flush
Lsk_24:
    v_mfma_f32_4x4x4_16b_bf16 v[56:59], v[6:7], v[28:29], v[56:59] cbsz:3 abid:3
    v_mfma_f32_4x4x4_16b_bf16 v[60:63], v[6:7], v[30:31], v[60:63] cbsz:3 abid:3
    buffer_load_dwordx4 v[28:31], v5, s[8:11], 0 offen
    s_sub_u32 s62, s62, 1
    s_cbranch_scc0 Lbs_2
    s_call_b64 s[68:69], L_flush
    s_branch Lbs_2
Lfs_4:
    s_add_u32 s62, s62, 2
    v_mfma_f32_4x4x4_16b_bf16 v[56:59], v[6:7], v[32:33], v[56:59] cbsz:3 abid:4
    v_mfma_f32_4x4x4_16b_bf16 v[60:63], v[6:7], v[34:35], v[60:63] cbsz:3 abid:4
    buffer_load_dwordx4 v[32:35], v4, s[8:11], 0 offen
    s_sub_u32 s62, s62, 1
    s_cbranch_scc0 Lsk_26
    s_call_b64 s[68:69], L_flush
Lsk_26:
    v_mfma_f32_4x4x4_16b_bf16 v[56:59], v[6:7], v[36:37], v[56:59] cbsz:3 abid:5
    v_mfma_f32_4x4x4_16b_bf16 v[60:63], v[6:7], v[38:39], v[60:63] cbsz:3 abid:5
    buffer_load_dwordx4 v[36:39], v5, s[8:11], 0 offen
    s_sub_u32 s62, s62, 1
    s_cbranch_scc0 Lbs_4
    s_call_b64 s[68:69], L_flush
    s_branch Lbs_4
Lfs_6:
    s_add_u32 s62, s62, 2
    v_mfma_f32_4x4x4_16b_bf16 v[56:59], v[6:7], v[40:41], v[56:59] cbsz:3 abid:6
    v_mfma_f32_4x4x4_16b_bf16 v[60:63], v[6:7], v[42:43], v[60:63] cbsz:3 abid:6
    buffer_load_dwordx4 v[40:43], v4, s[8:11], 0 offen
    s_sub_u32 s62, s62, 1
    s_cbranch_scc0 Lsk_28
    s_call_b64 s[68:69], L_flush
Lsk_28:
    v_mfma_f32_4x4x4_16b_bf16 v[56:59], v[6:7], v[44:45], v[56:59] cbsz:3 abid:7
    v_mfma_f32_4x4x4_16b_bf16 v[60:63], v[6:7], v[46:47], v[60:63] cbsz:3 abid:7
    buffer_load_dwordx4 v[44:47], v5, s[8:11], 0 offen
    s_sub_u32 s62, s62, 1
    s_cbranch_scc0 Lbs_6
    s_call_b64 s[68:69], L_flush
    s_branch Lbs_6
Lfd_0:
    s_call_b64 s[68:69], L_flush
    s_branch Lbd_0
Lfd_1:
    s_call_b64 s[68:69], L_flush
    s_branch Lbd_1
Lfd_2:
    s_call_b64 s[68:69], L_flush
    s_branch Lbd_2
Lfd_3:
    s_call_b64 s[68:69], L_flush
    s_branch Lbd_3
Lfd_4:
    s_call_b64 s[68:69], L_flush
    s_branch Lbd_4
Lfd_5:
    s_call_b64 s[68:69], L_flush
    s_branch Lbd_5
Lfd_6:
    s_call_b64 s[68:69], L_flush
    s_branch Lbd_6
L_flush:
    s_and_b32 s101, s65, 0x3ffff
    s_add_u32 s63, s63, 1
    v_permlane32_swap_b32 v56, v60
    v_permlane32_swap_b32 v57, v61
    v_permlane32_swap_b32 v58, v62
    v_permlane32_swap_b32 v59, v63
    s_lshr_b32 s62, s65, 26
    v_pk_add_f32 v[56:57], v[56:57], v[60:61]
    v_pk_add_f32 v[58:59], v[58:59], v[62:63]
    v_add_u32 v62, s101, v15
    v_pk_mul_f32 v[56:57], v[56:57], s[64:65] op_sel_hi:[1,0]
    v_pk_mul_f32 v[58:59], v[58:59], s[64:65] op_sel_hi:[1,0]
    v_lshl_add_u32 v63, s62, 2, v12
    v_cvt_pk_bf16_f32 v60, v56, v57
    v_cvt_pk_bf16_f32 v61, v58, v59
    ds_write_b64 v62, v[60:61]
    s_mov_b64 exec, 1
    ds_inc_u32 v63, v63 offset:36
    s_mov_b64 exec, -1
    v_readlane_b32 s65, v9, s63
    v_readlane_b32 s64, v8, s63
    v_mov_b64 v[56:57], 0
    v_mov_b64 v[58:59], 0
    v_mov_b64 v[60:61], 0
    v_mov_b64 v[62:63], 0
    s_bfe_u32 s62, s65, 0x80012
    s_setpc_b64 s[68:69]
L_preA:
    s_setprio 2
    s_mul_i32 s5, s6, 40
    v_mov_b32 v3, 159296
    s_mov_b32 s10, 5120000
    s_mov_b32 s11, 0x20000
    s_mov_b64 s[16:17], s[56:57]
    s_mov_b32 s18, 1441792
    s_mov_b32 s19, 0x20000
    v_and_b32 v6, 32, v0
    v_lshl_add_u32 v5, v6, 7, v2
    v_lshl_add_u32 v6, v6, 6, v2
    s_add_u32 s58, s3, s5
    s_mul_i32 s59, s3, 1056
    s_add_u32 m0, s59, 84480
    s_lshl_b32 s58, s58, 9
    buffer_load_dwordx4 v5, s[8:11], s58 offen lds
    s_add_u32 m0, s59, 92928
    s_add_u32 s58, s58, 8192
    s_waitcnt vmcnt(2)
    buffer_load_dwordx4 v5, s[8:11], s58 offen lds
    s_cmp_ge_u32 s3, 4
    s_cbranch_scc1 L_xa2
    s_add_u32 m0, s59, 101376
    s_add_u32 s58, s58, 8192
    s_waitcnt vmcnt(2)
    buffer_load_dwordx4 v6, s[8:11], s58 offen lds
L_xa2:
    v_and_b32 v4, 7, v0
    v_mul_u32_u24 v1, 1056, v4
    v_and_b32 v4, 8, v0
    v_lshl_add_u32 v1, v4, 6, v1
    v_and_b32 v4, 48, v0
    v_add_u32 v1, v4, v1
    v_add_u32 v12, 84480, v1
    s_mov_b64 s[20:21], s[52:53]
    s_mov_b32 s22, 5120000
    s_mov_b32 s23, 0x20000
    v_lshlrev_b32 v14, 4, v0
    s_lshl_b32 s61, s3, 6
    s_add_u32 s61, s61, 105600
    v_add_u32 v13, s61, v1
    s_lshl_b32 s100, s3, 14
    s_add_u32 s100, s100, 655360
    s_waitcnt lgkmcnt(0)
    v_lshl_add_u32 v104, s32, 9, v2
    v_lshl_add_u32 v105, s33, 9, v2
    v_lshl_add_u32 v106, s34, 9, v2
    v_lshl_add_u32 v107, s35, 9, v2
    v_lshl_add_u32 v108, s36, 9, v2
    v_lshl_add_u32 v109, s37, 9, v2
    v_lshl_add_u32 v110, s38, 9, v2
    v_lshl_add_u32 v111, s39, 9, v2
    v_lshl_add_u32 v112, s64, 9, v2
    v_lshl_add_u32 v113, s65, 9, v2
    s_mov_b32 exec_lo, 0
    v_lshl_add_u32 v104, s40, 9, v2
    v_lshl_add_u32 v105, s41, 9, v2
    v_lshl_add_u32 v106, s42, 9, v2
    v_lshl_add_u32 v107, s43, 9, v2
    v_lshl_add_u32 v108, s44, 9, v2
    v_lshl_add_u32 v109, s45, 9, v2
    v_lshl_add_u32 v110, s46, 9, v2
    v_lshl_add_u32 v111, s47, 9, v2
    v_lshl_add_u32 v112, s66, 9, v2
    v_lshl_add_u32 v113, s67, 9, v2
    s_mov_b64 exec, -1
    s_cmp_ge_u32 s2, 64
    s_cbranch_scc1 L_nopb
    s_barrier
    s_barrier
L_nopb:
    s_mul_i32 s67, s3, 2112
    s_mul_i32 s66, s3, 8448
    s_cmp_lt_u32 s2, 64
    s_cbranch_scc1 Lth_30
    s_waitcnt vmcnt(1)
Lth_30:
    s_add_u32 m0, s66, 0
    s_waitcnt vmcnt(2)
    buffer_load_dwordx4 v104, s[8:11], 0 offen lds
    s_cmp_lt_u32 s2, 64
    s_cbranch_scc1 Lth_31
    s_waitcnt vmcnt(1)
Lth_31:
    s_add_u32 m0, s66, 1056
    s_waitcnt vmcnt(2)
    buffer_load_dwordx4 v105, s[8:11], 0 offen lds
    v_and_b32 v4, 3, v0
    v_mov_b32 v5, 0x0c0c0c0c
    v_mov_b32 v6, 0x0c0c0302
    v_mov_b32 v7, 0x03020c0c
    v_cmp_eq_u32 s[58:59], 0, v4
    v_cmp_eq_u32 s[60:61], 2, v4
    v_cmp_eq_u32 vcc, 1, v4
    v_cndmask_b32 v8, v5, v6, s[58:59]
    v_cndmask_b32 v9, v5, v6, s[60:61]
    v_cndmask_b32 v8, v8, v7, vcc
    v_cmp_eq_u32 vcc, 3, v4
    s_nop 1
    v_cndmask_b32 v9, v9, v7, vcc
    v_mov_b32 v10, v8
    v_mov_b32 v11, v9
    v_and_b32 v8, 0xfdfdfdfd, v8
    v_and_b32 v9, 0xfdfdfdfd, v9
    s_cmp_lt_u32 s2, 64
    s_cbranch_scc1 Lth_32
    s_waitcnt vmcnt(1)
Lth_32:
    s_add_u32 m0, s66, 2112
    s_waitcnt vmcnt(2)
    buffer_load_dwordx4 v106, s[8:11], 0 offen lds
    s_cmp_lt_u32 s2, 64
    s_cbranch_scc1 Lth_33
    s_waitcnt vmcnt(1)
Lth_33:
    s_add_u32 m0, s66, 3168
    s_waitcnt vmcnt(2)
    buffer_load_dwordx4 v107, s[8:11], 0 offen lds
    s_mov_b64 exec, 1
    v_mov_b32 v4, 1
    ds_add_u32 v3, v4 offset:0
    s_mov_b64 exec, -1
    s_cmp_lt_u32 s2, 64
    s_cbranch_scc1 Lth_34
    s_waitcnt vmcnt(1)
Lth_34:
    s_add_u32 m0, s66, 4224
    s_waitcnt vmcnt(2)
    buffer_load_dwordx4 v108, s[8:11], 0 offen lds
    s_mov_b32 s59, 0
Lw_35:
    ds_read_b32 v4, v3 offset:0
    s_waitcnt lgkmcnt(0)
    v_cmp_gt_u32 vcc, 8, v4
    s_cbranch_vccz Lk_36
    s_add_u32 s59, s59, 1
    s_cmp_lt_u32 s59, 4194304
    s_cbranch_scc1 Lw_35
    s_branch L_end
Lk_36:
    ds_read_b128 v[80:83], v12 offset:0
    ds_read_b128 v[84:87], v12 offset:8448
    ds_read_b128 v[88:91], v12 offset:16896
    s_cmp_lt_u32 s2, 64
    s_cbranch_scc1 Lth_37
    s_waitcnt vmcnt(1)
Lth_37:
    s_add_u32 m0, s66, 5280
    s_waitcnt vmcnt(2)
    buffer_load_dwordx4 v109, s[8:11], 0 offen lds
    s_mov_b64 exec, 1
    v_mov_b32 v4, 1
    ds_add_u32 v3, v4 offset:60
    s_mov_b64 exec, -1
    s_cmp_lt_u32 s2, 64
    s_cbranch_scc1 Lth_38
    s_waitcnt vmcnt(1)
Lth_38:
    s_waitcnt vmcnt(2)
    ds_read_b32 v4, v3 offset:52
    s_add_u32 m0, s66, 6336
    s_waitcnt vmcnt(2)
    buffer_load_dwordx4 v110, s[8:11], 0 offen lds
    s_mov_b32 s62, 7
    s_waitcnt lgkmcnt(0)
    v_cmp_gt_u32 vcc, 8, v4
    s_cbranch_vccz L_eu10
    s_cmp_lt_u32 s2, 64
    s_cbranch_scc1 Lth_39
    s_waitcnt vmcnt(1)
Lth_39:
    s_waitcnt vmcnt(2)
    ds_read_b32 v4, v3 offset:52
    s_add_u32 m0, s66, 7392
    s_waitcnt vmcnt(2)
    buffer_load_dwordx4 v111, s[8:11], 0 offen lds
    s_mov_b32 s62, 8
    s_waitcnt lgkmcnt(0)
    v_cmp_gt_u32 vcc, 8, v4
    s_cbranch_vccz L_eu10
    s_cmp_lt_u32 s2, 64
    s_cbranch_scc1 Lth_40
    s_waitcnt vmcnt(1)
Lth_40:
    s_waitcnt vmcnt(2)
    ds_read_b32 v4, v3 offset:52
    s_add_u32 m0, s67, 67584
    s_waitcnt vmcnt(2)
    buffer_load_dwordx4 v112, s[8:11], 0 offen lds
    s_mov_b32 s62, 9
    s_waitcnt lgkmcnt(0)
    v_cmp_gt_u32 vcc, 8, v4
    s_cbranch_vccz L_eu10
    s_cmp_lt_u32 s2, 64
    s_cbranch_scc1 Lth_41
    s_waitcnt vmcnt(1)
Lth_41:
    s_waitcnt vmcnt(2)
    ds_read_b32 v4, v3 offset:52
    s_add_u32 m0, s67, 68640
    s_waitcnt vmcnt(2)
    buffer_load_dwordx4 v113, s[8:11], 0 offen lds
    s_mov_b32 s62, 10
    s_mov_b32 s59, 0
Lw_42:
    ds_read_b32 v4, v3 offset:52
    s_waitcnt lgkmcnt(0)
    v_cmp_gt_u32 vcc, 8, v4
    s_cbranch_vccz Lk_43
    s_sleep 1
    s_add_u32 s59, s59, 1
    s_cmp_lt_u32 s59, 4194304
    s_cbranch_scc1 Lw_42
    s_branch L_end
Lk_43:
L_eu10:
    s_setprio 3
    buffer_load_dwordx4 v[16:19], v14, s[16:19], s100 offen offset:0 sc1
    buffer_load_dwordx4 v[20:23], v14, s[16:19], s100 offen offset:1024 sc1
    buffer_load_dwordx4 v[24:27], v14, s[16:19], s100 offen offset:2048 sc1
    buffer_load_dwordx4 v[28:31], v14, s[16:19], s100 offen offset:3072 sc1
    s_add_u32 s100, s100, 4096
    buffer_load_dwordx4 v[32:35], v14, s[16:19], s100 offen offset:0 sc1
    s_cmp_gt_u32 s62, 7
    s_cbranch_scc1 Lem_44
    s_add_u32 m0, s66, 7392
    s_waitcnt vmcnt(63)
    buffer_load_dwordx4 v111, s[8:11], 0 offen lds
Lem_44:
    buffer_load_dwordx4 v[36:39], v14, s[16:19], s100 offen offset:1024 sc1
    buffer_load_dwordx4 v[40:43], v14, s[16:19], s100 offen offset:2048 sc1
    buffer_load_dwordx4 v[44:47], v14, s[16:19], s100 offen offset:3072 sc1
    s_add_u32 s100, s100, 4096
    buffer_load_dwordx4 v[48:51], v14, s[16:19], s100 offen offset:0 sc1
    buffer_load_dwordx4 v[52:55], v14, s[16:19], s100 offen offset:1024 sc1
    s_cmp_gt_u32 s62, 8
    s_cbranch_scc1 Lem_45
    s_add_u32 m0, s67, 67584
    s_waitcnt vmcnt(63)
    buffer_load_dwordx4 v112, s[8:11], 0 offen lds
Lem_45:
    buffer_load_dwordx4 v[56:59], v14, s[16:19], s100 offen offset:2048 sc1
    buffer_load_dwordx4 v[60:63], v14, s[16:19], s100 offen offset:3072 sc1
    s_add_u32 s100, s100, 4096
    buffer_load_dwordx4 v[64:67], v14, s[16:19], s100 offen offset:0 sc1
    buffer_load_dwordx4 v[68:71], v14, s[16:19], s100 offen offset:1024 sc1
    buffer_load_dwordx4 v[72:75], v14, s[16:19], s100 offen offset:2048 sc1
    buffer_load_dwordx4 v[76:79], v14, s[16:19], s100 offen offset:3072 sc1
    s_cmp_gt_u32 s62, 9
    s_cbranch_scc1 Lem_46
    s_add_u32 m0, s67, 68640
    s_waitcnt vmcnt(63)
    buffer_load_dwordx4 v113, s[8:11], 0 offen lds
Lem_46:
    s_setprio 0
    ds_read_b128 v[92:95], v12 offset:64
    ds_read_b128 v[96:99], v12 offset:8512
    ds_read_b128 v[100:103], v12 offset:16960
    s_waitcnt vmcnt(14) lgkmcnt(3)
    v_mfma_f32_16x16x32_bf16 v[104:107], v[16:19], v[80:83], 0
    v_mfma_f32_16x16x32_bf16 v[108:111], v[20:23], v[80:83], 0
    v_mfma_f32_16x16x32_bf16 v[112:115], v[16:19], v[84:87], 0
    v_mfma_f32_16x16x32_bf16 v[116:119], v[20:23], v[84:87], 0
    v_mfma_f32_16x16x32_bf16 v[120:123], v[16:19], v[88:91], 0
    v_mfma_f32_16x16x32_bf16 v[124:127], v[20:23], v[88:91], 0
    ds_read_b128 v[80:83], v12 offset:128
    ds_read_b128 v[84:87], v12 offset:8576
    ds_read_b128 v[88:91], v12 offset:17024
    s_waitcnt vmcnt(12) lgkmcnt(3)
    v_mfma_f32_16x16x32_bf16 v[104:107], v[24:27], v[92:95], v[104:107]
    v_mfma_f32_16x16x32_bf16 v[108:111], v[28:31], v[92:95], v[108:111]
    v_mfma_f32_16x16x32_bf16 v[112:115], v[24:27], v[96:99], v[112:115]
    v_mfma_f32_16x16x32_bf16 v[116:119], v[28:31], v[96:99], v[116:119]
    v_mfma_f32_16x16x32_bf16 v[120:123], v[24:27], v[100:103], v[120:123]
    v_mfma_f32_16x16x32_bf16 v[124:127], v[28:31], v[100:103], v[124:127]
    ds_read_b128 v[92:95], v12 offset:192
    ds_read_b128 v[96:99], v12 offset:8640
    ds_read_b128 v[100:103], v12 offset:17088
    s_waitcnt vmcnt(10) lgkmcnt(3)
    v_mfma_f32_16x16x32_bf16 v[104:107], v[32:35], v[80:83], v[104:107]
    v_mfma_f32_16x16x32_bf16 v[108:111], v[36:39], v[80:83], v[108:111]
    v_mfma_f32_16x16x32_bf16 v[112:115], v[32:35], v[84:87], v[112:115]
    v_mfma_f32_16x16x32_bf16 v[116:119], v[36:39], v[84:87], v[116:119]
    v_mfma_f32_16x16x32_bf16 v[120:123], v[32:35], v[88:91], v[120:123]
    v_mfma_f32_16x16x32_bf16 v[124:127], v[36:39], v[88:91], v[124:127]
    ds_read_b128 v[80:83], v12 offset:256
    ds_read_b128 v[84:87], v12 offset:8704
    ds_read_b128 v[88:91], v12 offset:17152
    s_waitcnt vmcnt(8) lgkmcnt(3)
    v_mfma_f32_16x16x32_bf16 v[104:107], v[40:43], v[92:95], v[104:107]
    v_mfma_f32_16x16x32_bf16 v[108:111], v[44:47], v[92:95], v[108:111]
    v_mfma_f32_16x16x32_bf16 v[112:115], v[40:43], v[96:99], v[112:115]
    v_mfma_f32_16x16x32_bf16 v[116:119], v[44:47], v[96:99], v[116:119]
    v_mfma_f32_16x16x32_bf16 v[120:123], v[40:43], v[100:103], v[120:123]
    v_mfma_f32_16x16x32_bf16 v[124:127], v[44:47], v[100:103], v[124:127]
    ds_read_b128 v[92:95], v12 offset:320
    ds_read_b128 v[96:99], v12 offset:8768
    ds_read_b128 v[100:103], v12 offset:17216
    s_waitcnt vmcnt(6) lgkmcnt(3)
    v_mfma_f32_16x16x32_bf16 v[104:107], v[48:51], v[80:83], v[104:107]
    v_mfma_f32_16x16x32_bf16 v[108:111], v[52:55], v[80:83], v[108:111]
    v_mfma_f32_16x16x32_bf16 v[112:115], v[48:51], v[84:87], v[112:115]
    v_mfma_f32_16x16x32_bf16 v[116:119], v[52:55], v[84:87], v[116:119]
    v_mfma_f32_16x16x32_bf16 v[120:123], v[48:51], v[88:91], v[120:123]
    v_mfma_f32_16x16x32_bf16 v[124:127], v[52:55], v[88:91], v[124:127]
    s_setprio 3
    s_add_u32 s100, s100, 118784
    buffer_load_dwordx4 v[16:19], v14, s[16:19], s100 offen offset:0 sc1
    buffer_load_dwordx4 v[20:23], v14, s[16:19], s100 offen offset:1024 sc1
    buffer_load_dwordx4 v[24:27], v14, s[16:19], s100 offen offset:2048 sc1
    buffer_load_dwordx4 v[28:31], v14, s[16:19], s100 offen offset:3072 sc1
    s_setprio 0
    ds_read_b128 v[80:83], v12 offset:384
    ds_read_b128 v[84:87], v12 offset:8832
    ds_read_b128 v[88:91], v12 offset:17280
    s_waitcnt vmcnt(8) lgkmcnt(3)
    v_mfma_f32_16x16x32_bf16 v[104:107], v[56:59], v[92:95], v[104:107]
    v_mfma_f32_16x16x32_bf16 v[108:111], v[60:63], v[92:95], v[108:111]
    v_mfma_f32_16x16x32_bf16 v[112:115], v[56:59], v[96:99], v[112:115]
    v_mfma_f32_16x16x32_bf16 v[116:119], v[60:63], v[96:99], v[116:119]
    v_mfma_f32_16x16x32_bf16 v[120:123], v[56:59], v[100:103], v[120:123]
    v_mfma_f32_16x16x32_bf16 v[124:127], v[60:63], v[100:103], v[124:127]
    s_setprio 3
    s_add_u32 s100, s100, 4096
    buffer_load_dwordx4 v[32:35], v14, s[16:19], s100 offen offset:0 sc1
    buffer_load_dwordx4 v[36:39], v14, s[16:19], s100 offen offset:1024 sc1
    buffer_load_dwordx4 v[40:43], v14, s[16:19], s100 offen offset:2048 sc1
    buffer_load_dwordx4 v[44:47], v14, s[16:19], s100 offen offset:3072 sc1
    s_setprio 0
    ds_read_b128 v[92:95], v12 offset:448
    ds_read_b128 v[96:99], v12 offset:8896
    ds_read_b128 v[100:103], v12 offset:17344
    s_waitcnt vmcnt(10) lgkmcnt(3)
    v_mfma_f32_16x16x32_bf16 v[104:107], v[64:67], v[80:83], v[104:107]
    v_mfma_f32_16x16x32_bf16 v[108:111], v[68:71], v[80:83], v[108:111]
    v_mfma_f32_16x16x32_bf16 v[112:115], v[64:67], v[84:87], v[112:115]
    v_mfma_f32_16x16x32_bf16 v[116:119], v[68:71], v[84:87], v[116:119]
    v_mfma_f32_16x16x32_bf16 v[120:123], v[64:67], v[88:91], v[120:123]
    v_mfma_f32_16x16x32_bf16 v[124:127], v[68:71], v[88:91], v[124:127]
    s_setprio 3
    s_add_u32 s100, s100, 4096
    buffer_load_dwordx4 v[48:51], v14, s[16:19], s100 offen offset:0 sc1
    buffer_load_dwordx4 v[52:55], v14, s[16:19], s100 offen offset:1024 sc1
    buffer_load_dwordx4 v[56:59], v14, s[16:19], s100 offen offset:2048 sc1
    buffer_load_dwordx4 v[60:63], v14, s[16:19], s100 offen offset:3072 sc1
    s_setprio 0
    s_waitcnt vmcnt(12) lgkmcnt(0)
    v_mfma_f32_16x16x32_bf16 v[104:107], v[72:75], v[92:95], v[104:107]
    v_mfma_f32_16x16x32_bf16 v[108:111], v[76:79], v[92:95], v[108:111]
    v_mfma_f32_16x16x32_bf16 v[112:115], v[72:75], v[96:99], v[112:115]
    v_mfma_f32_16x16x32_bf16 v[116:119], v[76:79], v[96:99], v[116:119]
    v_mfma_f32_16x16x32_bf16 v[120:123], v[72:75], v[100:103], v[120:123]
    v_mfma_f32_16x16x32_bf16 v[124:127], v[76:79], v[100:103], v[124:127]
    s_setprio 3
    s_add_u32 s100, s100, 4096
    buffer_load_dwordx4 v[64:67], v14, s[16:19], s100 offen offset:0 sc1
    buffer_load_dwordx4 v[68:71], v14, s[16:19], s100 offen offset:1024 sc1
    buffer_load_dwordx4 v[72:75], v14, s[16:19], s100 offen offset:2048 sc1
    buffer_load_dwordx4 v[76:79], v14, s[16:19], s100 offen offset:3072 sc1
    s_setprio 0
    s_nop 3
    v_cvt_pk_bf16_f32 v80, v104, v105
    v_cvt_pk_bf16_f32 v81, v106, v107
    v_cvt_pk_bf16_f32 v82, v108, v109
    v_cvt_pk_bf16_f32 v83, v110, v111
    ds_write_b128 v13, v[80:83] offset:0
    v_cvt_pk_bf16_f32 v84, v112, v113
    v_cvt_pk_bf16_f32 v85, v114, v115
    v_cvt_pk_bf16_f32 v86, v116, v117
    v_cvt_pk_bf16_f32 v87, v118, v119
    ds_write_b128 v13, v[84:87] offset:8448
    v_cvt_pk_bf16_f32 v88, v120, v121
    v_cvt_pk_bf16_f32 v89, v122, v123
    v_cvt_pk_bf16_f32 v90, v124, v125
    v_cvt_pk_bf16_f32 v91, v126, v127
    ds_write_b128 v13, v[88:91] offset:16896
    s_mov_b64 exec, 1
    v_mov_b32 v4, 1
    ds_add_u32 v3, v4 offset:20
    s_mov_b64 exec, -1
    s_setprio 3
    s_setprio 0
L_late1:
    s_mov_b32 s63, s3
L_grp:
    s_mul_i32 s58, s63, 8448
    s_lshr_b32 s59, s63, 2
    s_mul_i32 s59, s59, 8448
    s_and_b32 s60, s63, 1
    s_bfe_u32 s61, s63, 0x10001
    s_cmp_ge_u32 s63, 8
    s_cselect_b32 s61, s60, s61
    s_cselect_b32 s60, 0, s60
    s_mul_i32 s60, s60, 4224
    s_lshl_b32 s61, s61, 9
    s_add_u32 s59, s59, s60
    s_add_u32 s59, s59, s61
    s_add_u32 s59, s59, 105600
    v_add_u32 v12, s58, v1
    v_bfe_u32 v4, v0, 2, 2
    v_mul_u32_u24 v4, 1056, v4
    v_and_b32 v5, 48, v0
    v_add3_u32 v13, v4, v5, s59
    v_lshl_add_u32 v14, v0, 3, s58
    v_lshl_add_u32 v2, v0, 3, s59
    s_cmp_ge_u32 s63, 8
    s_cbranch_scc1 L_grp2
    s_mov_b32 s59, 0
Lw_47:
    ds_read_b32 v4, v3 offset:20
    s_waitcnt lgkmcnt(0)
    v_cmp_gt_u32 vcc, 8, v4
    s_cbranch_vccz Lk_48
    s_sleep 1
    s_add_u32 s59, s59, 1
    s_cmp_lt_u32 s59, 4194304
    s_cbranch_scc1 Lw_47
    s_branch L_end
Lk_48:
L_grp2:
    s_waitcnt lgkmcnt(0)
    ds_read_b128 v[80:83], v12 offset:0
    ds_read_b128 v[84:87], v13 offset:0
    ds_read_b128 v[88:91], v12 offset:64
    ds_read_b128 v[92:95], v13 offset:64
    ds_read_b128 v[96:99], v12 offset:128
    ds_read_b128 v[100:103], v13 offset:128
    ds_read_b128 v[104:107], v12 offset:192
    ds_read_b128 v[108:111], v13 offset:192
    ds_read_b128 v[112:115], v12 offset:256
    ds_read_b128 v[116:119], v13 offset:256
    ds_read_b128 v[120:123], v12 offset:320
    ds_read_b128 v[124:127], v13 offset:320
    s_waitcnt lgkmcnt(10)
    v_mfma_f32_16x16x32_bf16 v[4:7], v[80:83], v[84:87], 0
    ds_read_b128 v[80:83], v12 offset:384
    ds_read_b128 v[84:87], v13 offset:384
    s_waitcnt lgkmcnt(10)
    v_mfma_f32_16x16x32_bf16 v[4:7], v[88:91], v[92:95], v[4:7]
    ds_read_b128 v[88:91], v12 offset:448
    ds_read_b128 v[92:95], v13 offset:448
    s_waitcnt lgkmcnt(10)
    v_mfma_f32_16x16x32_bf16 v[4:7], v[96:99], v[100:103], v[4:7]
    s_waitcnt lgkmcnt(8)
    v_mfma_f32_16x16x32_bf16 v[4:7], v[104:107], v[108:111], v[4:7]
    s_waitcnt lgkmcnt(6)
    v_mfma_f32_16x16x32_bf16 v[4:7], v[112:115], v[116:119], v[4:7]
    s_waitcnt lgkmcnt(4)
    v_mfma_f32_16x16x32_bf16 v[4:7], v[120:123], v[124:127], v[4:7]
    s_waitcnt lgkmcnt(2)
    v_mfma_f32_16x16x32_bf16 v[4:7], v[80:83], v[84:87], v[4:7]
    s_waitcnt lgkmcnt(0)
    v_mfma_f32_16x16x32_bf16 v[4:7], v[88:91], v[92:95], v[4:7]
    ds_read_b64 v[96:97], v14 offset:2112
    ds_read_b64 v[98:99], v14 offset:6336
    ds_read_b64 v[100:101], v14 offset:2624
    ds_read_b64 v[102:103], v14 offset:6848
    ds_read_b64 v[104:105], v14 offset:3168
    ds_read_b64 v[106:107], v14 offset:7392
    ds_read_b64 v[108:109], v14 offset:3680
    ds_read_b64 v[110:111], v14 offset:7904
    ds_read_b64 v[80:81], v14 offset:0
    ds_read_b64 v[82:83], v14 offset:4224
    ds_read_b64 v[84:85], v14 offset:512
    ds_read_b64 v[86:87], v14 offset:4736
    ds_read_b64 v[88:89], v14 offset:1056
    ds_read_b64 v[90:91], v14 offset:5280
    ds_read_b64 v[92:93], v14 offset:1568
    s_waitcnt lgkmcnt(14)
    ds_read_b64 v[94:95], v14 offset:5792
    v_mul_f32 v4, 0x3db8aa3b, v4
    v_mul_f32 v5, 0x3db8aa3b, v5
    v_mul_f32 v6, 0x3db8aa3b, v6
    v_mul_f32 v7, 0x3db8aa3b, v7
    v_exp_f32 v4, v4
    v_exp_f32 v5, v5
    v_exp_f32 v6, v6
    v_exp_f32 v7, v7
    v_add_f32 v12, v4, v5
    v_add_f32 v13, v6, v7
    v_add_f32 v12, v12, v13
    v_add_f32 v12, 0x3089705f, v12
    v_rcp_f32 v12, v12
    s_add_u32 s63, s63, 8
    v_mul_f32 v4, v4, v12
    v_mul_f32 v5, v5, v12
    v_mul_f32 v6, v6, v12
    v_mul_f32 v7, v7, v12
    v_cvt_pk_bf16_f32 v4, v4, v5
    v_cvt_pk_bf16_f32 v6, v6, v7
    v_perm_b32 v112, v4, v4, v8
    v_perm_b32 v113, v4, v4, v9
    v_perm_b32 v114, v4, v4, v10
    v_perm_b32 v115, v4, v4, v11
    v_perm_b32 v116, v6, v6, v8
    v_perm_b32 v117, v6, v6, v9
    v_perm_b32 v118, v6, v6, v10
    v_perm_b32 v119, v6, v6, v11
    s_waitcnt lgkmcnt(0)
    v_mfma_f32_4x4x4_16b_bf16 v[120:123], v[112:113], v[80:81], 0 cbsz:4 abid:0
    v_mfma_f32_4x4x4_16b_bf16 v[124:127], v[112:113], v[82:83], 0 cbsz:4 abid:5
    v_mfma_f32_4x4x4_16b_bf16 v[4:7], v[112:113], v[84:85], 0 cbsz:4 abid:10
    v_mfma_f32_4x4x4_16b_bf16 v[12:15], v[112:113], v[86:87], 0 cbsz:4 abid:15
    v_mfma_f32_4x4x4_16b_bf16 v[120:123], v[114:115], v[88:89], v[120:123] cbsz:4 abid:0
    v_mfma_f32_4x4x4_16b_bf16 v[124:127], v[114:115], v[90:91], v[124:127] cbsz:4 abid:5
    v_mfma_f32_4x4x4_16b_bf16 v[4:7], v[114:115], v[92:93], v[4:7] cbsz:4 abid:10
    v_mfma_f32_4x4x4_16b_bf16 v[12:15], v[114:115], v[94:95], v[12:15] cbsz:4 abid:15
    v_mfma_f32_4x4x4_16b_bf16 v[120:123], v[116:117], v[96:97], v[120:123] cbsz:4 abid:0
    v_mfma_f32_4x4x4_16b_bf16 v[124:127], v[116:117], v[98:99], v[124:127] cbsz:4 abid:5
    v_mfma_f32_4x4x4_16b_bf16 v[4:7], v[116:117], v[100:101], v[4:7] cbsz:4 abid:10
    v_mfma_f32_4x4x4_16b_bf16 v[12:15], v[116:117], v[102:103], v[12:15] cbsz:4 abid:15
    v_mfma_f32_4x4x4_16b_bf16 v[120:123], v[118:119], v[104:105], v[120:123] cbsz:4 abid:0
    v_mfma_f32_4x4x4_16b_bf16 v[124:127], v[118:119], v[106:107], v[124:127] cbsz:4 abid:5
    v_mfma_f32_4x4x4_16b_bf16 v[4:7], v[118:119], v[108:109], v[4:7] cbsz:4 abid:10
    v_mfma_f32_4x4x4_16b_bf16 v[12:15], v[118:119], v[110:111], v[12:15] cbsz:4 abid:15
    s_nop 1
    v_cvt_pk_bf16_f32 v112, v120, v121
    v_cvt_pk_bf16_f32 v113, v122, v123
    ds_write_b64 v2, v[112:113] offset:0
    v_cvt_pk_bf16_f32 v114, v124, v125
    v_cvt_pk_bf16_f32 v115, v126, v127
    ds_write_b64 v2, v[114:115] offset:1056
    v_cvt_pk_bf16_f32 v116, v4, v5
    v_cvt_pk_bf16_f32 v117, v6, v7
    ds_write_b64 v2, v[116:117] offset:2112
    v_cvt_pk_bf16_f32 v118, v12, v13
    v_cvt_pk_bf16_f32 v119, v14, v15
    ds_write_b64 v2, v[118:119] offset:3168
    s_cmp_lt_u32 s63, 10
    s_cbranch_scc1 L_grp
L_grpx:
    s_mov_b64 exec, 1
    v_mov_b32 v4, 1
    ds_add_u32 v3, v4 offset:24
    s_mov_b64 exec, -1
    v_add_u32 v12, 105600, v1
    v_lshlrev_b32 v14, 4, v0
    v_and_b32 v6, 15, v0
    v_lshlrev_b32 v6, 2, v6
    v_and_b32 v5, 48, v0
    v_lshl_add_u32 v8, v5, 7, v6
    v_and_b32 v5, 32, v0
    v_lshl_add_u32 v9, v5, 6, v6
    v_and_b32 v5, 16, v0
    v_lshl_add_u32 v9, v5, 22, v9
    s_lshl_b32 s60, s5, 9
    s_lshl_b32 s61, s3, 6
    s_add_u32 s60, s60, s61
    s_mov_b32 s59, 0
Lw_49:
    ds_read_b32 v4, v3 offset:24
    s_waitcnt lgkmcnt(0)
    v_cmp_gt_u32 vcc, 8, v4
    s_cbranch_vccz Lk_50
    s_sleep 1
    s_add_u32 s59, s59, 1
    s_cmp_lt_u32 s59, 4194304
    s_cbranch_scc1 Lw_49
    s_branch L_end
Lk_50:
    ds_read_b128 v[80:83], v12 offset:0
    ds_read_b128 v[84:87], v12 offset:8448
    ds_read_b128 v[88:91], v12 offset:16896
    ds_read_b128 v[92:95], v12 offset:64
    ds_read_b128 v[96:99], v12 offset:8512
    ds_read_b128 v[100:103], v12 offset:16960
    s_waitcnt vmcnt(14) lgkmcnt(3)
    v_mfma_f32_16x16x32_bf16 v[104:107], v[80:83], v[16:19], 0
    v_mfma_f32_16x16x32_bf16 v[108:111], v[80:83], v[20:23], 0
    v_mfma_f32_16x16x32_bf16 v[112:115], v[84:87], v[16:19], 0
    v_mfma_f32_16x16x32_bf16 v[116:119], v[84:87], v[20:23], 0
    v_mfma_f32_16x16x32_bf16 v[120:123], v[88:91], v[16:19], 0
    v_mfma_f32_16x16x32_bf16 v[124:127], v[88:91], v[20:23], 0
    ds_read_b128 v[80:83], v12 offset:128
    ds_read_b128 v[84:87], v12 offset:8576
    ds_read_b128 v[88:91], v12 offset:17024
    s_waitcnt vmcnt(12) lgkmcnt(3)
    v_mfma_f32_16x16x32_bf16 v[104:107], v[92:95], v[24:27], v[104:107]
    v_mfma_f32_16x16x32_bf16 v[108:111], v[92:95], v[28:31], v[108:111]
    v_mfma_f32_16x16x32_bf16 v[112:115], v[96:99], v[24:27], v[112:115]
    v_mfma_f32_16x16x32_bf16 v[116:119], v[96:99], v[28:31], v[116:119]
    v_mfma_f32_16x16x32_bf16 v[120:123], v[100:103], v[24:27], v[120:123]
    v_mfma_f32_16x16x32_bf16 v[124:127], v[100:103], v[28:31], v[124:127]
    ds_read_b128 v[92:95], v12 offset:192
    ds_read_b128 v[96:99], v12 offset:8640
    ds_read_b128 v[100:103], v12 offset:17088
    s_waitcnt vmcnt(10) lgkmcnt(3)
    v_mfma_f32_16x16x32_bf16 v[104:107], v[80:83], v[32:35], v[104:107]
    v_mfma_f32_16x16x32_bf16 v[108:111], v[80:83], v[36:39], v[108:111]
    v_mfma_f32_16x16x32_bf16 v[112:115], v[84:87], v[32:35], v[112:115]
    v_mfma_f32_16x16x32_bf16 v[116:119], v[84:87], v[36:39], v[116:119]
    v_mfma_f32_16x16x32_bf16 v[120:123], v[88:91], v[32:35], v[120:123]
    v_mfma_f32_16x16x32_bf16 v[124:127], v[88:91], v[36:39], v[124:127]
    ds_read_b128 v[80:83], v12 offset:256
    ds_read_b128 v[84:87], v12 offset:8704
    ds_read_b128 v[88:91], v12 offset:17152
    s_waitcnt vmcnt(8) lgkmcnt(3)
    v_mfma_f32_16x16x32_bf16 v[104:107], v[92:95], v[40:43], v[104:107]
    v_mfma_f32_16x16x32_bf16 v[108:111], v[92:95], v[44:47], v[108:111]
    v_mfma_f32_16x16x32_bf16 v[112:115], v[96:99], v[40:43], v[112:115]
    v_mfma_f32_16x16x32_bf16 v[116:119], v[96:99], v[44:47], v[116:119]
    v_mfma_f32_16x16x32_bf16 v[120:123], v[100:103], v[40:43], v[120:123]
    v_mfma_f32_16x16x32_bf16 v[124:127], v[100:103], v[44:47], v[124:127]
    ds_read_b128 v[92:95], v12 offset:320
    ds_read_b128 v[96:99], v12 offset:8768
    ds_read_b128 v[100:103], v12 offset:17216
    s_waitcnt vmcnt(6) lgkmcnt(3)
    v_mfma_f32_16x16x32_bf16 v[104:107], v[80:83], v[48:51], v[104:107]
    v_mfma_f32_16x16x32_bf16 v[108:111], v[80:83], v[52:55], v[108:111]
    v_mfma_f32_16x16x32_bf16 v[112:115], v[84:87], v[48:51], v[112:115]
    v_mfma_f32_16x16x32_bf16 v[116:119], v[84:87], v[52:55], v[116:119]
    v_mfma_f32_16x16x32_bf16 v[120:123], v[88:91], v[48:51], v[120:123]
    v_mfma_f32_16x16x32_bf16 v[124:127], v[88:91], v[52:55], v[124:127]
    s_setprio 3
    s_add_u32 s100, s100, 118784
    buffer_load_dwordx4 v[16:19], v14, s[16:19], s100 offen offset:0 sc1
    buffer_load_dwordx4 v[20:23], v14, s[16:19], s100 offen offset:1024 sc1
    buffer_load_dwordx4 v[24:27], v14, s[16:19], s100 offen offset:2048 sc1
    buffer_load_dwordx4 v[28:31], v14, s[16:19], s100 offen offset:3072 sc1
    s_setprio 0
    ds_read_b128 v[80:83], v12 offset:384
    ds_read_b128 v[84:87], v12 offset:8832
    ds_read_b128 v[88:91], v12 offset:17280
    s_waitcnt vmcnt(8) lgkmcnt(3)
    v_mfma_f32_16x16x32_bf16 v[104:107], v[92:95], v[56:59], v[104:107]
    v_mfma_f32_16x16x32_bf16 v[108:111], v[92:95], v[60:63], v[108:111]
    v_mfma_f32_16x16x32_bf16 v[112:115], v[96:99], v[56:59], v[112:115]
    v_mfma_f32_16x16x32_bf16 v[116:119], v[96:99], v[60:63], v[116:119]
    v_mfma_f32_16x16x32_bf16 v[120:123], v[100:103], v[56:59], v[120:123]
    v_mfma_f32_16x16x32_bf16 v[124:127], v[100:103], v[60:63], v[124:127]
    s_setprio 3
    s_add_u32 s100, s100, 4096
    buffer_load_dwordx4 v[32:35], v14, s[16:19], s100 offen offset:0 sc1
    buffer_load_dwordx4 v[36:39], v14, s[16:19], s100 offen offset:1024 sc1
    buffer_load_dwordx4 v[40:43], v14, s[16:19], s100 offen offset:2048 sc1
    buffer_load_dwordx4 v[44:47], v14, s[16:19], s100 offen offset:3072 sc1
    s_setprio 0
    ds_read_b128 v[92:95], v12 offset:448
    ds_read_b128 v[96:99], v12 offset:8896
    ds_read_b128 v[100:103], v12 offset:17344
    s_waitcnt vmcnt(10) lgkmcnt(3)
    v_mfma_f32_16x16x32_bf16 v[104:107], v[80:83], v[64:67], v[104:107]
    v_mfma_f32_16x16x32_bf16 v[108:111], v[80:83], v[68:71], v[108:111]
    v_mfma_f32_16x16x32_bf16 v[112:115], v[84:87], v[64:67], v[112:115]
    v_mfma_f32_16x16x32_bf16 v[116:119], v[84:87], v[68:71], v[116:119]
    v_mfma_f32_16x16x32_bf16 v[120:123], v[88:91], v[64:67], v[120:123]
    v_mfma_f32_16x16x32_bf16 v[124:127], v[88:91], v[68:71], v[124:127]
    s_setprio 3
    s_add_u32 s100, s100, 4096
    buffer_load_dwordx4 v[48:51], v14, s[16:19], s100 offen offset:0 sc1
    buffer_load_dwordx4 v[52:55], v14, s[16:19], s100 offen offset:1024 sc1
    buffer_load_dwordx4 v[56:59], v14, s[16:19], s100 offen offset:2048 sc1
    buffer_load_dwordx4 v[60:63], v14, s[16:19], s100 offen offset:3072 sc1
    s_setprio 0
    s_waitcnt vmcnt(12) lgkmcnt(0)
    v_mfma_f32_16x16x32_bf16 v[104:107], v[92:95], v[72:75], v[104:107]
    v_mfma_f32_16x16x32_bf16 v[108:111], v[92:95], v[76:79], v[108:111]
    v_mfma_f32_16x16x32_bf16 v[112:115], v[96:99], v[72:75], v[112:115]
    v_mfma_f32_16x16x32_bf16 v[116:119], v[96:99], v[76:79], v[116:119]
    v_mfma_f32_16x16x32_bf16 v[120:123], v[100:103], v[72:75], v[120:123]
    v_mfma_f32_16x16x32_bf16 v[124:127], v[100:103], v[76:79], v[124:127]
    s_setprio 3
    s_add_u32 s100, s100, 4096
    buffer_load_dwordx4 v[64:67], v14, s[16:19], s100 offen offset:0 sc1
    buffer_load_dwordx4 v[68:71], v14, s[16:19], s100 offen offset:1024 sc1
    buffer_load_dwordx4 v[72:75], v14, s[16:19], s100 offen offset:2048 sc1
    buffer_load_dwordx4 v[76:79], v14, s[16:19], s100 offen offset:3072 sc1
    s_setprio 0
    s_setprio 3
    s_setprio 0
    v_add_u32 v12, 130944, v1
    s_mov_b32 s59, 0
Lw_51:
    ds_read_b32 v4, v3 offset:36
    s_waitcnt lgkmcnt(0)
    v_cmp_gt_u32 vcc, 16, v4
    s_cbranch_vccz Lk_52
    s_sleep 3
    s_add_u32 s59, s59, 1
    s_cmp_lt_u32 s59, 16777216
    s_cbranch_scc1 Lw_51
    s_branch L_end
Lk_52:
    ds_read_b128 v[80:83], v12 offset:0
    ds_read_b128 v[84:87], v12 offset:64
    ds_read_b128 v[88:91], v12 offset:128
    ds_read_b128 v[92:95], v12 offset:192
    ds_read_b128 v[96:99], v12 offset:256
    ds_read_b128 v[100:103], v12 offset:320
    s_waitcnt vmcnt(14) lgkmcnt(5)
    v_mfma_f32_16x16x32_bf16 v[104:107], v[80:83], v[16:19], v[104:107]
    v_mfma_f32_16x16x32_bf16 v[108:111], v[80:83], v[20:23], v[108:111]
    ds_read_b128 v[80:83], v12 offset:384
    s_waitcnt vmcnt(12) lgkmcnt(5)
    v_mfma_f32_16x16x32_bf16 v[104:107], v[84:87], v[24:27], v[104:107]
    v_mfma_f32_16x16x32_bf16 v[108:111], v[84:87], v[28:31], v[108:111]
    ds_read_b128 v[84:87], v12 offset:448
    s_waitcnt vmcnt(10) lgkmcnt(5)
    v_mfma_f32_16x16x32_bf16 v[104:107], v[88:91], v[32:35], v[104:107]
    v_mfma_f32_16x16x32_bf16 v[108:111], v[88:91], v[36:39], v[108:111]
    s_waitcnt vmcnt(8) lgkmcnt(4)
    v_mfma_f32_16x16x32_bf16 v[104:107], v[92:95], v[40:43], v[104:107]
    v_mfma_f32_16x16x32_bf16 v[108:111], v[92:95], v[44:47], v[108:111]
    s_waitcnt vmcnt(6) lgkmcnt(3)
    v_mfma_f32_16x16x32_bf16 v[104:107], v[96:99], v[48:51], v[104:107]
    v_mfma_f32_16x16x32_bf16 v[108:111], v[96:99], v[52:55], v[108:111]
    s_waitcnt vmcnt(4) lgkmcnt(2)
    v_mfma_f32_16x16x32_bf16 v[104:107], v[100:103], v[56:59], v[104:107]
    v_mfma_f32_16x16x32_bf16 v[108:111], v[100:103], v[60:63], v[108:111]
    s_waitcnt vmcnt(2) lgkmcnt(1)
    v_mfma_f32_16x16x32_bf16 v[104:107], v[80:83], v[64:67], v[104:107]
    v_mfma_f32_16x16x32_bf16 v[108:111], v[80:83], v[68:71], v[108:111]
    s_waitcnt vmcnt(0) lgkmcnt(0)
    v_mfma_f32_16x16x32_bf16 v[104:107], v[84:87], v[72:75], v[104:107]
    v_mfma_f32_16x16x32_bf16 v[108:111], v[84:87], v[76:79], v[108:111]
    s_nop 7
    v_cvt_pk_bf16_f32 v104, v104, v108
    buffer_store_dword v104, v8, s[20:23], s60 offen offset:0 sc1
    v_cvt_pk_bf16_f32 v105, v105, v109
    buffer_store_dword v105, v8, s[20:23], s60 offen offset:512 sc1
    v_cvt_pk_bf16_f32 v106, v106, v110
    buffer_store_dword v106, v8, s[20:23], s60 offen offset:1024 sc1
    v_cvt_pk_bf16_f32 v107, v107, v111
    buffer_store_dword v107, v8, s[20:23], s60 offen offset:1536 sc1
    s_add_u32 s60, s60, 8192
    s_mov_b32 s59, 0
Lw_53:
    ds_read_b32 v4, v3 offset:40
    s_waitcnt lgkmcnt(0)
    v_cmp_gt_u32 vcc, 16, v4
    s_cbranch_vccz Lk_54
    s_sleep 3
    s_add_u32 s59, s59, 1
    s_cmp_lt_u32 s59, 16777216
    s_cbranch_scc1 Lw_53
    s_branch L_end
Lk_54:
    ds_read_b128 v[80:83], v12 offset:8448
    ds_read_b128 v[84:87], v12 offset:8512
    ds_read_b128 v[88:91], v12 offset:8576
    ds_read_b128 v[92:95], v12 offset:8640
    ds_read_b128 v[96:99], v12 offset:8704
    ds_read_b128 v[100:103], v12 offset:8768
    s_waitcnt lgkmcnt(5)
    v_mfma_f32_16x16x32_bf16 v[112:115], v[80:83], v[16:19], v[112:115]
    v_mfma_f32_16x16x32_bf16 v[116:119], v[80:83], v[20:23], v[116:119]
    ds_read_b128 v[80:83], v12 offset:8832
    s_waitcnt lgkmcnt(5)
    v_mfma_f32_16x16x32_bf16 v[112:115], v[84:87], v[24:27], v[112:115]
    v_mfma_f32_16x16x32_bf16 v[116:119], v[84:87], v[28:31], v[116:119]
    ds_read_b128 v[84:87], v12 offset:8896
    s_waitcnt lgkmcnt(5)
    v_mfma_f32_16x16x32_bf16 v[112:115], v[88:91], v[32:35], v[112:115]
    v_mfma_f32_16x16x32_bf16 v[116:119], v[88:91], v[36:39], v[116:119]
    s_waitcnt lgkmcnt(4)
    v_mfma_f32_16x16x32_bf16 v[112:115], v[92:95], v[40:43], v[112:115]
    v_mfma_f32_16x16x32_bf16 v[116:119], v[92:95], v[44:47], v[116:119]
    s_waitcnt lgkmcnt(3)
    v_mfma_f32_16x16x32_bf16 v[112:115], v[96:99], v[48:51], v[112:115]
    v_mfma_f32_16x16x32_bf16 v[116:119], v[96:99], v[52:55], v[116:119]
    s_waitcnt lgkmcnt(2)
    v_mfma_f32_16x16x32_bf16 v[112:115], v[100:103], v[56:59], v[112:115]
    v_mfma_f32_16x16x32_bf16 v[116:119], v[100:103], v[60:63], v[116:119]
    s_waitcnt lgkmcnt(1)
    v_mfma_f32_16x16x32_bf16 v[112:115], v[80:83], v[64:67], v[112:115]
    v_mfma_f32_16x16x32_bf16 v[116:119], v[80:83], v[68:71], v[116:119]
    s_waitcnt lgkmcnt(0)
    v_mfma_f32_16x16x32_bf16 v[112:115], v[84:87], v[72:75], v[112:115]
    v_mfma_f32_16x16x32_bf16 v[116:119], v[84:87], v[76:79], v[116:119]
    s_nop 7
    v_cvt_pk_bf16_f32 v112, v112, v116
    buffer_store_dword v112, v8, s[20:23], s60 offen offset:0 sc1
    v_cvt_pk_bf16_f32 v113, v113, v117
    buffer_store_dword v113, v8, s[20:23], s60 offen offset:512 sc1
    v_cvt_pk_bf16_f32 v114, v114, v118
    buffer_store_dword v114, v8, s[20:23], s60 offen offset:1024 sc1
    v_cvt_pk_bf16_f32 v115, v115, v119
    buffer_store_dword v115, v8, s[20:23], s60 offen offset:1536 sc1
    s_add_u32 s60, s60, 8192
    s_mov_b32 s59, 0
Lw_55:
    ds_read_b32 v4, v3 offset:44
    s_waitcnt lgkmcnt(0)
    v_cmp_gt_u32 vcc, 8, v4
    s_cbranch_vccz Lk_56
    s_add_u32 s59, s59, 1
    s_cmp_lt_u32 s59, 16777216
    s_cbranch_scc1 Lw_55
    s_branch L_end
Lk_56:
    ds_read_b128 v[80:83], v12 offset:16896
    ds_read_b128 v[84:87], v12 offset:16960
    ds_read_b128 v[88:91], v12 offset:17024
    ds_read_b128 v[92:95], v12 offset:17088
    ds_read_b128 v[96:99], v12 offset:17152
    ds_read_b128 v[100:103], v12 offset:17216
    s_waitcnt lgkmcnt(5)
    v_mfma_f32_16x16x32_bf16 v[120:123], v[80:83], v[16:19], v[120:123]
    v_mfma_f32_16x16x32_bf16 v[124:127], v[80:83], v[20:23], v[124:127]
    ds_read_b128 v[80:83], v12 offset:17280
    s_waitcnt lgkmcnt(5)
    v_mfma_f32_16x16x32_bf16 v[120:123], v[84:87], v[24:27], v[120:123]
    v_mfma_f32_16x16x32_bf16 v[124:127], v[84:87], v[28:31], v[124:127]
    ds_read_b128 v[84:87], v12 offset:17344
    s_waitcnt lgkmcnt(5)
    v_mfma_f32_16x16x32_bf16 v[120:123], v[88:91], v[32:35], v[120:123]
    v_mfma_f32_16x16x32_bf16 v[124:127], v[88:91], v[36:39], v[124:127]
    s_waitcnt lgkmcnt(4)
    v_mfma_f32_16x16x32_bf16 v[120:123], v[92:95], v[40:43], v[120:123]
    v_mfma_f32_16x16x32_bf16 v[124:127], v[92:95], v[44:47], v[124:127]
    s_waitcnt lgkmcnt(3)
    v_mfma_f32_16x16x32_bf16 v[120:123], v[96:99], v[48:51], v[120:123]
    v_mfma_f32_16x16x32_bf16 v[124:127], v[96:99], v[52:55], v[124:127]
    s_waitcnt lgkmcnt(2)
    v_mfma_f32_16x16x32_bf16 v[120:123], v[100:103], v[56:59], v[120:123]
    v_mfma_f32_16x16x32_bf16 v[124:127], v[100:103], v[60:63], v[124:127]
    s_waitcnt lgkmcnt(1)
    v_mfma_f32_16x16x32_bf16 v[120:123], v[80:83], v[64:67], v[120:123]
    v_mfma_f32_16x16x32_bf16 v[124:127], v[80:83], v[68:71], v[124:127]
    s_waitcnt lgkmcnt(0)
    v_mfma_f32_16x16x32_bf16 v[120:123], v[84:87], v[72:75], v[120:123]
    v_mfma_f32_16x16x32_bf16 v[124:127], v[84:87], v[76:79], v[124:127]
    s_nop 7
    v_cvt_pk_bf16_f32 v120, v120, v124
    buffer_store_dword v120, v9, s[20:23], s60 offen offset:0 sc1
    v_cvt_pk_bf16_f32 v121, v121, v125
    buffer_store_dword v121, v9, s[20:23], s60 offen offset:512 sc1
    v_cvt_pk_bf16_f32 v122, v122, v126
    buffer_store_dword v122, v9, s[20:23], s60 offen offset:1024 sc1
    v_cvt_pk_bf16_f32 v123, v123, v127
    buffer_store_dword v123, v9, s[20:23], s60 offen offset:1536 sc1
L_end:
L_exit:
    s_endpgm
L_slow:
    s_setprio 0
    s_mov_b64 exec, 1
    ds_add_u32 v3, v62 offset:16
    s_mov_b64 exec, -1
    s_mov_b32 s59, 0
Lw_57:
    ds_read_b32 v4, v3 offset:16
    s_waitcnt lgkmcnt(0)
    v_cmp_gt_u32 vcc, 8, v4
    s_cbranch_vccz Lk_58
    s_add_u32 s59, s59, 1
    s_cmp_lt_u32 s59, 4194304
    s_cbranch_scc1 Lw_57
    s_branch L_end
Lk_58:
    v_mov_b32 v12, v3
    s_mov_b64 s[24:25], s[34:35]
    s_mov_b32 s26, 640000
    s_mov_b64 s[28:29], s[36:37]
    s_mov_b32 s30, 640000
    s_mov_b64 s[12:13], s[42:43]
    s_mov_b32 s14, 20000
    s_mov_b32 s15, 0x20000
    s_sub_u32 s63, s67, 1
    s_mov_b32 s65, 201486528
    s_mov_b32 s64, 0
    s_call_b64 s[68:69], L_flush
    s_add_u32 s66, s4, s5
    s_add_u32 s67, s66, 40
    v_lshlrev_b32 v16, 2, v0
    v_and_b32 v17, 32, v0
    v_lshl_add_u32 v17, v17, 22, v2
    v_mov_b32 v24, 0
L_sn:
    s_mov_b32 s60, 0
L_sc:
    buffer_load_dword v18, v16, s[28:31], s60 offen
    buffer_load_dword v19, v16, s[24:27], s60 offen
    s_waitcnt vmcnt(0)
    v_cmp_eq_u32 vcc, s66, v18
    s_cbranch_vccz L_sx
L_se:
    s_ff1_i32_b64 s58, vcc
    s_bitset0_b64 vcc, s58
    v_readlane_b32 s59, v19, s58
    s_nop 0
    s_lshl_b32 s61, s59, 9
    s_lshl_b32 s59, s59, 1
    buffer_load_dwordx4 v[20:23], v17, s[8:11], s61 offen
    buffer_load_ushort v1, v24, s[12:15], s59 offen
    s_waitcnt vmcnt(0)
    v_perm_b32 v6, v1, v1, v10
    v_perm_b32 v7, v1, v1, v11
    s_nop 1
    v_mfma_f32_4x4x4_16b_bf16 v[56:59], v[6:7], v[20:21], v[56:59]
    v_mfma_f32_4x4x4_16b_bf16 v[60:63], v[6:7], v[22:23], v[60:63]
    s_cmp_lg_u64 vcc, 0
    s_cbranch_scc1 L_se
L_sx:
    s_add_u32 s60, s60, 256
    s_cmp_lt_u32 s60, 640000
    s_cbranch_scc1 L_sc
    s_call_b64 s[68:69], L_flush
    s_add_u32 s66, s66, 8
    s_cmp_lt_u32 s66, s67
    s_cbranch_scc1 L_sn
    s_branch L_gdone
.section .rodata,"a"
.p2align 6
.amdhsa_kernel standalone__hybrid_graph_tf_exphormer__graph_kernel
  .amdhsa_next_free_vgpr 128
  .amdhsa_next_free_sgpr 102
  .amdhsa_accum_offset 128
  .amdhsa_group_segment_fixed_size 0
  .amdhsa_kernarg_size 104
  .amdhsa_user_sgpr_count 2
  .amdhsa_user_sgpr_kernarg_segment_ptr 1
  .amdhsa_system_sgpr_workgroup_id_x 1
.end_amdhsa_kernel
```

```asm
; @launch grid=(250,1,1) block=(1024,1,1) lds=162752
.amdgcn_target "amdgcn-amd-amdhsa--gfx950"
.text
.globl standalone__hybrid_graph_tf_exphormer__graph_kernel
.p2align 8
.type standalone__hybrid_graph_tf_exphormer__graph_kernel,@function
standalone__hybrid_graph_tf_exphormer__graph_kernel:
    s_cmp_ge_u32 s2, 250
    s_cbranch_scc1 L_exit
    s_load_dwordx16 s[32:47], s[0:1], 0
    s_load_dwordx8 s[48:55], s[0:1], 64
    s_load_dwordx2 s[56:57], s[0:1], 96
    s_getpc_b64 s[60:61]
    s_lshr_b32 s6, s2, 3
    v_lshl_add_u32 v1, v0, 5, s6
    v_cmp_gt_u32 vcc, 92, v1
    v_lshlrev_b32 v1, 7, v1
    s_and_saveexec_b64 s[58:59], vcc
    s_cbranch_execz L_nopf
    global_load_dword v15, v1, s[60:61]
L_nopf:
    s_mov_b64 exec, -1
    v_lshrrev_b32 v1, 6, v0
    v_mov_b32 v8, 33554432
    v_readfirstlane_b32 s3, v1
    v_cmp_gt_u32 vcc, 320, v0
    v_lshlrev_b32 v5, 4, v0
    v_add_u32 v4, 152064, v5
    v_cndmask_b32 v8, 0, v8, vcc
    v_mov_b32 v9, v8
    v_mov_b64 v[10:11], v[8:9]
    v_cmp_gt_u32 vcc, 604, v0
    s_and_saveexec_b64 s[58:59], vcc
    ds_write_b128 v4, v[8:11]
    s_mov_b64 exec, -1
    v_and_b32 v0, 63, v0
    v_and_b32 v2, 31, v0
    v_lshlrev_b32 v2, 4, v2
    s_and_b32 s59, s2, 7
    s_mul_i32 s60, s59, 31
    s_min_u32 s59, s59, 2
    s_add_u32 s6, s6, s60
    s_add_u32 s6, s6, s59
    s_mov_b32 s27, 0x20000
    s_mov_b32 s31, 0x20000
    s_xor_b32 s3, s3, 8
    s_and_b32 s4, s3, 7
    s_cmp_lt_u32 s3, 8
    s_cbranch_scc1 L_e3
    s_setprio 3
    s_cmp_ge_u32 s2, 64
    s_cbranch_scc1 L_e1
    v_lshrrev_b32 v6, 2, v5
    s_mul_i32 s58, s2, 10000
    s_add_u32 s60, s58, 8192
    s_mov_b32 s26, 640000
    s_mov_b32 s30, 640000
    s_mov_b32 s59, 1048576
    s_mov_b32 s63, 1
    s_waitcnt lgkmcnt(0)
    s_mov_b64 s[28:29], s[36:37]
    s_mov_b64 s[24:25], s[34:35]
    buffer_load_dwordx4 v[22:25], v5, s[28:31], s58 offen
    buffer_load_dword v26, v6, s[28:31], s60 offen
    s_setprio 2
    buffer_load_dwordx4 v[16:19], v5, s[24:27], s58 offen
    buffer_load_dword v20, v6, s[24:27], s60 offen
    s_setprio 3
L_ep:
    s_load_dword s40, s[56:57], s59
    s_branch L_bar
L_e1:
    s_mov_b32 s26, 131072
    s_sub_u32 s60, s3, 9
    s_cmp_lt_u32 s60, 3
    s_cbranch_scc1 L_e1b
    s_mov_b32 s63, 0
    s_cmp_eq_u32 s3, 8
    s_cbranch_scc0 L_barw
    s_mov_b32 s63, 5
    s_mov_b32 s59, 1048576
    s_waitcnt lgkmcnt(0)
    s_branch L_ep
L_e1b:
    s_sub_u32 s62, s2, 64
    s_cmp_ge_u32 s62, 128
    s_cbranch_scc1 L_e2
    s_and_b32 s58, s62, 7
    s_lshr_b32 s59, s62, 4
    s_bfe_u32 s61, s62, 0x10003
    s_cmp_eq_u32 s60, 2
    s_cselect_b32 s58, s59, s58
    s_cselect_b32 s61, s61, s60
    s_lshl_b32 s58, s58, 14
    s_lshl_b32 s61, s61, 11
    s_add_u32 s58, s58, s61
    s_add_u32 s59, s58, 4096
    v_and_b32 v4, 32, v0
    v_lshl_add_u32 v4, v4, 8, v2
    s_mul_i32 s61, s60, 8448
    s_add_u32 m0, s61, 105600
    s_cmp_eq_u32 s60, 0
    s_cselect_b32 s63, 2, 3
    s_cmp_eq_u32 s60, 2
    s_waitcnt lgkmcnt(0)
    s_cselect_b64 s[24:25], s[48:49], s[46:47]
    buffer_load_dwordx4 v4, s[24:27], s58 offen offset:0 lds
    s_add_u32 m0, m0, 544
    s_nop 0
    buffer_load_dwordx4 v4, s[24:27], s58 offen offset:512 lds
    s_add_u32 m0, m0, 544
    s_nop 0
    buffer_load_dwordx4 v4, s[24:27], s58 offen offset:1024 lds
    s_add_u32 m0, m0, 544
    s_nop 0
    buffer_load_dwordx4 v4, s[24:27], s58 offen offset:1536 lds
    s_add_u32 m0, m0, 2592
    s_nop 0
    buffer_load_dwordx4 v4, s[24:27], s59 offen offset:0 lds
    s_add_u32 m0, m0, 544
    s_nop 0
    buffer_load_dwordx4 v4, s[24:27], s59 offen offset:512 lds
    s_add_u32 m0, m0, 544
    s_nop 0
    buffer_load_dwordx4 v4, s[24:27], s59 offen offset:1024 lds
    s_add_u32 m0, m0, 544
    s_nop 0
    buffer_load_dwordx4 v4, s[24:27], s59 offen offset:1536 lds
    s_branch L_bar
L_e2:
    s_mul_i32 s60, s60, 58
    s_add_u32 s62, s62, s60
    s_sub_u32 s62, s62, 128
    s_mov_b32 s63, 3
    s_cmp_ge_u32 s62, 96
    s_cbranch_scc1 L_barw
    s_and_b32 s59, s62, 28
    s_add_u32 s59, s59, 4
    s_cmp_ge_u32 s62, 64
    s_cselect_b32 s59, s59, 0
    s_add_u32 s62, s62, s59
    s_mov_b32 s63, 4
    s_and_b32 s59, s62, 7
    s_lshl_b32 s59, s59, 14
    s_bfe_u32 s60, s62, 0x30003
    s_lshl_b32 s60, s60, 6
    s_add_u32 s59, s59, s60
    v_and_b32 v4, 15, v0
    v_lshlrev_b32 v4, 2, v4
    v_and_b32 v5, 48, v0
    v_lshl_add_u32 v4, v5, 8, v4
    s_cmp_lt_u32 s62, 64
    s_waitcnt lgkmcnt(0)
    s_cselect_b64 s[24:25], s[50:51], s[44:45]
    buffer_load_dword v16, v4, s[24:27], s59 offen offset:0
    buffer_load_dword v17, v4, s[24:27], s59 offen offset:512
    buffer_load_dword v18, v4, s[24:27], s59 offen offset:1024
    buffer_load_dword v19, v4, s[24:27], s59 offen offset:1536
    buffer_load_dword v20, v4, s[24:27], s59 offen offset:2048
    buffer_load_dword v21, v4, s[24:27], s59 offen offset:2560
    buffer_load_dword v22, v4, s[24:27], s59 offen offset:3072
    buffer_load_dword v23, v4, s[24:27], s59 offen offset:3584
    s_branch L_bar
L_e3:
    s_mul_i32 s58, s6, 640
    s_lshl_b32 s59, s3, 6
    s_add_u32 s59, s59, s58
    s_lshr_b32 s60, s3, 2
    s_lshl_b32 s60, s60, 6
    s_and_b32 s61, s3, 3
    s_lshl_b32 s61, s61, 3
    s_add_u32 s60, s60, s61
    s_add_u32 s60, s60, s58
    s_add_u32 s60, s60, 512
    s_add_u32 s61, s60, 32
    s_waitcnt lgkmcnt(0)
    s_mov_b64 s[62:63], s[38:39]
    s_mov_b64 s[8:9], s[32:33]
    s_load_dwordx16 s[32:47], s[62:63], s59
    s_load_dwordx2 s[64:65], s[62:63], s60
    s_load_dwordx2 s[66:67], s[62:63], s61
    s_barrier
    s_branch L_preA
L_barw:
    s_waitcnt lgkmcnt(0)
L_bar:
    s_barrier
    s_mov_b64 s[8:9], s[32:33]
    s_mul_i32 s5, s6, 40
    v_mov_b32 v3, 160064
    s_mov_b32 s10, 5120000
    s_mov_b32 s11, 0x20000
    s_mov_b64 s[16:17], s[56:57]
    s_mov_b32 s18, 1441792
    s_mov_b32 s19, 0x20000
    v_mov_b32 v62, 1
    s_cmp_eq_u32 s63, 1
    s_cbranch_scc0 L_notprod
    v_mov_b32 v9, 4
    v_mov_b32 v10, 160704
    v_lshl_add_u32 v11, v0, 4, v10
    v_cmp_gt_u32 vcc, 7232, v5
    v_add_u32 v59, 105600, v5
    s_mul_i32 s58, s2, 10240
    s_mov_b64 s[66:67], vcc
    s_waitcnt vmcnt(3)
    v_mul_u32_u24 v28, 52429, v22
    v_lshrrev_b32 v28, 21, v28
    v_lshl_add_u32 v28, v28, 2, v10
    ds_add_rtn_u32 v34, v28, v9
    v_mul_u32_u24 v29, 52429, v23
    v_lshrrev_b32 v29, 21, v29
    v_lshl_add_u32 v29, v29, 2, v10
    ds_add_rtn_u32 v35, v29, v9
    v_mul_u32_u24 v30, 52429, v24
    v_lshrrev_b32 v30, 21, v30
    v_lshl_add_u32 v30, v30, 2, v10
    ds_add_rtn_u32 v36, v30, v9
    v_mul_u32_u24 v31, 52429, v25
    v_lshrrev_b32 v31, 21, v31
    v_lshl_add_u32 v31, v31, 2, v10
    ds_add_rtn_u32 v37, v31, v9
    s_waitcnt vmcnt(2)
    s_mov_b64 exec, s[66:67]
    v_mul_u32_u24 v32, 52429, v26
    v_lshrrev_b32 v32, 21, v32
    v_lshl_add_u32 v32, v32, 2, v10
    ds_add_rtn_u32 v38, v32, v9
    s_mov_b64 exec, -1
    s_waitcnt lgkmcnt(0)
    s_barrier
    ds_read_b128 v[12:15], v11
    s_add_u32 s40, s40, 0x9e377000
    s_and_b32 s40, s40, 4294963200
    s_waitcnt lgkmcnt(0)
    v_add_u32 v56, v12, v13
    v_add3_u32 v57, v56, v14, v15
    s_nop 1
    v_add_u32_dpp v58, v57, v57 row_shr:1 row_mask:0xf bank_mask:0xf bound_ctrl:1
    s_nop 1
    v_add_u32_dpp v58, v58, v58 row_shr:2 row_mask:0xf bank_mask:0xf bound_ctrl:1
    s_nop 1
    v_add_u32_dpp v58, v58, v58 row_shr:4 row_mask:0xf bank_mask:0xf bound_ctrl:1
    s_nop 1
    v_add_u32_dpp v58, v58, v58 row_shr:8 row_mask:0xf bank_mask:0xf bound_ctrl:1
    s_nop 1
    v_add_u32_dpp v58, v58, v58 row_bcast:15 row_mask:0xa bank_mask:0xf
    s_nop 1
    v_add_u32_dpp v58, v58, v58 row_bcast:31 row_mask:0xc bank_mask:0xf
    v_sub_u32 v64, v58, v57
    v_add_u32 v65, v64, v12
    v_add_u32 v66, v64, v56
    v_add_u32 v67, v66, v14
    ds_write_b128 v11, v[64:67] offset:1024
    ds_read_b32 v40, v28 offset:1024
    ds_read_b32 v41, v29 offset:1024
    ds_read_b32 v42, v30 offset:1024
    ds_read_b32 v43, v31 offset:1024
    s_mov_b64 exec, s[66:67]
    ds_read_b32 v44, v32 offset:1024
    s_mov_b64 exec, -1
    s_mov_b32 s60, 105600
    s_waitcnt vmcnt(0)
    v_lshl_or_b32 v16, v22, 16, v16
    v_lshl_or_b32 v17, v23, 16, v17
    v_lshl_or_b32 v18, v24, 16, v18
    v_lshl_or_b32 v19, v25, 16, v19
    v_lshl_or_b32 v20, v26, 16, v20
    s_waitcnt lgkmcnt(4)
    v_add3_u32 v40, v40, v34, s60
    ds_write_b32 v40, v16
    s_waitcnt lgkmcnt(4)
    v_add3_u32 v41, v41, v35, s60
    ds_write_b32 v41, v17
    s_waitcnt lgkmcnt(4)
    v_add3_u32 v42, v42, v36, s60
    ds_write_b32 v42, v18
    s_waitcnt lgkmcnt(4)
    v_add3_u32 v43, v43, v37, s60
    ds_write_b32 v43, v19
    s_mov_b64 exec, s[66:67]
    s_waitcnt lgkmcnt(4)
    v_add3_u32 v44, v44, v38, s60
    ds_write_b32 v44, v20
    s_mov_b64 exec, -1
    v_lshrrev_b32 v64, 2, v64
    v_or_b32 v64, s40, v64
    v_lshrrev_b32 v65, 2, v65
    v_or_b32 v65, s40, v65
    v_lshrrev_b32 v66, 2, v66
    v_or_b32 v66, s40, v66
    v_lshrrev_b32 v67, 2, v67
    v_or_b32 v67, s40, v67
    s_waitcnt lgkmcnt(0)
    s_barrier
    ds_read_b128 v[12:15], v59
    ds_read_b128 v[68:71], v59 offset:8192
    s_add_u32 s60, s58, 8192
    s_cmp_ge_u32 s4, 2
    s_waitcnt lgkmcnt(1)
    buffer_store_dwordx4 v[12:15], v5, s[16:19], s58 offen sc1
    s_cbranch_scc1 L_cp1
    s_waitcnt lgkmcnt(0)
    buffer_store_dwordx4 v[68:71], v5, s[16:19], s60 offen sc1
L_cp1:
    s_waitcnt vmcnt(0)
    s_mov_b64 exec, 1
    ds_add_u32 v3, v62 offset:56
    s_mov_b64 exec, -1
    s_cmp_eq_u32 s4, 0
    s_cbranch_scc0 L_preB
    s_lshl_b32 s61, s2, 10
    s_add_u32 s61, s61, 1114112
    s_or_b32 s60, s40, 1
    v_mov_b32 v8, s60
    s_mov_b32 s59, 0
Lw_1:
    ds_read_b32 v4, v3 offset:56
    s_waitcnt lgkmcnt(0)
    v_cmp_gt_u32 vcc, 8, v4
    s_cbranch_vccz Lk_2
    s_add_u32 s59, s59, 1
    s_cmp_lt_u32 s59, 4194304
    s_cbranch_scc1 Lw_1
    s_branch L_end
Lk_2:
    buffer_store_dwordx4 v[64:67], v5, s[16:19], s61 offen sc1
    ds_write_b32 v3, v8 offset:32
    s_branch L_preB
L_notprod:
    s_cmp_eq_u32 s63, 0
    s_cbranch_scc1 L_preB
    s_cmp_eq_u32 s63, 3
    s_cbranch_scc1 L_taskw
    s_cmp_eq_u32 s63, 4
    s_cbranch_scc1 L_wtask
    s_cmp_eq_u32 s63, 5
    s_cbranch_scc1 L_flag
    v_and_b32 v4, 7, v0
    v_mul_u32_u24 v1, 1056, v4
    v_and_b32 v4, 8, v0
    v_lshl_add_u32 v1, v4, 6, v1
    v_and_b32 v4, 48, v0
    v_add_u32 v1, v4, v1
    v_add_u32 v5, 105600, v1
    s_lshr_b32 s58, s62, 4
    s_lshl_b32 s58, s58, 3
    s_and_b32 s59, s62, 7
    s_add_u32 s58, s58, s59
    s_lshl_b32 s58, s58, 1
    s_bfe_u32 s59, s62, 0x10003
    s_add_u32 s58, s58, s59
    s_lshl_b32 s58, s58, 10
    s_add_u32 s58, s58, 655360
    v_lshlrev_b32 v6, 4, v0
    s_waitcnt vmcnt(0)
    s_mov_b32 s59, 0
Lw_3:
    ds_read_b32 v4, v3 offset:56
    s_waitcnt lgkmcnt(0)
    v_cmp_gt_u32 vcc, 2, v4
    s_cbranch_vccz Lk_4
    s_add_u32 s59, s59, 1
    s_cmp_lt_u32 s59, 4194304
    s_cbranch_scc1 Lw_3
    s_branch L_end
Lk_4:
    ds_read_b128 v[16:19], v5 offset:0
    ds_read_b128 v[20:23], v5 offset:8448
    ds_read_b128 v[24:27], v5 offset:16896
    ds_read_b128 v[28:31], v5 offset:64
    ds_read_b128 v[32:35], v5 offset:8512
    ds_read_b128 v[36:39], v5 offset:16960
    ds_read_b128 v[40:43], v5 offset:128
    ds_read_b128 v[44:47], v5 offset:8576
    ds_read_b128 v[48:51], v5 offset:17024
    ds_read_b128 v[64:67], v5 offset:192
    ds_read_b128 v[68:71], v5 offset:8640
    ds_read_b128 v[72:75], v5 offset:17088
    s_waitcnt lgkmcnt(9)
    ds_read_b128 v[76:79], v5 offset:256
    ds_read_b128 v[80:83], v5 offset:8704
    ds_read_b128 v[84:87], v5 offset:17152
    v_mfma_f32_16x16x32_bf16 v[8:11], v[16:19], v[24:27], 0
    v_mfma_f32_16x16x32_bf16 v[12:15], v[20:23], v[24:27], 0
    s_waitcnt lgkmcnt(9)
    ds_read_b128 v[88:91], v5 offset:320
    ds_read_b128 v[92:95], v5 offset:8768
    ds_read_b128 v[96:99], v5 offset:17216
    v_mfma_f32_16x16x32_bf16 v[8:11], v[28:31], v[36:39], v[8:11]
    v_mfma_f32_16x16x32_bf16 v[12:15], v[32:35], v[36:39], v[12:15]
    s_waitcnt lgkmcnt(9)
    ds_read_b128 v[100:103], v5 offset:384
    ds_read_b128 v[104:107], v5 offset:8832
    ds_read_b128 v[108:111], v5 offset:17280
    v_mfma_f32_16x16x32_bf16 v[8:11], v[40:43], v[48:51], v[8:11]
    v_mfma_f32_16x16x32_bf16 v[12:15], v[44:47], v[48:51], v[12:15]
    s_waitcnt lgkmcnt(9)
    ds_read_b128 v[112:115], v5 offset:448
    ds_read_b128 v[116:119], v5 offset:8896
    ds_read_b128 v[120:123], v5 offset:17344
    v_mfma_f32_16x16x32_bf16 v[8:11], v[64:67], v[72:75], v[8:11]
    v_mfma_f32_16x16x32_bf16 v[12:15], v[68:71], v[72:75], v[12:15]
    s_waitcnt lgkmcnt(9)
    v_mfma_f32_16x16x32_bf16 v[8:11], v[76:79], v[84:87], v[8:11]
    v_mfma_f32_16x16x32_bf16 v[12:15], v[80:83], v[84:87], v[12:15]
    s_waitcnt lgkmcnt(6)
    v_mfma_f32_16x16x32_bf16 v[8:11], v[88:91], v[96:99], v[8:11]
    v_mfma_f32_16x16x32_bf16 v[12:15], v[92:95], v[96:99], v[12:15]
    s_waitcnt lgkmcnt(3)
    v_mfma_f32_16x16x32_bf16 v[8:11], v[100:103], v[108:111], v[8:11]
    v_mfma_f32_16x16x32_bf16 v[12:15], v[104:107], v[108:111], v[12:15]
    s_waitcnt lgkmcnt(0)
    v_mfma_f32_16x16x32_bf16 v[8:11], v[112:115], v[120:123], v[8:11]
    v_mfma_f32_16x16x32_bf16 v[12:15], v[116:119], v[120:123], v[12:15]
    s_nop 6
    v_cvt_pk_bf16_f32 v16, v8, v9
    v_cvt_pk_bf16_f32 v17, v10, v11
    v_cvt_pk_bf16_f32 v18, v12, v13
    v_cvt_pk_bf16_f32 v19, v14, v15
    buffer_store_dwordx4 v[16:19], v6, s[16:19], s58 offen sc1
    s_branch L_taskw
L_wtask:
    s_lshl_b32 s58, s62, 11
    s_add_u32 s58, s58, 786432
    v_lshlrev_b32 v6, 4, v0
    s_mov_b32 s70, 0x05040100
    s_mov_b32 s71, 0x07060302
    s_waitcnt vmcnt(0)
    v_perm_b32 v64, v17, v16, s70
    v_perm_b32 v68, v17, v16, s71
    v_perm_b32 v65, v19, v18, s70
    v_perm_b32 v69, v19, v18, s71
    v_perm_b32 v66, v21, v20, s70
    v_perm_b32 v70, v21, v20, s71
    v_perm_b32 v67, v23, v22, s70
    v_perm_b32 v71, v23, v22, s71
    buffer_store_dwordx4 v[64:67], v6, s[16:19], s58 offen sc1
    buffer_store_dwordx4 v[68:71], v6, s[16:19], s58 offen offset:1024 sc1
L_taskw:
    s_waitcnt vmcnt(0)
    s_mov_b64 exec, 1
    ds_add_u32 v3, v62 offset:56
    s_mov_b64 exec, -1
    s_branch L_preB
L_flag:
    s_waitcnt vmcnt(0) lgkmcnt(0)
    s_add_u32 s40, s40, 0x9e377000
    s_and_b32 s40, s40, 4294963200
    s_mul_i32 s61, s2, 16
    s_add_u32 s61, s61, 1178624
    s_or_b32 s60, s40, 1
    v_mov_b32 v8, s60
    v_mov_b32 v10, s40
    v_mov_b32 v11, s40
    v_lshlrev_b32 v9, 15, v0
    s_mov_b32 s59, 0
Lw_5:
    ds_read_b32 v4, v3 offset:56
    s_waitcnt lgkmcnt(0)
    v_cmp_gt_u32 vcc, 3, v4
    s_cbranch_vccz Lk_6
    s_add_u32 s59, s59, 1
    s_cmp_lt_u32 s59, 4194304
    s_cbranch_scc1 Lw_5
    s_branch L_end
Lk_6:
    s_mov_b64 exec, 255
    buffer_store_dwordx2 v[10:11], v9, s[16:19], s61 offen sc1
    ds_write_b32 v3, v8 offset:32
    s_mov_b64 exec, -1
L_preB:
    s_setprio 3
    s_mov_b64 s[28:29], s[42:43]
    s_mov_b32 s30, 20000
    s_setprio 3
    s_lshl_b32 s58, s4, 10
    v_lshlrev_b32 v5, 4, v0
    s_add_u32 m0, s58, 130944
    s_add_u32 s59, s58, 0
    buffer_load_dwordx4 v5, s[28:31], s59 offen lds
    s_add_u32 m0, s58, 139136
    s_add_u32 s59, s58, 8192
    buffer_load_dwordx4 v5, s[28:31], s59 offen lds
    s_cmp_lt_u32 s4, 4
    s_cbranch_scc1 L_disd
    s_add_u32 m0, s58, 143232
    s_add_u32 s59, s58, 12288
    buffer_load_dwordx4 v5, s[28:31], s59 offen lds
L_disd:
    s_mov_b64 s[24:25], s[44:45]
    s_mov_b32 s26, 131072
    s_setprio 1
    s_lshl_b32 s58, s4, 10
    s_mov_b32 s41, 0
    buffer_load_dwordx4 v[96:99], v5, s[24:27], s58 offen
    s_add_u32 s58, s58, 8192
    buffer_load_dwordx4 v[100:103], v5, s[24:27], s58 offen
    s_add_u32 s58, s58, 8192
    buffer_load_dwordx4 v[104:107], v5, s[24:27], s58 offen
    s_add_u32 s58, s58, 8192
    buffer_load_dwordx4 v[108:111], v5, s[24:27], s58 offen
    s_add_u32 s58, s58, 8192
    buffer_load_dwordx4 v[112:115], v5, s[24:27], s58 offen
    s_add_u32 s58, s58, 8192
    buffer_load_dwordx4 v[116:119], v5, s[24:27], s58 offen
    s_add_u32 s58, s58, 8192
    buffer_load_dwordx4 v[120:123], v5, s[24:27], s58 offen
    s_add_u32 s58, s58, 8192
    buffer_load_dwordx4 v[124:127], v5, s[24:27], s58 offen
    s_setprio 3
    v_and_b32 v4, 3, v0
    v_mov_b32 v5, 0x0c0c0c0c
    v_mov_b32 v6, 0x0c0c0302
    v_mov_b32 v7, 0x03020c0c
    v_cmp_eq_u32 s[58:59], 0, v4
    v_cmp_eq_u32 s[60:61], 2, v4
    v_cmp_eq_u32 vcc, 1, v4
    v_cndmask_b32 v10, v5, v6, s[58:59]
    v_cndmask_b32 v11, v5, v6, s[60:61]
    v_cndmask_b32 v10, v10, v7, vcc
    v_cmp_eq_u32 vcc, 3, v4
    s_nop 1
    v_cndmask_b32 v11, v11, v7, vcc
    v_and_b32 v10, 0xfdfdfdfd, v10
    v_and_b32 v11, 0xfdfdfdfd, v11
    s_movk_i32 s7, 512
    s_lshl_b32 s58, s4, 3
    v_lshrrev_b32 v5, 3, v0
    v_and_b32 v6, 7, v0
    v_add_u32 v7, s58, v5
    v_mul_u32_u24 v49, 10240, v7
    v_lshl_add_u32 v49, v6, 4, v49
    v_lshlrev_b32 v56, 2, v6
    s_lshl_b32 s60, s6, 2
    s_add_u32 s60, s60, 1114112
    v_lshl_add_u32 v54, v7, 10, s60
    v_mad_u32_u24 v7, v7, 3, v6
    v_cmp_ge_u32 vcc, 186, v7
    v_cmp_gt_u32 s[64:65], 4, v6
    v_mul_u32_u24 v7, 16, v7
    s_and_b64 s[64:65], s[64:65], vcc
    v_cmp_eq_u32 vcc, 0, v6
    s_and_b32 s58, s2, 7
    s_lshl_b32 s58, s58, 15
    s_add_u32 s58, s58, 1179632
    v_add_u32 v7, s58, v7
    s_or_b64 s[64:65], s[64:65], vcc
    v_cndmask_b32 v54, v7, v54, vcc
    v_cmp_gt_u32 s[62:63], 5, v6
    v_lshl_add_u32 v50, v6, 3, v5
    v_mul_u32_u24 v55, 80, v5
    v_add_u32 v55, 80, v55
    v_lshrrev_b32 v5, 4, v50
    v_mul_u32_u24 v9, 8448, v5
    v_lshl_add_u32 v9, v5, 26, v9
    v_cmp_le_u32 vcc, 32, v50
    v_and_b32 v5, 7, v50
    v_and_b32 v6, 3, v50
    v_cndmask_b32 v5, v5, v6, vcc
    v_mul_u32_u24 v5, 1056, v5
    v_bfe_u32 v6, v50, 3, 1
    v_bfe_u32 v7, v50, 2, 1
    v_cndmask_b32 v6, v6, v7, vcc
    v_lshl_add_u32 v5, v6, 9, v5
    v_mov_b32 v52, 130944
    v_add3_u32 v9, v9, v5, v52
    v_lshrrev_b32 v5, 5, v0
    v_lshl_add_u32 v15, v5, 3, v2
    s_lshl_b32 s58, s5, 2
    s_sub_u32 s58, 159744, s58
    v_mov_b32 v53, s58
    v_add_u32 v5, s5, v50
    v_lshl_add_u32 v8, v5, 1, v52
    v_lshlrev_b32 v50, 2, v50
    v_add_u32 v50, 159744, v50
    v_mov_b32 v57, 157184
    v_mov_b32 v60, 152064
    v_mov_b64 v[16:17], 0
    v_mov_b64 v[18:19], 0
    s_mov_b32 s59, 0
Lw_7:
    ds_read_b32 v4, v3 offset:60
    s_waitcnt lgkmcnt(0)
    v_cmp_gt_u32 vcc, 8, v4
    s_cbranch_vccz Lk_8
    s_sleep 2
    s_add_u32 s59, s59, 1
    s_cmp_lt_u32 s59, 4194304
    s_cbranch_scc1 Lw_7
    s_branch L_end
Lk_8:
    s_mov_b32 s59, 0
Lw_9:
    ds_read_b32 v4, v3 offset:32
    s_waitcnt lgkmcnt(0)
    v_cmp_gt_u32 vcc, 1, v4
    s_cbranch_vccz Lk_10
    s_sleep 1
    s_add_u32 s59, s59, 1
    s_cmp_lt_u32 s59, 4194304
    s_cbranch_scc1 Lw_9
    s_branch L_end
Lk_10:
    v_readfirstlane_b32 s40, v4
    s_mov_b32 s59, 0
    s_bitset0_b32 s40, 0
    s_and_b32 exec_lo, s64, 0xfefefefe
    s_and_b32 exec_hi, s65, 0xfefefefe
L_spolla:
    buffer_load_dwordx2 v[58:59], v54, s[16:19], 0 offen sc1
    s_add_u32 s59, s59, 1
    s_cmp_gt_u32 s59, 0x40000
    s_cbranch_scc1 L_end
    s_waitcnt vmcnt(0)
    v_xor_b32 v58, s40, v58
    v_xor_b32 v59, s40, v59
    v_or_b32 v5, v58, v59
    v_cmpx_lt_u32 vcc, 4095, v5
    s_cbranch_execz L_soka
    s_sleep 8
    s_branch L_spolla
L_soka:
    s_mov_b64 exec, -1
    s_mov_b64 exec, 1
    ds_add_u32 v3, v62 offset:52
    s_mov_b64 exec, -1
    s_mov_b32 exec_lo, 0x01010101
    s_mov_b32 exec_hi, 0x01010101
L_spollb:
    buffer_load_dwordx2 v[58:59], v54, s[16:19], 0 offen sc1
    s_add_u32 s59, s59, 1
    s_cmp_gt_u32 s59, 0x40000
    s_cbranch_scc1 L_end
    s_waitcnt vmcnt(0)
    v_xor_b32 v58, s40, v58
    v_xor_b32 v59, s40, v59
    v_or_b32 v5, v58, v59
    v_cmpx_lt_u32 vcc, 4095, v5
    s_cbranch_execz L_sokb
    s_sleep 8
    s_branch L_spollb
L_sokb:
    s_mov_b64 exec, -1
    v_sub_u32 v48, v59, v58
    v_lshl_or_b32 v48, v48, 16, v58
    s_nop 1
    v_mov_b32_dpp v48, v48 quad_perm:[0,0,0,0] row_mask:0xf bank_mask:0xf
    s_nop 1
    v_mov_b32_dpp v48, v48 row_shr:4 row_mask:0xf bank_mask:0xa
    v_mad_u32_u16 v49, v48, 4, v49
    v_lshrrev_b32 v48, 16, v48
    v_sub_u32 v48, v48, v56
    v_cmpx_lt_i32 vcc, 0, v48
    s_cbranch_execz L_entld
    buffer_load_dwordx4 v[16:19], v49, s[16:19], 0 offen sc1
    v_cmpx_lt_i32 vcc, 32, v48
    ds_write_b32 v3, v62 offset:28
L_entld:
    s_mov_b64 exec, -1
    s_waitcnt vmcnt(0)
    v_cmpx_lt_i32 vcc, 0, v48
    v_mad_u32_u16 v24, v16, 4, v53 op_sel:[1,0,0,0]
    ds_add_rtn_u32 v32, v24, v62
    v_cmpx_lt_i32 vcc, 1, v48
    v_mad_u32_u16 v25, v17, 4, v53 op_sel:[1,0,0,0]
    ds_add_rtn_u32 v33, v25, v62
    v_cmpx_lt_i32 vcc, 2, v48
    v_mad_u32_u16 v26, v18, 4, v53 op_sel:[1,0,0,0]
    ds_add_rtn_u32 v34, v26, v62
    v_cmpx_lt_i32 vcc, 3, v48
    v_mad_u32_u16 v27, v19, 4, v53 op_sel:[1,0,0,0]
    ds_add_rtn_u32 v35, v27, v62
    s_mov_b64 exec, -1
    s_mov_b64 exec, 1
    ds_add_u32 v3, v62 offset:12
    s_mov_b64 exec, -1
    v_mad_u32_u16 v40, v16, 2, v52
    v_mad_u32_u16 v16, v16, s7, 0
    v_mad_u32_u16 v41, v17, 2, v52
    v_mad_u32_u16 v17, v17, s7, 0
    v_mad_u32_u16 v42, v18, 2, v52
    v_mad_u32_u16 v18, v18, s7, 0
    v_mad_u32_u16 v43, v19, 2, v52
    v_mad_u32_u16 v19, v19, s7, 0
    s_mov_b32 s59, 0
Lw_11:
    ds_read_b32 v4, v3 offset:12
    s_waitcnt lgkmcnt(0)
    v_cmp_gt_u32 vcc, 8, v4
    s_cbranch_vccz Lk_12
    s_add_u32 s59, s59, 1
    s_cmp_lt_u32 s59, 4194304
    s_cbranch_scc1 Lw_11
    s_branch L_end
Lk_12:
    ds_read_b32 v12, v50
    ds_read_b32 v5, v3 offset:28
    ds_read_u16 v8, v8
    ds_read_u16 v40, v40
    ds_read_u16 v41, v41
    ds_read_u16 v42, v42
    ds_read_u16 v43, v43
    s_lshl_b32 s58, s2, 4
    s_add_u32 s58, s58, s3
    s_cmp_eq_u32 s58, 15
    s_cbranch_scc0 L_noep
    v_mov_b32 v6, s40
    v_mov_b32 v7, 1048576
    s_mov_b64 exec, 1
    buffer_store_dword v6, v7, s[16:19], 0 offen sc1
    s_mov_b64 exec, -1
L_noep:
    s_waitcnt lgkmcnt(6)
    v_add_u32 v12, 1, v12
    v_lshrrev_b32 v12, 1, v12
    v_max_u32 v12, 1, v12
    v_cndmask_b32 v12, 0, v12, s[62:63]
    s_lshl_b32 s67, s4, 3
    s_movk_i32 s58, 2560
    v_add_u32_dpp v51, v12, v12 row_shl:1 row_mask:0xf bank_mask:0xf bound_ctrl:1
    s_nop 1
    v_add_u32_dpp v51, v51, v51 row_shl:2 row_mask:0xf bank_mask:0xf bound_ctrl:1
    s_nop 1
    v_add_u32_dpp v51, v12, v51 row_shl:4 row_mask:0xf bank_mask:0x5 bound_ctrl:1
    s_waitcnt lgkmcnt(0)
    v_lshlrev_b32 v8, 16, v8
    v_lshl_add_u32 v5, v5, 10, v51
    v_sub_u32 v6, v55, v51
    v_cmp_le_u32 vcc, 80, v5
    v_lshlrev_b32 v6, 1, v6
    v_subrev_u32 v12, 1, v12
    s_cbranch_vccnz L_slow
    v_and_b32 v12, 0xff, v12
    v_lshl_add_u32 v9, v12, 18, v9
    s_mov_b64 exec, s[62:63]
    ds_write_b32 v50, v6 offset:160
    s_mov_b64 exec, -1
    s_sub_u32 s63, s67, 1
    v_readlane_b32 s67, v51, s67
    v_cmpx_lt_i32 vcc, 0, v48
    ds_read_b32 v24, v24 offset:160
    v_cmpx_lt_i32 vcc, 1, v48
    ds_read_b32 v25, v25 offset:160
    v_cmpx_lt_i32 vcc, 2, v48
    ds_read_b32 v26, v26 offset:160
    v_cmpx_lt_i32 vcc, 3, v48
    ds_read_b32 v27, v27 offset:160
    s_mov_b64 exec, -1
    s_lshr_b32 s66, s67, 3
    s_add_u32 s60, s66, 1
    s_lshl_b32 s60, s60, 3
    s_sub_u32 s67, s60, s67
    s_sub_u32 s62, s67, 1
    s_add_u32 s61, s4, 1
    s_mul_i32 s61, s61, 80
    s_sub_u32 s60, s61, s60
    s_lshl_b32 s60, s60, 2
    s_waitcnt lgkmcnt(0)
    v_cmpx_lt_i32 vcc, 0, v48
    v_add_u32 v24, v24, v32
    v_lshl_add_u32 v5, v24, 1, v57
    ds_write_b16 v5, v40
    v_lshrrev_b32 v6, 1, v24
    v_lshl_add_u32 v6, v6, 2, v60
    v_and_b32 v7, 1, v24
    v_mad_u32_u24 v6, v7, s58, v6
    ds_write_b32 v6, v16
    v_cmpx_lt_i32 vcc, 1, v48
    v_add_u32 v25, v25, v33
    v_lshl_add_u32 v5, v25, 1, v57
    ds_write_b16 v5, v41
    v_lshrrev_b32 v6, 1, v25
    v_lshl_add_u32 v6, v6, 2, v60
    v_and_b32 v7, 1, v25
    v_mad_u32_u24 v6, v7, s58, v6
    ds_write_b32 v6, v17
    v_cmpx_lt_i32 vcc, 2, v48
    v_add_u32 v26, v26, v34
    v_lshl_add_u32 v5, v26, 1, v57
    ds_write_b16 v5, v42
    v_lshrrev_b32 v6, 1, v26
    v_lshl_add_u32 v6, v6, 2, v60
    v_and_b32 v7, 1, v26
    v_mad_u32_u24 v6, v7, s58, v6
    ds_write_b32 v6, v18
    v_cmpx_lt_i32 vcc, 3, v48
    v_add_u32 v27, v27, v35
    v_lshl_add_u32 v5, v27, 1, v57
    ds_write_b16 v5, v43
    v_lshrrev_b32 v6, 1, v27
    v_lshl_add_u32 v6, v6, 2, v60
    v_and_b32 v7, 1, v27
    v_mad_u32_u24 v6, v7, s58, v6
    ds_write_b32 v6, v19
    s_mov_b64 exec, -1
    s_mov_b64 exec, 1
    ds_add_u32 v3, v62 offset:16
    s_mov_b64 exec, -1
    v_lshrrev_b32 v5, 5, v0
    v_mad_u32_u24 v13, v5, s58, v60
    v_add_u32 v13, s60, v13
    v_lshl_add_u32 v14, v5, 1, v57
    v_and_b32 v5, 28, v0
    v_add3_u32 v14, v14, v5, s60
    s_mov_b32 s65, 201487296
    s_mov_b32 s64, 0
    s_mov_b32 s59, 0
Lw_13:
    ds_read_b32 v4, v3 offset:16
    s_waitcnt lgkmcnt(0)
    v_cmp_gt_u32 vcc, 8, v4
    s_cbranch_vccz Lk_14
    s_add_u32 s59, s59, 1
    s_cmp_lt_u32 s59, 4194304
    s_cbranch_scc1 Lw_13
    s_branch L_end
Lk_14:
    v_mov_b32 v12, v3
    v_mov_b32 v3, v2
    s_setprio 1
    s_cmp_lt_u32 s4, 4
    s_cbranch_scc1 L_old
    s_setprio 2
L_old:
    s_mov_b64 vcc, 0
    ds_read_b128 v[64:67], v13 offset:0
    ds_read_b128 v[68:71], v13 offset:16
    ds_read_u16 v1, v14
    ds_read_b128 v[48:51], v13 offset:32
    ds_read_b128 v[52:55], v13 offset:48
    s_waitcnt lgkmcnt(3)
L_p0:
    s_cmp_ge_u32 s67, 4
    s_cbranch_scc1 L_p4
    s_cmp_gt_u32 s67, 1
    s_cbranch_scc1 Lps_15
    v_add_u32 v65, v65, v2
    buffer_load_dwordx4 v[20:23], v65, s[8:11], 0 offen
Lps_15:
    s_cmp_gt_u32 s67, 2
    s_cbranch_scc1 Lps_16
    v_add_u32 v66, v66, v2
    buffer_load_dwordx4 v[24:27], v66, s[8:11], 0 offen
Lps_16:
    s_cmp_gt_u32 s67, 3
    s_cbranch_scc1 Lps_17
    v_add_u32 v67, v67, v2
    buffer_load_dwordx4 v[28:31], v67, s[8:11], 0 offen
Lps_17:
L_p4:
    s_cmp_gt_u32 s67, 4
    s_cbranch_scc1 Lps_18
    v_add_u32 v68, v68, v2
    buffer_load_dwordx4 v[32:35], v68, s[8:11], 0 offen
Lps_18:
    s_cmp_gt_u32 s67, 5
    s_cbranch_scc1 Lps_19
    v_add_u32 v69, v69, v2
    buffer_load_dwordx4 v[36:39], v69, s[8:11], 0 offen
Lps_19:
    s_cmp_gt_u32 s67, 6
    s_cbranch_scc1 Lps_20
    v_add_u32 v70, v70, v2
    buffer_load_dwordx4 v[40:43], v70, s[8:11], 0 offen
Lps_20:
    s_cmp_gt_u32 s67, 7
    s_cbranch_scc1 Lps_21
    v_add_u32 v71, v71, v2
    buffer_load_dwordx4 v[44:47], v71, s[8:11], 0 offen
Lps_21:
    s_cmp_eq_u32 s66, 0
    s_cbranch_scc1 L_drain
L_gl:
    s_cmp_le_u32 s66, 4
    s_cbranch_scc1 L_dm0
L_dm0b:
    s_waitcnt lgkmcnt(1)
    v_perm_b32 v6, v1, v1, v10
    v_perm_b32 v7, v1, v1, v11
    ds_read_u16 v1, v14 offset:32
    s_waitcnt vmcnt(6)
    v_lshl_add_u64 v[4:5], v[48:49], 0, v[2:3]
    s_sub_u32 s62, s62, 2
    s_cbranch_scc1 Lfs_0
    v_mfma_f32_4x4x4_16b_bf16 v[56:59], v[6:7], v[16:17], v[56:59] cbsz:3 abid:0
    v_mfma_f32_4x4x4_16b_bf16 v[60:63], v[6:7], v[18:19], v[60:63] cbsz:3 abid:0
    buffer_load_dwordx4 v[16:19], v4, s[8:11], 0 offen
    v_mfma_f32_4x4x4_16b_bf16 v[56:59], v[6:7], v[20:21], v[56:59] cbsz:3 abid:1
    v_mfma_f32_4x4x4_16b_bf16 v[60:63], v[6:7], v[22:23], v[60:63] cbsz:3 abid:1
    buffer_load_dwordx4 v[20:23], v5, s[8:11], 0 offen
Lbs_0:
    s_cbranch_vccnz Ldm_0
Ldb_0:
    s_waitcnt vmcnt(6)
    v_lshl_add_u64 v[4:5], v[50:51], 0, v[2:3]
    s_sub_u32 s62, s62, 2
    s_cbranch_scc1 Lfs_2
    v_mfma_f32_4x4x4_16b_bf16 v[56:59], v[6:7], v[24:25], v[56:59] cbsz:3 abid:2
    v_mfma_f32_4x4x4_16b_bf16 v[60:63], v[6:7], v[26:27], v[60:63] cbsz:3 abid:2
    buffer_load_dwordx4 v[24:27], v4, s[8:11], 0 offen
    v_mfma_f32_4x4x4_16b_bf16 v[56:59], v[6:7], v[28:29], v[56:59] cbsz:3 abid:3
    v_mfma_f32_4x4x4_16b_bf16 v[60:63], v[6:7], v[30:31], v[60:63] cbsz:3 abid:3
    buffer_load_dwordx4 v[28:31], v5, s[8:11], 0 offen
Lbs_2:
    s_cbranch_vccnz Ldm_2
Ldb_2:
    ds_read_b128 v[48:51], v13 offset:64
    s_waitcnt vmcnt(6) lgkmcnt(2)
    v_lshl_add_u64 v[4:5], v[52:53], 0, v[2:3]
    s_sub_u32 s62, s62, 2
    s_cbranch_scc1 Lfs_4
    v_mfma_f32_4x4x4_16b_bf16 v[56:59], v[6:7], v[32:33], v[56:59] cbsz:3 abid:4
    v_mfma_f32_4x4x4_16b_bf16 v[60:63], v[6:7], v[34:35], v[60:63] cbsz:3 abid:4
    buffer_load_dwordx4 v[32:35], v4, s[8:11], 0 offen
    v_mfma_f32_4x4x4_16b_bf16 v[56:59], v[6:7], v[36:37], v[56:59] cbsz:3 abid:5
    v_mfma_f32_4x4x4_16b_bf16 v[60:63], v[6:7], v[38:39], v[60:63] cbsz:3 abid:5
    buffer_load_dwordx4 v[36:39], v5, s[8:11], 0 offen
Lbs_4:
    s_cbranch_vccnz Ldm_4
Ldb_4:
    s_waitcnt vmcnt(6)
    v_lshl_add_u64 v[4:5], v[54:55], 0, v[2:3]
    s_sub_u32 s62, s62, 2
    s_cbranch_scc1 Lfs_6
    v_mfma_f32_4x4x4_16b_bf16 v[56:59], v[6:7], v[40:41], v[56:59] cbsz:3 abid:6
    v_mfma_f32_4x4x4_16b_bf16 v[60:63], v[6:7], v[42:43], v[60:63] cbsz:3 abid:6
    buffer_load_dwordx4 v[40:43], v4, s[8:11], 0 offen
    v_mfma_f32_4x4x4_16b_bf16 v[56:59], v[6:7], v[44:45], v[56:59] cbsz:3 abid:7
    v_mfma_f32_4x4x4_16b_bf16 v[60:63], v[6:7], v[46:47], v[60:63] cbsz:3 abid:7
    buffer_load_dwordx4 v[44:47], v5, s[8:11], 0 offen
Lbs_6:
    s_cbranch_vccnz Ldm_6
Ldb_6:
    ds_read_b128 v[52:55], v13 offset:80
    v_add_u32 v13, 32, v13
    v_add_u32 v14, 32, v14
    s_sub_u32 s66, s66, 1
    s_cmp_eq_u32 s66, 3
    s_cbranch_scc0 L_nf
    s_setprio 1
L_nf:
    s_cmp_lg_u32 s66, 0
    s_cbranch_scc1 L_gl
L_drain:
    s_waitcnt lgkmcnt(0)
    v_perm_b32 v6, v1, v1, v10
    v_perm_b32 v7, v1, v1, v11
    ds_read_u16 v1, v14 offset:32
    s_waitcnt vmcnt(7)
    v_mfma_f32_4x4x4_16b_bf16 v[56:59], v[6:7], v[16:17], v[56:59] cbsz:3 abid:0
    v_mfma_f32_4x4x4_16b_bf16 v[60:63], v[6:7], v[18:19], v[60:63] cbsz:3 abid:0
    s_sub_u32 s62, s62, 1
    s_cbranch_scc1 Lfd_0
Lbd_0:
    s_waitcnt vmcnt(6)
    v_mfma_f32_4x4x4_16b_bf16 v[56:59], v[6:7], v[20:21], v[56:59] cbsz:3 abid:1
    v_mfma_f32_4x4x4_16b_bf16 v[60:63], v[6:7], v[22:23], v[60:63] cbsz:3 abid:1
    s_sub_u32 s62, s62, 1
    s_cbranch_scc1 Lfd_1
Lbd_1:
    s_waitcnt vmcnt(5)
    v_mfma_f32_4x4x4_16b_bf16 v[56:59], v[6:7], v[24:25], v[56:59] cbsz:3 abid:2
    v_mfma_f32_4x4x4_16b_bf16 v[60:63], v[6:7], v[26:27], v[60:63] cbsz:3 abid:2
    s_sub_u32 s62, s62, 1
    s_cbranch_scc1 Lfd_2
Lbd_2:
    s_waitcnt vmcnt(4)
    v_mfma_f32_4x4x4_16b_bf16 v[56:59], v[6:7], v[28:29], v[56:59] cbsz:3 abid:3
    v_mfma_f32_4x4x4_16b_bf16 v[60:63], v[6:7], v[30:31], v[60:63] cbsz:3 abid:3
    s_sub_u32 s62, s62, 1
    s_cbranch_scc1 Lfd_3
Lbd_3:
    s_waitcnt vmcnt(3)
    v_mfma_f32_4x4x4_16b_bf16 v[56:59], v[6:7], v[32:33], v[56:59] cbsz:3 abid:4
    v_mfma_f32_4x4x4_16b_bf16 v[60:63], v[6:7], v[34:35], v[60:63] cbsz:3 abid:4
    s_sub_u32 s62, s62, 1
    s_cbranch_scc1 Lfd_4
Lbd_4:
    s_waitcnt vmcnt(2)
    v_mfma_f32_4x4x4_16b_bf16 v[56:59], v[6:7], v[36:37], v[56:59] cbsz:3 abid:5
    v_mfma_f32_4x4x4_16b_bf16 v[60:63], v[6:7], v[38:39], v[60:63] cbsz:3 abid:5
    s_sub_u32 s62, s62, 1
    s_cbranch_scc1 Lfd_5
Lbd_5:
    s_waitcnt vmcnt(1)
    v_mfma_f32_4x4x4_16b_bf16 v[56:59], v[6:7], v[40:41], v[56:59] cbsz:3 abid:6
    v_mfma_f32_4x4x4_16b_bf16 v[60:63], v[6:7], v[42:43], v[60:63] cbsz:3 abid:6
    s_sub_u32 s62, s62, 1
    s_cbranch_scc1 Lfd_6
Lbd_6:
    s_waitcnt vmcnt(0)
    v_mfma_f32_4x4x4_16b_bf16 v[56:59], v[6:7], v[44:45], v[56:59] cbsz:3 abid:7
    v_mfma_f32_4x4x4_16b_bf16 v[60:63], v[6:7], v[46:47], v[60:63] cbsz:3 abid:7
    s_nop 1
    s_call_b64 s[68:69], L_flush
L_gdone:
    s_cmp_eq_u32 s41, 0
    s_cbranch_scc0 L_dd
    s_mov_b32 s59, 0
Lw_22:
    ds_read_b32 v4, v12 offset:24
    s_waitcnt lgkmcnt(0)
    v_cmp_gt_u32 vcc, 8, v4
    s_cbranch_vccz Lk_23
    s_sleep 2
    s_add_u32 s59, s59, 1
    s_cmp_lt_u32 s59, 4194304
    s_cbranch_scc1 Lw_22
    s_branch L_end
Lk_23:
    s_lshl_b32 s58, s4, 10
    v_lshl_add_u32 v72, v0, 4, s58
    s_and_b32 s58, s4, 4
    v_lshl_add_u32 v73, s58, 4, v72
    s_movk_i32 s58, 0x1f0
    v_bfi_b32 v72, s58, v73, v72
    ds_write_b128 v72, v[96:99] offset:0
    ds_write_b128 v72, v[100:103] offset:8192
    ds_write_b128 v72, v[104:107] offset:16384
    ds_write_b128 v72, v[108:111] offset:24576
    ds_write_b128 v72, v[112:115] offset:32768
    ds_write_b128 v72, v[116:119] offset:40960
    ds_write_b128 v72, v[120:123] offset:49152
    ds_write_b128 v72, v[124:127] offset:57344
    s_mov_b64 exec, 1
    ds_inc_u32 v12, v12 offset:76
    s_mov_b64 exec, -1
L_dd:
    s_endpgm
Lfs_0:
    s_add_u32 s62, s62, 2
    v_mfma_f32_4x4x4_16b_bf16 v[56:59], v[6:7], v[16:17], v[56:59] cbsz:3 abid:0
    v_mfma_f32_4x4x4_16b_bf16 v[60:63], v[6:7], v[18:19], v[60:63] cbsz:3 abid:0
    buffer_load_dwordx4 v[16:19], v4, s[8:11], 0 offen
    s_sub_u32 s62, s62, 1
    s_cbranch_scc0 Lsk_24
    s_call_b64 s[68:69], L_flush
Lsk_24:
    v_mfma_f32_4x4x4_16b_bf16 v[56:59], v[6:7], v[20:21], v[56:59] cbsz:3 abid:1
    v_mfma_f32_4x4x4_16b_bf16 v[60:63], v[6:7], v[22:23], v[60:63] cbsz:3 abid:1
    buffer_load_dwordx4 v[20:23], v5, s[8:11], 0 offen
    s_sub_u32 s62, s62, 1
    s_cbranch_scc0 Lbs_0
    s_call_b64 s[68:69], L_flush
    s_branch Lbs_0
Lfs_2:
    s_add_u32 s62, s62, 2
    v_mfma_f32_4x4x4_16b_bf16 v[56:59], v[6:7], v[24:25], v[56:59] cbsz:3 abid:2
    v_mfma_f32_4x4x4_16b_bf16 v[60:63], v[6:7], v[26:27], v[60:63] cbsz:3 abid:2
    buffer_load_dwordx4 v[24:27], v4, s[8:11], 0 offen
    s_sub_u32 s62, s62, 1
    s_cbranch_scc0 Lsk_26
    s_call_b64 s[68:69], L_flush
Lsk_26:
    v_mfma_f32_4x4x4_16b_bf16 v[56:59], v[6:7], v[28:29], v[56:59] cbsz:3 abid:3
    v_mfma_f32_4x4x4_16b_bf16 v[60:63], v[6:7], v[30:31], v[60:63] cbsz:3 abid:3
    buffer_load_dwordx4 v[28:31], v5, s[8:11], 0 offen
    s_sub_u32 s62, s62, 1
    s_cbranch_scc0 Lbs_2
    s_call_b64 s[68:69], L_flush
    s_branch Lbs_2
Lfs_4:
    s_add_u32 s62, s62, 2
    v_mfma_f32_4x4x4_16b_bf16 v[56:59], v[6:7], v[32:33], v[56:59] cbsz:3 abid:4
    v_mfma_f32_4x4x4_16b_bf16 v[60:63], v[6:7], v[34:35], v[60:63] cbsz:3 abid:4
    buffer_load_dwordx4 v[32:35], v4, s[8:11], 0 offen
    s_sub_u32 s62, s62, 1
    s_cbranch_scc0 Lsk_28
    s_call_b64 s[68:69], L_flush
Lsk_28:
    v_mfma_f32_4x4x4_16b_bf16 v[56:59], v[6:7], v[36:37], v[56:59] cbsz:3 abid:5
    v_mfma_f32_4x4x4_16b_bf16 v[60:63], v[6:7], v[38:39], v[60:63] cbsz:3 abid:5
    buffer_load_dwordx4 v[36:39], v5, s[8:11], 0 offen
    s_sub_u32 s62, s62, 1
    s_cbranch_scc0 Lbs_4
    s_call_b64 s[68:69], L_flush
    s_branch Lbs_4
Lfs_6:
    s_add_u32 s62, s62, 2
    v_mfma_f32_4x4x4_16b_bf16 v[56:59], v[6:7], v[40:41], v[56:59] cbsz:3 abid:6
    v_mfma_f32_4x4x4_16b_bf16 v[60:63], v[6:7], v[42:43], v[60:63] cbsz:3 abid:6
    buffer_load_dwordx4 v[40:43], v4, s[8:11], 0 offen
    s_sub_u32 s62, s62, 1
    s_cbranch_scc0 Lsk_30
    s_call_b64 s[68:69], L_flush
Lsk_30:
    v_mfma_f32_4x4x4_16b_bf16 v[56:59], v[6:7], v[44:45], v[56:59] cbsz:3 abid:7
    v_mfma_f32_4x4x4_16b_bf16 v[60:63], v[6:7], v[46:47], v[60:63] cbsz:3 abid:7
    buffer_load_dwordx4 v[44:47], v5, s[8:11], 0 offen
    s_sub_u32 s62, s62, 1
    s_cbranch_scc0 Lbs_6
    s_call_b64 s[68:69], L_flush
    s_branch Lbs_6
Lfd_0:
    s_call_b64 s[68:69], L_flush
    s_branch Lbd_0
Lfd_1:
    s_call_b64 s[68:69], L_flush
    s_branch Lbd_1
Lfd_2:
    s_call_b64 s[68:69], L_flush
    s_branch Lbd_2
Lfd_3:
    s_call_b64 s[68:69], L_flush
    s_branch Lbd_3
Lfd_4:
    s_call_b64 s[68:69], L_flush
    s_branch Lbd_4
Lfd_5:
    s_call_b64 s[68:69], L_flush
    s_branch Lbd_5
Lfd_6:
    s_call_b64 s[68:69], L_flush
    s_branch Lbd_6
L_dm0:
    s_mov_b64 vcc, 0
    s_cmp_eq_u32 s41, 0
    s_cbranch_scc0 L_dm0b
    ds_read_b32 v4, v12 offset:24
    s_waitcnt lgkmcnt(0)
    v_cmp_le_u32 vcc, 8, v4
    s_cbranch_vccz L_dm0b
    s_lshl_b32 s58, s4, 10
    v_lshl_add_u32 v72, v0, 4, s58
    s_and_b32 s58, s4, 4
    v_lshl_add_u32 v73, s58, 4, v72
    s_movk_i32 s58, 0x1f0
    v_bfi_b32 v72, s58, v73, v72
    s_mov_b32 s41, 1
    s_mov_b64 vcc, -1
    s_branch L_dm0b
Ldm_0:
    ds_write_b128 v72, v[96:99] offset:0
    ds_write_b128 v72, v[100:103] offset:8192
    s_branch Ldb_0
Ldm_2:
    ds_write_b128 v72, v[104:107] offset:16384
    ds_write_b128 v72, v[108:111] offset:24576
    s_branch Ldb_2
Ldm_4:
    ds_write_b128 v72, v[112:115] offset:32768
    ds_write_b128 v72, v[116:119] offset:40960
    s_branch Ldb_4
Ldm_6:
    ds_write_b128 v72, v[120:123] offset:49152
    ds_write_b128 v72, v[124:127] offset:57344
    s_mov_b64 exec, 1
    ds_inc_u32 v12, v12 offset:76
    s_mov_b64 exec, -1
    s_branch Ldb_6
L_flush:
    s_and_b32 s101, s65, 0x3ffff
    s_add_u32 s63, s63, 1
    v_permlane32_swap_b32 v56, v60
    v_permlane32_swap_b32 v57, v61
    v_permlane32_swap_b32 v58, v62
    v_permlane32_swap_b32 v59, v63
    s_lshr_b32 s62, s65, 26
    v_pk_add_f32 v[56:57], v[56:57], v[60:61]
    v_pk_add_f32 v[58:59], v[58:59], v[62:63]
    v_add_u32 v62, s101, v15
    v_pk_mul_f32 v[56:57], v[56:57], s[64:65] op_sel_hi:[1,0]
    v_pk_mul_f32 v[58:59], v[58:59], s[64:65] op_sel_hi:[1,0]
    v_lshl_add_u32 v63, s62, 2, v12
    v_cvt_pk_bf16_f32 v60, v56, v57
    v_cvt_pk_bf16_f32 v61, v58, v59
    ds_write_b64 v62, v[60:61]
    s_mov_b64 exec, 1
    ds_inc_u32 v63, v63 offset:36
    s_mov_b64 exec, -1
    v_readlane_b32 s65, v9, s63
    v_readlane_b32 s64, v8, s63
    v_mov_b64 v[56:57], 0
    v_mov_b64 v[58:59], 0
    v_mov_b64 v[60:61], 0
    v_mov_b64 v[62:63], 0
    s_bfe_u32 s62, s65, 0x80012
    s_setpc_b64 s[68:69]
L_preA:
    s_setprio 2
    s_mul_i32 s5, s6, 40
    v_mov_b32 v3, 160064
    s_mov_b32 s10, 5120000
    s_mov_b32 s11, 0x20000
    s_mov_b64 s[16:17], s[56:57]
    s_mov_b32 s18, 1441792
    s_mov_b32 s19, 0x20000
    v_and_b32 v6, 32, v0
    v_lshl_add_u32 v5, v6, 7, v2
    v_lshl_add_u32 v6, v6, 6, v2
    s_add_u32 s58, s3, s5
    s_mul_i32 s59, s3, 1056
    s_add_u32 m0, s59, 84480
    s_lshl_b32 s58, s58, 9
    buffer_load_dwordx4 v5, s[8:11], s58 offen lds
    s_add_u32 m0, s59, 92928
    s_add_u32 s58, s58, 8192
    s_waitcnt vmcnt(2)
    buffer_load_dwordx4 v5, s[8:11], s58 offen lds
    s_cmp_ge_u32 s3, 4
    s_cbranch_scc1 L_xa2
    s_add_u32 m0, s59, 101376
    s_add_u32 s58, s58, 8192
    s_waitcnt vmcnt(2)
    buffer_load_dwordx4 v6, s[8:11], s58 offen lds
L_xa2:
    v_and_b32 v4, 7, v0
    v_mul_u32_u24 v1, 1056, v4
    v_and_b32 v4, 8, v0
    v_lshl_add_u32 v1, v4, 6, v1
    v_and_b32 v4, 48, v0
    v_add_u32 v1, v4, v1
    v_add_u32 v12, 84480, v1
    s_mov_b64 s[20:21], s[52:53]
    s_mov_b32 s22, 5120000
    s_mov_b32 s23, 0x20000
    v_lshlrev_b32 v14, 4, v0
    s_lshl_b32 s61, s3, 6
    s_add_u32 s61, s61, 105600
    v_add_u32 v13, s61, v1
    s_lshl_b32 s100, s3, 14
    s_add_u32 s100, s100, 655360
    s_waitcnt lgkmcnt(0)
    v_lshl_add_u32 v104, s32, 9, v2
    v_lshl_add_u32 v105, s33, 9, v2
    v_lshl_add_u32 v106, s34, 9, v2
    v_lshl_add_u32 v107, s35, 9, v2
    v_lshl_add_u32 v108, s36, 9, v2
    v_lshl_add_u32 v109, s37, 9, v2
    v_lshl_add_u32 v110, s38, 9, v2
    v_lshl_add_u32 v111, s39, 9, v2
    v_lshl_add_u32 v112, s64, 9, v2
    v_lshl_add_u32 v113, s65, 9, v2
    s_mov_b32 exec_lo, 0
    v_lshl_add_u32 v104, s40, 9, v2
    v_lshl_add_u32 v105, s41, 9, v2
    v_lshl_add_u32 v106, s42, 9, v2
    v_lshl_add_u32 v107, s43, 9, v2
    v_lshl_add_u32 v108, s44, 9, v2
    v_lshl_add_u32 v109, s45, 9, v2
    v_lshl_add_u32 v110, s46, 9, v2
    v_lshl_add_u32 v111, s47, 9, v2
    v_lshl_add_u32 v112, s66, 9, v2
    v_lshl_add_u32 v113, s67, 9, v2
    s_mov_b64 exec, -1
    s_cmp_ge_u32 s2, 64
    s_cbranch_scc1 L_nopb
    s_barrier
    s_barrier
L_nopb:
    s_mul_i32 s67, s3, 2112
    s_mul_i32 s66, s3, 8448
    s_add_u32 m0, s66, 0
    s_waitcnt vmcnt(1)
    buffer_load_dwordx4 v104, s[8:11], 0 offen lds
    s_add_u32 m0, s66, 1056
    s_waitcnt vmcnt(1)
    buffer_load_dwordx4 v105, s[8:11], 0 offen lds
    v_and_b32 v4, 3, v0
    v_mov_b32 v5, 0x0c0c0c0c
    v_mov_b32 v6, 0x0c0c0302
    v_mov_b32 v7, 0x03020c0c
    v_cmp_eq_u32 s[58:59], 0, v4
    v_cmp_eq_u32 s[60:61], 2, v4
    v_cmp_eq_u32 vcc, 1, v4
    v_cndmask_b32 v8, v5, v6, s[58:59]
    v_cndmask_b32 v9, v5, v6, s[60:61]
    v_cndmask_b32 v8, v8, v7, vcc
    v_cmp_eq_u32 vcc, 3, v4
    s_nop 1
    v_cndmask_b32 v9, v9, v7, vcc
    v_mov_b32 v10, v8
    v_mov_b32 v11, v9
    v_and_b32 v8, 0xfdfdfdfd, v8
    v_and_b32 v9, 0xfdfdfdfd, v9
    s_add_u32 m0, s66, 2112
    s_waitcnt vmcnt(1)
    buffer_load_dwordx4 v106, s[8:11], 0 offen lds
    s_mov_b64 exec, 1
    v_mov_b32 v4, 1
    ds_add_u32 v3, v4 offset:0
    s_mov_b64 exec, -1
    s_add_u32 m0, s66, 3168
    s_waitcnt vmcnt(1)
    buffer_load_dwordx4 v107, s[8:11], 0 offen lds
    s_add_u32 m0, s66, 4224
    s_waitcnt vmcnt(1)
    buffer_load_dwordx4 v108, s[8:11], 0 offen lds
    s_mov_b32 s59, 0
Lw_32:
    ds_read_b32 v4, v3 offset:0
    s_waitcnt lgkmcnt(0)
    v_cmp_gt_u32 vcc, 8, v4
    s_cbranch_vccz Lk_33
    s_add_u32 s59, s59, 1
    s_cmp_lt_u32 s59, 4194304
    s_cbranch_scc1 Lw_32
    s_branch L_end
Lk_33:
    ds_read_b128 v[80:83], v12 offset:0
    ds_read_b128 v[84:87], v12 offset:8448
    ds_read_b128 v[88:91], v12 offset:16896
    s_add_u32 m0, s66, 5280
    s_waitcnt vmcnt(1)
    buffer_load_dwordx4 v109, s[8:11], 0 offen lds
    s_mov_b64 exec, 1
    v_mov_b32 v4, 1
    ds_add_u32 v3, v4 offset:60
    s_mov_b64 exec, -1
    s_waitcnt vmcnt(1)
    ds_read_b32 v4, v3 offset:52
    s_add_u32 m0, s66, 6336
    s_waitcnt vmcnt(1)
    buffer_load_dwordx4 v110, s[8:11], 0 offen lds
    s_mov_b32 s62, 7
    s_waitcnt lgkmcnt(0)
    v_cmp_gt_u32 vcc, 8, v4
    s_cbranch_vccz L_eu10
    s_waitcnt vmcnt(1)
    ds_read_b32 v4, v3 offset:52
    s_add_u32 m0, s66, 7392
    s_waitcnt vmcnt(1)
    buffer_load_dwordx4 v111, s[8:11], 0 offen lds
    s_mov_b32 s62, 8
    s_waitcnt lgkmcnt(0)
    v_cmp_gt_u32 vcc, 8, v4
    s_cbranch_vccz L_eu10
    s_waitcnt vmcnt(1)
    ds_read_b32 v4, v3 offset:52
    s_add_u32 m0, s67, 67584
    s_waitcnt vmcnt(1)
    buffer_load_dwordx4 v112, s[8:11], 0 offen lds
    s_mov_b32 s62, 9
    s_waitcnt lgkmcnt(0)
    v_cmp_gt_u32 vcc, 8, v4
    s_cbranch_vccz L_eu10
    s_waitcnt vmcnt(1)
    ds_read_b32 v4, v3 offset:52
    s_add_u32 m0, s67, 68640
    s_waitcnt vmcnt(1)
    buffer_load_dwordx4 v113, s[8:11], 0 offen lds
    s_mov_b32 s62, 10
    s_mov_b32 s59, 0
Lw_34:
    ds_read_b32 v4, v3 offset:52
    s_waitcnt lgkmcnt(0)
    v_cmp_gt_u32 vcc, 8, v4
    s_cbranch_vccz Lk_35
    s_sleep 1
    s_add_u32 s59, s59, 1
    s_cmp_lt_u32 s59, 4194304
    s_cbranch_scc1 Lw_34
    s_branch L_end
Lk_35:
L_eu10:
    s_setprio 3
    buffer_load_dwordx4 v[16:19], v14, s[16:19], s100 offen offset:0 sc1
    buffer_load_dwordx4 v[20:23], v14, s[16:19], s100 offen offset:1024 sc1
    buffer_load_dwordx4 v[24:27], v14, s[16:19], s100 offen offset:2048 sc1
    buffer_load_dwordx4 v[28:31], v14, s[16:19], s100 offen offset:3072 sc1
    s_add_u32 s100, s100, 4096
    buffer_load_dwordx4 v[32:35], v14, s[16:19], s100 offen offset:0 sc1
    s_cmp_gt_u32 s62, 7
    s_cbranch_scc1 Lem_36
    s_add_u32 m0, s66, 7392
    s_waitcnt vmcnt(63)
    buffer_load_dwordx4 v111, s[8:11], 0 offen lds
Lem_36:
    buffer_load_dwordx4 v[36:39], v14, s[16:19], s100 offen offset:1024 sc1
    buffer_load_dwordx4 v[40:43], v14, s[16:19], s100 offen offset:2048 sc1
    buffer_load_dwordx4 v[44:47], v14, s[16:19], s100 offen offset:3072 sc1
    s_add_u32 s100, s100, 4096
    buffer_load_dwordx4 v[48:51], v14, s[16:19], s100 offen offset:0 sc1
    buffer_load_dwordx4 v[52:55], v14, s[16:19], s100 offen offset:1024 sc1
    s_cmp_gt_u32 s62, 8
    s_cbranch_scc1 Lem_37
    s_add_u32 m0, s67, 67584
    s_waitcnt vmcnt(63)
    buffer_load_dwordx4 v112, s[8:11], 0 offen lds
Lem_37:
    buffer_load_dwordx4 v[56:59], v14, s[16:19], s100 offen offset:2048 sc1
    buffer_load_dwordx4 v[60:63], v14, s[16:19], s100 offen offset:3072 sc1
    s_add_u32 s100, s100, 4096
    buffer_load_dwordx4 v[64:67], v14, s[16:19], s100 offen offset:0 sc1
    buffer_load_dwordx4 v[68:71], v14, s[16:19], s100 offen offset:1024 sc1
    buffer_load_dwordx4 v[72:75], v14, s[16:19], s100 offen offset:2048 sc1
    buffer_load_dwordx4 v[76:79], v14, s[16:19], s100 offen offset:3072 sc1
    s_cmp_gt_u32 s62, 9
    s_cbranch_scc1 Lem_38
    s_add_u32 m0, s67, 68640
    s_waitcnt vmcnt(63)
    buffer_load_dwordx4 v113, s[8:11], 0 offen lds
Lem_38:
    s_setprio 0
    ds_read_b128 v[92:95], v12 offset:64
    ds_read_b128 v[96:99], v12 offset:8512
    ds_read_b128 v[100:103], v12 offset:16960
    s_waitcnt vmcnt(14) lgkmcnt(3)
    v_mfma_f32_16x16x32_bf16 v[104:107], v[16:19], v[80:83], 0
    v_mfma_f32_16x16x32_bf16 v[108:111], v[20:23], v[80:83], 0
    v_mfma_f32_16x16x32_bf16 v[112:115], v[16:19], v[84:87], 0
    v_mfma_f32_16x16x32_bf16 v[116:119], v[20:23], v[84:87], 0
    v_mfma_f32_16x16x32_bf16 v[120:123], v[16:19], v[88:91], 0
    v_mfma_f32_16x16x32_bf16 v[124:127], v[20:23], v[88:91], 0
    ds_read_b128 v[80:83], v12 offset:128
    ds_read_b128 v[84:87], v12 offset:8576
    ds_read_b128 v[88:91], v12 offset:17024
    s_waitcnt vmcnt(12) lgkmcnt(3)
    v_mfma_f32_16x16x32_bf16 v[104:107], v[24:27], v[92:95], v[104:107]
    v_mfma_f32_16x16x32_bf16 v[108:111], v[28:31], v[92:95], v[108:111]
    v_mfma_f32_16x16x32_bf16 v[112:115], v[24:27], v[96:99], v[112:115]
    v_mfma_f32_16x16x32_bf16 v[116:119], v[28:31], v[96:99], v[116:119]
    v_mfma_f32_16x16x32_bf16 v[120:123], v[24:27], v[100:103], v[120:123]
    v_mfma_f32_16x16x32_bf16 v[124:127], v[28:31], v[100:103], v[124:127]
    ds_read_b128 v[92:95], v12 offset:192
    ds_read_b128 v[96:99], v12 offset:8640
    ds_read_b128 v[100:103], v12 offset:17088
    s_waitcnt vmcnt(10) lgkmcnt(3)
    v_mfma_f32_16x16x32_bf16 v[104:107], v[32:35], v[80:83], v[104:107]
    v_mfma_f32_16x16x32_bf16 v[108:111], v[36:39], v[80:83], v[108:111]
    v_mfma_f32_16x16x32_bf16 v[112:115], v[32:35], v[84:87], v[112:115]
    v_mfma_f32_16x16x32_bf16 v[116:119], v[36:39], v[84:87], v[116:119]
    v_mfma_f32_16x16x32_bf16 v[120:123], v[32:35], v[88:91], v[120:123]
    v_mfma_f32_16x16x32_bf16 v[124:127], v[36:39], v[88:91], v[124:127]
    ds_read_b128 v[80:83], v12 offset:256
    ds_read_b128 v[84:87], v12 offset:8704
    ds_read_b128 v[88:91], v12 offset:17152
    s_waitcnt vmcnt(8) lgkmcnt(3)
    v_mfma_f32_16x16x32_bf16 v[104:107], v[40:43], v[92:95], v[104:107]
    v_mfma_f32_16x16x32_bf16 v[108:111], v[44:47], v[92:95], v[108:111]
    v_mfma_f32_16x16x32_bf16 v[112:115], v[40:43], v[96:99], v[112:115]
    v_mfma_f32_16x16x32_bf16 v[116:119], v[44:47], v[96:99], v[116:119]
    v_mfma_f32_16x16x32_bf16 v[120:123], v[40:43], v[100:103], v[120:123]
    v_mfma_f32_16x16x32_bf16 v[124:127], v[44:47], v[100:103], v[124:127]
    ds_read_b128 v[92:95], v12 offset:320
    ds_read_b128 v[96:99], v12 offset:8768
    ds_read_b128 v[100:103], v12 offset:17216
    s_waitcnt vmcnt(6) lgkmcnt(3)
    v_mfma_f32_16x16x32_bf16 v[104:107], v[48:51], v[80:83], v[104:107]
    v_mfma_f32_16x16x32_bf16 v[108:111], v[52:55], v[80:83], v[108:111]
    v_mfma_f32_16x16x32_bf16 v[112:115], v[48:51], v[84:87], v[112:115]
    v_mfma_f32_16x16x32_bf16 v[116:119], v[52:55], v[84:87], v[116:119]
    v_mfma_f32_16x16x32_bf16 v[120:123], v[48:51], v[88:91], v[120:123]
    v_mfma_f32_16x16x32_bf16 v[124:127], v[52:55], v[88:91], v[124:127]
    ds_read_b128 v[80:83], v12 offset:384
    ds_read_b128 v[84:87], v12 offset:8832
    ds_read_b128 v[88:91], v12 offset:17280
    s_waitcnt vmcnt(4) lgkmcnt(3)
    v_mfma_f32_16x16x32_bf16 v[104:107], v[56:59], v[92:95], v[104:107]
    v_mfma_f32_16x16x32_bf16 v[108:111], v[60:63], v[92:95], v[108:111]
    v_mfma_f32_16x16x32_bf16 v[112:115], v[56:59], v[96:99], v[112:115]
    v_mfma_f32_16x16x32_bf16 v[116:119], v[60:63], v[96:99], v[116:119]
    v_mfma_f32_16x16x32_bf16 v[120:123], v[56:59], v[100:103], v[120:123]
    v_mfma_f32_16x16x32_bf16 v[124:127], v[60:63], v[100:103], v[124:127]
    ds_read_b128 v[92:95], v12 offset:448
    ds_read_b128 v[96:99], v12 offset:8896
    ds_read_b128 v[100:103], v12 offset:17344
    s_waitcnt vmcnt(2) lgkmcnt(3)
    v_mfma_f32_16x16x32_bf16 v[104:107], v[64:67], v[80:83], v[104:107]
    v_mfma_f32_16x16x32_bf16 v[108:111], v[68:71], v[80:83], v[108:111]
    v_mfma_f32_16x16x32_bf16 v[112:115], v[64:67], v[84:87], v[112:115]
    v_mfma_f32_16x16x32_bf16 v[116:119], v[68:71], v[84:87], v[116:119]
    v_mfma_f32_16x16x32_bf16 v[120:123], v[64:67], v[88:91], v[120:123]
    v_mfma_f32_16x16x32_bf16 v[124:127], v[68:71], v[88:91], v[124:127]
    s_waitcnt vmcnt(0) lgkmcnt(0)
    v_mfma_f32_16x16x32_bf16 v[104:107], v[72:75], v[92:95], v[104:107]
    v_mfma_f32_16x16x32_bf16 v[108:111], v[76:79], v[92:95], v[108:111]
    v_mfma_f32_16x16x32_bf16 v[112:115], v[72:75], v[96:99], v[112:115]
    v_mfma_f32_16x16x32_bf16 v[116:119], v[76:79], v[96:99], v[116:119]
    v_mfma_f32_16x16x32_bf16 v[120:123], v[72:75], v[100:103], v[120:123]
    v_mfma_f32_16x16x32_bf16 v[124:127], v[76:79], v[100:103], v[124:127]
    s_nop 3
    v_cvt_pk_bf16_f32 v80, v104, v105
    v_cvt_pk_bf16_f32 v81, v106, v107
    v_cvt_pk_bf16_f32 v82, v108, v109
    v_cvt_pk_bf16_f32 v83, v110, v111
    ds_write_b128 v13, v[80:83] offset:0
    v_cvt_pk_bf16_f32 v84, v112, v113
    v_cvt_pk_bf16_f32 v85, v114, v115
    v_cvt_pk_bf16_f32 v86, v116, v117
    v_cvt_pk_bf16_f32 v87, v118, v119
    ds_write_b128 v13, v[84:87] offset:8448
    v_cvt_pk_bf16_f32 v88, v120, v121
    v_cvt_pk_bf16_f32 v89, v122, v123
    v_cvt_pk_bf16_f32 v90, v124, v125
    v_cvt_pk_bf16_f32 v91, v126, v127
    ds_write_b128 v13, v[88:91] offset:16896
    s_mov_b64 exec, 1
    v_mov_b32 v4, 1
    ds_add_u32 v3, v4 offset:20
    s_mov_b64 exec, -1
    s_setprio 3
    s_add_u32 s100, s100, 118784
    buffer_load_dwordx4 v[16:19], v14, s[16:19], s100 offen offset:0 sc1
    buffer_load_dwordx4 v[20:23], v14, s[16:19], s100 offen offset:1024 sc1
    buffer_load_dwordx4 v[24:27], v14, s[16:19], s100 offen offset:2048 sc1
    buffer_load_dwordx4 v[28:31], v14, s[16:19], s100 offen offset:3072 sc1
    s_add_u32 s100, s100, 4096
    buffer_load_dwordx4 v[32:35], v14, s[16:19], s100 offen offset:0 sc1
    buffer_load_dwordx4 v[36:39], v14, s[16:19], s100 offen offset:1024 sc1
    buffer_load_dwordx4 v[40:43], v14, s[16:19], s100 offen offset:2048 sc1
    buffer_load_dwordx4 v[44:47], v14, s[16:19], s100 offen offset:3072 sc1
    s_add_u32 s100, s100, 4096
    buffer_load_dwordx4 v[48:51], v14, s[16:19], s100 offen offset:0 sc1
    buffer_load_dwordx4 v[52:55], v14, s[16:19], s100 offen offset:1024 sc1
    buffer_load_dwordx4 v[56:59], v14, s[16:19], s100 offen offset:2048 sc1
    buffer_load_dwordx4 v[60:63], v14, s[16:19], s100 offen offset:3072 sc1
    s_add_u32 s100, s100, 4096
    buffer_load_dwordx4 v[64:67], v14, s[16:19], s100 offen offset:0 sc1
    buffer_load_dwordx4 v[68:71], v14, s[16:19], s100 offen offset:1024 sc1
    buffer_load_dwordx4 v[72:75], v14, s[16:19], s100 offen offset:2048 sc1
    buffer_load_dwordx4 v[76:79], v14, s[16:19], s100 offen offset:3072 sc1
    s_setprio 0
L_late1:
    s_mov_b32 s63, s3
L_grp:
    s_mul_i32 s58, s63, 8448
    s_lshr_b32 s59, s63, 2
    s_mul_i32 s59, s59, 8448
    s_and_b32 s60, s63, 1
    s_bfe_u32 s61, s63, 0x10001
    s_cmp_ge_u32 s63, 8
    s_cselect_b32 s61, s60, s61
    s_cselect_b32 s60, 0, s60
    s_mul_i32 s60, s60, 4224
    s_lshl_b32 s61, s61, 9
    s_add_u32 s59, s59, s60
    s_add_u32 s59, s59, s61
    s_add_u32 s59, s59, 105600
    v_add_u32 v12, s58, v1
    v_bfe_u32 v4, v0, 2, 2
    v_mul_u32_u24 v4, 1056, v4
    v_and_b32 v5, 48, v0
    v_add3_u32 v13, v4, v5, s59
    v_lshl_add_u32 v14, v0, 3, s58
    v_lshl_add_u32 v2, v0, 3, s59
    s_cmp_ge_u32 s63, 8
    s_cbranch_scc1 L_grp2
    s_mov_b32 s59, 0
Lw_39:
    ds_read_b32 v4, v3 offset:20
    s_waitcnt lgkmcnt(0)
    v_cmp_gt_u32 vcc, 8, v4
    s_cbranch_vccz Lk_40
    s_sleep 1
    s_add_u32 s59, s59, 1
    s_cmp_lt_u32 s59, 4194304
    s_cbranch_scc1 Lw_39
    s_branch L_end
Lk_40:
L_grp2:
    s_waitcnt lgkmcnt(0)
    ds_read_b128 v[80:83], v12 offset:0
    ds_read_b128 v[84:87], v13 offset:0
    ds_read_b128 v[88:91], v12 offset:64
    ds_read_b128 v[92:95], v13 offset:64
    ds_read_b128 v[96:99], v12 offset:128
    ds_read_b128 v[100:103], v13 offset:128
    ds_read_b128 v[104:107], v12 offset:192
    ds_read_b128 v[108:111], v13 offset:192
    ds_read_b128 v[112:115], v12 offset:256
    ds_read_b128 v[116:119], v13 offset:256
    ds_read_b128 v[120:123], v12 offset:320
    ds_read_b128 v[124:127], v13 offset:320
    s_waitcnt lgkmcnt(10)
    v_mfma_f32_16x16x32_bf16 v[4:7], v[80:83], v[84:87], 0
    ds_read_b128 v[80:83], v12 offset:384
    ds_read_b128 v[84:87], v13 offset:384
    s_waitcnt lgkmcnt(10)
    v_mfma_f32_16x16x32_bf16 v[4:7], v[88:91], v[92:95], v[4:7]
    ds_read_b128 v[88:91], v12 offset:448
    ds_read_b128 v[92:95], v13 offset:448
    s_waitcnt lgkmcnt(10)
    v_mfma_f32_16x16x32_bf16 v[4:7], v[96:99], v[100:103], v[4:7]
    s_waitcnt lgkmcnt(8)
    v_mfma_f32_16x16x32_bf16 v[4:7], v[104:107], v[108:111], v[4:7]
    s_waitcnt lgkmcnt(6)
    v_mfma_f32_16x16x32_bf16 v[4:7], v[112:115], v[116:119], v[4:7]
    s_waitcnt lgkmcnt(4)
    v_mfma_f32_16x16x32_bf16 v[4:7], v[120:123], v[124:127], v[4:7]
    s_waitcnt lgkmcnt(2)
    v_mfma_f32_16x16x32_bf16 v[4:7], v[80:83], v[84:87], v[4:7]
    s_waitcnt lgkmcnt(0)
    v_mfma_f32_16x16x32_bf16 v[4:7], v[88:91], v[92:95], v[4:7]
    ds_read_b64 v[96:97], v14 offset:2112
    ds_read_b64 v[98:99], v14 offset:6336
    ds_read_b64 v[100:101], v14 offset:2624
    ds_read_b64 v[102:103], v14 offset:6848
    ds_read_b64 v[104:105], v14 offset:3168
    ds_read_b64 v[106:107], v14 offset:7392
    ds_read_b64 v[108:109], v14 offset:3680
    ds_read_b64 v[110:111], v14 offset:7904
    ds_read_b64 v[80:81], v14 offset:0
    ds_read_b64 v[82:83], v14 offset:4224
    ds_read_b64 v[84:85], v14 offset:512
    ds_read_b64 v[86:87], v14 offset:4736
    ds_read_b64 v[88:89], v14 offset:1056
    ds_read_b64 v[90:91], v14 offset:5280
    ds_read_b64 v[92:93], v14 offset:1568
    s_waitcnt lgkmcnt(14)
    ds_read_b64 v[94:95], v14 offset:5792
    v_mul_f32 v4, 0x3db8aa3b, v4
    v_mul_f32 v5, 0x3db8aa3b, v5
    v_mul_f32 v6, 0x3db8aa3b, v6
    v_mul_f32 v7, 0x3db8aa3b, v7
    v_exp_f32 v4, v4
    v_exp_f32 v5, v5
    v_exp_f32 v6, v6
    v_exp_f32 v7, v7
    v_add_f32 v12, v4, v5
    v_add_f32 v13, v6, v7
    v_add_f32 v12, v12, v13
    v_add_f32 v12, 0x3089705f, v12
    v_rcp_f32 v12, v12
    s_add_u32 s63, s63, 8
    v_mul_f32 v4, v4, v12
    v_mul_f32 v5, v5, v12
    v_mul_f32 v6, v6, v12
    v_mul_f32 v7, v7, v12
    v_cvt_pk_bf16_f32 v4, v4, v5
    v_cvt_pk_bf16_f32 v6, v6, v7
    v_perm_b32 v112, v4, v4, v8
    v_perm_b32 v113, v4, v4, v9
    v_perm_b32 v114, v4, v4, v10
    v_perm_b32 v115, v4, v4, v11
    v_perm_b32 v116, v6, v6, v8
    v_perm_b32 v117, v6, v6, v9
    v_perm_b32 v118, v6, v6, v10
    v_perm_b32 v119, v6, v6, v11
    s_waitcnt lgkmcnt(0)
    v_mfma_f32_4x4x4_16b_bf16 v[120:123], v[112:113], v[80:81], 0 cbsz:4 abid:0
    v_mfma_f32_4x4x4_16b_bf16 v[124:127], v[112:113], v[82:83], 0 cbsz:4 abid:5
    v_mfma_f32_4x4x4_16b_bf16 v[4:7], v[112:113], v[84:85], 0 cbsz:4 abid:10
    v_mfma_f32_4x4x4_16b_bf16 v[12:15], v[112:113], v[86:87], 0 cbsz:4 abid:15
    v_mfma_f32_4x4x4_16b_bf16 v[120:123], v[114:115], v[88:89], v[120:123] cbsz:4 abid:0
    v_mfma_f32_4x4x4_16b_bf16 v[124:127], v[114:115], v[90:91], v[124:127] cbsz:4 abid:5
    v_mfma_f32_4x4x4_16b_bf16 v[4:7], v[114:115], v[92:93], v[4:7] cbsz:4 abid:10
    v_mfma_f32_4x4x4_16b_bf16 v[12:15], v[114:115], v[94:95], v[12:15] cbsz:4 abid:15
    v_mfma_f32_4x4x4_16b_bf16 v[120:123], v[116:117], v[96:97], v[120:123] cbsz:4 abid:0
    v_mfma_f32_4x4x4_16b_bf16 v[124:127], v[116:117], v[98:99], v[124:127] cbsz:4 abid:5
    v_mfma_f32_4x4x4_16b_bf16 v[4:7], v[116:117], v[100:101], v[4:7] cbsz:4 abid:10
    v_mfma_f32_4x4x4_16b_bf16 v[12:15], v[116:117], v[102:103], v[12:15] cbsz:4 abid:15
    v_mfma_f32_4x4x4_16b_bf16 v[120:123], v[118:119], v[104:105], v[120:123] cbsz:4 abid:0
    v_mfma_f32_4x4x4_16b_bf16 v[124:127], v[118:119], v[106:107], v[124:127] cbsz:4 abid:5
    v_mfma_f32_4x4x4_16b_bf16 v[4:7], v[118:119], v[108:109], v[4:7] cbsz:4 abid:10
    v_mfma_f32_4x4x4_16b_bf16 v[12:15], v[118:119], v[110:111], v[12:15] cbsz:4 abid:15
    s_nop 1
    v_cvt_pk_bf16_f32 v112, v120, v121
    v_cvt_pk_bf16_f32 v113, v122, v123
    ds_write_b64 v2, v[112:113] offset:0
    v_cvt_pk_bf16_f32 v114, v124, v125
    v_cvt_pk_bf16_f32 v115, v126, v127
    ds_write_b64 v2, v[114:115] offset:1056
    v_cvt_pk_bf16_f32 v116, v4, v5
    v_cvt_pk_bf16_f32 v117, v6, v7
    ds_write_b64 v2, v[116:117] offset:2112
    v_cvt_pk_bf16_f32 v118, v12, v13
    v_cvt_pk_bf16_f32 v119, v14, v15
    ds_write_b64 v2, v[118:119] offset:3168
    s_cmp_lt_u32 s63, 10
    s_cbranch_scc1 L_grp
L_grpx:
    s_mov_b64 exec, 1
    v_mov_b32 v4, 1
    ds_add_u32 v3, v4 offset:24
    s_mov_b64 exec, -1
    v_add_u32 v12, 105600, v1
    v_lshlrev_b32 v14, 4, v0
    v_and_b32 v6, 15, v0
    v_lshlrev_b32 v6, 2, v6
    v_and_b32 v5, 48, v0
    v_lshl_add_u32 v8, v5, 7, v6
    v_and_b32 v5, 32, v0
    v_lshl_add_u32 v9, v5, 6, v6
    v_and_b32 v5, 16, v0
    v_lshl_add_u32 v9, v5, 22, v9
    s_lshl_b32 s60, s5, 9
    s_lshl_b32 s61, s3, 6
    s_add_u32 s60, s60, s61
    s_mov_b32 s59, 0
Lw_41:
    ds_read_b32 v4, v3 offset:24
    s_waitcnt lgkmcnt(0)
    v_cmp_gt_u32 vcc, 8, v4
    s_cbranch_vccz Lk_42
    s_sleep 1
    s_add_u32 s59, s59, 1
    s_cmp_lt_u32 s59, 4194304
    s_cbranch_scc1 Lw_41
    s_branch L_end
Lk_42:
    ds_read_b128 v[80:83], v12 offset:0
    ds_read_b128 v[84:87], v12 offset:8448
    ds_read_b128 v[88:91], v12 offset:16896
    ds_read_b128 v[92:95], v12 offset:64
    ds_read_b128 v[96:99], v12 offset:8512
    ds_read_b128 v[100:103], v12 offset:16960
    s_waitcnt vmcnt(14) lgkmcnt(3)
    v_mfma_f32_16x16x32_bf16 v[104:107], v[80:83], v[16:19], 0
    v_mfma_f32_16x16x32_bf16 v[108:111], v[80:83], v[20:23], 0
    v_mfma_f32_16x16x32_bf16 v[112:115], v[84:87], v[16:19], 0
    v_mfma_f32_16x16x32_bf16 v[116:119], v[84:87], v[20:23], 0
    v_mfma_f32_16x16x32_bf16 v[120:123], v[88:91], v[16:19], 0
    v_mfma_f32_16x16x32_bf16 v[124:127], v[88:91], v[20:23], 0
    ds_read_b128 v[80:83], v12 offset:128
    ds_read_b128 v[84:87], v12 offset:8576
    ds_read_b128 v[88:91], v12 offset:17024
    s_waitcnt vmcnt(12) lgkmcnt(3)
    v_mfma_f32_16x16x32_bf16 v[104:107], v[92:95], v[24:27], v[104:107]
    v_mfma_f32_16x16x32_bf16 v[108:111], v[92:95], v[28:31], v[108:111]
    v_mfma_f32_16x16x32_bf16 v[112:115], v[96:99], v[24:27], v[112:115]
    v_mfma_f32_16x16x32_bf16 v[116:119], v[96:99], v[28:31], v[116:119]
    v_mfma_f32_16x16x32_bf16 v[120:123], v[100:103], v[24:27], v[120:123]
    v_mfma_f32_16x16x32_bf16 v[124:127], v[100:103], v[28:31], v[124:127]
    ds_read_b128 v[92:95], v12 offset:192
    ds_read_b128 v[96:99], v12 offset:8640
    ds_read_b128 v[100:103], v12 offset:17088
    s_waitcnt vmcnt(10) lgkmcnt(3)
    v_mfma_f32_16x16x32_bf16 v[104:107], v[80:83], v[32:35], v[104:107]
    v_mfma_f32_16x16x32_bf16 v[108:111], v[80:83], v[36:39], v[108:111]
    v_mfma_f32_16x16x32_bf16 v[112:115], v[84:87], v[32:35], v[112:115]
    v_mfma_f32_16x16x32_bf16 v[116:119], v[84:87], v[36:39], v[116:119]
    v_mfma_f32_16x16x32_bf16 v[120:123], v[88:91], v[32:35], v[120:123]
    v_mfma_f32_16x16x32_bf16 v[124:127], v[88:91], v[36:39], v[124:127]
    ds_read_b128 v[80:83], v12 offset:256
    ds_read_b128 v[84:87], v12 offset:8704
    ds_read_b128 v[88:91], v12 offset:17152
    s_waitcnt vmcnt(8) lgkmcnt(3)
    v_mfma_f32_16x16x32_bf16 v[104:107], v[92:95], v[40:43], v[104:107]
    v_mfma_f32_16x16x32_bf16 v[108:111], v[92:95], v[44:47], v[108:111]
    v_mfma_f32_16x16x32_bf16 v[112:115], v[96:99], v[40:43], v[112:115]
    v_mfma_f32_16x16x32_bf16 v[116:119], v[96:99], v[44:47], v[116:119]
    v_mfma_f32_16x16x32_bf16 v[120:123], v[100:103], v[40:43], v[120:123]
    v_mfma_f32_16x16x32_bf16 v[124:127], v[100:103], v[44:47], v[124:127]
    ds_read_b128 v[92:95], v12 offset:320
    ds_read_b128 v[96:99], v12 offset:8768
    ds_read_b128 v[100:103], v12 offset:17216
    s_waitcnt vmcnt(6) lgkmcnt(3)
    v_mfma_f32_16x16x32_bf16 v[104:107], v[80:83], v[48:51], v[104:107]
    v_mfma_f32_16x16x32_bf16 v[108:111], v[80:83], v[52:55], v[108:111]
    v_mfma_f32_16x16x32_bf16 v[112:115], v[84:87], v[48:51], v[112:115]
    v_mfma_f32_16x16x32_bf16 v[116:119], v[84:87], v[52:55], v[116:119]
    v_mfma_f32_16x16x32_bf16 v[120:123], v[88:91], v[48:51], v[120:123]
    v_mfma_f32_16x16x32_bf16 v[124:127], v[88:91], v[52:55], v[124:127]
    ds_read_b128 v[80:83], v12 offset:384
    ds_read_b128 v[84:87], v12 offset:8832
    ds_read_b128 v[88:91], v12 offset:17280
    s_waitcnt vmcnt(4) lgkmcnt(3)
    v_mfma_f32_16x16x32_bf16 v[104:107], v[92:95], v[56:59], v[104:107]
    v_mfma_f32_16x16x32_bf16 v[108:111], v[92:95], v[60:63], v[108:111]
    v_mfma_f32_16x16x32_bf16 v[112:115], v[96:99], v[56:59], v[112:115]
    v_mfma_f32_16x16x32_bf16 v[116:119], v[96:99], v[60:63], v[116:119]
    v_mfma_f32_16x16x32_bf16 v[120:123], v[100:103], v[56:59], v[120:123]
    v_mfma_f32_16x16x32_bf16 v[124:127], v[100:103], v[60:63], v[124:127]
    ds_read_b128 v[92:95], v12 offset:448
    ds_read_b128 v[96:99], v12 offset:8896
    ds_read_b128 v[100:103], v12 offset:17344
    s_waitcnt vmcnt(2) lgkmcnt(3)
    v_mfma_f32_16x16x32_bf16 v[104:107], v[80:83], v[64:67], v[104:107]
    v_mfma_f32_16x16x32_bf16 v[108:111], v[80:83], v[68:71], v[108:111]
    v_mfma_f32_16x16x32_bf16 v[112:115], v[84:87], v[64:67], v[112:115]
    v_mfma_f32_16x16x32_bf16 v[116:119], v[84:87], v[68:71], v[116:119]
    v_mfma_f32_16x16x32_bf16 v[120:123], v[88:91], v[64:67], v[120:123]
    v_mfma_f32_16x16x32_bf16 v[124:127], v[88:91], v[68:71], v[124:127]
    s_waitcnt vmcnt(0) lgkmcnt(0)
    v_mfma_f32_16x16x32_bf16 v[104:107], v[92:95], v[72:75], v[104:107]
    v_mfma_f32_16x16x32_bf16 v[108:111], v[92:95], v[76:79], v[108:111]
    v_mfma_f32_16x16x32_bf16 v[112:115], v[96:99], v[72:75], v[112:115]
    v_mfma_f32_16x16x32_bf16 v[116:119], v[96:99], v[76:79], v[116:119]
    v_mfma_f32_16x16x32_bf16 v[120:123], v[100:103], v[72:75], v[120:123]
    v_mfma_f32_16x16x32_bf16 v[124:127], v[100:103], v[76:79], v[124:127]
    s_add_u32 s100, s100, 122880
    s_setprio 3
    s_add_u32 s100, s100, 4096
    buffer_load_dwordx4 v[48:51], v14, s[16:19], s100 offen offset:0 sc1
    buffer_load_dwordx4 v[52:55], v14, s[16:19], s100 offen offset:1024 sc1
    buffer_load_dwordx4 v[56:59], v14, s[16:19], s100 offen offset:2048 sc1
    buffer_load_dwordx4 v[60:63], v14, s[16:19], s100 offen offset:3072 sc1
    s_add_u32 s100, s100, 4096
    buffer_load_dwordx4 v[64:67], v14, s[16:19], s100 offen offset:0 sc1
    buffer_load_dwordx4 v[68:71], v14, s[16:19], s100 offen offset:1024 sc1
    buffer_load_dwordx4 v[72:75], v14, s[16:19], s100 offen offset:2048 sc1
    buffer_load_dwordx4 v[76:79], v14, s[16:19], s100 offen offset:3072 sc1
    s_setprio 0
    v_and_b32 v5, 15, v0
    v_lshlrev_b32 v5, 2, v5
    v_and_b32 v6, 16, v0
    v_lshl_add_u32 v5, v6, 2, v5
    s_lshl_b32 s58, s3, 6
    v_add_u32 v5, s58, v5
    v_and_b32 v5, 0x1ff, v5
    v_and_b32 v6, 48, v0
    v_lshl_add_u32 v5, v6, 8, v5
    s_mov_b32 s70, 0x05040100
    s_mov_b32 s71, 0x07060302
    s_mov_b32 s59, 0
Lw_43:
    ds_read_b32 v4, v3 offset:76
    s_waitcnt lgkmcnt(0)
    v_cmp_gt_u32 vcc, 8, v4
    s_cbranch_vccz Lk_44
    s_sleep 2
    s_add_u32 s59, s59, 1
    s_cmp_lt_u32 s59, 16777216
    s_cbranch_scc1 Lw_43
    s_branch L_end
Lk_44:
    ds_read2st64_b32 v[24:25], v5 offset0:0 offset1:2
    ds_read2st64_b32 v[26:27], v5 offset0:4 offset1:6
    ds_read2st64_b32 v[28:29], v5 offset0:8 offset1:10
    ds_read2st64_b32 v[30:31], v5 offset0:12 offset1:14
    ds_read2st64_b32 v[32:33], v5 offset0:64 offset1:66
    ds_read2st64_b32 v[34:35], v5 offset0:68 offset1:70
    ds_read2st64_b32 v[36:37], v5 offset0:72 offset1:74
    ds_read2st64_b32 v[38:39], v5 offset0:76 offset1:78
    ds_read2st64_b32 v[40:41], v5 offset0:128 offset1:130
    ds_read2st64_b32 v[42:43], v5 offset0:132 offset1:134
    ds_read2st64_b32 v[44:45], v5 offset0:136 offset1:138
    ds_read2st64_b32 v[46:47], v5 offset0:140 offset1:142
    s_waitcnt lgkmcnt(8)
    ds_read2st64_b32 v[80:81], v5 offset0:192 offset1:194
    ds_read2st64_b32 v[82:83], v5 offset0:196 offset1:198
    ds_read2st64_b32 v[84:85], v5 offset0:200 offset1:202
    ds_read2st64_b32 v[86:87], v5 offset0:204 offset1:206
    v_perm_b32 v16, v25, v24, s70
    v_perm_b32 v20, v25, v24, s71
    v_perm_b32 v17, v27, v26, s70
    v_perm_b32 v21, v27, v26, s71
    v_perm_b32 v18, v29, v28, s70
    v_perm_b32 v22, v29, v28, s71
    v_perm_b32 v19, v31, v30, s70
    v_perm_b32 v23, v31, v30, s71
    s_waitcnt lgkmcnt(8)
    v_perm_b32 v24, v33, v32, s70
    v_perm_b32 v28, v33, v32, s71
    v_perm_b32 v25, v35, v34, s70
    v_perm_b32 v29, v35, v34, s71
    v_perm_b32 v26, v37, v36, s70
    v_perm_b32 v30, v37, v36, s71
    v_perm_b32 v27, v39, v38, s70
    v_perm_b32 v31, v39, v38, s71
    s_waitcnt lgkmcnt(4)
    v_perm_b32 v32, v41, v40, s70
    v_perm_b32 v36, v41, v40, s71
    v_perm_b32 v33, v43, v42, s70
    v_perm_b32 v37, v43, v42, s71
    v_perm_b32 v34, v45, v44, s70
    v_perm_b32 v38, v45, v44, s71
    v_perm_b32 v35, v47, v46, s70
    v_perm_b32 v39, v47, v46, s71
    s_waitcnt lgkmcnt(0)
    v_perm_b32 v40, v81, v80, s70
    v_perm_b32 v44, v81, v80, s71
    v_perm_b32 v41, v83, v82, s70
    v_perm_b32 v45, v83, v82, s71
    v_perm_b32 v42, v85, v84, s70
    v_perm_b32 v46, v85, v84, s71
    v_perm_b32 v43, v87, v86, s70
    v_perm_b32 v47, v87, v86, s71
    v_add_u32 v12, 130944, v1
    s_mov_b32 s59, 0
Lw_45:
    ds_read_b32 v4, v3 offset:36
    s_waitcnt lgkmcnt(0)
    v_cmp_gt_u32 vcc, 16, v4
    s_cbranch_vccz Lk_46
    s_sleep 3
    s_add_u32 s59, s59, 1
    s_cmp_lt_u32 s59, 16777216
    s_cbranch_scc1 Lw_45
    s_branch L_end
Lk_46:
    ds_read_b128 v[80:83], v12 offset:0
    ds_read_b128 v[84:87], v12 offset:64
    ds_read_b128 v[88:91], v12 offset:128
    ds_read_b128 v[92:95], v12 offset:192
    ds_read_b128 v[96:99], v12 offset:256
    ds_read_b128 v[100:103], v12 offset:320
    s_waitcnt vmcnt(14) lgkmcnt(5)
    v_mfma_f32_16x16x32_bf16 v[104:107], v[80:83], v[16:19], v[104:107]
    v_mfma_f32_16x16x32_bf16 v[108:111], v[80:83], v[20:23], v[108:111]
    ds_read_b128 v[80:83], v12 offset:384
    s_waitcnt vmcnt(12) lgkmcnt(5)
    v_mfma_f32_16x16x32_bf16 v[104:107], v[84:87], v[24:27], v[104:107]
    v_mfma_f32_16x16x32_bf16 v[108:111], v[84:87], v[28:31], v[108:111]
    ds_read_b128 v[84:87], v12 offset:448
    s_waitcnt vmcnt(10) lgkmcnt(5)
    v_mfma_f32_16x16x32_bf16 v[104:107], v[88:91], v[32:35], v[104:107]
    v_mfma_f32_16x16x32_bf16 v[108:111], v[88:91], v[36:39], v[108:111]
    s_waitcnt vmcnt(8) lgkmcnt(4)
    v_mfma_f32_16x16x32_bf16 v[104:107], v[92:95], v[40:43], v[104:107]
    v_mfma_f32_16x16x32_bf16 v[108:111], v[92:95], v[44:47], v[108:111]
    s_waitcnt vmcnt(6) lgkmcnt(3)
    v_mfma_f32_16x16x32_bf16 v[104:107], v[96:99], v[48:51], v[104:107]
    v_mfma_f32_16x16x32_bf16 v[108:111], v[96:99], v[52:55], v[108:111]
    s_waitcnt vmcnt(4) lgkmcnt(2)
    v_mfma_f32_16x16x32_bf16 v[104:107], v[100:103], v[56:59], v[104:107]
    v_mfma_f32_16x16x32_bf16 v[108:111], v[100:103], v[60:63], v[108:111]
    s_waitcnt vmcnt(2) lgkmcnt(1)
    v_mfma_f32_16x16x32_bf16 v[104:107], v[80:83], v[64:67], v[104:107]
    v_mfma_f32_16x16x32_bf16 v[108:111], v[80:83], v[68:71], v[108:111]
    s_waitcnt vmcnt(0) lgkmcnt(0)
    v_mfma_f32_16x16x32_bf16 v[104:107], v[84:87], v[72:75], v[104:107]
    v_mfma_f32_16x16x32_bf16 v[108:111], v[84:87], v[76:79], v[108:111]
    s_nop 7
    v_cvt_pk_bf16_f32 v104, v104, v108
    buffer_store_dword v104, v8, s[20:23], s60 offen offset:0 sc1
    v_cvt_pk_bf16_f32 v105, v105, v109
    buffer_store_dword v105, v8, s[20:23], s60 offen offset:512 sc1
    v_cvt_pk_bf16_f32 v106, v106, v110
    buffer_store_dword v106, v8, s[20:23], s60 offen offset:1024 sc1
    v_cvt_pk_bf16_f32 v107, v107, v111
    buffer_store_dword v107, v8, s[20:23], s60 offen offset:1536 sc1
    s_add_u32 s60, s60, 8192
    s_mov_b32 s59, 0
Lw_47:
    ds_read_b32 v4, v3 offset:40
    s_waitcnt lgkmcnt(0)
    v_cmp_gt_u32 vcc, 16, v4
    s_cbranch_vccz Lk_48
    s_sleep 3
    s_add_u32 s59, s59, 1
    s_cmp_lt_u32 s59, 16777216
    s_cbranch_scc1 Lw_47
    s_branch L_end
Lk_48:
    ds_read_b128 v[80:83], v12 offset:8448
    ds_read_b128 v[84:87], v12 offset:8512
    ds_read_b128 v[88:91], v12 offset:8576
    ds_read_b128 v[92:95], v12 offset:8640
    ds_read_b128 v[96:99], v12 offset:8704
    ds_read_b128 v[100:103], v12 offset:8768
    s_waitcnt lgkmcnt(5)
    v_mfma_f32_16x16x32_bf16 v[112:115], v[80:83], v[16:19], v[112:115]
    v_mfma_f32_16x16x32_bf16 v[116:119], v[80:83], v[20:23], v[116:119]
    ds_read_b128 v[80:83], v12 offset:8832
    s_waitcnt lgkmcnt(5)
    v_mfma_f32_16x16x32_bf16 v[112:115], v[84:87], v[24:27], v[112:115]
    v_mfma_f32_16x16x32_bf16 v[116:119], v[84:87], v[28:31], v[116:119]
    ds_read_b128 v[84:87], v12 offset:8896
    s_waitcnt lgkmcnt(5)
    v_mfma_f32_16x16x32_bf16 v[112:115], v[88:91], v[32:35], v[112:115]
    v_mfma_f32_16x16x32_bf16 v[116:119], v[88:91], v[36:39], v[116:119]
    s_waitcnt lgkmcnt(4)
    v_mfma_f32_16x16x32_bf16 v[112:115], v[92:95], v[40:43], v[112:115]
    v_mfma_f32_16x16x32_bf16 v[116:119], v[92:95], v[44:47], v[116:119]
    s_waitcnt lgkmcnt(3)
    v_mfma_f32_16x16x32_bf16 v[112:115], v[96:99], v[48:51], v[112:115]
    v_mfma_f32_16x16x32_bf16 v[116:119], v[96:99], v[52:55], v[116:119]
    s_waitcnt lgkmcnt(2)
    v_mfma_f32_16x16x32_bf16 v[112:115], v[100:103], v[56:59], v[112:115]
    v_mfma_f32_16x16x32_bf16 v[116:119], v[100:103], v[60:63], v[116:119]
    s_waitcnt lgkmcnt(1)
    v_mfma_f32_16x16x32_bf16 v[112:115], v[80:83], v[64:67], v[112:115]
    v_mfma_f32_16x16x32_bf16 v[116:119], v[80:83], v[68:71], v[116:119]
    s_waitcnt lgkmcnt(0)
    v_mfma_f32_16x16x32_bf16 v[112:115], v[84:87], v[72:75], v[112:115]
    v_mfma_f32_16x16x32_bf16 v[116:119], v[84:87], v[76:79], v[116:119]
    s_nop 7
    v_cvt_pk_bf16_f32 v112, v112, v116
    buffer_store_dword v112, v8, s[20:23], s60 offen offset:0 sc1
    v_cvt_pk_bf16_f32 v113, v113, v117
    buffer_store_dword v113, v8, s[20:23], s60 offen offset:512 sc1
    v_cvt_pk_bf16_f32 v114, v114, v118
    buffer_store_dword v114, v8, s[20:23], s60 offen offset:1024 sc1
    v_cvt_pk_bf16_f32 v115, v115, v119
    buffer_store_dword v115, v8, s[20:23], s60 offen offset:1536 sc1
    s_add_u32 s60, s60, 8192
    s_mov_b32 s59, 0
Lw_49:
    ds_read_b32 v4, v3 offset:44
    s_waitcnt lgkmcnt(0)
    v_cmp_gt_u32 vcc, 8, v4
    s_cbranch_vccz Lk_50
    s_add_u32 s59, s59, 1
    s_cmp_lt_u32 s59, 16777216
    s_cbranch_scc1 Lw_49
    s_branch L_end
Lk_50:
    ds_read_b128 v[80:83], v12 offset:16896
    ds_read_b128 v[84:87], v12 offset:16960
    ds_read_b128 v[88:91], v12 offset:17024
    ds_read_b128 v[92:95], v12 offset:17088
    ds_read_b128 v[96:99], v12 offset:17152
    ds_read_b128 v[100:103], v12 offset:17216
    s_waitcnt lgkmcnt(5)
    v_mfma_f32_16x16x32_bf16 v[120:123], v[80:83], v[16:19], v[120:123]
    v_mfma_f32_16x16x32_bf16 v[124:127], v[80:83], v[20:23], v[124:127]
    ds_read_b128 v[80:83], v12 offset:17280
    s_waitcnt lgkmcnt(5)
    v_mfma_f32_16x16x32_bf16 v[120:123], v[84:87], v[24:27], v[120:123]
    v_mfma_f32_16x16x32_bf16 v[124:127], v[84:87], v[28:31], v[124:127]
    ds_read_b128 v[84:87], v12 offset:17344
    s_waitcnt lgkmcnt(5)
    v_mfma_f32_16x16x32_bf16 v[120:123], v[88:91], v[32:35], v[120:123]
    v_mfma_f32_16x16x32_bf16 v[124:127], v[88:91], v[36:39], v[124:127]
    s_waitcnt lgkmcnt(4)
    v_mfma_f32_16x16x32_bf16 v[120:123], v[92:95], v[40:43], v[120:123]
    v_mfma_f32_16x16x32_bf16 v[124:127], v[92:95], v[44:47], v[124:127]
    s_waitcnt lgkmcnt(3)
    v_mfma_f32_16x16x32_bf16 v[120:123], v[96:99], v[48:51], v[120:123]
    v_mfma_f32_16x16x32_bf16 v[124:127], v[96:99], v[52:55], v[124:127]
    s_waitcnt lgkmcnt(2)
    v_mfma_f32_16x16x32_bf16 v[120:123], v[100:103], v[56:59], v[120:123]
    v_mfma_f32_16x16x32_bf16 v[124:127], v[100:103], v[60:63], v[124:127]
    s_waitcnt lgkmcnt(1)
    v_mfma_f32_16x16x32_bf16 v[120:123], v[80:83], v[64:67], v[120:123]
    v_mfma_f32_16x16x32_bf16 v[124:127], v[80:83], v[68:71], v[124:127]
    s_waitcnt lgkmcnt(0)
    v_mfma_f32_16x16x32_bf16 v[120:123], v[84:87], v[72:75], v[120:123]
    v_mfma_f32_16x16x32_bf16 v[124:127], v[84:87], v[76:79], v[124:127]
    s_nop 7
    v_cvt_pk_bf16_f32 v120, v120, v124
    buffer_store_dword v120, v9, s[20:23], s60 offen offset:0 sc1
    v_cvt_pk_bf16_f32 v121, v121, v125
    buffer_store_dword v121, v9, s[20:23], s60 offen offset:512 sc1
    v_cvt_pk_bf16_f32 v122, v122, v126
    buffer_store_dword v122, v9, s[20:23], s60 offen offset:1024 sc1
    v_cvt_pk_bf16_f32 v123, v123, v127
    buffer_store_dword v123, v9, s[20:23], s60 offen offset:1536 sc1
L_end:
L_exit:
    s_endpgm
L_slow:
    s_setprio 0
    s_mov_b64 exec, 1
    ds_add_u32 v3, v62 offset:16
    s_mov_b64 exec, -1
    s_mov_b32 s59, 0
Lw_51:
    ds_read_b32 v4, v3 offset:16
    s_waitcnt lgkmcnt(0)
    v_cmp_gt_u32 vcc, 8, v4
    s_cbranch_vccz Lk_52
    s_add_u32 s59, s59, 1
    s_cmp_lt_u32 s59, 4194304
    s_cbranch_scc1 Lw_51
    s_branch L_end
Lk_52:
    v_mov_b32 v12, v3
    s_mov_b64 s[24:25], s[34:35]
    s_mov_b32 s26, 640000
    s_mov_b64 s[28:29], s[36:37]
    s_mov_b32 s30, 640000
    s_mov_b64 s[12:13], s[42:43]
    s_mov_b32 s14, 20000
    s_mov_b32 s15, 0x20000
    s_sub_u32 s63, s67, 1
    s_mov_b32 s65, 201487296
    s_mov_b32 s64, 0
    s_call_b64 s[68:69], L_flush
    s_add_u32 s66, s4, s5
    s_add_u32 s67, s66, 40
    v_lshlrev_b32 v16, 2, v0
    v_and_b32 v17, 32, v0
    v_lshl_add_u32 v17, v17, 22, v2
    v_mov_b32 v24, 0
L_sn:
    s_mov_b32 s60, 0
L_sc:
    buffer_load_dword v18, v16, s[28:31], s60 offen
    buffer_load_dword v19, v16, s[24:27], s60 offen
    s_waitcnt vmcnt(0)
    v_cmp_eq_u32 vcc, s66, v18
    s_cbranch_vccz L_sx
L_se:
    s_ff1_i32_b64 s58, vcc
    s_bitset0_b64 vcc, s58
    v_readlane_b32 s59, v19, s58
    s_nop 0
    s_lshl_b32 s61, s59, 9
    s_lshl_b32 s59, s59, 1
    buffer_load_dwordx4 v[20:23], v17, s[8:11], s61 offen
    buffer_load_ushort v1, v24, s[12:15], s59 offen
    s_waitcnt vmcnt(0)
    v_perm_b32 v6, v1, v1, v10
    v_perm_b32 v7, v1, v1, v11
    s_nop 1
    v_mfma_f32_4x4x4_16b_bf16 v[56:59], v[6:7], v[20:21], v[56:59]
    v_mfma_f32_4x4x4_16b_bf16 v[60:63], v[6:7], v[22:23], v[60:63]
    s_cmp_lg_u64 vcc, 0
    s_cbranch_scc1 L_se
L_sx:
    s_add_u32 s60, s60, 256
    s_cmp_lt_u32 s60, 640000
    s_cbranch_scc1 L_sc
    s_call_b64 s[68:69], L_flush
    s_add_u32 s66, s66, 8
    s_cmp_lt_u32 s66, s67
    s_cbranch_scc1 L_sn
    s_branch L_gdone
.section .rodata,"a"
.p2align 6
.amdhsa_kernel standalone__hybrid_graph_tf_exphormer__graph_kernel
  .amdhsa_next_free_vgpr 128
  .amdhsa_next_free_sgpr 102
  .amdhsa_accum_offset 128
  .amdhsa_group_segment_fixed_size 0
  .amdhsa_kernarg_size 104
  .amdhsa_user_sgpr_count 2
  .amdhsa_user_sgpr_kernarg_segment_ptr 1
  .amdhsa_system_sgpr_workgroup_id_x 1
.end_amdhsa_kernel
```

```asm
; @launch grid=(250,1,1) block=(1024,1,1) lds=162240
.amdgcn_target "amdgcn-amd-amdhsa--gfx950"
.text
.globl standalone__hybrid_graph_tf_exphormer__graph_kernel
.p2align 8
.type standalone__hybrid_graph_tf_exphormer__graph_kernel,@function
standalone__hybrid_graph_tf_exphormer__graph_kernel:
    s_cmp_ge_u32 s2, 250
    s_cbranch_scc1 L_exit
    s_load_dwordx16 s[32:47], s[0:1], 0
    s_load_dwordx8 s[48:55], s[0:1], 64
    s_load_dwordx2 s[56:57], s[0:1], 96
    s_getpc_b64 s[60:61]
    s_lshr_b32 s6, s2, 3
    v_lshl_add_u32 v1, v0, 5, s6
    v_cmp_gt_u32 vcc, 92, v1
    v_lshlrev_b32 v1, 7, v1
    s_and_saveexec_b64 s[58:59], vcc
    s_cbranch_execz L_nopf
    global_load_dword v15, v1, s[60:61]
L_nopf:
    s_mov_b64 exec, -1
    v_lshrrev_b32 v1, 6, v0
    v_mov_b32 v8, 33554432
    v_readfirstlane_b32 s3, v1
    v_cmp_gt_u32 vcc, 320, v0
    v_lshlrev_b32 v5, 4, v0
    v_add_u32 v4, 152064, v5
    v_cndmask_b32 v8, 0, v8, vcc
    v_mov_b32 v9, v8
    v_mov_b64 v[10:11], v[8:9]
    v_cmp_gt_u32 vcc, 572, v0
    s_and_saveexec_b64 s[58:59], vcc
    ds_write_b128 v4, v[8:11]
    s_mov_b64 exec, -1
    v_and_b32 v0, 63, v0
    v_and_b32 v2, 31, v0
    v_lshlrev_b32 v2, 4, v2
    s_and_b32 s59, s2, 7
    s_mul_i32 s60, s59, 31
    s_min_u32 s59, s59, 2
    s_add_u32 s6, s6, s60
    s_add_u32 s6, s6, s59
    s_mov_b32 s27, 0x20000
    s_mov_b32 s31, 0x20000
    s_xor_b32 s3, s3, 8
    s_and_b32 s4, s3, 7
    s_cmp_lt_u32 s3, 8
    s_cbranch_scc1 L_e3
    s_setprio 3
    s_cmp_ge_u32 s2, 64
    s_cbranch_scc1 L_e1
    v_lshrrev_b32 v6, 2, v5
    s_mul_i32 s58, s2, 10000
    s_add_u32 s60, s58, 8192
    s_mov_b32 s26, 640000
    s_mov_b32 s30, 640000
    s_mov_b32 s59, 1048576
    s_mov_b32 s63, 1
    s_waitcnt lgkmcnt(0)
    s_mov_b64 s[28:29], s[36:37]
    s_mov_b64 s[24:25], s[34:35]
    buffer_load_dwordx4 v[22:25], v5, s[28:31], s58 offen
    buffer_load_dword v26, v6, s[28:31], s60 offen
    s_setprio 2
    buffer_load_dwordx4 v[16:19], v5, s[24:27], s58 offen
    buffer_load_dword v20, v6, s[24:27], s60 offen
    s_setprio 3
L_ep:
    s_load_dword s40, s[56:57], s59
    s_branch L_bar
L_e1:
    s_mov_b32 s26, 131072
    s_sub_u32 s60, s3, 9
    s_cmp_lt_u32 s60, 3
    s_cbranch_scc1 L_e1b
    s_mov_b32 s63, 0
    s_cmp_eq_u32 s3, 8
    s_cbranch_scc0 L_barw
    s_mov_b32 s63, 5
    s_mov_b32 s59, 1048576
    s_waitcnt lgkmcnt(0)
    s_branch L_ep
L_e1b:
    s_sub_u32 s62, s2, 64
    s_cmp_ge_u32 s62, 128
    s_cbranch_scc1 L_e2
    s_and_b32 s58, s62, 7
    s_lshr_b32 s59, s62, 4
    s_bfe_u32 s61, s62, 0x10003
    s_cmp_eq_u32 s60, 2
    s_cselect_b32 s58, s59, s58
    s_cselect_b32 s61, s61, s60
    s_lshl_b32 s58, s58, 14
    s_lshl_b32 s61, s61, 11
    s_add_u32 s58, s58, s61
    s_add_u32 s59, s58, 4096
    v_and_b32 v4, 32, v0
    v_lshl_add_u32 v4, v4, 8, v2
    s_mul_i32 s61, s60, 8448
    s_add_u32 m0, s61, 105600
    s_cmp_eq_u32 s60, 0
    s_cselect_b32 s63, 2, 3
    s_cmp_eq_u32 s60, 2
    s_waitcnt lgkmcnt(0)
    s_cselect_b64 s[24:25], s[48:49], s[46:47]
    buffer_load_dwordx4 v4, s[24:27], s58 offen offset:0 lds
    s_add_u32 m0, m0, 544
    s_nop 0
    buffer_load_dwordx4 v4, s[24:27], s58 offen offset:512 lds
    s_add_u32 m0, m0, 544
    s_nop 0
    buffer_load_dwordx4 v4, s[24:27], s58 offen offset:1024 lds
    s_add_u32 m0, m0, 544
    s_nop 0
    buffer_load_dwordx4 v4, s[24:27], s58 offen offset:1536 lds
    s_add_u32 m0, m0, 2592
    s_nop 0
    buffer_load_dwordx4 v4, s[24:27], s59 offen offset:0 lds
    s_add_u32 m0, m0, 544
    s_nop 0
    buffer_load_dwordx4 v4, s[24:27], s59 offen offset:512 lds
    s_add_u32 m0, m0, 544
    s_nop 0
    buffer_load_dwordx4 v4, s[24:27], s59 offen offset:1024 lds
    s_add_u32 m0, m0, 544
    s_nop 0
    buffer_load_dwordx4 v4, s[24:27], s59 offen offset:1536 lds
    s_branch L_bar
L_e2:
    s_mul_i32 s60, s60, 58
    s_add_u32 s62, s62, s60
    s_sub_u32 s62, s62, 128
    s_mov_b32 s63, 3
    s_cmp_ge_u32 s62, 96
    s_cbranch_scc1 L_barw
    s_and_b32 s59, s62, 28
    s_add_u32 s59, s59, 4
    s_cmp_ge_u32 s62, 64
    s_cselect_b32 s59, s59, 0
    s_add_u32 s62, s62, s59
    s_mov_b32 s63, 4
    s_and_b32 s59, s62, 7
    s_lshl_b32 s59, s59, 14
    s_bfe_u32 s60, s62, 0x30003
    s_lshl_b32 s60, s60, 6
    s_add_u32 s59, s59, s60
    v_and_b32 v4, 15, v0
    v_lshlrev_b32 v4, 2, v4
    v_and_b32 v5, 48, v0
    v_lshl_add_u32 v4, v5, 8, v4
    s_cmp_lt_u32 s62, 64
    s_waitcnt lgkmcnt(0)
    s_cselect_b64 s[24:25], s[50:51], s[44:45]
    buffer_load_dword v16, v4, s[24:27], s59 offen offset:0
    buffer_load_dword v17, v4, s[24:27], s59 offen offset:512
    buffer_load_dword v18, v4, s[24:27], s59 offen offset:1024
    buffer_load_dword v19, v4, s[24:27], s59 offen offset:1536
    buffer_load_dword v20, v4, s[24:27], s59 offen offset:2048
    buffer_load_dword v21, v4, s[24:27], s59 offen offset:2560
    buffer_load_dword v22, v4, s[24:27], s59 offen offset:3072
    buffer_load_dword v23, v4, s[24:27], s59 offen offset:3584
    s_branch L_bar
L_e3:
    s_mul_i32 s58, s6, 640
    s_lshl_b32 s59, s3, 6
    s_add_u32 s59, s59, s58
    s_lshr_b32 s60, s3, 2
    s_lshl_b32 s60, s60, 6
    s_and_b32 s61, s3, 3
    s_lshl_b32 s61, s61, 3
    s_add_u32 s60, s60, s61
    s_add_u32 s60, s60, s58
    s_add_u32 s60, s60, 512
    s_add_u32 s61, s60, 32
    s_waitcnt lgkmcnt(0)
    s_mov_b64 s[62:63], s[38:39]
    s_mov_b64 s[8:9], s[32:33]
    s_load_dwordx16 s[32:47], s[62:63], s59
    s_load_dwordx2 s[64:65], s[62:63], s60
    s_load_dwordx2 s[66:67], s[62:63], s61
    s_barrier
    s_branch L_preA
L_barw:
    s_waitcnt lgkmcnt(0)
L_bar:
    s_barrier
    s_mov_b64 s[8:9], s[32:33]
    s_mul_i32 s5, s6, 40
    v_mov_b32 v3, 160064
    s_mov_b32 s10, 5120000
    s_mov_b32 s11, 0x20000
    s_mov_b64 s[16:17], s[56:57]
    s_mov_b32 s18, 1441792
    s_mov_b32 s19, 0x20000
    v_mov_b32 v62, 1
    s_cmp_eq_u32 s63, 1
    s_cbranch_scc0 L_notprod
    v_mov_b32 v9, 4
    v_mov_b32 v10, 160192
    v_lshl_add_u32 v11, v0, 4, v10
    v_cmp_gt_u32 vcc, 7232, v5
    v_add_u32 v59, 105600, v5
    s_mul_i32 s58, s2, 10240
    s_mov_b64 s[66:67], vcc
    s_waitcnt vmcnt(3)
    v_mul_u32_u24 v28, 52429, v22
    v_lshrrev_b32 v28, 21, v28
    v_lshl_add_u32 v28, v28, 2, v10
    ds_add_rtn_u32 v34, v28, v9
    v_mul_u32_u24 v29, 52429, v23
    v_lshrrev_b32 v29, 21, v29
    v_lshl_add_u32 v29, v29, 2, v10
    ds_add_rtn_u32 v35, v29, v9
    v_mul_u32_u24 v30, 52429, v24
    v_lshrrev_b32 v30, 21, v30
    v_lshl_add_u32 v30, v30, 2, v10
    ds_add_rtn_u32 v36, v30, v9
    v_mul_u32_u24 v31, 52429, v25
    v_lshrrev_b32 v31, 21, v31
    v_lshl_add_u32 v31, v31, 2, v10
    ds_add_rtn_u32 v37, v31, v9
    s_waitcnt vmcnt(2)
    s_mov_b64 exec, s[66:67]
    v_mul_u32_u24 v32, 52429, v26
    v_lshrrev_b32 v32, 21, v32
    v_lshl_add_u32 v32, v32, 2, v10
    ds_add_rtn_u32 v38, v32, v9
    s_mov_b64 exec, -1
    s_waitcnt lgkmcnt(0)
    s_barrier
    ds_read_b128 v[12:15], v11
    s_add_u32 s40, s40, 0x9e377000
    s_and_b32 s40, s40, 4294963200
    s_waitcnt lgkmcnt(0)
    v_add_u32 v56, v12, v13
    v_add3_u32 v57, v56, v14, v15
    s_nop 1
    v_add_u32_dpp v58, v57, v57 row_shr:1 row_mask:0xf bank_mask:0xf bound_ctrl:1
    s_nop 1
    v_add_u32_dpp v58, v58, v58 row_shr:2 row_mask:0xf bank_mask:0xf bound_ctrl:1
    s_nop 1
    v_add_u32_dpp v58, v58, v58 row_shr:4 row_mask:0xf bank_mask:0xf bound_ctrl:1
    s_nop 1
    v_add_u32_dpp v58, v58, v58 row_shr:8 row_mask:0xf bank_mask:0xf bound_ctrl:1
    s_nop 1
    v_add_u32_dpp v58, v58, v58 row_bcast:15 row_mask:0xa bank_mask:0xf
    s_nop 1
    v_add_u32_dpp v58, v58, v58 row_bcast:31 row_mask:0xc bank_mask:0xf
    v_sub_u32 v64, v58, v57
    v_add_u32 v65, v64, v12
    v_add_u32 v66, v64, v56
    v_add_u32 v67, v66, v14
    ds_write_b128 v11, v[64:67] offset:1024
    ds_read_b32 v40, v28 offset:1024
    ds_read_b32 v41, v29 offset:1024
    ds_read_b32 v42, v30 offset:1024
    ds_read_b32 v43, v31 offset:1024
    s_mov_b64 exec, s[66:67]
    ds_read_b32 v44, v32 offset:1024
    s_mov_b64 exec, -1
    s_mov_b32 s60, 105600
    s_waitcnt vmcnt(0)
    v_lshl_or_b32 v16, v22, 16, v16
    v_lshl_or_b32 v17, v23, 16, v17
    v_lshl_or_b32 v18, v24, 16, v18
    v_lshl_or_b32 v19, v25, 16, v19
    v_lshl_or_b32 v20, v26, 16, v20
    s_waitcnt lgkmcnt(4)
    v_add3_u32 v40, v40, v34, s60
    ds_write_b32 v40, v16
    s_waitcnt lgkmcnt(4)
    v_add3_u32 v41, v41, v35, s60
    ds_write_b32 v41, v17
    s_waitcnt lgkmcnt(4)
    v_add3_u32 v42, v42, v36, s60
    ds_write_b32 v42, v18
    s_waitcnt lgkmcnt(4)
    v_add3_u32 v43, v43, v37, s60
    ds_write_b32 v43, v19
    s_mov_b64 exec, s[66:67]
    s_waitcnt lgkmcnt(4)
    v_add3_u32 v44, v44, v38, s60
    ds_write_b32 v44, v20
    s_mov_b64 exec, -1
    v_lshrrev_b32 v64, 2, v64
    v_or_b32 v64, s40, v64
    v_lshrrev_b32 v65, 2, v65
    v_or_b32 v65, s40, v65
    v_lshrrev_b32 v66, 2, v66
    v_or_b32 v66, s40, v66
    v_lshrrev_b32 v67, 2, v67
    v_or_b32 v67, s40, v67
    s_waitcnt lgkmcnt(0)
    s_barrier
    ds_read_b128 v[12:15], v59
    ds_read_b128 v[68:71], v59 offset:8192
    s_add_u32 s60, s58, 8192
    s_cmp_ge_u32 s4, 2
    s_waitcnt lgkmcnt(1)
    buffer_store_dwordx4 v[12:15], v5, s[16:19], s58 offen sc1
    s_cbranch_scc1 L_cp1
    s_waitcnt lgkmcnt(0)
    buffer_store_dwordx4 v[68:71], v5, s[16:19], s60 offen sc1
L_cp1:
    s_waitcnt vmcnt(0)
    s_mov_b64 exec, 1
    ds_add_u32 v3, v62 offset:56
    s_mov_b64 exec, -1
    s_cmp_eq_u32 s4, 0
    s_cbranch_scc0 L_preB
    s_lshl_b32 s61, s2, 10
    s_add_u32 s61, s61, 1114112
    s_or_b32 s60, s40, 1
    v_mov_b32 v8, s60
    s_mov_b32 s59, 0
Lw_1:
    ds_read_b32 v4, v3 offset:56
    s_waitcnt lgkmcnt(0)
    v_cmp_gt_u32 vcc, 8, v4
    s_cbranch_vccz Lk_2
    s_add_u32 s59, s59, 1
    s_cmp_lt_u32 s59, 4194304
    s_cbranch_scc1 Lw_1
    s_branch L_end
Lk_2:
    buffer_store_dwordx4 v[64:67], v5, s[16:19], s61 offen sc1
    ds_write_b32 v3, v8 offset:32
    s_branch L_preB
L_notprod:
    s_cmp_eq_u32 s63, 0
    s_cbranch_scc1 L_preB
    s_cmp_eq_u32 s63, 3
    s_cbranch_scc1 L_taskw
    s_cmp_eq_u32 s63, 4
    s_cbranch_scc1 L_wtask
    s_cmp_eq_u32 s63, 5
    s_cbranch_scc1 L_flag
    v_and_b32 v4, 7, v0
    v_mul_u32_u24 v1, 1056, v4
    v_and_b32 v4, 8, v0
    v_lshl_add_u32 v1, v4, 6, v1
    v_and_b32 v4, 48, v0
    v_add_u32 v1, v4, v1
    v_add_u32 v5, 105600, v1
    s_lshr_b32 s58, s62, 4
    s_lshl_b32 s58, s58, 3
    s_and_b32 s59, s62, 7
    s_add_u32 s58, s58, s59
    s_lshl_b32 s58, s58, 1
    s_bfe_u32 s59, s62, 0x10003
    s_add_u32 s58, s58, s59
    s_lshl_b32 s58, s58, 10
    s_add_u32 s58, s58, 655360
    v_lshlrev_b32 v6, 4, v0
    s_waitcnt vmcnt(0)
    s_mov_b32 s59, 0
Lw_3:
    ds_read_b32 v4, v3 offset:56
    s_waitcnt lgkmcnt(0)
    v_cmp_gt_u32 vcc, 2, v4
    s_cbranch_vccz Lk_4
    s_add_u32 s59, s59, 1
    s_cmp_lt_u32 s59, 4194304
    s_cbranch_scc1 Lw_3
    s_branch L_end
Lk_4:
    ds_read_b128 v[16:19], v5 offset:0
    ds_read_b128 v[20:23], v5 offset:8448
    ds_read_b128 v[24:27], v5 offset:16896
    ds_read_b128 v[28:31], v5 offset:64
    ds_read_b128 v[32:35], v5 offset:8512
    ds_read_b128 v[36:39], v5 offset:16960
    ds_read_b128 v[40:43], v5 offset:128
    ds_read_b128 v[44:47], v5 offset:8576
    ds_read_b128 v[48:51], v5 offset:17024
    ds_read_b128 v[64:67], v5 offset:192
    ds_read_b128 v[68:71], v5 offset:8640
    ds_read_b128 v[72:75], v5 offset:17088
    s_waitcnt lgkmcnt(9)
    ds_read_b128 v[76:79], v5 offset:256
    ds_read_b128 v[80:83], v5 offset:8704
    ds_read_b128 v[84:87], v5 offset:17152
    v_mfma_f32_16x16x32_bf16 v[8:11], v[16:19], v[24:27], 0
    v_mfma_f32_16x16x32_bf16 v[12:15], v[20:23], v[24:27], 0
    s_waitcnt lgkmcnt(9)
    ds_read_b128 v[88:91], v5 offset:320
    ds_read_b128 v[92:95], v5 offset:8768
    ds_read_b128 v[96:99], v5 offset:17216
    v_mfma_f32_16x16x32_bf16 v[8:11], v[28:31], v[36:39], v[8:11]
    v_mfma_f32_16x16x32_bf16 v[12:15], v[32:35], v[36:39], v[12:15]
    s_waitcnt lgkmcnt(9)
    ds_read_b128 v[100:103], v5 offset:384
    ds_read_b128 v[104:107], v5 offset:8832
    ds_read_b128 v[108:111], v5 offset:17280
    v_mfma_f32_16x16x32_bf16 v[8:11], v[40:43], v[48:51], v[8:11]
    v_mfma_f32_16x16x32_bf16 v[12:15], v[44:47], v[48:51], v[12:15]
    s_waitcnt lgkmcnt(9)
    ds_read_b128 v[112:115], v5 offset:448
    ds_read_b128 v[116:119], v5 offset:8896
    ds_read_b128 v[120:123], v5 offset:17344
    v_mfma_f32_16x16x32_bf16 v[8:11], v[64:67], v[72:75], v[8:11]
    v_mfma_f32_16x16x32_bf16 v[12:15], v[68:71], v[72:75], v[12:15]
    s_waitcnt lgkmcnt(9)
    v_mfma_f32_16x16x32_bf16 v[8:11], v[76:79], v[84:87], v[8:11]
    v_mfma_f32_16x16x32_bf16 v[12:15], v[80:83], v[84:87], v[12:15]
    s_waitcnt lgkmcnt(6)
    v_mfma_f32_16x16x32_bf16 v[8:11], v[88:91], v[96:99], v[8:11]
    v_mfma_f32_16x16x32_bf16 v[12:15], v[92:95], v[96:99], v[12:15]
    s_waitcnt lgkmcnt(3)
    v_mfma_f32_16x16x32_bf16 v[8:11], v[100:103], v[108:111], v[8:11]
    v_mfma_f32_16x16x32_bf16 v[12:15], v[104:107], v[108:111], v[12:15]
    s_waitcnt lgkmcnt(0)
    v_mfma_f32_16x16x32_bf16 v[8:11], v[112:115], v[120:123], v[8:11]
    v_mfma_f32_16x16x32_bf16 v[12:15], v[116:119], v[120:123], v[12:15]
    s_nop 6
    v_cvt_pk_bf16_f32 v16, v8, v9
    v_cvt_pk_bf16_f32 v17, v10, v11
    v_cvt_pk_bf16_f32 v18, v12, v13
    v_cvt_pk_bf16_f32 v19, v14, v15
    buffer_store_dwordx4 v[16:19], v6, s[16:19], s58 offen sc1
    s_branch L_taskw
L_wtask:
    s_lshl_b32 s58, s62, 11
    s_add_u32 s58, s58, 786432
    v_lshlrev_b32 v6, 4, v0
    s_mov_b32 s70, 0x05040100
    s_mov_b32 s71, 0x07060302
    s_waitcnt vmcnt(0)
    v_perm_b32 v64, v17, v16, s70
    v_perm_b32 v68, v17, v16, s71
    v_perm_b32 v65, v19, v18, s70
    v_perm_b32 v69, v19, v18, s71
    v_perm_b32 v66, v21, v20, s70
    v_perm_b32 v70, v21, v20, s71
    v_perm_b32 v67, v23, v22, s70
    v_perm_b32 v71, v23, v22, s71
    buffer_store_dwordx4 v[64:67], v6, s[16:19], s58 offen sc1
    buffer_store_dwordx4 v[68:71], v6, s[16:19], s58 offen offset:1024 sc1
L_taskw:
    s_waitcnt vmcnt(0)
    s_mov_b64 exec, 1
    ds_add_u32 v3, v62 offset:56
    s_mov_b64 exec, -1
    s_branch L_preB
L_flag:
    s_waitcnt vmcnt(0) lgkmcnt(0)
    s_add_u32 s40, s40, 0x9e377000
    s_and_b32 s40, s40, 4294963200
    s_mul_i32 s61, s2, 16
    s_add_u32 s61, s61, 1178624
    s_or_b32 s60, s40, 1
    v_mov_b32 v8, s60
    v_mov_b32 v10, s40
    v_mov_b32 v11, s40
    v_lshlrev_b32 v9, 15, v0
    s_mov_b32 s59, 0
Lw_5:
    ds_read_b32 v4, v3 offset:56
    s_waitcnt lgkmcnt(0)
    v_cmp_gt_u32 vcc, 3, v4
    s_cbranch_vccz Lk_6
    s_add_u32 s59, s59, 1
    s_cmp_lt_u32 s59, 4194304
    s_cbranch_scc1 Lw_5
    s_branch L_end
Lk_6:
    s_mov_b64 exec, 255
    buffer_store_dwordx2 v[10:11], v9, s[16:19], s61 offen sc1
    ds_write_b32 v3, v8 offset:32
    s_mov_b64 exec, -1
L_preB:
    s_setprio 3
    s_mov_b64 s[28:29], s[42:43]
    s_mov_b32 s30, 20000
    s_lshl_b32 s58, s4, 10
    v_lshlrev_b32 v5, 4, v0
    s_add_u32 m0, s58, 130944
    s_add_u32 s59, s58, 0
    buffer_load_dwordx4 v5, s[28:31], s59 offen lds
    s_add_u32 m0, s58, 139136
    s_add_u32 s59, s58, 8192
    buffer_load_dwordx4 v5, s[28:31], s59 offen lds
    s_cmp_lt_u32 s4, 4
    s_cbranch_scc1 L_disd
    s_add_u32 m0, s58, 143232
    s_add_u32 s59, s58, 12288
    buffer_load_dwordx4 v5, s[28:31], s59 offen lds
L_disd:
    s_mov_b64 s[24:25], s[44:45]
    s_mov_b32 s26, 131072
    s_setprio 1
    s_lshl_b32 s58, s4, 10
    s_mov_b32 s41, 0
    buffer_load_dwordx4 v[96:99], v5, s[24:27], s58 offen
    s_add_u32 s58, s58, 8192
    buffer_load_dwordx4 v[100:103], v5, s[24:27], s58 offen
    s_add_u32 s58, s58, 8192
    buffer_load_dwordx4 v[104:107], v5, s[24:27], s58 offen
    s_add_u32 s58, s58, 8192
    buffer_load_dwordx4 v[108:111], v5, s[24:27], s58 offen
    s_add_u32 s58, s58, 8192
    buffer_load_dwordx4 v[112:115], v5, s[24:27], s58 offen
    s_add_u32 s58, s58, 8192
    buffer_load_dwordx4 v[116:119], v5, s[24:27], s58 offen
    s_add_u32 s58, s58, 8192
    buffer_load_dwordx4 v[120:123], v5, s[24:27], s58 offen
    s_add_u32 s58, s58, 8192
    buffer_load_dwordx4 v[124:127], v5, s[24:27], s58 offen
    s_setprio 3
    v_and_b32 v4, 3, v0
    v_mov_b32 v5, 0x0c0c0c0c
    v_mov_b32 v6, 0x0c0c0302
    v_mov_b32 v7, 0x03020c0c
    v_cmp_eq_u32 s[58:59], 0, v4
    v_cmp_eq_u32 s[60:61], 2, v4
    v_cmp_eq_u32 vcc, 1, v4
    v_cndmask_b32 v10, v5, v6, s[58:59]
    v_cndmask_b32 v11, v5, v6, s[60:61]
    v_cndmask_b32 v10, v10, v7, vcc
    v_cmp_eq_u32 vcc, 3, v4
    s_nop 1
    v_cndmask_b32 v11, v11, v7, vcc
    v_and_b32 v10, 0xfdfdfdfd, v10
    v_and_b32 v11, 0xfdfdfdfd, v11
    s_movk_i32 s7, 512
    s_lshl_b32 s58, s4, 3
    v_lshrrev_b32 v5, 3, v0
    v_and_b32 v6, 7, v0
    v_add_u32 v7, s58, v5
    v_mul_u32_u24 v49, 10240, v7
    v_lshl_add_u32 v49, v6, 4, v49
    v_lshlrev_b32 v56, 2, v6
    s_lshl_b32 s60, s6, 2
    s_add_u32 s60, s60, 1114112
    v_lshl_add_u32 v54, v7, 10, s60
    v_mad_u32_u24 v7, v7, 3, v6
    v_cmp_ge_u32 vcc, 186, v7
    v_cmp_gt_u32 s[64:65], 4, v6
    v_mul_u32_u24 v7, 16, v7
    s_and_b64 s[64:65], s[64:65], vcc
    v_cmp_eq_u32 vcc, 0, v6
    s_and_b32 s58, s2, 7
    s_lshl_b32 s58, s58, 15
    s_add_u32 s58, s58, 1179632
    v_add_u32 v7, s58, v7
    s_or_b64 s[64:65], s[64:65], vcc
    v_cndmask_b32 v54, v7, v54, vcc
    v_cmp_gt_u32 s[62:63], 5, v6
    v_lshl_add_u32 v50, v6, 3, v5
    v_mul_u32_u24 v55, 80, v5
    v_add_u32 v55, 80, v55
    v_lshrrev_b32 v5, 4, v50
    v_mul_u32_u24 v9, 8448, v5
    v_lshl_add_u32 v9, v5, 26, v9
    v_cmp_le_u32 vcc, 32, v50
    v_and_b32 v5, 7, v50
    v_and_b32 v6, 3, v50
    v_cndmask_b32 v5, v5, v6, vcc
    v_mul_u32_u24 v5, 1056, v5
    v_bfe_u32 v6, v50, 3, 1
    v_bfe_u32 v7, v50, 2, 1
    v_cndmask_b32 v6, v6, v7, vcc
    v_lshl_add_u32 v5, v6, 9, v5
    v_mov_b32 v52, 130944
    v_add3_u32 v9, v9, v5, v52
    v_lshrrev_b32 v5, 5, v0
    v_lshl_add_u32 v15, v5, 3, v2
    s_lshl_b32 s58, s5, 2
    s_sub_u32 s58, 159744, s58
    v_mov_b32 v53, s58
    v_add_u32 v5, s5, v50
    v_lshl_add_u32 v8, v5, 1, v52
    v_lshlrev_b32 v50, 2, v50
    v_add_u32 v50, 159744, v50
    v_mov_b32 v57, 157184
    v_mov_b32 v60, 152064
    v_mov_b64 v[16:17], 0
    v_mov_b64 v[18:19], 0
    s_mov_b32 s59, 0
Lw_7:
    ds_read_b32 v4, v3 offset:60
    s_waitcnt lgkmcnt(0)
    v_cmp_gt_u32 vcc, 8, v4
    s_cbranch_vccz Lk_8
    s_sleep 2
    s_add_u32 s59, s59, 1
    s_cmp_lt_u32 s59, 4194304
    s_cbranch_scc1 Lw_7
    s_branch L_end
Lk_8:
    s_mov_b32 s59, 0
Lw_9:
    ds_read_b32 v4, v3 offset:32
    s_waitcnt lgkmcnt(0)
    v_cmp_gt_u32 vcc, 1, v4
    s_cbranch_vccz Lk_10
    s_sleep 1
    s_add_u32 s59, s59, 1
    s_cmp_lt_u32 s59, 4194304
    s_cbranch_scc1 Lw_9
    s_branch L_end
Lk_10:
    v_readfirstlane_b32 s40, v4
    s_mov_b32 s59, 0
    s_bitset0_b32 s40, 0
    s_and_b32 exec_lo, s64, 0xfefefefe
    s_and_b32 exec_hi, s65, 0xfefefefe
L_spolla:
    buffer_load_dwordx2 v[58:59], v54, s[16:19], 0 offen sc1
    s_add_u32 s59, s59, 1
    s_cmp_gt_u32 s59, 0x40000
    s_cbranch_scc1 L_end
    s_waitcnt vmcnt(0)
    v_xor_b32 v58, s40, v58
    v_xor_b32 v59, s40, v59
    v_or_b32 v5, v58, v59
    v_cmpx_lt_u32 vcc, 4095, v5
    s_cbranch_execz L_soka
    s_sleep 8
    s_branch L_spolla
L_soka:
    s_mov_b64 exec, -1
    s_mov_b64 exec, 1
    ds_add_u32 v3, v62 offset:52
    s_mov_b64 exec, -1
    s_mov_b32 exec_lo, 0x01010101
    s_mov_b32 exec_hi, 0x01010101
L_spollb:
    buffer_load_dwordx2 v[58:59], v54, s[16:19], 0 offen sc1
    s_add_u32 s59, s59, 1
    s_cmp_gt_u32 s59, 0x40000
    s_cbranch_scc1 L_end
    s_waitcnt vmcnt(0)
    v_xor_b32 v58, s40, v58
    v_xor_b32 v59, s40, v59
    v_or_b32 v5, v58, v59
    v_cmpx_lt_u32 vcc, 4095, v5
    s_cbranch_execz L_sokb
    s_sleep 8
    s_branch L_spollb
L_sokb:
    s_mov_b64 exec, -1
    v_sub_u32 v48, v59, v58
    v_lshl_or_b32 v48, v48, 16, v58
    s_nop 1
    v_mov_b32_dpp v48, v48 quad_perm:[0,0,0,0] row_mask:0xf bank_mask:0xf
    s_nop 1
    v_mov_b32_dpp v48, v48 row_shr:4 row_mask:0xf bank_mask:0xa
    v_mad_u32_u16 v49, v48, 4, v49
    v_lshrrev_b32 v48, 16, v48
    v_sub_u32 v48, v48, v56
    v_cmpx_lt_i32 vcc, 0, v48
    s_cbranch_execz L_entld
    buffer_load_dwordx4 v[16:19], v49, s[16:19], 0 offen sc1
    v_cmpx_lt_i32 vcc, 32, v48
    ds_write_b32 v3, v62 offset:28
L_entld:
    s_mov_b64 exec, -1
    s_waitcnt vmcnt(0)
    v_cmpx_lt_i32 vcc, 0, v48
    v_mad_u32_u16 v24, v16, 4, v53 op_sel:[1,0,0,0]
    ds_add_rtn_u32 v32, v24, v62
    v_cmpx_lt_i32 vcc, 1, v48
    v_mad_u32_u16 v25, v17, 4, v53 op_sel:[1,0,0,0]
    ds_add_rtn_u32 v33, v25, v62
    v_cmpx_lt_i32 vcc, 2, v48
    v_mad_u32_u16 v26, v18, 4, v53 op_sel:[1,0,0,0]
    ds_add_rtn_u32 v34, v26, v62
    v_cmpx_lt_i32 vcc, 3, v48
    v_mad_u32_u16 v27, v19, 4, v53 op_sel:[1,0,0,0]
    ds_add_rtn_u32 v35, v27, v62
    s_mov_b64 exec, -1
    s_mov_b64 exec, 1
    ds_add_u32 v3, v62 offset:12
    s_mov_b64 exec, -1
    v_mad_u32_u16 v40, v16, 2, v52
    v_mad_u32_u16 v16, v16, s7, 0
    v_mad_u32_u16 v41, v17, 2, v52
    v_mad_u32_u16 v17, v17, s7, 0
    v_mad_u32_u16 v42, v18, 2, v52
    v_mad_u32_u16 v18, v18, s7, 0
    v_mad_u32_u16 v43, v19, 2, v52
    v_mad_u32_u16 v19, v19, s7, 0
    s_mov_b32 s59, 0
Lw_11:
    ds_read_b32 v4, v3 offset:12
    s_waitcnt lgkmcnt(0)
    v_cmp_gt_u32 vcc, 8, v4
    s_cbranch_vccz Lk_12
    s_add_u32 s59, s59, 1
    s_cmp_lt_u32 s59, 4194304
    s_cbranch_scc1 Lw_11
    s_branch L_end
Lk_12:
    ds_read_b32 v12, v50
    ds_read_b32 v5, v3 offset:28
    ds_read_u16 v8, v8
    ds_read_u16 v40, v40
    ds_read_u16 v41, v41
    ds_read_u16 v42, v42
    ds_read_u16 v43, v43
    s_lshl_b32 s58, s2, 4
    s_add_u32 s58, s58, s3
    s_cmp_eq_u32 s58, 15
    s_cbranch_scc0 L_noep
    v_mov_b32 v6, s40
    v_mov_b32 v7, 1048576
    s_mov_b64 exec, 1
    buffer_store_dword v6, v7, s[16:19], 0 offen sc1
    s_mov_b64 exec, -1
L_noep:
    s_waitcnt lgkmcnt(6)
    v_add_u32 v12, 1, v12
    v_lshrrev_b32 v12, 1, v12
    v_max_u32 v12, 1, v12
    v_cndmask_b32 v12, 0, v12, s[62:63]
    s_lshl_b32 s67, s4, 3
    s_movk_i32 s58, 2560
    v_add_u32_dpp v51, v12, v12 row_shl:1 row_mask:0xf bank_mask:0xf bound_ctrl:1
    s_nop 1
    v_add_u32_dpp v51, v51, v51 row_shl:2 row_mask:0xf bank_mask:0xf bound_ctrl:1
    s_nop 1
    v_add_u32_dpp v51, v12, v51 row_shl:4 row_mask:0xf bank_mask:0x5 bound_ctrl:1
    s_waitcnt lgkmcnt(0)
    v_lshlrev_b32 v8, 16, v8
    v_lshl_add_u32 v5, v5, 10, v51
    v_sub_u32 v6, v55, v51
    v_cmp_le_u32 vcc, 80, v5
    v_lshlrev_b32 v6, 1, v6
    v_subrev_u32 v12, 1, v12
    s_cbranch_vccnz L_slow
    v_and_b32 v12, 0xff, v12
    v_lshl_add_u32 v9, v12, 18, v9
    s_mov_b64 exec, s[62:63]
    ds_write_b32 v50, v6 offset:160
    s_mov_b64 exec, -1
    s_sub_u32 s63, s67, 1
    v_readlane_b32 s67, v51, s67
    v_cmpx_lt_i32 vcc, 0, v48
    ds_read_b32 v24, v24 offset:160
    v_cmpx_lt_i32 vcc, 1, v48
    ds_read_b32 v25, v25 offset:160
    v_cmpx_lt_i32 vcc, 2, v48
    ds_read_b32 v26, v26 offset:160
    v_cmpx_lt_i32 vcc, 3, v48
    ds_read_b32 v27, v27 offset:160
    s_mov_b64 exec, -1
    s_lshr_b32 s66, s67, 3
    s_add_u32 s60, s66, 1
    s_lshl_b32 s60, s60, 3
    s_sub_u32 s67, s60, s67
    s_sub_u32 s62, s67, 1
    s_add_u32 s61, s4, 1
    s_mul_i32 s61, s61, 80
    s_sub_u32 s60, s61, s60
    s_lshl_b32 s60, s60, 2
    s_waitcnt lgkmcnt(0)
    v_cmpx_lt_i32 vcc, 0, v48
    v_add_u32 v24, v24, v32
    v_lshl_add_u32 v5, v24, 1, v57
    ds_write_b16 v5, v40
    v_lshrrev_b32 v6, 1, v24
    v_lshl_add_u32 v6, v6, 2, v60
    v_and_b32 v7, 1, v24
    v_mad_u32_u24 v6, v7, s58, v6
    ds_write_b32 v6, v16
    v_cmpx_lt_i32 vcc, 1, v48
    v_add_u32 v25, v25, v33
    v_lshl_add_u32 v5, v25, 1, v57
    ds_write_b16 v5, v41
    v_lshrrev_b32 v6, 1, v25
    v_lshl_add_u32 v6, v6, 2, v60
    v_and_b32 v7, 1, v25
    v_mad_u32_u24 v6, v7, s58, v6
    ds_write_b32 v6, v17
    v_cmpx_lt_i32 vcc, 2, v48
    v_add_u32 v26, v26, v34
    v_lshl_add_u32 v5, v26, 1, v57
    ds_write_b16 v5, v42
    v_lshrrev_b32 v6, 1, v26
    v_lshl_add_u32 v6, v6, 2, v60
    v_and_b32 v7, 1, v26
    v_mad_u32_u24 v6, v7, s58, v6
    ds_write_b32 v6, v18
    v_cmpx_lt_i32 vcc, 3, v48
    v_add_u32 v27, v27, v35
    v_lshl_add_u32 v5, v27, 1, v57
    ds_write_b16 v5, v43
    v_lshrrev_b32 v6, 1, v27
    v_lshl_add_u32 v6, v6, 2, v60
    v_and_b32 v7, 1, v27
    v_mad_u32_u24 v6, v7, s58, v6
    ds_write_b32 v6, v19
    s_mov_b64 exec, -1
    s_mov_b64 exec, 1
    ds_add_u32 v3, v62 offset:16
    s_mov_b64 exec, -1
    v_lshrrev_b32 v5, 5, v0
    v_mad_u32_u24 v13, v5, s58, v60
    v_add_u32 v13, s60, v13
    v_lshl_add_u32 v14, v5, 1, v57
    v_and_b32 v5, 28, v0
    v_add3_u32 v14, v14, v5, s60
    s_mov_b32 s65, 201486784
    s_mov_b32 s64, 0
    s_mov_b32 s59, 0
Lw_13:
    ds_read_b32 v4, v3 offset:16
    s_waitcnt lgkmcnt(0)
    v_cmp_gt_u32 vcc, 8, v4
    s_cbranch_vccz Lk_14
    s_add_u32 s59, s59, 1
    s_cmp_lt_u32 s59, 4194304
    s_cbranch_scc1 Lw_13
    s_branch L_end
Lk_14:
    v_mov_b32 v12, v3
    v_mov_b32 v3, v2
    s_setprio 1
    s_cmp_lt_u32 s4, 4
    s_cbranch_scc1 L_old
    s_setprio 2
L_old:
    s_mov_b64 vcc, 0
    ds_read_b128 v[64:67], v13 offset:0
    ds_read_b128 v[68:71], v13 offset:16
    ds_read_u16 v1, v14
    ds_read_b128 v[48:51], v13 offset:32
    ds_read_b128 v[52:55], v13 offset:48
    s_waitcnt lgkmcnt(3)
L_p0:
    s_cmp_ge_u32 s67, 4
    s_cbranch_scc1 L_p4
    s_cmp_gt_u32 s67, 1
    s_cbranch_scc1 Lps_15
    v_add_u32 v65, v65, v2
    buffer_load_dwordx4 v[20:23], v65, s[8:11], 0 offen
Lps_15:
    s_cmp_gt_u32 s67, 2
    s_cbranch_scc1 Lps_16
    v_add_u32 v66, v66, v2
    buffer_load_dwordx4 v[24:27], v66, s[8:11], 0 offen
Lps_16:
    s_cmp_gt_u32 s67, 3
    s_cbranch_scc1 Lps_17
    v_add_u32 v67, v67, v2
    buffer_load_dwordx4 v[28:31], v67, s[8:11], 0 offen
Lps_17:
L_p4:
    s_cmp_gt_u32 s67, 4
    s_cbranch_scc1 Lps_18
    v_add_u32 v68, v68, v2
    buffer_load_dwordx4 v[32:35], v68, s[8:11], 0 offen
Lps_18:
    s_cmp_gt_u32 s67, 5
    s_cbranch_scc1 Lps_19
    v_add_u32 v69, v69, v2
    buffer_load_dwordx4 v[36:39], v69, s[8:11], 0 offen
Lps_19:
    s_cmp_gt_u32 s67, 6
    s_cbranch_scc1 Lps_20
    v_add_u32 v70, v70, v2
    buffer_load_dwordx4 v[40:43], v70, s[8:11], 0 offen
Lps_20:
    s_cmp_gt_u32 s67, 7
    s_cbranch_scc1 Lps_21
    v_add_u32 v71, v71, v2
    buffer_load_dwordx4 v[44:47], v71, s[8:11], 0 offen
Lps_21:
    s_cmp_eq_u32 s66, 0
    s_cbranch_scc1 L_drain
L_gl:
    s_cmp_le_u32 s66, 4
    s_cbranch_scc1 L_dm0
L_dm0b:
    s_waitcnt lgkmcnt(1)
    v_perm_b32 v6, v1, v1, v10
    v_perm_b32 v7, v1, v1, v11
    ds_read_u16 v1, v14 offset:32
    s_waitcnt vmcnt(6)
    v_lshl_add_u64 v[4:5], v[48:49], 0, v[2:3]
    s_sub_u32 s62, s62, 2
    s_cbranch_scc1 Lfs_0
    v_mfma_f32_4x4x4_16b_bf16 v[56:59], v[6:7], v[16:17], v[56:59] cbsz:3 abid:0
    v_mfma_f32_4x4x4_16b_bf16 v[60:63], v[6:7], v[18:19], v[60:63] cbsz:3 abid:0
    buffer_load_dwordx4 v[16:19], v4, s[8:11], 0 offen
    v_mfma_f32_4x4x4_16b_bf16 v[56:59], v[6:7], v[20:21], v[56:59] cbsz:3 abid:1
    v_mfma_f32_4x4x4_16b_bf16 v[60:63], v[6:7], v[22:23], v[60:63] cbsz:3 abid:1
    buffer_load_dwordx4 v[20:23], v5, s[8:11], 0 offen
Lbs_0:
    s_cbranch_vccnz Ldm_0
Ldb_0:
    s_waitcnt vmcnt(6)
    v_lshl_add_u64 v[4:5], v[50:51], 0, v[2:3]
    s_sub_u32 s62, s62, 2
    s_cbranch_scc1 Lfs_2
    v_mfma_f32_4x4x4_16b_bf16 v[56:59], v[6:7], v[24:25], v[56:59] cbsz:3 abid:2
    v_mfma_f32_4x4x4_16b_bf16 v[60:63], v[6:7], v[26:27], v[60:63] cbsz:3 abid:2
    buffer_load_dwordx4 v[24:27], v4, s[8:11], 0 offen
    v_mfma_f32_4x4x4_16b_bf16 v[56:59], v[6:7], v[28:29], v[56:59] cbsz:3 abid:3
    v_mfma_f32_4x4x4_16b_bf16 v[60:63], v[6:7], v[30:31], v[60:63] cbsz:3 abid:3
    buffer_load_dwordx4 v[28:31], v5, s[8:11], 0 offen
Lbs_2:
    s_cbranch_vccnz Ldm_2
Ldb_2:
    ds_read_b128 v[48:51], v13 offset:64
    s_waitcnt vmcnt(6) lgkmcnt(2)
    v_lshl_add_u64 v[4:5], v[52:53], 0, v[2:3]
    s_sub_u32 s62, s62, 2
    s_cbranch_scc1 Lfs_4
    v_mfma_f32_4x4x4_16b_bf16 v[56:59], v[6:7], v[32:33], v[56:59] cbsz:3 abid:4
    v_mfma_f32_4x4x4_16b_bf16 v[60:63], v[6:7], v[34:35], v[60:63] cbsz:3 abid:4
    buffer_load_dwordx4 v[32:35], v4, s[8:11], 0 offen
    v_mfma_f32_4x4x4_16b_bf16 v[56:59], v[6:7], v[36:37], v[56:59] cbsz:3 abid:5
    v_mfma_f32_4x4x4_16b_bf16 v[60:63], v[6:7], v[38:39], v[60:63] cbsz:3 abid:5
    buffer_load_dwordx4 v[36:39], v5, s[8:11], 0 offen
Lbs_4:
    s_cbranch_vccnz Ldm_4
Ldb_4:
    s_waitcnt vmcnt(6)
    v_lshl_add_u64 v[4:5], v[54:55], 0, v[2:3]
    s_sub_u32 s62, s62, 2
    s_cbranch_scc1 Lfs_6
    v_mfma_f32_4x4x4_16b_bf16 v[56:59], v[6:7], v[40:41], v[56:59] cbsz:3 abid:6
    v_mfma_f32_4x4x4_16b_bf16 v[60:63], v[6:7], v[42:43], v[60:63] cbsz:3 abid:6
    buffer_load_dwordx4 v[40:43], v4, s[8:11], 0 offen
    v_mfma_f32_4x4x4_16b_bf16 v[56:59], v[6:7], v[44:45], v[56:59] cbsz:3 abid:7
    v_mfma_f32_4x4x4_16b_bf16 v[60:63], v[6:7], v[46:47], v[60:63] cbsz:3 abid:7
    buffer_load_dwordx4 v[44:47], v5, s[8:11], 0 offen
Lbs_6:
    s_cbranch_vccnz Ldm_6
Ldb_6:
    ds_read_b128 v[52:55], v13 offset:80
    v_add_u32 v13, 32, v13
    v_add_u32 v14, 32, v14
    s_sub_u32 s66, s66, 1
    s_cmp_eq_u32 s66, 3
    s_cbranch_scc0 L_nf
    s_setprio 1
L_nf:
    s_cmp_lg_u32 s66, 0
    s_cbranch_scc1 L_gl
L_drain:
    s_waitcnt lgkmcnt(0)
    v_perm_b32 v6, v1, v1, v10
    v_perm_b32 v7, v1, v1, v11
    ds_read_u16 v1, v14 offset:32
    s_waitcnt vmcnt(7)
    v_mfma_f32_4x4x4_16b_bf16 v[56:59], v[6:7], v[16:17], v[56:59] cbsz:3 abid:0
    v_mfma_f32_4x4x4_16b_bf16 v[60:63], v[6:7], v[18:19], v[60:63] cbsz:3 abid:0
    s_sub_u32 s62, s62, 1
    s_cbranch_scc1 Lfd_0
Lbd_0:
    s_waitcnt vmcnt(6)
    v_mfma_f32_4x4x4_16b_bf16 v[56:59], v[6:7], v[20:21], v[56:59] cbsz:3 abid:1
    v_mfma_f32_4x4x4_16b_bf16 v[60:63], v[6:7], v[22:23], v[60:63] cbsz:3 abid:1
    s_sub_u32 s62, s62, 1
    s_cbranch_scc1 Lfd_1
Lbd_1:
    s_waitcnt vmcnt(5)
    v_mfma_f32_4x4x4_16b_bf16 v[56:59], v[6:7], v[24:25], v[56:59] cbsz:3 abid:2
    v_mfma_f32_4x4x4_16b_bf16 v[60:63], v[6:7], v[26:27], v[60:63] cbsz:3 abid:2
    s_sub_u32 s62, s62, 1
    s_cbranch_scc1 Lfd_2
Lbd_2:
    s_waitcnt vmcnt(4)
    v_mfma_f32_4x4x4_16b_bf16 v[56:59], v[6:7], v[28:29], v[56:59] cbsz:3 abid:3
    v_mfma_f32_4x4x4_16b_bf16 v[60:63], v[6:7], v[30:31], v[60:63] cbsz:3 abid:3
    s_sub_u32 s62, s62, 1
    s_cbranch_scc1 Lfd_3
Lbd_3:
    s_waitcnt vmcnt(3)
    v_mfma_f32_4x4x4_16b_bf16 v[56:59], v[6:7], v[32:33], v[56:59] cbsz:3 abid:4
    v_mfma_f32_4x4x4_16b_bf16 v[60:63], v[6:7], v[34:35], v[60:63] cbsz:3 abid:4
    s_sub_u32 s62, s62, 1
    s_cbranch_scc1 Lfd_4
Lbd_4:
    s_waitcnt vmcnt(2)
    v_mfma_f32_4x4x4_16b_bf16 v[56:59], v[6:7], v[36:37], v[56:59] cbsz:3 abid:5
    v_mfma_f32_4x4x4_16b_bf16 v[60:63], v[6:7], v[38:39], v[60:63] cbsz:3 abid:5
    s_sub_u32 s62, s62, 1
    s_cbranch_scc1 Lfd_5
Lbd_5:
    s_waitcnt vmcnt(1)
    v_mfma_f32_4x4x4_16b_bf16 v[56:59], v[6:7], v[40:41], v[56:59] cbsz:3 abid:6
    v_mfma_f32_4x4x4_16b_bf16 v[60:63], v[6:7], v[42:43], v[60:63] cbsz:3 abid:6
    s_sub_u32 s62, s62, 1
    s_cbranch_scc1 Lfd_6
Lbd_6:
    s_waitcnt vmcnt(0)
    v_mfma_f32_4x4x4_16b_bf16 v[56:59], v[6:7], v[44:45], v[56:59] cbsz:3 abid:7
    v_mfma_f32_4x4x4_16b_bf16 v[60:63], v[6:7], v[46:47], v[60:63] cbsz:3 abid:7
    s_nop 1
    s_call_b64 s[68:69], L_flush
L_gdone:
    s_cmp_eq_u32 s41, 0
    s_cbranch_scc0 L_dd
    s_mov_b32 s59, 0
Lw_22:
    ds_read_b32 v4, v12 offset:24
    s_waitcnt lgkmcnt(0)
    v_cmp_gt_u32 vcc, 8, v4
    s_cbranch_vccz Lk_23
    s_sleep 2
    s_add_u32 s59, s59, 1
    s_cmp_lt_u32 s59, 4194304
    s_cbranch_scc1 Lw_22
    s_branch L_end
Lk_23:
    s_lshl_b32 s58, s4, 10
    v_lshl_add_u32 v72, v0, 4, s58
    s_and_b32 s58, s4, 4
    v_lshl_add_u32 v73, s58, 4, v72
    s_movk_i32 s58, 0x1f0
    v_bfi_b32 v72, s58, v73, v72
    ds_write_b128 v72, v[96:99] offset:0
    ds_write_b128 v72, v[100:103] offset:8192
    ds_write_b128 v72, v[104:107] offset:16384
    ds_write_b128 v72, v[108:111] offset:24576
    ds_write_b128 v72, v[112:115] offset:32768
    ds_write_b128 v72, v[116:119] offset:40960
    ds_write_b128 v72, v[120:123] offset:49152
    ds_write_b128 v72, v[124:127] offset:57344
    s_mov_b64 exec, 1
    ds_inc_u32 v12, v12 offset:64
    s_mov_b64 exec, -1
L_dd:
    s_endpgm
Lfs_0:
    s_add_u32 s62, s62, 2
    v_mfma_f32_4x4x4_16b_bf16 v[56:59], v[6:7], v[16:17], v[56:59] cbsz:3 abid:0
    v_mfma_f32_4x4x4_16b_bf16 v[60:63], v[6:7], v[18:19], v[60:63] cbsz:3 abid:0
    buffer_load_dwordx4 v[16:19], v4, s[8:11], 0 offen
    s_sub_u32 s62, s62, 1
    s_cbranch_scc0 Lsk_24
    s_call_b64 s[68:69], L_flush
Lsk_24:
    v_mfma_f32_4x4x4_16b_bf16 v[56:59], v[6:7], v[20:21], v[56:59] cbsz:3 abid:1
    v_mfma_f32_4x4x4_16b_bf16 v[60:63], v[6:7], v[22:23], v[60:63] cbsz:3 abid:1
    buffer_load_dwordx4 v[20:23], v5, s[8:11], 0 offen
    s_sub_u32 s62, s62, 1
    s_cbranch_scc0 Lbs_0
    s_call_b64 s[68:69], L_flush
    s_branch Lbs_0
Lfs_2:
    s_add_u32 s62, s62, 2
    v_mfma_f32_4x4x4_16b_bf16 v[56:59], v[6:7], v[24:25], v[56:59] cbsz:3 abid:2
    v_mfma_f32_4x4x4_16b_bf16 v[60:63], v[6:7], v[26:27], v[60:63] cbsz:3 abid:2
    buffer_load_dwordx4 v[24:27], v4, s[8:11], 0 offen
    s_sub_u32 s62, s62, 1
    s_cbranch_scc0 Lsk_26
    s_call_b64 s[68:69], L_flush
Lsk_26:
    v_mfma_f32_4x4x4_16b_bf16 v[56:59], v[6:7], v[28:29], v[56:59] cbsz:3 abid:3
    v_mfma_f32_4x4x4_16b_bf16 v[60:63], v[6:7], v[30:31], v[60:63] cbsz:3 abid:3
    buffer_load_dwordx4 v[28:31], v5, s[8:11], 0 offen
    s_sub_u32 s62, s62, 1
    s_cbranch_scc0 Lbs_2
    s_call_b64 s[68:69], L_flush
    s_branch Lbs_2
Lfs_4:
    s_add_u32 s62, s62, 2
    v_mfma_f32_4x4x4_16b_bf16 v[56:59], v[6:7], v[32:33], v[56:59] cbsz:3 abid:4
    v_mfma_f32_4x4x4_16b_bf16 v[60:63], v[6:7], v[34:35], v[60:63] cbsz:3 abid:4
    buffer_load_dwordx4 v[32:35], v4, s[8:11], 0 offen
    s_sub_u32 s62, s62, 1
    s_cbranch_scc0 Lsk_28
    s_call_b64 s[68:69], L_flush
Lsk_28:
    v_mfma_f32_4x4x4_16b_bf16 v[56:59], v[6:7], v[36:37], v[56:59] cbsz:3 abid:5
    v_mfma_f32_4x4x4_16b_bf16 v[60:63], v[6:7], v[38:39], v[60:63] cbsz:3 abid:5
    buffer_load_dwordx4 v[36:39], v5, s[8:11], 0 offen
    s_sub_u32 s62, s62, 1
    s_cbranch_scc0 Lbs_4
    s_call_b64 s[68:69], L_flush
    s_branch Lbs_4
Lfs_6:
    s_add_u32 s62, s62, 2
    v_mfma_f32_4x4x4_16b_bf16 v[56:59], v[6:7], v[40:41], v[56:59] cbsz:3 abid:6
    v_mfma_f32_4x4x4_16b_bf16 v[60:63], v[6:7], v[42:43], v[60:63] cbsz:3 abid:6
    buffer_load_dwordx4 v[40:43], v4, s[8:11], 0 offen
    s_sub_u32 s62, s62, 1
    s_cbranch_scc0 Lsk_30
    s_call_b64 s[68:69], L_flush
Lsk_30:
    v_mfma_f32_4x4x4_16b_bf16 v[56:59], v[6:7], v[44:45], v[56:59] cbsz:3 abid:7
    v_mfma_f32_4x4x4_16b_bf16 v[60:63], v[6:7], v[46:47], v[60:63] cbsz:3 abid:7
    buffer_load_dwordx4 v[44:47], v5, s[8:11], 0 offen
    s_sub_u32 s62, s62, 1
    s_cbranch_scc0 Lbs_6
    s_call_b64 s[68:69], L_flush
    s_branch Lbs_6
Lfd_0:
    s_call_b64 s[68:69], L_flush
    s_branch Lbd_0
Lfd_1:
    s_call_b64 s[68:69], L_flush
    s_branch Lbd_1
Lfd_2:
    s_call_b64 s[68:69], L_flush
    s_branch Lbd_2
Lfd_3:
    s_call_b64 s[68:69], L_flush
    s_branch Lbd_3
Lfd_4:
    s_call_b64 s[68:69], L_flush
    s_branch Lbd_4
Lfd_5:
    s_call_b64 s[68:69], L_flush
    s_branch Lbd_5
Lfd_6:
    s_call_b64 s[68:69], L_flush
    s_branch Lbd_6
L_dm0:
    s_mov_b64 vcc, 0
    s_cmp_eq_u32 s41, 0
    s_cbranch_scc0 L_dm0b
    ds_read_b32 v4, v12 offset:24
    s_waitcnt lgkmcnt(0)
    v_cmp_le_u32 vcc, 8, v4
    s_cbranch_vccz L_dm0b
    s_lshl_b32 s58, s4, 10
    v_lshl_add_u32 v72, v0, 4, s58
    s_and_b32 s58, s4, 4
    v_lshl_add_u32 v73, s58, 4, v72
    s_movk_i32 s58, 0x1f0
    v_bfi_b32 v72, s58, v73, v72
    s_mov_b32 s41, 1
    s_mov_b64 vcc, -1
    s_branch L_dm0b
Ldm_0:
    ds_write_b128 v72, v[96:99] offset:0
    ds_write_b128 v72, v[100:103] offset:8192
    s_branch Ldb_0
Ldm_2:
    ds_write_b128 v72, v[104:107] offset:16384
    ds_write_b128 v72, v[108:111] offset:24576
    s_branch Ldb_2
Ldm_4:
    ds_write_b128 v72, v[112:115] offset:32768
    ds_write_b128 v72, v[116:119] offset:40960
    s_branch Ldb_4
Ldm_6:
    ds_write_b128 v72, v[120:123] offset:49152
    ds_write_b128 v72, v[124:127] offset:57344
    s_mov_b64 exec, 1
    ds_inc_u32 v12, v12 offset:64
    s_mov_b64 exec, -1
    s_branch Ldb_6
L_flush:
    s_and_b32 s101, s65, 0x3ffff
    s_add_u32 s63, s63, 1
    v_permlane32_swap_b32 v56, v60
    v_permlane32_swap_b32 v57, v61
    v_permlane32_swap_b32 v58, v62
    v_permlane32_swap_b32 v59, v63
    s_lshr_b32 s62, s65, 26
    v_pk_add_f32 v[56:57], v[56:57], v[60:61]
    v_pk_add_f32 v[58:59], v[58:59], v[62:63]
    v_add_u32 v62, s101, v15
    v_pk_mul_f32 v[56:57], v[56:57], s[64:65] op_sel_hi:[1,0]
    v_pk_mul_f32 v[58:59], v[58:59], s[64:65] op_sel_hi:[1,0]
    v_lshl_add_u32 v63, s62, 2, v12
    v_cvt_pk_bf16_f32 v60, v56, v57
    v_cvt_pk_bf16_f32 v61, v58, v59
    ds_write_b64 v62, v[60:61]
    s_mov_b64 exec, 1
    ds_inc_u32 v63, v63 offset:36
    s_mov_b64 exec, -1
    v_readlane_b32 s65, v9, s63
    v_readlane_b32 s64, v8, s63
    v_mov_b64 v[56:57], 0
    v_mov_b64 v[58:59], 0
    v_mov_b64 v[60:61], 0
    v_mov_b64 v[62:63], 0
    s_bfe_u32 s62, s65, 0x80012
    s_setpc_b64 s[68:69]
L_preA:
    s_setprio 2
    s_mul_i32 s5, s6, 40
    v_mov_b32 v3, 160064
    s_mov_b32 s10, 5120000
    s_mov_b32 s11, 0x20000
    s_mov_b64 s[16:17], s[56:57]
    s_mov_b32 s18, 1441792
    s_mov_b32 s19, 0x20000
    v_and_b32 v6, 32, v0
    v_lshl_add_u32 v5, v6, 7, v2
    v_lshl_add_u32 v6, v6, 6, v2
    s_add_u32 s58, s3, s5
    s_mul_i32 s59, s3, 1056
    s_add_u32 m0, s59, 84480
    s_lshl_b32 s58, s58, 9
    buffer_load_dwordx4 v5, s[8:11], s58 offen lds
    s_add_u32 m0, s59, 92928
    s_add_u32 s58, s58, 8192
    buffer_load_dwordx4 v5, s[8:11], s58 offen lds
    s_cmp_ge_u32 s3, 4
    s_cbranch_scc1 L_xa2
    s_add_u32 m0, s59, 101376
    s_add_u32 s58, s58, 8192
    buffer_load_dwordx4 v6, s[8:11], s58 offen lds
L_xa2:
    v_and_b32 v4, 7, v0
    v_mul_u32_u24 v1, 1056, v4
    v_and_b32 v4, 8, v0
    v_lshl_add_u32 v1, v4, 6, v1
    v_and_b32 v4, 48, v0
    v_add_u32 v1, v4, v1
    v_add_u32 v12, 84480, v1
    s_mov_b64 s[20:21], s[52:53]
    s_mov_b32 s22, 5120000
    s_mov_b32 s23, 0x20000
    v_lshlrev_b32 v14, 4, v0
    s_lshl_b32 s61, s3, 6
    s_add_u32 s61, s61, 105600
    v_add_u32 v13, s61, v1
    s_lshl_b32 s100, s3, 14
    s_add_u32 s100, s100, 655360
    s_waitcnt lgkmcnt(0)
    v_lshl_add_u32 v104, s32, 9, v2
    v_lshl_add_u32 v105, s33, 9, v2
    v_lshl_add_u32 v106, s34, 9, v2
    v_lshl_add_u32 v107, s35, 9, v2
    v_lshl_add_u32 v108, s36, 9, v2
    v_lshl_add_u32 v109, s37, 9, v2
    v_lshl_add_u32 v110, s38, 9, v2
    v_lshl_add_u32 v111, s39, 9, v2
    v_lshl_add_u32 v112, s64, 9, v2
    v_lshl_add_u32 v113, s65, 9, v2
    s_mov_b32 exec_lo, 0
    v_lshl_add_u32 v104, s40, 9, v2
    v_lshl_add_u32 v105, s41, 9, v2
    v_lshl_add_u32 v106, s42, 9, v2
    v_lshl_add_u32 v107, s43, 9, v2
    v_lshl_add_u32 v108, s44, 9, v2
    v_lshl_add_u32 v109, s45, 9, v2
    v_lshl_add_u32 v110, s46, 9, v2
    v_lshl_add_u32 v111, s47, 9, v2
    v_lshl_add_u32 v112, s66, 9, v2
    v_lshl_add_u32 v113, s67, 9, v2
    s_mov_b64 exec, -1
    s_cmp_ge_u32 s2, 64
    s_cbranch_scc1 L_nopb
    s_barrier
    s_barrier
L_nopb:
    s_mul_i32 s67, s3, 2112
    s_mul_i32 s66, s3, 8448
    s_add_u32 m0, s66, 0
    s_waitcnt vmcnt(1)
    buffer_load_dwordx4 v104, s[8:11], 0 offen lds
    s_add_u32 m0, s66, 1056
    s_waitcnt vmcnt(1)
    buffer_load_dwordx4 v105, s[8:11], 0 offen lds
    v_and_b32 v4, 3, v0
    v_mov_b32 v5, 0x0c0c0c0c
    v_mov_b32 v6, 0x0c0c0302
    v_mov_b32 v7, 0x03020c0c
    v_cmp_eq_u32 s[58:59], 0, v4
    v_cmp_eq_u32 s[60:61], 2, v4
    v_cmp_eq_u32 vcc, 1, v4
    v_cndmask_b32 v8, v5, v6, s[58:59]
    v_cndmask_b32 v9, v5, v6, s[60:61]
    v_cndmask_b32 v8, v8, v7, vcc
    v_cmp_eq_u32 vcc, 3, v4
    s_nop 1
    v_cndmask_b32 v9, v9, v7, vcc
    v_mov_b32 v10, v8
    v_mov_b32 v11, v9
    v_and_b32 v8, 0xfdfdfdfd, v8
    v_and_b32 v9, 0xfdfdfdfd, v9
    s_add_u32 m0, s66, 2112
    s_waitcnt vmcnt(1)
    buffer_load_dwordx4 v106, s[8:11], 0 offen lds
    s_mov_b64 exec, 1
    v_mov_b32 v4, 1
    ds_add_u32 v3, v4 offset:0
    s_mov_b64 exec, -1
    s_add_u32 m0, s66, 3168
    s_waitcnt vmcnt(1)
    buffer_load_dwordx4 v107, s[8:11], 0 offen lds
    s_add_u32 m0, s66, 4224
    s_waitcnt vmcnt(1)
    buffer_load_dwordx4 v108, s[8:11], 0 offen lds
    s_mov_b32 s59, 0
Lw_32:
    ds_read_b32 v4, v3 offset:0
    s_waitcnt lgkmcnt(0)
    v_cmp_gt_u32 vcc, 8, v4
    s_cbranch_vccz Lk_33
    s_add_u32 s59, s59, 1
    s_cmp_lt_u32 s59, 4194304
    s_cbranch_scc1 Lw_32
    s_branch L_end
Lk_33:
    ds_read_b128 v[80:83], v12 offset:0
    ds_read_b128 v[84:87], v12 offset:8448
    ds_read_b128 v[88:91], v12 offset:16896
    s_add_u32 m0, s66, 5280
    s_waitcnt vmcnt(1)
    buffer_load_dwordx4 v109, s[8:11], 0 offen lds
    s_mov_b64 exec, 1
    v_mov_b32 v4, 1
    ds_add_u32 v3, v4 offset:60
    s_mov_b64 exec, -1
    s_waitcnt vmcnt(1)
    ds_read_b32 v4, v3 offset:52
    s_add_u32 m0, s66, 6336
    s_waitcnt vmcnt(1)
    buffer_load_dwordx4 v110, s[8:11], 0 offen lds
    s_mov_b32 s62, 7
    s_waitcnt lgkmcnt(0)
    v_cmp_gt_u32 vcc, 8, v4
    s_cbranch_vccz L_eu10
    s_waitcnt vmcnt(1)
    ds_read_b32 v4, v3 offset:52
    s_add_u32 m0, s66, 7392
    s_waitcnt vmcnt(1)
    buffer_load_dwordx4 v111, s[8:11], 0 offen lds
    s_mov_b32 s62, 8
    s_waitcnt lgkmcnt(0)
    v_cmp_gt_u32 vcc, 8, v4
    s_cbranch_vccz L_eu10
    s_waitcnt vmcnt(1)
    ds_read_b32 v4, v3 offset:52
    s_add_u32 m0, s67, 67584
    s_waitcnt vmcnt(1)
    buffer_load_dwordx4 v112, s[8:11], 0 offen lds
    s_mov_b32 s62, 9
    s_waitcnt lgkmcnt(0)
    v_cmp_gt_u32 vcc, 8, v4
    s_cbranch_vccz L_eu10
    s_waitcnt vmcnt(1)
    ds_read_b32 v4, v3 offset:52
    s_add_u32 m0, s67, 68640
    s_waitcnt vmcnt(1)
    buffer_load_dwordx4 v113, s[8:11], 0 offen lds
    s_mov_b32 s62, 10
    s_mov_b32 s59, 0
Lw_34:
    ds_read_b32 v4, v3 offset:52
    s_waitcnt lgkmcnt(0)
    v_cmp_gt_u32 vcc, 8, v4
    s_cbranch_vccz Lk_35
    s_sleep 1
    s_add_u32 s59, s59, 1
    s_cmp_lt_u32 s59, 4194304
    s_cbranch_scc1 Lw_34
    s_branch L_end
Lk_35:
L_eu10:
    s_setprio 3
    buffer_load_dwordx4 v[16:19], v14, s[16:19], s100 offen offset:0 sc1
    buffer_load_dwordx4 v[20:23], v14, s[16:19], s100 offen offset:1024 sc1
    buffer_load_dwordx4 v[24:27], v14, s[16:19], s100 offen offset:2048 sc1
    buffer_load_dwordx4 v[28:31], v14, s[16:19], s100 offen offset:3072 sc1
    s_add_u32 s100, s100, 4096
    buffer_load_dwordx4 v[32:35], v14, s[16:19], s100 offen offset:0 sc1
    s_cmp_gt_u32 s62, 7
    s_cbranch_scc1 Lem_36
    s_add_u32 m0, s66, 7392
    s_waitcnt vmcnt(63)
    buffer_load_dwordx4 v111, s[8:11], 0 offen lds
Lem_36:
    buffer_load_dwordx4 v[36:39], v14, s[16:19], s100 offen offset:1024 sc1
    buffer_load_dwordx4 v[40:43], v14, s[16:19], s100 offen offset:2048 sc1
    buffer_load_dwordx4 v[44:47], v14, s[16:19], s100 offen offset:3072 sc1
    s_add_u32 s100, s100, 4096
    buffer_load_dwordx4 v[48:51], v14, s[16:19], s100 offen offset:0 sc1
    buffer_load_dwordx4 v[52:55], v14, s[16:19], s100 offen offset:1024 sc1
    s_cmp_gt_u32 s62, 8
    s_cbranch_scc1 Lem_37
    s_add_u32 m0, s67, 67584
    s_waitcnt vmcnt(63)
    buffer_load_dwordx4 v112, s[8:11], 0 offen lds
Lem_37:
    buffer_load_dwordx4 v[56:59], v14, s[16:19], s100 offen offset:2048 sc1
    buffer_load_dwordx4 v[60:63], v14, s[16:19], s100 offen offset:3072 sc1
    s_add_u32 s100, s100, 4096
    buffer_load_dwordx4 v[64:67], v14, s[16:19], s100 offen offset:0 sc1
    buffer_load_dwordx4 v[68:71], v14, s[16:19], s100 offen offset:1024 sc1
    buffer_load_dwordx4 v[72:75], v14, s[16:19], s100 offen offset:2048 sc1
    buffer_load_dwordx4 v[76:79], v14, s[16:19], s100 offen offset:3072 sc1
    s_cmp_gt_u32 s62, 9
    s_cbranch_scc1 Lem_38
    s_add_u32 m0, s67, 68640
    s_waitcnt vmcnt(63)
    buffer_load_dwordx4 v113, s[8:11], 0 offen lds
Lem_38:
    s_setprio 0
    ds_read_b128 v[92:95], v12 offset:64
    ds_read_b128 v[96:99], v12 offset:8512
    ds_read_b128 v[100:103], v12 offset:16960
    s_waitcnt vmcnt(14) lgkmcnt(3)
    v_mfma_f32_16x16x32_bf16 v[104:107], v[16:19], v[80:83], 0
    v_mfma_f32_16x16x32_bf16 v[108:111], v[20:23], v[80:83], 0
    v_mfma_f32_16x16x32_bf16 v[112:115], v[16:19], v[84:87], 0
    v_mfma_f32_16x16x32_bf16 v[116:119], v[20:23], v[84:87], 0
    v_mfma_f32_16x16x32_bf16 v[120:123], v[16:19], v[88:91], 0
    v_mfma_f32_16x16x32_bf16 v[124:127], v[20:23], v[88:91], 0
    ds_read_b128 v[80:83], v12 offset:128
    ds_read_b128 v[84:87], v12 offset:8576
    ds_read_b128 v[88:91], v12 offset:17024
    s_waitcnt vmcnt(12) lgkmcnt(3)
    v_mfma_f32_16x16x32_bf16 v[104:107], v[24:27], v[92:95], v[104:107]
    v_mfma_f32_16x16x32_bf16 v[108:111], v[28:31], v[92:95], v[108:111]
    v_mfma_f32_16x16x32_bf16 v[112:115], v[24:27], v[96:99], v[112:115]
    v_mfma_f32_16x16x32_bf16 v[116:119], v[28:31], v[96:99], v[116:119]
    v_mfma_f32_16x16x32_bf16 v[120:123], v[24:27], v[100:103], v[120:123]
    v_mfma_f32_16x16x32_bf16 v[124:127], v[28:31], v[100:103], v[124:127]
    ds_read_b128 v[92:95], v12 offset:192
    ds_read_b128 v[96:99], v12 offset:8640
    ds_read_b128 v[100:103], v12 offset:17088
    s_waitcnt vmcnt(10) lgkmcnt(3)
    v_mfma_f32_16x16x32_bf16 v[104:107], v[32:35], v[80:83], v[104:107]
    v_mfma_f32_16x16x32_bf16 v[108:111], v[36:39], v[80:83], v[108:111]
    v_mfma_f32_16x16x32_bf16 v[112:115], v[32:35], v[84:87], v[112:115]
    v_mfma_f32_16x16x32_bf16 v[116:119], v[36:39], v[84:87], v[116:119]
    v_mfma_f32_16x16x32_bf16 v[120:123], v[32:35], v[88:91], v[120:123]
    v_mfma_f32_16x16x32_bf16 v[124:127], v[36:39], v[88:91], v[124:127]
    ds_read_b128 v[80:83], v12 offset:256
    ds_read_b128 v[84:87], v12 offset:8704
    ds_read_b128 v[88:91], v12 offset:17152
    s_waitcnt vmcnt(8) lgkmcnt(3)
    v_mfma_f32_16x16x32_bf16 v[104:107], v[40:43], v[92:95], v[104:107]
    v_mfma_f32_16x16x32_bf16 v[108:111], v[44:47], v[92:95], v[108:111]
    v_mfma_f32_16x16x32_bf16 v[112:115], v[40:43], v[96:99], v[112:115]
    v_mfma_f32_16x16x32_bf16 v[116:119], v[44:47], v[96:99], v[116:119]
    v_mfma_f32_16x16x32_bf16 v[120:123], v[40:43], v[100:103], v[120:123]
    v_mfma_f32_16x16x32_bf16 v[124:127], v[44:47], v[100:103], v[124:127]
    ds_read_b128 v[92:95], v12 offset:320
    ds_read_b128 v[96:99], v12 offset:8768
    ds_read_b128 v[100:103], v12 offset:17216
    s_waitcnt vmcnt(6) lgkmcnt(3)
    v_mfma_f32_16x16x32_bf16 v[104:107], v[48:51], v[80:83], v[104:107]
    v_mfma_f32_16x16x32_bf16 v[108:111], v[52:55], v[80:83], v[108:111]
    v_mfma_f32_16x16x32_bf16 v[112:115], v[48:51], v[84:87], v[112:115]
    v_mfma_f32_16x16x32_bf16 v[116:119], v[52:55], v[84:87], v[116:119]
    v_mfma_f32_16x16x32_bf16 v[120:123], v[48:51], v[88:91], v[120:123]
    v_mfma_f32_16x16x32_bf16 v[124:127], v[52:55], v[88:91], v[124:127]
    ds_read_b128 v[80:83], v12 offset:384
    ds_read_b128 v[84:87], v12 offset:8832
    ds_read_b128 v[88:91], v12 offset:17280
    s_waitcnt vmcnt(4) lgkmcnt(3)
    v_mfma_f32_16x16x32_bf16 v[104:107], v[56:59], v[92:95], v[104:107]
    v_mfma_f32_16x16x32_bf16 v[108:111], v[60:63], v[92:95], v[108:111]
    v_mfma_f32_16x16x32_bf16 v[112:115], v[56:59], v[96:99], v[112:115]
    v_mfma_f32_16x16x32_bf16 v[116:119], v[60:63], v[96:99], v[116:119]
    v_mfma_f32_16x16x32_bf16 v[120:123], v[56:59], v[100:103], v[120:123]
    v_mfma_f32_16x16x32_bf16 v[124:127], v[60:63], v[100:103], v[124:127]
    ds_read_b128 v[92:95], v12 offset:448
    ds_read_b128 v[96:99], v12 offset:8896
    ds_read_b128 v[100:103], v12 offset:17344
    s_waitcnt vmcnt(2) lgkmcnt(3)
    v_mfma_f32_16x16x32_bf16 v[104:107], v[64:67], v[80:83], v[104:107]
    v_mfma_f32_16x16x32_bf16 v[108:111], v[68:71], v[80:83], v[108:111]
    v_mfma_f32_16x16x32_bf16 v[112:115], v[64:67], v[84:87], v[112:115]
    v_mfma_f32_16x16x32_bf16 v[116:119], v[68:71], v[84:87], v[116:119]
    v_mfma_f32_16x16x32_bf16 v[120:123], v[64:67], v[88:91], v[120:123]
    v_mfma_f32_16x16x32_bf16 v[124:127], v[68:71], v[88:91], v[124:127]
    s_waitcnt vmcnt(0) lgkmcnt(0)
    v_mfma_f32_16x16x32_bf16 v[104:107], v[72:75], v[92:95], v[104:107]
    v_mfma_f32_16x16x32_bf16 v[108:111], v[76:79], v[92:95], v[108:111]
    v_mfma_f32_16x16x32_bf16 v[112:115], v[72:75], v[96:99], v[112:115]
    v_mfma_f32_16x16x32_bf16 v[116:119], v[76:79], v[96:99], v[116:119]
    v_mfma_f32_16x16x32_bf16 v[120:123], v[72:75], v[100:103], v[120:123]
    v_mfma_f32_16x16x32_bf16 v[124:127], v[76:79], v[100:103], v[124:127]
    s_nop 3
    v_cvt_pk_bf16_f32 v80, v104, v105
    v_cvt_pk_bf16_f32 v81, v106, v107
    v_cvt_pk_bf16_f32 v82, v108, v109
    v_cvt_pk_bf16_f32 v83, v110, v111
    ds_write_b128 v13, v[80:83] offset:0
    v_cvt_pk_bf16_f32 v84, v112, v113
    v_cvt_pk_bf16_f32 v85, v114, v115
    v_cvt_pk_bf16_f32 v86, v116, v117
    v_cvt_pk_bf16_f32 v87, v118, v119
    ds_write_b128 v13, v[84:87] offset:8448
    v_cvt_pk_bf16_f32 v88, v120, v121
    v_cvt_pk_bf16_f32 v89, v122, v123
    v_cvt_pk_bf16_f32 v90, v124, v125
    v_cvt_pk_bf16_f32 v91, v126, v127
    ds_write_b128 v13, v[88:91] offset:16896
    s_mov_b64 exec, 1
    v_mov_b32 v4, 1
    ds_add_u32 v3, v4 offset:20
    s_mov_b64 exec, -1
    s_setprio 3
    s_add_u32 s100, s100, 118784
    buffer_load_dwordx4 v[16:19], v14, s[16:19], s100 offen offset:0 sc1
    buffer_load_dwordx4 v[20:23], v14, s[16:19], s100 offen offset:1024 sc1
    buffer_load_dwordx4 v[24:27], v14, s[16:19], s100 offen offset:2048 sc1
    buffer_load_dwordx4 v[28:31], v14, s[16:19], s100 offen offset:3072 sc1
    s_add_u32 s100, s100, 4096
    buffer_load_dwordx4 v[32:35], v14, s[16:19], s100 offen offset:0 sc1
    buffer_load_dwordx4 v[36:39], v14, s[16:19], s100 offen offset:1024 sc1
    buffer_load_dwordx4 v[40:43], v14, s[16:19], s100 offen offset:2048 sc1
    buffer_load_dwordx4 v[44:47], v14, s[16:19], s100 offen offset:3072 sc1
    s_add_u32 s100, s100, 4096
    buffer_load_dwordx4 v[48:51], v14, s[16:19], s100 offen offset:0 sc1
    buffer_load_dwordx4 v[52:55], v14, s[16:19], s100 offen offset:1024 sc1
    buffer_load_dwordx4 v[56:59], v14, s[16:19], s100 offen offset:2048 sc1
    buffer_load_dwordx4 v[60:63], v14, s[16:19], s100 offen offset:3072 sc1
    s_add_u32 s100, s100, 4096
    buffer_load_dwordx4 v[64:67], v14, s[16:19], s100 offen offset:0 sc1
    buffer_load_dwordx4 v[68:71], v14, s[16:19], s100 offen offset:1024 sc1
    buffer_load_dwordx4 v[72:75], v14, s[16:19], s100 offen offset:2048 sc1
    buffer_load_dwordx4 v[76:79], v14, s[16:19], s100 offen offset:3072 sc1
    s_setprio 0
    s_mov_b32 s63, s3
L_grp:
    s_mul_i32 s58, s63, 8448
    s_lshr_b32 s59, s63, 2
    s_mul_i32 s59, s59, 8448
    s_and_b32 s60, s63, 1
    s_bfe_u32 s61, s63, 0x10001
    s_cmp_ge_u32 s63, 8
    s_cselect_b32 s61, s60, s61
    s_cselect_b32 s60, 0, s60
    s_mul_i32 s60, s60, 4224
    s_lshl_b32 s61, s61, 9
    s_add_u32 s59, s59, s60
    s_add_u32 s59, s59, s61
    s_add_u32 s59, s59, 105600
    v_add_u32 v12, s58, v1
    v_bfe_u32 v4, v0, 2, 2
    v_mul_u32_u24 v4, 1056, v4
    v_and_b32 v5, 48, v0
    v_add3_u32 v13, v4, v5, s59
    v_lshl_add_u32 v14, v0, 3, s58
    v_lshl_add_u32 v2, v0, 3, s59
    s_cmp_ge_u32 s63, 8
    s_cbranch_scc1 L_grp2
    s_mov_b32 s59, 0
Lw_39:
    ds_read_b32 v4, v3 offset:20
    s_waitcnt lgkmcnt(0)
    v_cmp_gt_u32 vcc, 8, v4
    s_cbranch_vccz Lk_40
    s_sleep 1
    s_add_u32 s59, s59, 1
    s_cmp_lt_u32 s59, 4194304
    s_cbranch_scc1 Lw_39
    s_branch L_end
Lk_40:
L_grp2:
    s_waitcnt lgkmcnt(0)
    ds_read_b128 v[80:83], v12 offset:0
    ds_read_b128 v[84:87], v13 offset:0
    ds_read_b128 v[88:91], v12 offset:64
    ds_read_b128 v[92:95], v13 offset:64
    ds_read_b128 v[96:99], v12 offset:128
    ds_read_b128 v[100:103], v13 offset:128
    ds_read_b128 v[104:107], v12 offset:192
    ds_read_b128 v[108:111], v13 offset:192
    ds_read_b128 v[112:115], v12 offset:256
    ds_read_b128 v[116:119], v13 offset:256
    ds_read_b128 v[120:123], v12 offset:320
    ds_read_b128 v[124:127], v13 offset:320
    s_waitcnt lgkmcnt(10)
    v_mfma_f32_16x16x32_bf16 v[4:7], v[80:83], v[84:87], 0
    ds_read_b128 v[80:83], v12 offset:384
    ds_read_b128 v[84:87], v13 offset:384
    s_waitcnt lgkmcnt(10)
    v_mfma_f32_16x16x32_bf16 v[4:7], v[88:91], v[92:95], v[4:7]
    ds_read_b128 v[88:91], v12 offset:448
    ds_read_b128 v[92:95], v13 offset:448
    s_waitcnt lgkmcnt(10)
    v_mfma_f32_16x16x32_bf16 v[4:7], v[96:99], v[100:103], v[4:7]
    s_waitcnt lgkmcnt(8)
    v_mfma_f32_16x16x32_bf16 v[4:7], v[104:107], v[108:111], v[4:7]
    s_waitcnt lgkmcnt(6)
    v_mfma_f32_16x16x32_bf16 v[4:7], v[112:115], v[116:119], v[4:7]
    s_waitcnt lgkmcnt(4)
    v_mfma_f32_16x16x32_bf16 v[4:7], v[120:123], v[124:127], v[4:7]
    s_waitcnt lgkmcnt(2)
    v_mfma_f32_16x16x32_bf16 v[4:7], v[80:83], v[84:87], v[4:7]
    s_waitcnt lgkmcnt(0)
    v_mfma_f32_16x16x32_bf16 v[4:7], v[88:91], v[92:95], v[4:7]
    ds_read_b64 v[96:97], v14 offset:2112
    ds_read_b64 v[98:99], v14 offset:6336
    ds_read_b64 v[100:101], v14 offset:2624
    ds_read_b64 v[102:103], v14 offset:6848
    ds_read_b64 v[104:105], v14 offset:3168
    ds_read_b64 v[106:107], v14 offset:7392
    ds_read_b64 v[108:109], v14 offset:3680
    ds_read_b64 v[110:111], v14 offset:7904
    ds_read_b64 v[80:81], v14 offset:0
    ds_read_b64 v[82:83], v14 offset:4224
    ds_read_b64 v[84:85], v14 offset:512
    ds_read_b64 v[86:87], v14 offset:4736
    ds_read_b64 v[88:89], v14 offset:1056
    ds_read_b64 v[90:91], v14 offset:5280
    ds_read_b64 v[92:93], v14 offset:1568
    s_waitcnt lgkmcnt(14)
    ds_read_b64 v[94:95], v14 offset:5792
    v_mul_f32 v4, 0x3db8aa3b, v4
    v_mul_f32 v5, 0x3db8aa3b, v5
    v_mul_f32 v6, 0x3db8aa3b, v6
    v_mul_f32 v7, 0x3db8aa3b, v7
    v_exp_f32 v4, v4
    v_exp_f32 v5, v5
    v_exp_f32 v6, v6
    v_exp_f32 v7, v7
    v_add_f32 v12, v4, v5
    v_add_f32 v13, v6, v7
    v_add_f32 v12, v12, v13
    v_add_f32 v12, 0x3089705f, v12
    v_rcp_f32 v12, v12
    s_add_u32 s63, s63, 8
    v_mul_f32 v4, v4, v12
    v_mul_f32 v5, v5, v12
    v_mul_f32 v6, v6, v12
    v_mul_f32 v7, v7, v12
    v_cvt_pk_bf16_f32 v4, v4, v5
    v_cvt_pk_bf16_f32 v6, v6, v7
    v_perm_b32 v112, v4, v4, v8
    v_perm_b32 v113, v4, v4, v9
    v_perm_b32 v114, v4, v4, v10
    v_perm_b32 v115, v4, v4, v11
    v_perm_b32 v116, v6, v6, v8
    v_perm_b32 v117, v6, v6, v9
    v_perm_b32 v118, v6, v6, v10
    v_perm_b32 v119, v6, v6, v11
    s_waitcnt lgkmcnt(0)
    v_mfma_f32_4x4x4_16b_bf16 v[120:123], v[112:113], v[80:81], 0 cbsz:4 abid:0
    v_mfma_f32_4x4x4_16b_bf16 v[124:127], v[112:113], v[82:83], 0 cbsz:4 abid:5
    v_mfma_f32_4x4x4_16b_bf16 v[4:7], v[112:113], v[84:85], 0 cbsz:4 abid:10
    v_mfma_f32_4x4x4_16b_bf16 v[12:15], v[112:113], v[86:87], 0 cbsz:4 abid:15
    v_mfma_f32_4x4x4_16b_bf16 v[120:123], v[114:115], v[88:89], v[120:123] cbsz:4 abid:0
    v_mfma_f32_4x4x4_16b_bf16 v[124:127], v[114:115], v[90:91], v[124:127] cbsz:4 abid:5
    v_mfma_f32_4x4x4_16b_bf16 v[4:7], v[114:115], v[92:93], v[4:7] cbsz:4 abid:10
    v_mfma_f32_4x4x4_16b_bf16 v[12:15], v[114:115], v[94:95], v[12:15] cbsz:4 abid:15
    v_mfma_f32_4x4x4_16b_bf16 v[120:123], v[116:117], v[96:97], v[120:123] cbsz:4 abid:0
    v_mfma_f32_4x4x4_16b_bf16 v[124:127], v[116:117], v[98:99], v[124:127] cbsz:4 abid:5
    v_mfma_f32_4x4x4_16b_bf16 v[4:7], v[116:117], v[100:101], v[4:7] cbsz:4 abid:10
    v_mfma_f32_4x4x4_16b_bf16 v[12:15], v[116:117], v[102:103], v[12:15] cbsz:4 abid:15
    v_mfma_f32_4x4x4_16b_bf16 v[120:123], v[118:119], v[104:105], v[120:123] cbsz:4 abid:0
    v_mfma_f32_4x4x4_16b_bf16 v[124:127], v[118:119], v[106:107], v[124:127] cbsz:4 abid:5
    v_mfma_f32_4x4x4_16b_bf16 v[4:7], v[118:119], v[108:109], v[4:7] cbsz:4 abid:10
    v_mfma_f32_4x4x4_16b_bf16 v[12:15], v[118:119], v[110:111], v[12:15] cbsz:4 abid:15
    s_nop 1
    v_cvt_pk_bf16_f32 v112, v120, v121
    v_cvt_pk_bf16_f32 v113, v122, v123
    ds_write_b64 v2, v[112:113] offset:0
    v_cvt_pk_bf16_f32 v114, v124, v125
    v_cvt_pk_bf16_f32 v115, v126, v127
    ds_write_b64 v2, v[114:115] offset:1056
    v_cvt_pk_bf16_f32 v116, v4, v5
    v_cvt_pk_bf16_f32 v117, v6, v7
    ds_write_b64 v2, v[116:117] offset:2112
    v_cvt_pk_bf16_f32 v118, v12, v13
    v_cvt_pk_bf16_f32 v119, v14, v15
    ds_write_b64 v2, v[118:119] offset:3168
    s_cmp_lt_u32 s63, 10
    s_cbranch_scc1 L_grp
L_grpx:
    s_mov_b64 exec, 1
    v_mov_b32 v4, 1
    ds_add_u32 v3, v4 offset:24
    s_mov_b64 exec, -1
    v_add_u32 v12, 105600, v1
    v_lshlrev_b32 v14, 4, v0
    v_and_b32 v6, 15, v0
    v_lshlrev_b32 v6, 2, v6
    v_and_b32 v5, 48, v0
    v_lshl_add_u32 v8, v5, 7, v6
    v_and_b32 v5, 32, v0
    v_lshl_add_u32 v9, v5, 6, v6
    v_and_b32 v5, 16, v0
    v_lshl_add_u32 v9, v5, 22, v9
    s_lshl_b32 s60, s5, 9
    s_lshl_b32 s61, s3, 6
    s_add_u32 s60, s60, s61
    s_mov_b32 s59, 0
Lw_41:
    ds_read_b32 v4, v3 offset:24
    s_waitcnt lgkmcnt(0)
    v_cmp_gt_u32 vcc, 8, v4
    s_cbranch_vccz Lk_42
    s_sleep 1
    s_add_u32 s59, s59, 1
    s_cmp_lt_u32 s59, 4194304
    s_cbranch_scc1 Lw_41
    s_branch L_end
Lk_42:
    ds_read_b128 v[80:83], v12 offset:0
    ds_read_b128 v[84:87], v12 offset:8448
    ds_read_b128 v[88:91], v12 offset:16896
    ds_read_b128 v[92:95], v12 offset:64
    ds_read_b128 v[96:99], v12 offset:8512
    ds_read_b128 v[100:103], v12 offset:16960
    s_waitcnt vmcnt(14) lgkmcnt(3)
    v_mfma_f32_16x16x32_bf16 v[104:107], v[80:83], v[16:19], 0
    v_mfma_f32_16x16x32_bf16 v[108:111], v[80:83], v[20:23], 0
    v_mfma_f32_16x16x32_bf16 v[112:115], v[84:87], v[16:19], 0
    v_mfma_f32_16x16x32_bf16 v[116:119], v[84:87], v[20:23], 0
    v_mfma_f32_16x16x32_bf16 v[120:123], v[88:91], v[16:19], 0
    v_mfma_f32_16x16x32_bf16 v[124:127], v[88:91], v[20:23], 0
    ds_read_b128 v[80:83], v12 offset:128
    ds_read_b128 v[84:87], v12 offset:8576
    ds_read_b128 v[88:91], v12 offset:17024
    s_waitcnt vmcnt(12) lgkmcnt(3)
    v_mfma_f32_16x16x32_bf16 v[104:107], v[92:95], v[24:27], v[104:107]
    v_mfma_f32_16x16x32_bf16 v[108:111], v[92:95], v[28:31], v[108:111]
    v_mfma_f32_16x16x32_bf16 v[112:115], v[96:99], v[24:27], v[112:115]
    v_mfma_f32_16x16x32_bf16 v[116:119], v[96:99], v[28:31], v[116:119]
    v_mfma_f32_16x16x32_bf16 v[120:123], v[100:103], v[24:27], v[120:123]
    v_mfma_f32_16x16x32_bf16 v[124:127], v[100:103], v[28:31], v[124:127]
    ds_read_b128 v[92:95], v12 offset:192
    ds_read_b128 v[96:99], v12 offset:8640
    ds_read_b128 v[100:103], v12 offset:17088
    s_waitcnt vmcnt(10) lgkmcnt(3)
    v_mfma_f32_16x16x32_bf16 v[104:107], v[80:83], v[32:35], v[104:107]
    v_mfma_f32_16x16x32_bf16 v[108:111], v[80:83], v[36:39], v[108:111]
    v_mfma_f32_16x16x32_bf16 v[112:115], v[84:87], v[32:35], v[112:115]
    v_mfma_f32_16x16x32_bf16 v[116:119], v[84:87], v[36:39], v[116:119]
    v_mfma_f32_16x16x32_bf16 v[120:123], v[88:91], v[32:35], v[120:123]
    v_mfma_f32_16x16x32_bf16 v[124:127], v[88:91], v[36:39], v[124:127]
    ds_read_b128 v[80:83], v12 offset:256
    ds_read_b128 v[84:87], v12 offset:8704
    ds_read_b128 v[88:91], v12 offset:17152
    s_waitcnt vmcnt(8) lgkmcnt(3)
    v_mfma_f32_16x16x32_bf16 v[104:107], v[92:95], v[40:43], v[104:107]
    v_mfma_f32_16x16x32_bf16 v[108:111], v[92:95], v[44:47], v[108:111]
    v_mfma_f32_16x16x32_bf16 v[112:115], v[96:99], v[40:43], v[112:115]
    v_mfma_f32_16x16x32_bf16 v[116:119], v[96:99], v[44:47], v[116:119]
    v_mfma_f32_16x16x32_bf16 v[120:123], v[100:103], v[40:43], v[120:123]
    v_mfma_f32_16x16x32_bf16 v[124:127], v[100:103], v[44:47], v[124:127]
    ds_read_b128 v[92:95], v12 offset:320
    ds_read_b128 v[96:99], v12 offset:8768
    ds_read_b128 v[100:103], v12 offset:17216
    s_waitcnt vmcnt(6) lgkmcnt(3)
    v_mfma_f32_16x16x32_bf16 v[104:107], v[80:83], v[48:51], v[104:107]
    v_mfma_f32_16x16x32_bf16 v[108:111], v[80:83], v[52:55], v[108:111]
    v_mfma_f32_16x16x32_bf16 v[112:115], v[84:87], v[48:51], v[112:115]
    v_mfma_f32_16x16x32_bf16 v[116:119], v[84:87], v[52:55], v[116:119]
    v_mfma_f32_16x16x32_bf16 v[120:123], v[88:91], v[48:51], v[120:123]
    v_mfma_f32_16x16x32_bf16 v[124:127], v[88:91], v[52:55], v[124:127]
    ds_read_b128 v[80:83], v12 offset:384
    ds_read_b128 v[84:87], v12 offset:8832
    ds_read_b128 v[88:91], v12 offset:17280
    s_waitcnt vmcnt(4) lgkmcnt(3)
    v_mfma_f32_16x16x32_bf16 v[104:107], v[92:95], v[56:59], v[104:107]
    v_mfma_f32_16x16x32_bf16 v[108:111], v[92:95], v[60:63], v[108:111]
    v_mfma_f32_16x16x32_bf16 v[112:115], v[96:99], v[56:59], v[112:115]
    v_mfma_f32_16x16x32_bf16 v[116:119], v[96:99], v[60:63], v[116:119]
    v_mfma_f32_16x16x32_bf16 v[120:123], v[100:103], v[56:59], v[120:123]
    v_mfma_f32_16x16x32_bf16 v[124:127], v[100:103], v[60:63], v[124:127]
    ds_read_b128 v[92:95], v12 offset:448
    ds_read_b128 v[96:99], v12 offset:8896
    ds_read_b128 v[100:103], v12 offset:17344
    s_waitcnt vmcnt(2) lgkmcnt(3)
    v_mfma_f32_16x16x32_bf16 v[104:107], v[80:83], v[64:67], v[104:107]
    v_mfma_f32_16x16x32_bf16 v[108:111], v[80:83], v[68:71], v[108:111]
    v_mfma_f32_16x16x32_bf16 v[112:115], v[84:87], v[64:67], v[112:115]
    v_mfma_f32_16x16x32_bf16 v[116:119], v[84:87], v[68:71], v[116:119]
    v_mfma_f32_16x16x32_bf16 v[120:123], v[88:91], v[64:67], v[120:123]
    v_mfma_f32_16x16x32_bf16 v[124:127], v[88:91], v[68:71], v[124:127]
    s_waitcnt vmcnt(0) lgkmcnt(0)
    v_mfma_f32_16x16x32_bf16 v[104:107], v[92:95], v[72:75], v[104:107]
    v_mfma_f32_16x16x32_bf16 v[108:111], v[92:95], v[76:79], v[108:111]
    v_mfma_f32_16x16x32_bf16 v[112:115], v[96:99], v[72:75], v[112:115]
    v_mfma_f32_16x16x32_bf16 v[116:119], v[96:99], v[76:79], v[116:119]
    v_mfma_f32_16x16x32_bf16 v[120:123], v[100:103], v[72:75], v[120:123]
    v_mfma_f32_16x16x32_bf16 v[124:127], v[100:103], v[76:79], v[124:127]
    s_add_u32 s100, s100, 122880
    s_setprio 3
    s_add_u32 s100, s100, 4096
    buffer_load_dwordx4 v[48:51], v14, s[16:19], s100 offen offset:0 sc1
    buffer_load_dwordx4 v[52:55], v14, s[16:19], s100 offen offset:1024 sc1
    buffer_load_dwordx4 v[56:59], v14, s[16:19], s100 offen offset:2048 sc1
    buffer_load_dwordx4 v[60:63], v14, s[16:19], s100 offen offset:3072 sc1
    s_add_u32 s100, s100, 4096
    buffer_load_dwordx4 v[64:67], v14, s[16:19], s100 offen offset:0 sc1
    buffer_load_dwordx4 v[68:71], v14, s[16:19], s100 offen offset:1024 sc1
    buffer_load_dwordx4 v[72:75], v14, s[16:19], s100 offen offset:2048 sc1
    buffer_load_dwordx4 v[76:79], v14, s[16:19], s100 offen offset:3072 sc1
    s_setprio 0
    v_and_b32 v5, 15, v0
    v_lshlrev_b32 v5, 2, v5
    v_and_b32 v6, 16, v0
    v_lshl_add_u32 v5, v6, 2, v5
    s_lshl_b32 s58, s3, 6
    v_add_u32 v5, s58, v5
    v_and_b32 v5, 0x1ff, v5
    v_and_b32 v6, 48, v0
    v_lshl_add_u32 v5, v6, 8, v5
    s_mov_b32 s70, 0x05040100
    s_mov_b32 s71, 0x07060302
    s_mov_b32 s59, 0
Lw_43:
    ds_read_b32 v4, v3 offset:64
    s_waitcnt lgkmcnt(0)
    v_cmp_gt_u32 vcc, 8, v4
    s_cbranch_vccz Lk_44
    s_sleep 2
    s_add_u32 s59, s59, 1
    s_cmp_lt_u32 s59, 16777216
    s_cbranch_scc1 Lw_43
    s_branch L_end
Lk_44:
    ds_read2st64_b32 v[24:25], v5 offset0:0 offset1:2
    ds_read2st64_b32 v[26:27], v5 offset0:4 offset1:6
    ds_read2st64_b32 v[28:29], v5 offset0:8 offset1:10
    ds_read2st64_b32 v[30:31], v5 offset0:12 offset1:14
    ds_read2st64_b32 v[32:33], v5 offset0:64 offset1:66
    ds_read2st64_b32 v[34:35], v5 offset0:68 offset1:70
    ds_read2st64_b32 v[36:37], v5 offset0:72 offset1:74
    ds_read2st64_b32 v[38:39], v5 offset0:76 offset1:78
    ds_read2st64_b32 v[40:41], v5 offset0:128 offset1:130
    ds_read2st64_b32 v[42:43], v5 offset0:132 offset1:134
    ds_read2st64_b32 v[44:45], v5 offset0:136 offset1:138
    ds_read2st64_b32 v[46:47], v5 offset0:140 offset1:142
    s_waitcnt lgkmcnt(8)
    ds_read2st64_b32 v[80:81], v5 offset0:192 offset1:194
    ds_read2st64_b32 v[82:83], v5 offset0:196 offset1:198
    ds_read2st64_b32 v[84:85], v5 offset0:200 offset1:202
    ds_read2st64_b32 v[86:87], v5 offset0:204 offset1:206
    v_perm_b32 v16, v25, v24, s70
    v_perm_b32 v20, v25, v24, s71
    v_perm_b32 v17, v27, v26, s70
    v_perm_b32 v21, v27, v26, s71
    v_perm_b32 v18, v29, v28, s70
    v_perm_b32 v22, v29, v28, s71
    v_perm_b32 v19, v31, v30, s70
    v_perm_b32 v23, v31, v30, s71
    s_waitcnt lgkmcnt(8)
    v_perm_b32 v24, v33, v32, s70
    v_perm_b32 v28, v33, v32, s71
    v_perm_b32 v25, v35, v34, s70
    v_perm_b32 v29, v35, v34, s71
    v_perm_b32 v26, v37, v36, s70
    v_perm_b32 v30, v37, v36, s71
    v_perm_b32 v27, v39, v38, s70
    v_perm_b32 v31, v39, v38, s71
    s_waitcnt lgkmcnt(4)
    v_perm_b32 v32, v41, v40, s70
    v_perm_b32 v36, v41, v40, s71
    v_perm_b32 v33, v43, v42, s70
    v_perm_b32 v37, v43, v42, s71
    v_perm_b32 v34, v45, v44, s70
    v_perm_b32 v38, v45, v44, s71
    v_perm_b32 v35, v47, v46, s70
    v_perm_b32 v39, v47, v46, s71
    s_waitcnt lgkmcnt(0)
    v_perm_b32 v40, v81, v80, s70
    v_perm_b32 v44, v81, v80, s71
    v_perm_b32 v41, v83, v82, s70
    v_perm_b32 v45, v83, v82, s71
    v_perm_b32 v42, v85, v84, s70
    v_perm_b32 v46, v85, v84, s71
    v_perm_b32 v43, v87, v86, s70
    v_perm_b32 v47, v87, v86, s71
    v_add_u32 v12, 130944, v1
    s_mov_b32 s59, 0
Lw_45:
    ds_read_b32 v4, v3 offset:36
    s_waitcnt lgkmcnt(0)
    v_cmp_gt_u32 vcc, 16, v4
    s_cbranch_vccz Lk_46
    s_sleep 3
    s_add_u32 s59, s59, 1
    s_cmp_lt_u32 s59, 16777216
    s_cbranch_scc1 Lw_45
    s_branch L_end
Lk_46:
    ds_read_b128 v[80:83], v12 offset:0
    ds_read_b128 v[84:87], v12 offset:64
    ds_read_b128 v[88:91], v12 offset:128
    ds_read_b128 v[92:95], v12 offset:192
    ds_read_b128 v[96:99], v12 offset:256
    ds_read_b128 v[100:103], v12 offset:320
    s_waitcnt vmcnt(14) lgkmcnt(5)
    v_mfma_f32_16x16x32_bf16 v[104:107], v[80:83], v[16:19], v[104:107]
    v_mfma_f32_16x16x32_bf16 v[108:111], v[80:83], v[20:23], v[108:111]
    ds_read_b128 v[80:83], v12 offset:384
    s_waitcnt vmcnt(12) lgkmcnt(5)
    v_mfma_f32_16x16x32_bf16 v[104:107], v[84:87], v[24:27], v[104:107]
    v_mfma_f32_16x16x32_bf16 v[108:111], v[84:87], v[28:31], v[108:111]
    ds_read_b128 v[84:87], v12 offset:448
    s_waitcnt vmcnt(10) lgkmcnt(5)
    v_mfma_f32_16x16x32_bf16 v[104:107], v[88:91], v[32:35], v[104:107]
    v_mfma_f32_16x16x32_bf16 v[108:111], v[88:91], v[36:39], v[108:111]
    s_waitcnt vmcnt(8) lgkmcnt(4)
    v_mfma_f32_16x16x32_bf16 v[104:107], v[92:95], v[40:43], v[104:107]
    v_mfma_f32_16x16x32_bf16 v[108:111], v[92:95], v[44:47], v[108:111]
    s_waitcnt vmcnt(6) lgkmcnt(3)
    v_mfma_f32_16x16x32_bf16 v[104:107], v[96:99], v[48:51], v[104:107]
    v_mfma_f32_16x16x32_bf16 v[108:111], v[96:99], v[52:55], v[108:111]
    s_waitcnt vmcnt(4) lgkmcnt(2)
    v_mfma_f32_16x16x32_bf16 v[104:107], v[100:103], v[56:59], v[104:107]
    v_mfma_f32_16x16x32_bf16 v[108:111], v[100:103], v[60:63], v[108:111]
    s_waitcnt vmcnt(2) lgkmcnt(1)
    v_mfma_f32_16x16x32_bf16 v[104:107], v[80:83], v[64:67], v[104:107]
    v_mfma_f32_16x16x32_bf16 v[108:111], v[80:83], v[68:71], v[108:111]
    s_waitcnt vmcnt(0) lgkmcnt(0)
    v_mfma_f32_16x16x32_bf16 v[104:107], v[84:87], v[72:75], v[104:107]
    v_mfma_f32_16x16x32_bf16 v[108:111], v[84:87], v[76:79], v[108:111]
    s_nop 7
    v_cvt_pk_bf16_f32 v104, v104, v108
    buffer_store_dword v104, v8, s[20:23], s60 offen offset:0 sc1
    v_cvt_pk_bf16_f32 v105, v105, v109
    buffer_store_dword v105, v8, s[20:23], s60 offen offset:512 sc1
    v_cvt_pk_bf16_f32 v106, v106, v110
    buffer_store_dword v106, v8, s[20:23], s60 offen offset:1024 sc1
    v_cvt_pk_bf16_f32 v107, v107, v111
    buffer_store_dword v107, v8, s[20:23], s60 offen offset:1536 sc1
    s_add_u32 s60, s60, 8192
    s_mov_b32 s59, 0
Lw_47:
    ds_read_b32 v4, v3 offset:40
    s_waitcnt lgkmcnt(0)
    v_cmp_gt_u32 vcc, 16, v4
    s_cbranch_vccz Lk_48
    s_sleep 3
    s_add_u32 s59, s59, 1
    s_cmp_lt_u32 s59, 16777216
    s_cbranch_scc1 Lw_47
    s_branch L_end
Lk_48:
    ds_read_b128 v[80:83], v12 offset:8448
    ds_read_b128 v[84:87], v12 offset:8512
    ds_read_b128 v[88:91], v12 offset:8576
    ds_read_b128 v[92:95], v12 offset:8640
    ds_read_b128 v[96:99], v12 offset:8704
    ds_read_b128 v[100:103], v12 offset:8768
    s_waitcnt lgkmcnt(5)
    v_mfma_f32_16x16x32_bf16 v[112:115], v[80:83], v[16:19], v[112:115]
    v_mfma_f32_16x16x32_bf16 v[116:119], v[80:83], v[20:23], v[116:119]
    ds_read_b128 v[80:83], v12 offset:8832
    s_waitcnt lgkmcnt(5)
    v_mfma_f32_16x16x32_bf16 v[112:115], v[84:87], v[24:27], v[112:115]
    v_mfma_f32_16x16x32_bf16 v[116:119], v[84:87], v[28:31], v[116:119]
    ds_read_b128 v[84:87], v12 offset:8896
    s_waitcnt lgkmcnt(5)
    v_mfma_f32_16x16x32_bf16 v[112:115], v[88:91], v[32:35], v[112:115]
    v_mfma_f32_16x16x32_bf16 v[116:119], v[88:91], v[36:39], v[116:119]
    s_waitcnt lgkmcnt(4)
    v_mfma_f32_16x16x32_bf16 v[112:115], v[92:95], v[40:43], v[112:115]
    v_mfma_f32_16x16x32_bf16 v[116:119], v[92:95], v[44:47], v[116:119]
    s_waitcnt lgkmcnt(3)
    v_mfma_f32_16x16x32_bf16 v[112:115], v[96:99], v[48:51], v[112:115]
    v_mfma_f32_16x16x32_bf16 v[116:119], v[96:99], v[52:55], v[116:119]
    s_waitcnt lgkmcnt(2)
    v_mfma_f32_16x16x32_bf16 v[112:115], v[100:103], v[56:59], v[112:115]
    v_mfma_f32_16x16x32_bf16 v[116:119], v[100:103], v[60:63], v[116:119]
    s_waitcnt lgkmcnt(1)
    v_mfma_f32_16x16x32_bf16 v[112:115], v[80:83], v[64:67], v[112:115]
    v_mfma_f32_16x16x32_bf16 v[116:119], v[80:83], v[68:71], v[116:119]
    s_waitcnt lgkmcnt(0)
    v_mfma_f32_16x16x32_bf16 v[112:115], v[84:87], v[72:75], v[112:115]
    v_mfma_f32_16x16x32_bf16 v[116:119], v[84:87], v[76:79], v[116:119]
    s_nop 7
    v_cvt_pk_bf16_f32 v112, v112, v116
    buffer_store_dword v112, v8, s[20:23], s60 offen offset:0 sc1
    v_cvt_pk_bf16_f32 v113, v113, v117
    buffer_store_dword v113, v8, s[20:23], s60 offen offset:512 sc1
    v_cvt_pk_bf16_f32 v114, v114, v118
    buffer_store_dword v114, v8, s[20:23], s60 offen offset:1024 sc1
    v_cvt_pk_bf16_f32 v115, v115, v119
    buffer_store_dword v115, v8, s[20:23], s60 offen offset:1536 sc1
    s_add_u32 s60, s60, 8192
    s_mov_b32 s59, 0
Lw_49:
    ds_read_b32 v4, v3 offset:44
    s_waitcnt lgkmcnt(0)
    v_cmp_gt_u32 vcc, 8, v4
    s_cbranch_vccz Lk_50
    s_add_u32 s59, s59, 1
    s_cmp_lt_u32 s59, 16777216
    s_cbranch_scc1 Lw_49
    s_branch L_end
Lk_50:
    ds_read_b128 v[80:83], v12 offset:16896
    ds_read_b128 v[84:87], v12 offset:16960
    ds_read_b128 v[88:91], v12 offset:17024
    ds_read_b128 v[92:95], v12 offset:17088
    ds_read_b128 v[96:99], v12 offset:17152
    ds_read_b128 v[100:103], v12 offset:17216
    s_waitcnt lgkmcnt(5)
    v_mfma_f32_16x16x32_bf16 v[120:123], v[80:83], v[16:19], v[120:123]
    v_mfma_f32_16x16x32_bf16 v[124:127], v[80:83], v[20:23], v[124:127]
    ds_read_b128 v[80:83], v12 offset:17280
    s_waitcnt lgkmcnt(5)
    v_mfma_f32_16x16x32_bf16 v[120:123], v[84:87], v[24:27], v[120:123]
    v_mfma_f32_16x16x32_bf16 v[124:127], v[84:87], v[28:31], v[124:127]
    ds_read_b128 v[84:87], v12 offset:17344
    s_waitcnt lgkmcnt(5)
    v_mfma_f32_16x16x32_bf16 v[120:123], v[88:91], v[32:35], v[120:123]
    v_mfma_f32_16x16x32_bf16 v[124:127], v[88:91], v[36:39], v[124:127]
    s_waitcnt lgkmcnt(4)
    v_mfma_f32_16x16x32_bf16 v[120:123], v[92:95], v[40:43], v[120:123]
    v_mfma_f32_16x16x32_bf16 v[124:127], v[92:95], v[44:47], v[124:127]
    s_waitcnt lgkmcnt(3)
    v_mfma_f32_16x16x32_bf16 v[120:123], v[96:99], v[48:51], v[120:123]
    v_mfma_f32_16x16x32_bf16 v[124:127], v[96:99], v[52:55], v[124:127]
    s_waitcnt lgkmcnt(2)
    v_mfma_f32_16x16x32_bf16 v[120:123], v[100:103], v[56:59], v[120:123]
    v_mfma_f32_16x16x32_bf16 v[124:127], v[100:103], v[60:63], v[124:127]
    s_waitcnt lgkmcnt(1)
    v_mfma_f32_16x16x32_bf16 v[120:123], v[80:83], v[64:67], v[120:123]
    v_mfma_f32_16x16x32_bf16 v[124:127], v[80:83], v[68:71], v[124:127]
    s_waitcnt lgkmcnt(0)
    v_mfma_f32_16x16x32_bf16 v[120:123], v[84:87], v[72:75], v[120:123]
    v_mfma_f32_16x16x32_bf16 v[124:127], v[84:87], v[76:79], v[124:127]
    s_nop 7
    v_cvt_pk_bf16_f32 v120, v120, v124
    buffer_store_dword v120, v9, s[20:23], s60 offen offset:0 sc1
    v_cvt_pk_bf16_f32 v121, v121, v125
    buffer_store_dword v121, v9, s[20:23], s60 offen offset:512 sc1
    v_cvt_pk_bf16_f32 v122, v122, v126
    buffer_store_dword v122, v9, s[20:23], s60 offen offset:1024 sc1
    v_cvt_pk_bf16_f32 v123, v123, v127
    buffer_store_dword v123, v9, s[20:23], s60 offen offset:1536 sc1
L_end:
L_exit:
    s_endpgm
L_slow:
    s_setprio 0
    s_mov_b64 exec, 1
    ds_add_u32 v3, v62 offset:16
    s_mov_b64 exec, -1
    s_mov_b32 s59, 0
Lw_51:
    ds_read_b32 v4, v3 offset:16
    s_waitcnt lgkmcnt(0)
    v_cmp_gt_u32 vcc, 8, v4
    s_cbranch_vccz Lk_52
    s_add_u32 s59, s59, 1
    s_cmp_lt_u32 s59, 4194304
    s_cbranch_scc1 Lw_51
    s_branch L_end
Lk_52:
    v_mov_b32 v12, v3
    s_mov_b64 s[24:25], s[34:35]
    s_mov_b32 s26, 640000
    s_mov_b64 s[28:29], s[36:37]
    s_mov_b32 s30, 640000
    s_mov_b64 s[12:13], s[42:43]
    s_mov_b32 s14, 20000
    s_mov_b32 s15, 0x20000
    s_sub_u32 s63, s67, 1
    s_mov_b32 s65, 201486784
    s_mov_b32 s64, 0
    s_call_b64 s[68:69], L_flush
    s_add_u32 s66, s4, s5
    s_add_u32 s67, s66, 40
    v_lshlrev_b32 v16, 2, v0
    v_and_b32 v17, 32, v0
    v_lshl_add_u32 v17, v17, 22, v2
    v_mov_b32 v24, 0
L_sn:
    s_mov_b32 s60, 0
L_sc:
    buffer_load_dword v18, v16, s[28:31], s60 offen
    buffer_load_dword v19, v16, s[24:27], s60 offen
    s_waitcnt vmcnt(0)
    v_cmp_eq_u32 vcc, s66, v18
    s_cbranch_vccz L_sx
L_se:
    s_ff1_i32_b64 s58, vcc
    s_bitset0_b64 vcc, s58
    v_readlane_b32 s59, v19, s58
    s_nop 3
    s_lshl_b32 s61, s59, 9
    s_lshl_b32 s59, s59, 1
    buffer_load_dwordx4 v[20:23], v17, s[8:11], s61 offen
    buffer_load_ushort v1, v24, s[12:15], s59 offen
    s_waitcnt vmcnt(0)
    v_perm_b32 v6, v1, v1, v10
    v_perm_b32 v7, v1, v1, v11
    s_nop 1
    v_mfma_f32_4x4x4_16b_bf16 v[56:59], v[6:7], v[20:21], v[56:59]
    v_mfma_f32_4x4x4_16b_bf16 v[60:63], v[6:7], v[22:23], v[60:63]
    s_cmp_lg_u64 vcc, 0
    s_cbranch_scc1 L_se
L_sx:
    s_add_u32 s60, s60, 256
    s_cmp_lt_u32 s60, 640000
    s_cbranch_scc1 L_sc
    s_call_b64 s[68:69], L_flush
    s_add_u32 s66, s66, 8
    s_cmp_lt_u32 s66, s67
    s_cbranch_scc1 L_sn
    s_branch L_gdone
.section .rodata,"a"
.p2align 6
.amdhsa_kernel standalone__hybrid_graph_tf_exphormer__graph_kernel
  .amdhsa_next_free_vgpr 128
  .amdhsa_next_free_sgpr 102
  .amdhsa_accum_offset 128
  .amdhsa_group_segment_fixed_size 0
  .amdhsa_kernarg_size 104
  .amdhsa_user_sgpr_count 2
  .amdhsa_user_sgpr_kernarg_segment_ptr 1
  .amdhsa_system_sgpr_workgroup_id_x 1
.end_amdhsa_kernel
```

```asm
; @launch grid=(250,1,1) block=(1024,1,1) lds=162240
.amdgcn_target "amdgcn-amd-amdhsa--gfx950"
.text
.globl standalone__hybrid_graph_tf_exphormer__graph_kernel
.p2align 8
.type standalone__hybrid_graph_tf_exphormer__graph_kernel,@function
standalone__hybrid_graph_tf_exphormer__graph_kernel:
    s_cmpk_ge_u32 s2, 250
    s_cbranch_scc1 L_exit
    s_load_dwordx16 s[32:47], s[0:1], 0
    s_load_dwordx8 s[48:55], s[0:1], 64
    s_load_dwordx2 s[56:57], s[0:1], 96
    s_getpc_b64 s[60:61]
    s_lshr_b32 s6, s2, 3
    v_lshl_add_u32 v1, v0, 5, s6
    v_lshlrev_b32 v2, 7, v1
    v_cmpx_gt_u32 vcc, 90, v1
    s_cbranch_execz L_nopf
    global_load_dword v15, v2, s[60:61] offset:384
L_nopf:
    s_mov_b64 exec, -1
    v_lshrrev_b32 v1, 6, v0
    v_lshlrev_b32 v5, 4, v0
    v_and_b32 v6, 32, v0
    v_readfirstlane_b32 s3, v1
    v_and_b32 v2, 0x1f0, v5
    s_and_b32 s4, s3, 7
    s_and_b32 s61, s3, 4
    s_add_u32 s61, s61, s4
    s_mul_i32 s101, s4, 1056
    s_cmp_ge_u32 s3, 8
    s_cbranch_scc1 L_eA
    s_setprio 3
    s_sub_u32 s62, s2, 64
    s_cbranch_scc0 L_eM
    s_mul_i32 s58, s2, 10000
    v_add_u32 v8, s58, v5
    v_min_u32 v9, 451, v0
    s_addk_i32 s58, 8192
    v_lshl_add_u32 v9, v9, 2, s58
    s_mov_b32 s63, 1
    s_waitcnt lgkmcnt(0)
    global_load_dwordx4 v[22:25], v8, s[36:37]
    global_load_dword v26, v9, s[36:37]
    s_setprio 2
    global_load_dwordx4 v[16:19], v8, s[34:35]
    global_load_dword v20, v9, s[34:35]
    s_branch L_eB
L_eM:
    s_cmpk_ge_u32 s62, 128
    s_cbranch_scc1 L_eW
    s_mov_b32 s63, 0
    s_cmp_ge_u32 s4, 4
    s_cbranch_scc1 L_eBw
    v_lshl_add_u32 v8, v6, 8, v2
    v_lshl_add_u32 v8, s61, 9, v8
    s_lshr_b32 s58, s62, 4
    s_bfe_u32 s59, s62, 0x10003
    s_lshl3_add_u32 s58, s58, s59
    v_lshl_add_u32 v9, s58, 11, v8
    s_and_b32 s58, s62, 7
    v_lshl_add_u32 v8, s58, 14, v8
    s_add_u32 m0, s101, 105600
    s_waitcnt lgkmcnt(0)
    global_load_lds_dwordx4 v8, s[46:47]
    s_addk_i32 m0, 6400
    s_mov_b32 s63, 2
    global_load_lds_dwordx4 v8, s[46:47] offset:2048
    s_addk_i32 m0, 10496
    s_nop 0
    global_load_lds_dwordx4 v9, s[48:49]
    s_addk_i32 m0, 4224
    v_add_u32 v9, 4096, v9
    global_load_lds_dwordx4 v9, s[48:49]
    s_addk_i32 m0, 48640
    v_add_u32 v8, 4096, v8
    global_load_lds_dwordx4 v8, s[46:47]
    s_addk_i32 m0, 6400
    s_nop 0
    global_load_lds_dwordx4 v8, s[46:47] offset:2048
    s_branch L_eB
L_eA:
    s_and_b32 s59, s2, 7
    s_mul_i32 s60, s59, 31
    s_min_u32 s59, s59, 2
    s_add_u32 s6, s6, s60
    s_add_u32 s6, s6, s59
    s_mul_i32 s5, s6, 40
    s_lshl_b32 s58, s5, 4
    s_lshl3_add_u32 s59, s61, s58
    s_lshl_b32 s60, s4, 6
    s_add_u32 s58, s58, s60
    s_add_u32 s60, s5, s4
    v_lshl_add_u32 v8, s60, 9, v2
    v_lshl_add_u32 v9, v6, 7, v8
    s_add_u32 m0, s101, 84480
    s_waitcnt lgkmcnt(0)
    s_load_dwordx16 s[12:27], s[38:39], s58
    s_load_dwordx2 s[28:29], s[38:39], s59 offset:512
    s_load_dwordx2 s[30:31], s[38:39], s59 offset:544
    s_load_dword s40, s[56:57], 655616
    s_barrier
    global_load_lds_dwordx4 v9, s[32:33]
    s_addk_i32 m0, 8448
    v_add_u32 v9, 8192, v9
    global_load_lds_dwordx4 v9, s[32:33]
    s_cmp_ge_u32 s4, 4
    s_cbranch_scc1 L_preA
    s_addk_i32 m0, 8448
    v_lshl_add_u32 v9, v6, 6, v8
    v_add_u32 v9, 16384, v9
    global_load_lds_dwordx4 v9, s[32:33]
    s_branch L_preA
L_eW:
    s_mul_i32 s58, s4, 58
    s_add_u32 s62, s62, s58
    s_sub_u32 s62, s62, 128
    s_mov_b32 s63, 0
    s_cmp_ge_u32 s62, 96
    s_waitcnt lgkmcnt(0)
    s_cbranch_scc1 L_eB
    s_and_b32 s59, s62, 28
    s_add_u32 s59, s59, 4
    s_cmp_ge_u32 s62, 64
    s_cselect_b32 s59, s59, 0
    s_add_u32 s62, s62, s59
    s_mov_b32 s63, 4
    s_and_b32 s59, s62, 7
    s_lshl_b32 s59, s59, 14
    s_bfe_u32 s60, s62, 0x30003
    s_lshl_b32 s60, s60, 6
    s_add_u32 s59, s59, s60
    v_and_b32 v8, 15, v0
    v_lshl_add_u32 v8, v8, 2, s59
    v_and_b32 v9, 48, v0
    v_lshl_add_u32 v8, v9, 8, v8
    s_cmp_lt_u32 s62, 64
    s_cselect_b64 s[58:59], s[50:51], s[44:45]
    global_load_dword v16, v8, s[58:59] offset:0
    global_load_dword v17, v8, s[58:59] offset:512
    global_load_dword v18, v8, s[58:59] offset:1024
    global_load_dword v19, v8, s[58:59] offset:1536
    global_load_dword v20, v8, s[58:59] offset:2048
    global_load_dword v21, v8, s[58:59] offset:2560
    global_load_dword v22, v8, s[58:59] offset:3072
    global_load_dword v23, v8, s[58:59] offset:3584
L_eBw:
    s_waitcnt lgkmcnt(0)
L_eB:
    s_setprio 3
    v_mov_b32 v8, 33554432
    v_cmp_gt_u32 vcc, 320, v0
    v_add_u32 v4, 152064, v5
    v_mov_b64 v[12:13], 0
    v_cndmask_b32 v8, 0, v8, vcc
    v_mov_b32 v9, v8
    v_mov_b64 v[10:11], v[8:9]
    ds_write_b128 v4, v[8:11]
    v_cmpx_gt_u32 vcc, 60, v0
    ds_write_b64 v4, v[12:13] offset:8192
    ds_write_b64 v4, v[12:13] offset:8200
    s_mov_b64 exec, -1
    s_and_b32 s59, s2, 7
    s_mul_i32 s60, s59, 31
    s_min_u32 s59, s59, 2
    s_add_u32 s6, s6, s60
    s_add_u32 s6, s6, s59
    s_mul_i32 s5, s6, 40
    s_waitcnt lgkmcnt(0)
    s_barrier
    v_and_b32 v0, 63, v0
    s_xor_b32 s3, s3, 8
    v_mov_b32 v3, 160064
    s_mov_b64 s[8:9], s[32:33]
    s_mov_b32 s10, 5120000
    s_mov_b32 s11, 0x20000
    s_mov_b64 s[16:17], s[56:57]
    s_mov_b32 s18, 1441792
    s_mov_b32 s19, 0x20000
    s_mov_b32 s27, 0x20000
    s_mov_b32 s31, 0x20000
    v_mov_b32 v62, 1
    s_cmp_eq_u32 s63, 1
    s_cbranch_scc0 L_notprod
    v_mov_b32 v9, 4
    v_mov_b32 v10, 160192
    v_lshl_add_u32 v11, v0, 4, v10
    v_cmp_gt_u32 vcc, 7232, v5
    v_add_u32 v59, 105600, v5
    s_mul_i32 s58, s2, 10240
    s_mov_b64 s[66:67], vcc
    s_waitcnt vmcnt(3)
    v_mul_u32_u24 v28, 52429, v22
    v_lshrrev_b32 v28, 21, v28
    v_lshl_add_u32 v28, v28, 2, v10
    ds_add_rtn_u32 v34, v28, v9
    v_mul_u32_u24 v29, 52429, v23
    v_lshrrev_b32 v29, 21, v29
    v_lshl_add_u32 v29, v29, 2, v10
    ds_add_rtn_u32 v35, v29, v9
    v_mul_u32_u24 v30, 52429, v24
    v_lshrrev_b32 v30, 21, v30
    v_lshl_add_u32 v30, v30, 2, v10
    ds_add_rtn_u32 v36, v30, v9
    v_mul_u32_u24 v31, 52429, v25
    v_lshrrev_b32 v31, 21, v31
    v_lshl_add_u32 v31, v31, 2, v10
    ds_add_rtn_u32 v37, v31, v9
    s_waitcnt vmcnt(2)
    s_mov_b64 exec, s[66:67]
    v_mul_u32_u24 v32, 52429, v26
    v_lshrrev_b32 v32, 21, v32
    v_lshl_add_u32 v32, v32, 2, v10
    ds_add_rtn_u32 v38, v32, v9
    s_mov_b64 exec, -1
    s_waitcnt lgkmcnt(0)
    s_barrier
    ds_read_b128 v[12:15], v11
    s_waitcnt lgkmcnt(0)
    v_add_u32 v56, v12, v13
    v_add3_u32 v57, v56, v14, v15
    s_nop 1
    v_add_u32_dpp v58, v57, v57 row_shr:1 row_mask:0xf bank_mask:0xf bound_ctrl:1
    s_nop 1
    v_add_u32_dpp v58, v58, v58 row_shr:2 row_mask:0xf bank_mask:0xf bound_ctrl:1
    s_nop 1
    v_add_u32_dpp v58, v58, v58 row_shr:4 row_mask:0xf bank_mask:0xf bound_ctrl:1
    s_nop 1
    v_add_u32_dpp v58, v58, v58 row_shr:8 row_mask:0xf bank_mask:0xf bound_ctrl:1
    s_nop 1
    v_add_u32_dpp v58, v58, v58 row_bcast:15 row_mask:0xa bank_mask:0xf
    s_nop 1
    v_add_u32_dpp v58, v58, v58 row_bcast:31 row_mask:0xc bank_mask:0xf
    v_sub_u32 v64, v58, v57
    v_add_u32 v65, v64, v12
    v_add_u32 v66, v64, v56
    v_add_u32 v67, v66, v14
    ds_write_b128 v11, v[64:67] offset:1024
    ds_read_b32 v40, v28 offset:1024
    ds_read_b32 v41, v29 offset:1024
    ds_read_b32 v42, v30 offset:1024
    ds_read_b32 v43, v31 offset:1024
    s_mov_b64 exec, s[66:67]
    ds_read_b32 v44, v32 offset:1024
    s_mov_b64 exec, -1
    s_mov_b32 s60, 105600
    s_waitcnt vmcnt(0)
    v_lshl_or_b32 v16, v22, 16, v16
    v_lshl_or_b32 v17, v23, 16, v17
    v_lshl_or_b32 v18, v24, 16, v18
    v_lshl_or_b32 v19, v25, 16, v19
    v_lshl_or_b32 v20, v26, 16, v20
    s_waitcnt lgkmcnt(4)
    v_add3_u32 v40, v40, v34, s60
    ds_write_b32 v40, v16
    s_waitcnt lgkmcnt(4)
    v_add3_u32 v41, v41, v35, s60
    ds_write_b32 v41, v17
    s_waitcnt lgkmcnt(4)
    v_add3_u32 v42, v42, v36, s60
    ds_write_b32 v42, v18
    s_waitcnt lgkmcnt(4)
    v_add3_u32 v43, v43, v37, s60
    ds_write_b32 v43, v19
    s_mov_b64 exec, s[66:67]
    s_waitcnt lgkmcnt(4)
    v_add3_u32 v44, v44, v38, s60
    ds_write_b32 v44, v20
    s_mov_b64 exec, -1
    s_waitcnt lgkmcnt(0)
    s_barrier
    ds_read_b128 v[12:15], v59
    ds_read_b128 v[68:71], v59 offset:8192
    s_add_u32 s60, s58, 8192
    s_cmp_ge_u32 s4, 2
    s_waitcnt lgkmcnt(1)
    buffer_store_dwordx4 v[12:15], v5, s[16:19], s58 offen sc1
    s_cbranch_scc1 L_cp1
    s_waitcnt lgkmcnt(0)
    buffer_store_dwordx4 v[68:71], v5, s[16:19], s60 offen sc1
L_cp1:
    s_cmp_eq_u32 s4, 0
    s_cbranch_scc1 L_row
    s_waitcnt vmcnt(0)
    s_mov_b64 exec, 1
    ds_add_u32 v3, v62 offset:56
    s_mov_b64 exec, -1
    s_branch L_preB
L_row:
    s_lshl_b32 s61, s2, 10
    s_add_u32 s61, s61, 1114112
    s_mov_b32 s59, 0
Lw_1:
    ds_read_b32 v4, v3 offset:68
    s_waitcnt lgkmcnt(0)
    v_cmp_gt_u32 vcc, 1, v4
    s_cbranch_vccz Lk_2
    s_add_u32 s59, s59, 1
    s_cmp_lt_u32 s59, 4194304
    s_cbranch_scc1 Lw_1
    s_branch L_end
Lk_2:
    v_readfirstlane_b32 s40, v4
    s_nop 0
    s_bitset0_b32 s40, 0
    v_lshrrev_b32 v64, 2, v64
    v_or_b32 v64, s40, v64
    v_lshrrev_b32 v65, 2, v65
    v_or_b32 v65, s40, v65
    v_lshrrev_b32 v66, 2, v66
    v_or_b32 v66, s40, v66
    v_lshrrev_b32 v67, 2, v67
    v_or_b32 v67, s40, v67
    s_mov_b32 s59, 0
Lw_3:
    ds_read_b32 v4, v3 offset:56
    s_waitcnt lgkmcnt(0)
    v_cmp_gt_u32 vcc, 7, v4
    s_cbranch_vccz Lk_4
    s_add_u32 s59, s59, 1
    s_cmp_lt_u32 s59, 4194304
    s_cbranch_scc1 Lw_3
    s_branch L_end
Lk_4:
    s_waitcnt vmcnt(0)
    buffer_store_dwordx4 v[64:67], v5, s[16:19], s61 offen sc1
    ds_write_b32 v3, v62 offset:32
    s_branch L_preB
L_notprod:
    s_cmp_eq_u32 s63, 0
    s_cbranch_scc1 L_taskw
    v_and_b32 v4, 7, v0
    v_mul_u32_u24 v1, 1056, v4
    v_and_b32 v4, 8, v0
    v_lshl_add_u32 v1, v4, 6, v1
    v_and_b32 v4, 48, v0
    v_add_u32 v1, v4, v1
    v_add_u32 v5, 105600, v1
    s_lshr_b32 s58, s62, 4
    s_and_b32 s59, s62, 7
    s_lshl3_add_u32 s58, s58, s59
    s_bfe_u32 s59, s62, 0x10003
    s_lshl1_add_u32 s58, s58, s59
    s_lshl_b32 s58, s58, 10
    s_add_u32 s58, s58, 720896
    v_lshlrev_b32 v6, 4, v0
    s_waitcnt vmcnt(0)
    s_cmp_eq_u32 s63, 4
    s_cbranch_scc1 L_wtask
    s_cmp_eq_u32 s4, 0
    s_cbranch_scc0 L_taskw
    s_mov_b32 s59, 0
Lw_5:
    ds_read_b32 v4, v3 offset:56
    s_waitcnt lgkmcnt(0)
    v_cmp_gt_u32 vcc, 7, v4
    s_cbranch_vccz Lk_6
    s_add_u32 s59, s59, 1
    s_cmp_lt_u32 s59, 4194304
    s_cbranch_scc1 Lw_5
    s_branch L_end
Lk_6:
    ds_read_b128 v[16:19], v5 offset:0
    ds_read_b128 v[20:23], v5 offset:8448
    ds_read_b128 v[24:27], v5 offset:16896
    ds_read_b128 v[28:31], v5 offset:64
    ds_read_b128 v[32:35], v5 offset:8512
    ds_read_b128 v[36:39], v5 offset:16960
    ds_read_b128 v[40:43], v5 offset:128
    ds_read_b128 v[44:47], v5 offset:8576
    ds_read_b128 v[48:51], v5 offset:17024
    ds_read_b128 v[64:67], v5 offset:192
    ds_read_b128 v[68:71], v5 offset:8640
    ds_read_b128 v[72:75], v5 offset:17088
    s_waitcnt lgkmcnt(9)
    ds_read_b128 v[76:79], v5 offset:256
    ds_read_b128 v[80:83], v5 offset:8704
    ds_read_b128 v[84:87], v5 offset:17152
    v_mfma_f32_16x16x32_bf16 v[8:11], v[16:19], v[24:27], 0
    v_mfma_f32_16x16x32_bf16 v[12:15], v[20:23], v[24:27], 0
    s_waitcnt lgkmcnt(9)
    ds_read_b128 v[88:91], v5 offset:320
    ds_read_b128 v[92:95], v5 offset:8768
    ds_read_b128 v[96:99], v5 offset:17216
    v_mfma_f32_16x16x32_bf16 v[8:11], v[28:31], v[36:39], v[8:11]
    v_mfma_f32_16x16x32_bf16 v[12:15], v[32:35], v[36:39], v[12:15]
    s_waitcnt lgkmcnt(9)
    ds_read_b128 v[100:103], v5 offset:384
    ds_read_b128 v[104:107], v5 offset:8832
    ds_read_b128 v[108:111], v5 offset:17280
    v_mfma_f32_16x16x32_bf16 v[8:11], v[40:43], v[48:51], v[8:11]
    v_mfma_f32_16x16x32_bf16 v[12:15], v[44:47], v[48:51], v[12:15]
    s_waitcnt lgkmcnt(9)
    ds_read_b128 v[112:115], v5 offset:448
    ds_read_b128 v[116:119], v5 offset:8896
    ds_read_b128 v[120:123], v5 offset:17344
    v_mfma_f32_16x16x32_bf16 v[8:11], v[64:67], v[72:75], v[8:11]
    v_mfma_f32_16x16x32_bf16 v[12:15], v[68:71], v[72:75], v[12:15]
    s_waitcnt lgkmcnt(9)
    v_mfma_f32_16x16x32_bf16 v[8:11], v[76:79], v[84:87], v[8:11]
    v_mfma_f32_16x16x32_bf16 v[12:15], v[80:83], v[84:87], v[12:15]
    s_waitcnt lgkmcnt(6)
    v_mfma_f32_16x16x32_bf16 v[8:11], v[88:91], v[96:99], v[8:11]
    v_mfma_f32_16x16x32_bf16 v[12:15], v[92:95], v[96:99], v[12:15]
    s_waitcnt lgkmcnt(3)
    v_mfma_f32_16x16x32_bf16 v[8:11], v[100:103], v[108:111], v[8:11]
    v_mfma_f32_16x16x32_bf16 v[12:15], v[104:107], v[108:111], v[12:15]
    s_waitcnt lgkmcnt(0)
    v_mfma_f32_16x16x32_bf16 v[8:11], v[112:115], v[120:123], v[8:11]
    v_mfma_f32_16x16x32_bf16 v[12:15], v[116:119], v[120:123], v[12:15]
    s_nop 6
    v_cvt_pk_bf16_f32 v16, v8, v9
    v_cvt_pk_bf16_f32 v17, v10, v11
    v_cvt_pk_bf16_f32 v18, v12, v13
    v_cvt_pk_bf16_f32 v19, v14, v15
    buffer_store_dwordx4 v[16:19], v6, s[16:19], s58 offen sc1
    s_branch L_flag
L_wtask:
    s_lshl_b32 s58, s62, 11
    s_add_u32 s58, s58, 851968
    s_mov_b32 s70, 0x05040100
    s_mov_b32 s71, 0x07060302
    v_perm_b32 v64, v17, v16, s70
    v_perm_b32 v68, v17, v16, s71
    v_perm_b32 v65, v19, v18, s70
    v_perm_b32 v69, v19, v18, s71
    v_perm_b32 v66, v21, v20, s70
    v_perm_b32 v70, v21, v20, s71
    v_perm_b32 v67, v23, v22, s70
    v_perm_b32 v71, v23, v22, s71
    buffer_store_dwordx4 v[64:67], v6, s[16:19], s58 offen sc1
    buffer_store_dwordx4 v[68:71], v6, s[16:19], s58 offen offset:1024 sc1
    s_cmp_eq_u32 s4, 0
    s_cbranch_scc1 L_flag
    s_waitcnt vmcnt(0)
L_taskw:
    s_mov_b64 exec, 1
    ds_add_u32 v3, v62 offset:56
    s_mov_b64 exec, -1
    s_branch L_preB
L_flag:
    s_mov_b32 s59, 0
Lw_7:
    ds_read_b32 v4, v3 offset:68
    s_waitcnt lgkmcnt(0)
    v_cmp_gt_u32 vcc, 1, v4
    s_cbranch_vccz Lk_8
    s_add_u32 s59, s59, 1
    s_cmp_lt_u32 s59, 4194304
    s_cbranch_scc1 Lw_7
    s_branch L_end
Lk_8:
    v_readfirstlane_b32 s40, v4
    s_nop 0
    s_bitset0_b32 s40, 0
    s_mul_i32 s61, s2, 16
    s_add_u32 s61, s61, 1178624
    v_mov_b32 v10, s40
    v_mov_b32 v11, s40
    v_lshlrev_b32 v9, 15, v0
    s_mov_b32 s59, 0
Lw_9:
    ds_read_b32 v4, v3 offset:56
    s_waitcnt lgkmcnt(0)
    v_cmp_gt_u32 vcc, 7, v4
    s_cbranch_vccz Lk_10
    s_add_u32 s59, s59, 1
    s_cmp_lt_u32 s59, 4194304
    s_cbranch_scc1 Lw_9
    s_branch L_end
Lk_10:
    s_waitcnt vmcnt(0)
    s_mov_b64 exec, 255
    buffer_store_dwordx2 v[10:11], v9, s[16:19], s61 offen sc1
    ds_write_b32 v3, v62 offset:32
    s_mov_b64 exec, -1
L_preB:
    s_setprio 3
    s_mov_b64 s[28:29], s[42:43]
    s_mov_b32 s30, 20000
    s_lshl_b32 s58, s4, 10
    v_lshlrev_b32 v5, 4, v0
    s_add_u32 m0, s58, 130944
    s_add_u32 s59, s58, 0
    buffer_load_dwordx4 v5, s[28:31], s59 offen lds
    s_add_u32 m0, s58, 139136
    s_add_u32 s59, s58, 8192
    buffer_load_dwordx4 v5, s[28:31], s59 offen lds
    s_cmp_lt_u32 s4, 4
    s_cbranch_scc1 L_disd
    s_add_u32 m0, s58, 143232
    s_add_u32 s59, s58, 12288
    buffer_load_dwordx4 v5, s[28:31], s59 offen lds
L_disd:
    s_mov_b64 s[24:25], s[44:45]
    s_mov_b32 s26, 131072
    s_setprio 1
    s_lshl_b32 s58, s4, 10
    s_mov_b32 s41, 0
    buffer_load_dwordx4 v[96:99], v5, s[24:27], s58 offen
    s_add_u32 s58, s58, 8192
    buffer_load_dwordx4 v[100:103], v5, s[24:27], s58 offen
    s_add_u32 s58, s58, 8192
    buffer_load_dwordx4 v[104:107], v5, s[24:27], s58 offen
    s_add_u32 s58, s58, 8192
    buffer_load_dwordx4 v[108:111], v5, s[24:27], s58 offen
    s_add_u32 s58, s58, 8192
    buffer_load_dwordx4 v[112:115], v5, s[24:27], s58 offen
    s_add_u32 s58, s58, 8192
    buffer_load_dwordx4 v[116:119], v5, s[24:27], s58 offen
    s_add_u32 s58, s58, 8192
    buffer_load_dwordx4 v[120:123], v5, s[24:27], s58 offen
    s_add_u32 s58, s58, 8192
    buffer_load_dwordx4 v[124:127], v5, s[24:27], s58 offen
    s_setprio 3
    v_and_b32 v4, 3, v0
    v_mov_b32 v5, 0x0c0c0c0c
    v_mov_b32 v6, 0x0c0c0302
    v_mov_b32 v7, 0x03020c0c
    v_cmp_eq_u32 s[58:59], 0, v4
    v_cmp_eq_u32 s[60:61], 2, v4
    v_cmp_eq_u32 vcc, 1, v4
    v_cndmask_b32 v10, v5, v6, s[58:59]
    v_cndmask_b32 v11, v5, v6, s[60:61]
    v_cndmask_b32 v10, v10, v7, vcc
    v_cmp_eq_u32 vcc, 3, v4
    s_nop 1
    v_cndmask_b32 v11, v11, v7, vcc
    v_and_b32 v10, 0xfdfdfdfd, v10
    v_and_b32 v11, 0xfdfdfdfd, v11
    s_movk_i32 s7, 512
    s_lshl_b32 s58, s4, 3
    v_lshrrev_b32 v5, 3, v0
    v_and_b32 v6, 7, v0
    v_add_u32 v7, s58, v5
    v_mul_u32_u24 v49, 10240, v7
    v_lshl_add_u32 v49, v6, 4, v49
    v_lshlrev_b32 v56, 2, v6
    s_lshl_b32 s60, s6, 2
    s_add_u32 s60, s60, 1114112
    v_lshl_add_u32 v54, v7, 10, s60
    v_mad_u32_u24 v7, v7, 3, v6
    v_cmp_ge_u32 vcc, 186, v7
    v_cmp_gt_u32 s[64:65], 4, v6
    v_mul_u32_u24 v7, 16, v7
    s_and_b64 s[64:65], s[64:65], vcc
    v_cmp_eq_u32 vcc, 0, v6
    s_and_b32 s58, s2, 7
    s_lshl_b32 s58, s58, 15
    s_add_u32 s58, s58, 1179632
    v_add_u32 v7, s58, v7
    s_or_b64 s[64:65], s[64:65], vcc
    v_cndmask_b32 v54, v7, v54, vcc
    v_cmp_gt_u32 s[62:63], 5, v6
    v_lshl_add_u32 v50, v6, 3, v5
    v_mul_u32_u24 v55, 80, v5
    v_add_u32 v55, 80, v55
    v_lshrrev_b32 v5, 4, v50
    v_mul_u32_u24 v9, 8448, v5
    v_lshl_add_u32 v9, v5, 26, v9
    v_cmp_le_u32 vcc, 32, v50
    v_and_b32 v5, 7, v50
    v_and_b32 v6, 3, v50
    v_cndmask_b32 v5, v5, v6, vcc
    v_mul_u32_u24 v5, 1056, v5
    v_bfe_u32 v6, v50, 3, 1
    v_bfe_u32 v7, v50, 2, 1
    v_cndmask_b32 v6, v6, v7, vcc
    v_lshl_add_u32 v5, v6, 9, v5
    v_mov_b32 v52, 130944
    v_add3_u32 v9, v9, v5, v52
    v_lshrrev_b32 v5, 5, v0
    v_lshl_add_u32 v15, v5, 3, v2
    s_lshl_b32 s58, s5, 2
    s_sub_u32 s58, 159744, s58
    v_mov_b32 v53, s58
    v_add_u32 v5, s5, v50
    v_lshl_add_u32 v8, v5, 1, v52
    v_lshlrev_b32 v50, 2, v50
    v_add_u32 v50, 159744, v50
    v_mov_b32 v57, 157184
    v_mov_b32 v60, 152064
    v_mov_b64 v[16:17], 0
    v_mov_b64 v[18:19], 0
    s_mov_b32 s59, 0
Lw_11:
    ds_read_b32 v4, v3 offset:32
    s_waitcnt lgkmcnt(0)
    v_cmp_gt_u32 vcc, 1, v4
    s_cbranch_vccz Lk_12
    s_sleep 2
    s_add_u32 s59, s59, 1
    s_cmp_lt_u32 s59, 4194304
    s_cbranch_scc1 Lw_11
    s_branch L_end
Lk_12:
    s_mov_b32 s59, 0
Lw_13:
    ds_read_b32 v4, v3 offset:68
    s_waitcnt lgkmcnt(0)
    v_cmp_gt_u32 vcc, 1, v4
    s_cbranch_vccz Lk_14
    s_add_u32 s59, s59, 1
    s_cmp_lt_u32 s59, 4194304
    s_cbranch_scc1 Lw_13
    s_branch L_end
Lk_14:
    v_readfirstlane_b32 s40, v4
    s_nop 0
    s_bitset0_b32 s40, 0
    s_mov_b32 s59, 0
Lw_15:
    ds_read_b32 v4, v3 offset:60
    s_waitcnt lgkmcnt(0)
    v_cmp_gt_u32 vcc, 8, v4
    s_cbranch_vccz Lk_16
    s_sleep 2
    s_add_u32 s59, s59, 1
    s_cmp_lt_u32 s59, 4194304
    s_cbranch_scc1 Lw_15
    s_branch L_end
Lk_16:
    s_mov_b32 s59, 0
    s_and_b32 exec_lo, s64, 0xfefefefe
    s_and_b32 exec_hi, s65, 0xfefefefe
L_spolla:
    buffer_load_dwordx2 v[58:59], v54, s[16:19], 0 offen sc1
    s_add_u32 s59, s59, 1
    s_cmp_gt_u32 s59, 0x40000
    s_cbranch_scc1 L_end
    s_waitcnt vmcnt(0)
    v_xor_b32 v58, s40, v58
    v_xor_b32 v59, s40, v59
    v_or_b32 v5, v58, v59
    v_cmpx_lt_u32 vcc, 4095, v5
    s_cbranch_execz L_soka
    s_sleep 8
    s_branch L_spolla
L_soka:
    s_mov_b64 exec, -1
    s_mov_b64 exec, 1
    ds_add_u32 v3, v62 offset:52
    s_mov_b64 exec, -1
    s_mov_b32 exec_lo, 0x01010101
    s_mov_b32 exec_hi, 0x01010101
L_spollb:
    buffer_load_dwordx2 v[58:59], v54, s[16:19], 0 offen sc1
    s_add_u32 s59, s59, 1
    s_cmp_gt_u32 s59, 0x40000
    s_cbranch_scc1 L_end
    s_waitcnt vmcnt(0)
    v_xor_b32 v58, s40, v58
    v_xor_b32 v59, s40, v59
    v_or_b32 v5, v58, v59
    v_cmpx_lt_u32 vcc, 4095, v5
    s_cbranch_execz L_sokb
    s_sleep 8
    s_branch L_spollb
L_sokb:
    s_mov_b64 exec, -1
    v_sub_u32 v48, v59, v58
    v_lshl_or_b32 v48, v48, 16, v58
    s_nop 1
    v_mov_b32_dpp v48, v48 quad_perm:[0,0,0,0] row_mask:0xf bank_mask:0xf
    s_nop 1
    v_mov_b32_dpp v48, v48 row_shr:4 row_mask:0xf bank_mask:0xa
    v_mad_u32_u16 v49, v48, 4, v49
    v_lshrrev_b32 v48, 16, v48
    v_sub_u32 v48, v48, v56
    v_cmpx_lt_i32 vcc, 0, v48
    s_cbranch_execz L_entld
    buffer_load_dwordx4 v[16:19], v49, s[16:19], 0 offen sc1
    v_cmpx_lt_i32 vcc, 32, v48
    ds_write_b32 v3, v62 offset:28
L_entld:
    s_mov_b64 exec, -1
    s_waitcnt vmcnt(0)
    v_cmpx_lt_i32 vcc, 0, v48
    v_mad_u32_u16 v24, v16, 4, v53 op_sel:[1,0,0,0]
    ds_add_rtn_u32 v32, v24, v62
    v_cmpx_lt_i32 vcc, 1, v48
    v_mad_u32_u16 v25, v17, 4, v53 op_sel:[1,0,0,0]
    ds_add_rtn_u32 v33, v25, v62
    v_cmpx_lt_i32 vcc, 2, v48
    v_mad_u32_u16 v26, v18, 4, v53 op_sel:[1,0,0,0]
    ds_add_rtn_u32 v34, v26, v62
    v_cmpx_lt_i32 vcc, 3, v48
    v_mad_u32_u16 v27, v19, 4, v53 op_sel:[1,0,0,0]
    ds_add_rtn_u32 v35, v27, v62
    s_mov_b64 exec, -1
    s_mov_b64 exec, 1
    ds_add_u32 v3, v62 offset:12
    s_mov_b64 exec, -1
    v_mad_u32_u16 v40, v16, 2, v52
    v_mad_u32_u16 v16, v16, s7, 0
    v_mad_u32_u16 v41, v17, 2, v52
    v_mad_u32_u16 v17, v17, s7, 0
    v_mad_u32_u16 v42, v18, 2, v52
    v_mad_u32_u16 v18, v18, s7, 0
    v_mad_u32_u16 v43, v19, 2, v52
    v_mad_u32_u16 v19, v19, s7, 0
    s_mov_b32 s59, 0
Lw_17:
    ds_read_b32 v4, v3 offset:12
    s_waitcnt lgkmcnt(0)
    v_cmp_gt_u32 vcc, 8, v4
    s_cbranch_vccz Lk_18
    s_add_u32 s59, s59, 1
    s_cmp_lt_u32 s59, 4194304
    s_cbranch_scc1 Lw_17
    s_branch L_end
Lk_18:
    ds_read_b32 v12, v50
    ds_read_b32 v5, v3 offset:28
    ds_read_u16 v8, v8
    ds_read_u16 v40, v40
    ds_read_u16 v41, v41
    ds_read_u16 v42, v42
    ds_read_u16 v43, v43
    s_lshl_b32 s58, s2, 4
    s_add_u32 s58, s58, s3
    s_cmp_eq_u32 s58, 15
    s_cbranch_scc0 L_noep
    v_mov_b32 v6, s40
    v_mov_b32 v7, 655616
    s_mov_b64 exec, 1
    buffer_store_dword v6, v7, s[16:19], 0 offen sc1
    s_mov_b64 exec, -1
L_noep:
    s_waitcnt lgkmcnt(6)
    v_add_u32 v12, 1, v12
    v_lshrrev_b32 v12, 1, v12
    v_max_u32 v12, 1, v12
    v_cndmask_b32 v12, 0, v12, s[62:63]
    s_lshl_b32 s67, s4, 3
    s_movk_i32 s58, 2560
    v_add_u32_dpp v51, v12, v12 row_shl:1 row_mask:0xf bank_mask:0xf bound_ctrl:1
    s_nop 1
    v_add_u32_dpp v51, v51, v51 row_shl:2 row_mask:0xf bank_mask:0xf bound_ctrl:1
    s_nop 1
    v_add_u32_dpp v51, v12, v51 row_shl:4 row_mask:0xf bank_mask:0x5 bound_ctrl:1
    s_waitcnt lgkmcnt(0)
    v_lshlrev_b32 v8, 16, v8
    v_lshl_add_u32 v5, v5, 10, v51
    v_sub_u32 v6, v55, v51
    v_cmp_le_u32 vcc, 80, v5
    v_lshlrev_b32 v6, 1, v6
    v_subrev_u32 v12, 1, v12
    s_cbranch_vccnz L_slow
    v_and_b32 v12, 0xff, v12
    v_lshl_add_u32 v9, v12, 18, v9
    s_mov_b64 exec, s[62:63]
    ds_write_b32 v50, v6 offset:160
    s_mov_b64 exec, -1
    s_sub_u32 s63, s67, 1
    v_readlane_b32 s67, v51, s67
    v_cmpx_lt_i32 vcc, 0, v48
    ds_read_b32 v24, v24 offset:160
    v_cmpx_lt_i32 vcc, 1, v48
    ds_read_b32 v25, v25 offset:160
    v_cmpx_lt_i32 vcc, 2, v48
    ds_read_b32 v26, v26 offset:160
    v_cmpx_lt_i32 vcc, 3, v48
    ds_read_b32 v27, v27 offset:160
    s_mov_b64 exec, -1
    s_lshr_b32 s66, s67, 3
    s_add_u32 s60, s66, 1
    s_lshl_b32 s60, s60, 3
    s_sub_u32 s67, s60, s67
    s_sub_u32 s62, s67, 1
    s_add_u32 s61, s4, 1
    s_mul_i32 s61, s61, 80
    s_sub_u32 s60, s61, s60
    s_lshl_b32 s60, s60, 2
    s_waitcnt lgkmcnt(0)
    v_cmpx_lt_i32 vcc, 0, v48
    v_add_u32 v24, v24, v32
    v_lshl_add_u32 v5, v24, 1, v57
    ds_write_b16 v5, v40
    v_lshrrev_b32 v6, 1, v24
    v_lshl_add_u32 v6, v6, 2, v60
    v_and_b32 v7, 1, v24
    v_mad_u32_u24 v6, v7, s58, v6
    ds_write_b32 v6, v16
    v_cmpx_lt_i32 vcc, 1, v48
    v_add_u32 v25, v25, v33
    v_lshl_add_u32 v5, v25, 1, v57
    ds_write_b16 v5, v41
    v_lshrrev_b32 v6, 1, v25
    v_lshl_add_u32 v6, v6, 2, v60
    v_and_b32 v7, 1, v25
    v_mad_u32_u24 v6, v7, s58, v6
    ds_write_b32 v6, v17
    v_cmpx_lt_i32 vcc, 2, v48
    v_add_u32 v26, v26, v34
    v_lshl_add_u32 v5, v26, 1, v57
    ds_write_b16 v5, v42
    v_lshrrev_b32 v6, 1, v26
    v_lshl_add_u32 v6, v6, 2, v60
    v_and_b32 v7, 1, v26
    v_mad_u32_u24 v6, v7, s58, v6
    ds_write_b32 v6, v18
    v_cmpx_lt_i32 vcc, 3, v48
    v_add_u32 v27, v27, v35
    v_lshl_add_u32 v5, v27, 1, v57
    ds_write_b16 v5, v43
    v_lshrrev_b32 v6, 1, v27
    v_lshl_add_u32 v6, v6, 2, v60
    v_and_b32 v7, 1, v27
    v_mad_u32_u24 v6, v7, s58, v6
    ds_write_b32 v6, v19
    s_mov_b64 exec, -1
    s_mov_b64 exec, 1
    ds_add_u32 v3, v62 offset:16
    s_mov_b64 exec, -1
    v_lshrrev_b32 v5, 5, v0
    v_mad_u32_u24 v13, v5, s58, v60
    v_add_u32 v13, s60, v13
    v_lshl_add_u32 v14, v5, 1, v57
    v_and_b32 v5, 28, v0
    v_add3_u32 v14, v14, v5, s60
    s_mov_b32 s65, 201486784
    s_mov_b32 s64, 0
    s_mov_b32 s59, 0
Lw_19:
    ds_read_b32 v4, v3 offset:16
    s_waitcnt lgkmcnt(0)
    v_cmp_gt_u32 vcc, 8, v4
    s_cbranch_vccz Lk_20
    s_add_u32 s59, s59, 1
    s_cmp_lt_u32 s59, 4194304
    s_cbranch_scc1 Lw_19
    s_branch L_end
Lk_20:
    v_mov_b32 v12, v3
    v_mov_b32 v3, v2
    s_setprio 1
    s_cmp_lt_u32 s4, 4
    s_cbranch_scc1 L_old
    s_setprio 2
L_old:
    s_mov_b64 vcc, 0
    ds_read_b128 v[64:67], v13 offset:0
    ds_read_b128 v[68:71], v13 offset:16
    ds_read_u16 v1, v14
    ds_read_b128 v[48:51], v13 offset:32
    ds_read_b128 v[52:55], v13 offset:48
    s_waitcnt lgkmcnt(3)
L_p0:
    s_cmp_ge_u32 s67, 4
    s_cbranch_scc1 L_p4
    s_cmp_gt_u32 s67, 1
    s_cbranch_scc1 Lps_21
    v_add_u32 v65, v65, v2
    buffer_load_dwordx4 v[20:23], v65, s[8:11], 0 offen
Lps_21:
    s_cmp_gt_u32 s67, 2
    s_cbranch_scc1 Lps_22
    v_add_u32 v66, v66, v2
    buffer_load_dwordx4 v[24:27], v66, s[8:11], 0 offen
Lps_22:
    s_cmp_gt_u32 s67, 3
    s_cbranch_scc1 Lps_23
    v_add_u32 v67, v67, v2
    buffer_load_dwordx4 v[28:31], v67, s[8:11], 0 offen
Lps_23:
L_p4:
    s_cmp_gt_u32 s67, 4
    s_cbranch_scc1 Lps_24
    v_add_u32 v68, v68, v2
    buffer_load_dwordx4 v[32:35], v68, s[8:11], 0 offen
Lps_24:
    s_cmp_gt_u32 s67, 5
    s_cbranch_scc1 Lps_25
    v_add_u32 v69, v69, v2
    buffer_load_dwordx4 v[36:39], v69, s[8:11], 0 offen
Lps_25:
    s_cmp_gt_u32 s67, 6
    s_cbranch_scc1 Lps_26
    v_add_u32 v70, v70, v2
    buffer_load_dwordx4 v[40:43], v70, s[8:11], 0 offen
Lps_26:
    s_cmp_gt_u32 s67, 7
    s_cbranch_scc1 Lps_27
    v_add_u32 v71, v71, v2
    buffer_load_dwordx4 v[44:47], v71, s[8:11], 0 offen
Lps_27:
    s_cmp_eq_u32 s66, 0
    s_cbranch_scc1 L_drain
L_gl:
    s_cmp_le_u32 s66, 4
    s_cbranch_scc1 L_dm0
L_dm0b:
    s_waitcnt lgkmcnt(1)
    v_perm_b32 v6, v1, v1, v10
    v_perm_b32 v7, v1, v1, v11
    ds_read_u16 v1, v14 offset:32
    s_waitcnt vmcnt(6)
    v_lshl_add_u64 v[4:5], v[48:49], 0, v[2:3]
    s_sub_u32 s62, s62, 2
    s_cbranch_scc1 Lfs_0
    v_mfma_f32_4x4x4_16b_bf16 v[56:59], v[6:7], v[16:17], v[56:59] cbsz:3 abid:0
    v_mfma_f32_4x4x4_16b_bf16 v[60:63], v[6:7], v[18:19], v[60:63] cbsz:3 abid:0
    buffer_load_dwordx4 v[16:19], v4, s[8:11], 0 offen
    v_mfma_f32_4x4x4_16b_bf16 v[56:59], v[6:7], v[20:21], v[56:59] cbsz:3 abid:1
    v_mfma_f32_4x4x4_16b_bf16 v[60:63], v[6:7], v[22:23], v[60:63] cbsz:3 abid:1
    buffer_load_dwordx4 v[20:23], v5, s[8:11], 0 offen
Lbs_0:
    s_cbranch_vccnz Ldm_0
Ldb_0:
    s_waitcnt vmcnt(6)
    v_lshl_add_u64 v[4:5], v[50:51], 0, v[2:3]
    s_sub_u32 s62, s62, 2
    s_cbranch_scc1 Lfs_2
    v_mfma_f32_4x4x4_16b_bf16 v[56:59], v[6:7], v[24:25], v[56:59] cbsz:3 abid:2
    v_mfma_f32_4x4x4_16b_bf16 v[60:63], v[6:7], v[26:27], v[60:63] cbsz:3 abid:2
    buffer_load_dwordx4 v[24:27], v4, s[8:11], 0 offen
    v_mfma_f32_4x4x4_16b_bf16 v[56:59], v[6:7], v[28:29], v[56:59] cbsz:3 abid:3
    v_mfma_f32_4x4x4_16b_bf16 v[60:63], v[6:7], v[30:31], v[60:63] cbsz:3 abid:3
    buffer_load_dwordx4 v[28:31], v5, s[8:11], 0 offen
Lbs_2:
    s_cbranch_vccnz Ldm_2
Ldb_2:
    ds_read_b128 v[48:51], v13 offset:64
    s_waitcnt vmcnt(6) lgkmcnt(2)
    v_lshl_add_u64 v[4:5], v[52:53], 0, v[2:3]
    s_sub_u32 s62, s62, 2
    s_cbranch_scc1 Lfs_4
    v_mfma_f32_4x4x4_16b_bf16 v[56:59], v[6:7], v[32:33], v[56:59] cbsz:3 abid:4
    v_mfma_f32_4x4x4_16b_bf16 v[60:63], v[6:7], v[34:35], v[60:63] cbsz:3 abid:4
    buffer_load_dwordx4 v[32:35], v4, s[8:11], 0 offen
    v_mfma_f32_4x4x4_16b_bf16 v[56:59], v[6:7], v[36:37], v[56:59] cbsz:3 abid:5
    v_mfma_f32_4x4x4_16b_bf16 v[60:63], v[6:7], v[38:39], v[60:63] cbsz:3 abid:5
    buffer_load_dwordx4 v[36:39], v5, s[8:11], 0 offen
Lbs_4:
    s_cbranch_vccnz Ldm_4
Ldb_4:
    s_waitcnt vmcnt(6)
    v_lshl_add_u64 v[4:5], v[54:55], 0, v[2:3]
    s_sub_u32 s62, s62, 2
    s_cbranch_scc1 Lfs_6
    v_mfma_f32_4x4x4_16b_bf16 v[56:59], v[6:7], v[40:41], v[56:59] cbsz:3 abid:6
    v_mfma_f32_4x4x4_16b_bf16 v[60:63], v[6:7], v[42:43], v[60:63] cbsz:3 abid:6
    buffer_load_dwordx4 v[40:43], v4, s[8:11], 0 offen
    v_mfma_f32_4x4x4_16b_bf16 v[56:59], v[6:7], v[44:45], v[56:59] cbsz:3 abid:7
    v_mfma_f32_4x4x4_16b_bf16 v[60:63], v[6:7], v[46:47], v[60:63] cbsz:3 abid:7
    buffer_load_dwordx4 v[44:47], v5, s[8:11], 0 offen
Lbs_6:
    s_cbranch_vccnz Ldm_6
Ldb_6:
    ds_read_b128 v[52:55], v13 offset:80
    v_add_u32 v13, 32, v13
    v_add_u32 v14, 32, v14
    s_sub_u32 s66, s66, 1
    s_cmp_eq_u32 s66, 3
    s_cbranch_scc0 L_nf
    s_setprio 1
L_nf:
    s_cmp_lg_u32 s66, 0
    s_cbranch_scc1 L_gl
L_drain:
    s_waitcnt lgkmcnt(0)
    v_perm_b32 v6, v1, v1, v10
    v_perm_b32 v7, v1, v1, v11
    ds_read_u16 v1, v14 offset:32
    s_waitcnt vmcnt(7)
    v_mfma_f32_4x4x4_16b_bf16 v[56:59], v[6:7], v[16:17], v[56:59] cbsz:3 abid:0
    v_mfma_f32_4x4x4_16b_bf16 v[60:63], v[6:7], v[18:19], v[60:63] cbsz:3 abid:0
    s_sub_u32 s62, s62, 1
    s_cbranch_scc1 Lfd_0
Lbd_0:
    s_waitcnt vmcnt(6)
    v_mfma_f32_4x4x4_16b_bf16 v[56:59], v[6:7], v[20:21], v[56:59] cbsz:3 abid:1
    v_mfma_f32_4x4x4_16b_bf16 v[60:63], v[6:7], v[22:23], v[60:63] cbsz:3 abid:1
    s_sub_u32 s62, s62, 1
    s_cbranch_scc1 Lfd_1
Lbd_1:
    s_waitcnt vmcnt(5)
    v_mfma_f32_4x4x4_16b_bf16 v[56:59], v[6:7], v[24:25], v[56:59] cbsz:3 abid:2
    v_mfma_f32_4x4x4_16b_bf16 v[60:63], v[6:7], v[26:27], v[60:63] cbsz:3 abid:2
    s_sub_u32 s62, s62, 1
    s_cbranch_scc1 Lfd_2
Lbd_2:
    s_waitcnt vmcnt(4)
    v_mfma_f32_4x4x4_16b_bf16 v[56:59], v[6:7], v[28:29], v[56:59] cbsz:3 abid:3
    v_mfma_f32_4x4x4_16b_bf16 v[60:63], v[6:7], v[30:31], v[60:63] cbsz:3 abid:3
    s_sub_u32 s62, s62, 1
    s_cbranch_scc1 Lfd_3
Lbd_3:
    s_waitcnt vmcnt(3)
    v_mfma_f32_4x4x4_16b_bf16 v[56:59], v[6:7], v[32:33], v[56:59] cbsz:3 abid:4
    v_mfma_f32_4x4x4_16b_bf16 v[60:63], v[6:7], v[34:35], v[60:63] cbsz:3 abid:4
    s_sub_u32 s62, s62, 1
    s_cbranch_scc1 Lfd_4
Lbd_4:
    s_waitcnt vmcnt(2)
    v_mfma_f32_4x4x4_16b_bf16 v[56:59], v[6:7], v[36:37], v[56:59] cbsz:3 abid:5
    v_mfma_f32_4x4x4_16b_bf16 v[60:63], v[6:7], v[38:39], v[60:63] cbsz:3 abid:5
    s_sub_u32 s62, s62, 1
    s_cbranch_scc1 Lfd_5
Lbd_5:
    s_waitcnt vmcnt(1)
    v_mfma_f32_4x4x4_16b_bf16 v[56:59], v[6:7], v[40:41], v[56:59] cbsz:3 abid:6
    v_mfma_f32_4x4x4_16b_bf16 v[60:63], v[6:7], v[42:43], v[60:63] cbsz:3 abid:6
    s_sub_u32 s62, s62, 1
    s_cbranch_scc1 Lfd_6
Lbd_6:
    s_waitcnt vmcnt(0)
    v_mfma_f32_4x4x4_16b_bf16 v[56:59], v[6:7], v[44:45], v[56:59] cbsz:3 abid:7
    v_mfma_f32_4x4x4_16b_bf16 v[60:63], v[6:7], v[46:47], v[60:63] cbsz:3 abid:7
    s_nop 1
    s_call_b64 s[68:69], L_flush
L_gdone:
    s_cmp_eq_u32 s41, 0
    s_cbranch_scc0 L_dd
    s_mov_b32 s59, 0
Lw_28:
    ds_read_b32 v4, v12 offset:24
    s_waitcnt lgkmcnt(0)
    v_cmp_gt_u32 vcc, 8, v4
    s_cbranch_vccz Lk_29
    s_sleep 2
    s_add_u32 s59, s59, 1
    s_cmp_lt_u32 s59, 4194304
    s_cbranch_scc1 Lw_28
    s_branch L_end
Lk_29:
    s_lshl_b32 s58, s4, 10
    v_lshl_add_u32 v72, v0, 4, s58
    s_and_b32 s58, s4, 4
    v_lshl_add_u32 v73, s58, 4, v72
    s_movk_i32 s58, 0x1f0
    v_bfi_b32 v72, s58, v73, v72
    ds_write_b128 v72, v[96:99] offset:0
    ds_write_b128 v72, v[100:103] offset:8192
    ds_write_b128 v72, v[104:107] offset:16384
    ds_write_b128 v72, v[108:111] offset:24576
    ds_write_b128 v72, v[112:115] offset:32768
    ds_write_b128 v72, v[116:119] offset:40960
    ds_write_b128 v72, v[120:123] offset:49152
    ds_write_b128 v72, v[124:127] offset:57344
    s_mov_b64 exec, 1
    ds_inc_u32 v12, v12 offset:64
    s_mov_b64 exec, -1
L_dd:
    s_endpgm
Lfs_0:
    s_add_u32 s62, s62, 2
    v_mfma_f32_4x4x4_16b_bf16 v[56:59], v[6:7], v[16:17], v[56:59] cbsz:3 abid:0
    v_mfma_f32_4x4x4_16b_bf16 v[60:63], v[6:7], v[18:19], v[60:63] cbsz:3 abid:0
    buffer_load_dwordx4 v[16:19], v4, s[8:11], 0 offen
    s_sub_u32 s62, s62, 1
    s_cbranch_scc0 Lsk_30
    s_call_b64 s[68:69], L_flush
Lsk_30:
    v_mfma_f32_4x4x4_16b_bf16 v[56:59], v[6:7], v[20:21], v[56:59] cbsz:3 abid:1
    v_mfma_f32_4x4x4_16b_bf16 v[60:63], v[6:7], v[22:23], v[60:63] cbsz:3 abid:1
    buffer_load_dwordx4 v[20:23], v5, s[8:11], 0 offen
    s_sub_u32 s62, s62, 1
    s_cbranch_scc0 Lbs_0
    s_call_b64 s[68:69], L_flush
    s_branch Lbs_0
Lfs_2:
    s_add_u32 s62, s62, 2
    v_mfma_f32_4x4x4_16b_bf16 v[56:59], v[6:7], v[24:25], v[56:59] cbsz:3 abid:2
    v_mfma_f32_4x4x4_16b_bf16 v[60:63], v[6:7], v[26:27], v[60:63] cbsz:3 abid:2
    buffer_load_dwordx4 v[24:27], v4, s[8:11], 0 offen
    s_sub_u32 s62, s62, 1
    s_cbranch_scc0 Lsk_32
    s_call_b64 s[68:69], L_flush
Lsk_32:
    v_mfma_f32_4x4x4_16b_bf16 v[56:59], v[6:7], v[28:29], v[56:59] cbsz:3 abid:3
    v_mfma_f32_4x4x4_16b_bf16 v[60:63], v[6:7], v[30:31], v[60:63] cbsz:3 abid:3
    buffer_load_dwordx4 v[28:31], v5, s[8:11], 0 offen
    s_sub_u32 s62, s62, 1
    s_cbranch_scc0 Lbs_2
    s_call_b64 s[68:69], L_flush
    s_branch Lbs_2
Lfs_4:
    s_add_u32 s62, s62, 2
    v_mfma_f32_4x4x4_16b_bf16 v[56:59], v[6:7], v[32:33], v[56:59] cbsz:3 abid:4
    v_mfma_f32_4x4x4_16b_bf16 v[60:63], v[6:7], v[34:35], v[60:63] cbsz:3 abid:4
    buffer_load_dwordx4 v[32:35], v4, s[8:11], 0 offen
    s_sub_u32 s62, s62, 1
    s_cbranch_scc0 Lsk_34
    s_call_b64 s[68:69], L_flush
Lsk_34:
    v_mfma_f32_4x4x4_16b_bf16 v[56:59], v[6:7], v[36:37], v[56:59] cbsz:3 abid:5
    v_mfma_f32_4x4x4_16b_bf16 v[60:63], v[6:7], v[38:39], v[60:63] cbsz:3 abid:5
    buffer_load_dwordx4 v[36:39], v5, s[8:11], 0 offen
    s_sub_u32 s62, s62, 1
    s_cbranch_scc0 Lbs_4
    s_call_b64 s[68:69], L_flush
    s_branch Lbs_4
Lfs_6:
    s_add_u32 s62, s62, 2
    v_mfma_f32_4x4x4_16b_bf16 v[56:59], v[6:7], v[40:41], v[56:59] cbsz:3 abid:6
    v_mfma_f32_4x4x4_16b_bf16 v[60:63], v[6:7], v[42:43], v[60:63] cbsz:3 abid:6
    buffer_load_dwordx4 v[40:43], v4, s[8:11], 0 offen
    s_sub_u32 s62, s62, 1
    s_cbranch_scc0 Lsk_36
    s_call_b64 s[68:69], L_flush
Lsk_36:
    v_mfma_f32_4x4x4_16b_bf16 v[56:59], v[6:7], v[44:45], v[56:59] cbsz:3 abid:7
    v_mfma_f32_4x4x4_16b_bf16 v[60:63], v[6:7], v[46:47], v[60:63] cbsz:3 abid:7
    buffer_load_dwordx4 v[44:47], v5, s[8:11], 0 offen
    s_sub_u32 s62, s62, 1
    s_cbranch_scc0 Lbs_6
    s_call_b64 s[68:69], L_flush
    s_branch Lbs_6
Lfd_0:
    s_call_b64 s[68:69], L_flush
    s_branch Lbd_0
Lfd_1:
    s_call_b64 s[68:69], L_flush
    s_branch Lbd_1
Lfd_2:
    s_call_b64 s[68:69], L_flush
    s_branch Lbd_2
Lfd_3:
    s_call_b64 s[68:69], L_flush
    s_branch Lbd_3
Lfd_4:
    s_call_b64 s[68:69], L_flush
    s_branch Lbd_4
Lfd_5:
    s_call_b64 s[68:69], L_flush
    s_branch Lbd_5
Lfd_6:
    s_call_b64 s[68:69], L_flush
    s_branch Lbd_6
L_dm0:
    s_mov_b64 vcc, 0
    s_cmp_eq_u32 s41, 0
    s_cbranch_scc0 L_dm0b
    ds_read_b32 v4, v12 offset:24
    s_waitcnt lgkmcnt(0)
    v_cmp_le_u32 vcc, 8, v4
    s_cbranch_vccz L_dm0b
    s_lshl_b32 s58, s4, 10
    v_lshl_add_u32 v72, v0, 4, s58
    s_and_b32 s58, s4, 4
    v_lshl_add_u32 v73, s58, 4, v72
    s_movk_i32 s58, 0x1f0
    v_bfi_b32 v72, s58, v73, v72
    s_mov_b32 s41, 1
    s_mov_b64 vcc, -1
    s_branch L_dm0b
Ldm_0:
    ds_write_b128 v72, v[96:99] offset:0
    ds_write_b128 v72, v[100:103] offset:8192
    s_branch Ldb_0
Ldm_2:
    ds_write_b128 v72, v[104:107] offset:16384
    ds_write_b128 v72, v[108:111] offset:24576
    s_branch Ldb_2
Ldm_4:
    ds_write_b128 v72, v[112:115] offset:32768
    ds_write_b128 v72, v[116:119] offset:40960
    s_branch Ldb_4
Ldm_6:
    ds_write_b128 v72, v[120:123] offset:49152
    ds_write_b128 v72, v[124:127] offset:57344
    s_mov_b64 exec, 1
    ds_inc_u32 v12, v12 offset:64
    s_mov_b64 exec, -1
    s_branch Ldb_6
L_flush:
    s_and_b32 s101, s65, 0x3ffff
    s_add_u32 s63, s63, 1
    v_permlane32_swap_b32 v56, v60
    v_permlane32_swap_b32 v57, v61
    v_permlane32_swap_b32 v58, v62
    v_permlane32_swap_b32 v59, v63
    s_lshr_b32 s62, s65, 26
    v_pk_add_f32 v[56:57], v[56:57], v[60:61]
    v_pk_add_f32 v[58:59], v[58:59], v[62:63]
    v_add_u32 v62, s101, v15
    v_pk_mul_f32 v[56:57], v[56:57], s[64:65] op_sel_hi:[1,0]
    v_pk_mul_f32 v[58:59], v[58:59], s[64:65] op_sel_hi:[1,0]
    v_lshl_add_u32 v63, s62, 2, v12
    v_cvt_pk_bf16_f32 v60, v56, v57
    v_cvt_pk_bf16_f32 v61, v58, v59
    ds_write_b64 v62, v[60:61]
    s_mov_b64 exec, 1
    ds_inc_u32 v63, v63 offset:36
    s_mov_b64 exec, -1
    v_readlane_b32 s65, v9, s63
    v_readlane_b32 s64, v8, s63
    v_mov_b64 v[56:57], 0
    v_mov_b64 v[58:59], 0
    v_mov_b64 v[60:61], 0
    v_mov_b64 v[62:63], 0
    s_bfe_u32 s62, s65, 0x80012
    s_setpc_b64 s[68:69]
L_preA:
    s_setprio 2
    v_and_b32 v0, 63, v0
    s_xor_b32 s3, s3, 8
    v_mov_b32 v3, 160064
    s_mov_b64 s[8:9], s[32:33]
    s_mov_b32 s10, 5120000
    s_mov_b32 s11, 0x20000
    v_and_b32 v4, 7, v0
    v_mul_u32_u24 v1, 1056, v4
    v_and_b32 v4, 8, v0
    v_lshl_add_u32 v1, v4, 6, v1
    v_and_b32 v4, 48, v0
    v_add_u32 v1, v4, v1
    v_add_u32 v12, 84480, v1
    v_lshlrev_b32 v14, 4, v0
    s_lshl_b32 s61, s3, 6
    s_add_u32 s61, s61, 105600
    v_add_u32 v13, s61, v1
    s_lshl_b32 s100, s3, 14
    s_add_u32 s100, s100, 720896
    s_waitcnt lgkmcnt(0)
    s_cmp_eq_u32 s3, 0
    s_cbranch_scc0 L_notag
    s_add_u32 s40, s40, 0x9e377000
    s_and_b32 s40, s40, 4294963200
    s_bitset1_b32 s40, 0
    v_mov_b32 v4, s40
    ds_write_b32 v3, v4 offset:68
L_notag:
    v_lshl_add_u32 v104, s12, 9, v2
    v_lshl_add_u32 v105, s13, 9, v2
    v_lshl_add_u32 v106, s14, 9, v2
    v_lshl_add_u32 v107, s15, 9, v2
    v_lshl_add_u32 v108, s16, 9, v2
    v_lshl_add_u32 v109, s17, 9, v2
    v_lshl_add_u32 v110, s18, 9, v2
    v_lshl_add_u32 v111, s19, 9, v2
    v_lshl_add_u32 v112, s28, 9, v2
    v_lshl_add_u32 v113, s29, 9, v2
    s_mov_b32 exec_lo, 0
    v_lshl_add_u32 v104, s20, 9, v2
    v_lshl_add_u32 v105, s21, 9, v2
    v_lshl_add_u32 v106, s22, 9, v2
    v_lshl_add_u32 v107, s23, 9, v2
    v_lshl_add_u32 v108, s24, 9, v2
    v_lshl_add_u32 v109, s25, 9, v2
    v_lshl_add_u32 v110, s26, 9, v2
    v_lshl_add_u32 v111, s27, 9, v2
    v_lshl_add_u32 v112, s30, 9, v2
    v_lshl_add_u32 v113, s31, 9, v2
    s_mov_b64 exec, -1
    s_mov_b64 s[16:17], s[56:57]
    s_mov_b32 s18, 1441792
    s_mov_b32 s19, 0x20000
    s_mov_b64 s[20:21], s[52:53]
    s_mov_b32 s22, 5120000
    s_mov_b32 s23, 0x20000
    s_cmp_ge_u32 s2, 64
    s_cbranch_scc1 L_nopb
    s_barrier
    s_barrier
L_nopb:
    s_mul_i32 s67, s3, 2112
    s_mul_i32 s66, s3, 8448
    s_add_u32 m0, s66, 0
    s_waitcnt vmcnt(1)
    buffer_load_dwordx4 v104, s[8:11], 0 offen lds
    s_add_u32 m0, s66, 1056
    s_waitcnt vmcnt(1)
    buffer_load_dwordx4 v105, s[8:11], 0 offen lds
    v_and_b32 v4, 3, v0
    v_mov_b32 v5, 0x0c0c0c0c
    v_mov_b32 v6, 0x0c0c0302
    v_mov_b32 v7, 0x03020c0c
    v_cmp_eq_u32 s[58:59], 0, v4
    v_cmp_eq_u32 s[60:61], 2, v4
    v_cmp_eq_u32 vcc, 1, v4
    v_cndmask_b32 v8, v5, v6, s[58:59]
    v_cndmask_b32 v9, v5, v6, s[60:61]
    v_cndmask_b32 v8, v8, v7, vcc
    v_cmp_eq_u32 vcc, 3, v4
    s_nop 1
    v_cndmask_b32 v9, v9, v7, vcc
    v_mov_b32 v10, v8
    v_mov_b32 v11, v9
    v_and_b32 v8, 0xfdfdfdfd, v8
    v_and_b32 v9, 0xfdfdfdfd, v9
    s_add_u32 m0, s66, 2112
    s_waitcnt vmcnt(1)
    buffer_load_dwordx4 v106, s[8:11], 0 offen lds
    s_mov_b64 exec, 1
    v_mov_b32 v4, 1
    ds_add_u32 v3, v4 offset:0
    s_mov_b64 exec, -1
    s_add_u32 m0, s66, 3168
    s_waitcnt vmcnt(1)
    buffer_load_dwordx4 v107, s[8:11], 0 offen lds
    s_add_u32 m0, s66, 4224
    s_waitcnt vmcnt(1)
    buffer_load_dwordx4 v108, s[8:11], 0 offen lds
    s_mov_b32 s59, 0
Lw_38:
    ds_read_b32 v4, v3 offset:0
    s_waitcnt lgkmcnt(0)
    v_cmp_gt_u32 vcc, 8, v4
    s_cbranch_vccz Lk_39
    s_add_u32 s59, s59, 1
    s_cmp_lt_u32 s59, 4194304
    s_cbranch_scc1 Lw_38
    s_branch L_end
Lk_39:
    ds_read_b128 v[80:83], v12 offset:0
    ds_read_b128 v[84:87], v12 offset:8448
    ds_read_b128 v[88:91], v12 offset:16896
    s_add_u32 m0, s66, 5280
    s_waitcnt vmcnt(1)
    buffer_load_dwordx4 v109, s[8:11], 0 offen lds
    s_mov_b64 exec, 1
    v_mov_b32 v4, 1
    ds_add_u32 v3, v4 offset:60
    s_mov_b64 exec, -1
    s_waitcnt vmcnt(1)
    ds_read_b32 v4, v3 offset:52
    s_add_u32 m0, s66, 6336
    s_waitcnt vmcnt(1)
    buffer_load_dwordx4 v110, s[8:11], 0 offen lds
    s_mov_b32 s62, 7
    s_waitcnt lgkmcnt(0)
    v_cmp_gt_u32 vcc, 8, v4
    s_cbranch_vccz L_eu10
    s_waitcnt vmcnt(1)
    ds_read_b32 v4, v3 offset:52
    s_add_u32 m0, s66, 7392
    s_waitcnt vmcnt(1)
    buffer_load_dwordx4 v111, s[8:11], 0 offen lds
    s_mov_b32 s62, 8
    s_waitcnt lgkmcnt(0)
    v_cmp_gt_u32 vcc, 8, v4
    s_cbranch_vccz L_eu10
    s_waitcnt vmcnt(1)
    ds_read_b32 v4, v3 offset:52
    s_add_u32 m0, s67, 67584
    s_waitcnt vmcnt(1)
    buffer_load_dwordx4 v112, s[8:11], 0 offen lds
    s_mov_b32 s62, 9
    s_waitcnt lgkmcnt(0)
    v_cmp_gt_u32 vcc, 8, v4
    s_cbranch_vccz L_eu10
    s_waitcnt vmcnt(1)
    ds_read_b32 v4, v3 offset:52
    s_add_u32 m0, s67, 68640
    s_waitcnt vmcnt(1)
    buffer_load_dwordx4 v113, s[8:11], 0 offen lds
    s_mov_b32 s62, 10
    s_mov_b32 s59, 0
Lw_40:
    ds_read_b32 v4, v3 offset:52
    s_waitcnt lgkmcnt(0)
    v_cmp_gt_u32 vcc, 8, v4
    s_cbranch_vccz Lk_41
    s_sleep 1
    s_add_u32 s59, s59, 1
    s_cmp_lt_u32 s59, 4194304
    s_cbranch_scc1 Lw_40
    s_branch L_end
Lk_41:
L_eu10:
    s_setprio 3
    buffer_load_dwordx4 v[16:19], v14, s[16:19], s100 offen offset:0 sc1
    buffer_load_dwordx4 v[20:23], v14, s[16:19], s100 offen offset:1024 sc1
    buffer_load_dwordx4 v[24:27], v14, s[16:19], s100 offen offset:2048 sc1
    buffer_load_dwordx4 v[28:31], v14, s[16:19], s100 offen offset:3072 sc1
    s_add_u32 s100, s100, 4096
    buffer_load_dwordx4 v[32:35], v14, s[16:19], s100 offen offset:0 sc1
    s_cmp_gt_u32 s62, 7
    s_cbranch_scc1 Lem_42
    s_add_u32 m0, s66, 7392
    s_waitcnt vmcnt(63)
    buffer_load_dwordx4 v111, s[8:11], 0 offen lds
Lem_42:
    buffer_load_dwordx4 v[36:39], v14, s[16:19], s100 offen offset:1024 sc1
    buffer_load_dwordx4 v[40:43], v14, s[16:19], s100 offen offset:2048 sc1
    buffer_load_dwordx4 v[44:47], v14, s[16:19], s100 offen offset:3072 sc1
    s_add_u32 s100, s100, 4096
    buffer_load_dwordx4 v[48:51], v14, s[16:19], s100 offen offset:0 sc1
    buffer_load_dwordx4 v[52:55], v14, s[16:19], s100 offen offset:1024 sc1
    s_cmp_gt_u32 s62, 8
    s_cbranch_scc1 Lem_43
    s_add_u32 m0, s67, 67584
    s_waitcnt vmcnt(63)
    buffer_load_dwordx4 v112, s[8:11], 0 offen lds
Lem_43:
    buffer_load_dwordx4 v[56:59], v14, s[16:19], s100 offen offset:2048 sc1
    buffer_load_dwordx4 v[60:63], v14, s[16:19], s100 offen offset:3072 sc1
    s_add_u32 s100, s100, 4096
    buffer_load_dwordx4 v[64:67], v14, s[16:19], s100 offen offset:0 sc1
    buffer_load_dwordx4 v[68:71], v14, s[16:19], s100 offen offset:1024 sc1
    buffer_load_dwordx4 v[72:75], v14, s[16:19], s100 offen offset:2048 sc1
    buffer_load_dwordx4 v[76:79], v14, s[16:19], s100 offen offset:3072 sc1
    s_cmp_gt_u32 s62, 9
    s_cbranch_scc1 Lem_44
    s_add_u32 m0, s67, 68640
    s_waitcnt vmcnt(63)
    buffer_load_dwordx4 v113, s[8:11], 0 offen lds
Lem_44:
    s_setprio 0
    ds_read_b128 v[92:95], v12 offset:64
    ds_read_b128 v[96:99], v12 offset:8512
    ds_read_b128 v[100:103], v12 offset:16960
    s_waitcnt vmcnt(14) lgkmcnt(3)
    v_mfma_f32_16x16x32_bf16 v[104:107], v[16:19], v[80:83], 0
    v_mfma_f32_16x16x32_bf16 v[108:111], v[20:23], v[80:83], 0
    v_mfma_f32_16x16x32_bf16 v[112:115], v[16:19], v[84:87], 0
    v_mfma_f32_16x16x32_bf16 v[116:119], v[20:23], v[84:87], 0
    v_mfma_f32_16x16x32_bf16 v[120:123], v[16:19], v[88:91], 0
    v_mfma_f32_16x16x32_bf16 v[124:127], v[20:23], v[88:91], 0
    ds_read_b128 v[80:83], v12 offset:128
    ds_read_b128 v[84:87], v12 offset:8576
    ds_read_b128 v[88:91], v12 offset:17024
    s_waitcnt vmcnt(12) lgkmcnt(3)
    v_mfma_f32_16x16x32_bf16 v[104:107], v[24:27], v[92:95], v[104:107]
    v_mfma_f32_16x16x32_bf16 v[108:111], v[28:31], v[92:95], v[108:111]
    v_mfma_f32_16x16x32_bf16 v[112:115], v[24:27], v[96:99], v[112:115]
    v_mfma_f32_16x16x32_bf16 v[116:119], v[28:31], v[96:99], v[116:119]
    v_mfma_f32_16x16x32_bf16 v[120:123], v[24:27], v[100:103], v[120:123]
    v_mfma_f32_16x16x32_bf16 v[124:127], v[28:31], v[100:103], v[124:127]
    ds_read_b128 v[92:95], v12 offset:192
    ds_read_b128 v[96:99], v12 offset:8640
    ds_read_b128 v[100:103], v12 offset:17088
    s_waitcnt vmcnt(10) lgkmcnt(3)
    v_mfma_f32_16x16x32_bf16 v[104:107], v[32:35], v[80:83], v[104:107]
    v_mfma_f32_16x16x32_bf16 v[108:111], v[36:39], v[80:83], v[108:111]
    v_mfma_f32_16x16x32_bf16 v[112:115], v[32:35], v[84:87], v[112:115]
    v_mfma_f32_16x16x32_bf16 v[116:119], v[36:39], v[84:87], v[116:119]
    v_mfma_f32_16x16x32_bf16 v[120:123], v[32:35], v[88:91], v[120:123]
    v_mfma_f32_16x16x32_bf16 v[124:127], v[36:39], v[88:91], v[124:127]
    ds_read_b128 v[80:83], v12 offset:256
    ds_read_b128 v[84:87], v12 offset:8704
    ds_read_b128 v[88:91], v12 offset:17152
    s_waitcnt vmcnt(8) lgkmcnt(3)
    v_mfma_f32_16x16x32_bf16 v[104:107], v[40:43], v[92:95], v[104:107]
    v_mfma_f32_16x16x32_bf16 v[108:111], v[44:47], v[92:95], v[108:111]
    v_mfma_f32_16x16x32_bf16 v[112:115], v[40:43], v[96:99], v[112:115]
    v_mfma_f32_16x16x32_bf16 v[116:119], v[44:47], v[96:99], v[116:119]
    v_mfma_f32_16x16x32_bf16 v[120:123], v[40:43], v[100:103], v[120:123]
    v_mfma_f32_16x16x32_bf16 v[124:127], v[44:47], v[100:103], v[124:127]
    ds_read_b128 v[92:95], v12 offset:320
    ds_read_b128 v[96:99], v12 offset:8768
    ds_read_b128 v[100:103], v12 offset:17216
    s_waitcnt vmcnt(6) lgkmcnt(3)
    v_mfma_f32_16x16x32_bf16 v[104:107], v[48:51], v[80:83], v[104:107]
    v_mfma_f32_16x16x32_bf16 v[108:111], v[52:55], v[80:83], v[108:111]
    v_mfma_f32_16x16x32_bf16 v[112:115], v[48:51], v[84:87], v[112:115]
    v_mfma_f32_16x16x32_bf16 v[116:119], v[52:55], v[84:87], v[116:119]
    v_mfma_f32_16x16x32_bf16 v[120:123], v[48:51], v[88:91], v[120:123]
    v_mfma_f32_16x16x32_bf16 v[124:127], v[52:55], v[88:91], v[124:127]
    ds_read_b128 v[80:83], v12 offset:384
    ds_read_b128 v[84:87], v12 offset:8832
    ds_read_b128 v[88:91], v12 offset:17280
    s_waitcnt vmcnt(4) lgkmcnt(3)
    v_mfma_f32_16x16x32_bf16 v[104:107], v[56:59], v[92:95], v[104:107]
    v_mfma_f32_16x16x32_bf16 v[108:111], v[60:63], v[92:95], v[108:111]
    v_mfma_f32_16x16x32_bf16 v[112:115], v[56:59], v[96:99], v[112:115]
    v_mfma_f32_16x16x32_bf16 v[116:119], v[60:63], v[96:99], v[116:119]
    v_mfma_f32_16x16x32_bf16 v[120:123], v[56:59], v[100:103], v[120:123]
    v_mfma_f32_16x16x32_bf16 v[124:127], v[60:63], v[100:103], v[124:127]
    ds_read_b128 v[92:95], v12 offset:448
    ds_read_b128 v[96:99], v12 offset:8896
    ds_read_b128 v[100:103], v12 offset:17344
    s_waitcnt vmcnt(2) lgkmcnt(3)
    v_mfma_f32_16x16x32_bf16 v[104:107], v[64:67], v[80:83], v[104:107]
    v_mfma_f32_16x16x32_bf16 v[108:111], v[68:71], v[80:83], v[108:111]
    v_mfma_f32_16x16x32_bf16 v[112:115], v[64:67], v[84:87], v[112:115]
    v_mfma_f32_16x16x32_bf16 v[116:119], v[68:71], v[84:87], v[116:119]
    v_mfma_f32_16x16x32_bf16 v[120:123], v[64:67], v[88:91], v[120:123]
    v_mfma_f32_16x16x32_bf16 v[124:127], v[68:71], v[88:91], v[124:127]
    s_waitcnt vmcnt(0) lgkmcnt(0)
    v_mfma_f32_16x16x32_bf16 v[104:107], v[72:75], v[92:95], v[104:107]
    v_mfma_f32_16x16x32_bf16 v[108:111], v[76:79], v[92:95], v[108:111]
    v_mfma_f32_16x16x32_bf16 v[112:115], v[72:75], v[96:99], v[112:115]
    v_mfma_f32_16x16x32_bf16 v[116:119], v[76:79], v[96:99], v[116:119]
    v_mfma_f32_16x16x32_bf16 v[120:123], v[72:75], v[100:103], v[120:123]
    v_mfma_f32_16x16x32_bf16 v[124:127], v[76:79], v[100:103], v[124:127]
    s_nop 3
    v_cvt_pk_bf16_f32 v80, v104, v105
    v_cvt_pk_bf16_f32 v81, v106, v107
    v_cvt_pk_bf16_f32 v82, v108, v109
    v_cvt_pk_bf16_f32 v83, v110, v111
    ds_write_b128 v13, v[80:83] offset:0
    v_cvt_pk_bf16_f32 v84, v112, v113
    v_cvt_pk_bf16_f32 v85, v114, v115
    v_cvt_pk_bf16_f32 v86, v116, v117
    v_cvt_pk_bf16_f32 v87, v118, v119
    ds_write_b128 v13, v[84:87] offset:8448
    v_cvt_pk_bf16_f32 v88, v120, v121
    v_cvt_pk_bf16_f32 v89, v122, v123
    v_cvt_pk_bf16_f32 v90, v124, v125
    v_cvt_pk_bf16_f32 v91, v126, v127
    ds_write_b128 v13, v[88:91] offset:16896
    s_mov_b64 exec, 1
    v_mov_b32 v4, 1
    ds_add_u32 v3, v4 offset:20
    s_mov_b64 exec, -1
    s_setprio 3
    s_add_u32 s100, s100, 118784
    buffer_load_dwordx4 v[16:19], v14, s[16:19], s100 offen offset:0 sc1
    buffer_load_dwordx4 v[20:23], v14, s[16:19], s100 offen offset:1024 sc1
    buffer_load_dwordx4 v[24:27], v14, s[16:19], s100 offen offset:2048 sc1
    buffer_load_dwordx4 v[28:31], v14, s[16:19], s100 offen offset:3072 sc1
    s_add_u32 s100, s100, 4096
    buffer_load_dwordx4 v[32:35], v14, s[16:19], s100 offen offset:0 sc1
    buffer_load_dwordx4 v[36:39], v14, s[16:19], s100 offen offset:1024 sc1
    buffer_load_dwordx4 v[40:43], v14, s[16:19], s100 offen offset:2048 sc1
    buffer_load_dwordx4 v[44:47], v14, s[16:19], s100 offen offset:3072 sc1
    s_add_u32 s100, s100, 4096
    buffer_load_dwordx4 v[48:51], v14, s[16:19], s100 offen offset:0 sc1
    buffer_load_dwordx4 v[52:55], v14, s[16:19], s100 offen offset:1024 sc1
    buffer_load_dwordx4 v[56:59], v14, s[16:19], s100 offen offset:2048 sc1
    buffer_load_dwordx4 v[60:63], v14, s[16:19], s100 offen offset:3072 sc1
    s_add_u32 s100, s100, 4096
    buffer_load_dwordx4 v[64:67], v14, s[16:19], s100 offen offset:0 sc1
    buffer_load_dwordx4 v[68:71], v14, s[16:19], s100 offen offset:1024 sc1
    buffer_load_dwordx4 v[72:75], v14, s[16:19], s100 offen offset:2048 sc1
    buffer_load_dwordx4 v[76:79], v14, s[16:19], s100 offen offset:3072 sc1
    s_setprio 0
    s_mov_b32 s63, s3
L_grp:
    s_mul_i32 s58, s63, 8448
    s_lshr_b32 s59, s63, 2
    s_mul_i32 s59, s59, 8448
    s_and_b32 s60, s63, 1
    s_bfe_u32 s61, s63, 0x10001
    s_cmp_ge_u32 s63, 8
    s_cselect_b32 s61, s60, s61
    s_cselect_b32 s60, 0, s60
    s_mul_i32 s60, s60, 4224
    s_lshl_b32 s61, s61, 9
    s_add_u32 s59, s59, s60
    s_add_u32 s59, s59, s61
    s_add_u32 s59, s59, 105600
    v_add_u32 v12, s58, v1
    v_bfe_u32 v4, v0, 2, 2
    v_mul_u32_u24 v4, 1056, v4
    v_and_b32 v5, 48, v0
    v_add3_u32 v13, v4, v5, s59
    v_lshl_add_u32 v14, v0, 3, s58
    v_lshl_add_u32 v2, v0, 3, s59
    s_cmp_ge_u32 s63, 8
    s_cbranch_scc1 L_grp2
    s_mov_b32 s59, 0
Lw_45:
    ds_read_b32 v4, v3 offset:20
    s_waitcnt lgkmcnt(0)
    v_cmp_gt_u32 vcc, 8, v4
    s_cbranch_vccz Lk_46
    s_sleep 1
    s_add_u32 s59, s59, 1
    s_cmp_lt_u32 s59, 4194304
    s_cbranch_scc1 Lw_45
    s_branch L_end
Lk_46:
L_grp2:
    s_waitcnt lgkmcnt(0)
    ds_read_b128 v[80:83], v12 offset:0
    ds_read_b128 v[84:87], v13 offset:0
    ds_read_b128 v[88:91], v12 offset:64
    ds_read_b128 v[92:95], v13 offset:64
    ds_read_b128 v[96:99], v12 offset:128
    ds_read_b128 v[100:103], v13 offset:128
    ds_read_b128 v[104:107], v12 offset:192
    ds_read_b128 v[108:111], v13 offset:192
    ds_read_b128 v[112:115], v12 offset:256
    ds_read_b128 v[116:119], v13 offset:256
    ds_read_b128 v[120:123], v12 offset:320
    ds_read_b128 v[124:127], v13 offset:320
    s_waitcnt lgkmcnt(10)
    v_mfma_f32_16x16x32_bf16 v[4:7], v[80:83], v[84:87], 0
    ds_read_b128 v[80:83], v12 offset:384
    ds_read_b128 v[84:87], v13 offset:384
    s_waitcnt lgkmcnt(10)
    v_mfma_f32_16x16x32_bf16 v[4:7], v[88:91], v[92:95], v[4:7]
    ds_read_b128 v[88:91], v12 offset:448
    ds_read_b128 v[92:95], v13 offset:448
    s_waitcnt lgkmcnt(10)
    v_mfma_f32_16x16x32_bf16 v[4:7], v[96:99], v[100:103], v[4:7]
    s_waitcnt lgkmcnt(8)
    v_mfma_f32_16x16x32_bf16 v[4:7], v[104:107], v[108:111], v[4:7]
    s_waitcnt lgkmcnt(6)
    v_mfma_f32_16x16x32_bf16 v[4:7], v[112:115], v[116:119], v[4:7]
    s_waitcnt lgkmcnt(4)
    v_mfma_f32_16x16x32_bf16 v[4:7], v[120:123], v[124:127], v[4:7]
    s_waitcnt lgkmcnt(2)
    v_mfma_f32_16x16x32_bf16 v[4:7], v[80:83], v[84:87], v[4:7]
    s_waitcnt lgkmcnt(0)
    v_mfma_f32_16x16x32_bf16 v[4:7], v[88:91], v[92:95], v[4:7]
    ds_read_b64 v[96:97], v14 offset:2112
    ds_read_b64 v[98:99], v14 offset:6336
    ds_read_b64 v[100:101], v14 offset:2624
    ds_read_b64 v[102:103], v14 offset:6848
    ds_read_b64 v[104:105], v14 offset:3168
    ds_read_b64 v[106:107], v14 offset:7392
    ds_read_b64 v[108:109], v14 offset:3680
    ds_read_b64 v[110:111], v14 offset:7904
    ds_read_b64 v[80:81], v14 offset:0
    ds_read_b64 v[82:83], v14 offset:4224
    ds_read_b64 v[84:85], v14 offset:512
    ds_read_b64 v[86:87], v14 offset:4736
    ds_read_b64 v[88:89], v14 offset:1056
    ds_read_b64 v[90:91], v14 offset:5280
    ds_read_b64 v[92:93], v14 offset:1568
    s_waitcnt lgkmcnt(14)
    ds_read_b64 v[94:95], v14 offset:5792
    v_mul_f32 v4, 0x3db8aa3b, v4
    v_mul_f32 v5, 0x3db8aa3b, v5
    v_mul_f32 v6, 0x3db8aa3b, v6
    v_mul_f32 v7, 0x3db8aa3b, v7
    v_exp_f32 v4, v4
    v_exp_f32 v5, v5
    v_exp_f32 v6, v6
    v_exp_f32 v7, v7
    v_add_f32 v12, v4, v5
    v_add_f32 v13, v6, v7
    v_add_f32 v12, v12, v13
    v_add_f32 v12, 0x3089705f, v12
    v_rcp_f32 v12, v12
    s_add_u32 s63, s63, 8
    v_mul_f32 v4, v4, v12
    v_mul_f32 v5, v5, v12
    v_mul_f32 v6, v6, v12
    v_mul_f32 v7, v7, v12
    v_cvt_pk_bf16_f32 v4, v4, v5
    v_cvt_pk_bf16_f32 v6, v6, v7
    v_perm_b32 v112, v4, v4, v8
    v_perm_b32 v113, v4, v4, v9
    v_perm_b32 v114, v4, v4, v10
    v_perm_b32 v115, v4, v4, v11
    v_perm_b32 v116, v6, v6, v8
    v_perm_b32 v117, v6, v6, v9
    v_perm_b32 v118, v6, v6, v10
    v_perm_b32 v119, v6, v6, v11
    s_waitcnt lgkmcnt(0)
    v_mfma_f32_4x4x4_16b_bf16 v[120:123], v[112:113], v[80:81], 0 cbsz:4 abid:0
    v_mfma_f32_4x4x4_16b_bf16 v[124:127], v[112:113], v[82:83], 0 cbsz:4 abid:5
    v_mfma_f32_4x4x4_16b_bf16 v[4:7], v[112:113], v[84:85], 0 cbsz:4 abid:10
    v_mfma_f32_4x4x4_16b_bf16 v[12:15], v[112:113], v[86:87], 0 cbsz:4 abid:15
    v_mfma_f32_4x4x4_16b_bf16 v[120:123], v[114:115], v[88:89], v[120:123] cbsz:4 abid:0
    v_mfma_f32_4x4x4_16b_bf16 v[124:127], v[114:115], v[90:91], v[124:127] cbsz:4 abid:5
    v_mfma_f32_4x4x4_16b_bf16 v[4:7], v[114:115], v[92:93], v[4:7] cbsz:4 abid:10
    v_mfma_f32_4x4x4_16b_bf16 v[12:15], v[114:115], v[94:95], v[12:15] cbsz:4 abid:15
    v_mfma_f32_4x4x4_16b_bf16 v[120:123], v[116:117], v[96:97], v[120:123] cbsz:4 abid:0
    v_mfma_f32_4x4x4_16b_bf16 v[124:127], v[116:117], v[98:99], v[124:127] cbsz:4 abid:5
    v_mfma_f32_4x4x4_16b_bf16 v[4:7], v[116:117], v[100:101], v[4:7] cbsz:4 abid:10
    v_mfma_f32_4x4x4_16b_bf16 v[12:15], v[116:117], v[102:103], v[12:15] cbsz:4 abid:15
    v_mfma_f32_4x4x4_16b_bf16 v[120:123], v[118:119], v[104:105], v[120:123] cbsz:4 abid:0
    v_mfma_f32_4x4x4_16b_bf16 v[124:127], v[118:119], v[106:107], v[124:127] cbsz:4 abid:5
    v_mfma_f32_4x4x4_16b_bf16 v[4:7], v[118:119], v[108:109], v[4:7] cbsz:4 abid:10
    v_mfma_f32_4x4x4_16b_bf16 v[12:15], v[118:119], v[110:111], v[12:15] cbsz:4 abid:15
    s_nop 1
    v_cvt_pk_bf16_f32 v112, v120, v121
    v_cvt_pk_bf16_f32 v113, v122, v123
    ds_write_b64 v2, v[112:113] offset:0
    v_cvt_pk_bf16_f32 v114, v124, v125
    v_cvt_pk_bf16_f32 v115, v126, v127
    ds_write_b64 v2, v[114:115] offset:1056
    v_cvt_pk_bf16_f32 v116, v4, v5
    v_cvt_pk_bf16_f32 v117, v6, v7
    ds_write_b64 v2, v[116:117] offset:2112
    v_cvt_pk_bf16_f32 v118, v12, v13
    v_cvt_pk_bf16_f32 v119, v14, v15
    ds_write_b64 v2, v[118:119] offset:3168
    s_cmp_lt_u32 s63, 10
    s_cbranch_scc1 L_grp
L_grpx:
    s_mov_b64 exec, 1
    v_mov_b32 v4, 1
    ds_add_u32 v3, v4 offset:24
    s_mov_b64 exec, -1
    v_add_u32 v12, 105600, v1
    v_lshlrev_b32 v14, 4, v0
    v_and_b32 v6, 15, v0
    v_lshlrev_b32 v6, 2, v6
    v_and_b32 v5, 48, v0
    v_lshl_add_u32 v8, v5, 7, v6
    v_and_b32 v5, 32, v0
    v_lshl_add_u32 v9, v5, 6, v6
    v_and_b32 v5, 16, v0
    v_lshl_add_u32 v9, v5, 22, v9
    s_lshl_b32 s60, s5, 9
    s_lshl_b32 s61, s3, 6
    s_add_u32 s60, s60, s61
    s_mov_b32 s59, 0
Lw_47:
    ds_read_b32 v4, v3 offset:24
    s_waitcnt lgkmcnt(0)
    v_cmp_gt_u32 vcc, 8, v4
    s_cbranch_vccz Lk_48
    s_sleep 1
    s_add_u32 s59, s59, 1
    s_cmp_lt_u32 s59, 4194304
    s_cbranch_scc1 Lw_47
    s_branch L_end
Lk_48:
    ds_read_b128 v[80:83], v12 offset:0
    ds_read_b128 v[84:87], v12 offset:8448
    ds_read_b128 v[88:91], v12 offset:16896
    ds_read_b128 v[92:95], v12 offset:64
    ds_read_b128 v[96:99], v12 offset:8512
    ds_read_b128 v[100:103], v12 offset:16960
    s_waitcnt vmcnt(14) lgkmcnt(3)
    v_mfma_f32_16x16x32_bf16 v[104:107], v[80:83], v[16:19], 0
    v_mfma_f32_16x16x32_bf16 v[108:111], v[80:83], v[20:23], 0
    v_mfma_f32_16x16x32_bf16 v[112:115], v[84:87], v[16:19], 0
    v_mfma_f32_16x16x32_bf16 v[116:119], v[84:87], v[20:23], 0
    v_mfma_f32_16x16x32_bf16 v[120:123], v[88:91], v[16:19], 0
    v_mfma_f32_16x16x32_bf16 v[124:127], v[88:91], v[20:23], 0
    ds_read_b128 v[80:83], v12 offset:128
    ds_read_b128 v[84:87], v12 offset:8576
    ds_read_b128 v[88:91], v12 offset:17024
    s_waitcnt vmcnt(12) lgkmcnt(3)
    v_mfma_f32_16x16x32_bf16 v[104:107], v[92:95], v[24:27], v[104:107]
    v_mfma_f32_16x16x32_bf16 v[108:111], v[92:95], v[28:31], v[108:111]
    v_mfma_f32_16x16x32_bf16 v[112:115], v[96:99], v[24:27], v[112:115]
    v_mfma_f32_16x16x32_bf16 v[116:119], v[96:99], v[28:31], v[116:119]
    v_mfma_f32_16x16x32_bf16 v[120:123], v[100:103], v[24:27], v[120:123]
    v_mfma_f32_16x16x32_bf16 v[124:127], v[100:103], v[28:31], v[124:127]
    ds_read_b128 v[92:95], v12 offset:192
    ds_read_b128 v[96:99], v12 offset:8640
    ds_read_b128 v[100:103], v12 offset:17088
    s_waitcnt vmcnt(10) lgkmcnt(3)
    v_mfma_f32_16x16x32_bf16 v[104:107], v[80:83], v[32:35], v[104:107]
    v_mfma_f32_16x16x32_bf16 v[108:111], v[80:83], v[36:39], v[108:111]
    v_mfma_f32_16x16x32_bf16 v[112:115], v[84:87], v[32:35], v[112:115]
    v_mfma_f32_16x16x32_bf16 v[116:119], v[84:87], v[36:39], v[116:119]
    v_mfma_f32_16x16x32_bf16 v[120:123], v[88:91], v[32:35], v[120:123]
    v_mfma_f32_16x16x32_bf16 v[124:127], v[88:91], v[36:39], v[124:127]
    ds_read_b128 v[80:83], v12 offset:256
    ds_read_b128 v[84:87], v12 offset:8704
    ds_read_b128 v[88:91], v12 offset:17152
    s_waitcnt vmcnt(8) lgkmcnt(3)
    v_mfma_f32_16x16x32_bf16 v[104:107], v[92:95], v[40:43], v[104:107]
    v_mfma_f32_16x16x32_bf16 v[108:111], v[92:95], v[44:47], v[108:111]
    v_mfma_f32_16x16x32_bf16 v[112:115], v[96:99], v[40:43], v[112:115]
    v_mfma_f32_16x16x32_bf16 v[116:119], v[96:99], v[44:47], v[116:119]
    v_mfma_f32_16x16x32_bf16 v[120:123], v[100:103], v[40:43], v[120:123]
    v_mfma_f32_16x16x32_bf16 v[124:127], v[100:103], v[44:47], v[124:127]
    ds_read_b128 v[92:95], v12 offset:320
    ds_read_b128 v[96:99], v12 offset:8768
    ds_read_b128 v[100:103], v12 offset:17216
    s_waitcnt vmcnt(6) lgkmcnt(3)
    v_mfma_f32_16x16x32_bf16 v[104:107], v[80:83], v[48:51], v[104:107]
    v_mfma_f32_16x16x32_bf16 v[108:111], v[80:83], v[52:55], v[108:111]
    v_mfma_f32_16x16x32_bf16 v[112:115], v[84:87], v[48:51], v[112:115]
    v_mfma_f32_16x16x32_bf16 v[116:119], v[84:87], v[52:55], v[116:119]
    v_mfma_f32_16x16x32_bf16 v[120:123], v[88:91], v[48:51], v[120:123]
    v_mfma_f32_16x16x32_bf16 v[124:127], v[88:91], v[52:55], v[124:127]
    ds_read_b128 v[80:83], v12 offset:384
    ds_read_b128 v[84:87], v12 offset:8832
    ds_read_b128 v[88:91], v12 offset:17280
    s_waitcnt vmcnt(4) lgkmcnt(3)
    v_mfma_f32_16x16x32_bf16 v[104:107], v[92:95], v[56:59], v[104:107]
    v_mfma_f32_16x16x32_bf16 v[108:111], v[92:95], v[60:63], v[108:111]
    v_mfma_f32_16x16x32_bf16 v[112:115], v[96:99], v[56:59], v[112:115]
    v_mfma_f32_16x16x32_bf16 v[116:119], v[96:99], v[60:63], v[116:119]
    v_mfma_f32_16x16x32_bf16 v[120:123], v[100:103], v[56:59], v[120:123]
    v_mfma_f32_16x16x32_bf16 v[124:127], v[100:103], v[60:63], v[124:127]
    ds_read_b128 v[92:95], v12 offset:448
    ds_read_b128 v[96:99], v12 offset:8896
    ds_read_b128 v[100:103], v12 offset:17344
    s_waitcnt vmcnt(2) lgkmcnt(3)
    v_mfma_f32_16x16x32_bf16 v[104:107], v[80:83], v[64:67], v[104:107]
    v_mfma_f32_16x16x32_bf16 v[108:111], v[80:83], v[68:71], v[108:111]
    v_mfma_f32_16x16x32_bf16 v[112:115], v[84:87], v[64:67], v[112:115]
    v_mfma_f32_16x16x32_bf16 v[116:119], v[84:87], v[68:71], v[116:119]
    v_mfma_f32_16x16x32_bf16 v[120:123], v[88:91], v[64:67], v[120:123]
    v_mfma_f32_16x16x32_bf16 v[124:127], v[88:91], v[68:71], v[124:127]
    s_waitcnt vmcnt(0) lgkmcnt(0)
    v_mfma_f32_16x16x32_bf16 v[104:107], v[92:95], v[72:75], v[104:107]
    v_mfma_f32_16x16x32_bf16 v[108:111], v[92:95], v[76:79], v[108:111]
    v_mfma_f32_16x16x32_bf16 v[112:115], v[96:99], v[72:75], v[112:115]
    v_mfma_f32_16x16x32_bf16 v[116:119], v[96:99], v[76:79], v[116:119]
    v_mfma_f32_16x16x32_bf16 v[120:123], v[100:103], v[72:75], v[120:123]
    v_mfma_f32_16x16x32_bf16 v[124:127], v[100:103], v[76:79], v[124:127]
    s_add_u32 s100, s100, 122880
    s_setprio 3
    s_add_u32 s100, s100, 4096
    buffer_load_dwordx4 v[48:51], v14, s[16:19], s100 offen offset:0 sc1
    buffer_load_dwordx4 v[52:55], v14, s[16:19], s100 offen offset:1024 sc1
    buffer_load_dwordx4 v[56:59], v14, s[16:19], s100 offen offset:2048 sc1
    buffer_load_dwordx4 v[60:63], v14, s[16:19], s100 offen offset:3072 sc1
    s_add_u32 s100, s100, 4096
    buffer_load_dwordx4 v[64:67], v14, s[16:19], s100 offen offset:0 sc1
    buffer_load_dwordx4 v[68:71], v14, s[16:19], s100 offen offset:1024 sc1
    buffer_load_dwordx4 v[72:75], v14, s[16:19], s100 offen offset:2048 sc1
    buffer_load_dwordx4 v[76:79], v14, s[16:19], s100 offen offset:3072 sc1
    s_setprio 0
    v_and_b32 v5, 15, v0
    v_lshlrev_b32 v5, 2, v5
    v_and_b32 v6, 16, v0
    v_lshl_add_u32 v5, v6, 2, v5
    s_lshl_b32 s58, s3, 6
    v_add_u32 v5, s58, v5
    v_and_b32 v5, 0x1ff, v5
    v_and_b32 v6, 48, v0
    v_lshl_add_u32 v5, v6, 8, v5
    s_mov_b32 s70, 0x05040100
    s_mov_b32 s71, 0x07060302
    s_mov_b32 s59, 0
Lw_49:
    ds_read_b32 v4, v3 offset:64
    s_waitcnt lgkmcnt(0)
    v_cmp_gt_u32 vcc, 8, v4
    s_cbranch_vccz Lk_50
    s_sleep 2
    s_add_u32 s59, s59, 1
    s_cmp_lt_u32 s59, 16777216
    s_cbranch_scc1 Lw_49
    s_branch L_end
Lk_50:
    ds_read2st64_b32 v[24:25], v5 offset0:0 offset1:2
    ds_read2st64_b32 v[26:27], v5 offset0:4 offset1:6
    ds_read2st64_b32 v[28:29], v5 offset0:8 offset1:10
    ds_read2st64_b32 v[30:31], v5 offset0:12 offset1:14
    ds_read2st64_b32 v[32:33], v5 offset0:64 offset1:66
    ds_read2st64_b32 v[34:35], v5 offset0:68 offset1:70
    ds_read2st64_b32 v[36:37], v5 offset0:72 offset1:74
    ds_read2st64_b32 v[38:39], v5 offset0:76 offset1:78
    ds_read2st64_b32 v[40:41], v5 offset0:128 offset1:130
    ds_read2st64_b32 v[42:43], v5 offset0:132 offset1:134
    ds_read2st64_b32 v[44:45], v5 offset0:136 offset1:138
    ds_read2st64_b32 v[46:47], v5 offset0:140 offset1:142
    s_waitcnt lgkmcnt(8)
    ds_read2st64_b32 v[80:81], v5 offset0:192 offset1:194
    ds_read2st64_b32 v[82:83], v5 offset0:196 offset1:198
    ds_read2st64_b32 v[84:85], v5 offset0:200 offset1:202
    ds_read2st64_b32 v[86:87], v5 offset0:204 offset1:206
    v_perm_b32 v16, v25, v24, s70
    v_perm_b32 v20, v25, v24, s71
    v_perm_b32 v17, v27, v26, s70
    v_perm_b32 v21, v27, v26, s71
    v_perm_b32 v18, v29, v28, s70
    v_perm_b32 v22, v29, v28, s71
    v_perm_b32 v19, v31, v30, s70
    v_perm_b32 v23, v31, v30, s71
    s_waitcnt lgkmcnt(8)
    v_perm_b32 v24, v33, v32, s70
    v_perm_b32 v28, v33, v32, s71
    v_perm_b32 v25, v35, v34, s70
    v_perm_b32 v29, v35, v34, s71
    v_perm_b32 v26, v37, v36, s70
    v_perm_b32 v30, v37, v36, s71
    v_perm_b32 v27, v39, v38, s70
    v_perm_b32 v31, v39, v38, s71
    s_waitcnt lgkmcnt(4)
    v_perm_b32 v32, v41, v40, s70
    v_perm_b32 v36, v41, v40, s71
    v_perm_b32 v33, v43, v42, s70
    v_perm_b32 v37, v43, v42, s71
    v_perm_b32 v34, v45, v44, s70
    v_perm_b32 v38, v45, v44, s71
    v_perm_b32 v35, v47, v46, s70
    v_perm_b32 v39, v47, v46, s71
    s_waitcnt lgkmcnt(0)
    v_perm_b32 v40, v81, v80, s70
    v_perm_b32 v44, v81, v80, s71
    v_perm_b32 v41, v83, v82, s70
    v_perm_b32 v45, v83, v82, s71
    v_perm_b32 v42, v85, v84, s70
    v_perm_b32 v46, v85, v84, s71
    v_perm_b32 v43, v87, v86, s70
    v_perm_b32 v47, v87, v86, s71
    v_add_u32 v12, 130944, v1
    s_mov_b32 s59, 0
Lw_51:
    ds_read_b32 v4, v3 offset:36
    s_waitcnt lgkmcnt(0)
    v_cmp_gt_u32 vcc, 16, v4
    s_cbranch_vccz Lk_52
    s_sleep 3
    s_add_u32 s59, s59, 1
    s_cmp_lt_u32 s59, 16777216
    s_cbranch_scc1 Lw_51
    s_branch L_end
Lk_52:
    ds_read_b128 v[80:83], v12 offset:0
    ds_read_b128 v[84:87], v12 offset:64
    ds_read_b128 v[88:91], v12 offset:128
    ds_read_b128 v[92:95], v12 offset:192
    ds_read_b128 v[96:99], v12 offset:256
    ds_read_b128 v[100:103], v12 offset:320
    s_waitcnt vmcnt(14) lgkmcnt(5)
    v_mfma_f32_16x16x32_bf16 v[104:107], v[80:83], v[16:19], v[104:107]
    v_mfma_f32_16x16x32_bf16 v[108:111], v[80:83], v[20:23], v[108:111]
    ds_read_b128 v[80:83], v12 offset:384
    s_waitcnt vmcnt(12) lgkmcnt(5)
    v_mfma_f32_16x16x32_bf16 v[104:107], v[84:87], v[24:27], v[104:107]
    v_mfma_f32_16x16x32_bf16 v[108:111], v[84:87], v[28:31], v[108:111]
    ds_read_b128 v[84:87], v12 offset:448
    s_waitcnt vmcnt(10) lgkmcnt(5)
    v_mfma_f32_16x16x32_bf16 v[104:107], v[88:91], v[32:35], v[104:107]
    v_mfma_f32_16x16x32_bf16 v[108:111], v[88:91], v[36:39], v[108:111]
    s_waitcnt vmcnt(8) lgkmcnt(4)
    v_mfma_f32_16x16x32_bf16 v[104:107], v[92:95], v[40:43], v[104:107]
    v_mfma_f32_16x16x32_bf16 v[108:111], v[92:95], v[44:47], v[108:111]
    s_waitcnt vmcnt(6) lgkmcnt(3)
    v_mfma_f32_16x16x32_bf16 v[104:107], v[96:99], v[48:51], v[104:107]
    v_mfma_f32_16x16x32_bf16 v[108:111], v[96:99], v[52:55], v[108:111]
    s_waitcnt vmcnt(4) lgkmcnt(2)
    v_mfma_f32_16x16x32_bf16 v[104:107], v[100:103], v[56:59], v[104:107]
    v_mfma_f32_16x16x32_bf16 v[108:111], v[100:103], v[60:63], v[108:111]
    s_waitcnt vmcnt(2) lgkmcnt(1)
    v_mfma_f32_16x16x32_bf16 v[104:107], v[80:83], v[64:67], v[104:107]
    v_mfma_f32_16x16x32_bf16 v[108:111], v[80:83], v[68:71], v[108:111]
    s_waitcnt vmcnt(0) lgkmcnt(0)
    v_mfma_f32_16x16x32_bf16 v[104:107], v[84:87], v[72:75], v[104:107]
    v_mfma_f32_16x16x32_bf16 v[108:111], v[84:87], v[76:79], v[108:111]
    s_nop 7
    v_cvt_pk_bf16_f32 v104, v104, v108
    buffer_store_dword v104, v8, s[20:23], s60 offen offset:0 sc1
    v_cvt_pk_bf16_f32 v105, v105, v109
    buffer_store_dword v105, v8, s[20:23], s60 offen offset:512 sc1
    v_cvt_pk_bf16_f32 v106, v106, v110
    buffer_store_dword v106, v8, s[20:23], s60 offen offset:1024 sc1
    v_cvt_pk_bf16_f32 v107, v107, v111
    buffer_store_dword v107, v8, s[20:23], s60 offen offset:1536 sc1
    s_add_u32 s60, s60, 8192
    s_mov_b32 s59, 0
Lw_53:
    ds_read_b32 v4, v3 offset:40
    s_waitcnt lgkmcnt(0)
    v_cmp_gt_u32 vcc, 16, v4
    s_cbranch_vccz Lk_54
    s_sleep 3
    s_add_u32 s59, s59, 1
    s_cmp_lt_u32 s59, 16777216
    s_cbranch_scc1 Lw_53
    s_branch L_end
Lk_54:
    ds_read_b128 v[80:83], v12 offset:8448
    ds_read_b128 v[84:87], v12 offset:8512
    ds_read_b128 v[88:91], v12 offset:8576
    ds_read_b128 v[92:95], v12 offset:8640
    ds_read_b128 v[96:99], v12 offset:8704
    ds_read_b128 v[100:103], v12 offset:8768
    s_waitcnt lgkmcnt(5)
    v_mfma_f32_16x16x32_bf16 v[112:115], v[80:83], v[16:19], v[112:115]
    v_mfma_f32_16x16x32_bf16 v[116:119], v[80:83], v[20:23], v[116:119]
    ds_read_b128 v[80:83], v12 offset:8832
    s_waitcnt lgkmcnt(5)
    v_mfma_f32_16x16x32_bf16 v[112:115], v[84:87], v[24:27], v[112:115]
    v_mfma_f32_16x16x32_bf16 v[116:119], v[84:87], v[28:31], v[116:119]
    ds_read_b128 v[84:87], v12 offset:8896
    s_waitcnt lgkmcnt(5)
    v_mfma_f32_16x16x32_bf16 v[112:115], v[88:91], v[32:35], v[112:115]
    v_mfma_f32_16x16x32_bf16 v[116:119], v[88:91], v[36:39], v[116:119]
    s_waitcnt lgkmcnt(4)
    v_mfma_f32_16x16x32_bf16 v[112:115], v[92:95], v[40:43], v[112:115]
    v_mfma_f32_16x16x32_bf16 v[116:119], v[92:95], v[44:47], v[116:119]
    s_waitcnt lgkmcnt(3)
    v_mfma_f32_16x16x32_bf16 v[112:115], v[96:99], v[48:51], v[112:115]
    v_mfma_f32_16x16x32_bf16 v[116:119], v[96:99], v[52:55], v[116:119]
    s_waitcnt lgkmcnt(2)
    v_mfma_f32_16x16x32_bf16 v[112:115], v[100:103], v[56:59], v[112:115]
    v_mfma_f32_16x16x32_bf16 v[116:119], v[100:103], v[60:63], v[116:119]
    s_waitcnt lgkmcnt(1)
    v_mfma_f32_16x16x32_bf16 v[112:115], v[80:83], v[64:67], v[112:115]
    v_mfma_f32_16x16x32_bf16 v[116:119], v[80:83], v[68:71], v[116:119]
    s_waitcnt lgkmcnt(0)
    v_mfma_f32_16x16x32_bf16 v[112:115], v[84:87], v[72:75], v[112:115]
    v_mfma_f32_16x16x32_bf16 v[116:119], v[84:87], v[76:79], v[116:119]
    s_nop 7
    v_cvt_pk_bf16_f32 v112, v112, v116
    buffer_store_dword v112, v8, s[20:23], s60 offen offset:0 sc1
    v_cvt_pk_bf16_f32 v113, v113, v117
    buffer_store_dword v113, v8, s[20:23], s60 offen offset:512 sc1
    v_cvt_pk_bf16_f32 v114, v114, v118
    buffer_store_dword v114, v8, s[20:23], s60 offen offset:1024 sc1
    v_cvt_pk_bf16_f32 v115, v115, v119
    buffer_store_dword v115, v8, s[20:23], s60 offen offset:1536 sc1
    s_add_u32 s60, s60, 8192
    s_mov_b32 s59, 0
Lw_55:
    ds_read_b32 v4, v3 offset:44
    s_waitcnt lgkmcnt(0)
    v_cmp_gt_u32 vcc, 8, v4
    s_cbranch_vccz Lk_56
    s_add_u32 s59, s59, 1
    s_cmp_lt_u32 s59, 16777216
    s_cbranch_scc1 Lw_55
    s_branch L_end
Lk_56:
    ds_read_b128 v[80:83], v12 offset:16896
    ds_read_b128 v[84:87], v12 offset:16960
    ds_read_b128 v[88:91], v12 offset:17024
    ds_read_b128 v[92:95], v12 offset:17088
    ds_read_b128 v[96:99], v12 offset:17152
    ds_read_b128 v[100:103], v12 offset:17216
    s_waitcnt lgkmcnt(5)
    v_mfma_f32_16x16x32_bf16 v[120:123], v[80:83], v[16:19], v[120:123]
    v_mfma_f32_16x16x32_bf16 v[124:127], v[80:83], v[20:23], v[124:127]
    ds_read_b128 v[80:83], v12 offset:17280
    s_waitcnt lgkmcnt(5)
    v_mfma_f32_16x16x32_bf16 v[120:123], v[84:87], v[24:27], v[120:123]
    v_mfma_f32_16x16x32_bf16 v[124:127], v[84:87], v[28:31], v[124:127]
    ds_read_b128 v[84:87], v12 offset:17344
    s_waitcnt lgkmcnt(5)
    v_mfma_f32_16x16x32_bf16 v[120:123], v[88:91], v[32:35], v[120:123]
    v_mfma_f32_16x16x32_bf16 v[124:127], v[88:91], v[36:39], v[124:127]
    s_waitcnt lgkmcnt(4)
    v_mfma_f32_16x16x32_bf16 v[120:123], v[92:95], v[40:43], v[120:123]
    v_mfma_f32_16x16x32_bf16 v[124:127], v[92:95], v[44:47], v[124:127]
    s_waitcnt lgkmcnt(3)
    v_mfma_f32_16x16x32_bf16 v[120:123], v[96:99], v[48:51], v[120:123]
    v_mfma_f32_16x16x32_bf16 v[124:127], v[96:99], v[52:55], v[124:127]
    s_waitcnt lgkmcnt(2)
    v_mfma_f32_16x16x32_bf16 v[120:123], v[100:103], v[56:59], v[120:123]
    v_mfma_f32_16x16x32_bf16 v[124:127], v[100:103], v[60:63], v[124:127]
    s_waitcnt lgkmcnt(1)
    v_mfma_f32_16x16x32_bf16 v[120:123], v[80:83], v[64:67], v[120:123]
    v_mfma_f32_16x16x32_bf16 v[124:127], v[80:83], v[68:71], v[124:127]
    s_waitcnt lgkmcnt(0)
    v_mfma_f32_16x16x32_bf16 v[120:123], v[84:87], v[72:75], v[120:123]
    v_mfma_f32_16x16x32_bf16 v[124:127], v[84:87], v[76:79], v[124:127]
    s_nop 7
    v_cvt_pk_bf16_f32 v120, v120, v124
    buffer_store_dword v120, v9, s[20:23], s60 offen offset:0 sc1
    v_cvt_pk_bf16_f32 v121, v121, v125
    buffer_store_dword v121, v9, s[20:23], s60 offen offset:512 sc1
    v_cvt_pk_bf16_f32 v122, v122, v126
    buffer_store_dword v122, v9, s[20:23], s60 offen offset:1024 sc1
    v_cvt_pk_bf16_f32 v123, v123, v127
    buffer_store_dword v123, v9, s[20:23], s60 offen offset:1536 sc1
L_end:
L_exit:
    s_endpgm
L_slow:
    s_setprio 0
    s_mov_b64 exec, 1
    ds_add_u32 v3, v62 offset:16
    s_mov_b64 exec, -1
    s_mov_b32 s59, 0
Lw_57:
    ds_read_b32 v4, v3 offset:16
    s_waitcnt lgkmcnt(0)
    v_cmp_gt_u32 vcc, 8, v4
    s_cbranch_vccz Lk_58
    s_add_u32 s59, s59, 1
    s_cmp_lt_u32 s59, 4194304
    s_cbranch_scc1 Lw_57
    s_branch L_end
Lk_58:
    v_mov_b32 v12, v3
    s_mov_b64 s[24:25], s[34:35]
    s_mov_b32 s26, 640000
    s_mov_b64 s[28:29], s[36:37]
    s_mov_b32 s30, 640000
    s_mov_b64 s[12:13], s[42:43]
    s_mov_b32 s14, 20000
    s_mov_b32 s15, 0x20000
    s_sub_u32 s63, s67, 1
    s_mov_b32 s65, 201486784
    s_mov_b32 s64, 0
    s_call_b64 s[68:69], L_flush
    s_add_u32 s66, s4, s5
    s_add_u32 s67, s66, 40
    v_lshlrev_b32 v16, 2, v0
    v_and_b32 v17, 32, v0
    v_lshl_add_u32 v17, v17, 22, v2
    v_mov_b32 v24, 0
L_sn:
    s_mov_b32 s60, 0
L_sc:
    buffer_load_dword v18, v16, s[28:31], s60 offen
    buffer_load_dword v19, v16, s[24:27], s60 offen
    s_waitcnt vmcnt(0)
    v_cmp_eq_u32 vcc, s66, v18
    s_cbranch_vccz L_sx
L_se:
    s_ff1_i32_b64 s58, vcc
    s_bitset0_b64 vcc, s58
    v_readlane_b32 s59, v19, s58
    s_nop 3
    s_lshl_b32 s61, s59, 9
    s_lshl_b32 s59, s59, 1
    buffer_load_dwordx4 v[20:23], v17, s[8:11], s61 offen
    buffer_load_ushort v1, v24, s[12:15], s59 offen
    s_waitcnt vmcnt(0)
    v_perm_b32 v6, v1, v1, v10
    v_perm_b32 v7, v1, v1, v11
    s_nop 1
    v_mfma_f32_4x4x4_16b_bf16 v[56:59], v[6:7], v[20:21], v[56:59]
    v_mfma_f32_4x4x4_16b_bf16 v[60:63], v[6:7], v[22:23], v[60:63]
    s_cmp_lg_u64 vcc, 0
    s_cbranch_scc1 L_se
L_sx:
    s_add_u32 s60, s60, 256
    s_cmp_lt_u32 s60, 640000
    s_cbranch_scc1 L_sc
    s_call_b64 s[68:69], L_flush
    s_add_u32 s66, s66, 8
    s_cmp_lt_u32 s66, s67
    s_cbranch_scc1 L_sn
    s_branch L_gdone
.section .rodata,"a"
.p2align 6
.amdhsa_kernel standalone__hybrid_graph_tf_exphormer__graph_kernel
  .amdhsa_next_free_vgpr 128
  .amdhsa_next_free_sgpr 102
  .amdhsa_accum_offset 128
  .amdhsa_group_segment_fixed_size 0
  .amdhsa_kernarg_size 104
  .amdhsa_user_sgpr_count 2
  .amdhsa_user_sgpr_kernarg_segment_ptr 1
  .amdhsa_system_sgpr_workgroup_id_x 1
.end_amdhsa_kernel
```

```asm
; @launch grid=(250,1,1) block=(1024,1,1) lds=162240
.amdgcn_target "amdgcn-amd-amdhsa--gfx950"
.text
.globl standalone__hybrid_graph_tf_exphormer__graph_kernel
.p2align 8
.type standalone__hybrid_graph_tf_exphormer__graph_kernel,@function
standalone__hybrid_graph_tf_exphormer__graph_kernel:
    s_cmpk_ge_u32 s2, 250
    s_cbranch_scc1 L_exit
    s_load_dwordx16 s[32:47], s[0:1], 0
    s_load_dwordx8 s[48:55], s[0:1], 64
    s_load_dwordx2 s[56:57], s[0:1], 96
    s_getpc_b64 s[60:61]
    s_lshr_b32 s6, s2, 3
    v_lshl_add_u32 v1, v0, 5, s6
    v_lshlrev_b32 v2, 7, v1
    v_cmpx_gt_u32 vcc, 91, v1
    s_cbranch_execz L_nopf
    global_load_dword v15, v2, s[60:61] offset:384
L_nopf:
    s_mov_b64 exec, -1
    v_lshrrev_b32 v1, 6, v0
    v_lshlrev_b32 v5, 4, v0
    v_and_b32 v6, 32, v0
    v_readfirstlane_b32 s3, v1
    v_and_b32 v2, 0x1f0, v5
    s_and_b32 s4, s3, 7
    s_and_b32 s61, s3, 4
    s_add_u32 s61, s61, s4
    s_mul_i32 s101, s4, 1056
    s_cmp_ge_u32 s3, 8
    s_cbranch_scc1 L_eA
    s_setprio 3
    s_sub_u32 s62, s2, 64
    s_cbranch_scc0 L_eM
    s_mul_i32 s58, s2, 10000
    v_add_u32 v8, s58, v5
    v_min_u32 v9, 451, v0
    s_addk_i32 s58, 8192
    v_lshl_add_u32 v9, v9, 2, s58
    s_mov_b32 s63, 1
    s_waitcnt lgkmcnt(0)
    global_load_dwordx4 v[22:25], v8, s[36:37]
    global_load_dword v26, v9, s[36:37]
    s_setprio 2
    global_load_dwordx4 v[16:19], v8, s[34:35]
    global_load_dword v20, v9, s[34:35]
    s_branch L_eB
L_eM:
    s_cmpk_ge_u32 s62, 128
    s_cbranch_scc1 L_eW
    s_mov_b32 s63, 0
    s_cmp_ge_u32 s4, 4
    s_cbranch_scc1 L_eBw
    v_lshl_add_u32 v8, v6, 8, v2
    v_lshl_add_u32 v8, s61, 9, v8
    s_lshr_b32 s58, s62, 4
    s_bfe_u32 s59, s62, 0x10003
    s_lshl3_add_u32 s58, s58, s59
    v_lshl_add_u32 v9, s58, 11, v8
    s_and_b32 s58, s62, 7
    v_lshl_add_u32 v8, s58, 14, v8
    s_add_u32 m0, s101, 105600
    s_waitcnt lgkmcnt(0)
    global_load_lds_dwordx4 v8, s[46:47]
    s_addk_i32 m0, 6400
    s_mov_b32 s63, 2
    global_load_lds_dwordx4 v8, s[46:47] offset:2048
    s_addk_i32 m0, 10496
    s_nop 0
    global_load_lds_dwordx4 v9, s[48:49]
    s_addk_i32 m0, 4224
    v_add_u32 v9, 4096, v9
    global_load_lds_dwordx4 v9, s[48:49]
    s_addk_i32 m0, 48640
    v_add_u32 v8, 4096, v8
    global_load_lds_dwordx4 v8, s[46:47]
    s_addk_i32 m0, 6400
    s_nop 0
    global_load_lds_dwordx4 v8, s[46:47] offset:2048
    s_branch L_eB
L_eA:
    s_and_b32 s59, s2, 7
    s_mul_i32 s60, s59, 31
    s_min_u32 s59, s59, 2
    s_add_u32 s6, s6, s60
    s_add_u32 s6, s6, s59
    s_mul_i32 s5, s6, 40
    s_lshl_b32 s58, s5, 4
    s_lshl3_add_u32 s59, s61, s58
    s_lshl_b32 s60, s4, 6
    s_add_u32 s58, s58, s60
    s_add_u32 s60, s5, s4
    v_lshl_add_u32 v8, s60, 9, v2
    v_lshl_add_u32 v9, v6, 7, v8
    s_add_u32 m0, s101, 84480
    s_waitcnt lgkmcnt(0)
    s_load_dwordx16 s[12:27], s[38:39], s58
    s_load_dwordx2 s[28:29], s[38:39], s59 offset:512
    s_load_dwordx2 s[30:31], s[38:39], s59 offset:544
    s_load_dword s40, s[56:57], 655616
    s_barrier
    global_load_lds_dwordx4 v9, s[32:33]
    s_addk_i32 m0, 8448
    v_add_u32 v9, 8192, v9
    global_load_lds_dwordx4 v9, s[32:33]
    s_cmp_ge_u32 s4, 4
    s_cbranch_scc1 L_preA
    s_addk_i32 m0, 8448
    v_lshl_add_u32 v9, v6, 6, v8
    v_add_u32 v9, 16384, v9
    global_load_lds_dwordx4 v9, s[32:33]
    s_branch L_preA
L_eW:
    s_mul_i32 s58, s4, 58
    s_add_u32 s62, s62, s58
    s_sub_u32 s62, s62, 128
    s_mov_b32 s63, 0
    s_cmp_ge_u32 s62, 96
    s_waitcnt lgkmcnt(0)
    s_cbranch_scc1 L_eB
    s_and_b32 s59, s62, 28
    s_add_u32 s59, s59, 4
    s_cmp_ge_u32 s62, 64
    s_cselect_b32 s59, s59, 0
    s_add_u32 s62, s62, s59
    s_mov_b32 s63, 4
    s_and_b32 s59, s62, 7
    s_lshl_b32 s59, s59, 14
    s_bfe_u32 s60, s62, 0x30003
    s_lshl_b32 s60, s60, 6
    s_add_u32 s59, s59, s60
    v_and_b32 v8, 15, v0
    v_lshl_add_u32 v8, v8, 2, s59
    v_and_b32 v9, 48, v0
    v_lshl_add_u32 v8, v9, 8, v8
    s_cmp_lt_u32 s62, 64
    s_cselect_b64 s[58:59], s[50:51], s[44:45]
    global_load_dword v16, v8, s[58:59] offset:0
    global_load_dword v17, v8, s[58:59] offset:512
    global_load_dword v18, v8, s[58:59] offset:1024
    global_load_dword v19, v8, s[58:59] offset:1536
    global_load_dword v20, v8, s[58:59] offset:2048
    global_load_dword v21, v8, s[58:59] offset:2560
    global_load_dword v22, v8, s[58:59] offset:3072
    global_load_dword v23, v8, s[58:59] offset:3584
L_eBw:
    s_waitcnt lgkmcnt(0)
L_eB:
    s_setprio 3
    v_mov_b32 v8, 33554432
    v_cmp_gt_u32 vcc, 320, v0
    v_add_u32 v4, 152064, v5
    v_mov_b64 v[12:13], 0
    v_cndmask_b32 v8, 0, v8, vcc
    v_mov_b32 v9, v8
    v_mov_b64 v[10:11], v[8:9]
    ds_write_b128 v4, v[8:11]
    v_cmpx_gt_u32 vcc, 60, v0
    ds_write_b64 v4, v[12:13] offset:8192
    ds_write_b64 v4, v[12:13] offset:8200
    s_mov_b64 exec, -1
    s_and_b32 s59, s2, 7
    s_mul_i32 s60, s59, 31
    s_min_u32 s59, s59, 2
    s_add_u32 s6, s6, s60
    s_add_u32 s6, s6, s59
    s_mul_i32 s5, s6, 40
    s_waitcnt lgkmcnt(0)
    s_barrier
    v_and_b32 v0, 63, v0
    s_xor_b32 s3, s3, 8
    v_mov_b32 v3, 160064
    s_mov_b64 s[8:9], s[32:33]
    s_mov_b32 s10, 5120000
    s_mov_b32 s11, 0x20000
    s_mov_b64 s[16:17], s[56:57]
    s_mov_b32 s18, 1441792
    s_mov_b32 s19, 0x20000
    s_mov_b32 s27, 0x20000
    s_mov_b32 s31, 0x20000
    v_mov_b32 v62, 1
    s_cmp_eq_u32 s63, 1
    s_cbranch_scc0 L_notprod
    v_mov_b32 v9, 4
    v_mov_b32 v10, 160192
    v_lshl_add_u32 v11, v0, 4, v10
    v_cmp_gt_u32 vcc, 7232, v5
    v_add_u32 v59, 105600, v5
    s_mul_i32 s58, s2, 10240
    s_mov_b64 s[66:67], vcc
    s_waitcnt vmcnt(3)
    v_mul_u32_u24 v28, 52429, v22
    v_lshrrev_b32 v28, 21, v28
    v_lshl_add_u32 v28, v28, 2, v10
    ds_add_rtn_u32 v34, v28, v9
    v_mul_u32_u24 v29, 52429, v23
    v_lshrrev_b32 v29, 21, v29
    v_lshl_add_u32 v29, v29, 2, v10
    ds_add_rtn_u32 v35, v29, v9
    v_mul_u32_u24 v30, 52429, v24
    v_lshrrev_b32 v30, 21, v30
    v_lshl_add_u32 v30, v30, 2, v10
    ds_add_rtn_u32 v36, v30, v9
    v_mul_u32_u24 v31, 52429, v25
    v_lshrrev_b32 v31, 21, v31
    v_lshl_add_u32 v31, v31, 2, v10
    ds_add_rtn_u32 v37, v31, v9
    s_waitcnt vmcnt(2)
    s_mov_b64 exec, s[66:67]
    v_mul_u32_u24 v32, 52429, v26
    v_lshrrev_b32 v32, 21, v32
    v_lshl_add_u32 v32, v32, 2, v10
    ds_add_rtn_u32 v38, v32, v9
    s_mov_b64 exec, -1
    s_waitcnt lgkmcnt(0)
    s_barrier
    ds_read_b128 v[12:15], v11
    s_waitcnt lgkmcnt(0)
    v_add_u32 v56, v12, v13
    v_add3_u32 v57, v56, v14, v15
    s_nop 1
    v_add_u32_dpp v58, v57, v57 row_shr:1 row_mask:0xf bank_mask:0xf bound_ctrl:1
    s_nop 1
    v_add_u32_dpp v58, v58, v58 row_shr:2 row_mask:0xf bank_mask:0xf bound_ctrl:1
    s_nop 1
    v_add_u32_dpp v58, v58, v58 row_shr:4 row_mask:0xf bank_mask:0xf bound_ctrl:1
    s_nop 1
    v_add_u32_dpp v58, v58, v58 row_shr:8 row_mask:0xf bank_mask:0xf bound_ctrl:1
    s_nop 1
    v_add_u32_dpp v58, v58, v58 row_bcast:15 row_mask:0xa bank_mask:0xf
    s_nop 1
    v_add_u32_dpp v58, v58, v58 row_bcast:31 row_mask:0xc bank_mask:0xf
    v_sub_u32 v64, v58, v57
    v_add_u32 v65, v64, v12
    v_add_u32 v66, v64, v56
    v_add_u32 v67, v66, v14
    ds_write_b128 v11, v[64:67] offset:1024
    ds_read_b32 v40, v28 offset:1024
    ds_read_b32 v41, v29 offset:1024
    ds_read_b32 v42, v30 offset:1024
    ds_read_b32 v43, v31 offset:1024
    s_mov_b64 exec, s[66:67]
    ds_read_b32 v44, v32 offset:1024
    s_mov_b64 exec, -1
    s_mov_b32 s60, 105600
    s_waitcnt vmcnt(0)
    v_lshl_or_b32 v16, v22, 16, v16
    v_lshl_or_b32 v17, v23, 16, v17
    v_lshl_or_b32 v18, v24, 16, v18
    v_lshl_or_b32 v19, v25, 16, v19
    v_lshl_or_b32 v20, v26, 16, v20
    s_waitcnt lgkmcnt(4)
    v_add3_u32 v40, v40, v34, s60
    ds_write_b32 v40, v16
    s_waitcnt lgkmcnt(4)
    v_add3_u32 v41, v41, v35, s60
    ds_write_b32 v41, v17
    s_waitcnt lgkmcnt(4)
    v_add3_u32 v42, v42, v36, s60
    ds_write_b32 v42, v18
    s_waitcnt lgkmcnt(4)
    v_add3_u32 v43, v43, v37, s60
    ds_write_b32 v43, v19
    s_mov_b64 exec, s[66:67]
    s_waitcnt lgkmcnt(4)
    v_add3_u32 v44, v44, v38, s60
    ds_write_b32 v44, v20
    s_mov_b64 exec, -1
    s_waitcnt lgkmcnt(0)
    s_barrier
    ds_read_b128 v[12:15], v59
    ds_read_b128 v[68:71], v59 offset:8192
    s_add_u32 s60, s58, 8192
    s_cmp_ge_u32 s4, 2
    s_waitcnt lgkmcnt(1)
    buffer_store_dwordx4 v[12:15], v5, s[16:19], s58 offen sc1
    s_cbranch_scc1 L_cp1
    s_waitcnt lgkmcnt(0)
    buffer_store_dwordx4 v[68:71], v5, s[16:19], s60 offen sc1
L_cp1:
    s_cmp_eq_u32 s4, 0
    s_cbranch_scc1 L_row
    s_waitcnt vmcnt(0)
    s_mov_b64 exec, 1
    ds_add_u32 v3, v62 offset:56
    s_mov_b64 exec, -1
    s_branch L_preB
L_row:
    s_lshl_b32 s61, s2, 10
    s_add_u32 s61, s61, 1114112
    s_mov_b32 s59, 0
Lw_1:
    ds_read_b32 v4, v3 offset:68
    s_waitcnt lgkmcnt(0)
    v_cmp_gt_u32 vcc, 1, v4
    s_cbranch_vccz Lk_2
    s_add_u32 s59, s59, 1
    s_cmp_lt_u32 s59, 4194304
    s_cbranch_scc1 Lw_1
    s_branch L_end
Lk_2:
    v_readfirstlane_b32 s40, v4
    s_nop 0
    s_bitset0_b32 s40, 0
    v_lshrrev_b32 v64, 2, v64
    v_or_b32 v64, s40, v64
    v_lshrrev_b32 v65, 2, v65
    v_or_b32 v65, s40, v65
    v_lshrrev_b32 v66, 2, v66
    v_or_b32 v66, s40, v66
    v_lshrrev_b32 v67, 2, v67
    v_or_b32 v67, s40, v67
    s_mov_b32 s59, 0
Lw_3:
    ds_read_b32 v4, v3 offset:56
    s_waitcnt lgkmcnt(0)
    v_cmp_gt_u32 vcc, 7, v4
    s_cbranch_vccz Lk_4
    s_add_u32 s59, s59, 1
    s_cmp_lt_u32 s59, 4194304
    s_cbranch_scc1 Lw_3
    s_branch L_end
Lk_4:
    s_waitcnt vmcnt(0)
    buffer_store_dwordx4 v[64:67], v5, s[16:19], s61 offen sc1
    ds_write_b32 v3, v62 offset:32
    s_branch L_preB
L_notprod:
    s_cmp_eq_u32 s63, 0
    s_cbranch_scc1 L_taskw
    v_and_b32 v4, 7, v0
    v_mul_u32_u24 v1, 1056, v4
    v_and_b32 v4, 8, v0
    v_lshl_add_u32 v1, v4, 6, v1
    v_and_b32 v4, 48, v0
    v_add_u32 v1, v4, v1
    v_add_u32 v5, 105600, v1
    s_lshr_b32 s58, s62, 4
    s_and_b32 s59, s62, 7
    s_lshl3_add_u32 s58, s58, s59
    s_bfe_u32 s59, s62, 0x10003
    s_lshl1_add_u32 s58, s58, s59
    s_lshl_b32 s58, s58, 10
    s_add_u32 s58, s58, 720896
    v_lshlrev_b32 v6, 4, v0
    s_waitcnt vmcnt(0)
    s_cmp_eq_u32 s63, 4
    s_cbranch_scc1 L_wtask
    s_cmp_eq_u32 s4, 0
    s_cbranch_scc0 L_taskw
    s_mov_b32 s59, 0
Lw_5:
    ds_read_b32 v4, v3 offset:56
    s_waitcnt lgkmcnt(0)
    v_cmp_gt_u32 vcc, 7, v4
    s_cbranch_vccz Lk_6
    s_add_u32 s59, s59, 1
    s_cmp_lt_u32 s59, 4194304
    s_cbranch_scc1 Lw_5
    s_branch L_end
Lk_6:
    ds_read_b128 v[16:19], v5 offset:0
    ds_read_b128 v[20:23], v5 offset:8448
    ds_read_b128 v[24:27], v5 offset:16896
    ds_read_b128 v[28:31], v5 offset:64
    ds_read_b128 v[32:35], v5 offset:8512
    ds_read_b128 v[36:39], v5 offset:16960
    ds_read_b128 v[40:43], v5 offset:128
    ds_read_b128 v[44:47], v5 offset:8576
    ds_read_b128 v[48:51], v5 offset:17024
    ds_read_b128 v[64:67], v5 offset:192
    ds_read_b128 v[68:71], v5 offset:8640
    ds_read_b128 v[72:75], v5 offset:17088
    s_waitcnt lgkmcnt(9)
    ds_read_b128 v[76:79], v5 offset:256
    ds_read_b128 v[80:83], v5 offset:8704
    ds_read_b128 v[84:87], v5 offset:17152
    v_mfma_f32_16x16x32_bf16 v[8:11], v[16:19], v[24:27], 0
    v_mfma_f32_16x16x32_bf16 v[12:15], v[20:23], v[24:27], 0
    s_waitcnt lgkmcnt(9)
    ds_read_b128 v[88:91], v5 offset:320
    ds_read_b128 v[92:95], v5 offset:8768
    ds_read_b128 v[96:99], v5 offset:17216
    v_mfma_f32_16x16x32_bf16 v[8:11], v[28:31], v[36:39], v[8:11]
    v_mfma_f32_16x16x32_bf16 v[12:15], v[32:35], v[36:39], v[12:15]
    s_waitcnt lgkmcnt(9)
    ds_read_b128 v[100:103], v5 offset:384
    ds_read_b128 v[104:107], v5 offset:8832
    ds_read_b128 v[108:111], v5 offset:17280
    v_mfma_f32_16x16x32_bf16 v[8:11], v[40:43], v[48:51], v[8:11]
    v_mfma_f32_16x16x32_bf16 v[12:15], v[44:47], v[48:51], v[12:15]
    s_waitcnt lgkmcnt(9)
    ds_read_b128 v[112:115], v5 offset:448
    ds_read_b128 v[116:119], v5 offset:8896
    ds_read_b128 v[120:123], v5 offset:17344
    v_mfma_f32_16x16x32_bf16 v[8:11], v[64:67], v[72:75], v[8:11]
    v_mfma_f32_16x16x32_bf16 v[12:15], v[68:71], v[72:75], v[12:15]
    s_waitcnt lgkmcnt(9)
    v_mfma_f32_16x16x32_bf16 v[8:11], v[76:79], v[84:87], v[8:11]
    v_mfma_f32_16x16x32_bf16 v[12:15], v[80:83], v[84:87], v[12:15]
    s_waitcnt lgkmcnt(6)
    v_mfma_f32_16x16x32_bf16 v[8:11], v[88:91], v[96:99], v[8:11]
    v_mfma_f32_16x16x32_bf16 v[12:15], v[92:95], v[96:99], v[12:15]
    s_waitcnt lgkmcnt(3)
    v_mfma_f32_16x16x32_bf16 v[8:11], v[100:103], v[108:111], v[8:11]
    v_mfma_f32_16x16x32_bf16 v[12:15], v[104:107], v[108:111], v[12:15]
    s_waitcnt lgkmcnt(0)
    v_mfma_f32_16x16x32_bf16 v[8:11], v[112:115], v[120:123], v[8:11]
    v_mfma_f32_16x16x32_bf16 v[12:15], v[116:119], v[120:123], v[12:15]
    s_nop 6
    v_cvt_pk_bf16_f32 v16, v8, v9
    v_cvt_pk_bf16_f32 v17, v10, v11
    v_cvt_pk_bf16_f32 v18, v12, v13
    v_cvt_pk_bf16_f32 v19, v14, v15
    buffer_store_dwordx4 v[16:19], v6, s[16:19], s58 offen sc1
    s_branch L_flag
L_wtask:
    s_lshl_b32 s58, s62, 11
    s_add_u32 s58, s58, 851968
    s_mov_b32 s70, 0x05040100
    s_mov_b32 s71, 0x07060302
    v_perm_b32 v64, v17, v16, s70
    v_perm_b32 v68, v17, v16, s71
    v_perm_b32 v65, v19, v18, s70
    v_perm_b32 v69, v19, v18, s71
    v_perm_b32 v66, v21, v20, s70
    v_perm_b32 v70, v21, v20, s71
    v_perm_b32 v67, v23, v22, s70
    v_perm_b32 v71, v23, v22, s71
    buffer_store_dwordx4 v[64:67], v6, s[16:19], s58 offen sc1
    buffer_store_dwordx4 v[68:71], v6, s[16:19], s58 offen offset:1024 sc1
    s_cmp_eq_u32 s4, 0
    s_cbranch_scc1 L_flag
    s_waitcnt vmcnt(0)
L_taskw:
    s_mov_b64 exec, 1
    ds_add_u32 v3, v62 offset:56
    s_mov_b64 exec, -1
    s_branch L_preB
L_flag:
    s_mov_b32 s59, 0
Lw_7:
    ds_read_b32 v4, v3 offset:68
    s_waitcnt lgkmcnt(0)
    v_cmp_gt_u32 vcc, 1, v4
    s_cbranch_vccz Lk_8
    s_add_u32 s59, s59, 1
    s_cmp_lt_u32 s59, 4194304
    s_cbranch_scc1 Lw_7
    s_branch L_end
Lk_8:
    v_readfirstlane_b32 s40, v4
    s_nop 0
    s_bitset0_b32 s40, 0
    s_mul_i32 s61, s2, 16
    s_add_u32 s61, s61, 1178624
    v_mov_b32 v10, s40
    v_mov_b32 v11, s40
    v_lshlrev_b32 v9, 15, v0
    s_mov_b32 s59, 0
Lw_9:
    ds_read_b32 v4, v3 offset:56
    s_waitcnt lgkmcnt(0)
    v_cmp_gt_u32 vcc, 7, v4
    s_cbranch_vccz Lk_10
    s_add_u32 s59, s59, 1
    s_cmp_lt_u32 s59, 4194304
    s_cbranch_scc1 Lw_9
    s_branch L_end
Lk_10:
    s_waitcnt vmcnt(0)
    s_mov_b64 exec, 255
    buffer_store_dwordx2 v[10:11], v9, s[16:19], s61 offen sc1
    ds_write_b32 v3, v62 offset:32
    s_mov_b64 exec, -1
L_preB:
    s_setprio 3
    s_mov_b64 s[28:29], s[42:43]
    s_mov_b32 s30, 20000
    s_lshl_b32 s58, s4, 10
    v_lshlrev_b32 v5, 4, v0
    s_add_u32 m0, s58, 130944
    s_add_u32 s59, s58, 0
    buffer_load_dwordx4 v5, s[28:31], s59 offen lds
    s_add_u32 m0, s58, 139136
    s_add_u32 s59, s58, 8192
    buffer_load_dwordx4 v5, s[28:31], s59 offen lds
    s_cmp_lt_u32 s4, 4
    s_cbranch_scc1 L_disd
    s_add_u32 m0, s58, 143232
    s_add_u32 s59, s58, 12288
    buffer_load_dwordx4 v5, s[28:31], s59 offen lds
L_disd:
    s_mov_b64 s[24:25], s[44:45]
    s_mov_b32 s26, 131072
    s_setprio 1
    s_lshl_b32 s58, s4, 10
    s_mov_b32 s41, 0
    buffer_load_dwordx4 v[96:99], v5, s[24:27], s58 offen
    s_add_u32 s58, s58, 8192
    buffer_load_dwordx4 v[100:103], v5, s[24:27], s58 offen
    s_add_u32 s58, s58, 8192
    buffer_load_dwordx4 v[104:107], v5, s[24:27], s58 offen
    s_add_u32 s58, s58, 8192
    buffer_load_dwordx4 v[108:111], v5, s[24:27], s58 offen
    s_add_u32 s58, s58, 8192
    buffer_load_dwordx4 v[112:115], v5, s[24:27], s58 offen
    s_add_u32 s58, s58, 8192
    buffer_load_dwordx4 v[116:119], v5, s[24:27], s58 offen
    s_add_u32 s58, s58, 8192
    buffer_load_dwordx4 v[120:123], v5, s[24:27], s58 offen
    s_add_u32 s58, s58, 8192
    buffer_load_dwordx4 v[124:127], v5, s[24:27], s58 offen
    s_setprio 3
    v_and_b32 v4, 3, v0
    v_mov_b32 v5, 0x0c0c0c0c
    v_mov_b32 v6, 0x0c0c0302
    v_mov_b32 v7, 0x03020c0c
    v_cmp_eq_u32 s[58:59], 0, v4
    v_cmp_eq_u32 s[60:61], 2, v4
    v_cmp_eq_u32 vcc, 1, v4
    v_cndmask_b32 v10, v5, v6, s[58:59]
    v_cndmask_b32 v11, v5, v6, s[60:61]
    v_cndmask_b32 v10, v10, v7, vcc
    v_cmp_eq_u32 vcc, 3, v4
    s_nop 1
    v_cndmask_b32 v11, v11, v7, vcc
    v_and_b32 v10, 0xfdfdfdfd, v10
    v_and_b32 v11, 0xfdfdfdfd, v11
    s_movk_i32 s7, 512
    s_lshl_b32 s58, s4, 3
    v_lshrrev_b32 v5, 3, v0
    v_and_b32 v6, 7, v0
    v_add_u32 v7, s58, v5
    v_mul_u32_u24 v49, 10240, v7
    v_lshl_add_u32 v49, v6, 4, v49
    v_lshlrev_b32 v56, 2, v6
    s_lshl_b32 s60, s6, 2
    s_add_u32 s60, s60, 1114112
    v_lshl_add_u32 v54, v7, 10, s60
    v_mad_u32_u24 v7, v7, 3, v6
    v_cmp_ge_u32 vcc, 186, v7
    v_cmp_gt_u32 s[64:65], 4, v6
    v_mul_u32_u24 v7, 16, v7
    s_and_b64 s[64:65], s[64:65], vcc
    v_cmp_eq_u32 vcc, 0, v6
    s_and_b32 s58, s2, 7
    s_lshl_b32 s58, s58, 15
    s_add_u32 s58, s58, 1179632
    v_add_u32 v7, s58, v7
    s_or_b64 s[64:65], s[64:65], vcc
    v_cndmask_b32 v54, v7, v54, vcc
    v_cmp_gt_u32 s[62:63], 5, v6
    v_lshl_add_u32 v50, v6, 3, v5
    v_mul_u32_u24 v55, 80, v5
    v_add_u32 v55, 80, v55
    v_lshrrev_b32 v5, 4, v50
    v_mul_u32_u24 v9, 8448, v5
    v_lshl_add_u32 v9, v5, 26, v9
    v_cmp_le_u32 vcc, 32, v50
    v_and_b32 v5, 7, v50
    v_and_b32 v6, 3, v50
    v_cndmask_b32 v5, v5, v6, vcc
    v_mul_u32_u24 v5, 1056, v5
    v_bfe_u32 v6, v50, 3, 1
    v_bfe_u32 v7, v50, 2, 1
    v_cndmask_b32 v6, v6, v7, vcc
    v_lshl_add_u32 v5, v6, 9, v5
    v_mov_b32 v52, 130944
    v_add3_u32 v9, v9, v5, v52
    v_lshrrev_b32 v5, 5, v0
    v_lshl_add_u32 v15, v5, 3, v2
    s_lshl_b32 s58, s5, 2
    s_sub_u32 s58, 159744, s58
    v_mov_b32 v53, s58
    v_add_u32 v5, s5, v50
    v_lshl_add_u32 v8, v5, 1, v52
    v_lshlrev_b32 v50, 2, v50
    v_add_u32 v50, 159744, v50
    v_and_b32 v74, 0x1e0, v2
    v_and_b32 v5, 24, v15
    v_lshrrev_b32 v5, 1, v5
    v_add_u32 v74, v74, v5
    v_mov_b32 v57, 157184
    v_mov_b32 v60, 152064
    v_mov_b64 v[16:17], 0
    v_mov_b64 v[18:19], 0
    s_mov_b32 s59, 0
Lw_11:
    ds_read_b32 v4, v3 offset:32
    s_waitcnt lgkmcnt(0)
    v_cmp_gt_u32 vcc, 1, v4
    s_cbranch_vccz Lk_12
    s_sleep 2
    s_add_u32 s59, s59, 1
    s_cmp_lt_u32 s59, 4194304
    s_cbranch_scc1 Lw_11
    s_branch L_end
Lk_12:
    s_mov_b32 s59, 0
Lw_13:
    ds_read_b32 v4, v3 offset:68
    s_waitcnt lgkmcnt(0)
    v_cmp_gt_u32 vcc, 1, v4
    s_cbranch_vccz Lk_14
    s_add_u32 s59, s59, 1
    s_cmp_lt_u32 s59, 4194304
    s_cbranch_scc1 Lw_13
    s_branch L_end
Lk_14:
    v_readfirstlane_b32 s40, v4
    s_nop 0
    s_bitset0_b32 s40, 0
    s_mov_b32 s59, 0
Lw_15:
    ds_read_b32 v4, v3 offset:60
    s_waitcnt lgkmcnt(0)
    v_cmp_gt_u32 vcc, 8, v4
    s_cbranch_vccz Lk_16
    s_sleep 2
    s_add_u32 s59, s59, 1
    s_cmp_lt_u32 s59, 4194304
    s_cbranch_scc1 Lw_15
    s_branch L_end
Lk_16:
    s_mov_b32 s59, 0
    s_and_b32 exec_lo, s64, 0xfefefefe
    s_and_b32 exec_hi, s65, 0xfefefefe
L_spolla:
    buffer_load_dwordx2 v[58:59], v54, s[16:19], 0 offen sc1
    s_add_u32 s59, s59, 1
    s_cmp_gt_u32 s59, 0x40000
    s_cbranch_scc1 L_end
    s_waitcnt vmcnt(0)
    v_xor_b32 v58, s40, v58
    v_xor_b32 v59, s40, v59
    v_or_b32 v5, v58, v59
    v_cmpx_lt_u32 vcc, 4095, v5
    s_cbranch_execz L_soka
    s_sleep 8
    s_branch L_spolla
L_soka:
    s_mov_b64 exec, -1
    s_mov_b64 exec, 1
    ds_add_u32 v3, v62 offset:52
    s_mov_b64 exec, -1
    s_mov_b32 exec_lo, 0x01010101
    s_mov_b32 exec_hi, 0x01010101
L_spollb:
    buffer_load_dwordx2 v[58:59], v54, s[16:19], 0 offen sc1
    s_add_u32 s59, s59, 1
    s_cmp_gt_u32 s59, 0x40000
    s_cbranch_scc1 L_end
    s_waitcnt vmcnt(0)
    v_xor_b32 v58, s40, v58
    v_xor_b32 v59, s40, v59
    v_or_b32 v5, v58, v59
    v_cmpx_lt_u32 vcc, 4095, v5
    s_cbranch_execz L_sokb
    s_sleep 8
    s_branch L_spollb
L_sokb:
    s_mov_b64 exec, -1
    v_sub_u32 v48, v59, v58
    v_lshl_or_b32 v48, v48, 16, v58
    s_nop 1
    v_mov_b32_dpp v48, v48 quad_perm:[0,0,0,0] row_mask:0xf bank_mask:0xf
    s_nop 1
    v_mov_b32_dpp v48, v48 row_shr:4 row_mask:0xf bank_mask:0xa
    v_mad_u32_u16 v49, v48, 4, v49
    v_lshrrev_b32 v48, 16, v48
    v_sub_u32 v48, v48, v56
    v_cmpx_lt_i32 vcc, 0, v48
    s_cbranch_execz L_entld
    buffer_load_dwordx4 v[16:19], v49, s[16:19], 0 offen sc1
    v_cmpx_lt_i32 vcc, 32, v48
    ds_write_b32 v3, v62 offset:28
L_entld:
    s_mov_b64 exec, -1
    s_waitcnt vmcnt(0)
    v_cmpx_lt_i32 vcc, 0, v48
    v_mad_u32_u16 v24, v16, 4, v53 op_sel:[1,0,0,0]
    ds_add_rtn_u32 v32, v24, v62
    v_cmpx_lt_i32 vcc, 1, v48
    v_mad_u32_u16 v25, v17, 4, v53 op_sel:[1,0,0,0]
    ds_add_rtn_u32 v33, v25, v62
    v_cmpx_lt_i32 vcc, 2, v48
    v_mad_u32_u16 v26, v18, 4, v53 op_sel:[1,0,0,0]
    ds_add_rtn_u32 v34, v26, v62
    v_cmpx_lt_i32 vcc, 3, v48
    v_mad_u32_u16 v27, v19, 4, v53 op_sel:[1,0,0,0]
    ds_add_rtn_u32 v35, v27, v62
    s_mov_b64 exec, -1
    s_mov_b64 exec, 1
    ds_add_u32 v3, v62 offset:12
    s_mov_b64 exec, -1
    v_mad_u32_u16 v40, v16, 2, v52
    v_mad_u32_u16 v16, v16, s7, 0
    v_mad_u32_u16 v41, v17, 2, v52
    v_mad_u32_u16 v17, v17, s7, 0
    v_mad_u32_u16 v42, v18, 2, v52
    v_mad_u32_u16 v18, v18, s7, 0
    v_mad_u32_u16 v43, v19, 2, v52
    v_mad_u32_u16 v19, v19, s7, 0
    s_mov_b32 s59, 0
Lw_17:
    ds_read_b32 v4, v3 offset:12
    s_waitcnt lgkmcnt(0)
    v_cmp_gt_u32 vcc, 8, v4
    s_cbranch_vccz Lk_18
    s_add_u32 s59, s59, 1
    s_cmp_lt_u32 s59, 4194304
    s_cbranch_scc1 Lw_17
    s_branch L_end
Lk_18:
    ds_read_b32 v12, v50
    ds_read_b32 v5, v3 offset:28
    ds_read_u16 v8, v8
    ds_read_u16 v40, v40
    ds_read_u16 v41, v41
    ds_read_u16 v42, v42
    ds_read_u16 v43, v43
    s_lshl_b32 s58, s2, 4
    s_add_u32 s58, s58, s3
    s_cmp_eq_u32 s58, 15
    s_cbranch_scc0 L_noep
    v_mov_b32 v6, s40
    v_mov_b32 v7, 655616
    s_mov_b64 exec, 1
    buffer_store_dword v6, v7, s[16:19], 0 offen sc1
    s_mov_b64 exec, -1
L_noep:
    s_waitcnt lgkmcnt(6)
    v_add_u32 v12, 1, v12
    v_lshrrev_b32 v12, 1, v12
    v_max_u32 v12, 1, v12
    v_cndmask_b32 v12, 0, v12, s[62:63]
    s_lshl_b32 s67, s4, 3
    s_movk_i32 s58, 2560
    v_add_u32_dpp v51, v12, v12 row_shl:1 row_mask:0xf bank_mask:0xf bound_ctrl:1
    s_nop 1
    v_add_u32_dpp v51, v51, v51 row_shl:2 row_mask:0xf bank_mask:0xf bound_ctrl:1
    s_nop 1
    v_add_u32_dpp v51, v12, v51 row_shl:4 row_mask:0xf bank_mask:0x5 bound_ctrl:1
    s_waitcnt lgkmcnt(0)
    v_lshlrev_b32 v8, 16, v8
    v_lshl_add_u32 v5, v5, 10, v51
    v_sub_u32 v6, v55, v51
    v_cmp_le_u32 vcc, 80, v5
    v_lshlrev_b32 v6, 1, v6
    v_subrev_u32 v12, 1, v12
    s_cbranch_vccnz L_slow
    v_and_b32 v12, 0xff, v12
    v_lshl_add_u32 v9, v12, 18, v9
    s_mov_b64 exec, s[62:63]
    ds_write_b32 v50, v6 offset:160
    s_mov_b64 exec, -1
    s_sub_u32 s63, s67, 1
    v_readlane_b32 s67, v51, s67
    v_cmpx_lt_i32 vcc, 0, v48
    ds_read_b32 v24, v24 offset:160
    v_cmpx_lt_i32 vcc, 1, v48
    ds_read_b32 v25, v25 offset:160
    v_cmpx_lt_i32 vcc, 2, v48
    ds_read_b32 v26, v26 offset:160
    v_cmpx_lt_i32 vcc, 3, v48
    ds_read_b32 v27, v27 offset:160
    s_mov_b64 exec, -1
    s_lshr_b32 s66, s67, 3
    s_add_u32 s60, s66, 1
    s_lshl_b32 s60, s60, 3
    s_sub_u32 s67, s60, s67
    s_sub_u32 s62, s67, 1
    s_add_u32 s61, s4, 1
    s_mul_i32 s61, s61, 80
    s_sub_u32 s60, s61, s60
    s_lshl_b32 s60, s60, 2
    s_waitcnt lgkmcnt(0)
    v_cmpx_lt_i32 vcc, 0, v48
    v_add_u32 v24, v24, v32
    v_lshl_add_u32 v5, v24, 1, v57
    ds_write_b16 v5, v40
    v_lshrrev_b32 v6, 1, v24
    v_lshl_add_u32 v6, v6, 2, v60
    v_and_b32 v7, 1, v24
    v_mad_u32_u24 v6, v7, s58, v6
    ds_write_b32 v6, v16
    v_cmpx_lt_i32 vcc, 1, v48
    v_add_u32 v25, v25, v33
    v_lshl_add_u32 v5, v25, 1, v57
    ds_write_b16 v5, v41
    v_lshrrev_b32 v6, 1, v25
    v_lshl_add_u32 v6, v6, 2, v60
    v_and_b32 v7, 1, v25
    v_mad_u32_u24 v6, v7, s58, v6
    ds_write_b32 v6, v17
    v_cmpx_lt_i32 vcc, 2, v48
    v_add_u32 v26, v26, v34
    v_lshl_add_u32 v5, v26, 1, v57
    ds_write_b16 v5, v42
    v_lshrrev_b32 v6, 1, v26
    v_lshl_add_u32 v6, v6, 2, v60
    v_and_b32 v7, 1, v26
    v_mad_u32_u24 v6, v7, s58, v6
    ds_write_b32 v6, v18
    v_cmpx_lt_i32 vcc, 3, v48
    v_add_u32 v27, v27, v35
    v_lshl_add_u32 v5, v27, 1, v57
    ds_write_b16 v5, v43
    v_lshrrev_b32 v6, 1, v27
    v_lshl_add_u32 v6, v6, 2, v60
    v_and_b32 v7, 1, v27
    v_mad_u32_u24 v6, v7, s58, v6
    ds_write_b32 v6, v19
    s_mov_b64 exec, -1
    s_mov_b64 exec, 1
    ds_add_u32 v3, v62 offset:16
    s_mov_b64 exec, -1
    v_lshrrev_b32 v5, 5, v0
    v_mad_u32_u24 v13, v5, s58, v60
    v_add_u32 v13, s60, v13
    v_lshl_add_u32 v14, v5, 1, v57
    v_and_b32 v5, 28, v0
    v_add3_u32 v14, v14, v5, s60
    s_mov_b32 s65, 201486784
    s_mov_b32 s64, 0
    s_mov_b32 s59, 0
Lw_19:
    ds_read_b32 v4, v3 offset:16
    s_waitcnt lgkmcnt(0)
    v_cmp_gt_u32 vcc, 8, v4
    s_cbranch_vccz Lk_20
    s_add_u32 s59, s59, 1
    s_cmp_lt_u32 s59, 4194304
    s_cbranch_scc1 Lw_19
    s_branch L_end
Lk_20:
    v_mov_b32 v12, v3
    v_mov_b32 v3, v2
    s_setprio 1
    s_cmp_lt_u32 s4, 4
    s_cbranch_scc1 L_old
    s_setprio 2
L_old:
    s_mov_b64 vcc, 0
    ds_read_b128 v[64:67], v13 offset:0
    ds_read_b128 v[68:71], v13 offset:16
    ds_read_u16 v1, v14
    ds_read_b128 v[48:51], v13 offset:32
    ds_read_b128 v[52:55], v13 offset:48
    s_waitcnt lgkmcnt(3)
L_p0:
    s_cmp_ge_u32 s67, 4
    s_cbranch_scc1 L_p4
    s_cmp_gt_u32 s67, 1
    s_cbranch_scc1 Lps_21
    v_add_u32 v65, v65, v2
    buffer_load_dwordx4 v[20:23], v65, s[8:11], 0 offen
Lps_21:
    s_cmp_gt_u32 s67, 2
    s_cbranch_scc1 Lps_22
    v_add_u32 v66, v66, v2
    buffer_load_dwordx4 v[24:27], v66, s[8:11], 0 offen
Lps_22:
    s_cmp_gt_u32 s67, 3
    s_cbranch_scc1 Lps_23
    v_add_u32 v67, v67, v2
    buffer_load_dwordx4 v[28:31], v67, s[8:11], 0 offen
Lps_23:
L_p4:
    s_cmp_gt_u32 s67, 4
    s_cbranch_scc1 Lps_24
    v_add_u32 v68, v68, v2
    buffer_load_dwordx4 v[32:35], v68, s[8:11], 0 offen
Lps_24:
    s_cmp_gt_u32 s67, 5
    s_cbranch_scc1 Lps_25
    v_add_u32 v69, v69, v2
    buffer_load_dwordx4 v[36:39], v69, s[8:11], 0 offen
Lps_25:
    s_cmp_gt_u32 s67, 6
    s_cbranch_scc1 Lps_26
    v_add_u32 v70, v70, v2
    buffer_load_dwordx4 v[40:43], v70, s[8:11], 0 offen
Lps_26:
    s_cmp_gt_u32 s67, 7
    s_cbranch_scc1 Lps_27
    v_add_u32 v71, v71, v2
    buffer_load_dwordx4 v[44:47], v71, s[8:11], 0 offen
Lps_27:
    s_cmp_eq_u32 s66, 0
    s_cbranch_scc1 L_drain
L_gl:
    s_cmp_le_u32 s66, 4
    s_cbranch_scc1 L_dm0
L_dm0b:
    s_waitcnt lgkmcnt(1)
    v_perm_b32 v6, v1, v1, v10
    v_perm_b32 v7, v1, v1, v11
    ds_read_u16 v1, v14 offset:32
    s_waitcnt vmcnt(6)
    v_lshl_add_u64 v[4:5], v[48:49], 0, v[2:3]
    s_sub_u32 s62, s62, 2
    s_cbranch_scc1 Lfs_0
    v_mfma_f32_4x4x4_16b_bf16 v[56:59], v[6:7], v[16:17], v[56:59] cbsz:3 abid:0
    v_mfma_f32_4x4x4_16b_bf16 v[60:63], v[6:7], v[18:19], v[60:63] cbsz:3 abid:0
    buffer_load_dwordx4 v[16:19], v4, s[8:11], 0 offen
    v_mfma_f32_4x4x4_16b_bf16 v[56:59], v[6:7], v[20:21], v[56:59] cbsz:3 abid:1
    v_mfma_f32_4x4x4_16b_bf16 v[60:63], v[6:7], v[22:23], v[60:63] cbsz:3 abid:1
    buffer_load_dwordx4 v[20:23], v5, s[8:11], 0 offen
Lbs_0:
    s_cbranch_vccnz Ldm_0
Ldb_0:
    s_waitcnt vmcnt(6)
    v_lshl_add_u64 v[4:5], v[50:51], 0, v[2:3]
    s_sub_u32 s62, s62, 2
    s_cbranch_scc1 Lfs_2
    v_mfma_f32_4x4x4_16b_bf16 v[56:59], v[6:7], v[24:25], v[56:59] cbsz:3 abid:2
    v_mfma_f32_4x4x4_16b_bf16 v[60:63], v[6:7], v[26:27], v[60:63] cbsz:3 abid:2
    buffer_load_dwordx4 v[24:27], v4, s[8:11], 0 offen
    v_mfma_f32_4x4x4_16b_bf16 v[56:59], v[6:7], v[28:29], v[56:59] cbsz:3 abid:3
    v_mfma_f32_4x4x4_16b_bf16 v[60:63], v[6:7], v[30:31], v[60:63] cbsz:3 abid:3
    buffer_load_dwordx4 v[28:31], v5, s[8:11], 0 offen
Lbs_2:
    s_cbranch_vccnz Ldm_2
Ldb_2:
    ds_read_b128 v[48:51], v13 offset:64
    s_waitcnt vmcnt(6) lgkmcnt(2)
    v_lshl_add_u64 v[4:5], v[52:53], 0, v[2:3]
    s_sub_u32 s62, s62, 2
    s_cbranch_scc1 Lfs_4
    v_mfma_f32_4x4x4_16b_bf16 v[56:59], v[6:7], v[32:33], v[56:59] cbsz:3 abid:4
    v_mfma_f32_4x4x4_16b_bf16 v[60:63], v[6:7], v[34:35], v[60:63] cbsz:3 abid:4
    buffer_load_dwordx4 v[32:35], v4, s[8:11], 0 offen
    v_mfma_f32_4x4x4_16b_bf16 v[56:59], v[6:7], v[36:37], v[56:59] cbsz:3 abid:5
    v_mfma_f32_4x4x4_16b_bf16 v[60:63], v[6:7], v[38:39], v[60:63] cbsz:3 abid:5
    buffer_load_dwordx4 v[36:39], v5, s[8:11], 0 offen
Lbs_4:
    s_cbranch_vccnz Ldm_4
Ldb_4:
    s_waitcnt vmcnt(6)
    v_lshl_add_u64 v[4:5], v[54:55], 0, v[2:3]
    s_sub_u32 s62, s62, 2
    s_cbranch_scc1 Lfs_6
    v_mfma_f32_4x4x4_16b_bf16 v[56:59], v[6:7], v[40:41], v[56:59] cbsz:3 abid:6
    v_mfma_f32_4x4x4_16b_bf16 v[60:63], v[6:7], v[42:43], v[60:63] cbsz:3 abid:6
    buffer_load_dwordx4 v[40:43], v4, s[8:11], 0 offen
    v_mfma_f32_4x4x4_16b_bf16 v[56:59], v[6:7], v[44:45], v[56:59] cbsz:3 abid:7
    v_mfma_f32_4x4x4_16b_bf16 v[60:63], v[6:7], v[46:47], v[60:63] cbsz:3 abid:7
    buffer_load_dwordx4 v[44:47], v5, s[8:11], 0 offen
Lbs_6:
    s_cbranch_vccnz Ldm_6
Ldb_6:
    ds_read_b128 v[52:55], v13 offset:80
    v_add_u32 v13, 32, v13
    v_add_u32 v14, 32, v14
    s_sub_u32 s66, s66, 1
    s_cmp_eq_u32 s66, 3
    s_cbranch_scc0 L_nf
    s_setprio 1
L_nf:
    s_cmp_lg_u32 s66, 0
    s_cbranch_scc1 L_gl
L_drain:
    s_waitcnt lgkmcnt(0)
    v_perm_b32 v6, v1, v1, v10
    v_perm_b32 v7, v1, v1, v11
    ds_read_u16 v1, v14 offset:32
    s_waitcnt vmcnt(7)
    v_mfma_f32_4x4x4_16b_bf16 v[56:59], v[6:7], v[16:17], v[56:59] cbsz:3 abid:0
    v_mfma_f32_4x4x4_16b_bf16 v[60:63], v[6:7], v[18:19], v[60:63] cbsz:3 abid:0
    s_sub_u32 s62, s62, 1
    s_cbranch_scc1 Lfd_0
Lbd_0:
    s_waitcnt vmcnt(6)
    v_mfma_f32_4x4x4_16b_bf16 v[56:59], v[6:7], v[20:21], v[56:59] cbsz:3 abid:1
    v_mfma_f32_4x4x4_16b_bf16 v[60:63], v[6:7], v[22:23], v[60:63] cbsz:3 abid:1
    s_sub_u32 s62, s62, 1
    s_cbranch_scc1 Lfd_1
Lbd_1:
    s_waitcnt vmcnt(5)
    v_mfma_f32_4x4x4_16b_bf16 v[56:59], v[6:7], v[24:25], v[56:59] cbsz:3 abid:2
    v_mfma_f32_4x4x4_16b_bf16 v[60:63], v[6:7], v[26:27], v[60:63] cbsz:3 abid:2
    s_sub_u32 s62, s62, 1
    s_cbranch_scc1 Lfd_2
Lbd_2:
    s_waitcnt vmcnt(4)
    v_mfma_f32_4x4x4_16b_bf16 v[56:59], v[6:7], v[28:29], v[56:59] cbsz:3 abid:3
    v_mfma_f32_4x4x4_16b_bf16 v[60:63], v[6:7], v[30:31], v[60:63] cbsz:3 abid:3
    s_sub_u32 s62, s62, 1
    s_cbranch_scc1 Lfd_3
Lbd_3:
    s_waitcnt vmcnt(3)
    v_mfma_f32_4x4x4_16b_bf16 v[56:59], v[6:7], v[32:33], v[56:59] cbsz:3 abid:4
    v_mfma_f32_4x4x4_16b_bf16 v[60:63], v[6:7], v[34:35], v[60:63] cbsz:3 abid:4
    s_sub_u32 s62, s62, 1
    s_cbranch_scc1 Lfd_4
Lbd_4:
    s_waitcnt vmcnt(2)
    v_mfma_f32_4x4x4_16b_bf16 v[56:59], v[6:7], v[36:37], v[56:59] cbsz:3 abid:5
    v_mfma_f32_4x4x4_16b_bf16 v[60:63], v[6:7], v[38:39], v[60:63] cbsz:3 abid:5
    s_sub_u32 s62, s62, 1
    s_cbranch_scc1 Lfd_5
Lbd_5:
    s_waitcnt vmcnt(1)
    v_mfma_f32_4x4x4_16b_bf16 v[56:59], v[6:7], v[40:41], v[56:59] cbsz:3 abid:6
    v_mfma_f32_4x4x4_16b_bf16 v[60:63], v[6:7], v[42:43], v[60:63] cbsz:3 abid:6
    s_sub_u32 s62, s62, 1
    s_cbranch_scc1 Lfd_6
Lbd_6:
    s_waitcnt vmcnt(0)
    v_mfma_f32_4x4x4_16b_bf16 v[56:59], v[6:7], v[44:45], v[56:59] cbsz:3 abid:7
    v_mfma_f32_4x4x4_16b_bf16 v[60:63], v[6:7], v[46:47], v[60:63] cbsz:3 abid:7
    s_nop 1
    s_call_b64 s[68:69], L_flush
L_gdone:
    s_cmp_eq_u32 s41, 0
    s_cbranch_scc0 L_dd
    s_mov_b32 s59, 0
Lw_28:
    ds_read_b32 v4, v12 offset:24
    s_waitcnt lgkmcnt(0)
    v_cmp_gt_u32 vcc, 8, v4
    s_cbranch_vccz Lk_29
    s_sleep 2
    s_add_u32 s59, s59, 1
    s_cmp_lt_u32 s59, 4194304
    s_cbranch_scc1 Lw_28
    s_branch L_end
Lk_29:
    s_lshl_b32 s58, s4, 10
    v_lshl_add_u32 v72, v0, 4, s58
    s_and_b32 s58, s4, 4
    v_lshl_add_u32 v73, s58, 4, v72
    s_movk_i32 s58, 0x1f0
    v_bfi_b32 v72, s58, v73, v72
    ds_write_b128 v72, v[96:99] offset:0
    ds_write_b128 v72, v[100:103] offset:8192
    ds_write_b128 v72, v[104:107] offset:16384
    ds_write_b128 v72, v[108:111] offset:24576
    ds_write_b128 v72, v[112:115] offset:32768
    ds_write_b128 v72, v[116:119] offset:40960
    ds_write_b128 v72, v[120:123] offset:49152
    ds_write_b128 v72, v[124:127] offset:57344
    s_mov_b64 exec, 1
    ds_inc_u32 v12, v12 offset:64
    s_mov_b64 exec, -1
L_dd:
    s_endpgm
Lfs_0:
    s_add_u32 s62, s62, 2
    v_mfma_f32_4x4x4_16b_bf16 v[56:59], v[6:7], v[16:17], v[56:59] cbsz:3 abid:0
    v_mfma_f32_4x4x4_16b_bf16 v[60:63], v[6:7], v[18:19], v[60:63] cbsz:3 abid:0
    buffer_load_dwordx4 v[16:19], v4, s[8:11], 0 offen
    s_sub_u32 s62, s62, 1
    s_cbranch_scc0 Lsk_30
    s_call_b64 s[68:69], L_flush
Lsk_30:
    v_mfma_f32_4x4x4_16b_bf16 v[56:59], v[6:7], v[20:21], v[56:59] cbsz:3 abid:1
    v_mfma_f32_4x4x4_16b_bf16 v[60:63], v[6:7], v[22:23], v[60:63] cbsz:3 abid:1
    buffer_load_dwordx4 v[20:23], v5, s[8:11], 0 offen
    s_sub_u32 s62, s62, 1
    s_cbranch_scc0 Lbs_0
    s_call_b64 s[68:69], L_flush
    s_branch Lbs_0
Lfs_2:
    s_add_u32 s62, s62, 2
    v_mfma_f32_4x4x4_16b_bf16 v[56:59], v[6:7], v[24:25], v[56:59] cbsz:3 abid:2
    v_mfma_f32_4x4x4_16b_bf16 v[60:63], v[6:7], v[26:27], v[60:63] cbsz:3 abid:2
    buffer_load_dwordx4 v[24:27], v4, s[8:11], 0 offen
    s_sub_u32 s62, s62, 1
    s_cbranch_scc0 Lsk_32
    s_call_b64 s[68:69], L_flush
Lsk_32:
    v_mfma_f32_4x4x4_16b_bf16 v[56:59], v[6:7], v[28:29], v[56:59] cbsz:3 abid:3
    v_mfma_f32_4x4x4_16b_bf16 v[60:63], v[6:7], v[30:31], v[60:63] cbsz:3 abid:3
    buffer_load_dwordx4 v[28:31], v5, s[8:11], 0 offen
    s_sub_u32 s62, s62, 1
    s_cbranch_scc0 Lbs_2
    s_call_b64 s[68:69], L_flush
    s_branch Lbs_2
Lfs_4:
    s_add_u32 s62, s62, 2
    v_mfma_f32_4x4x4_16b_bf16 v[56:59], v[6:7], v[32:33], v[56:59] cbsz:3 abid:4
    v_mfma_f32_4x4x4_16b_bf16 v[60:63], v[6:7], v[34:35], v[60:63] cbsz:3 abid:4
    buffer_load_dwordx4 v[32:35], v4, s[8:11], 0 offen
    s_sub_u32 s62, s62, 1
    s_cbranch_scc0 Lsk_34
    s_call_b64 s[68:69], L_flush
Lsk_34:
    v_mfma_f32_4x4x4_16b_bf16 v[56:59], v[6:7], v[36:37], v[56:59] cbsz:3 abid:5
    v_mfma_f32_4x4x4_16b_bf16 v[60:63], v[6:7], v[38:39], v[60:63] cbsz:3 abid:5
    buffer_load_dwordx4 v[36:39], v5, s[8:11], 0 offen
    s_sub_u32 s62, s62, 1
    s_cbranch_scc0 Lbs_4
    s_call_b64 s[68:69], L_flush
    s_branch Lbs_4
Lfs_6:
    s_add_u32 s62, s62, 2
    v_mfma_f32_4x4x4_16b_bf16 v[56:59], v[6:7], v[40:41], v[56:59] cbsz:3 abid:6
    v_mfma_f32_4x4x4_16b_bf16 v[60:63], v[6:7], v[42:43], v[60:63] cbsz:3 abid:6
    buffer_load_dwordx4 v[40:43], v4, s[8:11], 0 offen
    s_sub_u32 s62, s62, 1
    s_cbranch_scc0 Lsk_36
    s_call_b64 s[68:69], L_flush
Lsk_36:
    v_mfma_f32_4x4x4_16b_bf16 v[56:59], v[6:7], v[44:45], v[56:59] cbsz:3 abid:7
    v_mfma_f32_4x4x4_16b_bf16 v[60:63], v[6:7], v[46:47], v[60:63] cbsz:3 abid:7
    buffer_load_dwordx4 v[44:47], v5, s[8:11], 0 offen
    s_sub_u32 s62, s62, 1
    s_cbranch_scc0 Lbs_6
    s_call_b64 s[68:69], L_flush
    s_branch Lbs_6
Lfd_0:
    s_call_b64 s[68:69], L_flush
    s_branch Lbd_0
Lfd_1:
    s_call_b64 s[68:69], L_flush
    s_branch Lbd_1
Lfd_2:
    s_call_b64 s[68:69], L_flush
    s_branch Lbd_2
Lfd_3:
    s_call_b64 s[68:69], L_flush
    s_branch Lbd_3
Lfd_4:
    s_call_b64 s[68:69], L_flush
    s_branch Lbd_4
Lfd_5:
    s_call_b64 s[68:69], L_flush
    s_branch Lbd_5
Lfd_6:
    s_call_b64 s[68:69], L_flush
    s_branch Lbd_6
L_dm0:
    s_mov_b64 vcc, 0
    s_cmp_eq_u32 s41, 0
    s_cbranch_scc0 L_dm0b
    ds_read_b32 v4, v12 offset:24
    s_waitcnt lgkmcnt(0)
    v_cmp_le_u32 vcc, 8, v4
    s_cbranch_vccz L_dm0b
    s_lshl_b32 s58, s4, 10
    v_lshl_add_u32 v72, v0, 4, s58
    s_and_b32 s58, s4, 4
    v_lshl_add_u32 v73, s58, 4, v72
    s_movk_i32 s58, 0x1f0
    v_bfi_b32 v72, s58, v73, v72
    s_mov_b32 s41, 1
    s_mov_b64 vcc, -1
    s_branch L_dm0b
Ldm_0:
    ds_write_b128 v72, v[96:99] offset:0
    ds_write_b128 v72, v[100:103] offset:8192
    s_branch Ldb_0
Ldm_2:
    ds_write_b128 v72, v[104:107] offset:16384
    ds_write_b128 v72, v[108:111] offset:24576
    s_branch Ldb_2
Ldm_4:
    ds_write_b128 v72, v[112:115] offset:32768
    ds_write_b128 v72, v[116:119] offset:40960
    s_branch Ldb_4
Ldm_6:
    ds_write_b128 v72, v[120:123] offset:49152
    ds_write_b128 v72, v[124:127] offset:57344
    s_mov_b64 exec, 1
    ds_inc_u32 v12, v12 offset:64
    s_mov_b64 exec, -1
    s_branch Ldb_6
L_flush:
    s_and_b32 s101, s65, 0x3ffff
    s_add_u32 s63, s63, 1
    v_permlane32_swap_b32 v56, v60
    v_permlane32_swap_b32 v57, v61
    v_permlane32_swap_b32 v58, v62
    v_permlane32_swap_b32 v59, v63
    s_lshr_b32 s62, s65, 26
    v_pk_add_f32 v[56:57], v[56:57], v[60:61]
    v_pk_add_f32 v[58:59], v[58:59], v[62:63]
    v_add_u32 v62, s101, v15
    v_pk_mul_f32 v[56:57], v[56:57], s[64:65] op_sel_hi:[1,0]
    v_pk_mul_f32 v[58:59], v[58:59], s[64:65] op_sel_hi:[1,0]
    v_lshl_add_u32 v63, s62, 2, v12
    v_cvt_pk_bf16_f32 v60, v56, v57
    v_cvt_pk_bf16_f32 v61, v58, v59
    s_cmp_eq_u32 s62, 2
    s_cbranch_scc0 L_fl1
    v_add_u32 v62, s101, v74
    ds_write2_b32 v62, v60, v61 offset0:0 offset1:4
    s_mov_b64 exec, 1
    ds_inc_u32 v63, v63 offset:36
    s_mov_b64 exec, -1
    s_setpc_b64 s[68:69]
L_fl1:
    ds_write_b64 v62, v[60:61]
    s_mov_b64 exec, 1
    ds_inc_u32 v63, v63 offset:36
    s_mov_b64 exec, -1
    v_readlane_b32 s65, v9, s63
    v_readlane_b32 s64, v8, s63
    v_mov_b64 v[56:57], 0
    v_mov_b64 v[58:59], 0
    v_mov_b64 v[60:61], 0
    v_mov_b64 v[62:63], 0
    s_bfe_u32 s62, s65, 0x80012
    s_setpc_b64 s[68:69]
L_preA:
    s_setprio 2
    v_and_b32 v0, 63, v0
    s_xor_b32 s3, s3, 8
    v_mov_b32 v3, 160064
    s_mov_b64 s[8:9], s[32:33]
    s_mov_b32 s10, 5120000
    s_mov_b32 s11, 0x20000
    v_and_b32 v4, 7, v0
    v_mul_u32_u24 v1, 1056, v4
    v_and_b32 v4, 8, v0
    v_lshl_add_u32 v1, v4, 6, v1
    v_and_b32 v4, 48, v0
    v_add_u32 v1, v4, v1
    v_add_u32 v12, 84480, v1
    v_lshlrev_b32 v14, 4, v0
    s_lshl_b32 s61, s3, 6
    s_add_u32 s61, s61, 105600
    v_add_u32 v13, s61, v1
    s_lshl_b32 s100, s3, 14
    s_add_u32 s100, s100, 720896
    s_waitcnt lgkmcnt(0)
    s_cmp_eq_u32 s3, 0
    s_cbranch_scc0 L_notag
    s_add_u32 s40, s40, 0x9e377000
    s_and_b32 s40, s40, 4294963200
    s_bitset1_b32 s40, 0
    v_mov_b32 v4, s40
    ds_write_b32 v3, v4 offset:68
L_notag:
    v_lshl_add_u32 v104, s12, 9, v2
    v_lshl_add_u32 v105, s13, 9, v2
    v_lshl_add_u32 v106, s14, 9, v2
    v_lshl_add_u32 v107, s15, 9, v2
    v_lshl_add_u32 v108, s16, 9, v2
    v_lshl_add_u32 v109, s17, 9, v2
    v_lshl_add_u32 v110, s18, 9, v2
    v_lshl_add_u32 v111, s19, 9, v2
    v_lshl_add_u32 v112, s28, 9, v2
    v_lshl_add_u32 v113, s29, 9, v2
    s_mov_b32 exec_lo, 0
    v_lshl_add_u32 v104, s20, 9, v2
    v_lshl_add_u32 v105, s21, 9, v2
    v_lshl_add_u32 v106, s22, 9, v2
    v_lshl_add_u32 v107, s23, 9, v2
    v_lshl_add_u32 v108, s24, 9, v2
    v_lshl_add_u32 v109, s25, 9, v2
    v_lshl_add_u32 v110, s26, 9, v2
    v_lshl_add_u32 v111, s27, 9, v2
    v_lshl_add_u32 v112, s30, 9, v2
    v_lshl_add_u32 v113, s31, 9, v2
    s_mov_b64 exec, -1
    s_mov_b64 s[16:17], s[56:57]
    s_mov_b32 s18, 1441792
    s_mov_b32 s19, 0x20000
    s_mov_b64 s[20:21], s[52:53]
    s_mov_b32 s22, 5120000
    s_mov_b32 s23, 0x20000
    s_cmp_ge_u32 s2, 64
    s_cbranch_scc1 L_nopb
    s_barrier
    s_barrier
L_nopb:
    s_mul_i32 s67, s3, 2112
    s_mul_i32 s66, s3, 8448
    s_add_u32 m0, s66, 0
    s_waitcnt vmcnt(1)
    buffer_load_dwordx4 v104, s[8:11], 0 offen lds
    s_add_u32 m0, s66, 1056
    s_waitcnt vmcnt(1)
    buffer_load_dwordx4 v105, s[8:11], 0 offen lds
    v_and_b32 v4, 3, v0
    v_mov_b32 v5, 0x0c0c0c0c
    v_mov_b32 v6, 0x0c0c0302
    v_mov_b32 v7, 0x03020c0c
    v_cmp_eq_u32 s[58:59], 0, v4
    v_cmp_eq_u32 s[60:61], 2, v4
    v_cmp_eq_u32 vcc, 1, v4
    v_cndmask_b32 v8, v5, v6, s[58:59]
    v_cndmask_b32 v9, v5, v6, s[60:61]
    v_cndmask_b32 v8, v8, v7, vcc
    v_cmp_eq_u32 vcc, 3, v4
    s_nop 1
    v_cndmask_b32 v9, v9, v7, vcc
    v_mov_b32 v10, v8
    v_mov_b32 v11, v9
    v_and_b32 v8, 0xfdfdfdfd, v8
    v_and_b32 v9, 0xfdfdfdfd, v9
    s_add_u32 m0, s66, 2112
    s_waitcnt vmcnt(1)
    buffer_load_dwordx4 v106, s[8:11], 0 offen lds
    s_mov_b64 exec, 1
    v_mov_b32 v4, 1
    ds_add_u32 v3, v4 offset:0
    s_mov_b64 exec, -1
    s_add_u32 m0, s66, 3168
    s_waitcnt vmcnt(1)
    buffer_load_dwordx4 v107, s[8:11], 0 offen lds
    s_add_u32 m0, s66, 4224
    s_waitcnt vmcnt(1)
    buffer_load_dwordx4 v108, s[8:11], 0 offen lds
    s_mov_b32 s59, 0
Lw_38:
    ds_read_b32 v4, v3 offset:0
    s_waitcnt lgkmcnt(0)
    v_cmp_gt_u32 vcc, 8, v4
    s_cbranch_vccz Lk_39
    s_add_u32 s59, s59, 1
    s_cmp_lt_u32 s59, 4194304
    s_cbranch_scc1 Lw_38
    s_branch L_end
Lk_39:
    ds_read_b128 v[80:83], v12 offset:0
    ds_read_b128 v[84:87], v12 offset:8448
    ds_read_b128 v[88:91], v12 offset:16896
    s_add_u32 m0, s66, 5280
    s_waitcnt vmcnt(1)
    buffer_load_dwordx4 v109, s[8:11], 0 offen lds
    s_mov_b64 exec, 1
    v_mov_b32 v4, 1
    ds_add_u32 v3, v4 offset:60
    s_mov_b64 exec, -1
    s_waitcnt vmcnt(1)
    ds_read_b32 v4, v3 offset:52
    s_add_u32 m0, s66, 6336
    s_waitcnt vmcnt(1)
    buffer_load_dwordx4 v110, s[8:11], 0 offen lds
    s_mov_b32 s62, 7
    s_waitcnt lgkmcnt(0)
    v_cmp_gt_u32 vcc, 8, v4
    s_cbranch_vccz L_eu10
    s_waitcnt vmcnt(1)
    ds_read_b32 v4, v3 offset:52
    s_add_u32 m0, s66, 7392
    s_waitcnt vmcnt(1)
    buffer_load_dwordx4 v111, s[8:11], 0 offen lds
    s_mov_b32 s62, 8
    s_waitcnt lgkmcnt(0)
    v_cmp_gt_u32 vcc, 8, v4
    s_cbranch_vccz L_eu10
    s_waitcnt vmcnt(1)
    ds_read_b32 v4, v3 offset:52
    s_add_u32 m0, s67, 67584
    s_waitcnt vmcnt(1)
    buffer_load_dwordx4 v112, s[8:11], 0 offen lds
    s_mov_b32 s62, 9
    s_waitcnt lgkmcnt(0)
    v_cmp_gt_u32 vcc, 8, v4
    s_cbranch_vccz L_eu10
    s_waitcnt vmcnt(1)
    ds_read_b32 v4, v3 offset:52
    s_add_u32 m0, s67, 68640
    s_waitcnt vmcnt(1)
    buffer_load_dwordx4 v113, s[8:11], 0 offen lds
    s_mov_b32 s62, 10
    s_mov_b32 s59, 0
Lw_40:
    ds_read_b32 v4, v3 offset:52
    s_waitcnt lgkmcnt(0)
    v_cmp_gt_u32 vcc, 8, v4
    s_cbranch_vccz Lk_41
    s_sleep 1
    s_add_u32 s59, s59, 1
    s_cmp_lt_u32 s59, 4194304
    s_cbranch_scc1 Lw_40
    s_branch L_end
Lk_41:
L_eu10:
    s_setprio 3
    buffer_load_dwordx4 v[16:19], v14, s[16:19], s100 offen offset:0 sc1
    buffer_load_dwordx4 v[24:27], v14, s[16:19], s100 offen offset:1024 sc1
    buffer_load_dwordx4 v[20:23], v14, s[16:19], s100 offen offset:2048 sc1
    buffer_load_dwordx4 v[28:31], v14, s[16:19], s100 offen offset:3072 sc1
    s_add_u32 s100, s100, 4096
    buffer_load_dwordx4 v[32:35], v14, s[16:19], s100 offen offset:0 sc1
    s_cmp_gt_u32 s62, 7
    s_cbranch_scc1 Lem_42
    s_add_u32 m0, s66, 7392
    s_waitcnt vmcnt(63)
    buffer_load_dwordx4 v111, s[8:11], 0 offen lds
Lem_42:
    buffer_load_dwordx4 v[40:43], v14, s[16:19], s100 offen offset:1024 sc1
    buffer_load_dwordx4 v[36:39], v14, s[16:19], s100 offen offset:2048 sc1
    buffer_load_dwordx4 v[44:47], v14, s[16:19], s100 offen offset:3072 sc1
    s_add_u32 s100, s100, 4096
    buffer_load_dwordx4 v[48:51], v14, s[16:19], s100 offen offset:0 sc1
    buffer_load_dwordx4 v[56:59], v14, s[16:19], s100 offen offset:1024 sc1
    s_cmp_gt_u32 s62, 8
    s_cbranch_scc1 Lem_43
    s_add_u32 m0, s67, 67584
    s_waitcnt vmcnt(63)
    buffer_load_dwordx4 v112, s[8:11], 0 offen lds
Lem_43:
    buffer_load_dwordx4 v[52:55], v14, s[16:19], s100 offen offset:2048 sc1
    buffer_load_dwordx4 v[60:63], v14, s[16:19], s100 offen offset:3072 sc1
    s_add_u32 s100, s100, 4096
    buffer_load_dwordx4 v[64:67], v14, s[16:19], s100 offen offset:0 sc1
    buffer_load_dwordx4 v[72:75], v14, s[16:19], s100 offen offset:1024 sc1
    buffer_load_dwordx4 v[68:71], v14, s[16:19], s100 offen offset:2048 sc1
    buffer_load_dwordx4 v[76:79], v14, s[16:19], s100 offen offset:3072 sc1
    s_cmp_gt_u32 s62, 9
    s_cbranch_scc1 Lem_44
    s_add_u32 m0, s67, 68640
    s_waitcnt vmcnt(63)
    buffer_load_dwordx4 v113, s[8:11], 0 offen lds
Lem_44:
    s_setprio 0
    ds_read_b128 v[92:95], v12 offset:64
    ds_read_b128 v[96:99], v12 offset:8512
    ds_read_b128 v[100:103], v12 offset:16960
    s_waitcnt vmcnt(14) lgkmcnt(3)
    v_mfma_f32_16x16x32_bf16 v[104:107], v[16:19], v[80:83], 0
    v_mfma_f32_16x16x32_bf16 v[108:111], v[24:27], v[80:83], 0
    v_mfma_f32_16x16x32_bf16 v[112:115], v[16:19], v[84:87], 0
    v_mfma_f32_16x16x32_bf16 v[116:119], v[24:27], v[84:87], 0
    v_mfma_f32_16x16x32_bf16 v[120:123], v[16:19], v[88:91], 0
    v_mfma_f32_16x16x32_bf16 v[124:127], v[24:27], v[88:91], 0
    ds_read_b128 v[80:83], v12 offset:128
    ds_read_b128 v[84:87], v12 offset:8576
    ds_read_b128 v[88:91], v12 offset:17024
    s_waitcnt vmcnt(12) lgkmcnt(3)
    v_mfma_f32_16x16x32_bf16 v[104:107], v[20:23], v[92:95], v[104:107]
    v_mfma_f32_16x16x32_bf16 v[108:111], v[28:31], v[92:95], v[108:111]
    v_mfma_f32_16x16x32_bf16 v[112:115], v[20:23], v[96:99], v[112:115]
    v_mfma_f32_16x16x32_bf16 v[116:119], v[28:31], v[96:99], v[116:119]
    v_mfma_f32_16x16x32_bf16 v[120:123], v[20:23], v[100:103], v[120:123]
    v_mfma_f32_16x16x32_bf16 v[124:127], v[28:31], v[100:103], v[124:127]
    ds_read_b128 v[92:95], v12 offset:192
    ds_read_b128 v[96:99], v12 offset:8640
    ds_read_b128 v[100:103], v12 offset:17088
    s_waitcnt vmcnt(10) lgkmcnt(3)
    v_mfma_f32_16x16x32_bf16 v[104:107], v[32:35], v[80:83], v[104:107]
    v_mfma_f32_16x16x32_bf16 v[108:111], v[40:43], v[80:83], v[108:111]
    v_mfma_f32_16x16x32_bf16 v[112:115], v[32:35], v[84:87], v[112:115]
    v_mfma_f32_16x16x32_bf16 v[116:119], v[40:43], v[84:87], v[116:119]
    v_mfma_f32_16x16x32_bf16 v[120:123], v[32:35], v[88:91], v[120:123]
    v_mfma_f32_16x16x32_bf16 v[124:127], v[40:43], v[88:91], v[124:127]
    ds_read_b128 v[80:83], v12 offset:256
    ds_read_b128 v[84:87], v12 offset:8704
    ds_read_b128 v[88:91], v12 offset:17152
    s_waitcnt vmcnt(8) lgkmcnt(3)
    v_mfma_f32_16x16x32_bf16 v[104:107], v[36:39], v[92:95], v[104:107]
    v_mfma_f32_16x16x32_bf16 v[108:111], v[44:47], v[92:95], v[108:111]
    v_mfma_f32_16x16x32_bf16 v[112:115], v[36:39], v[96:99], v[112:115]
    v_mfma_f32_16x16x32_bf16 v[116:119], v[44:47], v[96:99], v[116:119]
    v_mfma_f32_16x16x32_bf16 v[120:123], v[36:39], v[100:103], v[120:123]
    v_mfma_f32_16x16x32_bf16 v[124:127], v[44:47], v[100:103], v[124:127]
    ds_read_b128 v[92:95], v12 offset:320
    ds_read_b128 v[96:99], v12 offset:8768
    ds_read_b128 v[100:103], v12 offset:17216
    s_waitcnt vmcnt(6) lgkmcnt(3)
    v_mfma_f32_16x16x32_bf16 v[104:107], v[48:51], v[80:83], v[104:107]
    v_mfma_f32_16x16x32_bf16 v[108:111], v[56:59], v[80:83], v[108:111]
    v_mfma_f32_16x16x32_bf16 v[112:115], v[48:51], v[84:87], v[112:115]
    v_mfma_f32_16x16x32_bf16 v[116:119], v[56:59], v[84:87], v[116:119]
    v_mfma_f32_16x16x32_bf16 v[120:123], v[48:51], v[88:91], v[120:123]
    v_mfma_f32_16x16x32_bf16 v[124:127], v[56:59], v[88:91], v[124:127]
    ds_read_b128 v[80:83], v12 offset:384
    ds_read_b128 v[84:87], v12 offset:8832
    ds_read_b128 v[88:91], v12 offset:17280
    s_waitcnt vmcnt(4) lgkmcnt(3)
    v_mfma_f32_16x16x32_bf16 v[104:107], v[52:55], v[92:95], v[104:107]
    v_mfma_f32_16x16x32_bf16 v[108:111], v[60:63], v[92:95], v[108:111]
    v_mfma_f32_16x16x32_bf16 v[112:115], v[52:55], v[96:99], v[112:115]
    v_mfma_f32_16x16x32_bf16 v[116:119], v[60:63], v[96:99], v[116:119]
    v_mfma_f32_16x16x32_bf16 v[120:123], v[52:55], v[100:103], v[120:123]
    v_mfma_f32_16x16x32_bf16 v[124:127], v[60:63], v[100:103], v[124:127]
    ds_read_b128 v[92:95], v12 offset:448
    ds_read_b128 v[96:99], v12 offset:8896
    ds_read_b128 v[100:103], v12 offset:17344
    s_waitcnt vmcnt(2) lgkmcnt(3)
    v_mfma_f32_16x16x32_bf16 v[104:107], v[64:67], v[80:83], v[104:107]
    v_mfma_f32_16x16x32_bf16 v[108:111], v[72:75], v[80:83], v[108:111]
    v_mfma_f32_16x16x32_bf16 v[112:115], v[64:67], v[84:87], v[112:115]
    v_mfma_f32_16x16x32_bf16 v[116:119], v[72:75], v[84:87], v[116:119]
    v_mfma_f32_16x16x32_bf16 v[120:123], v[64:67], v[88:91], v[120:123]
    v_mfma_f32_16x16x32_bf16 v[124:127], v[72:75], v[88:91], v[124:127]
    s_waitcnt vmcnt(0) lgkmcnt(0)
    v_mfma_f32_16x16x32_bf16 v[104:107], v[68:71], v[92:95], v[104:107]
    v_mfma_f32_16x16x32_bf16 v[108:111], v[76:79], v[92:95], v[108:111]
    v_mfma_f32_16x16x32_bf16 v[112:115], v[68:71], v[96:99], v[112:115]
    v_mfma_f32_16x16x32_bf16 v[116:119], v[76:79], v[96:99], v[116:119]
    v_mfma_f32_16x16x32_bf16 v[120:123], v[68:71], v[100:103], v[120:123]
    v_mfma_f32_16x16x32_bf16 v[124:127], v[76:79], v[100:103], v[124:127]
    s_nop 3
    v_cvt_pk_bf16_f32 v80, v104, v105
    v_cvt_pk_bf16_f32 v81, v106, v107
    v_cvt_pk_bf16_f32 v82, v108, v109
    v_cvt_pk_bf16_f32 v83, v110, v111
    ds_write_b128 v13, v[80:83] offset:0
    v_cvt_pk_bf16_f32 v84, v112, v113
    v_cvt_pk_bf16_f32 v85, v114, v115
    v_cvt_pk_bf16_f32 v86, v116, v117
    v_cvt_pk_bf16_f32 v87, v118, v119
    ds_write_b128 v13, v[84:87] offset:8448
    v_cvt_pk_bf16_f32 v88, v120, v121
    v_cvt_pk_bf16_f32 v89, v122, v123
    v_cvt_pk_bf16_f32 v90, v124, v125
    v_cvt_pk_bf16_f32 v91, v126, v127
    ds_write_b128 v13, v[88:91] offset:16896
    s_mov_b64 exec, 1
    v_mov_b32 v4, 1
    ds_add_u32 v3, v4 offset:20
    s_mov_b64 exec, -1
    s_setprio 3
    s_add_u32 s100, s100, 118784
    buffer_load_dwordx4 v[16:19], v14, s[16:19], s100 offen offset:0 sc1
    buffer_load_dwordx4 v[24:27], v14, s[16:19], s100 offen offset:1024 sc1
    buffer_load_dwordx4 v[20:23], v14, s[16:19], s100 offen offset:2048 sc1
    buffer_load_dwordx4 v[28:31], v14, s[16:19], s100 offen offset:3072 sc1
    s_add_u32 s100, s100, 4096
    buffer_load_dwordx4 v[32:35], v14, s[16:19], s100 offen offset:0 sc1
    buffer_load_dwordx4 v[40:43], v14, s[16:19], s100 offen offset:1024 sc1
    buffer_load_dwordx4 v[36:39], v14, s[16:19], s100 offen offset:2048 sc1
    buffer_load_dwordx4 v[44:47], v14, s[16:19], s100 offen offset:3072 sc1
    s_add_u32 s100, s100, 4096
    buffer_load_dwordx4 v[48:51], v14, s[16:19], s100 offen offset:0 sc1
    buffer_load_dwordx4 v[56:59], v14, s[16:19], s100 offen offset:1024 sc1
    buffer_load_dwordx4 v[52:55], v14, s[16:19], s100 offen offset:2048 sc1
    buffer_load_dwordx4 v[60:63], v14, s[16:19], s100 offen offset:3072 sc1
    s_add_u32 s100, s100, 4096
    buffer_load_dwordx4 v[64:67], v14, s[16:19], s100 offen offset:0 sc1
    buffer_load_dwordx4 v[72:75], v14, s[16:19], s100 offen offset:1024 sc1
    buffer_load_dwordx4 v[68:71], v14, s[16:19], s100 offen offset:2048 sc1
    buffer_load_dwordx4 v[76:79], v14, s[16:19], s100 offen offset:3072 sc1
    s_setprio 0
    s_mov_b32 s63, s3
L_grp:
    s_mul_i32 s58, s63, 8448
    s_lshr_b32 s59, s63, 2
    s_mul_i32 s59, s59, 8448
    s_and_b32 s60, s63, 1
    s_bfe_u32 s61, s63, 0x10001
    s_cmp_ge_u32 s63, 8
    s_cselect_b32 s61, s60, s61
    s_cselect_b32 s60, 0, s60
    s_mul_i32 s60, s60, 4224
    s_lshl_b32 s61, s61, 9
    s_add_u32 s59, s59, s60
    s_add_u32 s59, s59, s61
    s_add_u32 s59, s59, 105600
    v_add_u32 v12, s58, v1
    v_bfe_u32 v4, v0, 2, 2
    v_mul_u32_u24 v4, 1056, v4
    v_and_b32 v5, 48, v0
    v_add3_u32 v13, v4, v5, s59
    v_lshl_add_u32 v14, v0, 3, s58
    v_lshl_add_u32 v2, v0, 3, s59
    s_cmp_ge_u32 s63, 8
    s_cbranch_scc1 L_grp2
    s_mov_b32 s59, 0
Lw_45:
    ds_read_b32 v4, v3 offset:20
    s_waitcnt lgkmcnt(0)
    v_cmp_gt_u32 vcc, 8, v4
    s_cbranch_vccz Lk_46
    s_sleep 1
    s_add_u32 s59, s59, 1
    s_cmp_lt_u32 s59, 4194304
    s_cbranch_scc1 Lw_45
    s_branch L_end
Lk_46:
L_grp2:
    s_waitcnt lgkmcnt(0)
    ds_read_b128 v[80:83], v12 offset:0
    ds_read_b128 v[84:87], v13 offset:0
    ds_read_b128 v[88:91], v12 offset:64
    ds_read_b128 v[92:95], v13 offset:64
    ds_read_b128 v[96:99], v12 offset:128
    ds_read_b128 v[100:103], v13 offset:128
    ds_read_b128 v[104:107], v12 offset:192
    ds_read_b128 v[108:111], v13 offset:192
    ds_read_b128 v[112:115], v12 offset:256
    ds_read_b128 v[116:119], v13 offset:256
    ds_read_b128 v[120:123], v12 offset:320
    ds_read_b128 v[124:127], v13 offset:320
    s_waitcnt lgkmcnt(10)
    v_mfma_f32_16x16x32_bf16 v[4:7], v[80:83], v[84:87], 0
    ds_read_b128 v[80:83], v12 offset:384
    ds_read_b128 v[84:87], v13 offset:384
    s_waitcnt lgkmcnt(10)
    v_mfma_f32_16x16x32_bf16 v[4:7], v[88:91], v[92:95], v[4:7]
    ds_read_b128 v[88:91], v12 offset:448
    ds_read_b128 v[92:95], v13 offset:448
    s_waitcnt lgkmcnt(10)
    v_mfma_f32_16x16x32_bf16 v[4:7], v[96:99], v[100:103], v[4:7]
    s_waitcnt lgkmcnt(8)
    v_mfma_f32_16x16x32_bf16 v[4:7], v[104:107], v[108:111], v[4:7]
    s_waitcnt lgkmcnt(6)
    v_mfma_f32_16x16x32_bf16 v[4:7], v[112:115], v[116:119], v[4:7]
    s_waitcnt lgkmcnt(4)
    v_mfma_f32_16x16x32_bf16 v[4:7], v[120:123], v[124:127], v[4:7]
    s_waitcnt lgkmcnt(2)
    v_mfma_f32_16x16x32_bf16 v[4:7], v[80:83], v[84:87], v[4:7]
    s_waitcnt lgkmcnt(0)
    v_mfma_f32_16x16x32_bf16 v[4:7], v[88:91], v[92:95], v[4:7]
    ds_read_b64 v[96:97], v14 offset:2112
    ds_read_b64 v[98:99], v14 offset:6336
    ds_read_b64 v[100:101], v14 offset:2624
    ds_read_b64 v[102:103], v14 offset:6848
    ds_read_b64 v[104:105], v14 offset:3168
    ds_read_b64 v[106:107], v14 offset:7392
    ds_read_b64 v[108:109], v14 offset:3680
    ds_read_b64 v[110:111], v14 offset:7904
    ds_read_b64 v[80:81], v14 offset:0
    ds_read_b64 v[82:83], v14 offset:4224
    ds_read_b64 v[84:85], v14 offset:512
    ds_read_b64 v[86:87], v14 offset:4736
    ds_read_b64 v[88:89], v14 offset:1056
    ds_read_b64 v[90:91], v14 offset:5280
    ds_read_b64 v[92:93], v14 offset:1568
    s_waitcnt lgkmcnt(14)
    ds_read_b64 v[94:95], v14 offset:5792
    v_mul_f32 v4, 0x3db8aa3b, v4
    v_mul_f32 v5, 0x3db8aa3b, v5
    v_mul_f32 v6, 0x3db8aa3b, v6
    v_mul_f32 v7, 0x3db8aa3b, v7
    v_exp_f32 v4, v4
    v_exp_f32 v5, v5
    v_exp_f32 v6, v6
    v_exp_f32 v7, v7
    v_add_f32 v12, v4, v5
    v_add_f32 v13, v6, v7
    v_add_f32 v12, v12, v13
    v_add_f32 v12, 0x3089705f, v12
    v_rcp_f32 v12, v12
    s_add_u32 s63, s63, 8
    v_mul_f32 v4, v4, v12
    v_mul_f32 v5, v5, v12
    v_mul_f32 v6, v6, v12
    v_mul_f32 v7, v7, v12
    v_cvt_pk_bf16_f32 v4, v4, v5
    v_cvt_pk_bf16_f32 v6, v6, v7
    v_perm_b32 v112, v4, v4, v8
    v_perm_b32 v113, v4, v4, v9
    v_perm_b32 v114, v4, v4, v10
    v_perm_b32 v115, v4, v4, v11
    v_perm_b32 v116, v6, v6, v8
    v_perm_b32 v117, v6, v6, v9
    v_perm_b32 v118, v6, v6, v10
    v_perm_b32 v119, v6, v6, v11
    s_waitcnt lgkmcnt(0)
    v_mfma_f32_4x4x4_16b_bf16 v[120:123], v[112:113], v[80:81], 0 cbsz:4 abid:0
    v_mfma_f32_4x4x4_16b_bf16 v[124:127], v[112:113], v[82:83], 0 cbsz:4 abid:5
    v_mfma_f32_4x4x4_16b_bf16 v[4:7], v[112:113], v[84:85], 0 cbsz:4 abid:10
    v_mfma_f32_4x4x4_16b_bf16 v[12:15], v[112:113], v[86:87], 0 cbsz:4 abid:15
    v_mfma_f32_4x4x4_16b_bf16 v[120:123], v[114:115], v[88:89], v[120:123] cbsz:4 abid:0
    v_mfma_f32_4x4x4_16b_bf16 v[124:127], v[114:115], v[90:91], v[124:127] cbsz:4 abid:5
    v_mfma_f32_4x4x4_16b_bf16 v[4:7], v[114:115], v[92:93], v[4:7] cbsz:4 abid:10
    v_mfma_f32_4x4x4_16b_bf16 v[12:15], v[114:115], v[94:95], v[12:15] cbsz:4 abid:15
    v_mfma_f32_4x4x4_16b_bf16 v[120:123], v[116:117], v[96:97], v[120:123] cbsz:4 abid:0
    v_mfma_f32_4x4x4_16b_bf16 v[124:127], v[116:117], v[98:99], v[124:127] cbsz:4 abid:5
    v_mfma_f32_4x4x4_16b_bf16 v[4:7], v[116:117], v[100:101], v[4:7] cbsz:4 abid:10
    v_mfma_f32_4x4x4_16b_bf16 v[12:15], v[116:117], v[102:103], v[12:15] cbsz:4 abid:15
    v_mfma_f32_4x4x4_16b_bf16 v[120:123], v[118:119], v[104:105], v[120:123] cbsz:4 abid:0
    v_mfma_f32_4x4x4_16b_bf16 v[124:127], v[118:119], v[106:107], v[124:127] cbsz:4 abid:5
    v_mfma_f32_4x4x4_16b_bf16 v[4:7], v[118:119], v[108:109], v[4:7] cbsz:4 abid:10
    v_mfma_f32_4x4x4_16b_bf16 v[12:15], v[118:119], v[110:111], v[12:15] cbsz:4 abid:15
    s_nop 1
    v_cvt_pk_bf16_f32 v112, v120, v121
    v_cvt_pk_bf16_f32 v113, v122, v123
    ds_write_b64 v2, v[112:113] offset:0
    v_cvt_pk_bf16_f32 v114, v124, v125
    v_cvt_pk_bf16_f32 v115, v126, v127
    ds_write_b64 v2, v[114:115] offset:1056
    v_cvt_pk_bf16_f32 v116, v4, v5
    v_cvt_pk_bf16_f32 v117, v6, v7
    ds_write_b64 v2, v[116:117] offset:2112
    v_cvt_pk_bf16_f32 v118, v12, v13
    v_cvt_pk_bf16_f32 v119, v14, v15
    ds_write_b64 v2, v[118:119] offset:3168
    s_cmp_lt_u32 s63, 10
    s_cbranch_scc1 L_grp
L_grpx:
    s_mov_b64 exec, 1
    v_mov_b32 v4, 1
    ds_add_u32 v3, v4 offset:24
    s_mov_b64 exec, -1
    v_add_u32 v12, 105600, v1
    v_lshlrev_b32 v14, 4, v0
    v_and_b32 v6, 15, v0
    v_lshlrev_b32 v6, 2, v6
    v_and_b32 v5, 48, v0
    v_lshl_add_u32 v8, v5, 7, v6
    v_and_b32 v5, 32, v0
    v_lshl_add_u32 v9, v5, 6, v6
    v_and_b32 v5, 16, v0
    v_lshl_add_u32 v9, v5, 22, v9
    s_lshl_b32 s60, s5, 9
    s_lshl_b32 s61, s3, 6
    s_add_u32 s60, s60, s61
    s_mov_b32 s59, 0
Lw_47:
    ds_read_b32 v4, v3 offset:24
    s_waitcnt lgkmcnt(0)
    v_cmp_gt_u32 vcc, 8, v4
    s_cbranch_vccz Lk_48
    s_sleep 1
    s_add_u32 s59, s59, 1
    s_cmp_lt_u32 s59, 4194304
    s_cbranch_scc1 Lw_47
    s_branch L_end
Lk_48:
    ds_read_b128 v[80:83], v12 offset:0
    ds_read_b128 v[84:87], v12 offset:8448
    ds_read_b128 v[88:91], v12 offset:16896
    ds_read_b128 v[92:95], v12 offset:64
    ds_read_b128 v[96:99], v12 offset:8512
    ds_read_b128 v[100:103], v12 offset:16960
    s_waitcnt vmcnt(14) lgkmcnt(3)
    v_mfma_f32_16x16x32_bf16 v[104:107], v[80:83], v[16:19], 0
    v_mfma_f32_16x16x32_bf16 v[108:111], v[80:83], v[24:27], 0
    v_mfma_f32_16x16x32_bf16 v[112:115], v[84:87], v[16:19], 0
    v_mfma_f32_16x16x32_bf16 v[116:119], v[84:87], v[24:27], 0
    v_mfma_f32_16x16x32_bf16 v[120:123], v[88:91], v[16:19], 0
    v_mfma_f32_16x16x32_bf16 v[124:127], v[88:91], v[24:27], 0
    ds_read_b128 v[80:83], v12 offset:128
    ds_read_b128 v[84:87], v12 offset:8576
    ds_read_b128 v[88:91], v12 offset:17024
    s_waitcnt vmcnt(12) lgkmcnt(3)
    v_mfma_f32_16x16x32_bf16 v[104:107], v[92:95], v[20:23], v[104:107]
    v_mfma_f32_16x16x32_bf16 v[108:111], v[92:95], v[28:31], v[108:111]
    v_mfma_f32_16x16x32_bf16 v[112:115], v[96:99], v[20:23], v[112:115]
    v_mfma_f32_16x16x32_bf16 v[116:119], v[96:99], v[28:31], v[116:119]
    v_mfma_f32_16x16x32_bf16 v[120:123], v[100:103], v[20:23], v[120:123]
    v_mfma_f32_16x16x32_bf16 v[124:127], v[100:103], v[28:31], v[124:127]
    ds_read_b128 v[92:95], v12 offset:192
    ds_read_b128 v[96:99], v12 offset:8640
    ds_read_b128 v[100:103], v12 offset:17088
    s_waitcnt vmcnt(10) lgkmcnt(3)
    v_mfma_f32_16x16x32_bf16 v[104:107], v[80:83], v[32:35], v[104:107]
    v_mfma_f32_16x16x32_bf16 v[108:111], v[80:83], v[40:43], v[108:111]
    v_mfma_f32_16x16x32_bf16 v[112:115], v[84:87], v[32:35], v[112:115]
    v_mfma_f32_16x16x32_bf16 v[116:119], v[84:87], v[40:43], v[116:119]
    v_mfma_f32_16x16x32_bf16 v[120:123], v[88:91], v[32:35], v[120:123]
    v_mfma_f32_16x16x32_bf16 v[124:127], v[88:91], v[40:43], v[124:127]
    ds_read_b128 v[80:83], v12 offset:256
    ds_read_b128 v[84:87], v12 offset:8704
    ds_read_b128 v[88:91], v12 offset:17152
    s_waitcnt vmcnt(8) lgkmcnt(3)
    v_mfma_f32_16x16x32_bf16 v[104:107], v[92:95], v[36:39], v[104:107]
    v_mfma_f32_16x16x32_bf16 v[108:111], v[92:95], v[44:47], v[108:111]
    v_mfma_f32_16x16x32_bf16 v[112:115], v[96:99], v[36:39], v[112:115]
    v_mfma_f32_16x16x32_bf16 v[116:119], v[96:99], v[44:47], v[116:119]
    v_mfma_f32_16x16x32_bf16 v[120:123], v[100:103], v[36:39], v[120:123]
    v_mfma_f32_16x16x32_bf16 v[124:127], v[100:103], v[44:47], v[124:127]
    ds_read_b128 v[92:95], v12 offset:320
    ds_read_b128 v[96:99], v12 offset:8768
    ds_read_b128 v[100:103], v12 offset:17216
    s_waitcnt vmcnt(6) lgkmcnt(3)
    v_mfma_f32_16x16x32_bf16 v[104:107], v[80:83], v[48:51], v[104:107]
    v_mfma_f32_16x16x32_bf16 v[108:111], v[80:83], v[56:59], v[108:111]
    v_mfma_f32_16x16x32_bf16 v[112:115], v[84:87], v[48:51], v[112:115]
    v_mfma_f32_16x16x32_bf16 v[116:119], v[84:87], v[56:59], v[116:119]
    v_mfma_f32_16x16x32_bf16 v[120:123], v[88:91], v[48:51], v[120:123]
    v_mfma_f32_16x16x32_bf16 v[124:127], v[88:91], v[56:59], v[124:127]
    ds_read_b128 v[80:83], v12 offset:384
    ds_read_b128 v[84:87], v12 offset:8832
    ds_read_b128 v[88:91], v12 offset:17280
    s_waitcnt vmcnt(4) lgkmcnt(3)
    v_mfma_f32_16x16x32_bf16 v[104:107], v[92:95], v[52:55], v[104:107]
    v_mfma_f32_16x16x32_bf16 v[108:111], v[92:95], v[60:63], v[108:111]
    v_mfma_f32_16x16x32_bf16 v[112:115], v[96:99], v[52:55], v[112:115]
    v_mfma_f32_16x16x32_bf16 v[116:119], v[96:99], v[60:63], v[116:119]
    v_mfma_f32_16x16x32_bf16 v[120:123], v[100:103], v[52:55], v[120:123]
    v_mfma_f32_16x16x32_bf16 v[124:127], v[100:103], v[60:63], v[124:127]
    ds_read_b128 v[92:95], v12 offset:448
    ds_read_b128 v[96:99], v12 offset:8896
    ds_read_b128 v[100:103], v12 offset:17344
    s_waitcnt vmcnt(2) lgkmcnt(3)
    v_mfma_f32_16x16x32_bf16 v[104:107], v[80:83], v[64:67], v[104:107]
    v_mfma_f32_16x16x32_bf16 v[108:111], v[80:83], v[72:75], v[108:111]
    v_mfma_f32_16x16x32_bf16 v[112:115], v[84:87], v[64:67], v[112:115]
    v_mfma_f32_16x16x32_bf16 v[116:119], v[84:87], v[72:75], v[116:119]
    v_mfma_f32_16x16x32_bf16 v[120:123], v[88:91], v[64:67], v[120:123]
    v_mfma_f32_16x16x32_bf16 v[124:127], v[88:91], v[72:75], v[124:127]
    s_waitcnt vmcnt(0) lgkmcnt(0)
    v_mfma_f32_16x16x32_bf16 v[104:107], v[92:95], v[68:71], v[104:107]
    v_mfma_f32_16x16x32_bf16 v[108:111], v[92:95], v[76:79], v[108:111]
    v_mfma_f32_16x16x32_bf16 v[112:115], v[96:99], v[68:71], v[112:115]
    v_mfma_f32_16x16x32_bf16 v[116:119], v[96:99], v[76:79], v[116:119]
    v_mfma_f32_16x16x32_bf16 v[120:123], v[100:103], v[68:71], v[120:123]
    v_mfma_f32_16x16x32_bf16 v[124:127], v[100:103], v[76:79], v[124:127]
    s_add_u32 s100, s100, 122880
    s_setprio 3
    s_add_u32 s100, s100, 4096
    buffer_load_dwordx4 v[48:51], v14, s[16:19], s100 offen offset:0 sc1
    buffer_load_dwordx4 v[56:59], v14, s[16:19], s100 offen offset:1024 sc1
    buffer_load_dwordx4 v[52:55], v14, s[16:19], s100 offen offset:2048 sc1
    buffer_load_dwordx4 v[60:63], v14, s[16:19], s100 offen offset:3072 sc1
    s_add_u32 s100, s100, 4096
    buffer_load_dwordx4 v[64:67], v14, s[16:19], s100 offen offset:0 sc1
    buffer_load_dwordx4 v[72:75], v14, s[16:19], s100 offen offset:1024 sc1
    buffer_load_dwordx4 v[68:71], v14, s[16:19], s100 offen offset:2048 sc1
    buffer_load_dwordx4 v[76:79], v14, s[16:19], s100 offen offset:3072 sc1
    s_setprio 0
    v_and_b32 v5, 15, v0
    v_lshlrev_b32 v5, 2, v5
    v_and_b32 v6, 16, v0
    v_lshl_add_u32 v5, v6, 2, v5
    s_lshl_b32 s58, s3, 6
    v_add_u32 v5, s58, v5
    v_and_b32 v5, 0x1ff, v5
    v_and_b32 v6, 48, v0
    v_lshl_add_u32 v5, v6, 8, v5
    s_mov_b32 s70, 0x05040100
    s_mov_b32 s71, 0x07060302
    s_mov_b32 s59, 0
Lw_49:
    ds_read_b32 v4, v3 offset:64
    s_waitcnt lgkmcnt(0)
    v_cmp_gt_u32 vcc, 8, v4
    s_cbranch_vccz Lk_50
    s_sleep 2
    s_add_u32 s59, s59, 1
    s_cmp_lt_u32 s59, 16777216
    s_cbranch_scc1 Lw_49
    s_branch L_end
Lk_50:
    ds_read2st64_b32 v[80:81], v5 offset0:0 offset1:2
    ds_read2st64_b32 v[82:83], v5 offset0:4 offset1:6
    ds_read2st64_b32 v[84:85], v5 offset0:8 offset1:10
    ds_read2st64_b32 v[86:87], v5 offset0:12 offset1:14
    ds_read2st64_b32 v[88:89], v5 offset0:64 offset1:66
    ds_read2st64_b32 v[90:91], v5 offset0:68 offset1:70
    ds_read2st64_b32 v[92:93], v5 offset0:72 offset1:74
    ds_read2st64_b32 v[94:95], v5 offset0:76 offset1:78
    ds_read2st64_b32 v[96:97], v5 offset0:128 offset1:130
    ds_read2st64_b32 v[98:99], v5 offset0:132 offset1:134
    ds_read2st64_b32 v[100:101], v5 offset0:136 offset1:138
    ds_read2st64_b32 v[102:103], v5 offset0:140 offset1:142
    s_waitcnt lgkmcnt(8)
    v_perm_b32 v16, v81, v80, s70
    v_perm_b32 v24, v81, v80, s71
    v_perm_b32 v17, v83, v82, s70
    v_perm_b32 v25, v83, v82, s71
    v_perm_b32 v18, v85, v84, s70
    v_perm_b32 v26, v85, v84, s71
    v_perm_b32 v19, v87, v86, s70
    v_perm_b32 v27, v87, v86, s71
    ds_read2st64_b32 v[80:81], v5 offset0:192 offset1:194
    ds_read2st64_b32 v[82:83], v5 offset0:196 offset1:198
    ds_read2st64_b32 v[84:85], v5 offset0:200 offset1:202
    ds_read2st64_b32 v[86:87], v5 offset0:204 offset1:206
    s_waitcnt lgkmcnt(8)
    v_perm_b32 v20, v89, v88, s70
    v_perm_b32 v28, v89, v88, s71
    v_perm_b32 v21, v91, v90, s70
    v_perm_b32 v29, v91, v90, s71
    v_perm_b32 v22, v93, v92, s70
    v_perm_b32 v30, v93, v92, s71
    v_perm_b32 v23, v95, v94, s70
    v_perm_b32 v31, v95, v94, s71
    s_waitcnt lgkmcnt(4)
    v_perm_b32 v32, v97, v96, s70
    v_perm_b32 v40, v97, v96, s71
    v_perm_b32 v33, v99, v98, s70
    v_perm_b32 v41, v99, v98, s71
    v_perm_b32 v34, v101, v100, s70
    v_perm_b32 v42, v101, v100, s71
    v_perm_b32 v35, v103, v102, s70
    v_perm_b32 v43, v103, v102, s71
    s_waitcnt lgkmcnt(0)
    v_perm_b32 v36, v81, v80, s70
    v_perm_b32 v44, v81, v80, s71
    v_perm_b32 v37, v83, v82, s70
    v_perm_b32 v45, v83, v82, s71
    v_perm_b32 v38, v85, v84, s70
    v_perm_b32 v46, v85, v84, s71
    v_perm_b32 v39, v87, v86, s70
    v_perm_b32 v47, v87, v86, s71
    v_add_u32 v12, 130944, v1
    s_mov_b32 s59, 0
Lw_51:
    ds_read_b32 v4, v3 offset:36
    s_waitcnt lgkmcnt(0)
    v_cmp_gt_u32 vcc, 16, v4
    s_cbranch_vccz Lk_52
    s_sleep 3
    s_add_u32 s59, s59, 1
    s_cmp_lt_u32 s59, 16777216
    s_cbranch_scc1 Lw_51
    s_branch L_end
Lk_52:
    ds_read_b128 v[80:83], v12 offset:0
    ds_read_b128 v[84:87], v12 offset:64
    ds_read_b128 v[88:91], v12 offset:128
    ds_read_b128 v[92:95], v12 offset:192
    ds_read_b128 v[96:99], v12 offset:256
    ds_read_b128 v[100:103], v12 offset:320
    s_waitcnt vmcnt(14) lgkmcnt(5)
    v_mfma_f32_16x16x32_bf16 v[104:107], v[80:83], v[16:19], v[104:107]
    v_mfma_f32_16x16x32_bf16 v[108:111], v[80:83], v[24:27], v[108:111]
    ds_read_b128 v[80:83], v12 offset:384
    s_waitcnt vmcnt(12) lgkmcnt(5)
    v_mfma_f32_16x16x32_bf16 v[104:107], v[84:87], v[20:23], v[104:107]
    v_mfma_f32_16x16x32_bf16 v[108:111], v[84:87], v[28:31], v[108:111]
    ds_read_b128 v[84:87], v12 offset:448
    s_waitcnt vmcnt(10) lgkmcnt(5)
    v_mfma_f32_16x16x32_bf16 v[104:107], v[88:91], v[32:35], v[104:107]
    v_mfma_f32_16x16x32_bf16 v[108:111], v[88:91], v[40:43], v[108:111]
    s_waitcnt vmcnt(8) lgkmcnt(4)
    v_mfma_f32_16x16x32_bf16 v[104:107], v[92:95], v[36:39], v[104:107]
    v_mfma_f32_16x16x32_bf16 v[108:111], v[92:95], v[44:47], v[108:111]
    s_waitcnt vmcnt(6) lgkmcnt(3)
    v_mfma_f32_16x16x32_bf16 v[104:107], v[96:99], v[48:51], v[104:107]
    v_mfma_f32_16x16x32_bf16 v[108:111], v[96:99], v[56:59], v[108:111]
    s_waitcnt vmcnt(4) lgkmcnt(2)
    v_mfma_f32_16x16x32_bf16 v[104:107], v[100:103], v[52:55], v[104:107]
    v_mfma_f32_16x16x32_bf16 v[108:111], v[100:103], v[60:63], v[108:111]
    s_waitcnt vmcnt(2) lgkmcnt(1)
    v_mfma_f32_16x16x32_bf16 v[104:107], v[80:83], v[64:67], v[104:107]
    v_mfma_f32_16x16x32_bf16 v[108:111], v[80:83], v[72:75], v[108:111]
    s_waitcnt vmcnt(0) lgkmcnt(0)
    v_mfma_f32_16x16x32_bf16 v[104:107], v[84:87], v[68:71], v[104:107]
    v_mfma_f32_16x16x32_bf16 v[108:111], v[84:87], v[76:79], v[108:111]
    s_nop 7
    v_cvt_pk_bf16_f32 v104, v104, v108
    buffer_store_dword v104, v8, s[20:23], s60 offen offset:0 sc1
    v_cvt_pk_bf16_f32 v105, v105, v109
    buffer_store_dword v105, v8, s[20:23], s60 offen offset:512 sc1
    v_cvt_pk_bf16_f32 v106, v106, v110
    buffer_store_dword v106, v8, s[20:23], s60 offen offset:1024 sc1
    v_cvt_pk_bf16_f32 v107, v107, v111
    buffer_store_dword v107, v8, s[20:23], s60 offen offset:1536 sc1
    s_add_u32 s60, s60, 8192
    s_mov_b32 s59, 0
Lw_53:
    ds_read_b32 v4, v3 offset:40
    s_waitcnt lgkmcnt(0)
    v_cmp_gt_u32 vcc, 16, v4
    s_cbranch_vccz Lk_54
    s_sleep 3
    s_add_u32 s59, s59, 1
    s_cmp_lt_u32 s59, 16777216
    s_cbranch_scc1 Lw_53
    s_branch L_end
Lk_54:
    ds_read_b128 v[80:83], v12 offset:8448
    ds_read_b128 v[84:87], v12 offset:8512
    ds_read_b128 v[88:91], v12 offset:8576
    ds_read_b128 v[92:95], v12 offset:8640
    ds_read_b128 v[96:99], v12 offset:8704
    ds_read_b128 v[100:103], v12 offset:8768
    s_waitcnt lgkmcnt(5)
    v_mfma_f32_16x16x32_bf16 v[112:115], v[80:83], v[16:19], v[112:115]
    v_mfma_f32_16x16x32_bf16 v[116:119], v[80:83], v[24:27], v[116:119]
    ds_read_b128 v[80:83], v12 offset:8832
    s_waitcnt lgkmcnt(5)
    v_mfma_f32_16x16x32_bf16 v[112:115], v[84:87], v[20:23], v[112:115]
    v_mfma_f32_16x16x32_bf16 v[116:119], v[84:87], v[28:31], v[116:119]
    ds_read_b128 v[84:87], v12 offset:8896
    s_waitcnt lgkmcnt(5)
    v_mfma_f32_16x16x32_bf16 v[112:115], v[88:91], v[32:35], v[112:115]
    v_mfma_f32_16x16x32_bf16 v[116:119], v[88:91], v[40:43], v[116:119]
    s_waitcnt lgkmcnt(4)
    v_mfma_f32_16x16x32_bf16 v[112:115], v[92:95], v[36:39], v[112:115]
    v_mfma_f32_16x16x32_bf16 v[116:119], v[92:95], v[44:47], v[116:119]
    s_waitcnt lgkmcnt(3)
    v_mfma_f32_16x16x32_bf16 v[112:115], v[96:99], v[48:51], v[112:115]
    v_mfma_f32_16x16x32_bf16 v[116:119], v[96:99], v[56:59], v[116:119]
    s_waitcnt lgkmcnt(2)
    v_mfma_f32_16x16x32_bf16 v[112:115], v[100:103], v[52:55], v[112:115]
    v_mfma_f32_16x16x32_bf16 v[116:119], v[100:103], v[60:63], v[116:119]
    s_waitcnt lgkmcnt(1)
    v_mfma_f32_16x16x32_bf16 v[112:115], v[80:83], v[64:67], v[112:115]
    v_mfma_f32_16x16x32_bf16 v[116:119], v[80:83], v[72:75], v[116:119]
    s_waitcnt lgkmcnt(0)
    v_mfma_f32_16x16x32_bf16 v[112:115], v[84:87], v[68:71], v[112:115]
    v_mfma_f32_16x16x32_bf16 v[116:119], v[84:87], v[76:79], v[116:119]
    s_nop 7
    v_cvt_pk_bf16_f32 v112, v112, v116
    buffer_store_dword v112, v8, s[20:23], s60 offen offset:0 sc1
    v_cvt_pk_bf16_f32 v113, v113, v117
    buffer_store_dword v113, v8, s[20:23], s60 offen offset:512 sc1
    v_cvt_pk_bf16_f32 v114, v114, v118
    buffer_store_dword v114, v8, s[20:23], s60 offen offset:1024 sc1
    v_cvt_pk_bf16_f32 v115, v115, v119
    buffer_store_dword v115, v8, s[20:23], s60 offen offset:1536 sc1
    s_add_u32 s60, s60, 8192
    v_and_b32 v5, 3, v0
    v_mul_u32_u24 v12, 1056, v5
    v_and_b32 v5, 8, v0
    v_lshl_add_u32 v12, v5, 6, v12
    v_and_b32 v5, 48, v0
    v_lshl_add_u32 v12, v5, 1, v12
    v_and_b32 v6, 15, v0
    v_lshlrev_b32 v6, 2, v6
    v_lshl_add_u32 v9, v5, 6, v6
    v_and_b32 v5, 4, v0
    v_lshl_add_u32 v12, v5, 2, v12
    v_add_u32 v12, 147840, v12
    v_mul_u32_u24 v13, 21845, v5
    v_lshrrev_b32 v13, 1, v13
    v_add_u32 v13, 0x4444, v13
    s_mov_b32 exec_lo, 0xffff0000
    s_mov_b32 exec_hi, 0xffff0000
    v_mov_b64 v[120:121], 0
    v_mov_b64 v[122:123], 0
    v_mov_b64 v[124:125], 0
    v_mov_b64 v[126:127], 0
    s_mov_b64 exec, -1
    s_mov_b32 s59, 0
Lw_55:
    ds_read_b32 v4, v3 offset:44
    s_waitcnt lgkmcnt(0)
    v_cmp_gt_u32 vcc, 8, v4
    s_cbranch_vccz Lk_56
    s_add_u32 s59, s59, 1
    s_cmp_lt_u32 s59, 16777216
    s_cbranch_scc1 Lw_55
    s_branch L_end
Lk_56:
    ds_read_b128 v[80:83], v12 offset:0
    ds_read_b128 v[84:87], v12 offset:128
    ds_read_b128 v[88:91], v12 offset:256
    ds_read_b128 v[92:95], v12 offset:384
    s_waitcnt lgkmcnt(3)
    v_smfmac_f32_16x16x64_bf16 v[120:123], v[80:83], v[16:23], v13
    v_smfmac_f32_16x16x64_bf16 v[124:127], v[80:83], v[24:31], v13
    s_waitcnt lgkmcnt(2)
    v_smfmac_f32_16x16x64_bf16 v[120:123], v[84:87], v[32:39], v13
    v_smfmac_f32_16x16x64_bf16 v[124:127], v[84:87], v[40:47], v13
    s_waitcnt lgkmcnt(1)
    v_smfmac_f32_16x16x64_bf16 v[120:123], v[88:91], v[48:55], v13
    v_smfmac_f32_16x16x64_bf16 v[124:127], v[88:91], v[56:63], v13
    s_waitcnt lgkmcnt(0)
    v_smfmac_f32_16x16x64_bf16 v[120:123], v[92:95], v[64:71], v13
    v_smfmac_f32_16x16x64_bf16 v[124:127], v[92:95], v[72:79], v13
    s_nop 6
    v_permlane16_swap_b32 v120, v122
    v_permlane16_swap_b32 v121, v123
    v_permlane16_swap_b32 v124, v126
    v_permlane16_swap_b32 v125, v127
    v_pk_add_f32 v[120:121], v[120:121], v[122:123]
    v_pk_add_f32 v[124:125], v[124:125], v[126:127]
    v_cvt_pk_bf16_f32 v120, v120, v124
    buffer_store_dword v120, v9, s[20:23], s60 offen offset:0 sc1
    v_cvt_pk_bf16_f32 v121, v121, v125
    buffer_store_dword v121, v9, s[20:23], s60 offen offset:512 sc1
L_end:
L_exit:
    s_endpgm
L_slow:
    s_setprio 0
    s_mov_b64 exec, 1
    ds_add_u32 v3, v62 offset:16
    s_mov_b64 exec, -1
    s_mov_b32 s59, 0
Lw_57:
    ds_read_b32 v4, v3 offset:16
    s_waitcnt lgkmcnt(0)
    v_cmp_gt_u32 vcc, 8, v4
    s_cbranch_vccz Lk_58
    s_add_u32 s59, s59, 1
    s_cmp_lt_u32 s59, 4194304
    s_cbranch_scc1 Lw_57
    s_branch L_end
Lk_58:
    v_mov_b32 v12, v3
    s_mov_b64 s[24:25], s[34:35]
    s_mov_b32 s26, 640000
    s_mov_b64 s[28:29], s[36:37]
    s_mov_b32 s30, 640000
    s_mov_b64 s[12:13], s[42:43]
    s_mov_b32 s14, 20000
    s_mov_b32 s15, 0x20000
    s_sub_u32 s63, s67, 1
    s_mov_b32 s65, 201486784
    s_mov_b32 s64, 0
    s_call_b64 s[68:69], L_flush
    s_add_u32 s66, s4, s5
    s_add_u32 s67, s66, 40
    v_lshlrev_b32 v16, 2, v0
    v_and_b32 v17, 32, v0
    v_lshl_add_u32 v17, v17, 22, v2
    v_mov_b32 v24, 0
L_sn:
    s_mov_b32 s60, 0
L_sc:
    buffer_load_dword v18, v16, s[28:31], s60 offen
    buffer_load_dword v19, v16, s[24:27], s60 offen
    s_waitcnt vmcnt(0)
    v_cmp_eq_u32 vcc, s66, v18
    s_cbranch_vccz L_sx
L_se:
    s_ff1_i32_b64 s58, vcc
    s_bitset0_b64 vcc, s58
    v_readlane_b32 s59, v19, s58
    s_nop 3
    s_lshl_b32 s61, s59, 9
    s_lshl_b32 s59, s59, 1
    buffer_load_dwordx4 v[20:23], v17, s[8:11], s61 offen
    buffer_load_ushort v1, v24, s[12:15], s59 offen
    s_waitcnt vmcnt(0)
    v_perm_b32 v6, v1, v1, v10
    v_perm_b32 v7, v1, v1, v11
    s_nop 1
    v_mfma_f32_4x4x4_16b_bf16 v[56:59], v[6:7], v[20:21], v[56:59]
    v_mfma_f32_4x4x4_16b_bf16 v[60:63], v[6:7], v[22:23], v[60:63]
    s_cmp_lg_u64 vcc, 0
    s_cbranch_scc1 L_se
L_sx:
    s_add_u32 s60, s60, 256
    s_cmp_lt_u32 s60, 640000
    s_cbranch_scc1 L_sc
    s_call_b64 s[68:69], L_flush
    s_add_u32 s66, s66, 8
    s_cmp_lt_u32 s66, s67
    s_cbranch_scc1 L_sn
    s_branch L_gdone
.section .rodata,"a"
.p2align 6
.amdhsa_kernel standalone__hybrid_graph_tf_exphormer__graph_kernel
  .amdhsa_next_free_vgpr 128
  .amdhsa_next_free_sgpr 102
  .amdhsa_accum_offset 128
  .amdhsa_group_segment_fixed_size 0
  .amdhsa_kernarg_size 104
  .amdhsa_user_sgpr_count 2
  .amdhsa_user_sgpr_kernarg_segment_ptr 1
  .amdhsa_system_sgpr_workgroup_id_x 1
.end_amdhsa_kernel
```

```asm
; @launch grid=(250,1,1) block=(1024,1,1) lds=162240
.amdgcn_target "amdgcn-amd-amdhsa--gfx950"
.text
.globl standalone__hybrid_graph_tf_exphormer__graph_kernel
.p2align 8
.type standalone__hybrid_graph_tf_exphormer__graph_kernel,@function
standalone__hybrid_graph_tf_exphormer__graph_kernel:
    s_cmpk_ge_u32 s2, 250
    s_cbranch_scc1 L_exit
    s_load_dwordx16 s[32:47], s[0:1], 0
    s_load_dwordx8 s[48:55], s[0:1], 64
    s_load_dwordx2 s[56:57], s[0:1], 96
    s_getpc_b64 s[60:61]
    s_lshr_b32 s6, s2, 3
    v_lshl_add_u32 v1, v0, 5, s6
    v_lshlrev_b32 v2, 7, v1
    v_cmpx_gt_u32 vcc, 91, v1
    s_cbranch_execz L_nopf
    global_load_dword v15, v2, s[60:61] offset:384
L_nopf:
    s_mov_b64 exec, -1
    v_lshrrev_b32 v1, 6, v0
    v_lshlrev_b32 v5, 4, v0
    v_and_b32 v6, 32, v0
    v_readfirstlane_b32 s3, v1
    v_and_b32 v2, 0x1f0, v5
    s_and_b32 s4, s3, 7
    s_and_b32 s61, s3, 4
    s_add_u32 s61, s61, s4
    s_mul_i32 s101, s4, 1056
    s_cmp_ge_u32 s3, 8
    s_cbranch_scc1 L_eA
    s_setprio 3
    s_sub_u32 s62, s2, 64
    s_cbranch_scc0 L_eM
    s_mul_i32 s58, s2, 10000
    v_add_u32 v8, s58, v5
    v_min_u32 v9, 451, v0
    s_addk_i32 s58, 8192
    v_lshl_add_u32 v9, v9, 2, s58
    s_mov_b32 s63, 1
    s_waitcnt lgkmcnt(0)
    global_load_dwordx4 v[22:25], v8, s[36:37]
    global_load_dword v26, v9, s[36:37]
    s_setprio 2
    global_load_dwordx4 v[16:19], v8, s[34:35]
    global_load_dword v20, v9, s[34:35]
    s_branch L_eB
L_eM:
    s_cmpk_ge_u32 s62, 128
    s_cbranch_scc1 L_eW
    s_mov_b32 s63, 0
    s_cmp_ge_u32 s4, 4
    s_cbranch_scc1 L_eBw
    v_lshl_add_u32 v8, v6, 8, v2
    v_lshl_add_u32 v8, s61, 9, v8
    s_lshr_b32 s58, s62, 4
    s_bfe_u32 s59, s62, 0x10003
    s_lshl3_add_u32 s58, s58, s59
    v_lshl_add_u32 v9, s58, 11, v8
    s_and_b32 s58, s62, 7
    v_lshl_add_u32 v8, s58, 14, v8
    s_add_u32 m0, s101, 105600
    s_waitcnt lgkmcnt(0)
    global_load_lds_dwordx4 v8, s[46:47]
    s_addk_i32 m0, 6400
    s_mov_b32 s63, 2
    global_load_lds_dwordx4 v8, s[46:47] offset:2048
    s_addk_i32 m0, 10496
    s_nop 0
    global_load_lds_dwordx4 v9, s[48:49]
    s_addk_i32 m0, 4224
    v_add_u32 v9, 4096, v9
    global_load_lds_dwordx4 v9, s[48:49]
    s_addk_i32 m0, 48640
    v_add_u32 v8, 4096, v8
    global_load_lds_dwordx4 v8, s[46:47]
    s_addk_i32 m0, 6400
    s_nop 0
    global_load_lds_dwordx4 v8, s[46:47] offset:2048
    s_branch L_eB
L_eA:
    s_and_b32 s59, s2, 7
    s_mul_i32 s60, s59, 31
    s_min_u32 s59, s59, 2
    s_add_u32 s6, s6, s60
    s_add_u32 s6, s6, s59
    s_mul_i32 s5, s6, 40
    s_lshl_b32 s58, s5, 4
    s_lshl3_add_u32 s59, s61, s58
    s_lshl_b32 s60, s4, 6
    s_add_u32 s58, s58, s60
    s_add_u32 s60, s5, s4
    v_lshl_add_u32 v8, s60, 9, v2
    v_lshl_add_u32 v9, v6, 7, v8
    s_add_u32 m0, s101, 84480
    s_waitcnt lgkmcnt(0)
    s_load_dwordx16 s[12:27], s[38:39], s58
    s_load_dwordx2 s[28:29], s[38:39], s59 offset:512
    s_load_dwordx2 s[30:31], s[38:39], s59 offset:544
    s_load_dword s40, s[56:57], 655616
    s_barrier
    global_load_lds_dwordx4 v9, s[32:33]
    s_addk_i32 m0, 8448
    v_add_u32 v9, 8192, v9
    global_load_lds_dwordx4 v9, s[32:33]
    s_cmp_ge_u32 s4, 4
    s_cbranch_scc1 L_preA
    s_addk_i32 m0, 8448
    v_lshl_add_u32 v9, v6, 6, v8
    v_add_u32 v9, 16384, v9
    global_load_lds_dwordx4 v9, s[32:33]
    s_branch L_preA
L_eW:
    s_mul_i32 s58, s4, 58
    s_add_u32 s62, s62, s58
    s_sub_u32 s62, s62, 128
    s_mov_b32 s63, 0
    s_cmp_ge_u32 s62, 96
    s_waitcnt lgkmcnt(0)
    s_cbranch_scc1 L_eB
    s_and_b32 s59, s62, 28
    s_add_u32 s59, s59, 4
    s_cmp_ge_u32 s62, 64
    s_cselect_b32 s59, s59, 0
    s_add_u32 s62, s62, s59
    s_mov_b32 s63, 4
    s_and_b32 s59, s62, 7
    s_lshl_b32 s59, s59, 14
    s_bfe_u32 s60, s62, 0x30003
    s_lshl_b32 s60, s60, 6
    s_add_u32 s59, s59, s60
    v_and_b32 v8, 15, v0
    v_lshl_add_u32 v8, v8, 2, s59
    v_and_b32 v9, 48, v0
    v_lshl_add_u32 v8, v9, 8, v8
    s_cmp_lt_u32 s62, 64
    s_cselect_b64 s[58:59], s[50:51], s[44:45]
    global_load_dword v16, v8, s[58:59] offset:0
    global_load_dword v17, v8, s[58:59] offset:512
    global_load_dword v18, v8, s[58:59] offset:1024
    global_load_dword v19, v8, s[58:59] offset:1536
    global_load_dword v20, v8, s[58:59] offset:2048
    global_load_dword v21, v8, s[58:59] offset:2560
    global_load_dword v22, v8, s[58:59] offset:3072
    global_load_dword v23, v8, s[58:59] offset:3584
L_eBw:
    s_waitcnt lgkmcnt(0)
L_eB:
    s_setprio 3
    v_mov_b32 v8, 33554432
    v_cmp_gt_u32 vcc, 320, v0
    v_add_u32 v4, 152064, v5
    v_mov_b64 v[12:13], 0
    v_cndmask_b32 v8, 0, v8, vcc
    v_mov_b32 v9, v8
    v_mov_b64 v[10:11], v[8:9]
    ds_write_b128 v4, v[8:11]
    v_cmpx_gt_u32 vcc, 60, v0
    ds_write_b64 v4, v[12:13] offset:8192
    ds_write_b64 v4, v[12:13] offset:8200
    s_mov_b64 exec, -1
    s_and_b32 s59, s2, 7
    s_mul_i32 s60, s59, 31
    s_min_u32 s59, s59, 2
    s_add_u32 s6, s6, s60
    s_add_u32 s6, s6, s59
    s_mul_i32 s5, s6, 40
    s_waitcnt lgkmcnt(0)
    s_barrier
    v_and_b32 v0, 63, v0
    s_xor_b32 s3, s3, 8
    v_mov_b32 v3, 160064
    s_mov_b64 s[8:9], s[32:33]
    s_mov_b32 s10, 5120000
    s_mov_b32 s11, 0x20000
    s_mov_b64 s[16:17], s[56:57]
    s_mov_b32 s18, 1441792
    s_mov_b32 s19, 0x20000
    s_mov_b32 s27, 0x20000
    s_mov_b32 s31, 0x20000
    v_mov_b32 v62, 1
    s_cmp_eq_u32 s63, 1
    s_cbranch_scc0 L_notprod
    v_mov_b32 v9, 4
    v_mov_b32 v10, 160192
    v_lshl_add_u32 v11, v0, 4, v10
    v_cmp_gt_u32 vcc, 7232, v5
    v_add_u32 v59, 105600, v5
    s_mul_i32 s58, s2, 10240
    s_mov_b64 s[66:67], vcc
    s_waitcnt vmcnt(3)
    v_mul_u32_u24 v28, 52429, v22
    v_lshrrev_b32 v28, 21, v28
    v_lshl_add_u32 v28, v28, 2, v10
    ds_add_rtn_u32 v34, v28, v9
    v_mul_u32_u24 v29, 52429, v23
    v_lshrrev_b32 v29, 21, v29
    v_lshl_add_u32 v29, v29, 2, v10
    ds_add_rtn_u32 v35, v29, v9
    v_mul_u32_u24 v30, 52429, v24
    v_lshrrev_b32 v30, 21, v30
    v_lshl_add_u32 v30, v30, 2, v10
    ds_add_rtn_u32 v36, v30, v9
    v_mul_u32_u24 v31, 52429, v25
    v_lshrrev_b32 v31, 21, v31
    v_lshl_add_u32 v31, v31, 2, v10
    ds_add_rtn_u32 v37, v31, v9
    s_waitcnt vmcnt(2)
    s_mov_b64 exec, s[66:67]
    v_mul_u32_u24 v32, 52429, v26
    v_lshrrev_b32 v32, 21, v32
    v_lshl_add_u32 v32, v32, 2, v10
    ds_add_rtn_u32 v38, v32, v9
    s_mov_b64 exec, -1
    s_waitcnt lgkmcnt(0)
    s_barrier
    ds_read_b128 v[12:15], v11
    s_waitcnt lgkmcnt(0)
    v_add_u32 v56, v12, v13
    v_add3_u32 v57, v56, v14, v15
    s_nop 1
    v_add_u32_dpp v58, v57, v57 row_shr:1 row_mask:0xf bank_mask:0xf bound_ctrl:1
    s_nop 1
    v_add_u32_dpp v58, v58, v58 row_shr:2 row_mask:0xf bank_mask:0xf bound_ctrl:1
    s_nop 1
    v_add_u32_dpp v58, v58, v58 row_shr:4 row_mask:0xf bank_mask:0xf bound_ctrl:1
    s_nop 1
    v_add_u32_dpp v58, v58, v58 row_shr:8 row_mask:0xf bank_mask:0xf bound_ctrl:1
    s_nop 1
    v_add_u32_dpp v58, v58, v58 row_bcast:15 row_mask:0xa bank_mask:0xf
    s_nop 1
    v_add_u32_dpp v58, v58, v58 row_bcast:31 row_mask:0xc bank_mask:0xf
    v_sub_u32 v64, v58, v57
    v_add_u32 v65, v64, v12
    v_add_u32 v66, v64, v56
    v_add_u32 v67, v66, v14
    ds_write_b128 v11, v[64:67] offset:1024
    ds_read_b32 v40, v28 offset:1024
    ds_read_b32 v41, v29 offset:1024
    ds_read_b32 v42, v30 offset:1024
    ds_read_b32 v43, v31 offset:1024
    s_mov_b64 exec, s[66:67]
    ds_read_b32 v44, v32 offset:1024
    s_mov_b64 exec, -1
    s_mov_b32 s60, 105600
    s_waitcnt vmcnt(0)
    v_lshl_or_b32 v16, v22, 16, v16
    v_lshl_or_b32 v17, v23, 16, v17
    v_lshl_or_b32 v18, v24, 16, v18
    v_lshl_or_b32 v19, v25, 16, v19
    v_lshl_or_b32 v20, v26, 16, v20
    s_waitcnt lgkmcnt(4)
    v_add3_u32 v40, v40, v34, s60
    ds_write_b32 v40, v16
    s_waitcnt lgkmcnt(4)
    v_add3_u32 v41, v41, v35, s60
    ds_write_b32 v41, v17
    s_waitcnt lgkmcnt(4)
    v_add3_u32 v42, v42, v36, s60
    ds_write_b32 v42, v18
    s_waitcnt lgkmcnt(4)
    v_add3_u32 v43, v43, v37, s60
    ds_write_b32 v43, v19
    s_mov_b64 exec, s[66:67]
    s_waitcnt lgkmcnt(4)
    v_add3_u32 v44, v44, v38, s60
    ds_write_b32 v44, v20
    s_mov_b64 exec, -1
    s_waitcnt lgkmcnt(0)
    s_barrier
    ds_read_b128 v[12:15], v59
    ds_read_b128 v[68:71], v59 offset:8192
    s_add_u32 s60, s58, 8192
    s_cmp_ge_u32 s4, 2
    s_waitcnt lgkmcnt(1)
    buffer_store_dwordx4 v[12:15], v5, s[16:19], s58 offen sc1
    s_cbranch_scc1 L_cp1
    s_waitcnt lgkmcnt(0)
    buffer_store_dwordx4 v[68:71], v5, s[16:19], s60 offen sc1
L_cp1:
    s_cmp_eq_u32 s4, 0
    s_cbranch_scc1 L_row
    s_waitcnt vmcnt(0)
    s_mov_b64 exec, 1
    ds_add_u32 v3, v62 offset:56
    s_mov_b64 exec, -1
    s_branch L_preB
L_row:
    s_lshl_b32 s61, s2, 10
    s_add_u32 s61, s61, 1114112
    s_mov_b32 s59, 0
Lw_1:
    ds_read_b32 v4, v3 offset:68
    s_waitcnt lgkmcnt(0)
    v_cmp_gt_u32 vcc, 1, v4
    s_cbranch_vccz Lk_2
    s_add_u32 s59, s59, 1
    s_cmp_lt_u32 s59, 4194304
    s_cbranch_scc1 Lw_1
    s_branch L_end
Lk_2:
    v_readfirstlane_b32 s40, v4
    s_nop 0
    s_bitset0_b32 s40, 0
    v_lshrrev_b32 v64, 2, v64
    v_or_b32 v64, s40, v64
    v_lshrrev_b32 v65, 2, v65
    v_or_b32 v65, s40, v65
    v_lshrrev_b32 v66, 2, v66
    v_or_b32 v66, s40, v66
    v_lshrrev_b32 v67, 2, v67
    v_or_b32 v67, s40, v67
    s_mov_b32 s59, 0
Lw_3:
    ds_read_b32 v4, v3 offset:56
    s_waitcnt lgkmcnt(0)
    v_cmp_gt_u32 vcc, 7, v4
    s_cbranch_vccz Lk_4
    s_add_u32 s59, s59, 1
    s_cmp_lt_u32 s59, 4194304
    s_cbranch_scc1 Lw_3
    s_branch L_end
Lk_4:
    s_waitcnt vmcnt(0)
    buffer_store_dwordx4 v[64:67], v5, s[16:19], s61 offen sc1
    ds_write_b32 v3, v62 offset:32
    s_branch L_preB
L_notprod:
    s_cmp_eq_u32 s63, 0
    s_cbranch_scc1 L_taskw
    v_and_b32 v4, 7, v0
    v_mul_u32_u24 v1, 1056, v4
    v_and_b32 v4, 8, v0
    v_lshl_add_u32 v1, v4, 6, v1
    v_and_b32 v4, 48, v0
    v_add_u32 v1, v4, v1
    v_add_u32 v5, 105600, v1
    s_lshr_b32 s58, s62, 4
    s_and_b32 s59, s62, 7
    s_lshl3_add_u32 s58, s58, s59
    s_bfe_u32 s59, s62, 0x10003
    s_lshl1_add_u32 s58, s58, s59
    s_lshl_b32 s58, s58, 10
    s_add_u32 s58, s58, 720896
    v_lshlrev_b32 v6, 4, v0
    s_waitcnt vmcnt(0)
    s_cmp_eq_u32 s63, 4
    s_cbranch_scc1 L_wtask
    s_cmp_eq_u32 s4, 0
    s_cbranch_scc0 L_taskw
    s_mov_b32 s59, 0
Lw_5:
    ds_read_b32 v4, v3 offset:56
    s_waitcnt lgkmcnt(0)
    v_cmp_gt_u32 vcc, 7, v4
    s_cbranch_vccz Lk_6
    s_add_u32 s59, s59, 1
    s_cmp_lt_u32 s59, 4194304
    s_cbranch_scc1 Lw_5
    s_branch L_end
Lk_6:
    ds_read_b128 v[16:19], v5 offset:0
    ds_read_b128 v[20:23], v5 offset:8448
    ds_read_b128 v[24:27], v5 offset:16896
    ds_read_b128 v[28:31], v5 offset:64
    ds_read_b128 v[32:35], v5 offset:8512
    ds_read_b128 v[36:39], v5 offset:16960
    ds_read_b128 v[40:43], v5 offset:128
    ds_read_b128 v[44:47], v5 offset:8576
    ds_read_b128 v[48:51], v5 offset:17024
    ds_read_b128 v[64:67], v5 offset:192
    ds_read_b128 v[68:71], v5 offset:8640
    ds_read_b128 v[72:75], v5 offset:17088
    s_waitcnt lgkmcnt(9)
    ds_read_b128 v[76:79], v5 offset:256
    ds_read_b128 v[80:83], v5 offset:8704
    ds_read_b128 v[84:87], v5 offset:17152
    v_mfma_f32_16x16x32_bf16 v[8:11], v[16:19], v[24:27], 0
    v_mfma_f32_16x16x32_bf16 v[12:15], v[20:23], v[24:27], 0
    s_waitcnt lgkmcnt(9)
    ds_read_b128 v[88:91], v5 offset:320
    ds_read_b128 v[92:95], v5 offset:8768
    ds_read_b128 v[96:99], v5 offset:17216
    v_mfma_f32_16x16x32_bf16 v[8:11], v[28:31], v[36:39], v[8:11]
    v_mfma_f32_16x16x32_bf16 v[12:15], v[32:35], v[36:39], v[12:15]
    s_waitcnt lgkmcnt(9)
    ds_read_b128 v[100:103], v5 offset:384
    ds_read_b128 v[104:107], v5 offset:8832
    ds_read_b128 v[108:111], v5 offset:17280
    v_mfma_f32_16x16x32_bf16 v[8:11], v[40:43], v[48:51], v[8:11]
    v_mfma_f32_16x16x32_bf16 v[12:15], v[44:47], v[48:51], v[12:15]
    s_waitcnt lgkmcnt(9)
    ds_read_b128 v[112:115], v5 offset:448
    ds_read_b128 v[116:119], v5 offset:8896
    ds_read_b128 v[120:123], v5 offset:17344
    v_mfma_f32_16x16x32_bf16 v[8:11], v[64:67], v[72:75], v[8:11]
    v_mfma_f32_16x16x32_bf16 v[12:15], v[68:71], v[72:75], v[12:15]
    s_waitcnt lgkmcnt(9)
    v_mfma_f32_16x16x32_bf16 v[8:11], v[76:79], v[84:87], v[8:11]
    v_mfma_f32_16x16x32_bf16 v[12:15], v[80:83], v[84:87], v[12:15]
    s_waitcnt lgkmcnt(6)
    v_mfma_f32_16x16x32_bf16 v[8:11], v[88:91], v[96:99], v[8:11]
    v_mfma_f32_16x16x32_bf16 v[12:15], v[92:95], v[96:99], v[12:15]
    s_waitcnt lgkmcnt(3)
    v_mfma_f32_16x16x32_bf16 v[8:11], v[100:103], v[108:111], v[8:11]
    v_mfma_f32_16x16x32_bf16 v[12:15], v[104:107], v[108:111], v[12:15]
    s_waitcnt lgkmcnt(0)
    v_mfma_f32_16x16x32_bf16 v[8:11], v[112:115], v[120:123], v[8:11]
    v_mfma_f32_16x16x32_bf16 v[12:15], v[116:119], v[120:123], v[12:15]
    s_nop 6
    v_cvt_pk_bf16_f32 v16, v8, v9
    v_cvt_pk_bf16_f32 v17, v10, v11
    v_cvt_pk_bf16_f32 v18, v12, v13
    v_cvt_pk_bf16_f32 v19, v14, v15
    buffer_store_dwordx4 v[16:19], v6, s[16:19], s58 offen sc1
    s_branch L_flag
L_wtask:
    s_lshl_b32 s58, s62, 11
    s_add_u32 s58, s58, 851968
    s_mov_b32 s70, 0x05040100
    s_mov_b32 s71, 0x07060302
    v_perm_b32 v64, v17, v16, s70
    v_perm_b32 v68, v17, v16, s71
    v_perm_b32 v65, v19, v18, s70
    v_perm_b32 v69, v19, v18, s71
    v_perm_b32 v66, v21, v20, s70
    v_perm_b32 v70, v21, v20, s71
    v_perm_b32 v67, v23, v22, s70
    v_perm_b32 v71, v23, v22, s71
    buffer_store_dwordx4 v[64:67], v6, s[16:19], s58 offen sc1
    buffer_store_dwordx4 v[68:71], v6, s[16:19], s58 offen offset:1024 sc1
    s_cmp_eq_u32 s4, 0
    s_cbranch_scc1 L_flag
    s_waitcnt vmcnt(0)
L_taskw:
    s_mov_b64 exec, 1
    ds_add_u32 v3, v62 offset:56
    s_mov_b64 exec, -1
    s_branch L_preB
L_flag:
    s_mov_b32 s59, 0
Lw_7:
    ds_read_b32 v4, v3 offset:68
    s_waitcnt lgkmcnt(0)
    v_cmp_gt_u32 vcc, 1, v4
    s_cbranch_vccz Lk_8
    s_add_u32 s59, s59, 1
    s_cmp_lt_u32 s59, 4194304
    s_cbranch_scc1 Lw_7
    s_branch L_end
Lk_8:
    v_readfirstlane_b32 s40, v4
    s_nop 0
    s_bitset0_b32 s40, 0
    s_mul_i32 s61, s2, 16
    s_add_u32 s61, s61, 1178624
    v_mov_b32 v10, s40
    v_mov_b32 v11, s40
    v_lshlrev_b32 v9, 15, v0
    s_mov_b32 s59, 0
Lw_9:
    ds_read_b32 v4, v3 offset:56
    s_waitcnt lgkmcnt(0)
    v_cmp_gt_u32 vcc, 7, v4
    s_cbranch_vccz Lk_10
    s_add_u32 s59, s59, 1
    s_cmp_lt_u32 s59, 4194304
    s_cbranch_scc1 Lw_9
    s_branch L_end
Lk_10:
    s_waitcnt vmcnt(0)
    s_mov_b64 exec, 255
    buffer_store_dwordx2 v[10:11], v9, s[16:19], s61 offen sc1
    ds_write_b32 v3, v62 offset:32
    s_mov_b64 exec, -1
L_preB:
    s_setprio 3
    s_mov_b64 s[28:29], s[42:43]
    s_mov_b32 s30, 20000
    s_lshl_b32 s58, s4, 10
    v_lshlrev_b32 v5, 4, v0
    s_add_u32 m0, s58, 130944
    s_add_u32 s59, s58, 0
    buffer_load_dwordx4 v5, s[28:31], s59 offen lds
    s_add_u32 m0, s58, 139136
    s_add_u32 s59, s58, 8192
    buffer_load_dwordx4 v5, s[28:31], s59 offen lds
    s_cmp_lt_u32 s4, 4
    s_cbranch_scc1 L_disd
    s_add_u32 m0, s58, 143232
    s_add_u32 s59, s58, 12288
    buffer_load_dwordx4 v5, s[28:31], s59 offen lds
L_disd:
    s_mov_b64 s[24:25], s[44:45]
    s_mov_b32 s26, 131072
    s_setprio 1
    s_lshl_b32 s58, s4, 10
    s_mov_b32 s41, 0
    buffer_load_dwordx4 v[96:99], v5, s[24:27], s58 offen
    s_add_u32 s58, s58, 8192
    buffer_load_dwordx4 v[100:103], v5, s[24:27], s58 offen
    s_add_u32 s58, s58, 8192
    buffer_load_dwordx4 v[104:107], v5, s[24:27], s58 offen
    s_add_u32 s58, s58, 8192
    buffer_load_dwordx4 v[108:111], v5, s[24:27], s58 offen
    s_add_u32 s58, s58, 8192
    buffer_load_dwordx4 v[112:115], v5, s[24:27], s58 offen
    s_add_u32 s58, s58, 8192
    buffer_load_dwordx4 v[116:119], v5, s[24:27], s58 offen
    s_add_u32 s58, s58, 8192
    buffer_load_dwordx4 v[120:123], v5, s[24:27], s58 offen
    s_add_u32 s58, s58, 8192
    buffer_load_dwordx4 v[124:127], v5, s[24:27], s58 offen
    s_setprio 3
    v_and_b32 v4, 3, v0
    v_mov_b32 v5, 0x0c0c0c0c
    v_mov_b32 v6, 0x0c0c0302
    v_mov_b32 v7, 0x03020c0c
    v_cmp_eq_u32 s[58:59], 0, v4
    v_cmp_eq_u32 s[60:61], 2, v4
    v_cmp_eq_u32 vcc, 1, v4
    v_cndmask_b32 v10, v5, v6, s[58:59]
    v_cndmask_b32 v11, v5, v6, s[60:61]
    v_cndmask_b32 v10, v10, v7, vcc
    v_cmp_eq_u32 vcc, 3, v4
    s_nop 1
    v_cndmask_b32 v11, v11, v7, vcc
    v_and_b32 v10, 0xfdfdfdfd, v10
    v_and_b32 v11, 0xfdfdfdfd, v11
    s_movk_i32 s7, 512
    s_lshl_b32 s58, s4, 3
    v_lshrrev_b32 v5, 3, v0
    v_and_b32 v6, 7, v0
    v_add_u32 v7, s58, v5
    v_mul_u32_u24 v49, 10240, v7
    v_lshl_add_u32 v49, v6, 4, v49
    v_lshlrev_b32 v56, 2, v6
    s_lshl_b32 s60, s6, 2
    s_add_u32 s60, s60, 1114112
    v_lshl_add_u32 v54, v7, 10, s60
    v_mad_u32_u24 v7, v7, 3, v6
    v_cmp_ge_u32 vcc, 186, v7
    v_cmp_gt_u32 s[64:65], 4, v6
    v_mul_u32_u24 v7, 16, v7
    s_and_b64 s[64:65], s[64:65], vcc
    v_cmp_eq_u32 vcc, 0, v6
    s_and_b32 s58, s2, 7
    s_lshl_b32 s58, s58, 15
    s_add_u32 s58, s58, 1179632
    v_add_u32 v7, s58, v7
    s_or_b64 s[64:65], s[64:65], vcc
    v_cndmask_b32 v54, v7, v54, vcc
    v_cmp_gt_u32 s[62:63], 5, v6
    v_lshl_add_u32 v50, v6, 3, v5
    v_mul_u32_u24 v55, 80, v5
    v_add_u32 v55, 80, v55
    v_lshrrev_b32 v5, 4, v50
    v_mul_u32_u24 v9, 8448, v5
    v_lshl_add_u32 v9, v5, 26, v9
    v_cmp_le_u32 vcc, 32, v50
    v_and_b32 v5, 7, v50
    v_and_b32 v6, 3, v50
    v_cndmask_b32 v5, v5, v6, vcc
    v_mul_u32_u24 v5, 1056, v5
    v_bfe_u32 v6, v50, 3, 1
    v_bfe_u32 v7, v50, 2, 1
    v_cndmask_b32 v6, v6, v7, vcc
    v_lshl_add_u32 v5, v6, 9, v5
    v_mov_b32 v52, 130944
    v_add3_u32 v9, v9, v5, v52
    v_lshrrev_b32 v5, 5, v0
    v_lshl_add_u32 v15, v5, 3, v2
    s_lshl_b32 s58, s5, 2
    s_sub_u32 s58, 159744, s58
    v_mov_b32 v53, s58
    v_add_u32 v5, s5, v50
    v_lshl_add_u32 v8, v5, 1, v52
    v_lshlrev_b32 v50, 2, v50
    v_add_u32 v50, 159744, v50
    v_and_b32 v74, 0x1e0, v2
    v_and_b32 v5, 24, v15
    v_lshrrev_b32 v5, 1, v5
    v_add_u32 v74, v74, v5
    v_mov_b32 v57, 157184
    v_mov_b32 v60, 152064
    v_mov_b64 v[16:17], 0
    v_mov_b64 v[18:19], 0
    s_mov_b32 s59, 0
Lw_11:
    ds_read_b32 v4, v3 offset:32
    s_waitcnt lgkmcnt(0)
    v_cmp_gt_u32 vcc, 1, v4
    s_cbranch_vccz Lk_12
    s_sleep 2
    s_add_u32 s59, s59, 1
    s_cmp_lt_u32 s59, 4194304
    s_cbranch_scc1 Lw_11
    s_branch L_end
Lk_12:
    s_mov_b32 s59, 0
Lw_13:
    ds_read_b32 v4, v3 offset:68
    s_waitcnt lgkmcnt(0)
    v_cmp_gt_u32 vcc, 1, v4
    s_cbranch_vccz Lk_14
    s_add_u32 s59, s59, 1
    s_cmp_lt_u32 s59, 4194304
    s_cbranch_scc1 Lw_13
    s_branch L_end
Lk_14:
    v_readfirstlane_b32 s40, v4
    s_nop 0
    s_bitset0_b32 s40, 0
    s_mov_b32 s59, 0
Lw_15:
    ds_read_b32 v4, v3 offset:60
    s_waitcnt lgkmcnt(0)
    v_cmp_gt_u32 vcc, 8, v4
    s_cbranch_vccz Lk_16
    s_sleep 2
    s_add_u32 s59, s59, 1
    s_cmp_lt_u32 s59, 4194304
    s_cbranch_scc1 Lw_15
    s_branch L_end
Lk_16:
    s_mov_b32 s59, 0
    s_and_b32 exec_lo, s64, 0xfefefefe
    s_and_b32 exec_hi, s65, 0xfefefefe
L_spolla:
    buffer_load_dwordx2 v[58:59], v54, s[16:19], 0 offen sc1
    s_add_u32 s59, s59, 1
    s_cmp_gt_u32 s59, 0x40000
    s_cbranch_scc1 L_end
    s_waitcnt vmcnt(0)
    v_xor_b32 v58, s40, v58
    v_xor_b32 v59, s40, v59
    v_or_b32 v5, v58, v59
    v_cmpx_lt_u32 vcc, 4095, v5
    s_cbranch_execz L_soka
    s_sleep 8
    s_branch L_spolla
L_soka:
    s_mov_b64 exec, -1
    s_mov_b64 exec, 1
    ds_add_u32 v3, v62 offset:52
    s_mov_b64 exec, -1
    s_mov_b32 exec_lo, 0x01010101
    s_mov_b32 exec_hi, 0x01010101
L_spollb:
    buffer_load_dwordx2 v[58:59], v54, s[16:19], 0 offen sc1
    s_add_u32 s59, s59, 1
    s_cmp_gt_u32 s59, 0x40000
    s_cbranch_scc1 L_end
    s_waitcnt vmcnt(0)
    v_xor_b32 v58, s40, v58
    v_xor_b32 v59, s40, v59
    v_or_b32 v5, v58, v59
    v_cmpx_lt_u32 vcc, 4095, v5
    s_cbranch_execz L_sokb
    s_sleep 8
    s_branch L_spollb
L_sokb:
    s_mov_b64 exec, -1
    v_sub_u32 v48, v59, v58
    v_lshl_or_b32 v48, v48, 16, v58
    s_nop 1
    v_mov_b32_dpp v48, v48 quad_perm:[0,0,0,0] row_mask:0xf bank_mask:0xf
    s_nop 1
    v_mov_b32_dpp v48, v48 row_shr:4 row_mask:0xf bank_mask:0xa
    v_mad_u32_u16 v49, v48, 4, v49
    v_lshrrev_b32 v48, 16, v48
    v_sub_u32 v48, v48, v56
    v_cmpx_lt_i32 vcc, 0, v48
    s_cbranch_execz L_entld
    buffer_load_dwordx4 v[16:19], v49, s[16:19], 0 offen sc1
    v_cmpx_lt_i32 vcc, 32, v48
    ds_write_b32 v3, v62 offset:28
L_entld:
    s_mov_b64 exec, -1
    s_waitcnt vmcnt(0)
    v_cmpx_lt_i32 vcc, 0, v48
    v_mad_u32_u16 v24, v16, 4, v53 op_sel:[1,0,0,0]
    ds_add_rtn_u32 v32, v24, v62
    v_cmpx_lt_i32 vcc, 1, v48
    v_mad_u32_u16 v25, v17, 4, v53 op_sel:[1,0,0,0]
    ds_add_rtn_u32 v33, v25, v62
    v_cmpx_lt_i32 vcc, 2, v48
    v_mad_u32_u16 v26, v18, 4, v53 op_sel:[1,0,0,0]
    ds_add_rtn_u32 v34, v26, v62
    v_cmpx_lt_i32 vcc, 3, v48
    v_mad_u32_u16 v27, v19, 4, v53 op_sel:[1,0,0,0]
    ds_add_rtn_u32 v35, v27, v62
    s_mov_b64 exec, -1
    s_mov_b64 exec, 1
    ds_add_u32 v3, v62 offset:12
    s_mov_b64 exec, -1
    v_mad_u32_u16 v40, v16, 2, v52
    v_mad_u32_u16 v16, v16, s7, 0
    v_mad_u32_u16 v41, v17, 2, v52
    v_mad_u32_u16 v17, v17, s7, 0
    v_mad_u32_u16 v42, v18, 2, v52
    v_mad_u32_u16 v18, v18, s7, 0
    v_mad_u32_u16 v43, v19, 2, v52
    v_mad_u32_u16 v19, v19, s7, 0
    s_mov_b32 s59, 0
Lw_17:
    ds_read_b32 v4, v3 offset:12
    s_waitcnt lgkmcnt(0)
    v_cmp_gt_u32 vcc, 8, v4
    s_cbranch_vccz Lk_18
    s_add_u32 s59, s59, 1
    s_cmp_lt_u32 s59, 4194304
    s_cbranch_scc1 Lw_17
    s_branch L_end
Lk_18:
    ds_read_b32 v12, v50
    ds_read_b32 v5, v3 offset:28
    ds_read_u16 v8, v8
    ds_read_u16 v40, v40
    ds_read_u16 v41, v41
    ds_read_u16 v42, v42
    ds_read_u16 v43, v43
    s_lshl_b32 s58, s2, 4
    s_add_u32 s58, s58, s3
    s_cmp_eq_u32 s58, 15
    s_cbranch_scc0 L_noep
    v_mov_b32 v6, s40
    v_mov_b32 v7, 655616
    s_mov_b64 exec, 1
    buffer_store_dword v6, v7, s[16:19], 0 offen sc1
    s_mov_b64 exec, -1
L_noep:
    s_waitcnt lgkmcnt(6)
    v_add_u32 v12, 1, v12
    v_lshrrev_b32 v12, 1, v12
    v_max_u32 v12, 1, v12
    v_cndmask_b32 v12, 0, v12, s[62:63]
    s_lshl_b32 s67, s4, 3
    s_movk_i32 s58, 2560
    v_add_u32_dpp v51, v12, v12 row_shl:1 row_mask:0xf bank_mask:0xf bound_ctrl:1
    s_nop 1
    v_add_u32_dpp v51, v51, v51 row_shl:2 row_mask:0xf bank_mask:0xf bound_ctrl:1
    s_nop 1
    v_add_u32_dpp v51, v12, v51 row_shl:4 row_mask:0xf bank_mask:0x5 bound_ctrl:1
    s_waitcnt lgkmcnt(0)
    v_lshlrev_b32 v8, 16, v8
    v_lshl_add_u32 v5, v5, 10, v51
    v_sub_u32 v6, v55, v51
    v_cmp_le_u32 vcc, 80, v5
    v_lshlrev_b32 v6, 1, v6
    v_subrev_u32 v12, 1, v12
    s_cbranch_vccnz L_slow
    v_and_b32 v12, 0xff, v12
    v_lshl_add_u32 v9, v12, 18, v9
    s_mov_b64 exec, s[62:63]
    ds_write_b32 v50, v6 offset:160
    s_mov_b64 exec, -1
    s_sub_u32 s63, s67, 1
    v_readlane_b32 s67, v51, s67
    v_cmpx_lt_i32 vcc, 0, v48
    ds_read_b32 v24, v24 offset:160
    v_cmpx_lt_i32 vcc, 1, v48
    ds_read_b32 v25, v25 offset:160
    v_cmpx_lt_i32 vcc, 2, v48
    ds_read_b32 v26, v26 offset:160
    v_cmpx_lt_i32 vcc, 3, v48
    ds_read_b32 v27, v27 offset:160
    s_mov_b64 exec, -1
    s_lshr_b32 s66, s67, 3
    s_add_u32 s60, s66, 1
    s_lshl_b32 s60, s60, 3
    s_sub_u32 s67, s60, s67
    s_sub_u32 s62, s67, 1
    s_add_u32 s61, s4, 1
    s_mul_i32 s61, s61, 80
    s_sub_u32 s60, s61, s60
    s_lshl_b32 s60, s60, 2
    s_waitcnt lgkmcnt(0)
    v_cmpx_lt_i32 vcc, 0, v48
    v_add_u32 v24, v24, v32
    v_lshl_add_u32 v5, v24, 1, v57
    ds_write_b16 v5, v40
    v_lshrrev_b32 v6, 1, v24
    v_lshl_add_u32 v6, v6, 2, v60
    v_and_b32 v7, 1, v24
    v_mad_u32_u24 v6, v7, s58, v6
    ds_write_b32 v6, v16
    v_cmpx_lt_i32 vcc, 1, v48
    v_add_u32 v25, v25, v33
    v_lshl_add_u32 v5, v25, 1, v57
    ds_write_b16 v5, v41
    v_lshrrev_b32 v6, 1, v25
    v_lshl_add_u32 v6, v6, 2, v60
    v_and_b32 v7, 1, v25
    v_mad_u32_u24 v6, v7, s58, v6
    ds_write_b32 v6, v17
    v_cmpx_lt_i32 vcc, 2, v48
    v_add_u32 v26, v26, v34
    v_lshl_add_u32 v5, v26, 1, v57
    ds_write_b16 v5, v42
    v_lshrrev_b32 v6, 1, v26
    v_lshl_add_u32 v6, v6, 2, v60
    v_and_b32 v7, 1, v26
    v_mad_u32_u24 v6, v7, s58, v6
    ds_write_b32 v6, v18
    v_cmpx_lt_i32 vcc, 3, v48
    v_add_u32 v27, v27, v35
    v_lshl_add_u32 v5, v27, 1, v57
    ds_write_b16 v5, v43
    v_lshrrev_b32 v6, 1, v27
    v_lshl_add_u32 v6, v6, 2, v60
    v_and_b32 v7, 1, v27
    v_mad_u32_u24 v6, v7, s58, v6
    ds_write_b32 v6, v19
    s_mov_b64 exec, -1
    s_mov_b64 exec, 1
    ds_add_u32 v3, v62 offset:16
    s_mov_b64 exec, -1
    v_lshrrev_b32 v5, 5, v0
    v_mad_u32_u24 v13, v5, s58, v60
    v_add_u32 v13, s60, v13
    v_lshl_add_u32 v14, v5, 1, v57
    v_and_b32 v5, 28, v0
    v_add3_u32 v14, v14, v5, s60
    s_mov_b32 s65, 201486784
    s_mov_b32 s64, 0
    s_mov_b32 s59, 0
Lw_19:
    ds_read_b32 v4, v3 offset:16
    s_waitcnt lgkmcnt(0)
    v_cmp_gt_u32 vcc, 8, v4
    s_cbranch_vccz Lk_20
    s_add_u32 s59, s59, 1
    s_cmp_lt_u32 s59, 4194304
    s_cbranch_scc1 Lw_19
    s_branch L_end
Lk_20:
    v_mov_b32 v12, v3
    v_mov_b32 v3, v2
    s_setprio 1
    s_cmp_lt_u32 s4, 4
    s_cbranch_scc1 L_old
    s_setprio 2
L_old:
    s_mov_b64 vcc, 0
    ds_read_b128 v[64:67], v13 offset:0
    ds_read_b128 v[68:71], v13 offset:16
    ds_read_u16 v1, v14
    ds_read_b128 v[48:51], v13 offset:32
    ds_read_b128 v[52:55], v13 offset:48
    s_waitcnt lgkmcnt(3)
L_p0:
    s_cmp_ge_u32 s67, 4
    s_cbranch_scc1 L_p4
    s_cmp_gt_u32 s67, 1
    s_cbranch_scc1 Lps_21
    v_add_u32 v65, v65, v2
    buffer_load_dwordx4 v[20:23], v65, s[8:11], 0 offen
Lps_21:
    s_cmp_gt_u32 s67, 2
    s_cbranch_scc1 Lps_22
    v_add_u32 v66, v66, v2
    buffer_load_dwordx4 v[24:27], v66, s[8:11], 0 offen
Lps_22:
    s_cmp_gt_u32 s67, 3
    s_cbranch_scc1 Lps_23
    v_add_u32 v67, v67, v2
    buffer_load_dwordx4 v[28:31], v67, s[8:11], 0 offen
Lps_23:
L_p4:
    s_cmp_gt_u32 s67, 4
    s_cbranch_scc1 Lps_24
    v_add_u32 v68, v68, v2
    buffer_load_dwordx4 v[32:35], v68, s[8:11], 0 offen
Lps_24:
    s_cmp_gt_u32 s67, 5
    s_cbranch_scc1 Lps_25
    v_add_u32 v69, v69, v2
    buffer_load_dwordx4 v[36:39], v69, s[8:11], 0 offen
Lps_25:
    s_cmp_gt_u32 s67, 6
    s_cbranch_scc1 Lps_26
    v_add_u32 v70, v70, v2
    buffer_load_dwordx4 v[40:43], v70, s[8:11], 0 offen
Lps_26:
    s_cmp_gt_u32 s67, 7
    s_cbranch_scc1 Lps_27
    v_add_u32 v71, v71, v2
    buffer_load_dwordx4 v[44:47], v71, s[8:11], 0 offen
Lps_27:
    s_cmp_eq_u32 s66, 0
    s_cbranch_scc1 L_drain
L_gl:
    s_cmp_le_u32 s66, 4
    s_cbranch_scc1 L_dm0
L_dm0b:
    s_waitcnt lgkmcnt(1)
    v_perm_b32 v6, v1, v1, v10
    v_perm_b32 v7, v1, v1, v11
    ds_read_u16 v1, v14 offset:32
    s_waitcnt vmcnt(6)
    v_lshl_add_u64 v[4:5], v[48:49], 0, v[2:3]
    s_sub_u32 s62, s62, 2
    s_cbranch_scc1 Lfs_0
    v_mfma_f32_4x4x4_16b_bf16 v[56:59], v[6:7], v[16:17], v[56:59] cbsz:3 abid:0
    v_mfma_f32_4x4x4_16b_bf16 v[60:63], v[6:7], v[18:19], v[60:63] cbsz:3 abid:0
    buffer_load_dwordx4 v[16:19], v4, s[8:11], 0 offen
    v_mfma_f32_4x4x4_16b_bf16 v[56:59], v[6:7], v[20:21], v[56:59] cbsz:3 abid:1
    v_mfma_f32_4x4x4_16b_bf16 v[60:63], v[6:7], v[22:23], v[60:63] cbsz:3 abid:1
    buffer_load_dwordx4 v[20:23], v5, s[8:11], 0 offen
Lbs_0:
    s_cbranch_vccnz Ldm_0
Ldb_0:
    s_waitcnt vmcnt(6)
    v_lshl_add_u64 v[4:5], v[50:51], 0, v[2:3]
    s_sub_u32 s62, s62, 2
    s_cbranch_scc1 Lfs_2
    v_mfma_f32_4x4x4_16b_bf16 v[56:59], v[6:7], v[24:25], v[56:59] cbsz:3 abid:2
    v_mfma_f32_4x4x4_16b_bf16 v[60:63], v[6:7], v[26:27], v[60:63] cbsz:3 abid:2
    buffer_load_dwordx4 v[24:27], v4, s[8:11], 0 offen
    v_mfma_f32_4x4x4_16b_bf16 v[56:59], v[6:7], v[28:29], v[56:59] cbsz:3 abid:3
    v_mfma_f32_4x4x4_16b_bf16 v[60:63], v[6:7], v[30:31], v[60:63] cbsz:3 abid:3
    buffer_load_dwordx4 v[28:31], v5, s[8:11], 0 offen
Lbs_2:
    s_cbranch_vccnz Ldm_2
Ldb_2:
    ds_read_b128 v[48:51], v13 offset:64
    s_waitcnt vmcnt(6) lgkmcnt(2)
    v_lshl_add_u64 v[4:5], v[52:53], 0, v[2:3]
    s_sub_u32 s62, s62, 2
    s_cbranch_scc1 Lfs_4
    v_mfma_f32_4x4x4_16b_bf16 v[56:59], v[6:7], v[32:33], v[56:59] cbsz:3 abid:4
    v_mfma_f32_4x4x4_16b_bf16 v[60:63], v[6:7], v[34:35], v[60:63] cbsz:3 abid:4
    buffer_load_dwordx4 v[32:35], v4, s[8:11], 0 offen
    v_mfma_f32_4x4x4_16b_bf16 v[56:59], v[6:7], v[36:37], v[56:59] cbsz:3 abid:5
    v_mfma_f32_4x4x4_16b_bf16 v[60:63], v[6:7], v[38:39], v[60:63] cbsz:3 abid:5
    buffer_load_dwordx4 v[36:39], v5, s[8:11], 0 offen
Lbs_4:
    s_cbranch_vccnz Ldm_4
Ldb_4:
    s_waitcnt vmcnt(6)
    v_lshl_add_u64 v[4:5], v[54:55], 0, v[2:3]
    s_sub_u32 s62, s62, 2
    s_cbranch_scc1 Lfs_6
    v_mfma_f32_4x4x4_16b_bf16 v[56:59], v[6:7], v[40:41], v[56:59] cbsz:3 abid:6
    v_mfma_f32_4x4x4_16b_bf16 v[60:63], v[6:7], v[42:43], v[60:63] cbsz:3 abid:6
    buffer_load_dwordx4 v[40:43], v4, s[8:11], 0 offen
    v_mfma_f32_4x4x4_16b_bf16 v[56:59], v[6:7], v[44:45], v[56:59] cbsz:3 abid:7
    v_mfma_f32_4x4x4_16b_bf16 v[60:63], v[6:7], v[46:47], v[60:63] cbsz:3 abid:7
    buffer_load_dwordx4 v[44:47], v5, s[8:11], 0 offen
Lbs_6:
    s_cbranch_vccnz Ldm_6
Ldb_6:
    ds_read_b128 v[52:55], v13 offset:80
    v_add_u32 v13, 32, v13
    v_add_u32 v14, 32, v14
    s_sub_u32 s66, s66, 1
    s_cmp_eq_u32 s66, 3
    s_cbranch_scc0 L_nf
    s_setprio 1
L_nf:
    s_cmp_lg_u32 s66, 0
    s_cbranch_scc1 L_gl
L_drain:
    s_waitcnt lgkmcnt(0)
    v_perm_b32 v6, v1, v1, v10
    v_perm_b32 v7, v1, v1, v11
    ds_read_u16 v1, v14 offset:32
    s_waitcnt vmcnt(7)
    v_mfma_f32_4x4x4_16b_bf16 v[56:59], v[6:7], v[16:17], v[56:59] cbsz:3 abid:0
    v_mfma_f32_4x4x4_16b_bf16 v[60:63], v[6:7], v[18:19], v[60:63] cbsz:3 abid:0
    s_sub_u32 s62, s62, 1
    s_cbranch_scc1 Lfd_0
Lbd_0:
    s_waitcnt vmcnt(6)
    v_mfma_f32_4x4x4_16b_bf16 v[56:59], v[6:7], v[20:21], v[56:59] cbsz:3 abid:1
    v_mfma_f32_4x4x4_16b_bf16 v[60:63], v[6:7], v[22:23], v[60:63] cbsz:3 abid:1
    s_sub_u32 s62, s62, 1
    s_cbranch_scc1 Lfd_1
Lbd_1:
    s_waitcnt vmcnt(5)
    v_mfma_f32_4x4x4_16b_bf16 v[56:59], v[6:7], v[24:25], v[56:59] cbsz:3 abid:2
    v_mfma_f32_4x4x4_16b_bf16 v[60:63], v[6:7], v[26:27], v[60:63] cbsz:3 abid:2
    s_sub_u32 s62, s62, 1
    s_cbranch_scc1 Lfd_2
Lbd_2:
    s_waitcnt vmcnt(4)
    v_mfma_f32_4x4x4_16b_bf16 v[56:59], v[6:7], v[28:29], v[56:59] cbsz:3 abid:3
    v_mfma_f32_4x4x4_16b_bf16 v[60:63], v[6:7], v[30:31], v[60:63] cbsz:3 abid:3
    s_sub_u32 s62, s62, 1
    s_cbranch_scc1 Lfd_3
Lbd_3:
    s_waitcnt vmcnt(3)
    v_mfma_f32_4x4x4_16b_bf16 v[56:59], v[6:7], v[32:33], v[56:59] cbsz:3 abid:4
    v_mfma_f32_4x4x4_16b_bf16 v[60:63], v[6:7], v[34:35], v[60:63] cbsz:3 abid:4
    s_sub_u32 s62, s62, 1
    s_cbranch_scc1 Lfd_4
Lbd_4:
    s_waitcnt vmcnt(2)
    v_mfma_f32_4x4x4_16b_bf16 v[56:59], v[6:7], v[36:37], v[56:59] cbsz:3 abid:5
    v_mfma_f32_4x4x4_16b_bf16 v[60:63], v[6:7], v[38:39], v[60:63] cbsz:3 abid:5
    s_sub_u32 s62, s62, 1
    s_cbranch_scc1 Lfd_5
Lbd_5:
    s_waitcnt vmcnt(1)
    v_mfma_f32_4x4x4_16b_bf16 v[56:59], v[6:7], v[40:41], v[56:59] cbsz:3 abid:6
    v_mfma_f32_4x4x4_16b_bf16 v[60:63], v[6:7], v[42:43], v[60:63] cbsz:3 abid:6
    s_sub_u32 s62, s62, 1
    s_cbranch_scc1 Lfd_6
Lbd_6:
    s_waitcnt vmcnt(0)
    v_mfma_f32_4x4x4_16b_bf16 v[56:59], v[6:7], v[44:45], v[56:59] cbsz:3 abid:7
    v_mfma_f32_4x4x4_16b_bf16 v[60:63], v[6:7], v[46:47], v[60:63] cbsz:3 abid:7
    s_nop 1
    s_call_b64 s[68:69], L_flush
L_gdone:
    s_cmp_eq_u32 s41, 0
    s_cbranch_scc0 L_dd
    s_mov_b32 s59, 0
Lw_28:
    ds_read_b32 v4, v12 offset:24
    s_waitcnt lgkmcnt(0)
    v_cmp_gt_u32 vcc, 8, v4
    s_cbranch_vccz Lk_29
    s_sleep 2
    s_add_u32 s59, s59, 1
    s_cmp_lt_u32 s59, 4194304
    s_cbranch_scc1 Lw_28
    s_branch L_end
Lk_29:
    s_lshl_b32 s58, s4, 10
    v_lshl_add_u32 v72, v0, 4, s58
    s_and_b32 s58, s4, 4
    v_lshl_add_u32 v73, s58, 4, v72
    s_movk_i32 s58, 0x1f0
    v_bfi_b32 v72, s58, v73, v72
    ds_write_b128 v72, v[96:99] offset:0
    ds_write_b128 v72, v[100:103] offset:8192
    ds_write_b128 v72, v[104:107] offset:16384
    ds_write_b128 v72, v[108:111] offset:24576
    ds_write_b128 v72, v[112:115] offset:32768
    ds_write_b128 v72, v[116:119] offset:40960
    ds_write_b128 v72, v[120:123] offset:49152
    ds_write_b128 v72, v[124:127] offset:57344
    s_mov_b64 exec, 1
    ds_inc_u32 v12, v12 offset:64
    s_mov_b64 exec, -1
L_dd:
    s_endpgm
Lfs_0:
    s_add_u32 s62, s62, 2
    v_mfma_f32_4x4x4_16b_bf16 v[56:59], v[6:7], v[16:17], v[56:59] cbsz:3 abid:0
    v_mfma_f32_4x4x4_16b_bf16 v[60:63], v[6:7], v[18:19], v[60:63] cbsz:3 abid:0
    buffer_load_dwordx4 v[16:19], v4, s[8:11], 0 offen
    s_sub_u32 s62, s62, 1
    s_cbranch_scc0 Lsk_30
    s_call_b64 s[68:69], L_flush
Lsk_30:
    v_mfma_f32_4x4x4_16b_bf16 v[56:59], v[6:7], v[20:21], v[56:59] cbsz:3 abid:1
    v_mfma_f32_4x4x4_16b_bf16 v[60:63], v[6:7], v[22:23], v[60:63] cbsz:3 abid:1
    buffer_load_dwordx4 v[20:23], v5, s[8:11], 0 offen
    s_sub_u32 s62, s62, 1
    s_cbranch_scc0 Lbs_0
    s_call_b64 s[68:69], L_flush
    s_branch Lbs_0
Lfs_2:
    s_add_u32 s62, s62, 2
    v_mfma_f32_4x4x4_16b_bf16 v[56:59], v[6:7], v[24:25], v[56:59] cbsz:3 abid:2
    v_mfma_f32_4x4x4_16b_bf16 v[60:63], v[6:7], v[26:27], v[60:63] cbsz:3 abid:2
    buffer_load_dwordx4 v[24:27], v4, s[8:11], 0 offen
    s_sub_u32 s62, s62, 1
    s_cbranch_scc0 Lsk_32
    s_call_b64 s[68:69], L_flush
Lsk_32:
    v_mfma_f32_4x4x4_16b_bf16 v[56:59], v[6:7], v[28:29], v[56:59] cbsz:3 abid:3
    v_mfma_f32_4x4x4_16b_bf16 v[60:63], v[6:7], v[30:31], v[60:63] cbsz:3 abid:3
    buffer_load_dwordx4 v[28:31], v5, s[8:11], 0 offen
    s_sub_u32 s62, s62, 1
    s_cbranch_scc0 Lbs_2
    s_call_b64 s[68:69], L_flush
    s_branch Lbs_2
Lfs_4:
    s_add_u32 s62, s62, 2
    v_mfma_f32_4x4x4_16b_bf16 v[56:59], v[6:7], v[32:33], v[56:59] cbsz:3 abid:4
    v_mfma_f32_4x4x4_16b_bf16 v[60:63], v[6:7], v[34:35], v[60:63] cbsz:3 abid:4
    buffer_load_dwordx4 v[32:35], v4, s[8:11], 0 offen
    s_sub_u32 s62, s62, 1
    s_cbranch_scc0 Lsk_34
    s_call_b64 s[68:69], L_flush
Lsk_34:
    v_mfma_f32_4x4x4_16b_bf16 v[56:59], v[6:7], v[36:37], v[56:59] cbsz:3 abid:5
    v_mfma_f32_4x4x4_16b_bf16 v[60:63], v[6:7], v[38:39], v[60:63] cbsz:3 abid:5
    buffer_load_dwordx4 v[36:39], v5, s[8:11], 0 offen
    s_sub_u32 s62, s62, 1
    s_cbranch_scc0 Lbs_4
    s_call_b64 s[68:69], L_flush
    s_branch Lbs_4
Lfs_6:
    s_add_u32 s62, s62, 2
    v_mfma_f32_4x4x4_16b_bf16 v[56:59], v[6:7], v[40:41], v[56:59] cbsz:3 abid:6
    v_mfma_f32_4x4x4_16b_bf16 v[60:63], v[6:7], v[42:43], v[60:63] cbsz:3 abid:6
    buffer_load_dwordx4 v[40:43], v4, s[8:11], 0 offen
    s_sub_u32 s62, s62, 1
    s_cbranch_scc0 Lsk_36
    s_call_b64 s[68:69], L_flush
Lsk_36:
    v_mfma_f32_4x4x4_16b_bf16 v[56:59], v[6:7], v[44:45], v[56:59] cbsz:3 abid:7
    v_mfma_f32_4x4x4_16b_bf16 v[60:63], v[6:7], v[46:47], v[60:63] cbsz:3 abid:7
    buffer_load_dwordx4 v[44:47], v5, s[8:11], 0 offen
    s_sub_u32 s62, s62, 1
    s_cbranch_scc0 Lbs_6
    s_call_b64 s[68:69], L_flush
    s_branch Lbs_6
Lfd_0:
    s_call_b64 s[68:69], L_flush
    s_branch Lbd_0
Lfd_1:
    s_call_b64 s[68:69], L_flush
    s_branch Lbd_1
Lfd_2:
    s_call_b64 s[68:69], L_flush
    s_branch Lbd_2
Lfd_3:
    s_call_b64 s[68:69], L_flush
    s_branch Lbd_3
Lfd_4:
    s_call_b64 s[68:69], L_flush
    s_branch Lbd_4
Lfd_5:
    s_call_b64 s[68:69], L_flush
    s_branch Lbd_5
Lfd_6:
    s_call_b64 s[68:69], L_flush
    s_branch Lbd_6
L_dm0:
    s_mov_b64 vcc, 0
    s_cmp_eq_u32 s41, 0
    s_cbranch_scc0 L_dm0b
    ds_read_b32 v4, v12 offset:24
    s_waitcnt lgkmcnt(0)
    v_cmp_le_u32 vcc, 8, v4
    s_cbranch_vccz L_dm0b
    s_lshl_b32 s58, s4, 10
    v_lshl_add_u32 v72, v0, 4, s58
    s_and_b32 s58, s4, 4
    v_lshl_add_u32 v73, s58, 4, v72
    s_movk_i32 s58, 0x1f0
    v_bfi_b32 v72, s58, v73, v72
    s_mov_b32 s41, 1
    s_mov_b64 vcc, -1
    s_branch L_dm0b
Ldm_0:
    ds_write_b128 v72, v[96:99] offset:0
    ds_write_b128 v72, v[100:103] offset:8192
    s_branch Ldb_0
Ldm_2:
    ds_write_b128 v72, v[104:107] offset:16384
    ds_write_b128 v72, v[108:111] offset:24576
    s_branch Ldb_2
Ldm_4:
    ds_write_b128 v72, v[112:115] offset:32768
    ds_write_b128 v72, v[116:119] offset:40960
    s_branch Ldb_4
Ldm_6:
    ds_write_b128 v72, v[120:123] offset:49152
    ds_write_b128 v72, v[124:127] offset:57344
    s_mov_b64 exec, 1
    ds_inc_u32 v12, v12 offset:64
    s_mov_b64 exec, -1
    s_branch Ldb_6
L_flush:
    s_and_b32 s101, s65, 0x3ffff
    s_add_u32 s63, s63, 1
    v_permlane32_swap_b32 v56, v60
    v_permlane32_swap_b32 v57, v61
    v_permlane32_swap_b32 v58, v62
    v_permlane32_swap_b32 v59, v63
    s_lshr_b32 s62, s65, 26
    v_pk_add_f32 v[56:57], v[56:57], v[60:61]
    v_pk_add_f32 v[58:59], v[58:59], v[62:63]
    v_add_u32 v62, s101, v15
    v_pk_mul_f32 v[56:57], v[56:57], s[64:65] op_sel_hi:[1,0]
    v_pk_mul_f32 v[58:59], v[58:59], s[64:65] op_sel_hi:[1,0]
    v_lshl_add_u32 v63, s62, 2, v12
    v_cvt_pk_bf16_f32 v60, v56, v57
    v_cvt_pk_bf16_f32 v61, v58, v59
    s_cmp_eq_u32 s62, 2
    s_cbranch_scc0 L_fl1
    v_add_u32 v62, s101, v74
    ds_write2_b32 v62, v60, v61 offset0:0 offset1:4
    s_mov_b64 exec, 1
    ds_inc_u32 v63, v63 offset:36
    s_mov_b64 exec, -1
    s_setpc_b64 s[68:69]
L_fl1:
    ds_write_b64 v62, v[60:61]
    s_mov_b64 exec, 1
    ds_inc_u32 v63, v63 offset:36
    s_mov_b64 exec, -1
    v_readlane_b32 s65, v9, s63
    v_readlane_b32 s64, v8, s63
    v_mov_b64 v[56:57], 0
    v_mov_b64 v[58:59], 0
    v_mov_b64 v[60:61], 0
    v_mov_b64 v[62:63], 0
    s_bfe_u32 s62, s65, 0x80012
    s_setpc_b64 s[68:69]
L_preA:
    s_setprio 2
    v_and_b32 v0, 63, v0
    s_xor_b32 s3, s3, 8
    v_mov_b32 v3, 160064
    s_mov_b64 s[8:9], s[32:33]
    s_mov_b32 s10, 5120000
    s_mov_b32 s11, 0x20000
    v_and_b32 v4, 7, v0
    v_mul_u32_u24 v1, 1056, v4
    v_and_b32 v4, 8, v0
    v_lshl_add_u32 v1, v4, 6, v1
    v_and_b32 v4, 48, v0
    v_add_u32 v1, v4, v1
    v_add_u32 v12, 84480, v1
    v_lshlrev_b32 v14, 4, v0
    s_lshl_b32 s61, s3, 6
    s_add_u32 s61, s61, 105600
    v_add_u32 v13, s61, v1
    s_lshl_b32 s100, s3, 14
    s_add_u32 s100, s100, 720896
    s_waitcnt lgkmcnt(0)
    s_cmp_eq_u32 s3, 0
    s_cbranch_scc0 L_notag
    s_add_u32 s40, s40, 0x9e377000
    s_and_b32 s40, s40, 4294963200
    s_bitset1_b32 s40, 0
    v_mov_b32 v4, s40
    ds_write_b32 v3, v4 offset:68
L_notag:
    v_lshl_add_u32 v104, s12, 9, v2
    v_lshl_add_u32 v105, s13, 9, v2
    v_lshl_add_u32 v106, s14, 9, v2
    v_lshl_add_u32 v107, s15, 9, v2
    v_lshl_add_u32 v108, s16, 9, v2
    v_lshl_add_u32 v109, s17, 9, v2
    v_lshl_add_u32 v110, s18, 9, v2
    v_lshl_add_u32 v111, s19, 9, v2
    v_lshl_add_u32 v112, s28, 9, v2
    v_lshl_add_u32 v113, s29, 9, v2
    s_mov_b32 exec_lo, 0
    v_lshl_add_u32 v104, s20, 9, v2
    v_lshl_add_u32 v105, s21, 9, v2
    v_lshl_add_u32 v106, s22, 9, v2
    v_lshl_add_u32 v107, s23, 9, v2
    v_lshl_add_u32 v108, s24, 9, v2
    v_lshl_add_u32 v109, s25, 9, v2
    v_lshl_add_u32 v110, s26, 9, v2
    v_lshl_add_u32 v111, s27, 9, v2
    v_lshl_add_u32 v112, s30, 9, v2
    v_lshl_add_u32 v113, s31, 9, v2
    s_mov_b64 exec, -1
    s_mov_b64 s[16:17], s[56:57]
    s_mov_b32 s18, 1441792
    s_mov_b32 s19, 0x20000
    s_mov_b64 s[20:21], s[52:53]
    s_mov_b32 s22, 5120000
    s_mov_b32 s23, 0x20000
    s_cmp_ge_u32 s2, 64
    s_cbranch_scc1 L_nopb
    s_barrier
    s_barrier
L_nopb:
    s_mul_i32 s67, s3, 2112
    s_mul_i32 s66, s3, 8448
    s_add_u32 m0, s66, 0
    s_waitcnt vmcnt(1)
    buffer_load_dwordx4 v104, s[8:11], 0 offen lds
    s_add_u32 m0, s66, 1056
    s_waitcnt vmcnt(1)
    buffer_load_dwordx4 v105, s[8:11], 0 offen lds
    v_and_b32 v4, 3, v0
    v_mov_b32 v5, 0x0c0c0c0c
    v_mov_b32 v6, 0x0c0c0302
    v_mov_b32 v7, 0x03020c0c
    v_cmp_eq_u32 s[58:59], 0, v4
    v_cmp_eq_u32 s[60:61], 2, v4
    v_cmp_eq_u32 vcc, 1, v4
    v_cndmask_b32 v8, v5, v6, s[58:59]
    v_cndmask_b32 v9, v5, v6, s[60:61]
    v_cndmask_b32 v8, v8, v7, vcc
    v_cmp_eq_u32 vcc, 3, v4
    s_nop 1
    v_cndmask_b32 v9, v9, v7, vcc
    v_mov_b32 v10, v8
    v_mov_b32 v11, v9
    v_and_b32 v8, 0xfdfdfdfd, v8
    v_and_b32 v9, 0xfdfdfdfd, v9
    s_add_u32 m0, s66, 2112
    s_waitcnt vmcnt(1)
    buffer_load_dwordx4 v106, s[8:11], 0 offen lds
    s_mov_b64 exec, 1
    v_mov_b32 v4, 1
    ds_add_u32 v3, v4 offset:0
    s_mov_b64 exec, -1
    s_add_u32 m0, s66, 3168
    s_waitcnt vmcnt(1)
    buffer_load_dwordx4 v107, s[8:11], 0 offen lds
    s_add_u32 m0, s66, 4224
    s_waitcnt vmcnt(1)
    buffer_load_dwordx4 v108, s[8:11], 0 offen lds
    s_mov_b32 s59, 0
Lw_38:
    ds_read_b32 v4, v3 offset:0
    s_waitcnt lgkmcnt(0)
    v_cmp_gt_u32 vcc, 8, v4
    s_cbranch_vccz Lk_39
    s_add_u32 s59, s59, 1
    s_cmp_lt_u32 s59, 4194304
    s_cbranch_scc1 Lw_38
    s_branch L_end
Lk_39:
    ds_read_b128 v[80:83], v12 offset:0
    ds_read_b128 v[84:87], v12 offset:8448
    ds_read_b128 v[88:91], v12 offset:16896
    s_add_u32 m0, s66, 5280
    s_waitcnt vmcnt(1)
    buffer_load_dwordx4 v109, s[8:11], 0 offen lds
    s_mov_b64 exec, 1
    v_mov_b32 v4, 1
    ds_add_u32 v3, v4 offset:60
    s_mov_b64 exec, -1
    s_waitcnt vmcnt(1)
    ds_read_b32 v4, v3 offset:52
    s_add_u32 m0, s66, 6336
    s_waitcnt vmcnt(1)
    buffer_load_dwordx4 v110, s[8:11], 0 offen lds
    s_mov_b32 s62, 7
    s_waitcnt lgkmcnt(0)
    v_cmp_gt_u32 vcc, 8, v4
    s_cbranch_vccz L_eu10
    s_waitcnt vmcnt(1)
    ds_read_b32 v4, v3 offset:52
    s_add_u32 m0, s66, 7392
    s_waitcnt vmcnt(1)
    buffer_load_dwordx4 v111, s[8:11], 0 offen lds
    s_mov_b32 s62, 8
    s_waitcnt lgkmcnt(0)
    v_cmp_gt_u32 vcc, 8, v4
    s_cbranch_vccz L_eu10
    s_waitcnt vmcnt(1)
    ds_read_b32 v4, v3 offset:52
    s_add_u32 m0, s67, 67584
    s_waitcnt vmcnt(1)
    buffer_load_dwordx4 v112, s[8:11], 0 offen lds
    s_mov_b32 s62, 9
    s_waitcnt lgkmcnt(0)
    v_cmp_gt_u32 vcc, 8, v4
    s_cbranch_vccz L_eu10
    s_waitcnt vmcnt(1)
    ds_read_b32 v4, v3 offset:52
    s_add_u32 m0, s67, 68640
    s_waitcnt vmcnt(1)
    buffer_load_dwordx4 v113, s[8:11], 0 offen lds
    s_mov_b32 s62, 10
    s_mov_b32 s59, 0
Lw_40:
    ds_read_b32 v4, v3 offset:52
    s_waitcnt lgkmcnt(0)
    v_cmp_gt_u32 vcc, 8, v4
    s_cbranch_vccz Lk_41
    s_sleep 1
    s_add_u32 s59, s59, 1
    s_cmp_lt_u32 s59, 4194304
    s_cbranch_scc1 Lw_40
    s_branch L_end
Lk_41:
L_eu10:
    s_setprio 3
    buffer_load_dwordx4 v[16:19], v14, s[16:19], s100 offen offset:0 sc1
    buffer_load_dwordx4 v[24:27], v14, s[16:19], s100 offen offset:1024 sc1
    buffer_load_dwordx4 v[20:23], v14, s[16:19], s100 offen offset:2048 sc1
    buffer_load_dwordx4 v[28:31], v14, s[16:19], s100 offen offset:3072 sc1
    s_add_u32 s100, s100, 4096
    buffer_load_dwordx4 v[32:35], v14, s[16:19], s100 offen offset:0 sc1
    s_cmp_gt_u32 s62, 7
    s_cbranch_scc1 Lem_42
    s_add_u32 m0, s66, 7392
    s_waitcnt vmcnt(63)
    buffer_load_dwordx4 v111, s[8:11], 0 offen lds
Lem_42:
    buffer_load_dwordx4 v[40:43], v14, s[16:19], s100 offen offset:1024 sc1
    buffer_load_dwordx4 v[36:39], v14, s[16:19], s100 offen offset:2048 sc1
    buffer_load_dwordx4 v[44:47], v14, s[16:19], s100 offen offset:3072 sc1
    s_add_u32 s100, s100, 4096
    buffer_load_dwordx4 v[48:51], v14, s[16:19], s100 offen offset:0 sc1
    buffer_load_dwordx4 v[56:59], v14, s[16:19], s100 offen offset:1024 sc1
    s_cmp_gt_u32 s62, 8
    s_cbranch_scc1 Lem_43
    s_add_u32 m0, s67, 67584
    s_waitcnt vmcnt(63)
    buffer_load_dwordx4 v112, s[8:11], 0 offen lds
Lem_43:
    buffer_load_dwordx4 v[52:55], v14, s[16:19], s100 offen offset:2048 sc1
    buffer_load_dwordx4 v[60:63], v14, s[16:19], s100 offen offset:3072 sc1
    s_add_u32 s100, s100, 4096
    buffer_load_dwordx4 v[64:67], v14, s[16:19], s100 offen offset:0 sc1
    buffer_load_dwordx4 v[72:75], v14, s[16:19], s100 offen offset:1024 sc1
    buffer_load_dwordx4 v[68:71], v14, s[16:19], s100 offen offset:2048 sc1
    buffer_load_dwordx4 v[76:79], v14, s[16:19], s100 offen offset:3072 sc1
    s_cmp_gt_u32 s62, 9
    s_cbranch_scc1 Lem_44
    s_add_u32 m0, s67, 68640
    s_waitcnt vmcnt(63)
    buffer_load_dwordx4 v113, s[8:11], 0 offen lds
Lem_44:
    s_setprio 0
    ds_read_b128 v[92:95], v12 offset:64
    ds_read_b128 v[96:99], v12 offset:8512
    ds_read_b128 v[100:103], v12 offset:16960
    s_waitcnt vmcnt(14) lgkmcnt(3)
    v_mfma_f32_16x16x32_bf16 v[104:107], v[16:19], v[80:83], 0
    v_mfma_f32_16x16x32_bf16 v[108:111], v[24:27], v[80:83], 0
    v_mfma_f32_16x16x32_bf16 v[112:115], v[16:19], v[84:87], 0
    v_mfma_f32_16x16x32_bf16 v[116:119], v[24:27], v[84:87], 0
    v_mfma_f32_16x16x32_bf16 v[120:123], v[16:19], v[88:91], 0
    v_mfma_f32_16x16x32_bf16 v[124:127], v[24:27], v[88:91], 0
    ds_read_b128 v[80:83], v12 offset:128
    ds_read_b128 v[84:87], v12 offset:8576
    ds_read_b128 v[88:91], v12 offset:17024
    s_waitcnt vmcnt(12) lgkmcnt(3)
    v_mfma_f32_16x16x32_bf16 v[104:107], v[20:23], v[92:95], v[104:107]
    v_mfma_f32_16x16x32_bf16 v[108:111], v[28:31], v[92:95], v[108:111]
    v_mfma_f32_16x16x32_bf16 v[112:115], v[20:23], v[96:99], v[112:115]
    v_mfma_f32_16x16x32_bf16 v[116:119], v[28:31], v[96:99], v[116:119]
    v_mfma_f32_16x16x32_bf16 v[120:123], v[20:23], v[100:103], v[120:123]
    v_mfma_f32_16x16x32_bf16 v[124:127], v[28:31], v[100:103], v[124:127]
    ds_read_b128 v[92:95], v12 offset:192
    ds_read_b128 v[96:99], v12 offset:8640
    ds_read_b128 v[100:103], v12 offset:17088
    s_waitcnt vmcnt(10) lgkmcnt(3)
    v_mfma_f32_16x16x32_bf16 v[104:107], v[32:35], v[80:83], v[104:107]
    v_mfma_f32_16x16x32_bf16 v[108:111], v[40:43], v[80:83], v[108:111]
    v_mfma_f32_16x16x32_bf16 v[112:115], v[32:35], v[84:87], v[112:115]
    v_mfma_f32_16x16x32_bf16 v[116:119], v[40:43], v[84:87], v[116:119]
    v_mfma_f32_16x16x32_bf16 v[120:123], v[32:35], v[88:91], v[120:123]
    v_mfma_f32_16x16x32_bf16 v[124:127], v[40:43], v[88:91], v[124:127]
    ds_read_b128 v[80:83], v12 offset:256
    ds_read_b128 v[84:87], v12 offset:8704
    ds_read_b128 v[88:91], v12 offset:17152
    s_waitcnt vmcnt(8) lgkmcnt(3)
    v_mfma_f32_16x16x32_bf16 v[104:107], v[36:39], v[92:95], v[104:107]
    v_mfma_f32_16x16x32_bf16 v[108:111], v[44:47], v[92:95], v[108:111]
    v_mfma_f32_16x16x32_bf16 v[112:115], v[36:39], v[96:99], v[112:115]
    v_mfma_f32_16x16x32_bf16 v[116:119], v[44:47], v[96:99], v[116:119]
    v_mfma_f32_16x16x32_bf16 v[120:123], v[36:39], v[100:103], v[120:123]
    v_mfma_f32_16x16x32_bf16 v[124:127], v[44:47], v[100:103], v[124:127]
    ds_read_b128 v[92:95], v12 offset:320
    ds_read_b128 v[96:99], v12 offset:8768
    ds_read_b128 v[100:103], v12 offset:17216
    s_waitcnt vmcnt(6) lgkmcnt(3)
    v_mfma_f32_16x16x32_bf16 v[104:107], v[48:51], v[80:83], v[104:107]
    v_mfma_f32_16x16x32_bf16 v[108:111], v[56:59], v[80:83], v[108:111]
    v_mfma_f32_16x16x32_bf16 v[112:115], v[48:51], v[84:87], v[112:115]
    v_mfma_f32_16x16x32_bf16 v[116:119], v[56:59], v[84:87], v[116:119]
    v_mfma_f32_16x16x32_bf16 v[120:123], v[48:51], v[88:91], v[120:123]
    v_mfma_f32_16x16x32_bf16 v[124:127], v[56:59], v[88:91], v[124:127]
    ds_read_b128 v[80:83], v12 offset:384
    ds_read_b128 v[84:87], v12 offset:8832
    ds_read_b128 v[88:91], v12 offset:17280
    s_waitcnt vmcnt(4) lgkmcnt(3)
    v_mfma_f32_16x16x32_bf16 v[104:107], v[52:55], v[92:95], v[104:107]
    v_mfma_f32_16x16x32_bf16 v[108:111], v[60:63], v[92:95], v[108:111]
    v_mfma_f32_16x16x32_bf16 v[112:115], v[52:55], v[96:99], v[112:115]
    v_mfma_f32_16x16x32_bf16 v[116:119], v[60:63], v[96:99], v[116:119]
    v_mfma_f32_16x16x32_bf16 v[120:123], v[52:55], v[100:103], v[120:123]
    v_mfma_f32_16x16x32_bf16 v[124:127], v[60:63], v[100:103], v[124:127]
    ds_read_b128 v[92:95], v12 offset:448
    ds_read_b128 v[96:99], v12 offset:8896
    ds_read_b128 v[100:103], v12 offset:17344
    s_waitcnt vmcnt(2) lgkmcnt(3)
    v_mfma_f32_16x16x32_bf16 v[104:107], v[64:67], v[80:83], v[104:107]
    v_mfma_f32_16x16x32_bf16 v[108:111], v[72:75], v[80:83], v[108:111]
    v_mfma_f32_16x16x32_bf16 v[112:115], v[64:67], v[84:87], v[112:115]
    v_mfma_f32_16x16x32_bf16 v[116:119], v[72:75], v[84:87], v[116:119]
    v_mfma_f32_16x16x32_bf16 v[120:123], v[64:67], v[88:91], v[120:123]
    v_mfma_f32_16x16x32_bf16 v[124:127], v[72:75], v[88:91], v[124:127]
    s_waitcnt vmcnt(0) lgkmcnt(0)
    v_mfma_f32_16x16x32_bf16 v[104:107], v[68:71], v[92:95], v[104:107]
    v_mfma_f32_16x16x32_bf16 v[108:111], v[76:79], v[92:95], v[108:111]
    v_mfma_f32_16x16x32_bf16 v[112:115], v[68:71], v[96:99], v[112:115]
    v_mfma_f32_16x16x32_bf16 v[116:119], v[76:79], v[96:99], v[116:119]
    v_mfma_f32_16x16x32_bf16 v[120:123], v[68:71], v[100:103], v[120:123]
    v_mfma_f32_16x16x32_bf16 v[124:127], v[76:79], v[100:103], v[124:127]
    s_nop 3
    v_cvt_pk_bf16_f32 v80, v104, v105
    v_cvt_pk_bf16_f32 v81, v106, v107
    v_cvt_pk_bf16_f32 v82, v108, v109
    v_cvt_pk_bf16_f32 v83, v110, v111
    ds_write_b128 v13, v[80:83] offset:0
    v_cvt_pk_bf16_f32 v84, v112, v113
    v_cvt_pk_bf16_f32 v85, v114, v115
    v_cvt_pk_bf16_f32 v86, v116, v117
    v_cvt_pk_bf16_f32 v87, v118, v119
    ds_write_b128 v13, v[84:87] offset:8448
    v_cvt_pk_bf16_f32 v88, v120, v121
    v_cvt_pk_bf16_f32 v89, v122, v123
    v_cvt_pk_bf16_f32 v90, v124, v125
    v_cvt_pk_bf16_f32 v91, v126, v127
    ds_write_b128 v13, v[88:91] offset:16896
    s_mov_b64 exec, 1
    v_mov_b32 v4, 1
    ds_add_u32 v3, v4 offset:20
    s_mov_b64 exec, -1
    s_setprio 3
    s_add_u32 s100, s100, 118784
    buffer_load_dwordx4 v[16:19], v14, s[16:19], s100 offen offset:0 sc1
    buffer_load_dwordx4 v[24:27], v14, s[16:19], s100 offen offset:1024 sc1
    buffer_load_dwordx4 v[20:23], v14, s[16:19], s100 offen offset:2048 sc1
    buffer_load_dwordx4 v[28:31], v14, s[16:19], s100 offen offset:3072 sc1
    s_add_u32 s100, s100, 4096
    buffer_load_dwordx4 v[32:35], v14, s[16:19], s100 offen offset:0 sc1
    buffer_load_dwordx4 v[40:43], v14, s[16:19], s100 offen offset:1024 sc1
    buffer_load_dwordx4 v[36:39], v14, s[16:19], s100 offen offset:2048 sc1
    buffer_load_dwordx4 v[44:47], v14, s[16:19], s100 offen offset:3072 sc1
    s_add_u32 s100, s100, 4096
    buffer_load_dwordx4 v[48:51], v14, s[16:19], s100 offen offset:0 sc1
    buffer_load_dwordx4 v[56:59], v14, s[16:19], s100 offen offset:1024 sc1
    buffer_load_dwordx4 v[52:55], v14, s[16:19], s100 offen offset:2048 sc1
    buffer_load_dwordx4 v[60:63], v14, s[16:19], s100 offen offset:3072 sc1
    s_add_u32 s100, s100, 4096
    buffer_load_dwordx4 v[64:67], v14, s[16:19], s100 offen offset:0 sc1
    buffer_load_dwordx4 v[72:75], v14, s[16:19], s100 offen offset:1024 sc1
    buffer_load_dwordx4 v[68:71], v14, s[16:19], s100 offen offset:2048 sc1
    buffer_load_dwordx4 v[76:79], v14, s[16:19], s100 offen offset:3072 sc1
    s_setprio 0
    s_mov_b32 s63, s3
L_grp:
    s_mul_i32 s58, s63, 8448
    s_lshr_b32 s59, s63, 2
    s_mul_i32 s59, s59, 8448
    s_and_b32 s60, s63, 1
    s_bfe_u32 s61, s63, 0x10001
    s_cmp_ge_u32 s63, 8
    s_cselect_b32 s61, s60, s61
    s_cselect_b32 s60, 0, s60
    s_mul_i32 s60, s60, 4224
    s_lshl_b32 s61, s61, 9
    s_add_u32 s59, s59, s60
    s_add_u32 s59, s59, s61
    s_add_u32 s59, s59, 105600
    v_add_u32 v12, s58, v1
    v_bfe_u32 v4, v0, 2, 2
    v_mul_u32_u24 v4, 1056, v4
    v_and_b32 v5, 48, v0
    v_add3_u32 v13, v4, v5, s59
    v_lshl_add_u32 v14, v0, 3, s58
    v_lshl_add_u32 v2, v0, 3, s59
    s_cmp_ge_u32 s63, 8
    s_cbranch_scc1 L_grp2
    s_mov_b32 s59, 0
Lw_45:
    ds_read_b32 v4, v3 offset:20
    s_waitcnt lgkmcnt(0)
    v_cmp_gt_u32 vcc, 8, v4
    s_cbranch_vccz Lk_46
    s_sleep 1
    s_add_u32 s59, s59, 1
    s_cmp_lt_u32 s59, 4194304
    s_cbranch_scc1 Lw_45
    s_branch L_end
Lk_46:
L_grp2:
    s_waitcnt lgkmcnt(0)
    ds_read_b128 v[80:83], v12 offset:0
    ds_read_b128 v[84:87], v13 offset:0
    ds_read_b128 v[88:91], v12 offset:64
    ds_read_b128 v[92:95], v13 offset:64
    ds_read_b128 v[96:99], v12 offset:128
    ds_read_b128 v[100:103], v13 offset:128
    ds_read_b128 v[104:107], v12 offset:192
    ds_read_b128 v[108:111], v13 offset:192
    ds_read_b128 v[112:115], v12 offset:256
    ds_read_b128 v[116:119], v13 offset:256
    ds_read_b128 v[120:123], v12 offset:320
    ds_read_b128 v[124:127], v13 offset:320
    s_waitcnt lgkmcnt(10)
    v_mfma_f32_16x16x32_bf16 v[4:7], v[80:83], v[84:87], 0
    ds_read_b128 v[80:83], v12 offset:384
    ds_read_b128 v[84:87], v13 offset:384
    s_waitcnt lgkmcnt(10)
    v_mfma_f32_16x16x32_bf16 v[4:7], v[88:91], v[92:95], v[4:7]
    ds_read_b128 v[88:91], v12 offset:448
    ds_read_b128 v[92:95], v13 offset:448
    s_waitcnt lgkmcnt(10)
    v_mfma_f32_16x16x32_bf16 v[4:7], v[96:99], v[100:103], v[4:7]
    s_waitcnt lgkmcnt(8)
    v_mfma_f32_16x16x32_bf16 v[4:7], v[104:107], v[108:111], v[4:7]
    s_waitcnt lgkmcnt(6)
    v_mfma_f32_16x16x32_bf16 v[4:7], v[112:115], v[116:119], v[4:7]
    s_waitcnt lgkmcnt(4)
    v_mfma_f32_16x16x32_bf16 v[4:7], v[120:123], v[124:127], v[4:7]
    s_waitcnt lgkmcnt(2)
    v_mfma_f32_16x16x32_bf16 v[4:7], v[80:83], v[84:87], v[4:7]
    s_waitcnt lgkmcnt(0)
    v_mfma_f32_16x16x32_bf16 v[4:7], v[88:91], v[92:95], v[4:7]
    ds_read_b64 v[96:97], v14 offset:2112
    ds_read_b64 v[98:99], v14 offset:6336
    ds_read_b64 v[100:101], v14 offset:2624
    ds_read_b64 v[102:103], v14 offset:6848
    ds_read_b64 v[104:105], v14 offset:3168
    ds_read_b64 v[106:107], v14 offset:7392
    ds_read_b64 v[108:109], v14 offset:3680
    ds_read_b64 v[110:111], v14 offset:7904
    ds_read_b64 v[80:81], v14 offset:0
    ds_read_b64 v[82:83], v14 offset:4224
    ds_read_b64 v[84:85], v14 offset:512
    ds_read_b64 v[86:87], v14 offset:4736
    ds_read_b64 v[88:89], v14 offset:1056
    ds_read_b64 v[90:91], v14 offset:5280
    ds_read_b64 v[92:93], v14 offset:1568
    s_waitcnt lgkmcnt(14)
    ds_read_b64 v[94:95], v14 offset:5792
    v_mul_f32 v4, 0x3db8aa3b, v4
    v_mul_f32 v5, 0x3db8aa3b, v5
    v_mul_f32 v6, 0x3db8aa3b, v6
    v_mul_f32 v7, 0x3db8aa3b, v7
    v_exp_f32 v4, v4
    v_exp_f32 v5, v5
    v_exp_f32 v6, v6
    v_exp_f32 v7, v7
    v_add_f32 v12, v4, v5
    v_add_f32 v13, v6, v7
    v_add_f32 v12, v12, v13
    v_add_f32 v12, 0x3089705f, v12
    v_rcp_f32 v12, v12
    s_add_u32 s63, s63, 8
    v_mul_f32 v4, v4, v12
    v_mul_f32 v5, v5, v12
    v_mul_f32 v6, v6, v12
    v_mul_f32 v7, v7, v12
    v_cvt_pk_bf16_f32 v4, v4, v5
    v_cvt_pk_bf16_f32 v6, v6, v7
    v_perm_b32 v112, v4, v4, v8
    v_perm_b32 v113, v4, v4, v9
    v_perm_b32 v114, v4, v4, v10
    v_perm_b32 v115, v4, v4, v11
    v_perm_b32 v116, v6, v6, v8
    v_perm_b32 v117, v6, v6, v9
    v_perm_b32 v118, v6, v6, v10
    v_perm_b32 v119, v6, v6, v11
    s_waitcnt lgkmcnt(0)
    v_mfma_f32_4x4x4_16b_bf16 v[120:123], v[112:113], v[80:81], 0 cbsz:4 abid:0
    v_mfma_f32_4x4x4_16b_bf16 v[124:127], v[112:113], v[82:83], 0 cbsz:4 abid:5
    v_mfma_f32_4x4x4_16b_bf16 v[4:7], v[112:113], v[84:85], 0 cbsz:4 abid:10
    v_mfma_f32_4x4x4_16b_bf16 v[12:15], v[112:113], v[86:87], 0 cbsz:4 abid:15
    v_mfma_f32_4x4x4_16b_bf16 v[120:123], v[114:115], v[88:89], v[120:123] cbsz:4 abid:0
    v_mfma_f32_4x4x4_16b_bf16 v[124:127], v[114:115], v[90:91], v[124:127] cbsz:4 abid:5
    v_mfma_f32_4x4x4_16b_bf16 v[4:7], v[114:115], v[92:93], v[4:7] cbsz:4 abid:10
    v_mfma_f32_4x4x4_16b_bf16 v[12:15], v[114:115], v[94:95], v[12:15] cbsz:4 abid:15
    v_mfma_f32_4x4x4_16b_bf16 v[120:123], v[116:117], v[96:97], v[120:123] cbsz:4 abid:0
    v_mfma_f32_4x4x4_16b_bf16 v[124:127], v[116:117], v[98:99], v[124:127] cbsz:4 abid:5
    v_mfma_f32_4x4x4_16b_bf16 v[4:7], v[116:117], v[100:101], v[4:7] cbsz:4 abid:10
    v_mfma_f32_4x4x4_16b_bf16 v[12:15], v[116:117], v[102:103], v[12:15] cbsz:4 abid:15
    v_mfma_f32_4x4x4_16b_bf16 v[120:123], v[118:119], v[104:105], v[120:123] cbsz:4 abid:0
    v_mfma_f32_4x4x4_16b_bf16 v[124:127], v[118:119], v[106:107], v[124:127] cbsz:4 abid:5
    v_mfma_f32_4x4x4_16b_bf16 v[4:7], v[118:119], v[108:109], v[4:7] cbsz:4 abid:10
    v_mfma_f32_4x4x4_16b_bf16 v[12:15], v[118:119], v[110:111], v[12:15] cbsz:4 abid:15
    s_nop 1
    s_cmp_lt_u32 s63, 16
    s_cbranch_scc1 L_grp3
    v_cvt_pk_bf16_f32 v112, v120, v121
    v_cvt_pk_bf16_f32 v113, v122, v123
    v_cvt_pk_bf16_f32 v114, v124, v125
    v_cvt_pk_bf16_f32 v115, v126, v127
    v_cvt_pk_bf16_f32 v116, v4, v5
    v_cvt_pk_bf16_f32 v117, v6, v7
    v_cvt_pk_bf16_f32 v118, v12, v13
    v_cvt_pk_bf16_f32 v119, v14, v15
    v_and_b32 v4, 3, v0
    v_lshlrev_b32 v4, 2, v4
    v_sub_u32 v2, v2, v4
    ds_write_b32 v2, v112 offset:0
    ds_write_b32 v2, v113 offset:16
    ds_write_b32 v2, v114 offset:1056
    ds_write_b32 v2, v115 offset:1072
    ds_write_b32 v2, v116 offset:2112
    ds_write_b32 v2, v117 offset:2128
    ds_write_b32 v2, v118 offset:3168
    ds_write_b32 v2, v119 offset:3184
    s_branch L_grpx
L_grp3:
    v_cvt_pk_bf16_f32 v112, v120, v121
    v_cvt_pk_bf16_f32 v113, v122, v123
    ds_write_b64 v2, v[112:113] offset:0
    v_cvt_pk_bf16_f32 v114, v124, v125
    v_cvt_pk_bf16_f32 v115, v126, v127
    ds_write_b64 v2, v[114:115] offset:1056
    v_cvt_pk_bf16_f32 v116, v4, v5
    v_cvt_pk_bf16_f32 v117, v6, v7
    ds_write_b64 v2, v[116:117] offset:2112
    v_cvt_pk_bf16_f32 v118, v12, v13
    v_cvt_pk_bf16_f32 v119, v14, v15
    ds_write_b64 v2, v[118:119] offset:3168
    s_cmp_lt_u32 s63, 10
    s_cbranch_scc1 L_grp
L_grpx:
    s_mov_b64 exec, 1
    v_mov_b32 v4, 1
    ds_add_u32 v3, v4 offset:24
    s_mov_b64 exec, -1
    v_add_u32 v12, 105600, v1
    v_lshlrev_b32 v14, 4, v0
    v_and_b32 v6, 15, v0
    v_lshlrev_b32 v6, 2, v6
    v_and_b32 v5, 48, v0
    v_lshl_add_u32 v8, v5, 7, v6
    v_lshl_add_u32 v9, v5, 6, v6
    s_lshl_b32 s60, s5, 9
    s_lshl_b32 s61, s3, 6
    s_add_u32 s60, s60, s61
    v_and_b32 v4, 3, v0
    v_mul_u32_u24 v15, 1056, v4
    v_and_b32 v4, 8, v0
    v_lshl_add_u32 v15, v4, 6, v15
    v_and_b32 v4, 48, v0
    v_lshl_add_u32 v15, v4, 1, v15
    v_and_b32 v4, 4, v0
    v_lshl_add_u32 v15, v4, 2, v15
    v_add_u32 v15, 122496, v15
    v_mul_u32_u24 v13, 21845, v4
    v_lshrrev_b32 v13, 1, v13
    v_add_u32 v13, 0x4444, v13
    v_mov_b64 v[120:121], 0
    v_mov_b64 v[122:123], 0
    v_mov_b64 v[124:125], 0
    v_mov_b64 v[126:127], 0
    s_mov_b32 s59, 0
Lw_47:
    ds_read_b32 v4, v3 offset:24
    s_waitcnt lgkmcnt(0)
    v_cmp_gt_u32 vcc, 8, v4
    s_cbranch_vccz Lk_48
    s_sleep 1
    s_add_u32 s59, s59, 1
    s_cmp_lt_u32 s59, 4194304
    s_cbranch_scc1 Lw_47
    s_branch L_end
Lk_48:
    ds_read_b128 v[80:83], v12 offset:0
    ds_read_b128 v[84:87], v12 offset:8448
    ds_read_b128 v[92:95], v12 offset:64
    ds_read_b128 v[96:99], v12 offset:8512
    ds_read_b128 v[100:103], v15 offset:0
    s_waitcnt vmcnt(14) lgkmcnt(3)
    v_mfma_f32_16x16x32_bf16 v[104:107], v[80:83], v[16:19], 0
    v_mfma_f32_16x16x32_bf16 v[108:111], v[80:83], v[24:27], 0
    v_mfma_f32_16x16x32_bf16 v[112:115], v[84:87], v[16:19], 0
    v_mfma_f32_16x16x32_bf16 v[116:119], v[84:87], v[24:27], 0
    ds_read_b128 v[80:83], v12 offset:128
    ds_read_b128 v[84:87], v12 offset:8576
    s_waitcnt vmcnt(12) lgkmcnt(2)
    v_mfma_f32_16x16x32_bf16 v[104:107], v[92:95], v[20:23], v[104:107]
    v_mfma_f32_16x16x32_bf16 v[108:111], v[92:95], v[28:31], v[108:111]
    v_mfma_f32_16x16x32_bf16 v[112:115], v[96:99], v[20:23], v[112:115]
    v_mfma_f32_16x16x32_bf16 v[116:119], v[96:99], v[28:31], v[116:119]
    v_smfmac_f32_16x16x64_bf16 v[120:123], v[100:103], v[16:23], v13
    v_smfmac_f32_16x16x64_bf16 v[124:127], v[100:103], v[24:31], v13
    ds_read_b128 v[92:95], v12 offset:192
    ds_read_b128 v[96:99], v12 offset:8640
    ds_read_b128 v[100:103], v15 offset:128
    s_waitcnt vmcnt(10) lgkmcnt(3)
    v_mfma_f32_16x16x32_bf16 v[104:107], v[80:83], v[32:35], v[104:107]
    v_mfma_f32_16x16x32_bf16 v[108:111], v[80:83], v[40:43], v[108:111]
    v_mfma_f32_16x16x32_bf16 v[112:115], v[84:87], v[32:35], v[112:115]
    v_mfma_f32_16x16x32_bf16 v[116:119], v[84:87], v[40:43], v[116:119]
    ds_read_b128 v[80:83], v12 offset:256
    ds_read_b128 v[84:87], v12 offset:8704
    s_waitcnt vmcnt(8) lgkmcnt(2)
    v_mfma_f32_16x16x32_bf16 v[104:107], v[92:95], v[36:39], v[104:107]
    v_mfma_f32_16x16x32_bf16 v[108:111], v[92:95], v[44:47], v[108:111]
    v_mfma_f32_16x16x32_bf16 v[112:115], v[96:99], v[36:39], v[112:115]
    v_mfma_f32_16x16x32_bf16 v[116:119], v[96:99], v[44:47], v[116:119]
    v_smfmac_f32_16x16x64_bf16 v[120:123], v[100:103], v[32:39], v13
    v_smfmac_f32_16x16x64_bf16 v[124:127], v[100:103], v[40:47], v13
    ds_read_b128 v[92:95], v12 offset:320
    ds_read_b128 v[96:99], v12 offset:8768
    ds_read_b128 v[100:103], v15 offset:256
    s_waitcnt vmcnt(6) lgkmcnt(3)
    v_mfma_f32_16x16x32_bf16 v[104:107], v[80:83], v[48:51], v[104:107]
    v_mfma_f32_16x16x32_bf16 v[108:111], v[80:83], v[56:59], v[108:111]
    v_mfma_f32_16x16x32_bf16 v[112:115], v[84:87], v[48:51], v[112:115]
    v_mfma_f32_16x16x32_bf16 v[116:119], v[84:87], v[56:59], v[116:119]
    ds_read_b128 v[80:83], v12 offset:384
    ds_read_b128 v[84:87], v12 offset:8832
    s_waitcnt vmcnt(4) lgkmcnt(2)
    v_mfma_f32_16x16x32_bf16 v[104:107], v[92:95], v[52:55], v[104:107]
    v_mfma_f32_16x16x32_bf16 v[108:111], v[92:95], v[60:63], v[108:111]
    v_mfma_f32_16x16x32_bf16 v[112:115], v[96:99], v[52:55], v[112:115]
    v_mfma_f32_16x16x32_bf16 v[116:119], v[96:99], v[60:63], v[116:119]
    v_smfmac_f32_16x16x64_bf16 v[120:123], v[100:103], v[48:55], v13
    v_smfmac_f32_16x16x64_bf16 v[124:127], v[100:103], v[56:63], v13
    ds_read_b128 v[92:95], v12 offset:448
    ds_read_b128 v[96:99], v12 offset:8896
    ds_read_b128 v[100:103], v15 offset:384
    s_waitcnt vmcnt(2) lgkmcnt(3)
    v_mfma_f32_16x16x32_bf16 v[104:107], v[80:83], v[64:67], v[104:107]
    v_mfma_f32_16x16x32_bf16 v[108:111], v[80:83], v[72:75], v[108:111]
    v_mfma_f32_16x16x32_bf16 v[112:115], v[84:87], v[64:67], v[112:115]
    v_mfma_f32_16x16x32_bf16 v[116:119], v[84:87], v[72:75], v[116:119]
    s_waitcnt vmcnt(0) lgkmcnt(0)
    v_mfma_f32_16x16x32_bf16 v[104:107], v[92:95], v[68:71], v[104:107]
    v_mfma_f32_16x16x32_bf16 v[108:111], v[92:95], v[76:79], v[108:111]
    v_mfma_f32_16x16x32_bf16 v[112:115], v[96:99], v[68:71], v[112:115]
    v_mfma_f32_16x16x32_bf16 v[116:119], v[96:99], v[76:79], v[116:119]
    v_smfmac_f32_16x16x64_bf16 v[120:123], v[100:103], v[64:71], v13
    v_smfmac_f32_16x16x64_bf16 v[124:127], v[100:103], v[72:79], v13
    s_add_u32 s100, s100, 122880
    s_setprio 3
    s_add_u32 s100, s100, 4096
    buffer_load_dwordx4 v[48:51], v14, s[16:19], s100 offen offset:0 sc1
    buffer_load_dwordx4 v[56:59], v14, s[16:19], s100 offen offset:1024 sc1
    buffer_load_dwordx4 v[52:55], v14, s[16:19], s100 offen offset:2048 sc1
    buffer_load_dwordx4 v[60:63], v14, s[16:19], s100 offen offset:3072 sc1
    s_add_u32 s100, s100, 4096
    buffer_load_dwordx4 v[64:67], v14, s[16:19], s100 offen offset:0 sc1
    buffer_load_dwordx4 v[72:75], v14, s[16:19], s100 offen offset:1024 sc1
    buffer_load_dwordx4 v[68:71], v14, s[16:19], s100 offen offset:2048 sc1
    buffer_load_dwordx4 v[76:79], v14, s[16:19], s100 offen offset:3072 sc1
    s_setprio 0
    v_and_b32 v5, 15, v0
    v_lshlrev_b32 v5, 2, v5
    v_and_b32 v6, 16, v0
    v_lshl_add_u32 v5, v6, 2, v5
    s_lshl_b32 s58, s3, 6
    v_add_u32 v5, s58, v5
    v_and_b32 v5, 0x1ff, v5
    v_and_b32 v6, 48, v0
    v_lshl_add_u32 v5, v6, 8, v5
    s_mov_b32 s70, 0x05040100
    s_mov_b32 s71, 0x07060302
    s_mov_b32 s59, 0
Lw_49:
    ds_read_b32 v4, v3 offset:64
    s_waitcnt lgkmcnt(0)
    v_cmp_gt_u32 vcc, 8, v4
    s_cbranch_vccz Lk_50
    s_sleep 2
    s_add_u32 s59, s59, 1
    s_cmp_lt_u32 s59, 16777216
    s_cbranch_scc1 Lw_49
    s_branch L_end
Lk_50:
    ds_read2st64_b32 v[80:81], v5 offset0:0 offset1:2
    ds_read2st64_b32 v[82:83], v5 offset0:4 offset1:6
    ds_read2st64_b32 v[84:85], v5 offset0:8 offset1:10
    ds_read2st64_b32 v[86:87], v5 offset0:12 offset1:14
    ds_read2st64_b32 v[88:89], v5 offset0:64 offset1:66
    ds_read2st64_b32 v[90:91], v5 offset0:68 offset1:70
    ds_read2st64_b32 v[92:93], v5 offset0:72 offset1:74
    ds_read2st64_b32 v[94:95], v5 offset0:76 offset1:78
    ds_read2st64_b32 v[96:97], v5 offset0:128 offset1:130
    ds_read2st64_b32 v[98:99], v5 offset0:132 offset1:134
    ds_read2st64_b32 v[100:101], v5 offset0:136 offset1:138
    ds_read2st64_b32 v[102:103], v5 offset0:140 offset1:142
    s_waitcnt lgkmcnt(8)
    v_perm_b32 v16, v81, v80, s70
    v_perm_b32 v24, v81, v80, s71
    v_perm_b32 v17, v83, v82, s70
    v_perm_b32 v25, v83, v82, s71
    v_perm_b32 v18, v85, v84, s70
    v_perm_b32 v26, v85, v84, s71
    v_perm_b32 v19, v87, v86, s70
    v_perm_b32 v27, v87, v86, s71
    ds_read2st64_b32 v[80:81], v5 offset0:192 offset1:194
    ds_read2st64_b32 v[82:83], v5 offset0:196 offset1:198
    ds_read2st64_b32 v[84:85], v5 offset0:200 offset1:202
    ds_read2st64_b32 v[86:87], v5 offset0:204 offset1:206
    s_waitcnt lgkmcnt(8)
    v_perm_b32 v20, v89, v88, s70
    v_perm_b32 v28, v89, v88, s71
    v_perm_b32 v21, v91, v90, s70
    v_perm_b32 v29, v91, v90, s71
    v_perm_b32 v22, v93, v92, s70
    v_perm_b32 v30, v93, v92, s71
    v_perm_b32 v23, v95, v94, s70
    v_perm_b32 v31, v95, v94, s71
    s_waitcnt lgkmcnt(4)
    v_perm_b32 v32, v97, v96, s70
    v_perm_b32 v40, v97, v96, s71
    v_perm_b32 v33, v99, v98, s70
    v_perm_b32 v41, v99, v98, s71
    v_perm_b32 v34, v101, v100, s70
    v_perm_b32 v42, v101, v100, s71
    v_perm_b32 v35, v103, v102, s70
    v_perm_b32 v43, v103, v102, s71
    s_waitcnt lgkmcnt(0)
    v_perm_b32 v36, v81, v80, s70
    v_perm_b32 v44, v81, v80, s71
    v_perm_b32 v37, v83, v82, s70
    v_perm_b32 v45, v83, v82, s71
    v_perm_b32 v38, v85, v84, s70
    v_perm_b32 v46, v85, v84, s71
    v_perm_b32 v39, v87, v86, s70
    v_perm_b32 v47, v87, v86, s71
    v_add_u32 v12, 130944, v1
    s_mov_b32 s59, 0
Lw_51:
    ds_read_b32 v4, v3 offset:36
    s_waitcnt lgkmcnt(0)
    v_cmp_gt_u32 vcc, 16, v4
    s_cbranch_vccz Lk_52
    s_sleep 3
    s_add_u32 s59, s59, 1
    s_cmp_lt_u32 s59, 16777216
    s_cbranch_scc1 Lw_51
    s_branch L_end
Lk_52:
    ds_read_b128 v[80:83], v12 offset:0
    ds_read_b128 v[84:87], v12 offset:64
    ds_read_b128 v[88:91], v12 offset:128
    ds_read_b128 v[92:95], v12 offset:192
    ds_read_b128 v[96:99], v12 offset:256
    ds_read_b128 v[100:103], v12 offset:320
    s_waitcnt vmcnt(14) lgkmcnt(5)
    v_mfma_f32_16x16x32_bf16 v[104:107], v[80:83], v[16:19], v[104:107]
    v_mfma_f32_16x16x32_bf16 v[108:111], v[80:83], v[24:27], v[108:111]
    ds_read_b128 v[80:83], v12 offset:384
    s_waitcnt vmcnt(12) lgkmcnt(5)
    v_mfma_f32_16x16x32_bf16 v[104:107], v[84:87], v[20:23], v[104:107]
    v_mfma_f32_16x16x32_bf16 v[108:111], v[84:87], v[28:31], v[108:111]
    ds_read_b128 v[84:87], v12 offset:448
    s_waitcnt vmcnt(10) lgkmcnt(5)
    v_mfma_f32_16x16x32_bf16 v[104:107], v[88:91], v[32:35], v[104:107]
    v_mfma_f32_16x16x32_bf16 v[108:111], v[88:91], v[40:43], v[108:111]
    s_waitcnt vmcnt(8) lgkmcnt(4)
    v_mfma_f32_16x16x32_bf16 v[104:107], v[92:95], v[36:39], v[104:107]
    v_mfma_f32_16x16x32_bf16 v[108:111], v[92:95], v[44:47], v[108:111]
    s_waitcnt vmcnt(6) lgkmcnt(3)
    v_mfma_f32_16x16x32_bf16 v[104:107], v[96:99], v[48:51], v[104:107]
    v_mfma_f32_16x16x32_bf16 v[108:111], v[96:99], v[56:59], v[108:111]
    s_waitcnt vmcnt(4) lgkmcnt(2)
    v_mfma_f32_16x16x32_bf16 v[104:107], v[100:103], v[52:55], v[104:107]
    v_mfma_f32_16x16x32_bf16 v[108:111], v[100:103], v[60:63], v[108:111]
    s_waitcnt vmcnt(2) lgkmcnt(1)
    v_mfma_f32_16x16x32_bf16 v[104:107], v[80:83], v[64:67], v[104:107]
    v_mfma_f32_16x16x32_bf16 v[108:111], v[80:83], v[72:75], v[108:111]
    s_waitcnt vmcnt(0) lgkmcnt(0)
    v_mfma_f32_16x16x32_bf16 v[104:107], v[84:87], v[68:71], v[104:107]
    v_mfma_f32_16x16x32_bf16 v[108:111], v[84:87], v[76:79], v[108:111]
    s_nop 7
    v_cvt_pk_bf16_f32 v104, v104, v108
    buffer_store_dword v104, v8, s[20:23], s60 offen offset:0 sc1
    v_cvt_pk_bf16_f32 v105, v105, v109
    buffer_store_dword v105, v8, s[20:23], s60 offen offset:512 sc1
    v_cvt_pk_bf16_f32 v106, v106, v110
    buffer_store_dword v106, v8, s[20:23], s60 offen offset:1024 sc1
    v_cvt_pk_bf16_f32 v107, v107, v111
    buffer_store_dword v107, v8, s[20:23], s60 offen offset:1536 sc1
    s_add_u32 s60, s60, 8192
    s_mov_b32 s59, 0
Lw_53:
    ds_read_b32 v4, v3 offset:40
    s_waitcnt lgkmcnt(0)
    v_cmp_gt_u32 vcc, 16, v4
    s_cbranch_vccz Lk_54
    s_sleep 3
    s_add_u32 s59, s59, 1
    s_cmp_lt_u32 s59, 16777216
    s_cbranch_scc1 Lw_53
    s_branch L_end
Lk_54:
    ds_read_b128 v[80:83], v12 offset:8448
    ds_read_b128 v[84:87], v12 offset:8512
    ds_read_b128 v[88:91], v12 offset:8576
    ds_read_b128 v[92:95], v12 offset:8640
    ds_read_b128 v[96:99], v12 offset:8704
    ds_read_b128 v[100:103], v12 offset:8768
    s_waitcnt lgkmcnt(5)
    v_mfma_f32_16x16x32_bf16 v[112:115], v[80:83], v[16:19], v[112:115]
    v_mfma_f32_16x16x32_bf16 v[116:119], v[80:83], v[24:27], v[116:119]
    ds_read_b128 v[80:83], v12 offset:8832
    s_waitcnt lgkmcnt(5)
    v_mfma_f32_16x16x32_bf16 v[112:115], v[84:87], v[20:23], v[112:115]
    v_mfma_f32_16x16x32_bf16 v[116:119], v[84:87], v[28:31], v[116:119]
    ds_read_b128 v[84:87], v12 offset:8896
    s_waitcnt lgkmcnt(5)
    v_mfma_f32_16x16x32_bf16 v[112:115], v[88:91], v[32:35], v[112:115]
    v_mfma_f32_16x16x32_bf16 v[116:119], v[88:91], v[40:43], v[116:119]
    s_waitcnt lgkmcnt(4)
    v_mfma_f32_16x16x32_bf16 v[112:115], v[92:95], v[36:39], v[112:115]
    v_mfma_f32_16x16x32_bf16 v[116:119], v[92:95], v[44:47], v[116:119]
    s_waitcnt lgkmcnt(3)
    v_mfma_f32_16x16x32_bf16 v[112:115], v[96:99], v[48:51], v[112:115]
    v_mfma_f32_16x16x32_bf16 v[116:119], v[96:99], v[56:59], v[116:119]
    s_waitcnt lgkmcnt(2)
    v_mfma_f32_16x16x32_bf16 v[112:115], v[100:103], v[52:55], v[112:115]
    v_mfma_f32_16x16x32_bf16 v[116:119], v[100:103], v[60:63], v[116:119]
    s_waitcnt lgkmcnt(1)
    v_mfma_f32_16x16x32_bf16 v[112:115], v[80:83], v[64:67], v[112:115]
    v_mfma_f32_16x16x32_bf16 v[116:119], v[80:83], v[72:75], v[116:119]
    s_waitcnt lgkmcnt(0)
    v_mfma_f32_16x16x32_bf16 v[112:115], v[84:87], v[68:71], v[112:115]
    v_mfma_f32_16x16x32_bf16 v[116:119], v[84:87], v[76:79], v[116:119]
    s_nop 7
    v_cvt_pk_bf16_f32 v112, v112, v116
    buffer_store_dword v112, v8, s[20:23], s60 offen offset:0 sc1
    v_cvt_pk_bf16_f32 v113, v113, v117
    buffer_store_dword v113, v8, s[20:23], s60 offen offset:512 sc1
    v_cvt_pk_bf16_f32 v114, v114, v118
    buffer_store_dword v114, v8, s[20:23], s60 offen offset:1024 sc1
    v_cvt_pk_bf16_f32 v115, v115, v119
    buffer_store_dword v115, v8, s[20:23], s60 offen offset:1536 sc1
    s_add_u32 s60, s60, 8192
    v_add_u32 v15, 25344, v15
    s_mov_b32 s59, 0
Lw_55:
    ds_read_b32 v4, v3 offset:44
    s_waitcnt lgkmcnt(0)
    v_cmp_gt_u32 vcc, 8, v4
    s_cbranch_vccz Lk_56
    s_add_u32 s59, s59, 1
    s_cmp_lt_u32 s59, 16777216
    s_cbranch_scc1 Lw_55
    s_branch L_end
Lk_56:
    ds_read_b128 v[80:83], v15 offset:0
    ds_read_b128 v[84:87], v15 offset:128
    ds_read_b128 v[88:91], v15 offset:256
    ds_read_b128 v[92:95], v15 offset:384
    s_waitcnt lgkmcnt(3)
    v_smfmac_f32_16x16x64_bf16 v[120:123], v[80:83], v[16:23], v13
    v_smfmac_f32_16x16x64_bf16 v[124:127], v[80:83], v[24:31], v13
    s_waitcnt lgkmcnt(2)
    v_smfmac_f32_16x16x64_bf16 v[120:123], v[84:87], v[32:39], v13
    v_smfmac_f32_16x16x64_bf16 v[124:127], v[84:87], v[40:47], v13
    s_waitcnt lgkmcnt(1)
    v_smfmac_f32_16x16x64_bf16 v[120:123], v[88:91], v[48:55], v13
    v_smfmac_f32_16x16x64_bf16 v[124:127], v[88:91], v[56:63], v13
    s_waitcnt lgkmcnt(0)
    v_smfmac_f32_16x16x64_bf16 v[120:123], v[92:95], v[64:71], v13
    v_smfmac_f32_16x16x64_bf16 v[124:127], v[92:95], v[72:79], v13
    s_nop 6
    v_permlane16_swap_b32 v120, v122
    v_permlane16_swap_b32 v121, v123
    v_permlane16_swap_b32 v124, v126
    v_permlane16_swap_b32 v125, v127
    v_pk_add_f32 v[120:121], v[120:121], v[122:123]
    v_pk_add_f32 v[124:125], v[124:125], v[126:127]
    v_cvt_pk_bf16_f32 v120, v120, v124
    buffer_store_dword v120, v9, s[20:23], s60 offen offset:0 sc1
    v_cvt_pk_bf16_f32 v121, v121, v125
    buffer_store_dword v121, v9, s[20:23], s60 offen offset:512 sc1
L_end:
L_exit:
    s_endpgm
L_slow:
    s_setprio 0
    s_mov_b64 exec, 1
    ds_add_u32 v3, v62 offset:16
    s_mov_b64 exec, -1
    s_mov_b32 s59, 0
Lw_57:
    ds_read_b32 v4, v3 offset:16
    s_waitcnt lgkmcnt(0)
    v_cmp_gt_u32 vcc, 8, v4
    s_cbranch_vccz Lk_58
    s_add_u32 s59, s59, 1
    s_cmp_lt_u32 s59, 4194304
    s_cbranch_scc1 Lw_57
    s_branch L_end
Lk_58:
    v_mov_b32 v12, v3
    s_mov_b64 s[24:25], s[34:35]
    s_mov_b32 s26, 640000
    s_mov_b64 s[28:29], s[36:37]
    s_mov_b32 s30, 640000
    s_mov_b64 s[12:13], s[42:43]
    s_mov_b32 s14, 20000
    s_mov_b32 s15, 0x20000
    s_sub_u32 s63, s67, 1
    s_mov_b32 s65, 201486784
    s_mov_b32 s64, 0
    s_call_b64 s[68:69], L_flush
    s_add_u32 s66, s4, s5
    s_add_u32 s67, s66, 40
    v_lshlrev_b32 v16, 2, v0
    v_and_b32 v17, 32, v0
    v_lshl_add_u32 v17, v17, 22, v2
    v_mov_b32 v24, 0
L_sn:
    s_mov_b32 s60, 0
L_sc:
    buffer_load_dword v18, v16, s[28:31], s60 offen
    buffer_load_dword v19, v16, s[24:27], s60 offen
    s_waitcnt vmcnt(0)
    v_cmp_eq_u32 vcc, s66, v18
    s_cbranch_vccz L_sx
L_se:
    s_ff1_i32_b64 s58, vcc
    s_bitset0_b64 vcc, s58
    v_readlane_b32 s59, v19, s58
    s_nop 3
    s_lshl_b32 s61, s59, 9
    s_lshl_b32 s59, s59, 1
    buffer_load_dwordx4 v[20:23], v17, s[8:11], s61 offen
    buffer_load_ushort v1, v24, s[12:15], s59 offen
    s_waitcnt vmcnt(0)
    v_perm_b32 v6, v1, v1, v10
    v_perm_b32 v7, v1, v1, v11
    s_nop 1
    v_mfma_f32_4x4x4_16b_bf16 v[56:59], v[6:7], v[20:21], v[56:59]
    v_mfma_f32_4x4x4_16b_bf16 v[60:63], v[6:7], v[22:23], v[60:63]
    s_cmp_lg_u64 vcc, 0
    s_cbranch_scc1 L_se
L_sx:
    s_add_u32 s60, s60, 256
    s_cmp_lt_u32 s60, 640000
    s_cbranch_scc1 L_sc
    s_call_b64 s[68:69], L_flush
    s_add_u32 s66, s66, 8
    s_cmp_lt_u32 s66, s67
    s_cbranch_scc1 L_sn
    s_branch L_gdone
.section .rodata,"a"
.p2align 6
.amdhsa_kernel standalone__hybrid_graph_tf_exphormer__graph_kernel
  .amdhsa_next_free_vgpr 128
  .amdhsa_next_free_sgpr 102
  .amdhsa_accum_offset 128
  .amdhsa_group_segment_fixed_size 0
  .amdhsa_kernarg_size 104
  .amdhsa_user_sgpr_count 2
  .amdhsa_user_sgpr_kernarg_segment_ptr 1
  .amdhsa_system_sgpr_workgroup_id_x 1
.end_amdhsa_kernel
```

```asm
; @launch grid=(250,1,1) block=(1024,1,1) lds=162240
.amdgcn_target "amdgcn-amd-amdhsa--gfx950"
.text
.globl standalone__hybrid_graph_tf_exphormer__graph_kernel
.p2align 8
.type standalone__hybrid_graph_tf_exphormer__graph_kernel,@function
standalone__hybrid_graph_tf_exphormer__graph_kernel:
    s_cmpk_ge_u32 s2, 250
    s_cbranch_scc1 L_exit
    s_load_dwordx16 s[32:47], s[0:1], 0
    s_load_dwordx8 s[48:55], s[0:1], 64
    s_load_dwordx2 s[56:57], s[0:1], 96
    s_getpc_b64 s[60:61]
    s_lshr_b32 s6, s2, 3
    v_lshl_add_u32 v1, v0, 5, s6
    v_lshlrev_b32 v2, 7, v1
    v_cmpx_gt_u32 vcc, 91, v1
    s_cbranch_execz L_nopf
    global_load_dword v15, v2, s[60:61] offset:384
L_nopf:
    s_mov_b64 exec, -1
    v_lshrrev_b32 v1, 6, v0
    v_lshlrev_b32 v5, 4, v0
    v_and_b32 v6, 32, v0
    v_readfirstlane_b32 s3, v1
    v_and_b32 v2, 0x1f0, v5
    s_and_b32 s4, s3, 7
    s_and_b32 s61, s3, 4
    s_add_u32 s61, s61, s4
    s_mul_i32 s101, s4, 1056
    s_cmp_ge_u32 s3, 8
    s_cbranch_scc1 L_eA
    s_setprio 3
    s_sub_u32 s62, s2, 64
    s_cbranch_scc0 L_eM
    s_mul_i32 s58, s2, 10000
    v_add_u32 v8, s58, v5
    v_min_u32 v9, 451, v0
    s_addk_i32 s58, 8192
    v_lshl_add_u32 v9, v9, 2, s58
    s_mov_b32 s63, 1
    s_waitcnt lgkmcnt(0)
    global_load_dwordx4 v[22:25], v8, s[36:37]
    global_load_dword v26, v9, s[36:37]
    s_setprio 2
    global_load_dwordx4 v[16:19], v8, s[34:35]
    global_load_dword v20, v9, s[34:35]
    s_branch L_eB
L_eM:
    s_cmpk_ge_u32 s62, 128
    s_cbranch_scc1 L_eW
    s_mov_b32 s63, 0
    s_cmp_ge_u32 s4, 4
    s_cbranch_scc1 L_eBw
    v_lshl_add_u32 v8, v6, 8, v2
    v_lshl_add_u32 v8, s61, 9, v8
    s_lshr_b32 s58, s62, 4
    s_bfe_u32 s59, s62, 0x10003
    s_lshl3_add_u32 s58, s58, s59
    v_lshl_add_u32 v9, s58, 11, v8
    s_and_b32 s58, s62, 7
    v_lshl_add_u32 v8, s58, 14, v8
    s_add_u32 m0, s101, 105600
    s_waitcnt lgkmcnt(0)
    global_load_lds_dwordx4 v8, s[46:47]
    s_addk_i32 m0, 6400
    s_mov_b32 s63, 2
    global_load_lds_dwordx4 v8, s[46:47] offset:2048
    s_addk_i32 m0, 10496
    s_nop 0
    global_load_lds_dwordx4 v9, s[48:49]
    s_addk_i32 m0, 4224
    v_add_u32 v9, 4096, v9
    global_load_lds_dwordx4 v9, s[48:49]
    s_addk_i32 m0, 48640
    v_add_u32 v8, 4096, v8
    global_load_lds_dwordx4 v8, s[46:47]
    s_addk_i32 m0, 6400
    s_nop 0
    global_load_lds_dwordx4 v8, s[46:47] offset:2048
    s_branch L_eB
L_eA:
    s_and_b32 s59, s2, 7
    s_mul_i32 s60, s59, 31
    s_min_u32 s59, s59, 2
    s_add_u32 s6, s6, s60
    s_add_u32 s6, s6, s59
    s_mul_i32 s5, s6, 40
    s_lshl_b32 s58, s5, 4
    s_lshl3_add_u32 s59, s61, s58
    s_lshl_b32 s60, s4, 6
    s_add_u32 s58, s58, s60
    s_add_u32 s60, s5, s4
    v_lshl_add_u32 v8, s60, 9, v2
    v_lshl_add_u32 v9, v6, 7, v8
    s_add_u32 m0, s101, 84480
    s_waitcnt lgkmcnt(0)
    s_load_dwordx16 s[12:27], s[38:39], s58
    s_load_dwordx2 s[28:29], s[38:39], s59 offset:512
    s_load_dwordx2 s[30:31], s[38:39], s59 offset:544
    s_load_dword s40, s[56:57], 655616
    s_barrier
    global_load_lds_dwordx4 v9, s[32:33]
    s_addk_i32 m0, 8448
    v_add_u32 v9, 8192, v9
    global_load_lds_dwordx4 v9, s[32:33]
    s_cmp_ge_u32 s4, 4
    s_cbranch_scc1 L_preA
    s_addk_i32 m0, 8448
    v_lshl_add_u32 v9, v6, 6, v8
    v_add_u32 v9, 16384, v9
    global_load_lds_dwordx4 v9, s[32:33]
    s_branch L_preA
L_eW:
    s_mul_i32 s58, s4, 58
    s_add_u32 s62, s62, s58
    s_sub_u32 s62, s62, 128
    s_mov_b32 s63, 0
    s_cmp_ge_u32 s62, 96
    s_waitcnt lgkmcnt(0)
    s_cbranch_scc1 L_eB
    s_and_b32 s59, s62, 28
    s_add_u32 s59, s59, 4
    s_cmp_ge_u32 s62, 64
    s_cselect_b32 s59, s59, 0
    s_add_u32 s62, s62, s59
    s_mov_b32 s63, 4
    s_and_b32 s59, s62, 7
    s_lshl_b32 s59, s59, 14
    s_bfe_u32 s60, s62, 0x30003
    s_lshl_b32 s60, s60, 6
    s_add_u32 s59, s59, s60
    v_and_b32 v8, 15, v0
    v_lshl_add_u32 v8, v8, 2, s59
    v_and_b32 v9, 48, v0
    v_lshl_add_u32 v8, v9, 8, v8
    s_cmp_lt_u32 s62, 64
    s_cselect_b64 s[58:59], s[50:51], s[44:45]
    global_load_dword v16, v8, s[58:59] offset:0
    global_load_dword v17, v8, s[58:59] offset:512
    global_load_dword v18, v8, s[58:59] offset:1024
    global_load_dword v19, v8, s[58:59] offset:1536
    global_load_dword v20, v8, s[58:59] offset:2048
    global_load_dword v21, v8, s[58:59] offset:2560
    global_load_dword v22, v8, s[58:59] offset:3072
    global_load_dword v23, v8, s[58:59] offset:3584
L_eBw:
    s_waitcnt lgkmcnt(0)
L_eB:
    s_setprio 3
    v_mov_b32 v8, 33554432
    v_cmp_gt_u32 vcc, 320, v0
    v_add_u32 v4, 152064, v5
    v_mov_b64 v[12:13], 0
    v_cndmask_b32 v8, 0, v8, vcc
    v_mov_b32 v9, v8
    v_mov_b64 v[10:11], v[8:9]
    ds_write_b128 v4, v[8:11]
    v_cmpx_gt_u32 vcc, 60, v0
    ds_write_b64 v4, v[12:13] offset:8192
    ds_write_b64 v4, v[12:13] offset:8200
    s_mov_b64 exec, -1
    s_and_b32 s59, s2, 7
    s_mul_i32 s60, s59, 31
    s_min_u32 s59, s59, 2
    s_add_u32 s6, s6, s60
    s_add_u32 s6, s6, s59
    s_mul_i32 s5, s6, 40
    s_waitcnt lgkmcnt(0)
    s_barrier
    v_and_b32 v0, 63, v0
    s_xor_b32 s3, s3, 8
    v_mov_b32 v3, 160064
    s_mov_b64 s[8:9], s[32:33]
    s_mov_b32 s10, 5120000
    s_mov_b32 s11, 0x20000
    s_mov_b64 s[16:17], s[56:57]
    s_mov_b32 s18, 1441792
    s_mov_b32 s19, 0x20000
    s_mov_b32 s27, 0x20000
    s_mov_b32 s31, 0x20000
    v_mov_b32 v62, 1
    s_cmp_eq_u32 s63, 1
    s_cbranch_scc0 L_notprod
    v_mov_b32 v9, 4
    v_mov_b32 v10, 160192
    v_lshl_add_u32 v11, v0, 4, v10
    v_cmp_gt_u32 vcc, 7232, v5
    v_add_u32 v59, 105600, v5
    s_mul_i32 s58, s2, 10240
    s_mov_b64 s[66:67], vcc
    s_waitcnt vmcnt(3)
    v_mul_u32_u24 v28, 52429, v22
    v_lshrrev_b32 v28, 21, v28
    v_lshl_add_u32 v28, v28, 2, v10
    ds_add_rtn_u32 v34, v28, v9
    v_mul_u32_u24 v29, 52429, v23
    v_lshrrev_b32 v29, 21, v29
    v_lshl_add_u32 v29, v29, 2, v10
    ds_add_rtn_u32 v35, v29, v9
    v_mul_u32_u24 v30, 52429, v24
    v_lshrrev_b32 v30, 21, v30
    v_lshl_add_u32 v30, v30, 2, v10
    ds_add_rtn_u32 v36, v30, v9
    v_mul_u32_u24 v31, 52429, v25
    v_lshrrev_b32 v31, 21, v31
    v_lshl_add_u32 v31, v31, 2, v10
    ds_add_rtn_u32 v37, v31, v9
    s_waitcnt vmcnt(2)
    s_mov_b64 exec, s[66:67]
    v_mul_u32_u24 v32, 52429, v26
    v_lshrrev_b32 v32, 21, v32
    v_lshl_add_u32 v32, v32, 2, v10
    ds_add_rtn_u32 v38, v32, v9
    s_mov_b64 exec, -1
    s_waitcnt lgkmcnt(0)
    s_barrier
    ds_read_b128 v[12:15], v11
    s_waitcnt lgkmcnt(0)
    v_add_u32 v56, v12, v13
    v_add3_u32 v57, v56, v14, v15
    s_nop 1
    v_add_u32_dpp v58, v57, v57 row_shr:1 row_mask:0xf bank_mask:0xf bound_ctrl:1
    s_nop 1
    v_add_u32_dpp v58, v58, v58 row_shr:2 row_mask:0xf bank_mask:0xf bound_ctrl:1
    s_nop 1
    v_add_u32_dpp v58, v58, v58 row_shr:4 row_mask:0xf bank_mask:0xf bound_ctrl:1
    s_nop 1
    v_add_u32_dpp v58, v58, v58 row_shr:8 row_mask:0xf bank_mask:0xf bound_ctrl:1
    s_nop 1
    v_add_u32_dpp v58, v58, v58 row_bcast:15 row_mask:0xa bank_mask:0xf
    s_nop 1
    v_add_u32_dpp v58, v58, v58 row_bcast:31 row_mask:0xc bank_mask:0xf
    v_sub_u32 v64, v58, v57
    v_add_u32 v65, v64, v12
    v_add_u32 v66, v64, v56
    v_add_u32 v67, v66, v14
    ds_write_b128 v11, v[64:67] offset:1024
    ds_read_b32 v40, v28 offset:1024
    ds_read_b32 v41, v29 offset:1024
    ds_read_b32 v42, v30 offset:1024
    ds_read_b32 v43, v31 offset:1024
    s_mov_b64 exec, s[66:67]
    ds_read_b32 v44, v32 offset:1024
    s_mov_b64 exec, -1
    s_mov_b32 s60, 105600
    s_waitcnt vmcnt(0)
    v_lshl_or_b32 v16, v22, 16, v16
    v_lshl_or_b32 v17, v23, 16, v17
    v_lshl_or_b32 v18, v24, 16, v18
    v_lshl_or_b32 v19, v25, 16, v19
    v_lshl_or_b32 v20, v26, 16, v20
    s_waitcnt lgkmcnt(4)
    v_add3_u32 v40, v40, v34, s60
    ds_write_b32 v40, v16
    s_waitcnt lgkmcnt(4)
    v_add3_u32 v41, v41, v35, s60
    ds_write_b32 v41, v17
    s_waitcnt lgkmcnt(4)
    v_add3_u32 v42, v42, v36, s60
    ds_write_b32 v42, v18
    s_waitcnt lgkmcnt(4)
    v_add3_u32 v43, v43, v37, s60
    ds_write_b32 v43, v19
    s_mov_b64 exec, s[66:67]
    s_waitcnt lgkmcnt(4)
    v_add3_u32 v44, v44, v38, s60
    ds_write_b32 v44, v20
    s_mov_b64 exec, -1
    s_waitcnt lgkmcnt(0)
    s_barrier
    ds_read_b128 v[12:15], v59
    ds_read_b128 v[68:71], v59 offset:8192
    s_add_u32 s60, s58, 8192
    s_cmp_ge_u32 s4, 2
    s_waitcnt lgkmcnt(1)
    buffer_store_dwordx4 v[12:15], v5, s[16:19], s58 offen sc1
    s_cbranch_scc1 L_cp1
    s_waitcnt lgkmcnt(0)
    buffer_store_dwordx4 v[68:71], v5, s[16:19], s60 offen sc1
L_cp1:
    s_cmp_eq_u32 s4, 0
    s_cbranch_scc1 L_row
    s_waitcnt vmcnt(0)
    s_mov_b64 exec, 1
    ds_add_u32 v3, v62 offset:56
    s_mov_b64 exec, -1
    s_branch L_preB
L_row:
    s_lshl_b32 s61, s2, 10
    s_add_u32 s61, s61, 1114112
    s_mov_b32 s59, 0
Lw_1:
    ds_read_b32 v4, v3 offset:68
    s_waitcnt lgkmcnt(0)
    v_cmp_gt_u32 vcc, 1, v4
    s_cbranch_vccz Lk_2
    s_add_u32 s59, s59, 1
    s_cmp_lt_u32 s59, 4194304
    s_cbranch_scc1 Lw_1
    s_branch L_end
Lk_2:
    v_readfirstlane_b32 s40, v4
    s_nop 0
    s_bitset0_b32 s40, 0
    v_lshrrev_b32 v64, 2, v64
    v_or_b32 v64, s40, v64
    v_lshrrev_b32 v65, 2, v65
    v_or_b32 v65, s40, v65
    v_lshrrev_b32 v66, 2, v66
    v_or_b32 v66, s40, v66
    v_lshrrev_b32 v67, 2, v67
    v_or_b32 v67, s40, v67
    s_mov_b32 s59, 0
Lw_3:
    ds_read_b32 v4, v3 offset:56
    s_waitcnt lgkmcnt(0)
    v_cmp_gt_u32 vcc, 7, v4
    s_cbranch_vccz Lk_4
    s_add_u32 s59, s59, 1
    s_cmp_lt_u32 s59, 4194304
    s_cbranch_scc1 Lw_3
    s_branch L_end
Lk_4:
    s_waitcnt vmcnt(0)
    buffer_store_dwordx4 v[64:67], v5, s[16:19], s61 offen sc1
    ds_write_b32 v3, v62 offset:32
    s_branch L_preB
L_notprod:
    s_cmp_eq_u32 s63, 0
    s_cbranch_scc1 L_taskw
    v_and_b32 v4, 7, v0
    v_mul_u32_u24 v1, 1056, v4
    v_and_b32 v4, 8, v0
    v_lshl_add_u32 v1, v4, 6, v1
    v_and_b32 v4, 48, v0
    v_add_u32 v1, v4, v1
    v_add_u32 v5, 105600, v1
    s_lshr_b32 s58, s62, 4
    s_and_b32 s59, s62, 7
    s_lshl3_add_u32 s58, s58, s59
    s_bfe_u32 s59, s62, 0x10003
    s_lshl1_add_u32 s58, s58, s59
    s_lshl_b32 s58, s58, 10
    s_add_u32 s58, s58, 720896
    v_lshlrev_b32 v6, 4, v0
    s_waitcnt vmcnt(0)
    s_cmp_eq_u32 s63, 4
    s_cbranch_scc1 L_wtask
    s_cmp_eq_u32 s4, 0
    s_cbranch_scc0 L_taskw
    s_mov_b32 s59, 0
Lw_5:
    ds_read_b32 v4, v3 offset:56
    s_waitcnt lgkmcnt(0)
    v_cmp_gt_u32 vcc, 7, v4
    s_cbranch_vccz Lk_6
    s_add_u32 s59, s59, 1
    s_cmp_lt_u32 s59, 4194304
    s_cbranch_scc1 Lw_5
    s_branch L_end
Lk_6:
    ds_read_b128 v[16:19], v5 offset:0
    ds_read_b128 v[20:23], v5 offset:8448
    ds_read_b128 v[24:27], v5 offset:16896
    ds_read_b128 v[28:31], v5 offset:64
    ds_read_b128 v[32:35], v5 offset:8512
    ds_read_b128 v[36:39], v5 offset:16960
    ds_read_b128 v[40:43], v5 offset:128
    ds_read_b128 v[44:47], v5 offset:8576
    ds_read_b128 v[48:51], v5 offset:17024
    ds_read_b128 v[64:67], v5 offset:192
    ds_read_b128 v[68:71], v5 offset:8640
    ds_read_b128 v[72:75], v5 offset:17088
    s_waitcnt lgkmcnt(9)
    ds_read_b128 v[76:79], v5 offset:256
    ds_read_b128 v[80:83], v5 offset:8704
    ds_read_b128 v[84:87], v5 offset:17152
    v_mfma_f32_16x16x32_bf16 v[8:11], v[16:19], v[24:27], 0
    v_mfma_f32_16x16x32_bf16 v[12:15], v[20:23], v[24:27], 0
    s_waitcnt lgkmcnt(9)
    ds_read_b128 v[88:91], v5 offset:320
    ds_read_b128 v[92:95], v5 offset:8768
    ds_read_b128 v[96:99], v5 offset:17216
    v_mfma_f32_16x16x32_bf16 v[8:11], v[28:31], v[36:39], v[8:11]
    v_mfma_f32_16x16x32_bf16 v[12:15], v[32:35], v[36:39], v[12:15]
    s_waitcnt lgkmcnt(9)
    ds_read_b128 v[100:103], v5 offset:384
    ds_read_b128 v[104:107], v5 offset:8832
    ds_read_b128 v[108:111], v5 offset:17280
    v_mfma_f32_16x16x32_bf16 v[8:11], v[40:43], v[48:51], v[8:11]
    v_mfma_f32_16x16x32_bf16 v[12:15], v[44:47], v[48:51], v[12:15]
    s_waitcnt lgkmcnt(9)
    ds_read_b128 v[112:115], v5 offset:448
    ds_read_b128 v[116:119], v5 offset:8896
    ds_read_b128 v[120:123], v5 offset:17344
    v_mfma_f32_16x16x32_bf16 v[8:11], v[64:67], v[72:75], v[8:11]
    v_mfma_f32_16x16x32_bf16 v[12:15], v[68:71], v[72:75], v[12:15]
    s_waitcnt lgkmcnt(9)
    v_mfma_f32_16x16x32_bf16 v[8:11], v[76:79], v[84:87], v[8:11]
    v_mfma_f32_16x16x32_bf16 v[12:15], v[80:83], v[84:87], v[12:15]
    s_waitcnt lgkmcnt(6)
    v_mfma_f32_16x16x32_bf16 v[8:11], v[88:91], v[96:99], v[8:11]
    v_mfma_f32_16x16x32_bf16 v[12:15], v[92:95], v[96:99], v[12:15]
    s_waitcnt lgkmcnt(3)
    v_mfma_f32_16x16x32_bf16 v[8:11], v[100:103], v[108:111], v[8:11]
    v_mfma_f32_16x16x32_bf16 v[12:15], v[104:107], v[108:111], v[12:15]
    s_waitcnt lgkmcnt(0)
    v_mfma_f32_16x16x32_bf16 v[8:11], v[112:115], v[120:123], v[8:11]
    v_mfma_f32_16x16x32_bf16 v[12:15], v[116:119], v[120:123], v[12:15]
    s_nop 6
    v_cvt_pk_bf16_f32 v16, v8, v9
    v_cvt_pk_bf16_f32 v17, v10, v11
    v_cvt_pk_bf16_f32 v18, v12, v13
    v_cvt_pk_bf16_f32 v19, v14, v15
    buffer_store_dwordx4 v[16:19], v6, s[16:19], s58 offen sc1
    s_branch L_flag
L_wtask:
    s_lshl_b32 s58, s62, 11
    s_add_u32 s58, s58, 851968
    s_mov_b32 s70, 0x05040100
    s_mov_b32 s71, 0x07060302
    v_perm_b32 v64, v17, v16, s70
    v_perm_b32 v68, v17, v16, s71
    v_perm_b32 v65, v19, v18, s70
    v_perm_b32 v69, v19, v18, s71
    v_perm_b32 v66, v21, v20, s70
    v_perm_b32 v70, v21, v20, s71
    v_perm_b32 v67, v23, v22, s70
    v_perm_b32 v71, v23, v22, s71
    buffer_store_dwordx4 v[64:67], v6, s[16:19], s58 offen sc1
    buffer_store_dwordx4 v[68:71], v6, s[16:19], s58 offen offset:1024 sc1
    s_cmp_eq_u32 s4, 0
    s_cbranch_scc1 L_flag
    s_waitcnt vmcnt(0)
L_taskw:
    s_mov_b64 exec, 1
    ds_add_u32 v3, v62 offset:56
    s_mov_b64 exec, -1
    s_branch L_preB
L_flag:
    s_mov_b32 s59, 0
Lw_7:
    ds_read_b32 v4, v3 offset:68
    s_waitcnt lgkmcnt(0)
    v_cmp_gt_u32 vcc, 1, v4
    s_cbranch_vccz Lk_8
    s_add_u32 s59, s59, 1
    s_cmp_lt_u32 s59, 4194304
    s_cbranch_scc1 Lw_7
    s_branch L_end
Lk_8:
    v_readfirstlane_b32 s40, v4
    s_nop 0
    s_bitset0_b32 s40, 0
    s_mul_i32 s61, s2, 16
    s_add_u32 s61, s61, 1178624
    v_mov_b32 v10, s40
    v_mov_b32 v11, s40
    v_lshlrev_b32 v9, 15, v0
    s_mov_b32 s59, 0
Lw_9:
    ds_read_b32 v4, v3 offset:56
    s_waitcnt lgkmcnt(0)
    v_cmp_gt_u32 vcc, 7, v4
    s_cbranch_vccz Lk_10
    s_add_u32 s59, s59, 1
    s_cmp_lt_u32 s59, 4194304
    s_cbranch_scc1 Lw_9
    s_branch L_end
Lk_10:
    s_waitcnt vmcnt(0)
    s_mov_b64 exec, 255
    buffer_store_dwordx2 v[10:11], v9, s[16:19], s61 offen sc1
    ds_write_b32 v3, v62 offset:32
    s_mov_b64 exec, -1
L_preB:
    s_setprio 3
    s_mov_b64 s[28:29], s[42:43]
    s_mov_b32 s30, 20000
    s_lshl_b32 s58, s4, 10
    v_lshlrev_b32 v5, 4, v0
    s_add_u32 m0, s58, 130944
    s_add_u32 s59, s58, 0
    buffer_load_dwordx4 v5, s[28:31], s59 offen lds
    s_add_u32 m0, s58, 139136
    s_add_u32 s59, s58, 8192
    buffer_load_dwordx4 v5, s[28:31], s59 offen lds
    s_cmp_lt_u32 s4, 4
    s_cbranch_scc1 L_disd
    s_add_u32 m0, s58, 143232
    s_add_u32 s59, s58, 12288
    buffer_load_dwordx4 v5, s[28:31], s59 offen lds
L_disd:
    s_mov_b64 s[24:25], s[44:45]
    s_mov_b32 s26, 131072
    s_setprio 1
    s_lshl_b32 s58, s4, 10
    s_mov_b32 s41, 0
    buffer_load_dwordx4 v[96:99], v5, s[24:27], s58 offen
    s_add_u32 s58, s58, 8192
    buffer_load_dwordx4 v[100:103], v5, s[24:27], s58 offen
    s_add_u32 s58, s58, 8192
    buffer_load_dwordx4 v[104:107], v5, s[24:27], s58 offen
    s_add_u32 s58, s58, 8192
    buffer_load_dwordx4 v[108:111], v5, s[24:27], s58 offen
    s_add_u32 s58, s58, 8192
    buffer_load_dwordx4 v[112:115], v5, s[24:27], s58 offen
    s_add_u32 s58, s58, 8192
    buffer_load_dwordx4 v[116:119], v5, s[24:27], s58 offen
    s_add_u32 s58, s58, 8192
    buffer_load_dwordx4 v[120:123], v5, s[24:27], s58 offen
    s_add_u32 s58, s58, 8192
    buffer_load_dwordx4 v[124:127], v5, s[24:27], s58 offen
    s_setprio 3
    v_and_b32 v10, 3, v0
    v_mul_u32_u24 v10, 0x1111, v10
    v_mov_b64 v[76:77], 0
    v_mov_b64 v[78:79], 0
    v_mov_b64 v[80:81], 0
    v_mov_b64 v[82:83], 0
    v_mov_b64 v[84:85], 0
    v_mov_b64 v[86:87], 0
    s_movk_i32 s7, 512
    s_lshl_b32 s58, s4, 3
    v_lshrrev_b32 v5, 3, v0
    v_and_b32 v6, 7, v0
    v_add_u32 v7, s58, v5
    v_mul_u32_u24 v49, 10240, v7
    v_lshl_add_u32 v49, v6, 4, v49
    v_lshlrev_b32 v56, 2, v6
    s_lshl_b32 s60, s6, 2
    s_add_u32 s60, s60, 1114112
    v_lshl_add_u32 v54, v7, 10, s60
    v_mad_u32_u24 v7, v7, 3, v6
    v_cmp_ge_u32 vcc, 186, v7
    v_cmp_gt_u32 s[64:65], 4, v6
    v_mul_u32_u24 v7, 16, v7
    s_and_b64 s[64:65], s[64:65], vcc
    v_cmp_eq_u32 vcc, 0, v6
    s_and_b32 s58, s2, 7
    s_lshl_b32 s58, s58, 15
    s_add_u32 s58, s58, 1179632
    v_add_u32 v7, s58, v7
    s_or_b64 s[64:65], s[64:65], vcc
    v_cndmask_b32 v54, v7, v54, vcc
    v_cmp_gt_u32 s[62:63], 5, v6
    v_lshl_add_u32 v50, v6, 3, v5
    v_mul_u32_u24 v55, 80, v5
    v_add_u32 v55, 80, v55
    v_lshrrev_b32 v5, 4, v50
    v_mul_u32_u24 v9, 8448, v5
    v_lshl_add_u32 v9, v5, 26, v9
    v_cmp_le_u32 vcc, 32, v50
    v_and_b32 v5, 7, v50
    v_and_b32 v6, 3, v50
    v_cndmask_b32 v5, v5, v6, vcc
    v_mul_u32_u24 v5, 1056, v5
    v_bfe_u32 v6, v50, 3, 1
    v_bfe_u32 v7, v50, 2, 1
    v_cndmask_b32 v6, v6, v7, vcc
    v_lshl_add_u32 v5, v6, 9, v5
    v_mov_b32 v52, 130944
    v_add3_u32 v9, v9, v5, v52
    v_and_b32 v15, 0xf0, v2
    v_and_b32 v5, 32, v0
    v_lshl_add_u32 v15, v5, 3, v15
    v_bfe_u32 v5, v0, 4, 1
    v_lshl_add_u32 v15, v5, 3, v15
    s_lshl_b32 s58, s5, 2
    s_sub_u32 s58, 159744, s58
    v_mov_b32 v53, s58
    v_add_u32 v5, s5, v50
    v_lshl_add_u32 v8, v5, 1, v52
    v_lshlrev_b32 v50, 2, v50
    v_add_u32 v50, 159744, v50
    v_and_b32 v74, 0x1e0, v15
    v_and_b32 v5, 24, v15
    v_lshrrev_b32 v5, 1, v5
    v_add_u32 v74, v74, v5
    v_mov_b32 v57, 157184
    v_mov_b32 v60, 152064
    v_mov_b64 v[16:17], 0
    v_mov_b64 v[18:19], 0
    s_mov_b32 s59, 0
Lw_11:
    ds_read_b32 v4, v3 offset:32
    s_waitcnt lgkmcnt(0)
    v_cmp_gt_u32 vcc, 1, v4
    s_cbranch_vccz Lk_12
    s_sleep 2
    s_add_u32 s59, s59, 1
    s_cmp_lt_u32 s59, 4194304
    s_cbranch_scc1 Lw_11
    s_branch L_end
Lk_12:
    s_mov_b32 s59, 0
Lw_13:
    ds_read_b32 v4, v3 offset:68
    s_waitcnt lgkmcnt(0)
    v_cmp_gt_u32 vcc, 1, v4
    s_cbranch_vccz Lk_14
    s_add_u32 s59, s59, 1
    s_cmp_lt_u32 s59, 4194304
    s_cbranch_scc1 Lw_13
    s_branch L_end
Lk_14:
    v_readfirstlane_b32 s40, v4
    s_nop 0
    s_bitset0_b32 s40, 0
    s_mov_b32 s59, 0
Lw_15:
    ds_read_b32 v4, v3 offset:60
    s_waitcnt lgkmcnt(0)
    v_cmp_gt_u32 vcc, 8, v4
    s_cbranch_vccz Lk_16
    s_sleep 2
    s_add_u32 s59, s59, 1
    s_cmp_lt_u32 s59, 4194304
    s_cbranch_scc1 Lw_15
    s_branch L_end
Lk_16:
    s_mov_b32 s59, 0
    s_and_b32 exec_lo, s64, 0xfefefefe
    s_and_b32 exec_hi, s65, 0xfefefefe
L_spolla:
    buffer_load_dwordx2 v[58:59], v54, s[16:19], 0 offen sc1
    s_add_u32 s59, s59, 1
    s_cmp_gt_u32 s59, 0x40000
    s_cbranch_scc1 L_end
    s_waitcnt vmcnt(0)
    v_xor_b32 v58, s40, v58
    v_xor_b32 v59, s40, v59
    v_or_b32 v5, v58, v59
    v_cmpx_lt_u32 vcc, 4095, v5
    s_cbranch_execz L_soka
    s_sleep 8
    s_branch L_spolla
L_soka:
    s_mov_b64 exec, -1
    s_mov_b64 exec, 1
    ds_add_u32 v3, v62 offset:52
    s_mov_b64 exec, -1
    s_mov_b32 exec_lo, 0x01010101
    s_mov_b32 exec_hi, 0x01010101
L_spollb:
    buffer_load_dwordx2 v[58:59], v54, s[16:19], 0 offen sc1
    s_add_u32 s59, s59, 1
    s_cmp_gt_u32 s59, 0x40000
    s_cbranch_scc1 L_end
    s_waitcnt vmcnt(0)
    v_xor_b32 v58, s40, v58
    v_xor_b32 v59, s40, v59
    v_or_b32 v5, v58, v59
    v_cmpx_lt_u32 vcc, 4095, v5
    s_cbranch_execz L_sokb
    s_sleep 8
    s_branch L_spollb
L_sokb:
    s_mov_b64 exec, -1
    v_sub_u32 v48, v59, v58
    v_lshl_or_b32 v48, v48, 16, v58
    s_nop 1
    v_mov_b32_dpp v48, v48 quad_perm:[0,0,0,0] row_mask:0xf bank_mask:0xf
    s_nop 1
    v_mov_b32_dpp v48, v48 row_shr:4 row_mask:0xf bank_mask:0xa
    v_mad_u32_u16 v49, v48, 4, v49
    v_lshrrev_b32 v48, 16, v48
    v_sub_u32 v48, v48, v56
    v_cmpx_lt_i32 vcc, 0, v48
    s_cbranch_execz L_entld
    buffer_load_dwordx4 v[16:19], v49, s[16:19], 0 offen sc1
    v_cmpx_lt_i32 vcc, 32, v48
    ds_write_b32 v3, v62 offset:28
L_entld:
    s_mov_b64 exec, -1
    s_waitcnt vmcnt(0)
    v_cmpx_lt_i32 vcc, 0, v48
    v_mad_u32_u16 v24, v16, 4, v53 op_sel:[1,0,0,0]
    ds_add_rtn_u32 v32, v24, v62
    v_cmpx_lt_i32 vcc, 1, v48
    v_mad_u32_u16 v25, v17, 4, v53 op_sel:[1,0,0,0]
    ds_add_rtn_u32 v33, v25, v62
    v_cmpx_lt_i32 vcc, 2, v48
    v_mad_u32_u16 v26, v18, 4, v53 op_sel:[1,0,0,0]
    ds_add_rtn_u32 v34, v26, v62
    v_cmpx_lt_i32 vcc, 3, v48
    v_mad_u32_u16 v27, v19, 4, v53 op_sel:[1,0,0,0]
    ds_add_rtn_u32 v35, v27, v62
    s_mov_b64 exec, -1
    s_mov_b64 exec, 1
    ds_add_u32 v3, v62 offset:12
    s_mov_b64 exec, -1
    v_mad_u32_u16 v40, v16, 2, v52
    v_mad_u32_u16 v16, v16, s7, 0
    v_mad_u32_u16 v41, v17, 2, v52
    v_mad_u32_u16 v17, v17, s7, 0
    v_mad_u32_u16 v42, v18, 2, v52
    v_mad_u32_u16 v18, v18, s7, 0
    v_mad_u32_u16 v43, v19, 2, v52
    v_mad_u32_u16 v19, v19, s7, 0
    s_mov_b32 s59, 0
Lw_17:
    ds_read_b32 v4, v3 offset:12
    s_waitcnt lgkmcnt(0)
    v_cmp_gt_u32 vcc, 8, v4
    s_cbranch_vccz Lk_18
    s_add_u32 s59, s59, 1
    s_cmp_lt_u32 s59, 4194304
    s_cbranch_scc1 Lw_17
    s_branch L_end
Lk_18:
    ds_read_b32 v12, v50
    ds_read_b32 v5, v3 offset:28
    ds_read_u16 v8, v8
    ds_read_u16 v40, v40
    ds_read_u16 v41, v41
    ds_read_u16 v42, v42
    ds_read_u16 v43, v43
    s_lshl_b32 s58, s2, 4
    s_add_u32 s58, s58, s3
    s_cmp_eq_u32 s58, 15
    s_cbranch_scc0 L_noep
    v_mov_b32 v6, s40
    v_mov_b32 v7, 655616
    s_mov_b64 exec, 1
    buffer_store_dword v6, v7, s[16:19], 0 offen sc1
    s_mov_b64 exec, -1
L_noep:
    s_waitcnt lgkmcnt(6)
    v_add_u32 v12, 1, v12
    v_lshrrev_b32 v12, 1, v12
    v_max_u32 v12, 1, v12
    v_cndmask_b32 v12, 0, v12, s[62:63]
    s_lshl_b32 s67, s4, 3
    s_movk_i32 s58, 2560
    v_add_u32_dpp v51, v12, v12 row_shl:1 row_mask:0xf bank_mask:0xf bound_ctrl:1
    s_nop 1
    v_add_u32_dpp v51, v51, v51 row_shl:2 row_mask:0xf bank_mask:0xf bound_ctrl:1
    s_nop 1
    v_add_u32_dpp v51, v12, v51 row_shl:4 row_mask:0xf bank_mask:0x5 bound_ctrl:1
    s_waitcnt lgkmcnt(0)
    v_lshlrev_b32 v8, 16, v8
    v_lshl_add_u32 v5, v5, 10, v51
    v_sub_u32 v6, v55, v51
    v_cmp_le_u32 vcc, 80, v5
    v_lshlrev_b32 v6, 1, v6
    v_subrev_u32 v12, 1, v12
    s_cbranch_vccnz L_slow
    v_and_b32 v12, 0xff, v12
    v_lshl_add_u32 v9, v12, 18, v9
    s_mov_b64 exec, s[62:63]
    ds_write_b32 v50, v6 offset:160
    s_mov_b64 exec, -1
    s_sub_u32 s63, s67, 1
    v_readlane_b32 s67, v51, s67
    v_cmpx_lt_i32 vcc, 0, v48
    ds_read_b32 v24, v24 offset:160
    v_cmpx_lt_i32 vcc, 1, v48
    ds_read_b32 v25, v25 offset:160
    v_cmpx_lt_i32 vcc, 2, v48
    ds_read_b32 v26, v26 offset:160
    v_cmpx_lt_i32 vcc, 3, v48
    ds_read_b32 v27, v27 offset:160
    s_mov_b64 exec, -1
    s_lshr_b32 s66, s67, 3
    s_add_u32 s60, s66, 1
    s_lshl_b32 s60, s60, 3
    s_sub_u32 s67, s60, s67
    s_sub_u32 s62, s67, 1
    s_add_u32 s61, s4, 1
    s_mul_i32 s61, s61, 80
    s_sub_u32 s60, s61, s60
    s_lshl_b32 s60, s60, 2
    s_waitcnt lgkmcnt(0)
    v_cmpx_lt_i32 vcc, 0, v48
    v_add_u32 v24, v24, v32
    v_lshl_add_u32 v5, v24, 1, v57
    ds_write_b16 v5, v40
    v_lshrrev_b32 v6, 1, v24
    v_lshl_add_u32 v6, v6, 2, v60
    v_and_b32 v7, 1, v24
    v_mad_u32_u24 v6, v7, s58, v6
    ds_write_b32 v6, v16
    v_cmpx_lt_i32 vcc, 1, v48
    v_add_u32 v25, v25, v33
    v_lshl_add_u32 v5, v25, 1, v57
    ds_write_b16 v5, v41
    v_lshrrev_b32 v6, 1, v25
    v_lshl_add_u32 v6, v6, 2, v60
    v_and_b32 v7, 1, v25
    v_mad_u32_u24 v6, v7, s58, v6
    ds_write_b32 v6, v17
    v_cmpx_lt_i32 vcc, 2, v48
    v_add_u32 v26, v26, v34
    v_lshl_add_u32 v5, v26, 1, v57
    ds_write_b16 v5, v42
    v_lshrrev_b32 v6, 1, v26
    v_lshl_add_u32 v6, v6, 2, v60
    v_and_b32 v7, 1, v26
    v_mad_u32_u24 v6, v7, s58, v6
    ds_write_b32 v6, v18
    v_cmpx_lt_i32 vcc, 3, v48
    v_add_u32 v27, v27, v35
    v_lshl_add_u32 v5, v27, 1, v57
    ds_write_b16 v5, v43
    v_lshrrev_b32 v6, 1, v27
    v_lshl_add_u32 v6, v6, 2, v60
    v_and_b32 v7, 1, v27
    v_mad_u32_u24 v6, v7, s58, v6
    ds_write_b32 v6, v19
    s_mov_b64 exec, -1
    s_mov_b64 exec, 1
    ds_add_u32 v3, v62 offset:16
    s_mov_b64 exec, -1
    v_lshrrev_b32 v5, 5, v0
    v_mad_u32_u24 v13, v5, s58, v60
    v_add_u32 v13, s60, v13
    v_lshrrev_b32 v5, 4, v0
    v_lshl_add_u32 v14, v5, 1, v57
    v_and_b32 v5, 3, v0
    v_lshlrev_b32 v5, 3, v5
    v_add3_u32 v14, v14, v5, s60
    s_mov_b32 s65, 201486784
    s_mov_b32 s64, 0
    s_mov_b32 s59, 0
Lw_19:
    ds_read_b32 v4, v3 offset:16
    s_waitcnt lgkmcnt(0)
    v_cmp_gt_u32 vcc, 8, v4
    s_cbranch_vccz Lk_20
    s_add_u32 s59, s59, 1
    s_cmp_lt_u32 s59, 4194304
    s_cbranch_scc1 Lw_19
    s_branch L_end
Lk_20:
    v_mov_b64 v[16:17], 0
    v_mov_b64 v[18:19], 0
    v_mov_b64 v[24:25], 0
    v_mov_b64 v[26:27], 0
    v_mov_b64 v[32:33], 0
    v_mov_b64 v[34:35], 0
    v_mov_b64 v[40:41], 0
    v_mov_b64 v[42:43], 0
    v_mov_b32 v12, v3
    v_mov_b32 v3, v2
    s_setprio 1
    s_cmp_lt_u32 s4, 4
    s_cbranch_scc1 L_old
    s_setprio 2
L_old:
    s_mov_b64 vcc, 0
    ds_read_b128 v[64:67], v13 offset:0
    ds_read_b128 v[68:71], v13 offset:16
    ds_read_u16 v1, v14
    ds_read_b128 v[48:51], v13 offset:32
    ds_read_b128 v[52:55], v13 offset:48
    s_waitcnt lgkmcnt(3)
L_p0:
    s_cmp_ge_u32 s67, 4
    s_cbranch_scc1 L_p4
    s_cmp_gt_u32 s67, 1
    s_cbranch_scc1 Lps_21
    v_add_u32 v65, v65, v2
    buffer_load_dwordx4 v[20:23], v65, s[8:11], 0 offen
Lps_21:
    s_cmp_gt_u32 s67, 2
    s_cbranch_scc1 Lps_22
    v_add_u32 v66, v66, v2
    buffer_load_dwordx4 v[24:27], v66, s[8:11], 0 offen
Lps_22:
    s_cmp_gt_u32 s67, 3
    s_cbranch_scc1 Lps_23
    v_add_u32 v67, v67, v2
    buffer_load_dwordx4 v[28:31], v67, s[8:11], 0 offen
Lps_23:
L_p4:
    s_cmp_gt_u32 s67, 4
    s_cbranch_scc1 Lps_24
    v_add_u32 v68, v68, v2
    buffer_load_dwordx4 v[32:35], v68, s[8:11], 0 offen
Lps_24:
    s_cmp_gt_u32 s67, 5
    s_cbranch_scc1 Lps_25
    v_add_u32 v69, v69, v2
    buffer_load_dwordx4 v[36:39], v69, s[8:11], 0 offen
Lps_25:
    s_cmp_gt_u32 s67, 6
    s_cbranch_scc1 Lps_26
    v_add_u32 v70, v70, v2
    buffer_load_dwordx4 v[40:43], v70, s[8:11], 0 offen
Lps_26:
    s_cmp_gt_u32 s67, 7
    s_cbranch_scc1 Lps_27
    v_add_u32 v71, v71, v2
    buffer_load_dwordx4 v[44:47], v71, s[8:11], 0 offen
Lps_27:
    s_cmp_eq_u32 s66, 0
    s_cbranch_scc1 L_drain
L_gl:
    s_cmp_le_u32 s66, 4
    s_cbranch_scc1 L_dm0
L_dm0b:
    s_waitcnt lgkmcnt(1)
    v_mov_b32_dpp v76, v1 row_newbcast:0 row_mask:0xf bank_mask:1
    v_mov_b32_dpp v77, v1 row_newbcast:0 row_mask:0xf bank_mask:2
    v_mov_b32_dpp v78, v1 row_newbcast:0 row_mask:0xf bank_mask:4
    v_mov_b32_dpp v79, v1 row_newbcast:0 row_mask:0xf bank_mask:8
    s_waitcnt vmcnt(6)
    v_lshl_add_u64 v[4:5], v[48:49], 0, v[2:3]
    s_sub_u32 s62, s62, 2
    s_cbranch_scc1 Lfs_0
    v_smfmac_f32_16x16x64_bf16 v[56:59], v[76:79], v[16:23], v10
    buffer_load_dwordx4 v[16:19], v4, s[8:11], 0 offen
    buffer_load_dwordx4 v[20:23], v5, s[8:11], 0 offen
Lbs_0:
    s_cbranch_vccnz Ldm_0
Ldb_0:
    v_mov_b32_dpp v76, v1 row_newbcast:1 row_mask:0xf bank_mask:1
    v_mov_b32_dpp v77, v1 row_newbcast:1 row_mask:0xf bank_mask:2
    v_mov_b32_dpp v78, v1 row_newbcast:1 row_mask:0xf bank_mask:4
    v_mov_b32_dpp v79, v1 row_newbcast:1 row_mask:0xf bank_mask:8
    s_waitcnt vmcnt(6)
    v_lshl_add_u64 v[4:5], v[50:51], 0, v[2:3]
    s_sub_u32 s62, s62, 2
    s_cbranch_scc1 Lfs_2
    v_smfmac_f32_16x16x64_bf16 v[56:59], v[76:79], v[24:31], v10
    buffer_load_dwordx4 v[24:27], v4, s[8:11], 0 offen
    buffer_load_dwordx4 v[28:31], v5, s[8:11], 0 offen
Lbs_2:
    s_cbranch_vccnz Ldm_2
Ldb_2:
    ds_read_b128 v[48:51], v13 offset:64
    v_mov_b32_dpp v76, v1 row_newbcast:2 row_mask:0xf bank_mask:1
    v_mov_b32_dpp v77, v1 row_newbcast:2 row_mask:0xf bank_mask:2
    v_mov_b32_dpp v78, v1 row_newbcast:2 row_mask:0xf bank_mask:4
    v_mov_b32_dpp v79, v1 row_newbcast:2 row_mask:0xf bank_mask:8
    s_waitcnt vmcnt(6) lgkmcnt(1)
    v_lshl_add_u64 v[4:5], v[52:53], 0, v[2:3]
    s_sub_u32 s62, s62, 2
    s_cbranch_scc1 Lfs_4
    v_smfmac_f32_16x16x64_bf16 v[56:59], v[76:79], v[32:39], v10
    buffer_load_dwordx4 v[32:35], v4, s[8:11], 0 offen
    buffer_load_dwordx4 v[36:39], v5, s[8:11], 0 offen
Lbs_4:
    s_cbranch_vccnz Ldm_4
Ldb_4:
    v_mov_b32_dpp v76, v1 row_newbcast:3 row_mask:0xf bank_mask:1
    v_mov_b32_dpp v77, v1 row_newbcast:3 row_mask:0xf bank_mask:2
    v_mov_b32_dpp v78, v1 row_newbcast:3 row_mask:0xf bank_mask:4
    v_mov_b32_dpp v79, v1 row_newbcast:3 row_mask:0xf bank_mask:8
    ds_read_u16 v1, v14 offset:32
    s_waitcnt vmcnt(6)
    v_lshl_add_u64 v[4:5], v[54:55], 0, v[2:3]
    s_sub_u32 s62, s62, 2
    s_cbranch_scc1 Lfs_6
    v_smfmac_f32_16x16x64_bf16 v[56:59], v[76:79], v[40:47], v10
    buffer_load_dwordx4 v[40:43], v4, s[8:11], 0 offen
    buffer_load_dwordx4 v[44:47], v5, s[8:11], 0 offen
Lbs_6:
    s_cbranch_vccnz Ldm_6
Ldb_6:
    ds_read_b128 v[52:55], v13 offset:80
    v_add_u32 v13, 32, v13
    v_add_u32 v14, 32, v14
    s_sub_u32 s66, s66, 1
    s_cmp_eq_u32 s66, 3
    s_cbranch_scc0 L_nf
    s_setprio 1
L_nf:
    s_cmp_lg_u32 s66, 0
    s_cbranch_scc1 L_gl
L_drain:
    s_waitcnt lgkmcnt(0)
    v_mov_b32_dpp v76, v1 row_newbcast:0 row_mask:0xf bank_mask:1
    v_mov_b32_dpp v77, v1 row_newbcast:0 row_mask:0xf bank_mask:2
    v_mov_b32_dpp v78, v1 row_newbcast:0 row_mask:0xf bank_mask:4
    v_mov_b32_dpp v79, v1 row_newbcast:0 row_mask:0xf bank_mask:8
    s_sub_u32 s62, s62, 2
    s_waitcnt vmcnt(6)
    s_cbranch_scc1 Lfd_0
    v_smfmac_f32_16x16x64_bf16 v[56:59], v[76:79], v[16:23], v10
Lbd_0:
    v_mov_b32_dpp v76, v1 row_newbcast:1 row_mask:0xf bank_mask:1
    v_mov_b32_dpp v77, v1 row_newbcast:1 row_mask:0xf bank_mask:2
    v_mov_b32_dpp v78, v1 row_newbcast:1 row_mask:0xf bank_mask:4
    v_mov_b32_dpp v79, v1 row_newbcast:1 row_mask:0xf bank_mask:8
    s_sub_u32 s62, s62, 2
    s_waitcnt vmcnt(4)
    s_cbranch_scc1 Lfd_2
    v_smfmac_f32_16x16x64_bf16 v[56:59], v[76:79], v[24:31], v10
Lbd_2:
    v_mov_b32_dpp v76, v1 row_newbcast:2 row_mask:0xf bank_mask:1
    v_mov_b32_dpp v77, v1 row_newbcast:2 row_mask:0xf bank_mask:2
    v_mov_b32_dpp v78, v1 row_newbcast:2 row_mask:0xf bank_mask:4
    v_mov_b32_dpp v79, v1 row_newbcast:2 row_mask:0xf bank_mask:8
    s_sub_u32 s62, s62, 2
    s_waitcnt vmcnt(2)
    s_cbranch_scc1 Lfd_4
    v_smfmac_f32_16x16x64_bf16 v[56:59], v[76:79], v[32:39], v10
Lbd_4:
    v_mov_b32_dpp v76, v1 row_newbcast:3 row_mask:0xf bank_mask:1
    v_mov_b32_dpp v77, v1 row_newbcast:3 row_mask:0xf bank_mask:2
    v_mov_b32_dpp v78, v1 row_newbcast:3 row_mask:0xf bank_mask:4
    v_mov_b32_dpp v79, v1 row_newbcast:3 row_mask:0xf bank_mask:8
    s_sub_u32 s62, s62, 2
    s_waitcnt vmcnt(0)
    s_cmp_eq_u32 s62, -1
    s_cbranch_scc1 Lald_6
    s_mov_b32 exec_lo, 0
    v_mov_b64 v[80:81], v[76:77]
    v_mov_b64 v[82:83], v[78:79]
    v_mov_b64 v[76:77], 0
    v_mov_b64 v[78:79], 0
    s_mov_b64 exec, -1
    v_smfmac_f32_16x16x64_bf16 v[84:87], v[80:83], v[40:47], v10
Lald_6:
    v_smfmac_f32_16x16x64_bf16 v[56:59], v[76:79], v[40:47], v10
    s_call_b64 s[68:69], L_flush
L_gdone:
    s_cmp_eq_u32 s41, 0
    s_cbranch_scc0 L_dd
    s_mov_b32 s59, 0
Lw_28:
    ds_read_b32 v4, v12 offset:24
    s_waitcnt lgkmcnt(0)
    v_cmp_gt_u32 vcc, 8, v4
    s_cbranch_vccz Lk_29
    s_sleep 2
    s_add_u32 s59, s59, 1
    s_cmp_lt_u32 s59, 4194304
    s_cbranch_scc1 Lw_28
    s_branch L_end
Lk_29:
    s_lshl_b32 s58, s4, 10
    v_lshl_add_u32 v72, v0, 4, s58
    s_and_b32 s58, s4, 4
    v_lshl_add_u32 v73, s58, 4, v72
    s_movk_i32 s58, 0x1f0
    v_bfi_b32 v72, s58, v73, v72
    ds_write_b128 v72, v[96:99] offset:0
    ds_write_b128 v72, v[100:103] offset:8192
    ds_write_b128 v72, v[104:107] offset:16384
    ds_write_b128 v72, v[108:111] offset:24576
    ds_write_b128 v72, v[112:115] offset:32768
    ds_write_b128 v72, v[116:119] offset:40960
    ds_write_b128 v72, v[120:123] offset:49152
    ds_write_b128 v72, v[124:127] offset:57344
    s_mov_b64 exec, 1
    ds_inc_u32 v12, v12 offset:64
    s_mov_b64 exec, -1
L_dd:
    s_endpgm
Lfs_0:
    s_cmp_eq_u32 s62, -1
    s_cbranch_scc1 Lals_0
    s_mov_b32 exec_lo, 0
    v_mov_b64 v[80:81], v[76:77]
    v_mov_b64 v[82:83], v[78:79]
    v_mov_b64 v[76:77], 0
    v_mov_b64 v[78:79], 0
    s_mov_b64 exec, -1
    v_smfmac_f32_16x16x64_bf16 v[84:87], v[80:83], v[16:23], v10
Lals_0:
    v_smfmac_f32_16x16x64_bf16 v[56:59], v[76:79], v[16:23], v10
    buffer_load_dwordx4 v[16:19], v4, s[8:11], 0 offen
    buffer_load_dwordx4 v[20:23], v5, s[8:11], 0 offen
    s_call_b64 s[68:69], L_flush
    s_branch Lbs_0
Lfd_0:
    s_cmp_eq_u32 s62, -1
    s_cbranch_scc1 Lald_0
    s_mov_b32 exec_lo, 0
    v_mov_b64 v[80:81], v[76:77]
    v_mov_b64 v[82:83], v[78:79]
    v_mov_b64 v[76:77], 0
    v_mov_b64 v[78:79], 0
    s_mov_b64 exec, -1
    v_smfmac_f32_16x16x64_bf16 v[84:87], v[80:83], v[16:23], v10
Lald_0:
    v_smfmac_f32_16x16x64_bf16 v[56:59], v[76:79], v[16:23], v10
    s_call_b64 s[68:69], L_flush
    s_branch Lbd_0
Lfs_2:
    s_cmp_eq_u32 s62, -1
    s_cbranch_scc1 Lals_2
    s_mov_b32 exec_lo, 0
    v_mov_b64 v[80:81], v[76:77]
    v_mov_b64 v[82:83], v[78:79]
    v_mov_b64 v[76:77], 0
    v_mov_b64 v[78:79], 0
    s_mov_b64 exec, -1
    v_smfmac_f32_16x16x64_bf16 v[84:87], v[80:83], v[24:31], v10
Lals_2:
    v_smfmac_f32_16x16x64_bf16 v[56:59], v[76:79], v[24:31], v10
    buffer_load_dwordx4 v[24:27], v4, s[8:11], 0 offen
    buffer_load_dwordx4 v[28:31], v5, s[8:11], 0 offen
    s_call_b64 s[68:69], L_flush
    s_branch Lbs_2
Lfd_2:
    s_cmp_eq_u32 s62, -1
    s_cbranch_scc1 Lald_2
    s_mov_b32 exec_lo, 0
    v_mov_b64 v[80:81], v[76:77]
    v_mov_b64 v[82:83], v[78:79]
    v_mov_b64 v[76:77], 0
    v_mov_b64 v[78:79], 0
    s_mov_b64 exec, -1
    v_smfmac_f32_16x16x64_bf16 v[84:87], v[80:83], v[24:31], v10
Lald_2:
    v_smfmac_f32_16x16x64_bf16 v[56:59], v[76:79], v[24:31], v10
    s_call_b64 s[68:69], L_flush
    s_branch Lbd_2
Lfs_4:
    s_cmp_eq_u32 s62, -1
    s_cbranch_scc1 Lals_4
    s_mov_b32 exec_lo, 0
    v_mov_b64 v[80:81], v[76:77]
    v_mov_b64 v[82:83], v[78:79]
    v_mov_b64 v[76:77], 0
    v_mov_b64 v[78:79], 0
    s_mov_b64 exec, -1
    v_smfmac_f32_16x16x64_bf16 v[84:87], v[80:83], v[32:39], v10
Lals_4:
    v_smfmac_f32_16x16x64_bf16 v[56:59], v[76:79], v[32:39], v10
    buffer_load_dwordx4 v[32:35], v4, s[8:11], 0 offen
    buffer_load_dwordx4 v[36:39], v5, s[8:11], 0 offen
    s_call_b64 s[68:69], L_flush
    s_branch Lbs_4
Lfd_4:
    s_cmp_eq_u32 s62, -1
    s_cbranch_scc1 Lald_4
    s_mov_b32 exec_lo, 0
    v_mov_b64 v[80:81], v[76:77]
    v_mov_b64 v[82:83], v[78:79]
    v_mov_b64 v[76:77], 0
    v_mov_b64 v[78:79], 0
    s_mov_b64 exec, -1
    v_smfmac_f32_16x16x64_bf16 v[84:87], v[80:83], v[32:39], v10
Lald_4:
    v_smfmac_f32_16x16x64_bf16 v[56:59], v[76:79], v[32:39], v10
    s_call_b64 s[68:69], L_flush
    s_branch Lbd_4
Lfs_6:
    s_cmp_eq_u32 s62, -1
    s_cbranch_scc1 Lals_6
    s_mov_b32 exec_lo, 0
    v_mov_b64 v[80:81], v[76:77]
    v_mov_b64 v[82:83], v[78:79]
    v_mov_b64 v[76:77], 0
    v_mov_b64 v[78:79], 0
    s_mov_b64 exec, -1
    v_smfmac_f32_16x16x64_bf16 v[84:87], v[80:83], v[40:47], v10
Lals_6:
    v_smfmac_f32_16x16x64_bf16 v[56:59], v[76:79], v[40:47], v10
    buffer_load_dwordx4 v[40:43], v4, s[8:11], 0 offen
    buffer_load_dwordx4 v[44:47], v5, s[8:11], 0 offen
    s_call_b64 s[68:69], L_flush
    s_branch Lbs_6
L_dm0:
    s_mov_b64 vcc, 0
    s_cmp_eq_u32 s41, 0
    s_cbranch_scc0 L_dm0b
    ds_read_b32 v4, v12 offset:24
    s_waitcnt lgkmcnt(0)
    v_cmp_le_u32 vcc, 8, v4
    s_cbranch_vccz L_dm0b
    s_lshl_b32 s58, s4, 10
    v_lshl_add_u32 v72, v0, 4, s58
    s_and_b32 s58, s4, 4
    v_lshl_add_u32 v73, s58, 4, v72
    s_movk_i32 s58, 0x1f0
    v_bfi_b32 v72, s58, v73, v72
    s_mov_b32 s41, 1
    s_mov_b64 vcc, -1
    s_branch L_dm0b
Ldm_0:
    ds_write_b128 v72, v[96:99] offset:0
    ds_write_b128 v72, v[100:103] offset:8192
    s_branch Ldb_0
Ldm_2:
    ds_write_b128 v72, v[104:107] offset:16384
    ds_write_b128 v72, v[108:111] offset:24576
    s_branch Ldb_2
Ldm_4:
    ds_write_b128 v72, v[112:115] offset:32768
    ds_write_b128 v72, v[116:119] offset:40960
    s_branch Ldb_4
Ldm_6:
    ds_write_b128 v72, v[120:123] offset:49152
    ds_write_b128 v72, v[124:127] offset:57344
    s_mov_b64 exec, 1
    ds_inc_u32 v12, v12 offset:64
    s_mov_b64 exec, -1
    s_branch Ldb_6
L_flush:
    s_and_b32 s101, s65, 0x3ffff
    s_add_u32 s63, s63, 1
    s_mov_b32 s100, s62
    s_lshr_b32 s62, s65, 26
    v_add_u32 v62, s101, v15
    v_lshl_add_u32 v63, s62, 2, v12
    s_nop 0
    v_pk_mul_f32 v[56:57], v[56:57], s[64:65] op_sel_hi:[1,0]
    v_pk_mul_f32 v[58:59], v[58:59], s[64:65] op_sel_hi:[1,0]
    v_cvt_pk_bf16_f32 v60, v56, v57
    v_cvt_pk_bf16_f32 v61, v58, v59
    s_cmp_eq_u32 s62, 2
    s_cbranch_scc0 L_fl1
    v_add_u32 v62, s101, v74
    ds_write2_b32 v62, v60, v61 offset0:0 offset1:4
    s_mov_b64 exec, 1
    ds_inc_u32 v63, v63 offset:36
    s_mov_b64 exec, -1
    s_setpc_b64 s[68:69]
L_fl1:
    ds_write_b64 v62, v[60:61]
    s_mov_b64 exec, 1
    ds_inc_u32 v63, v63 offset:36
    s_mov_b64 exec, -1
    v_readlane_b32 s65, v9, s63
    v_readlane_b32 s64, v8, s63
    v_mov_b64 v[56:57], v[84:85]
    v_mov_b64 v[58:59], v[86:87]
    s_bfe_u32 s62, s65, 0x80012
    s_cmp_eq_u32 s100, -2
    s_cbranch_scc0 L_fl2
    v_mov_b64 v[84:85], 0
    v_mov_b64 v[86:87], 0
    s_sub_u32 s62, s62, 1
    s_cbranch_scc1 L_flush
L_fl2:
    s_setpc_b64 s[68:69]
L_preA:
    s_setprio 2
    v_and_b32 v0, 63, v0
    s_xor_b32 s3, s3, 8
    v_mov_b32 v3, 160064
    s_mov_b64 s[8:9], s[32:33]
    s_mov_b32 s10, 5120000
    s_mov_b32 s11, 0x20000
    v_and_b32 v4, 7, v0
    v_mul_u32_u24 v1, 1056, v4
    v_and_b32 v4, 8, v0
    v_lshl_add_u32 v1, v4, 6, v1
    v_and_b32 v4, 48, v0
    v_add_u32 v1, v4, v1
    v_add_u32 v12, 84480, v1
    v_lshlrev_b32 v14, 4, v0
    s_lshl_b32 s61, s3, 6
    s_add_u32 s61, s61, 105600
    v_add_u32 v13, s61, v1
    s_lshl_b32 s100, s3, 14
    s_add_u32 s100, s100, 720896
    s_waitcnt lgkmcnt(0)
    s_cmp_eq_u32 s3, 0
    s_cbranch_scc0 L_notag
    s_add_u32 s40, s40, 0x9e377000
    s_and_b32 s40, s40, 4294963200
    s_bitset1_b32 s40, 0
    v_mov_b32 v4, s40
    ds_write_b32 v3, v4 offset:68
L_notag:
    v_lshl_add_u32 v104, s12, 9, v2
    v_lshl_add_u32 v105, s13, 9, v2
    v_lshl_add_u32 v106, s14, 9, v2
    v_lshl_add_u32 v107, s15, 9, v2
    v_lshl_add_u32 v108, s16, 9, v2
    v_lshl_add_u32 v109, s17, 9, v2
    v_lshl_add_u32 v110, s18, 9, v2
    v_lshl_add_u32 v111, s19, 9, v2
    v_lshl_add_u32 v112, s28, 9, v2
    v_lshl_add_u32 v113, s29, 9, v2
    s_mov_b32 exec_lo, 0
    v_lshl_add_u32 v104, s20, 9, v2
    v_lshl_add_u32 v105, s21, 9, v2
    v_lshl_add_u32 v106, s22, 9, v2
    v_lshl_add_u32 v107, s23, 9, v2
    v_lshl_add_u32 v108, s24, 9, v2
    v_lshl_add_u32 v109, s25, 9, v2
    v_lshl_add_u32 v110, s26, 9, v2
    v_lshl_add_u32 v111, s27, 9, v2
    v_lshl_add_u32 v112, s30, 9, v2
    v_lshl_add_u32 v113, s31, 9, v2
    s_mov_b64 exec, -1
    s_mov_b64 s[16:17], s[56:57]
    s_mov_b32 s18, 1441792
    s_mov_b32 s19, 0x20000
    s_mov_b64 s[20:21], s[52:53]
    s_mov_b32 s22, 5120000
    s_mov_b32 s23, 0x20000
    s_cmp_ge_u32 s2, 64
    s_cbranch_scc1 L_nopb
    s_barrier
    s_barrier
L_nopb:
    s_mul_i32 s67, s3, 2112
    s_mul_i32 s66, s3, 8448
    s_add_u32 m0, s66, 0
    s_waitcnt vmcnt(1)
    buffer_load_dwordx4 v104, s[8:11], 0 offen lds
    s_add_u32 m0, s66, 1056
    s_waitcnt vmcnt(1)
    buffer_load_dwordx4 v105, s[8:11], 0 offen lds
    v_and_b32 v4, 3, v0
    v_mov_b32 v5, 0x0c0c0c0c
    v_mov_b32 v6, 0x0c0c0302
    v_mov_b32 v7, 0x03020c0c
    v_cmp_eq_u32 s[58:59], 0, v4
    v_cmp_eq_u32 s[60:61], 2, v4
    v_cmp_eq_u32 vcc, 1, v4
    v_cndmask_b32 v8, v5, v6, s[58:59]
    v_cndmask_b32 v9, v5, v6, s[60:61]
    v_cndmask_b32 v8, v8, v7, vcc
    v_cmp_eq_u32 vcc, 3, v4
    s_nop 1
    v_cndmask_b32 v9, v9, v7, vcc
    v_mov_b32 v10, v8
    v_mov_b32 v11, v9
    v_and_b32 v8, 0xfdfdfdfd, v8
    v_and_b32 v9, 0xfdfdfdfd, v9
    s_add_u32 m0, s66, 2112
    s_waitcnt vmcnt(1)
    buffer_load_dwordx4 v106, s[8:11], 0 offen lds
    s_mov_b64 exec, 1
    v_mov_b32 v4, 1
    ds_add_u32 v3, v4 offset:0
    s_mov_b64 exec, -1
    s_add_u32 m0, s66, 3168
    s_waitcnt vmcnt(1)
    buffer_load_dwordx4 v107, s[8:11], 0 offen lds
    s_add_u32 m0, s66, 4224
    s_waitcnt vmcnt(1)
    buffer_load_dwordx4 v108, s[8:11], 0 offen lds
    s_mov_b32 s59, 0
Lw_30:
    ds_read_b32 v4, v3 offset:0
    s_waitcnt lgkmcnt(0)
    v_cmp_gt_u32 vcc, 8, v4
    s_cbranch_vccz Lk_31
    s_add_u32 s59, s59, 1
    s_cmp_lt_u32 s59, 4194304
    s_cbranch_scc1 Lw_30
    s_branch L_end
Lk_31:
    ds_read_b128 v[80:83], v12 offset:0
    ds_read_b128 v[84:87], v12 offset:8448
    ds_read_b128 v[88:91], v12 offset:16896
    s_add_u32 m0, s66, 5280
    s_waitcnt vmcnt(1)
    buffer_load_dwordx4 v109, s[8:11], 0 offen lds
    s_mov_b64 exec, 1
    v_mov_b32 v4, 1
    ds_add_u32 v3, v4 offset:60
    s_mov_b64 exec, -1
    s_waitcnt vmcnt(1)
    ds_read_b32 v4, v3 offset:52
    s_add_u32 m0, s66, 6336
    s_waitcnt vmcnt(1)
    buffer_load_dwordx4 v110, s[8:11], 0 offen lds
    s_mov_b32 s62, 7
    s_waitcnt lgkmcnt(0)
    v_cmp_gt_u32 vcc, 8, v4
    s_cbranch_vccz L_eu10
    s_waitcnt vmcnt(1)
    ds_read_b32 v4, v3 offset:52
    s_add_u32 m0, s66, 7392
    s_waitcnt vmcnt(1)
    buffer_load_dwordx4 v111, s[8:11], 0 offen lds
    s_mov_b32 s62, 8
    s_waitcnt lgkmcnt(0)
    v_cmp_gt_u32 vcc, 8, v4
    s_cbranch_vccz L_eu10
    s_waitcnt vmcnt(1)
    ds_read_b32 v4, v3 offset:52
    s_add_u32 m0, s67, 67584
    s_waitcnt vmcnt(1)
    buffer_load_dwordx4 v112, s[8:11], 0 offen lds
    s_mov_b32 s62, 9
    s_waitcnt lgkmcnt(0)
    v_cmp_gt_u32 vcc, 8, v4
    s_cbranch_vccz L_eu10
    s_waitcnt vmcnt(1)
    ds_read_b32 v4, v3 offset:52
    s_add_u32 m0, s67, 68640
    s_waitcnt vmcnt(1)
    buffer_load_dwordx4 v113, s[8:11], 0 offen lds
    s_mov_b32 s62, 10
    s_mov_b32 s59, 0
Lw_32:
    ds_read_b32 v4, v3 offset:52
    s_waitcnt lgkmcnt(0)
    v_cmp_gt_u32 vcc, 8, v4
    s_cbranch_vccz Lk_33
    s_sleep 1
    s_add_u32 s59, s59, 1
    s_cmp_lt_u32 s59, 4194304
    s_cbranch_scc1 Lw_32
    s_branch L_end
Lk_33:
L_eu10:
    s_setprio 3
    buffer_load_dwordx4 v[16:19], v14, s[16:19], s100 offen offset:0 sc1
    buffer_load_dwordx4 v[24:27], v14, s[16:19], s100 offen offset:1024 sc1
    buffer_load_dwordx4 v[20:23], v14, s[16:19], s100 offen offset:2048 sc1
    buffer_load_dwordx4 v[28:31], v14, s[16:19], s100 offen offset:3072 sc1
    s_add_u32 s100, s100, 4096
    buffer_load_dwordx4 v[32:35], v14, s[16:19], s100 offen offset:0 sc1
    s_cmp_gt_u32 s62, 7
    s_cbranch_scc1 Lem_34
    s_add_u32 m0, s66, 7392
    s_waitcnt vmcnt(63)
    buffer_load_dwordx4 v111, s[8:11], 0 offen lds
Lem_34:
    buffer_load_dwordx4 v[40:43], v14, s[16:19], s100 offen offset:1024 sc1
    buffer_load_dwordx4 v[36:39], v14, s[16:19], s100 offen offset:2048 sc1
    buffer_load_dwordx4 v[44:47], v14, s[16:19], s100 offen offset:3072 sc1
    s_add_u32 s100, s100, 4096
    buffer_load_dwordx4 v[48:51], v14, s[16:19], s100 offen offset:0 sc1
    buffer_load_dwordx4 v[56:59], v14, s[16:19], s100 offen offset:1024 sc1
    s_cmp_gt_u32 s62, 8
    s_cbranch_scc1 Lem_35
    s_add_u32 m0, s67, 67584
    s_waitcnt vmcnt(63)
    buffer_load_dwordx4 v112, s[8:11], 0 offen lds
Lem_35:
    buffer_load_dwordx4 v[52:55], v14, s[16:19], s100 offen offset:2048 sc1
    buffer_load_dwordx4 v[60:63], v14, s[16:19], s100 offen offset:3072 sc1
    s_add_u32 s100, s100, 4096
    buffer_load_dwordx4 v[64:67], v14, s[16:19], s100 offen offset:0 sc1
    buffer_load_dwordx4 v[72:75], v14, s[16:19], s100 offen offset:1024 sc1
    buffer_load_dwordx4 v[68:71], v14, s[16:19], s100 offen offset:2048 sc1
    buffer_load_dwordx4 v[76:79], v14, s[16:19], s100 offen offset:3072 sc1
    s_cmp_gt_u32 s62, 9
    s_cbranch_scc1 Lem_36
    s_add_u32 m0, s67, 68640
    s_waitcnt vmcnt(63)
    buffer_load_dwordx4 v113, s[8:11], 0 offen lds
Lem_36:
    s_setprio 0
    ds_read_b128 v[92:95], v12 offset:64
    ds_read_b128 v[96:99], v12 offset:8512
    ds_read_b128 v[100:103], v12 offset:16960
    s_waitcnt vmcnt(14) lgkmcnt(3)
    v_mfma_f32_16x16x32_bf16 v[104:107], v[16:19], v[80:83], 0
    v_mfma_f32_16x16x32_bf16 v[108:111], v[24:27], v[80:83], 0
    v_mfma_f32_16x16x32_bf16 v[112:115], v[16:19], v[84:87], 0
    v_mfma_f32_16x16x32_bf16 v[116:119], v[24:27], v[84:87], 0
    v_mfma_f32_16x16x32_bf16 v[120:123], v[16:19], v[88:91], 0
    v_mfma_f32_16x16x32_bf16 v[124:127], v[24:27], v[88:91], 0
    ds_read_b128 v[80:83], v12 offset:128
    ds_read_b128 v[84:87], v12 offset:8576
    ds_read_b128 v[88:91], v12 offset:17024
    s_waitcnt vmcnt(12) lgkmcnt(3)
    v_mfma_f32_16x16x32_bf16 v[104:107], v[20:23], v[92:95], v[104:107]
    v_mfma_f32_16x16x32_bf16 v[108:111], v[28:31], v[92:95], v[108:111]
    v_mfma_f32_16x16x32_bf16 v[112:115], v[20:23], v[96:99], v[112:115]
    v_mfma_f32_16x16x32_bf16 v[116:119], v[28:31], v[96:99], v[116:119]
    v_mfma_f32_16x16x32_bf16 v[120:123], v[20:23], v[100:103], v[120:123]
    v_mfma_f32_16x16x32_bf16 v[124:127], v[28:31], v[100:103], v[124:127]
    ds_read_b128 v[92:95], v12 offset:192
    ds_read_b128 v[96:99], v12 offset:8640
    ds_read_b128 v[100:103], v12 offset:17088
    s_waitcnt vmcnt(10) lgkmcnt(3)
    v_mfma_f32_16x16x32_bf16 v[104:107], v[32:35], v[80:83], v[104:107]
    v_mfma_f32_16x16x32_bf16 v[108:111], v[40:43], v[80:83], v[108:111]
    v_mfma_f32_16x16x32_bf16 v[112:115], v[32:35], v[84:87], v[112:115]
    v_mfma_f32_16x16x32_bf16 v[116:119], v[40:43], v[84:87], v[116:119]
    v_mfma_f32_16x16x32_bf16 v[120:123], v[32:35], v[88:91], v[120:123]
    v_mfma_f32_16x16x32_bf16 v[124:127], v[40:43], v[88:91], v[124:127]
    ds_read_b128 v[80:83], v12 offset:256
    ds_read_b128 v[84:87], v12 offset:8704
    ds_read_b128 v[88:91], v12 offset:17152
    s_waitcnt vmcnt(8) lgkmcnt(3)
    v_mfma_f32_16x16x32_bf16 v[104:107], v[36:39], v[92:95], v[104:107]
    v_mfma_f32_16x16x32_bf16 v[108:111], v[44:47], v[92:95], v[108:111]
    v_mfma_f32_16x16x32_bf16 v[112:115], v[36:39], v[96:99], v[112:115]
    v_mfma_f32_16x16x32_bf16 v[116:119], v[44:47], v[96:99], v[116:119]
    v_mfma_f32_16x16x32_bf16 v[120:123], v[36:39], v[100:103], v[120:123]
    v_mfma_f32_16x16x32_bf16 v[124:127], v[44:47], v[100:103], v[124:127]
    ds_read_b128 v[92:95], v12 offset:320
    ds_read_b128 v[96:99], v12 offset:8768
    ds_read_b128 v[100:103], v12 offset:17216
    s_waitcnt vmcnt(6) lgkmcnt(3)
    v_mfma_f32_16x16x32_bf16 v[104:107], v[48:51], v[80:83], v[104:107]
    v_mfma_f32_16x16x32_bf16 v[108:111], v[56:59], v[80:83], v[108:111]
    v_mfma_f32_16x16x32_bf16 v[112:115], v[48:51], v[84:87], v[112:115]
    v_mfma_f32_16x16x32_bf16 v[116:119], v[56:59], v[84:87], v[116:119]
    v_mfma_f32_16x16x32_bf16 v[120:123], v[48:51], v[88:91], v[120:123]
    v_mfma_f32_16x16x32_bf16 v[124:127], v[56:59], v[88:91], v[124:127]
    ds_read_b128 v[80:83], v12 offset:384
    ds_read_b128 v[84:87], v12 offset:8832
    ds_read_b128 v[88:91], v12 offset:17280
    s_waitcnt vmcnt(4) lgkmcnt(3)
    v_mfma_f32_16x16x32_bf16 v[104:107], v[52:55], v[92:95], v[104:107]
    v_mfma_f32_16x16x32_bf16 v[108:111], v[60:63], v[92:95], v[108:111]
    v_mfma_f32_16x16x32_bf16 v[112:115], v[52:55], v[96:99], v[112:115]
    v_mfma_f32_16x16x32_bf16 v[116:119], v[60:63], v[96:99], v[116:119]
    v_mfma_f32_16x16x32_bf16 v[120:123], v[52:55], v[100:103], v[120:123]
    v_mfma_f32_16x16x32_bf16 v[124:127], v[60:63], v[100:103], v[124:127]
    ds_read_b128 v[92:95], v12 offset:448
    ds_read_b128 v[96:99], v12 offset:8896
    ds_read_b128 v[100:103], v12 offset:17344
    s_waitcnt vmcnt(2) lgkmcnt(3)
    v_mfma_f32_16x16x32_bf16 v[104:107], v[64:67], v[80:83], v[104:107]
    v_mfma_f32_16x16x32_bf16 v[108:111], v[72:75], v[80:83], v[108:111]
    v_mfma_f32_16x16x32_bf16 v[112:115], v[64:67], v[84:87], v[112:115]
    v_mfma_f32_16x16x32_bf16 v[116:119], v[72:75], v[84:87], v[116:119]
    v_mfma_f32_16x16x32_bf16 v[120:123], v[64:67], v[88:91], v[120:123]
    v_mfma_f32_16x16x32_bf16 v[124:127], v[72:75], v[88:91], v[124:127]
    s_waitcnt vmcnt(0) lgkmcnt(0)
    v_mfma_f32_16x16x32_bf16 v[104:107], v[68:71], v[92:95], v[104:107]
    v_mfma_f32_16x16x32_bf16 v[108:111], v[76:79], v[92:95], v[108:111]
    v_mfma_f32_16x16x32_bf16 v[112:115], v[68:71], v[96:99], v[112:115]
    v_mfma_f32_16x16x32_bf16 v[116:119], v[76:79], v[96:99], v[116:119]
    v_mfma_f32_16x16x32_bf16 v[120:123], v[68:71], v[100:103], v[120:123]
    v_mfma_f32_16x16x32_bf16 v[124:127], v[76:79], v[100:103], v[124:127]
    s_nop 3
    v_cvt_pk_bf16_f32 v80, v104, v105
    v_cvt_pk_bf16_f32 v81, v106, v107
    v_cvt_pk_bf16_f32 v82, v108, v109
    v_cvt_pk_bf16_f32 v83, v110, v111
    ds_write_b128 v13, v[80:83] offset:0
    v_cvt_pk_bf16_f32 v84, v112, v113
    v_cvt_pk_bf16_f32 v85, v114, v115
    v_cvt_pk_bf16_f32 v86, v116, v117
    v_cvt_pk_bf16_f32 v87, v118, v119
    ds_write_b128 v13, v[84:87] offset:8448
    v_cvt_pk_bf16_f32 v88, v120, v121
    v_cvt_pk_bf16_f32 v89, v122, v123
    v_cvt_pk_bf16_f32 v90, v124, v125
    v_cvt_pk_bf16_f32 v91, v126, v127
    ds_write_b128 v13, v[88:91] offset:16896
    s_mov_b64 exec, 1
    v_mov_b32 v4, 1
    ds_add_u32 v3, v4 offset:20
    s_mov_b64 exec, -1
    s_setprio 3
    s_add_u32 s100, s100, 118784
    buffer_load_dwordx4 v[16:19], v14, s[16:19], s100 offen offset:0 sc1
    buffer_load_dwordx4 v[24:27], v14, s[16:19], s100 offen offset:1024 sc1
    buffer_load_dwordx4 v[20:23], v14, s[16:19], s100 offen offset:2048 sc1
    buffer_load_dwordx4 v[28:31], v14, s[16:19], s100 offen offset:3072 sc1
    s_add_u32 s100, s100, 4096
    buffer_load_dwordx4 v[32:35], v14, s[16:19], s100 offen offset:0 sc1
    buffer_load_dwordx4 v[40:43], v14, s[16:19], s100 offen offset:1024 sc1
    buffer_load_dwordx4 v[36:39], v14, s[16:19], s100 offen offset:2048 sc1
    buffer_load_dwordx4 v[44:47], v14, s[16:19], s100 offen offset:3072 sc1
    s_add_u32 s100, s100, 4096
    buffer_load_dwordx4 v[48:51], v14, s[16:19], s100 offen offset:0 sc1
    buffer_load_dwordx4 v[56:59], v14, s[16:19], s100 offen offset:1024 sc1
    buffer_load_dwordx4 v[52:55], v14, s[16:19], s100 offen offset:2048 sc1
    buffer_load_dwordx4 v[60:63], v14, s[16:19], s100 offen offset:3072 sc1
    s_add_u32 s100, s100, 4096
    buffer_load_dwordx4 v[64:67], v14, s[16:19], s100 offen offset:0 sc1
    buffer_load_dwordx4 v[72:75], v14, s[16:19], s100 offen offset:1024 sc1
    buffer_load_dwordx4 v[68:71], v14, s[16:19], s100 offen offset:2048 sc1
    buffer_load_dwordx4 v[76:79], v14, s[16:19], s100 offen offset:3072 sc1
    s_setprio 0
    s_mov_b32 s63, s3
L_grp:
    s_mul_i32 s58, s63, 8448
    s_lshr_b32 s59, s63, 2
    s_mul_i32 s59, s59, 8448
    s_and_b32 s60, s63, 1
    s_bfe_u32 s61, s63, 0x10001
    s_cmp_ge_u32 s63, 8
    s_cselect_b32 s61, s60, s61
    s_cselect_b32 s60, 0, s60
    s_mul_i32 s60, s60, 4224
    s_lshl_b32 s61, s61, 9
    s_add_u32 s59, s59, s60
    s_add_u32 s59, s59, s61
    s_add_u32 s59, s59, 105600
    v_add_u32 v12, s58, v1
    v_bfe_u32 v4, v0, 2, 2
    v_mul_u32_u24 v4, 1056, v4
    v_and_b32 v5, 48, v0
    v_add3_u32 v13, v4, v5, s59
    v_lshl_add_u32 v14, v0, 3, s58
    v_lshl_add_u32 v2, v0, 3, s59
    s_cmp_ge_u32 s63, 8
    s_cbranch_scc1 L_grp2
    s_mov_b32 s59, 0
Lw_37:
    ds_read_b32 v4, v3 offset:20
    s_waitcnt lgkmcnt(0)
    v_cmp_gt_u32 vcc, 8, v4
    s_cbranch_vccz Lk_38
    s_sleep 1
    s_add_u32 s59, s59, 1
    s_cmp_lt_u32 s59, 4194304
    s_cbranch_scc1 Lw_37
    s_branch L_end
Lk_38:
L_grp2:
    s_waitcnt lgkmcnt(0)
    ds_read_b128 v[80:83], v12 offset:0
    ds_read_b128 v[84:87], v13 offset:0
    ds_read_b128 v[88:91], v12 offset:64
    ds_read_b128 v[92:95], v13 offset:64
    ds_read_b128 v[96:99], v12 offset:128
    ds_read_b128 v[100:103], v13 offset:128
    ds_read_b128 v[104:107], v12 offset:192
    ds_read_b128 v[108:111], v13 offset:192
    ds_read_b128 v[112:115], v12 offset:256
    ds_read_b128 v[116:119], v13 offset:256
    ds_read_b128 v[120:123], v12 offset:320
    ds_read_b128 v[124:127], v13 offset:320
    s_waitcnt lgkmcnt(10)
    v_mfma_f32_16x16x32_bf16 v[4:7], v[80:83], v[84:87], 0
    ds_read_b128 v[80:83], v12 offset:384
    ds_read_b128 v[84:87], v13 offset:384
    s_waitcnt lgkmcnt(10)
    v_mfma_f32_16x16x32_bf16 v[4:7], v[88:91], v[92:95], v[4:7]
    ds_read_b128 v[88:91], v12 offset:448
    ds_read_b128 v[92:95], v13 offset:448
    s_waitcnt lgkmcnt(10)
    v_mfma_f32_16x16x32_bf16 v[4:7], v[96:99], v[100:103], v[4:7]
    s_waitcnt lgkmcnt(8)
    v_mfma_f32_16x16x32_bf16 v[4:7], v[104:107], v[108:111], v[4:7]
    s_waitcnt lgkmcnt(6)
    v_mfma_f32_16x16x32_bf16 v[4:7], v[112:115], v[116:119], v[4:7]
    s_waitcnt lgkmcnt(4)
    v_mfma_f32_16x16x32_bf16 v[4:7], v[120:123], v[124:127], v[4:7]
    s_waitcnt lgkmcnt(2)
    v_mfma_f32_16x16x32_bf16 v[4:7], v[80:83], v[84:87], v[4:7]
    s_waitcnt lgkmcnt(0)
    v_mfma_f32_16x16x32_bf16 v[4:7], v[88:91], v[92:95], v[4:7]
    ds_read_b64 v[96:97], v14 offset:2112
    ds_read_b64 v[98:99], v14 offset:6336
    ds_read_b64 v[100:101], v14 offset:2624
    ds_read_b64 v[102:103], v14 offset:6848
    ds_read_b64 v[104:105], v14 offset:3168
    ds_read_b64 v[106:107], v14 offset:7392
    ds_read_b64 v[108:109], v14 offset:3680
    ds_read_b64 v[110:111], v14 offset:7904
    ds_read_b64 v[80:81], v14 offset:0
    ds_read_b64 v[82:83], v14 offset:4224
    ds_read_b64 v[84:85], v14 offset:512
    ds_read_b64 v[86:87], v14 offset:4736
    ds_read_b64 v[88:89], v14 offset:1056
    ds_read_b64 v[90:91], v14 offset:5280
    ds_read_b64 v[92:93], v14 offset:1568
    s_waitcnt lgkmcnt(14)
    ds_read_b64 v[94:95], v14 offset:5792
    v_mul_f32 v4, 0x3db8aa3b, v4
    v_mul_f32 v5, 0x3db8aa3b, v5
    v_mul_f32 v6, 0x3db8aa3b, v6
    v_mul_f32 v7, 0x3db8aa3b, v7
    v_exp_f32 v4, v4
    v_exp_f32 v5, v5
    v_exp_f32 v6, v6
    v_exp_f32 v7, v7
    v_add_f32 v12, v4, v5
    v_add_f32 v13, v6, v7
    v_add_f32 v12, v12, v13
    v_add_f32 v12, 0x3089705f, v12
    v_rcp_f32 v12, v12
    s_add_u32 s63, s63, 8
    v_mul_f32 v4, v4, v12
    v_mul_f32 v5, v5, v12
    v_mul_f32 v6, v6, v12
    v_mul_f32 v7, v7, v12
    v_cvt_pk_bf16_f32 v4, v4, v5
    v_cvt_pk_bf16_f32 v6, v6, v7
    v_perm_b32 v112, v4, v4, v8
    v_perm_b32 v113, v4, v4, v9
    v_perm_b32 v114, v4, v4, v10
    v_perm_b32 v115, v4, v4, v11
    v_perm_b32 v116, v6, v6, v8
    v_perm_b32 v117, v6, v6, v9
    v_perm_b32 v118, v6, v6, v10
    v_perm_b32 v119, v6, v6, v11
    s_waitcnt lgkmcnt(0)
    v_mfma_f32_4x4x4_16b_bf16 v[120:123], v[112:113], v[80:81], 0 cbsz:4 abid:0
    v_mfma_f32_4x4x4_16b_bf16 v[124:127], v[112:113], v[82:83], 0 cbsz:4 abid:5
    v_mfma_f32_4x4x4_16b_bf16 v[4:7], v[112:113], v[84:85], 0 cbsz:4 abid:10
    v_mfma_f32_4x4x4_16b_bf16 v[12:15], v[112:113], v[86:87], 0 cbsz:4 abid:15
    v_mfma_f32_4x4x4_16b_bf16 v[120:123], v[114:115], v[88:89], v[120:123] cbsz:4 abid:0
    v_mfma_f32_4x4x4_16b_bf16 v[124:127], v[114:115], v[90:91], v[124:127] cbsz:4 abid:5
    v_mfma_f32_4x4x4_16b_bf16 v[4:7], v[114:115], v[92:93], v[4:7] cbsz:4 abid:10
    v_mfma_f32_4x4x4_16b_bf16 v[12:15], v[114:115], v[94:95], v[12:15] cbsz:4 abid:15
    v_mfma_f32_4x4x4_16b_bf16 v[120:123], v[116:117], v[96:97], v[120:123] cbsz:4 abid:0
    v_mfma_f32_4x4x4_16b_bf16 v[124:127], v[116:117], v[98:99], v[124:127] cbsz:4 abid:5
    v_mfma_f32_4x4x4_16b_bf16 v[4:7], v[116:117], v[100:101], v[4:7] cbsz:4 abid:10
    v_mfma_f32_4x4x4_16b_bf16 v[12:15], v[116:117], v[102:103], v[12:15] cbsz:4 abid:15
    v_mfma_f32_4x4x4_16b_bf16 v[120:123], v[118:119], v[104:105], v[120:123] cbsz:4 abid:0
    v_mfma_f32_4x4x4_16b_bf16 v[124:127], v[118:119], v[106:107], v[124:127] cbsz:4 abid:5
    v_mfma_f32_4x4x4_16b_bf16 v[4:7], v[118:119], v[108:109], v[4:7] cbsz:4 abid:10
    v_mfma_f32_4x4x4_16b_bf16 v[12:15], v[118:119], v[110:111], v[12:15] cbsz:4 abid:15
    s_nop 1
    s_cmp_lt_u32 s63, 16
    s_cbranch_scc1 L_grp3
    v_cvt_pk_bf16_f32 v112, v120, v121
    v_cvt_pk_bf16_f32 v113, v122, v123
    v_cvt_pk_bf16_f32 v114, v124, v125
    v_cvt_pk_bf16_f32 v115, v126, v127
    v_cvt_pk_bf16_f32 v116, v4, v5
    v_cvt_pk_bf16_f32 v117, v6, v7
    v_cvt_pk_bf16_f32 v118, v12, v13
    v_cvt_pk_bf16_f32 v119, v14, v15
    v_and_b32 v4, 3, v0
    v_lshlrev_b32 v4, 2, v4
    v_sub_u32 v2, v2, v4
    ds_write_b32 v2, v112 offset:0
    ds_write_b32 v2, v113 offset:16
    ds_write_b32 v2, v114 offset:1056
    ds_write_b32 v2, v115 offset:1072
    ds_write_b32 v2, v116 offset:2112
    ds_write_b32 v2, v117 offset:2128
    ds_write_b32 v2, v118 offset:3168
    ds_write_b32 v2, v119 offset:3184
    s_branch L_grpx
L_grp3:
    v_cvt_pk_bf16_f32 v112, v120, v121
    v_cvt_pk_bf16_f32 v113, v122, v123
    ds_write_b64 v2, v[112:113] offset:0
    v_cvt_pk_bf16_f32 v114, v124, v125
    v_cvt_pk_bf16_f32 v115, v126, v127
    ds_write_b64 v2, v[114:115] offset:1056
    v_cvt_pk_bf16_f32 v116, v4, v5
    v_cvt_pk_bf16_f32 v117, v6, v7
    ds_write_b64 v2, v[116:117] offset:2112
    v_cvt_pk_bf16_f32 v118, v12, v13
    v_cvt_pk_bf16_f32 v119, v14, v15
    ds_write_b64 v2, v[118:119] offset:3168
    s_cmp_lt_u32 s63, 10
    s_cbranch_scc1 L_grp
L_grpx:
    s_mov_b64 exec, 1
    v_mov_b32 v4, 1
    ds_add_u32 v3, v4 offset:24
    s_mov_b64 exec, -1
    v_add_u32 v12, 105600, v1
    v_lshlrev_b32 v14, 4, v0
    v_and_b32 v6, 15, v0
    v_lshlrev_b32 v6, 2, v6
    v_and_b32 v5, 48, v0
    v_lshl_add_u32 v8, v5, 7, v6
    v_lshl_add_u32 v9, v5, 6, v6
    s_lshl_b32 s60, s5, 9
    s_lshl_b32 s61, s3, 6
    s_add_u32 s60, s60, s61
    v_and_b32 v4, 3, v0
    v_mul_u32_u24 v15, 1056, v4
    v_and_b32 v4, 8, v0
    v_lshl_add_u32 v15, v4, 6, v15
    v_and_b32 v4, 48, v0
    v_lshl_add_u32 v15, v4, 1, v15
    v_and_b32 v4, 4, v0
    v_lshl_add_u32 v15, v4, 2, v15
    v_add_u32 v15, 122496, v15
    v_mul_u32_u24 v13, 21845, v4
    v_lshrrev_b32 v13, 1, v13
    v_add_u32 v13, 0x4444, v13
    v_mov_b64 v[120:121], 0
    v_mov_b64 v[122:123], 0
    v_mov_b64 v[124:125], 0
    v_mov_b64 v[126:127], 0
    s_mov_b32 s59, 0
Lw_39:
    ds_read_b32 v4, v3 offset:24
    s_waitcnt lgkmcnt(0)
    v_cmp_gt_u32 vcc, 8, v4
    s_cbranch_vccz Lk_40
    s_sleep 1
    s_add_u32 s59, s59, 1
    s_cmp_lt_u32 s59, 4194304
    s_cbranch_scc1 Lw_39
    s_branch L_end
Lk_40:
    ds_read_b128 v[80:83], v12 offset:0
    ds_read_b128 v[84:87], v12 offset:8448
    ds_read_b128 v[92:95], v12 offset:64
    ds_read_b128 v[96:99], v12 offset:8512
    ds_read_b128 v[100:103], v15 offset:0
    s_waitcnt vmcnt(14) lgkmcnt(3)
    v_mfma_f32_16x16x32_bf16 v[104:107], v[80:83], v[16:19], 0
    v_mfma_f32_16x16x32_bf16 v[108:111], v[80:83], v[24:27], 0
    v_mfma_f32_16x16x32_bf16 v[112:115], v[84:87], v[16:19], 0
    v_mfma_f32_16x16x32_bf16 v[116:119], v[84:87], v[24:27], 0
    ds_read_b128 v[80:83], v12 offset:128
    ds_read_b128 v[84:87], v12 offset:8576
    s_waitcnt vmcnt(12) lgkmcnt(2)
    v_mfma_f32_16x16x32_bf16 v[104:107], v[92:95], v[20:23], v[104:107]
    v_mfma_f32_16x16x32_bf16 v[108:111], v[92:95], v[28:31], v[108:111]
    v_mfma_f32_16x16x32_bf16 v[112:115], v[96:99], v[20:23], v[112:115]
    v_mfma_f32_16x16x32_bf16 v[116:119], v[96:99], v[28:31], v[116:119]
    v_smfmac_f32_16x16x64_bf16 v[120:123], v[100:103], v[16:23], v13
    v_smfmac_f32_16x16x64_bf16 v[124:127], v[100:103], v[24:31], v13
    ds_read_b128 v[92:95], v12 offset:192
    ds_read_b128 v[96:99], v12 offset:8640
    ds_read_b128 v[100:103], v15 offset:128
    s_waitcnt vmcnt(10) lgkmcnt(3)
    v_mfma_f32_16x16x32_bf16 v[104:107], v[80:83], v[32:35], v[104:107]
    v_mfma_f32_16x16x32_bf16 v[108:111], v[80:83], v[40:43], v[108:111]
    v_mfma_f32_16x16x32_bf16 v[112:115], v[84:87], v[32:35], v[112:115]
    v_mfma_f32_16x16x32_bf16 v[116:119], v[84:87], v[40:43], v[116:119]
    ds_read_b128 v[80:83], v12 offset:256
    ds_read_b128 v[84:87], v12 offset:8704
    s_waitcnt vmcnt(8) lgkmcnt(2)
    v_mfma_f32_16x16x32_bf16 v[104:107], v[92:95], v[36:39], v[104:107]
    v_mfma_f32_16x16x32_bf16 v[108:111], v[92:95], v[44:47], v[108:111]
    v_mfma_f32_16x16x32_bf16 v[112:115], v[96:99], v[36:39], v[112:115]
    v_mfma_f32_16x16x32_bf16 v[116:119], v[96:99], v[44:47], v[116:119]
    v_smfmac_f32_16x16x64_bf16 v[120:123], v[100:103], v[32:39], v13
    v_smfmac_f32_16x16x64_bf16 v[124:127], v[100:103], v[40:47], v13
    ds_read_b128 v[92:95], v12 offset:320
    ds_read_b128 v[96:99], v12 offset:8768
    ds_read_b128 v[100:103], v15 offset:256
    s_waitcnt vmcnt(6) lgkmcnt(3)
    v_mfma_f32_16x16x32_bf16 v[104:107], v[80:83], v[48:51], v[104:107]
    v_mfma_f32_16x16x32_bf16 v[108:111], v[80:83], v[56:59], v[108:111]
    v_mfma_f32_16x16x32_bf16 v[112:115], v[84:87], v[48:51], v[112:115]
    v_mfma_f32_16x16x32_bf16 v[116:119], v[84:87], v[56:59], v[116:119]
    ds_read_b128 v[80:83], v12 offset:384
    ds_read_b128 v[84:87], v12 offset:8832
    s_waitcnt vmcnt(4) lgkmcnt(2)
    v_mfma_f32_16x16x32_bf16 v[104:107], v[92:95], v[52:55], v[104:107]
    v_mfma_f32_16x16x32_bf16 v[108:111], v[92:95], v[60:63], v[108:111]
    v_mfma_f32_16x16x32_bf16 v[112:115], v[96:99], v[52:55], v[112:115]
    v_mfma_f32_16x16x32_bf16 v[116:119], v[96:99], v[60:63], v[116:119]
    v_smfmac_f32_16x16x64_bf16 v[120:123], v[100:103], v[48:55], v13
    v_smfmac_f32_16x16x64_bf16 v[124:127], v[100:103], v[56:63], v13
    ds_read_b128 v[92:95], v12 offset:448
    ds_read_b128 v[96:99], v12 offset:8896
    ds_read_b128 v[100:103], v15 offset:384
    s_waitcnt vmcnt(2) lgkmcnt(3)
    v_mfma_f32_16x16x32_bf16 v[104:107], v[80:83], v[64:67], v[104:107]
    v_mfma_f32_16x16x32_bf16 v[108:111], v[80:83], v[72:75], v[108:111]
    v_mfma_f32_16x16x32_bf16 v[112:115], v[84:87], v[64:67], v[112:115]
    v_mfma_f32_16x16x32_bf16 v[116:119], v[84:87], v[72:75], v[116:119]
    s_waitcnt vmcnt(0) lgkmcnt(0)
    v_mfma_f32_16x16x32_bf16 v[104:107], v[92:95], v[68:71], v[104:107]
    v_mfma_f32_16x16x32_bf16 v[108:111], v[92:95], v[76:79], v[108:111]
    v_mfma_f32_16x16x32_bf16 v[112:115], v[96:99], v[68:71], v[112:115]
    v_mfma_f32_16x16x32_bf16 v[116:119], v[96:99], v[76:79], v[116:119]
    v_smfmac_f32_16x16x64_bf16 v[120:123], v[100:103], v[64:71], v13
    v_smfmac_f32_16x16x64_bf16 v[124:127], v[100:103], v[72:79], v13
    s_add_u32 s100, s100, 122880
    s_setprio 3
    s_add_u32 s100, s100, 4096
    buffer_load_dwordx4 v[48:51], v14, s[16:19], s100 offen offset:0 sc1
    buffer_load_dwordx4 v[56:59], v14, s[16:19], s100 offen offset:1024 sc1
    buffer_load_dwordx4 v[52:55], v14, s[16:19], s100 offen offset:2048 sc1
    buffer_load_dwordx4 v[60:63], v14, s[16:19], s100 offen offset:3072 sc1
    s_add_u32 s100, s100, 4096
    buffer_load_dwordx4 v[64:67], v14, s[16:19], s100 offen offset:0 sc1
    buffer_load_dwordx4 v[72:75], v14, s[16:19], s100 offen offset:1024 sc1
    buffer_load_dwordx4 v[68:71], v14, s[16:19], s100 offen offset:2048 sc1
    buffer_load_dwordx4 v[76:79], v14, s[16:19], s100 offen offset:3072 sc1
    s_setprio 0
    v_and_b32 v5, 15, v0
    v_lshlrev_b32 v5, 2, v5
    v_and_b32 v6, 16, v0
    v_lshl_add_u32 v5, v6, 2, v5
    s_lshl_b32 s58, s3, 6
    v_add_u32 v5, s58, v5
    v_and_b32 v5, 0x1ff, v5
    v_and_b32 v6, 48, v0
    v_lshl_add_u32 v5, v6, 8, v5
    s_mov_b32 s70, 0x05040100
    s_mov_b32 s71, 0x07060302
    s_mov_b32 s59, 0
Lw_41:
    ds_read_b32 v4, v3 offset:64
    s_waitcnt lgkmcnt(0)
    v_cmp_gt_u32 vcc, 8, v4
    s_cbranch_vccz Lk_42
    s_sleep 2
    s_add_u32 s59, s59, 1
    s_cmp_lt_u32 s59, 16777216
    s_cbranch_scc1 Lw_41
    s_branch L_end
Lk_42:
    ds_read2st64_b32 v[80:81], v5 offset0:0 offset1:2
    ds_read2st64_b32 v[82:83], v5 offset0:4 offset1:6
    ds_read2st64_b32 v[84:85], v5 offset0:8 offset1:10
    ds_read2st64_b32 v[86:87], v5 offset0:12 offset1:14
    ds_read2st64_b32 v[88:89], v5 offset0:64 offset1:66
    ds_read2st64_b32 v[90:91], v5 offset0:68 offset1:70
    ds_read2st64_b32 v[92:93], v5 offset0:72 offset1:74
    ds_read2st64_b32 v[94:95], v5 offset0:76 offset1:78
    ds_read2st64_b32 v[96:97], v5 offset0:128 offset1:130
    ds_read2st64_b32 v[98:99], v5 offset0:132 offset1:134
    ds_read2st64_b32 v[100:101], v5 offset0:136 offset1:138
    ds_read2st64_b32 v[102:103], v5 offset0:140 offset1:142
    s_waitcnt lgkmcnt(8)
    v_perm_b32 v16, v81, v80, s70
    v_perm_b32 v24, v81, v80, s71
    v_perm_b32 v17, v83, v82, s70
    v_perm_b32 v25, v83, v82, s71
    v_perm_b32 v18, v85, v84, s70
    v_perm_b32 v26, v85, v84, s71
    v_perm_b32 v19, v87, v86, s70
    v_perm_b32 v27, v87, v86, s71
    ds_read2st64_b32 v[80:81], v5 offset0:192 offset1:194
    ds_read2st64_b32 v[82:83], v5 offset0:196 offset1:198
    ds_read2st64_b32 v[84:85], v5 offset0:200 offset1:202
    ds_read2st64_b32 v[86:87], v5 offset0:204 offset1:206
    s_waitcnt lgkmcnt(8)
    v_perm_b32 v20, v89, v88, s70
    v_perm_b32 v28, v89, v88, s71
    v_perm_b32 v21, v91, v90, s70
    v_perm_b32 v29, v91, v90, s71
    v_perm_b32 v22, v93, v92, s70
    v_perm_b32 v30, v93, v92, s71
    v_perm_b32 v23, v95, v94, s70
    v_perm_b32 v31, v95, v94, s71
    s_waitcnt lgkmcnt(4)
    v_perm_b32 v32, v97, v96, s70
    v_perm_b32 v40, v97, v96, s71
    v_perm_b32 v33, v99, v98, s70
    v_perm_b32 v41, v99, v98, s71
    v_perm_b32 v34, v101, v100, s70
    v_perm_b32 v42, v101, v100, s71
    v_perm_b32 v35, v103, v102, s70
    v_perm_b32 v43, v103, v102, s71
    s_waitcnt lgkmcnt(0)
    v_perm_b32 v36, v81, v80, s70
    v_perm_b32 v44, v81, v80, s71
    v_perm_b32 v37, v83, v82, s70
    v_perm_b32 v45, v83, v82, s71
    v_perm_b32 v38, v85, v84, s70
    v_perm_b32 v46, v85, v84, s71
    v_perm_b32 v39, v87, v86, s70
    v_perm_b32 v47, v87, v86, s71
    v_add_u32 v12, 130944, v1
    s_mov_b32 s59, 0
Lw_43:
    ds_read_b32 v4, v3 offset:36
    s_waitcnt lgkmcnt(0)
    v_cmp_gt_u32 vcc, 16, v4
    s_cbranch_vccz Lk_44
    s_sleep 3
    s_add_u32 s59, s59, 1
    s_cmp_lt_u32 s59, 16777216
    s_cbranch_scc1 Lw_43
    s_branch L_end
Lk_44:
    ds_read_b128 v[80:83], v12 offset:0
    ds_read_b128 v[84:87], v12 offset:64
    ds_read_b128 v[88:91], v12 offset:128
    ds_read_b128 v[92:95], v12 offset:192
    ds_read_b128 v[96:99], v12 offset:256
    ds_read_b128 v[100:103], v12 offset:320
    s_waitcnt vmcnt(14) lgkmcnt(5)
    v_mfma_f32_16x16x32_bf16 v[104:107], v[80:83], v[16:19], v[104:107]
    v_mfma_f32_16x16x32_bf16 v[108:111], v[80:83], v[24:27], v[108:111]
    ds_read_b128 v[80:83], v12 offset:384
    s_waitcnt vmcnt(12) lgkmcnt(5)
    v_mfma_f32_16x16x32_bf16 v[104:107], v[84:87], v[20:23], v[104:107]
    v_mfma_f32_16x16x32_bf16 v[108:111], v[84:87], v[28:31], v[108:111]
    ds_read_b128 v[84:87], v12 offset:448
    s_waitcnt vmcnt(10) lgkmcnt(5)
    v_mfma_f32_16x16x32_bf16 v[104:107], v[88:91], v[32:35], v[104:107]
    v_mfma_f32_16x16x32_bf16 v[108:111], v[88:91], v[40:43], v[108:111]
    s_waitcnt vmcnt(8) lgkmcnt(4)
    v_mfma_f32_16x16x32_bf16 v[104:107], v[92:95], v[36:39], v[104:107]
    v_mfma_f32_16x16x32_bf16 v[108:111], v[92:95], v[44:47], v[108:111]
    s_waitcnt vmcnt(6) lgkmcnt(3)
    v_mfma_f32_16x16x32_bf16 v[104:107], v[96:99], v[48:51], v[104:107]
    v_mfma_f32_16x16x32_bf16 v[108:111], v[96:99], v[56:59], v[108:111]
    s_waitcnt vmcnt(4) lgkmcnt(2)
    v_mfma_f32_16x16x32_bf16 v[104:107], v[100:103], v[52:55], v[104:107]
    v_mfma_f32_16x16x32_bf16 v[108:111], v[100:103], v[60:63], v[108:111]
    s_waitcnt vmcnt(2) lgkmcnt(1)
    v_mfma_f32_16x16x32_bf16 v[104:107], v[80:83], v[64:67], v[104:107]
    v_mfma_f32_16x16x32_bf16 v[108:111], v[80:83], v[72:75], v[108:111]
    s_waitcnt vmcnt(0) lgkmcnt(0)
    v_mfma_f32_16x16x32_bf16 v[104:107], v[84:87], v[68:71], v[104:107]
    v_mfma_f32_16x16x32_bf16 v[108:111], v[84:87], v[76:79], v[108:111]
    s_nop 7
    v_cvt_pk_bf16_f32 v104, v104, v108
    buffer_store_dword v104, v8, s[20:23], s60 offen offset:0 sc1
    v_cvt_pk_bf16_f32 v105, v105, v109
    buffer_store_dword v105, v8, s[20:23], s60 offen offset:512 sc1
    v_cvt_pk_bf16_f32 v106, v106, v110
    buffer_store_dword v106, v8, s[20:23], s60 offen offset:1024 sc1
    v_cvt_pk_bf16_f32 v107, v107, v111
    buffer_store_dword v107, v8, s[20:23], s60 offen offset:1536 sc1
    s_add_u32 s60, s60, 8192
    s_mov_b32 s59, 0
Lw_45:
    ds_read_b32 v4, v3 offset:40
    s_waitcnt lgkmcnt(0)
    v_cmp_gt_u32 vcc, 16, v4
    s_cbranch_vccz Lk_46
    s_sleep 3
    s_add_u32 s59, s59, 1
    s_cmp_lt_u32 s59, 16777216
    s_cbranch_scc1 Lw_45
    s_branch L_end
Lk_46:
    ds_read_b128 v[80:83], v12 offset:8448
    ds_read_b128 v[84:87], v12 offset:8512
    ds_read_b128 v[88:91], v12 offset:8576
    ds_read_b128 v[92:95], v12 offset:8640
    ds_read_b128 v[96:99], v12 offset:8704
    ds_read_b128 v[100:103], v12 offset:8768
    s_waitcnt lgkmcnt(5)
    v_mfma_f32_16x16x32_bf16 v[112:115], v[80:83], v[16:19], v[112:115]
    v_mfma_f32_16x16x32_bf16 v[116:119], v[80:83], v[24:27], v[116:119]
    ds_read_b128 v[80:83], v12 offset:8832
    s_waitcnt lgkmcnt(5)
    v_mfma_f32_16x16x32_bf16 v[112:115], v[84:87], v[20:23], v[112:115]
    v_mfma_f32_16x16x32_bf16 v[116:119], v[84:87], v[28:31], v[116:119]
    ds_read_b128 v[84:87], v12 offset:8896
    s_waitcnt lgkmcnt(5)
    v_mfma_f32_16x16x32_bf16 v[112:115], v[88:91], v[32:35], v[112:115]
    v_mfma_f32_16x16x32_bf16 v[116:119], v[88:91], v[40:43], v[116:119]
    s_waitcnt lgkmcnt(4)
    v_mfma_f32_16x16x32_bf16 v[112:115], v[92:95], v[36:39], v[112:115]
    v_mfma_f32_16x16x32_bf16 v[116:119], v[92:95], v[44:47], v[116:119]
    s_waitcnt lgkmcnt(3)
    v_mfma_f32_16x16x32_bf16 v[112:115], v[96:99], v[48:51], v[112:115]
    v_mfma_f32_16x16x32_bf16 v[116:119], v[96:99], v[56:59], v[116:119]
    s_waitcnt lgkmcnt(2)
    v_mfma_f32_16x16x32_bf16 v[112:115], v[100:103], v[52:55], v[112:115]
    v_mfma_f32_16x16x32_bf16 v[116:119], v[100:103], v[60:63], v[116:119]
    s_waitcnt lgkmcnt(1)
    v_mfma_f32_16x16x32_bf16 v[112:115], v[80:83], v[64:67], v[112:115]
    v_mfma_f32_16x16x32_bf16 v[116:119], v[80:83], v[72:75], v[116:119]
    s_waitcnt lgkmcnt(0)
    v_mfma_f32_16x16x32_bf16 v[112:115], v[84:87], v[68:71], v[112:115]
    v_mfma_f32_16x16x32_bf16 v[116:119], v[84:87], v[76:79], v[116:119]
    s_nop 7
    v_cvt_pk_bf16_f32 v112, v112, v116
    buffer_store_dword v112, v8, s[20:23], s60 offen offset:0 sc1
    v_cvt_pk_bf16_f32 v113, v113, v117
    buffer_store_dword v113, v8, s[20:23], s60 offen offset:512 sc1
    v_cvt_pk_bf16_f32 v114, v114, v118
    buffer_store_dword v114, v8, s[20:23], s60 offen offset:1024 sc1
    v_cvt_pk_bf16_f32 v115, v115, v119
    buffer_store_dword v115, v8, s[20:23], s60 offen offset:1536 sc1
    s_add_u32 s60, s60, 8192
    v_add_u32 v15, 25344, v15
    s_mov_b32 s59, 0
Lw_47:
    ds_read_b32 v4, v3 offset:44
    s_waitcnt lgkmcnt(0)
    v_cmp_gt_u32 vcc, 8, v4
    s_cbranch_vccz Lk_48
    s_add_u32 s59, s59, 1
    s_cmp_lt_u32 s59, 16777216
    s_cbranch_scc1 Lw_47
    s_branch L_end
Lk_48:
    ds_read_b128 v[80:83], v15 offset:0
    ds_read_b128 v[84:87], v15 offset:128
    ds_read_b128 v[88:91], v15 offset:256
    ds_read_b128 v[92:95], v15 offset:384
    s_waitcnt lgkmcnt(3)
    v_smfmac_f32_16x16x64_bf16 v[120:123], v[80:83], v[16:23], v13
    v_smfmac_f32_16x16x64_bf16 v[124:127], v[80:83], v[24:31], v13
    s_waitcnt lgkmcnt(2)
    v_smfmac_f32_16x16x64_bf16 v[120:123], v[84:87], v[32:39], v13
    v_smfmac_f32_16x16x64_bf16 v[124:127], v[84:87], v[40:47], v13
    s_waitcnt lgkmcnt(1)
    v_smfmac_f32_16x16x64_bf16 v[120:123], v[88:91], v[48:55], v13
    v_smfmac_f32_16x16x64_bf16 v[124:127], v[88:91], v[56:63], v13
    s_waitcnt lgkmcnt(0)
    v_smfmac_f32_16x16x64_bf16 v[120:123], v[92:95], v[64:71], v13
    v_smfmac_f32_16x16x64_bf16 v[124:127], v[92:95], v[72:79], v13
    s_nop 6
    v_permlane16_swap_b32 v120, v122
    v_permlane16_swap_b32 v121, v123
    v_permlane16_swap_b32 v124, v126
    v_permlane16_swap_b32 v125, v127
    v_pk_add_f32 v[120:121], v[120:121], v[122:123]
    v_pk_add_f32 v[124:125], v[124:125], v[126:127]
    v_cvt_pk_bf16_f32 v120, v120, v124
    buffer_store_dword v120, v9, s[20:23], s60 offen offset:0 sc1
    v_cvt_pk_bf16_f32 v121, v121, v125
    buffer_store_dword v121, v9, s[20:23], s60 offen offset:512 sc1
L_end:
L_exit:
    s_endpgm
L_slow:
    s_setprio 0
    s_mov_b64 exec, 1
    ds_add_u32 v3, v62 offset:16
    s_mov_b64 exec, -1
    s_mov_b32 s59, 0
Lw_49:
    ds_read_b32 v4, v3 offset:16
    s_waitcnt lgkmcnt(0)
    v_cmp_gt_u32 vcc, 8, v4
    s_cbranch_vccz Lk_50
    s_add_u32 s59, s59, 1
    s_cmp_lt_u32 s59, 4194304
    s_cbranch_scc1 Lw_49
    s_branch L_end
Lk_50:
    v_mov_b32 v12, v3
    s_mov_b64 s[24:25], s[34:35]
    s_mov_b32 s26, 640000
    s_mov_b64 s[28:29], s[36:37]
    s_mov_b32 s30, 640000
    s_mov_b64 s[12:13], s[42:43]
    s_mov_b32 s14, 20000
    s_mov_b32 s15, 0x20000
    s_sub_u32 s63, s67, 1
    s_mov_b32 s65, 201486784
    s_mov_b32 s64, 0
    s_mov_b32 s62, 0
    s_call_b64 s[68:69], L_flush
    s_add_u32 s66, s4, s5
    s_add_u32 s67, s66, 40
    v_lshlrev_b32 v16, 2, v0
    v_and_b32 v17, 32, v0
    v_lshl_add_u32 v17, v17, 22, v2
    v_mov_b64 v[24:25], 0
    v_mov_b64 v[26:27], 0
L_sn:
    s_mov_b32 s60, 0
L_sc:
    buffer_load_dword v18, v16, s[28:31], s60 offen
    buffer_load_dword v19, v16, s[24:27], s60 offen
    s_waitcnt vmcnt(0)
    v_cmp_eq_u32 vcc, s66, v18
    s_cbranch_vccz L_sx
L_se:
    s_ff1_i32_b64 s58, vcc
    s_bitset0_b64 vcc, s58
    v_readlane_b32 s59, v19, s58
    s_nop 3
    s_lshl_b32 s61, s59, 9
    s_lshl_b32 s59, s59, 1
    buffer_load_dwordx4 v[20:23], v17, s[8:11], s61 offen
    buffer_load_ushort v1, v24, s[12:15], s59 offen
    s_waitcnt vmcnt(0)
    v_mov_b32_dpp v76, v1 row_newbcast:0 row_mask:0xf bank_mask:1
    v_mov_b32_dpp v77, v1 row_newbcast:0 row_mask:0xf bank_mask:2
    v_mov_b32_dpp v78, v1 row_newbcast:0 row_mask:0xf bank_mask:4
    v_mov_b32_dpp v79, v1 row_newbcast:0 row_mask:0xf bank_mask:8
    s_nop 1
    v_smfmac_f32_16x16x64_bf16 v[56:59], v[76:79], v[20:27], v10
    s_cmp_lg_u64 vcc, 0
    s_cbranch_scc1 L_se
L_sx:
    s_add_u32 s60, s60, 256
    s_cmp_lt_u32 s60, 640000
    s_cbranch_scc1 L_sc
    s_call_b64 s[68:69], L_flush
    s_add_u32 s66, s66, 8
    s_cmp_lt_u32 s66, s67
    s_cbranch_scc1 L_sn
    s_branch L_gdone
.section .rodata,"a"
.p2align 6
.amdhsa_kernel standalone__hybrid_graph_tf_exphormer__graph_kernel
  .amdhsa_next_free_vgpr 128
  .amdhsa_next_free_sgpr 102
  .amdhsa_accum_offset 128
  .amdhsa_group_segment_fixed_size 0
  .amdhsa_kernarg_size 104
  .amdhsa_user_sgpr_count 2
  .amdhsa_user_sgpr_kernarg_segment_ptr 1
  .amdhsa_system_sgpr_workgroup_id_x 1
.end_amdhsa_kernel
```
